```python
import torch

def _softmax(x, axis=-1):
    return torch.softmax(x, dim=axis)

def _gelu(x):
    return torch.nn.functional.gelu(x, approximate='tanh')

def _silu(x):
    return torch.nn.functional.silu(x)

def _sigmoid(x):
    return torch.sigmoid(x)

def _layernorm(x, axis=-1, eps=1e-05):
    m = x.mean(dim=axis, keepdim=True)
    v = x.var(dim=axis, keepdim=True, unbiased=False)
    return (x - m) / torch.sqrt(v + eps)

def _scatter_add(tgt, idx, src, axis=0):
    return tgt.clone().index_add_(axis, idx, src)

def _segment_sum(src, seg, n):
    out = torch.zeros((n,) + src.shape[1:], dtype=src.dtype)
    return out.index_add_(0, seg, src)

def _pad(x, pw):
    flat = tuple((v for pair in reversed(pw) for v in pair))
    return torch.nn.functional.pad(x, flat)
kernel_name = 'recurrent_scan__memory_aug_recurrent_mem_tr__glu_gated_glu__prompt'

def setup_inputs():

    _w = lambda a: (lambda t: t.to(torch.bfloat16) if t.is_floating_point() else t)(torch.as_tensor(a))

    def _A_setup():
        B, S, Dm = (1, 2048, 1024)
        H, Dh = (32, 128)
        M, seg = (8, 32)
        seg = min(seg, S)
        S = S // seg * seg
        return {'x': _w((lambda *s: torch.randn(*s, dtype=torch.bfloat16) * 0.05)(B, S, Dm)), 'mem0': _w((lambda *s: torch.randn(*s, dtype=torch.bfloat16) * 0.2)(B, M, Dm)), 'Wq': _w((lambda *s: torch.randn(*s, dtype=torch.bfloat16) * 0.8)(Dm, H, Dh) * Dm ** (-0.5)), 'Wk': _w((lambda *s: torch.randn(*s, dtype=torch.bfloat16) * 0.8)(Dm, H, Dh) * Dm ** (-0.5)), 'Wv': _w((lambda *s: torch.randn(*s, dtype=torch.bfloat16) * 0.2)(Dm, H, Dh) * Dm ** (-0.5)), 'Wo': _w((lambda *s: torch.randn(*s, dtype=torch.bfloat16) * 0.2)(H, Dh, Dm) * (H * Dh) ** (-0.5)), 'seg_len': seg}
    _A_in = _A_setup()

    def _B_setup():
        B, S, D, F = (1, 2048, 1024, 3584)
        return {'x': _w((lambda *s: torch.randn(*s, dtype=torch.bfloat16) * 0.05)(B, S, D)), 'w_gate': _w((lambda *s: torch.randn(*s, dtype=torch.bfloat16) * 0.2)(D, F)), 'w_up': _w((lambda *s: torch.randn(*s, dtype=torch.bfloat16) * 0.1)(D, F)), 'w_down': _w((lambda *s: torch.randn(*s, dtype=torch.bfloat16) * 0.1)(F, D))}
    _B_in = _B_setup()
    return {'A_x': _A_in['x'], 'A_mem0': _A_in['mem0'], 'A_Wq': _A_in['Wq'], 'A_Wk': _A_in['Wk'], 'A_Wv': _A_in['Wv'], 'A_Wo': _A_in['Wo'], 'A_seg_len': _A_in['seg_len'], 'B_x': _B_in['x'], 'B_w_gate': _B_in['w_gate'], 'B_w_up': _B_in['w_up'], 'B_w_down': _B_in['w_down']}

def reference(A_x, A_mem0, A_Wq, A_Wk, A_Wv, A_Wo, A_seg_len, B_x, B_w_gate, B_w_up, B_w_down):

    def _A_ref(x, mem0, Wq, Wk, Wv, Wo, seg_len):
        B, S, Dm = x.shape
        H, Dh = (Wq.shape[1], Wq.shape[2])
        M = mem0.shape[1]
        scale = Dh ** (-0.5)
        n_seg = S // seg_len
        L = M + seg_len
        idx = torch.arange(L)
        mask = (idx[:, None] < M) | (idx[:, None] >= idx[None, :])
        mem = mem0
        outs = []
        for s in range(n_seg):
            xs = x[:, s * seg_len:(s + 1) * seg_len, :].clone()
            h = torch.concatenate([mem, xs], axis=1)
            q = torch.einsum('btd,dhe->bhte', h, Wq)
            k = torch.einsum('btd,dhe->bhte', h, Wk)
            v = torch.einsum('btd,dhe->bhte', h, Wv)
            scores = torch.einsum('bhqe,bhke->bhqk', q, k) * scale
            scores = torch.where(mask[None, None], scores, -1000000000.0)
            p = _softmax(scores, axis=-1)
            o = torch.einsum('bhqk,bhke->bhqe', p, v)
            o = torch.einsum('bhte,hed->btd', o, Wo)
            mem = o[:, :M, :].clone()
            outs.append(o[:, M:, :])
        return torch.concatenate(outs, axis=1)

    def _B_ref(x, w_gate, w_up, w_down):
        g = torch.einsum('bsd,df->bsf', x, w_gate)
        u = torch.einsum('bsd,df->bsf', x, w_up)
        h = _sigmoid(g) * u
        return torch.einsum('bsf,fd->bsd', h, w_down)
    x = A_x
    xn = _layernorm(x, axis=-1)
    s = _A_ref(xn, A_mem0, A_Wq, A_Wk, A_Wv, A_Wo, A_seg_len)
    g = _silu(_B_ref(xn, B_w_gate, B_w_up, B_w_down))
    return x + s * g
```

```asm
; @launch grid=(256,1,1) block=(512,1,1) lds=163840
.amdgcn_target "amdgcn-amd-amdhsa--gfx950"
.text
.globl recurrent_scan__memory_aug_recurrent_mem_tr__glu_gated_glu__prompt_kernel
.p2align 8
.type recurrent_scan__memory_aug_recurrent_mem_tr__glu_gated_glu__prompt_kernel,@function
recurrent_scan__memory_aug_recurrent_mem_tr__glu_gated_glu__prompt_kernel:
    s_cmp_ge_u32 s2, 256
    s_cbranch_scc1 k_exit
    s_mov_b32 s99, s2
    s_load_dwordx2 s[4:5], s[0:1], 104
    s_load_dwordx2 s[64:65], s[0:1], 96
    v_lshrrev_b32 v2, 6, v0
    s_mov_b32 s6, 268435456
    s_mov_b32 s7, 131072
    s_mov_b32 s66, 256
    s_mov_b32 s67, 131072
    v_readfirstlane_b32 s3, v2
    s_lshr_b32 s13, s2, 3
    s_and_b32 s12, s2, 3
    s_waitcnt lgkmcnt(0)
    s_bitcmp0_b32 s2, 2
    s_cbranch_scc1 chain_map
    s_lshl_b32 s63, s13, 2
    s_add_u32 s63, s63, s12
    s_cmp_ge_u32 s3, 4
    s_cbranch_scc1 ln_touch
    s_load_dwordx2 s[8:9], s[0:1], 0
    v_and_b32 v1, 63, v0
    s_mov_b32 s10, 4194304
    s_mov_b32 s11, 131072
    v_and_b32 v3, 15, v1
    v_lshrrev_b32 v4, 4, v1
    v_lshlrev_b32 v5, 11, v3
    v_lshl_add_u32 v5, v4, 4, v5
    s_lshl_b32 s12, s63, 15
    s_lshl_b32 s13, s3, 9
    s_add_u32 s12, s12, s13
    s_waitcnt lgkmcnt(0)
    buffer_load_dwordx4 v[16:19], v5, s[8:11], s12 offen offset:0
    buffer_load_dwordx4 v[20:23], v5, s[8:11], s12 offen offset:64
    buffer_load_dwordx4 v[24:27], v5, s[8:11], s12 offen offset:128
    buffer_load_dwordx4 v[28:31], v5, s[8:11], s12 offen offset:192
    buffer_load_dwordx4 v[32:35], v5, s[8:11], s12 offen offset:256
    buffer_load_dwordx4 v[36:39], v5, s[8:11], s12 offen offset:320
    buffer_load_dwordx4 v[40:43], v5, s[8:11], s12 offen offset:384
    buffer_load_dwordx4 v[44:47], v5, s[8:11], s12 offen offset:448
    v_mov_b32 v14, 0
    s_lshl_b32 s13, s63, 7
    s_add_u32 s13, s13, 218103808
    v_lshlrev_b32 v13, 2, v0
    v_cmp_gt_u32 vcc, 32, v0
    s_and_saveexec_b64 s[22:23], vcc
    s_cbranch_execz ln_nz
    buffer_store_dword v14, v13, s[4:7], s13 offen sc1
ln_nz:
    s_mov_b64 exec, -1
    v_lshlrev_b32 v6, 4, v3
    s_lshl_b32 s14, s3, 2
    v_add_u32 v7, s14, v6
    v_lshlrev_b32 v8, 4, v1
    s_lshl_b32 s15, s63, 15
    s_lshl_b32 s16, s3, 13
    s_add_u32 s15, s15, s16
    s_add_u32 s16, s15, 4096
    v_and_b32 v9, 1, v4
    v_cmp_eq_u32 s[20:21], 1, v9
    s_waitcnt vmcnt(1)
    v_lshlrev_b32 v48, 16, v16
    v_and_b32 v49, 0xffff0000, v16
    v_lshlrev_b32 v50, 16, v17
    v_and_b32 v51, 0xffff0000, v17
    v_lshlrev_b32 v52, 16, v18
    v_and_b32 v53, 0xffff0000, v18
    v_lshlrev_b32 v54, 16, v19
    v_and_b32 v55, 0xffff0000, v19
    v_lshlrev_b32 v56, 16, v20
    v_and_b32 v57, 0xffff0000, v20
    v_lshlrev_b32 v58, 16, v21
    v_and_b32 v59, 0xffff0000, v21
    v_lshlrev_b32 v60, 16, v22
    v_and_b32 v61, 0xffff0000, v22
    v_lshlrev_b32 v62, 16, v23
    v_and_b32 v63, 0xffff0000, v23
    v_lshlrev_b32 v64, 16, v24
    v_and_b32 v65, 0xffff0000, v24
    v_lshlrev_b32 v66, 16, v25
    v_and_b32 v67, 0xffff0000, v25
    v_lshlrev_b32 v68, 16, v26
    v_and_b32 v69, 0xffff0000, v26
    v_lshlrev_b32 v70, 16, v27
    v_and_b32 v71, 0xffff0000, v27
    v_lshlrev_b32 v72, 16, v28
    v_and_b32 v73, 0xffff0000, v28
    v_lshlrev_b32 v74, 16, v29
    v_and_b32 v75, 0xffff0000, v29
    v_lshlrev_b32 v76, 16, v30
    v_and_b32 v77, 0xffff0000, v30
    v_lshlrev_b32 v78, 16, v31
    v_and_b32 v79, 0xffff0000, v31
    v_lshlrev_b32 v80, 16, v32
    v_and_b32 v81, 0xffff0000, v32
    v_lshlrev_b32 v82, 16, v33
    v_and_b32 v83, 0xffff0000, v33
    v_lshlrev_b32 v84, 16, v34
    v_and_b32 v85, 0xffff0000, v34
    v_lshlrev_b32 v86, 16, v35
    v_and_b32 v87, 0xffff0000, v35
    v_lshlrev_b32 v88, 16, v36
    v_and_b32 v89, 0xffff0000, v36
    v_lshlrev_b32 v90, 16, v37
    v_and_b32 v91, 0xffff0000, v37
    v_lshlrev_b32 v92, 16, v38
    v_and_b32 v93, 0xffff0000, v38
    v_lshlrev_b32 v94, 16, v39
    v_and_b32 v95, 0xffff0000, v39
    v_lshlrev_b32 v96, 16, v40
    v_and_b32 v97, 0xffff0000, v40
    v_lshlrev_b32 v98, 16, v41
    v_and_b32 v99, 0xffff0000, v41
    v_lshlrev_b32 v100, 16, v42
    v_and_b32 v101, 0xffff0000, v42
    v_lshlrev_b32 v102, 16, v43
    v_and_b32 v103, 0xffff0000, v43
    v_lshlrev_b32 v104, 16, v44
    v_and_b32 v105, 0xffff0000, v44
    v_lshlrev_b32 v106, 16, v45
    v_and_b32 v107, 0xffff0000, v45
    v_lshlrev_b32 v108, 16, v46
    v_and_b32 v109, 0xffff0000, v46
    v_lshlrev_b32 v110, 16, v47
    v_and_b32 v111, 0xffff0000, v47
    v_add_f32 v112, v48, v80
    v_add_f32 v113, v49, v81
    v_add_f32 v114, v50, v82
    v_add_f32 v115, v51, v83
    v_add_f32 v116, v52, v84
    v_add_f32 v117, v53, v85
    v_add_f32 v118, v54, v86
    v_add_f32 v119, v55, v87
    v_add_f32 v120, v56, v88
    v_add_f32 v121, v57, v89
    v_add_f32 v122, v58, v90
    v_add_f32 v123, v59, v91
    v_add_f32 v124, v60, v92
    v_add_f32 v125, v61, v93
    v_add_f32 v126, v62, v94
    v_add_f32 v127, v63, v95
    v_add_f32 v128, v64, v96
    v_add_f32 v129, v65, v97
    v_add_f32 v130, v66, v98
    v_add_f32 v131, v67, v99
    v_add_f32 v132, v68, v100
    v_add_f32 v133, v69, v101
    v_add_f32 v134, v70, v102
    v_add_f32 v135, v71, v103
    v_add_f32 v136, v72, v104
    v_add_f32 v137, v73, v105
    v_add_f32 v138, v74, v106
    v_add_f32 v139, v75, v107
    v_add_f32 v140, v76, v108
    v_add_f32 v141, v77, v109
    v_add_f32 v142, v78, v110
    v_add_f32 v143, v79, v111
    v_add_f32 v112, v112, v128
    v_add_f32 v113, v113, v129
    v_add_f32 v114, v114, v130
    v_add_f32 v115, v115, v131
    v_add_f32 v116, v116, v132
    v_add_f32 v117, v117, v133
    v_add_f32 v118, v118, v134
    v_add_f32 v119, v119, v135
    v_add_f32 v120, v120, v136
    v_add_f32 v121, v121, v137
    v_add_f32 v122, v122, v138
    v_add_f32 v123, v123, v139
    v_add_f32 v124, v124, v140
    v_add_f32 v125, v125, v141
    v_add_f32 v126, v126, v142
    v_add_f32 v127, v127, v143
    v_add_f32 v112, v112, v120
    v_add_f32 v113, v113, v121
    v_add_f32 v114, v114, v122
    v_add_f32 v115, v115, v123
    v_add_f32 v116, v116, v124
    v_add_f32 v117, v117, v125
    v_add_f32 v118, v118, v126
    v_add_f32 v119, v119, v127
    v_add_f32 v112, v112, v116
    v_add_f32 v113, v113, v117
    v_add_f32 v114, v114, v118
    v_add_f32 v115, v115, v119
    v_add_f32 v112, v112, v114
    v_add_f32 v113, v113, v115
    v_add_f32 v112, v112, v113
    v_mov_b32 v113, v112
    s_nop 1
    v_permlane16_swap_b32 v113, v112
    v_add_f32 v112, v112, v113
    v_mov_b32 v113, v112
    s_nop 1
    v_permlane32_swap_b32 v113, v112
    v_add_f32 v112, v112, v113
    ds_write_b32 v7, v112
    s_waitcnt lgkmcnt(0)
    s_barrier
    ds_read_b128 v[112:115], v6
    s_waitcnt lgkmcnt(0)
    v_add_f32 v112, v112, v114
    v_add_f32 v113, v113, v115
    v_add_f32 v112, v112, v113
    v_mul_f32 v10, 0x3a800000, v112
    v_sub_f32 v176, v48, v10
    v_sub_f32 v177, v49, v10
    v_sub_f32 v178, v50, v10
    v_sub_f32 v179, v51, v10
    v_sub_f32 v180, v52, v10
    v_sub_f32 v181, v53, v10
    v_sub_f32 v182, v54, v10
    v_sub_f32 v183, v55, v10
    v_sub_f32 v184, v56, v10
    v_sub_f32 v185, v57, v10
    v_sub_f32 v186, v58, v10
    v_sub_f32 v187, v59, v10
    v_sub_f32 v188, v60, v10
    v_sub_f32 v189, v61, v10
    v_sub_f32 v190, v62, v10
    v_sub_f32 v191, v63, v10
    v_sub_f32 v192, v64, v10
    v_sub_f32 v193, v65, v10
    v_sub_f32 v194, v66, v10
    v_sub_f32 v195, v67, v10
    v_sub_f32 v196, v68, v10
    v_sub_f32 v197, v69, v10
    v_sub_f32 v198, v70, v10
    v_sub_f32 v199, v71, v10
    v_sub_f32 v200, v72, v10
    v_sub_f32 v201, v73, v10
    v_sub_f32 v202, v74, v10
    v_sub_f32 v203, v75, v10
    v_sub_f32 v204, v76, v10
    v_sub_f32 v205, v77, v10
    v_sub_f32 v206, v78, v10
    v_sub_f32 v207, v79, v10
    v_sub_f32 v208, v80, v10
    v_sub_f32 v209, v81, v10
    v_sub_f32 v210, v82, v10
    v_sub_f32 v211, v83, v10
    v_sub_f32 v212, v84, v10
    v_sub_f32 v213, v85, v10
    v_sub_f32 v214, v86, v10
    v_sub_f32 v215, v87, v10
    v_sub_f32 v216, v88, v10
    v_sub_f32 v217, v89, v10
    v_sub_f32 v218, v90, v10
    v_sub_f32 v219, v91, v10
    v_sub_f32 v220, v92, v10
    v_sub_f32 v221, v93, v10
    v_sub_f32 v222, v94, v10
    v_sub_f32 v223, v95, v10
    v_sub_f32 v224, v96, v10
    v_sub_f32 v225, v97, v10
    v_sub_f32 v226, v98, v10
    v_sub_f32 v227, v99, v10
    v_sub_f32 v228, v100, v10
    v_sub_f32 v229, v101, v10
    v_sub_f32 v230, v102, v10
    v_sub_f32 v231, v103, v10
    v_sub_f32 v232, v104, v10
    v_sub_f32 v233, v105, v10
    v_sub_f32 v234, v106, v10
    v_sub_f32 v235, v107, v10
    v_sub_f32 v236, v108, v10
    v_sub_f32 v237, v109, v10
    v_sub_f32 v238, v110, v10
    v_sub_f32 v239, v111, v10
    v_mul_f32 v112, v176, v176
    v_fmac_f32 v112, v208, v208
    v_mul_f32 v113, v177, v177
    v_fmac_f32 v113, v209, v209
    v_mul_f32 v114, v178, v178
    v_fmac_f32 v114, v210, v210
    v_mul_f32 v115, v179, v179
    v_fmac_f32 v115, v211, v211
    v_mul_f32 v116, v180, v180
    v_fmac_f32 v116, v212, v212
    v_mul_f32 v117, v181, v181
    v_fmac_f32 v117, v213, v213
    v_mul_f32 v118, v182, v182
    v_fmac_f32 v118, v214, v214
    v_mul_f32 v119, v183, v183
    v_fmac_f32 v119, v215, v215
    v_mul_f32 v120, v184, v184
    v_fmac_f32 v120, v216, v216
    v_mul_f32 v121, v185, v185
    v_fmac_f32 v121, v217, v217
    v_mul_f32 v122, v186, v186
    v_fmac_f32 v122, v218, v218
    v_mul_f32 v123, v187, v187
    v_fmac_f32 v123, v219, v219
    v_mul_f32 v124, v188, v188
    v_fmac_f32 v124, v220, v220
    v_mul_f32 v125, v189, v189
    v_fmac_f32 v125, v221, v221
    v_mul_f32 v126, v190, v190
    v_fmac_f32 v126, v222, v222
    v_mul_f32 v127, v191, v191
    v_fmac_f32 v127, v223, v223
    v_mul_f32 v128, v192, v192
    v_fmac_f32 v128, v224, v224
    v_mul_f32 v129, v193, v193
    v_fmac_f32 v129, v225, v225
    v_mul_f32 v130, v194, v194
    v_fmac_f32 v130, v226, v226
    v_mul_f32 v131, v195, v195
    v_fmac_f32 v131, v227, v227
    v_mul_f32 v132, v196, v196
    v_fmac_f32 v132, v228, v228
    v_mul_f32 v133, v197, v197
    v_fmac_f32 v133, v229, v229
    v_mul_f32 v134, v198, v198
    v_fmac_f32 v134, v230, v230
    v_mul_f32 v135, v199, v199
    v_fmac_f32 v135, v231, v231
    v_mul_f32 v136, v200, v200
    v_fmac_f32 v136, v232, v232
    v_mul_f32 v137, v201, v201
    v_fmac_f32 v137, v233, v233
    v_mul_f32 v138, v202, v202
    v_fmac_f32 v138, v234, v234
    v_mul_f32 v139, v203, v203
    v_fmac_f32 v139, v235, v235
    v_mul_f32 v140, v204, v204
    v_fmac_f32 v140, v236, v236
    v_mul_f32 v141, v205, v205
    v_fmac_f32 v141, v237, v237
    v_mul_f32 v142, v206, v206
    v_fmac_f32 v142, v238, v238
    v_mul_f32 v143, v207, v207
    v_fmac_f32 v143, v239, v239
    v_add_f32 v112, v112, v128
    v_add_f32 v113, v113, v129
    v_add_f32 v114, v114, v130
    v_add_f32 v115, v115, v131
    v_add_f32 v116, v116, v132
    v_add_f32 v117, v117, v133
    v_add_f32 v118, v118, v134
    v_add_f32 v119, v119, v135
    v_add_f32 v120, v120, v136
    v_add_f32 v121, v121, v137
    v_add_f32 v122, v122, v138
    v_add_f32 v123, v123, v139
    v_add_f32 v124, v124, v140
    v_add_f32 v125, v125, v141
    v_add_f32 v126, v126, v142
    v_add_f32 v127, v127, v143
    v_add_f32 v112, v112, v120
    v_add_f32 v113, v113, v121
    v_add_f32 v114, v114, v122
    v_add_f32 v115, v115, v123
    v_add_f32 v116, v116, v124
    v_add_f32 v117, v117, v125
    v_add_f32 v118, v118, v126
    v_add_f32 v119, v119, v127
    v_add_f32 v112, v112, v116
    v_add_f32 v113, v113, v117
    v_add_f32 v114, v114, v118
    v_add_f32 v115, v115, v119
    v_add_f32 v112, v112, v114
    v_add_f32 v113, v113, v115
    v_add_f32 v112, v112, v113
    v_mov_b32 v113, v112
    s_nop 1
    v_permlane16_swap_b32 v113, v112
    v_add_f32 v112, v112, v113
    v_mov_b32 v113, v112
    s_nop 1
    v_permlane32_swap_b32 v113, v112
    v_add_f32 v112, v112, v113
    ds_write_b32 v7, v112 offset:512
    s_waitcnt lgkmcnt(0)
    s_barrier
    ds_read_b128 v[112:115], v6 offset:512
    s_waitcnt lgkmcnt(0)
    v_add_f32 v112, v112, v114
    v_add_f32 v113, v113, v115
    v_add_f32 v112, v112, v113
    v_mul_f32 v11, 0x3a800000, v112
    v_cvt_pk_bf16_f32 v10, v10, v10
    v_lshlrev_b32 v10, 16, v10
    v_cvt_pk_bf16_f32 v11, v11, v11
    v_lshlrev_b32 v11, 16, v11
    v_add_f32 v11, 0x3727c5ac, v11
    v_cvt_pk_bf16_f32 v11, v11, v11
    v_lshlrev_b32 v11, 16, v11
    v_sqrt_f32 v11, v11
    s_nop 0
    v_cvt_pk_bf16_f32 v11, v11, v11
    v_lshlrev_b32 v11, 16, v11
    v_rcp_f32 v11, v11
    s_nop 0
    v_sub_f32 v48, v48, v10
    v_sub_f32 v49, v49, v10
    v_cvt_pk_bf16_f32 v16, v48, v49
    v_lshlrev_b32 v48, 16, v16
    v_and_b32 v49, 0xffff0000, v16
    v_mul_f32 v48, v48, v11
    v_mul_f32 v49, v49, v11
    v_cvt_pk_bf16_f32 v16, v48, v49
    v_sub_f32 v50, v50, v10
    v_sub_f32 v51, v51, v10
    v_cvt_pk_bf16_f32 v17, v50, v51
    v_lshlrev_b32 v50, 16, v17
    v_and_b32 v51, 0xffff0000, v17
    v_mul_f32 v50, v50, v11
    v_mul_f32 v51, v51, v11
    v_cvt_pk_bf16_f32 v17, v50, v51
    v_sub_f32 v52, v52, v10
    v_sub_f32 v53, v53, v10
    v_cvt_pk_bf16_f32 v18, v52, v53
    v_lshlrev_b32 v52, 16, v18
    v_and_b32 v53, 0xffff0000, v18
    v_mul_f32 v52, v52, v11
    v_mul_f32 v53, v53, v11
    v_cvt_pk_bf16_f32 v18, v52, v53
    v_sub_f32 v54, v54, v10
    v_sub_f32 v55, v55, v10
    v_cvt_pk_bf16_f32 v19, v54, v55
    v_lshlrev_b32 v54, 16, v19
    v_and_b32 v55, 0xffff0000, v19
    v_mul_f32 v54, v54, v11
    v_mul_f32 v55, v55, v11
    v_cvt_pk_bf16_f32 v19, v54, v55
    v_cndmask_b32 v112, v16, v18, s[20:21]
    v_cndmask_b32 v113, v17, v19, s[20:21]
    v_cndmask_b32 v114, v18, v16, s[20:21]
    v_cndmask_b32 v115, v19, v17, s[20:21]
    buffer_store_dwordx4 v[112:115], v8, s[4:7], s15 offen offset:0 sc1
    v_sub_f32 v56, v56, v10
    v_sub_f32 v57, v57, v10
    v_cvt_pk_bf16_f32 v20, v56, v57
    v_lshlrev_b32 v56, 16, v20
    v_and_b32 v57, 0xffff0000, v20
    v_mul_f32 v56, v56, v11
    v_mul_f32 v57, v57, v11
    v_cvt_pk_bf16_f32 v20, v56, v57
    v_sub_f32 v58, v58, v10
    v_sub_f32 v59, v59, v10
    v_cvt_pk_bf16_f32 v21, v58, v59
    v_lshlrev_b32 v58, 16, v21
    v_and_b32 v59, 0xffff0000, v21
    v_mul_f32 v58, v58, v11
    v_mul_f32 v59, v59, v11
    v_cvt_pk_bf16_f32 v21, v58, v59
    v_sub_f32 v60, v60, v10
    v_sub_f32 v61, v61, v10
    v_cvt_pk_bf16_f32 v22, v60, v61
    v_lshlrev_b32 v60, 16, v22
    v_and_b32 v61, 0xffff0000, v22
    v_mul_f32 v60, v60, v11
    v_mul_f32 v61, v61, v11
    v_cvt_pk_bf16_f32 v22, v60, v61
    v_sub_f32 v62, v62, v10
    v_sub_f32 v63, v63, v10
    v_cvt_pk_bf16_f32 v23, v62, v63
    v_lshlrev_b32 v62, 16, v23
    v_and_b32 v63, 0xffff0000, v23
    v_mul_f32 v62, v62, v11
    v_mul_f32 v63, v63, v11
    v_cvt_pk_bf16_f32 v23, v62, v63
    v_cndmask_b32 v116, v20, v22, s[20:21]
    v_cndmask_b32 v117, v21, v23, s[20:21]
    v_cndmask_b32 v118, v22, v20, s[20:21]
    v_cndmask_b32 v119, v23, v21, s[20:21]
    buffer_store_dwordx4 v[116:119], v8, s[4:7], s15 offen offset:1024 sc1
    v_sub_f32 v64, v64, v10
    v_sub_f32 v65, v65, v10
    v_cvt_pk_bf16_f32 v24, v64, v65
    v_lshlrev_b32 v64, 16, v24
    v_and_b32 v65, 0xffff0000, v24
    v_mul_f32 v64, v64, v11
    v_mul_f32 v65, v65, v11
    v_cvt_pk_bf16_f32 v24, v64, v65
    v_sub_f32 v66, v66, v10
    v_sub_f32 v67, v67, v10
    v_cvt_pk_bf16_f32 v25, v66, v67
    v_lshlrev_b32 v66, 16, v25
    v_and_b32 v67, 0xffff0000, v25
    v_mul_f32 v66, v66, v11
    v_mul_f32 v67, v67, v11
    v_cvt_pk_bf16_f32 v25, v66, v67
    v_sub_f32 v68, v68, v10
    v_sub_f32 v69, v69, v10
    v_cvt_pk_bf16_f32 v26, v68, v69
    v_lshlrev_b32 v68, 16, v26
    v_and_b32 v69, 0xffff0000, v26
    v_mul_f32 v68, v68, v11
    v_mul_f32 v69, v69, v11
    v_cvt_pk_bf16_f32 v26, v68, v69
    v_sub_f32 v70, v70, v10
    v_sub_f32 v71, v71, v10
    v_cvt_pk_bf16_f32 v27, v70, v71
    v_lshlrev_b32 v70, 16, v27
    v_and_b32 v71, 0xffff0000, v27
    v_mul_f32 v70, v70, v11
    v_mul_f32 v71, v71, v11
    v_cvt_pk_bf16_f32 v27, v70, v71
    v_cndmask_b32 v120, v24, v26, s[20:21]
    v_cndmask_b32 v121, v25, v27, s[20:21]
    v_cndmask_b32 v122, v26, v24, s[20:21]
    v_cndmask_b32 v123, v27, v25, s[20:21]
    buffer_store_dwordx4 v[120:123], v8, s[4:7], s15 offen offset:2048 sc1
    v_sub_f32 v72, v72, v10
    v_sub_f32 v73, v73, v10
    v_cvt_pk_bf16_f32 v28, v72, v73
    v_lshlrev_b32 v72, 16, v28
    v_and_b32 v73, 0xffff0000, v28
    v_mul_f32 v72, v72, v11
    v_mul_f32 v73, v73, v11
    v_cvt_pk_bf16_f32 v28, v72, v73
    v_sub_f32 v74, v74, v10
    v_sub_f32 v75, v75, v10
    v_cvt_pk_bf16_f32 v29, v74, v75
    v_lshlrev_b32 v74, 16, v29
    v_and_b32 v75, 0xffff0000, v29
    v_mul_f32 v74, v74, v11
    v_mul_f32 v75, v75, v11
    v_cvt_pk_bf16_f32 v29, v74, v75
    v_sub_f32 v76, v76, v10
    v_sub_f32 v77, v77, v10
    v_cvt_pk_bf16_f32 v30, v76, v77
    v_lshlrev_b32 v76, 16, v30
    v_and_b32 v77, 0xffff0000, v30
    v_mul_f32 v76, v76, v11
    v_mul_f32 v77, v77, v11
    v_cvt_pk_bf16_f32 v30, v76, v77
    v_sub_f32 v78, v78, v10
    v_sub_f32 v79, v79, v10
    v_cvt_pk_bf16_f32 v31, v78, v79
    v_lshlrev_b32 v78, 16, v31
    v_and_b32 v79, 0xffff0000, v31
    v_mul_f32 v78, v78, v11
    v_mul_f32 v79, v79, v11
    v_cvt_pk_bf16_f32 v31, v78, v79
    v_cndmask_b32 v124, v28, v30, s[20:21]
    v_cndmask_b32 v125, v29, v31, s[20:21]
    v_cndmask_b32 v126, v30, v28, s[20:21]
    v_cndmask_b32 v127, v31, v29, s[20:21]
    buffer_store_dwordx4 v[124:127], v8, s[4:7], s15 offen offset:3072 sc1
    v_sub_f32 v80, v80, v10
    v_sub_f32 v81, v81, v10
    v_cvt_pk_bf16_f32 v32, v80, v81
    v_lshlrev_b32 v80, 16, v32
    v_and_b32 v81, 0xffff0000, v32
    v_mul_f32 v80, v80, v11
    v_mul_f32 v81, v81, v11
    v_cvt_pk_bf16_f32 v32, v80, v81
    v_sub_f32 v82, v82, v10
    v_sub_f32 v83, v83, v10
    v_cvt_pk_bf16_f32 v33, v82, v83
    v_lshlrev_b32 v82, 16, v33
    v_and_b32 v83, 0xffff0000, v33
    v_mul_f32 v82, v82, v11
    v_mul_f32 v83, v83, v11
    v_cvt_pk_bf16_f32 v33, v82, v83
    v_sub_f32 v84, v84, v10
    v_sub_f32 v85, v85, v10
    v_cvt_pk_bf16_f32 v34, v84, v85
    v_lshlrev_b32 v84, 16, v34
    v_and_b32 v85, 0xffff0000, v34
    v_mul_f32 v84, v84, v11
    v_mul_f32 v85, v85, v11
    v_cvt_pk_bf16_f32 v34, v84, v85
    v_sub_f32 v86, v86, v10
    v_sub_f32 v87, v87, v10
    v_cvt_pk_bf16_f32 v35, v86, v87
    v_lshlrev_b32 v86, 16, v35
    v_and_b32 v87, 0xffff0000, v35
    v_mul_f32 v86, v86, v11
    v_mul_f32 v87, v87, v11
    v_cvt_pk_bf16_f32 v35, v86, v87
    v_cndmask_b32 v128, v32, v34, s[20:21]
    v_cndmask_b32 v129, v33, v35, s[20:21]
    v_cndmask_b32 v130, v34, v32, s[20:21]
    v_cndmask_b32 v131, v35, v33, s[20:21]
    buffer_store_dwordx4 v[128:131], v8, s[4:7], s16 offen offset:0 sc1
    v_sub_f32 v88, v88, v10
    v_sub_f32 v89, v89, v10
    v_cvt_pk_bf16_f32 v36, v88, v89
    v_lshlrev_b32 v88, 16, v36
    v_and_b32 v89, 0xffff0000, v36
    v_mul_f32 v88, v88, v11
    v_mul_f32 v89, v89, v11
    v_cvt_pk_bf16_f32 v36, v88, v89
    v_sub_f32 v90, v90, v10
    v_sub_f32 v91, v91, v10
    v_cvt_pk_bf16_f32 v37, v90, v91
    v_lshlrev_b32 v90, 16, v37
    v_and_b32 v91, 0xffff0000, v37
    v_mul_f32 v90, v90, v11
    v_mul_f32 v91, v91, v11
    v_cvt_pk_bf16_f32 v37, v90, v91
    v_sub_f32 v92, v92, v10
    v_sub_f32 v93, v93, v10
    v_cvt_pk_bf16_f32 v38, v92, v93
    v_lshlrev_b32 v92, 16, v38
    v_and_b32 v93, 0xffff0000, v38
    v_mul_f32 v92, v92, v11
    v_mul_f32 v93, v93, v11
    v_cvt_pk_bf16_f32 v38, v92, v93
    v_sub_f32 v94, v94, v10
    v_sub_f32 v95, v95, v10
    v_cvt_pk_bf16_f32 v39, v94, v95
    v_lshlrev_b32 v94, 16, v39
    v_and_b32 v95, 0xffff0000, v39
    v_mul_f32 v94, v94, v11
    v_mul_f32 v95, v95, v11
    v_cvt_pk_bf16_f32 v39, v94, v95
    v_cndmask_b32 v132, v36, v38, s[20:21]
    v_cndmask_b32 v133, v37, v39, s[20:21]
    v_cndmask_b32 v134, v38, v36, s[20:21]
    v_cndmask_b32 v135, v39, v37, s[20:21]
    buffer_store_dwordx4 v[132:135], v8, s[4:7], s16 offen offset:1024 sc1
    v_sub_f32 v96, v96, v10
    v_sub_f32 v97, v97, v10
    v_cvt_pk_bf16_f32 v40, v96, v97
    v_lshlrev_b32 v96, 16, v40
    v_and_b32 v97, 0xffff0000, v40
    v_mul_f32 v96, v96, v11
    v_mul_f32 v97, v97, v11
    v_cvt_pk_bf16_f32 v40, v96, v97
    v_sub_f32 v98, v98, v10
    v_sub_f32 v99, v99, v10
    v_cvt_pk_bf16_f32 v41, v98, v99
    v_lshlrev_b32 v98, 16, v41
    v_and_b32 v99, 0xffff0000, v41
    v_mul_f32 v98, v98, v11
    v_mul_f32 v99, v99, v11
    v_cvt_pk_bf16_f32 v41, v98, v99
    v_sub_f32 v100, v100, v10
    v_sub_f32 v101, v101, v10
    v_cvt_pk_bf16_f32 v42, v100, v101
    v_lshlrev_b32 v100, 16, v42
    v_and_b32 v101, 0xffff0000, v42
    v_mul_f32 v100, v100, v11
    v_mul_f32 v101, v101, v11
    v_cvt_pk_bf16_f32 v42, v100, v101
    v_sub_f32 v102, v102, v10
    v_sub_f32 v103, v103, v10
    v_cvt_pk_bf16_f32 v43, v102, v103
    v_lshlrev_b32 v102, 16, v43
    v_and_b32 v103, 0xffff0000, v43
    v_mul_f32 v102, v102, v11
    v_mul_f32 v103, v103, v11
    v_cvt_pk_bf16_f32 v43, v102, v103
    v_cndmask_b32 v136, v40, v42, s[20:21]
    v_cndmask_b32 v137, v41, v43, s[20:21]
    v_cndmask_b32 v138, v42, v40, s[20:21]
    v_cndmask_b32 v139, v43, v41, s[20:21]
    buffer_store_dwordx4 v[136:139], v8, s[4:7], s16 offen offset:2048 sc1
    v_sub_f32 v104, v104, v10
    v_sub_f32 v105, v105, v10
    v_cvt_pk_bf16_f32 v44, v104, v105
    v_lshlrev_b32 v104, 16, v44
    v_and_b32 v105, 0xffff0000, v44
    v_mul_f32 v104, v104, v11
    v_mul_f32 v105, v105, v11
    v_cvt_pk_bf16_f32 v44, v104, v105
    v_sub_f32 v106, v106, v10
    v_sub_f32 v107, v107, v10
    v_cvt_pk_bf16_f32 v45, v106, v107
    v_lshlrev_b32 v106, 16, v45
    v_and_b32 v107, 0xffff0000, v45
    v_mul_f32 v106, v106, v11
    v_mul_f32 v107, v107, v11
    v_cvt_pk_bf16_f32 v45, v106, v107
    v_sub_f32 v108, v108, v10
    v_sub_f32 v109, v109, v10
    v_cvt_pk_bf16_f32 v46, v108, v109
    v_lshlrev_b32 v108, 16, v46
    v_and_b32 v109, 0xffff0000, v46
    v_mul_f32 v108, v108, v11
    v_mul_f32 v109, v109, v11
    v_cvt_pk_bf16_f32 v46, v108, v109
    v_sub_f32 v110, v110, v10
    v_sub_f32 v111, v111, v10
    v_cvt_pk_bf16_f32 v47, v110, v111
    v_lshlrev_b32 v110, 16, v47
    v_and_b32 v111, 0xffff0000, v47
    v_mul_f32 v110, v110, v11
    v_mul_f32 v111, v111, v11
    v_cvt_pk_bf16_f32 v47, v110, v111
    v_cndmask_b32 v140, v44, v46, s[20:21]
    v_cndmask_b32 v141, v45, v47, s[20:21]
    v_cndmask_b32 v142, v46, v44, s[20:21]
    v_cndmask_b32 v143, v47, v45, s[20:21]
    buffer_store_dwordx4 v[140:143], v8, s[4:7], s16 offen offset:3072 sc1
    s_waitcnt vmcnt(0)
    s_barrier
    s_cmp_lg_u32 s3, 0
    s_cbranch_scc1 ln_sig
    v_mov_b32 v2, 1
    s_mov_b64 exec, 1
    s_cmp_ge_u32 s63, 8
    s_cbranch_scc1 ln_sb
    buffer_atomic_add v2, off, s[64:67], 0 offset:192 sc1
ln_sb:
    buffer_atomic_add v2, off, s[64:67], 0 offset:0 sc1
    s_mov_b64 exec, -1
    s_branch ln_sig
ln_touch:
    s_getpc_b64 s[24:25]
    s_add_u32 s24, s24, jobtab@rel32@lo+4
    s_addc_u32 s25, s25, jobtab@rel32@hi+12
    s_mul_i32 s30, s63, 704
    s_add_u32 s24, s24, s30
    s_addc_u32 s25, s25, 0
    s_load_dwordx16 s[32:47], s[24:25], 0
    s_mov_b32 s11, 131072
    v_and_b32 v20, 63, v0
    s_waitcnt lgkmcnt(0)
    s_load_dwordx2 s[8:9], s[0:1], s33
    s_mov_b32 s10, s38
    s_lshl_b32 s30, s35, 4
    v_mul_lo_u32 v21, s30, v20
    v_and_b32 v22, 15, v20
    v_mul_lo_u32 v22, s43, v22
    s_waitcnt lgkmcnt(0)
    s_cmp_eq_u32 s3, 4
    s_cbranch_scc0 tlb_1_1
    buffer_load_dword v23, v21, s[8:11], s36 offen
    s_branch tlb_1
tlb_1_1:
    s_cmp_eq_u32 s3, 5
    s_cbranch_scc0 tlb_1
    buffer_load_dword v23, v22, s[4:7], s42 offen
    buffer_load_dword v23, off, s[4:7], s46
tlb_1:
    s_barrier
    s_barrier
    s_barrier
ln_sig:
    s_mov_b32 s29, s63
    v_and_b32 v20, 63, v0
    v_lshlrev_b32 v1, 4, v20
    v_add_u32 v19, 0x1000, v1
    v_lshrrev_b32 v4, 4, v20
    v_mov_b32 v17, 0
    v_mov_b32 v18, 1
    s_lshr_b32 s26, s3, 2
    s_and_b32 s27, s3, 3
    s_lshl_b32 s21, s3, 11
    s_lshl_b32 s22, s3, 10
    s_add_u32 s22, s22, 16384
    s_mov_b32 s11, 131072
    s_mov_b32 s15, 131072
    s_mov_b32 s28, 0
    v_and_b32 v21, 15, v20
    v_lshlrev_b32 v22, 2, v4
    v_xor_b32 v21, v21, v22
    s_lshr_b32 s30, s3, 1
    s_and_b32 s30, s30, 1
    v_xor_b32 v21, s30, v21
    v_lshlrev_b32 v3, 4, v21
    s_lshl_b32 s30, s26, 13
    v_add_u32 v5, s30, v1
    v_add_u32 v6, 0x10000, v5
    v_bfe_u32 v21, v20, 2, 2
    v_and_b32 v22, 3, v20
    v_and_b32 v23, 1, v4
    v_xor_b32 v24, s27, v21
    v_xor_b32 v25, v22, v23
    v_lshl_add_u32 v24, v24, 2, v25
    v_lshlrev_b32 v24, 4, v24
    v_lshl_add_u32 v25, v4, 3, v21
    v_lshl_add_u32 v24, v25, 8, v24
    v_and_b32 v22, 1, v22
    v_xor_b32 v25, 0, v23
    v_lshl_add_u32 v8, v25, 10, v24
    v_xor_b32 v25, 0, v22
    v_lshl_add_u32 v8, v25, 3, v8
    v_add_u32 v12, 0x10000, v8
    v_xor_b32 v25, 1, v23
    v_lshl_add_u32 v9, v25, 10, v24
    v_xor_b32 v25, 0, v22
    v_lshl_add_u32 v9, v25, 3, v9
    v_add_u32 v13, 0x10000, v9
    v_xor_b32 v25, 0, v23
    v_lshl_add_u32 v10, v25, 10, v24
    v_xor_b32 v25, 1, v22
    v_lshl_add_u32 v10, v25, 3, v10
    v_add_u32 v14, 0x10000, v10
    v_xor_b32 v25, 1, v23
    v_lshl_add_u32 v11, v25, 10, v24
    v_xor_b32 v25, 1, v22
    v_lshl_add_u32 v11, v25, 3, v11
    v_add_u32 v15, 0x10000, v11
    s_lshl_b32 s30, s3, 2
    s_add_u32 s30, s30, 131072
    v_mov_b32 v7, s30
    s_getpc_b64 s[24:25]
    s_add_u32 s24, s24, jobtab@rel32@lo+4
    s_addc_u32 s25, s25, jobtab@rel32@hi+12
    s_mul_i32 s30, s29, 704
    s_add_u32 s24, s24, s30
    s_addc_u32 s25, s25, 0
    s_load_dwordx16 s[32:47], s[24:25], 0
    s_add_u32 s24, s24, 64
    s_addc_u32 s25, s25, 0
    s_waitcnt lgkmcnt(0)
    s_cmp_lg_u32 s32, 4
    s_cbranch_scc1 w_nopre
    s_load_dwordx2 s[8:9], s[0:1], s33
    s_load_dwordx2 s[12:13], s[0:1], s34
    s_mov_b32 s10, s38
    s_mov_b32 s14, s38
    s_cmp_eq_u32 s32, 4
    s_cselect_b32 s31, 0, 1
    s_lshl_b32 s30, s3, s31
    s_mul_i32 s30, s30, s40
    s_add_u32 s16, s39, s30
    s_cmp_eq_u32 s32, 4
    s_cselect_b32 s30, 1024, s40
    s_cselect_b32 s31, 6, 5
    s_lshl_b32 s62, 32, s31
    s_add_u32 s17, s16, s30
    s_lshl_b32 s30, s3, 2
    s_mul_i32 s30, s30, s35
    s_add_u32 s18, s36, s30
    s_add_u32 s19, s37, s30
    s_lshl_b32 s20, s35, s31
    v_mul_u32_u24 v2, s35, v4
    v_add_u32 v2, v2, v3
    s_waitcnt lgkmcnt(0)
    s_add_u32 m0, s22, 0
    s_nop 0
    buffer_load_dwordx4 v2, s[8:11], s18 offen lds
    s_add_u32 s18, s18, s20
    s_add_u32 m0, s22, 8192
    s_nop 0
    buffer_load_dwordx4 v2, s[12:15], s19 offen lds
    s_add_u32 s19, s19, s20
    s_add_u32 m0, s22, 32768
    s_nop 0
    buffer_load_dwordx4 v2, s[8:11], s18 offen lds
    s_add_u32 s18, s18, s20
    s_add_u32 m0, s22, 40960
    s_nop 0
    buffer_load_dwordx4 v2, s[12:15], s19 offen lds
    s_add_u32 s19, s19, s20
    s_add_u32 m0, s22, 65536
    s_nop 0
    buffer_load_dwordx4 v2, s[8:11], s18 offen lds
    s_add_u32 s18, s18, s20
    s_add_u32 m0, s22, 73728
    s_nop 0
    buffer_load_dwordx4 v2, s[12:15], s19 offen lds
    s_add_u32 s19, s19, s20
    s_add_u32 m0, s22, 98304
    s_nop 0
    buffer_load_dwordx4 v2, s[8:11], s18 offen lds
    s_add_u32 s18, s18, s20
    s_add_u32 m0, s22, 106496
    s_nop 0
    buffer_load_dwordx4 v2, s[12:15], s19 offen lds
    s_add_u32 s19, s19, s20
    s_cmp_eq_u32 s32, 4
    s_cselect_b32 s70, 1, 0
    s_cmp_eq_u32 s39, 0
    s_cselect_b32 s70, s70, 0
    s_cmp_lg_u32 s3, 0
    s_cbranch_scc1 lnwp_ok
    s_cmp_eq_u32 s70, 0
    s_cbranch_scc1 lnwp_full
    s_mov_b32 s69, 65536
lnwap:
    buffer_load_dword v20, off, s[64:67], 0 offset:192 sc1
    s_waitcnt vmcnt(0)
    v_readfirstlane_b32 s68, v20
    s_cmp_ge_u32 s68, 8
    s_cbranch_scc1 lnwap_ok
    s_sleep 8
    s_sub_u32 s69, s69, 1
    s_cbranch_scc0 lnwap
lnwap_ok:
    s_branch lnwp_ok
lnwp_full:
    s_mov_b32 s69, 65536
lnwp:
    buffer_load_dword v20, off, s[64:67], 0 offset:0 sc1
    s_waitcnt vmcnt(0)
    v_readfirstlane_b32 s68, v20
    s_cmp_ge_u32 s68, 128
    s_cbranch_scc1 lnwp_ok
    s_sleep 8
    s_sub_u32 s69, s69, 1
    s_cbranch_scc0 lnwp
lnwp_ok:
    s_barrier
    s_add_u32 m0, s21, 0
    s_nop 0
    buffer_load_dwordx4 v1, s[4:7], s16 offen sc1 lds
    s_add_u32 s16, s16, s62
    s_add_u32 m0, s21, 1024
    s_nop 0
    buffer_load_dwordx4 v1, s[4:7], s17 offen sc1 lds
    s_add_u32 s17, s17, s62
    s_add_u32 m0, s21, 32768
    s_nop 0
    buffer_load_dwordx4 v1, s[4:7], s16 offen sc1 lds
    s_add_u32 s16, s16, s62
    s_add_u32 m0, s21, 33792
    s_nop 0
    buffer_load_dwordx4 v1, s[4:7], s17 offen sc1 lds
    s_add_u32 s17, s17, s62
    s_add_u32 m0, s21, 65536
    s_nop 0
    buffer_load_dwordx4 v1, s[4:7], s16 offen sc1 lds
    s_add_u32 s16, s16, s62
    s_add_u32 m0, s21, 66560
    s_nop 0
    buffer_load_dwordx4 v1, s[4:7], s17 offen sc1 lds
    s_add_u32 s17, s17, s62
    s_add_u32 m0, s21, 98304
    s_nop 0
    buffer_load_dwordx4 v1, s[4:7], s16 offen sc1 lds
    s_add_u32 s16, s16, s62
    s_add_u32 m0, s21, 99328
    s_nop 0
    buffer_load_dwordx4 v1, s[4:7], s17 offen sc1 lds
    s_add_u32 s17, s17, s62
    s_branch w_adopt
w_nopre:
    s_cmp_eq_u32 s32, 4
    s_cselect_b32 s70, 1, 0
    s_cmp_eq_u32 s39, 0
    s_cselect_b32 s70, s70, 0
    s_cmp_lg_u32 s3, 0
    s_cbranch_scc1 lnw_ok
    s_cmp_eq_u32 s70, 0
    s_cbranch_scc1 lnw_full
    s_mov_b32 s69, 65536
lnwa:
    buffer_load_dword v20, off, s[64:67], 0 offset:192 sc1
    s_waitcnt vmcnt(0)
    v_readfirstlane_b32 s68, v20
    s_cmp_ge_u32 s68, 8
    s_cbranch_scc1 lnwa_ok
    s_sleep 8
    s_sub_u32 s69, s69, 1
    s_cbranch_scc0 lnwa
lnwa_ok:
    s_branch lnw_ok
lnw_full:
    s_mov_b32 s69, 65536
lnw:
    buffer_load_dword v20, off, s[64:67], 0 offset:0 sc1
    s_waitcnt vmcnt(0)
    v_readfirstlane_b32 s68, v20
    s_cmp_ge_u32 s68, 128
    s_cbranch_scc1 lnw_ok
    s_sleep 8
    s_sub_u32 s69, s69, 1
    s_cbranch_scc0 lnw
lnw_ok:
    s_barrier
w_cold:
    s_cmp_eq_u32 s32, 0
    s_cbranch_scc1 fin_entry
    s_cmp_lg_u32 s3, 0
    s_cbranch_scc1 w_depok
    s_cmp_eq_u32 s45, 0
    s_cbranch_scc1 w_depok
    s_mov_b32 s31, 0x40000
w_waitdep:
    buffer_load_dword v16, v17, s[4:7], s44 offen sc1
    s_waitcnt vmcnt(0)
    v_readfirstlane_b32 s30, v16
    s_cmp_ge_u32 s30, s45
    s_cbranch_scc1 w_depok
    s_sleep 16
    s_sub_u32 s31, s31, 1
    s_cbranch_scc0 w_waitdep
w_depok:
    s_load_dwordx2 s[8:9], s[0:1], s33
    s_load_dwordx2 s[12:13], s[0:1], s34
    s_mov_b32 s10, s38
    s_mov_b32 s14, s38
    s_cmp_eq_u32 s32, 4
    s_cselect_b32 s31, 0, 1
    s_lshl_b32 s30, s3, s31
    s_mul_i32 s30, s30, s40
    s_add_u32 s16, s39, s30
    s_cmp_eq_u32 s32, 4
    s_cselect_b32 s30, 1024, s40
    s_cselect_b32 s31, 6, 5
    s_lshl_b32 s62, 32, s31
    s_add_u32 s17, s16, s30
    s_lshl_b32 s30, s3, 2
    s_mul_i32 s30, s30, s35
    s_add_u32 s18, s36, s30
    s_add_u32 s19, s37, s30
    s_lshl_b32 s20, s35, s31
    v_mul_u32_u24 v2, s35, v4
    v_add_u32 v2, v2, v3
    s_waitcnt lgkmcnt(0)
    s_barrier
    s_add_u32 m0, s21, 0
    s_nop 0
    buffer_load_dwordx4 v1, s[4:7], s16 offen sc1 lds
    s_add_u32 s16, s16, s62
    s_add_u32 m0, s21, 1024
    s_nop 0
    buffer_load_dwordx4 v1, s[4:7], s17 offen sc1 lds
    s_add_u32 s17, s17, s62
    s_add_u32 m0, s22, 0
    s_nop 0
    buffer_load_dwordx4 v2, s[8:11], s18 offen lds
    s_add_u32 s18, s18, s20
    s_add_u32 m0, s22, 8192
    s_nop 0
    buffer_load_dwordx4 v2, s[12:15], s19 offen lds
    s_add_u32 s19, s19, s20
    s_add_u32 m0, s21, 32768
    s_nop 0
    buffer_load_dwordx4 v1, s[4:7], s16 offen sc1 lds
    s_add_u32 s16, s16, s62
    s_add_u32 m0, s21, 33792
    s_nop 0
    buffer_load_dwordx4 v1, s[4:7], s17 offen sc1 lds
    s_add_u32 s17, s17, s62
    s_add_u32 m0, s22, 32768
    s_nop 0
    buffer_load_dwordx4 v2, s[8:11], s18 offen lds
    s_add_u32 s18, s18, s20
    s_add_u32 m0, s22, 40960
    s_nop 0
    buffer_load_dwordx4 v2, s[12:15], s19 offen lds
    s_add_u32 s19, s19, s20
    s_add_u32 m0, s21, 65536
    s_nop 0
    buffer_load_dwordx4 v1, s[4:7], s16 offen sc1 lds
    s_add_u32 s16, s16, s62
    s_add_u32 m0, s21, 66560
    s_nop 0
    buffer_load_dwordx4 v1, s[4:7], s17 offen sc1 lds
    s_add_u32 s17, s17, s62
    s_add_u32 m0, s22, 65536
    s_nop 0
    buffer_load_dwordx4 v2, s[8:11], s18 offen lds
    s_add_u32 s18, s18, s20
    s_add_u32 m0, s22, 73728
    s_nop 0
    buffer_load_dwordx4 v2, s[12:15], s19 offen lds
    s_add_u32 s19, s19, s20
    s_add_u32 m0, s21, 98304
    s_nop 0
    buffer_load_dwordx4 v1, s[4:7], s16 offen sc1 lds
    s_add_u32 s16, s16, s62
    s_add_u32 m0, s21, 99328
    s_nop 0
    buffer_load_dwordx4 v1, s[4:7], s17 offen sc1 lds
    s_add_u32 s17, s17, s62
    s_add_u32 m0, s22, 98304
    s_nop 0
    buffer_load_dwordx4 v2, s[8:11], s18 offen lds
    s_add_u32 s18, s18, s20
    s_add_u32 m0, s22, 106496
    s_nop 0
    buffer_load_dwordx4 v2, s[12:15], s19 offen lds
    s_add_u32 s19, s19, s20
w_adopt:
    s_mov_b32 s48, s32
    s_cmp_eq_u32 s32, 4
    s_cselect_b32 s30, 2, 3
    s_lshl_b32 s30, s26, s30
    s_mul_i32 s30, s30, s43
    s_add_u32 s49, s42, s30
    s_mov_b32 s50, s43
    s_mov_b32 s51, s46
    s_mov_b32 s23, s41
    s_mov_b32 s53, s47
    s_nop 0
    s_load_dwordx16 s[32:47], s[24:25], 0
    s_add_u32 s24, s24, 64
    s_addc_u32 s25, s25, 0
    s_waitcnt vmcnt(0)
    s_barrier
    ds_read_b64_tr_b16 v[64:65], v8 offset:16384
    ds_read_b64_tr_b16 v[66:67], v9 offset:16384
    ds_read_b64_tr_b16 v[68:69], v10 offset:16384
    ds_read_b64_tr_b16 v[70:71], v11 offset:16384
    ds_read_b64_tr_b16 v[72:73], v8 offset:24576
    ds_read_b64_tr_b16 v[74:75], v9 offset:24576
    ds_read_b64_tr_b16 v[76:77], v10 offset:24576
    ds_read_b64_tr_b16 v[78:79], v11 offset:24576
    ds_read_b128 v[32:35], v5 offset:0
    ds_read_b128 v[36:39], v5 offset:1024
    ds_read_b128 v[40:43], v5 offset:2048
    ds_read_b128 v[44:47], v5 offset:3072
    ds_read_b128 v[48:51], v5 offset:4096
    ds_read_b128 v[52:55], v5 offset:5120
    ds_read_b128 v[56:59], v5 offset:6144
    ds_read_b128 v[60:63], v5 offset:7168
    s_waitcnt lgkmcnt(0)
    s_cmp_eq_u32 s48, 4
    s_cbranch_scc1 w_firstH
    s_branch w_first16
w_first4:
    s_waitcnt vmcnt(12)
    s_barrier
    v_mfma_f32_16x16x32_bf16 v[128:131], v[64:67], v[32:35], 0
    ds_read_b64_tr_b16 v[112:113], v8 offset:49152
    v_mfma_f32_16x16x32_bf16 v[132:135], v[68:71], v[32:35], 0
    ds_read_b64_tr_b16 v[114:115], v9 offset:49152
    v_mfma_f32_16x16x32_bf16 v[136:139], v[72:75], v[32:35], 0
    ds_read_b64_tr_b16 v[116:117], v10 offset:49152
    v_mfma_f32_16x16x32_bf16 v[140:143], v[76:79], v[32:35], 0
    ds_read_b64_tr_b16 v[118:119], v11 offset:49152
    v_mfma_f32_16x16x32_bf16 v[144:147], v[64:67], v[36:39], 0
    ds_read_b64_tr_b16 v[120:121], v8 offset:57344
    v_mfma_f32_16x16x32_bf16 v[148:151], v[68:71], v[36:39], 0
    ds_read_b64_tr_b16 v[122:123], v9 offset:57344
    v_mfma_f32_16x16x32_bf16 v[152:155], v[72:75], v[36:39], 0
    ds_read_b64_tr_b16 v[124:125], v10 offset:57344
    v_mfma_f32_16x16x32_bf16 v[156:159], v[76:79], v[36:39], 0
    ds_read_b64_tr_b16 v[126:127], v11 offset:57344
    v_mfma_f32_16x16x32_bf16 v[160:163], v[64:67], v[40:43], 0
    ds_read_b128 v[80:83], v5 offset:32768
    v_mfma_f32_16x16x32_bf16 v[164:167], v[68:71], v[40:43], 0
    ds_read_b128 v[84:87], v5 offset:33792
    v_mfma_f32_16x16x32_bf16 v[168:171], v[72:75], v[40:43], 0
    ds_read_b128 v[88:91], v5 offset:34816
    v_mfma_f32_16x16x32_bf16 v[172:175], v[76:79], v[40:43], 0
    ds_read_b128 v[92:95], v5 offset:35840
    v_mfma_f32_16x16x32_bf16 v[176:179], v[64:67], v[44:47], 0
    ds_read_b128 v[96:99], v5 offset:36864
    v_mfma_f32_16x16x32_bf16 v[180:183], v[68:71], v[44:47], 0
    ds_read_b128 v[100:103], v5 offset:37888
    v_mfma_f32_16x16x32_bf16 v[184:187], v[72:75], v[44:47], 0
    ds_read_b128 v[104:107], v5 offset:38912
    v_mfma_f32_16x16x32_bf16 v[188:191], v[76:79], v[44:47], 0
    ds_read_b128 v[108:111], v5 offset:39936
    v_mfma_f32_16x16x32_bf16 v[192:195], v[64:67], v[48:51], 0
    v_mfma_f32_16x16x32_bf16 v[196:199], v[68:71], v[48:51], 0
    s_add_u32 m0, s21, 0
    s_nop 0
    buffer_load_dwordx4 v1, s[4:7], s16 offen sc1 lds
    s_add_u32 s16, s16, s62
    v_mfma_f32_16x16x32_bf16 v[200:203], v[72:75], v[48:51], 0
    v_mfma_f32_16x16x32_bf16 v[204:207], v[76:79], v[48:51], 0
    v_mfma_f32_16x16x32_bf16 v[208:211], v[64:67], v[52:55], 0
    s_add_u32 m0, s21, 1024
    s_nop 0
    buffer_load_dwordx4 v1, s[4:7], s17 offen sc1 lds
    s_add_u32 s17, s17, s62
    v_mfma_f32_16x16x32_bf16 v[212:215], v[68:71], v[52:55], 0
    v_mfma_f32_16x16x32_bf16 v[216:219], v[72:75], v[52:55], 0
    v_mfma_f32_16x16x32_bf16 v[220:223], v[76:79], v[52:55], 0
    s_add_u32 m0, s22, 0
    s_nop 0
    buffer_load_dwordx4 v2, s[8:11], s18 offen lds
    s_add_u32 s18, s18, s20
    v_mfma_f32_16x16x32_bf16 v[224:227], v[64:67], v[56:59], 0
    v_mfma_f32_16x16x32_bf16 v[228:231], v[68:71], v[56:59], 0
    v_mfma_f32_16x16x32_bf16 v[232:235], v[72:75], v[56:59], 0
    s_add_u32 m0, s22, 8192
    s_nop 0
    buffer_load_dwordx4 v2, s[12:15], s19 offen lds
    s_add_u32 s19, s19, s20
    v_mfma_f32_16x16x32_bf16 v[236:239], v[76:79], v[56:59], 0
    v_mfma_f32_16x16x32_bf16 v[240:243], v[64:67], v[60:63], 0
    v_mfma_f32_16x16x32_bf16 v[244:247], v[68:71], v[60:63], 0
    v_mfma_f32_16x16x32_bf16 v[248:251], v[72:75], v[60:63], 0
    v_mfma_f32_16x16x32_bf16 v[252:255], v[76:79], v[60:63], 0
    s_waitcnt lgkmcnt(0)
    s_waitcnt vmcnt(12)
    s_barrier
    v_mfma_f32_16x16x32_bf16 v[128:131], v[112:115], v[80:83], v[128:131]
    ds_read_b64_tr_b16 v[64:65], v12 offset:16384
    v_mfma_f32_16x16x32_bf16 v[132:135], v[116:119], v[80:83], v[132:135]
    ds_read_b64_tr_b16 v[66:67], v13 offset:16384
    v_mfma_f32_16x16x32_bf16 v[136:139], v[120:123], v[80:83], v[136:139]
    ds_read_b64_tr_b16 v[68:69], v14 offset:16384
    v_mfma_f32_16x16x32_bf16 v[140:143], v[124:127], v[80:83], v[140:143]
    ds_read_b64_tr_b16 v[70:71], v15 offset:16384
    v_mfma_f32_16x16x32_bf16 v[144:147], v[112:115], v[84:87], v[144:147]
    ds_read_b64_tr_b16 v[72:73], v12 offset:24576
    v_mfma_f32_16x16x32_bf16 v[148:151], v[116:119], v[84:87], v[148:151]
    ds_read_b64_tr_b16 v[74:75], v13 offset:24576
    v_mfma_f32_16x16x32_bf16 v[152:155], v[120:123], v[84:87], v[152:155]
    ds_read_b64_tr_b16 v[76:77], v14 offset:24576
    v_mfma_f32_16x16x32_bf16 v[156:159], v[124:127], v[84:87], v[156:159]
    ds_read_b64_tr_b16 v[78:79], v15 offset:24576
    v_mfma_f32_16x16x32_bf16 v[160:163], v[112:115], v[88:91], v[160:163]
    ds_read_b128 v[32:35], v6 offset:0
    v_mfma_f32_16x16x32_bf16 v[164:167], v[116:119], v[88:91], v[164:167]
    ds_read_b128 v[36:39], v6 offset:1024
    v_mfma_f32_16x16x32_bf16 v[168:171], v[120:123], v[88:91], v[168:171]
    ds_read_b128 v[40:43], v6 offset:2048
    v_mfma_f32_16x16x32_bf16 v[172:175], v[124:127], v[88:91], v[172:175]
    ds_read_b128 v[44:47], v6 offset:3072
    v_mfma_f32_16x16x32_bf16 v[176:179], v[112:115], v[92:95], v[176:179]
    ds_read_b128 v[48:51], v6 offset:4096
    v_mfma_f32_16x16x32_bf16 v[180:183], v[116:119], v[92:95], v[180:183]
    ds_read_b128 v[52:55], v6 offset:5120
    v_mfma_f32_16x16x32_bf16 v[184:187], v[120:123], v[92:95], v[184:187]
    ds_read_b128 v[56:59], v6 offset:6144
    v_mfma_f32_16x16x32_bf16 v[188:191], v[124:127], v[92:95], v[188:191]
    ds_read_b128 v[60:63], v6 offset:7168
    v_mfma_f32_16x16x32_bf16 v[192:195], v[112:115], v[96:99], v[192:195]
    v_mfma_f32_16x16x32_bf16 v[196:199], v[116:119], v[96:99], v[196:199]
    s_add_u32 m0, s21, 32768
    s_nop 0
    buffer_load_dwordx4 v1, s[4:7], s16 offen sc1 lds
    s_add_u32 s16, s16, s62
    v_mfma_f32_16x16x32_bf16 v[200:203], v[120:123], v[96:99], v[200:203]
    v_mfma_f32_16x16x32_bf16 v[204:207], v[124:127], v[96:99], v[204:207]
    v_mfma_f32_16x16x32_bf16 v[208:211], v[112:115], v[100:103], v[208:211]
    s_add_u32 m0, s21, 33792
    s_nop 0
    buffer_load_dwordx4 v1, s[4:7], s17 offen sc1 lds
    s_add_u32 s17, s17, s62
    v_mfma_f32_16x16x32_bf16 v[212:215], v[116:119], v[100:103], v[212:215]
    v_mfma_f32_16x16x32_bf16 v[216:219], v[120:123], v[100:103], v[216:219]
    v_mfma_f32_16x16x32_bf16 v[220:223], v[124:127], v[100:103], v[220:223]
    s_add_u32 m0, s22, 32768
    s_nop 0
    buffer_load_dwordx4 v2, s[8:11], s18 offen lds
    s_add_u32 s18, s18, s20
    v_mfma_f32_16x16x32_bf16 v[224:227], v[112:115], v[104:107], v[224:227]
    v_mfma_f32_16x16x32_bf16 v[228:231], v[116:119], v[104:107], v[228:231]
    v_mfma_f32_16x16x32_bf16 v[232:235], v[120:123], v[104:107], v[232:235]
    s_add_u32 m0, s22, 40960
    s_nop 0
    buffer_load_dwordx4 v2, s[12:15], s19 offen lds
    s_add_u32 s19, s19, s20
    v_mfma_f32_16x16x32_bf16 v[236:239], v[124:127], v[104:107], v[236:239]
    v_mfma_f32_16x16x32_bf16 v[240:243], v[112:115], v[108:111], v[240:243]
    v_mfma_f32_16x16x32_bf16 v[244:247], v[116:119], v[108:111], v[244:247]
    v_mfma_f32_16x16x32_bf16 v[248:251], v[120:123], v[108:111], v[248:251]
    v_mfma_f32_16x16x32_bf16 v[252:255], v[124:127], v[108:111], v[252:255]
    s_waitcnt lgkmcnt(0)
    s_waitcnt vmcnt(12)
    s_barrier
    v_mfma_f32_16x16x32_bf16 v[128:131], v[64:67], v[32:35], v[128:131]
    ds_read_b64_tr_b16 v[112:113], v12 offset:49152
    v_mfma_f32_16x16x32_bf16 v[132:135], v[68:71], v[32:35], v[132:135]
    ds_read_b64_tr_b16 v[114:115], v13 offset:49152
    v_mfma_f32_16x16x32_bf16 v[136:139], v[72:75], v[32:35], v[136:139]
    ds_read_b64_tr_b16 v[116:117], v14 offset:49152
    v_mfma_f32_16x16x32_bf16 v[140:143], v[76:79], v[32:35], v[140:143]
    ds_read_b64_tr_b16 v[118:119], v15 offset:49152
    v_mfma_f32_16x16x32_bf16 v[144:147], v[64:67], v[36:39], v[144:147]
    ds_read_b64_tr_b16 v[120:121], v12 offset:57344
    v_mfma_f32_16x16x32_bf16 v[148:151], v[68:71], v[36:39], v[148:151]
    ds_read_b64_tr_b16 v[122:123], v13 offset:57344
    v_mfma_f32_16x16x32_bf16 v[152:155], v[72:75], v[36:39], v[152:155]
    ds_read_b64_tr_b16 v[124:125], v14 offset:57344
    v_mfma_f32_16x16x32_bf16 v[156:159], v[76:79], v[36:39], v[156:159]
    ds_read_b64_tr_b16 v[126:127], v15 offset:57344
    v_mfma_f32_16x16x32_bf16 v[160:163], v[64:67], v[40:43], v[160:163]
    ds_read_b128 v[80:83], v6 offset:32768
    v_mfma_f32_16x16x32_bf16 v[164:167], v[68:71], v[40:43], v[164:167]
    ds_read_b128 v[84:87], v6 offset:33792
    v_mfma_f32_16x16x32_bf16 v[168:171], v[72:75], v[40:43], v[168:171]
    ds_read_b128 v[88:91], v6 offset:34816
    v_mfma_f32_16x16x32_bf16 v[172:175], v[76:79], v[40:43], v[172:175]
    ds_read_b128 v[92:95], v6 offset:35840
    v_mfma_f32_16x16x32_bf16 v[176:179], v[64:67], v[44:47], v[176:179]
    ds_read_b128 v[96:99], v6 offset:36864
    v_mfma_f32_16x16x32_bf16 v[180:183], v[68:71], v[44:47], v[180:183]
    ds_read_b128 v[100:103], v6 offset:37888
    v_mfma_f32_16x16x32_bf16 v[184:187], v[72:75], v[44:47], v[184:187]
    ds_read_b128 v[104:107], v6 offset:38912
    v_mfma_f32_16x16x32_bf16 v[188:191], v[76:79], v[44:47], v[188:191]
    ds_read_b128 v[108:111], v6 offset:39936
    v_mfma_f32_16x16x32_bf16 v[192:195], v[64:67], v[48:51], v[192:195]
    v_mfma_f32_16x16x32_bf16 v[196:199], v[68:71], v[48:51], v[196:199]
    s_add_u32 m0, s21, 65536
    s_nop 0
    buffer_load_dwordx4 v1, s[4:7], s16 offen sc1 lds
    s_add_u32 s16, s16, s62
    v_mfma_f32_16x16x32_bf16 v[200:203], v[72:75], v[48:51], v[200:203]
    v_mfma_f32_16x16x32_bf16 v[204:207], v[76:79], v[48:51], v[204:207]
    v_mfma_f32_16x16x32_bf16 v[208:211], v[64:67], v[52:55], v[208:211]
    s_add_u32 m0, s21, 66560
    s_nop 0
    buffer_load_dwordx4 v1, s[4:7], s17 offen sc1 lds
    s_add_u32 s17, s17, s62
    v_mfma_f32_16x16x32_bf16 v[212:215], v[68:71], v[52:55], v[212:215]
    v_mfma_f32_16x16x32_bf16 v[216:219], v[72:75], v[52:55], v[216:219]
    v_mfma_f32_16x16x32_bf16 v[220:223], v[76:79], v[52:55], v[220:223]
    s_add_u32 m0, s22, 65536
    s_nop 0
    buffer_load_dwordx4 v2, s[8:11], s18 offen lds
    s_add_u32 s18, s18, s20
    v_mfma_f32_16x16x32_bf16 v[224:227], v[64:67], v[56:59], v[224:227]
    v_mfma_f32_16x16x32_bf16 v[228:231], v[68:71], v[56:59], v[228:231]
    v_mfma_f32_16x16x32_bf16 v[232:235], v[72:75], v[56:59], v[232:235]
    s_add_u32 m0, s22, 73728
    s_nop 0
    buffer_load_dwordx4 v2, s[12:15], s19 offen lds
    s_add_u32 s19, s19, s20
    v_mfma_f32_16x16x32_bf16 v[236:239], v[76:79], v[56:59], v[236:239]
    v_mfma_f32_16x16x32_bf16 v[240:243], v[64:67], v[60:63], v[240:243]
    v_mfma_f32_16x16x32_bf16 v[244:247], v[68:71], v[60:63], v[244:247]
    v_mfma_f32_16x16x32_bf16 v[248:251], v[72:75], v[60:63], v[248:251]
    v_mfma_f32_16x16x32_bf16 v[252:255], v[76:79], v[60:63], v[252:255]
    s_waitcnt lgkmcnt(0)
    s_waitcnt vmcnt(8)
    s_barrier
    s_cmp_eq_u32 s28, 0
    s_cbranch_scc1 sig_2
    s_cmp_lg_u32 s3, 0
    s_cbranch_scc1 sig_2
    s_and_b32 s57, s28, 3
    v_mov_b32 v24, s57
    s_bfe_u32 s57, s28, 0x20002
    v_mov_b32 v25, s57
    s_andn2_b32 s28, s28, 15
    s_mov_b64 exec, 1
    buffer_atomic_add_x2 v[24:25], v17, s[4:7], s28 offen sc1
    s_mov_b64 exec, -1
sig_2:
    s_mov_b32 s28, 0
    v_mfma_f32_16x16x32_bf16 v[128:131], v[112:115], v[80:83], v[128:131]
    ds_read_b64_tr_b16 v[64:65], v8 offset:16384
    v_mfma_f32_16x16x32_bf16 v[132:135], v[116:119], v[80:83], v[132:135]
    ds_read_b64_tr_b16 v[66:67], v9 offset:16384
    v_mfma_f32_16x16x32_bf16 v[136:139], v[120:123], v[80:83], v[136:139]
    ds_read_b64_tr_b16 v[68:69], v10 offset:16384
    v_mfma_f32_16x16x32_bf16 v[140:143], v[124:127], v[80:83], v[140:143]
    ds_read_b64_tr_b16 v[70:71], v11 offset:16384
    v_mfma_f32_16x16x32_bf16 v[144:147], v[112:115], v[84:87], v[144:147]
    ds_read_b64_tr_b16 v[72:73], v8 offset:24576
    v_mfma_f32_16x16x32_bf16 v[148:151], v[116:119], v[84:87], v[148:151]
    ds_read_b64_tr_b16 v[74:75], v9 offset:24576
    v_mfma_f32_16x16x32_bf16 v[152:155], v[120:123], v[84:87], v[152:155]
    ds_read_b64_tr_b16 v[76:77], v10 offset:24576
    v_mfma_f32_16x16x32_bf16 v[156:159], v[124:127], v[84:87], v[156:159]
    ds_read_b64_tr_b16 v[78:79], v11 offset:24576
    v_mfma_f32_16x16x32_bf16 v[160:163], v[112:115], v[88:91], v[160:163]
    ds_read_b128 v[32:35], v5 offset:0
    v_mfma_f32_16x16x32_bf16 v[164:167], v[116:119], v[88:91], v[164:167]
    ds_read_b128 v[36:39], v5 offset:1024
    v_mfma_f32_16x16x32_bf16 v[168:171], v[120:123], v[88:91], v[168:171]
    ds_read_b128 v[40:43], v5 offset:2048
    v_mfma_f32_16x16x32_bf16 v[172:175], v[124:127], v[88:91], v[172:175]
    ds_read_b128 v[44:47], v5 offset:3072
    v_mfma_f32_16x16x32_bf16 v[176:179], v[112:115], v[92:95], v[176:179]
    ds_read_b128 v[48:51], v5 offset:4096
    v_mfma_f32_16x16x32_bf16 v[180:183], v[116:119], v[92:95], v[180:183]
    ds_read_b128 v[52:55], v5 offset:5120
    v_mfma_f32_16x16x32_bf16 v[184:187], v[120:123], v[92:95], v[184:187]
    ds_read_b128 v[56:59], v5 offset:6144
    v_mfma_f32_16x16x32_bf16 v[188:191], v[124:127], v[92:95], v[188:191]
    ds_read_b128 v[60:63], v5 offset:7168
    v_mfma_f32_16x16x32_bf16 v[192:195], v[112:115], v[96:99], v[192:195]
    v_mfma_f32_16x16x32_bf16 v[196:199], v[116:119], v[96:99], v[196:199]
    s_add_u32 m0, s21, 98304
    s_nop 0
    buffer_load_dwordx4 v1, s[4:7], s16 offen sc1 lds
    s_add_u32 s16, s16, s62
    v_mfma_f32_16x16x32_bf16 v[200:203], v[120:123], v[96:99], v[200:203]
    v_mfma_f32_16x16x32_bf16 v[204:207], v[124:127], v[96:99], v[204:207]
    v_mfma_f32_16x16x32_bf16 v[208:211], v[112:115], v[100:103], v[208:211]
    s_add_u32 m0, s21, 99328
    s_nop 0
    buffer_load_dwordx4 v1, s[4:7], s17 offen sc1 lds
    s_add_u32 s17, s17, s62
    v_mfma_f32_16x16x32_bf16 v[212:215], v[116:119], v[100:103], v[212:215]
    v_mfma_f32_16x16x32_bf16 v[216:219], v[120:123], v[100:103], v[216:219]
    v_mfma_f32_16x16x32_bf16 v[220:223], v[124:127], v[100:103], v[220:223]
    s_add_u32 m0, s22, 98304
    s_nop 0
    buffer_load_dwordx4 v2, s[8:11], s18 offen lds
    s_add_u32 s18, s18, s20
    v_mfma_f32_16x16x32_bf16 v[224:227], v[112:115], v[104:107], v[224:227]
    v_mfma_f32_16x16x32_bf16 v[228:231], v[116:119], v[104:107], v[228:231]
    v_mfma_f32_16x16x32_bf16 v[232:235], v[120:123], v[104:107], v[232:235]
    s_add_u32 m0, s22, 106496
    s_nop 0
    buffer_load_dwordx4 v2, s[12:15], s19 offen lds
    s_add_u32 s19, s19, s20
    v_mfma_f32_16x16x32_bf16 v[236:239], v[124:127], v[104:107], v[236:239]
    v_mfma_f32_16x16x32_bf16 v[240:243], v[112:115], v[108:111], v[240:243]
    v_mfma_f32_16x16x32_bf16 v[244:247], v[116:119], v[108:111], v[244:247]
    v_mfma_f32_16x16x32_bf16 v[248:251], v[120:123], v[108:111], v[248:251]
    v_mfma_f32_16x16x32_bf16 v[252:255], v[124:127], v[108:111], v[252:255]
    s_waitcnt lgkmcnt(0)
    s_branch w_loop_chk
w_first8:
    s_waitcnt vmcnt(16)
    s_barrier
    v_mfma_f32_16x16x32_bf16 v[128:131], v[64:67], v[32:35], 0
    ds_read_b64_tr_b16 v[112:113], v8 offset:49152
    v_mfma_f32_16x16x32_bf16 v[132:135], v[68:71], v[32:35], 0
    ds_read_b64_tr_b16 v[114:115], v9 offset:49152
    v_mfma_f32_16x16x32_bf16 v[136:139], v[72:75], v[32:35], 0
    ds_read_b64_tr_b16 v[116:117], v10 offset:49152
    v_mfma_f32_16x16x32_bf16 v[140:143], v[76:79], v[32:35], 0
    ds_read_b64_tr_b16 v[118:119], v11 offset:49152
    v_mfma_f32_16x16x32_bf16 v[144:147], v[64:67], v[36:39], 0
    ds_read_b64_tr_b16 v[120:121], v8 offset:57344
    v_mfma_f32_16x16x32_bf16 v[148:151], v[68:71], v[36:39], 0
    ds_read_b64_tr_b16 v[122:123], v9 offset:57344
    v_mfma_f32_16x16x32_bf16 v[152:155], v[72:75], v[36:39], 0
    ds_read_b64_tr_b16 v[124:125], v10 offset:57344
    v_mfma_f32_16x16x32_bf16 v[156:159], v[76:79], v[36:39], 0
    ds_read_b64_tr_b16 v[126:127], v11 offset:57344
    v_mfma_f32_16x16x32_bf16 v[160:163], v[64:67], v[40:43], 0
    ds_read_b128 v[80:83], v5 offset:32768
    v_mfma_f32_16x16x32_bf16 v[164:167], v[68:71], v[40:43], 0
    ds_read_b128 v[84:87], v5 offset:33792
    v_mfma_f32_16x16x32_bf16 v[168:171], v[72:75], v[40:43], 0
    ds_read_b128 v[88:91], v5 offset:34816
    v_mfma_f32_16x16x32_bf16 v[172:175], v[76:79], v[40:43], 0
    ds_read_b128 v[92:95], v5 offset:35840
    v_mfma_f32_16x16x32_bf16 v[176:179], v[64:67], v[44:47], 0
    ds_read_b128 v[96:99], v5 offset:36864
    v_mfma_f32_16x16x32_bf16 v[180:183], v[68:71], v[44:47], 0
    ds_read_b128 v[100:103], v5 offset:37888
    v_mfma_f32_16x16x32_bf16 v[184:187], v[72:75], v[44:47], 0
    ds_read_b128 v[104:107], v5 offset:38912
    v_mfma_f32_16x16x32_bf16 v[188:191], v[76:79], v[44:47], 0
    ds_read_b128 v[108:111], v5 offset:39936
    v_mfma_f32_16x16x32_bf16 v[192:195], v[64:67], v[48:51], 0
    v_mfma_f32_16x16x32_bf16 v[196:199], v[68:71], v[48:51], 0
    s_add_u32 m0, s21, 0
    s_nop 0
    buffer_load_dwordx4 v1, s[4:7], s16 offen sc1 lds
    s_add_u32 s16, s16, s62
    v_mfma_f32_16x16x32_bf16 v[200:203], v[72:75], v[48:51], 0
    v_mfma_f32_16x16x32_bf16 v[204:207], v[76:79], v[48:51], 0
    v_mfma_f32_16x16x32_bf16 v[208:211], v[64:67], v[52:55], 0
    s_add_u32 m0, s21, 1024
    s_nop 0
    buffer_load_dwordx4 v1, s[4:7], s17 offen sc1 lds
    s_add_u32 s17, s17, s62
    v_mfma_f32_16x16x32_bf16 v[212:215], v[68:71], v[52:55], 0
    v_mfma_f32_16x16x32_bf16 v[216:219], v[72:75], v[52:55], 0
    v_mfma_f32_16x16x32_bf16 v[220:223], v[76:79], v[52:55], 0
    s_add_u32 m0, s22, 0
    s_nop 0
    buffer_load_dwordx4 v2, s[8:11], s18 offen lds
    s_add_u32 s18, s18, s20
    v_mfma_f32_16x16x32_bf16 v[224:227], v[64:67], v[56:59], 0
    v_mfma_f32_16x16x32_bf16 v[228:231], v[68:71], v[56:59], 0
    v_mfma_f32_16x16x32_bf16 v[232:235], v[72:75], v[56:59], 0
    s_add_u32 m0, s22, 8192
    s_nop 0
    buffer_load_dwordx4 v2, s[12:15], s19 offen lds
    s_add_u32 s19, s19, s20
    v_mfma_f32_16x16x32_bf16 v[236:239], v[76:79], v[56:59], 0
    v_mfma_f32_16x16x32_bf16 v[240:243], v[64:67], v[60:63], 0
    v_mfma_f32_16x16x32_bf16 v[244:247], v[68:71], v[60:63], 0
    v_mfma_f32_16x16x32_bf16 v[248:251], v[72:75], v[60:63], 0
    v_mfma_f32_16x16x32_bf16 v[252:255], v[76:79], v[60:63], 0
    s_waitcnt lgkmcnt(0)
    s_waitcnt vmcnt(16)
    s_barrier
    v_mfma_f32_16x16x32_bf16 v[128:131], v[112:115], v[80:83], v[128:131]
    ds_read_b64_tr_b16 v[64:65], v12 offset:16384
    v_mfma_f32_16x16x32_bf16 v[132:135], v[116:119], v[80:83], v[132:135]
    ds_read_b64_tr_b16 v[66:67], v13 offset:16384
    v_mfma_f32_16x16x32_bf16 v[136:139], v[120:123], v[80:83], v[136:139]
    ds_read_b64_tr_b16 v[68:69], v14 offset:16384
    v_mfma_f32_16x16x32_bf16 v[140:143], v[124:127], v[80:83], v[140:143]
    ds_read_b64_tr_b16 v[70:71], v15 offset:16384
    v_mfma_f32_16x16x32_bf16 v[144:147], v[112:115], v[84:87], v[144:147]
    ds_read_b64_tr_b16 v[72:73], v12 offset:24576
    v_mfma_f32_16x16x32_bf16 v[148:151], v[116:119], v[84:87], v[148:151]
    ds_read_b64_tr_b16 v[74:75], v13 offset:24576
    v_mfma_f32_16x16x32_bf16 v[152:155], v[120:123], v[84:87], v[152:155]
    ds_read_b64_tr_b16 v[76:77], v14 offset:24576
    v_mfma_f32_16x16x32_bf16 v[156:159], v[124:127], v[84:87], v[156:159]
    ds_read_b64_tr_b16 v[78:79], v15 offset:24576
    v_mfma_f32_16x16x32_bf16 v[160:163], v[112:115], v[88:91], v[160:163]
    ds_read_b128 v[32:35], v6 offset:0
    v_mfma_f32_16x16x32_bf16 v[164:167], v[116:119], v[88:91], v[164:167]
    ds_read_b128 v[36:39], v6 offset:1024
    v_mfma_f32_16x16x32_bf16 v[168:171], v[120:123], v[88:91], v[168:171]
    ds_read_b128 v[40:43], v6 offset:2048
    v_mfma_f32_16x16x32_bf16 v[172:175], v[124:127], v[88:91], v[172:175]
    ds_read_b128 v[44:47], v6 offset:3072
    v_mfma_f32_16x16x32_bf16 v[176:179], v[112:115], v[92:95], v[176:179]
    ds_read_b128 v[48:51], v6 offset:4096
    v_mfma_f32_16x16x32_bf16 v[180:183], v[116:119], v[92:95], v[180:183]
    ds_read_b128 v[52:55], v6 offset:5120
    v_mfma_f32_16x16x32_bf16 v[184:187], v[120:123], v[92:95], v[184:187]
    ds_read_b128 v[56:59], v6 offset:6144
    v_mfma_f32_16x16x32_bf16 v[188:191], v[124:127], v[92:95], v[188:191]
    ds_read_b128 v[60:63], v6 offset:7168
    v_mfma_f32_16x16x32_bf16 v[192:195], v[112:115], v[96:99], v[192:195]
    v_mfma_f32_16x16x32_bf16 v[196:199], v[116:119], v[96:99], v[196:199]
    s_add_u32 m0, s21, 32768
    s_nop 0
    buffer_load_dwordx4 v1, s[4:7], s16 offen sc1 lds
    s_add_u32 s16, s16, s62
    v_mfma_f32_16x16x32_bf16 v[200:203], v[120:123], v[96:99], v[200:203]
    v_mfma_f32_16x16x32_bf16 v[204:207], v[124:127], v[96:99], v[204:207]
    v_mfma_f32_16x16x32_bf16 v[208:211], v[112:115], v[100:103], v[208:211]
    s_add_u32 m0, s21, 33792
    s_nop 0
    buffer_load_dwordx4 v1, s[4:7], s17 offen sc1 lds
    s_add_u32 s17, s17, s62
    v_mfma_f32_16x16x32_bf16 v[212:215], v[116:119], v[100:103], v[212:215]
    v_mfma_f32_16x16x32_bf16 v[216:219], v[120:123], v[100:103], v[216:219]
    v_mfma_f32_16x16x32_bf16 v[220:223], v[124:127], v[100:103], v[220:223]
    s_add_u32 m0, s22, 32768
    s_nop 0
    buffer_load_dwordx4 v2, s[8:11], s18 offen lds
    s_add_u32 s18, s18, s20
    v_mfma_f32_16x16x32_bf16 v[224:227], v[112:115], v[104:107], v[224:227]
    v_mfma_f32_16x16x32_bf16 v[228:231], v[116:119], v[104:107], v[228:231]
    v_mfma_f32_16x16x32_bf16 v[232:235], v[120:123], v[104:107], v[232:235]
    s_add_u32 m0, s22, 40960
    s_nop 0
    buffer_load_dwordx4 v2, s[12:15], s19 offen lds
    s_add_u32 s19, s19, s20
    v_mfma_f32_16x16x32_bf16 v[236:239], v[124:127], v[104:107], v[236:239]
    v_mfma_f32_16x16x32_bf16 v[240:243], v[112:115], v[108:111], v[240:243]
    v_mfma_f32_16x16x32_bf16 v[244:247], v[116:119], v[108:111], v[244:247]
    v_mfma_f32_16x16x32_bf16 v[248:251], v[120:123], v[108:111], v[248:251]
    v_mfma_f32_16x16x32_bf16 v[252:255], v[124:127], v[108:111], v[252:255]
    s_waitcnt lgkmcnt(0)
    s_waitcnt vmcnt(16)
    s_barrier
    v_mfma_f32_16x16x32_bf16 v[128:131], v[64:67], v[32:35], v[128:131]
    ds_read_b64_tr_b16 v[112:113], v12 offset:49152
    v_mfma_f32_16x16x32_bf16 v[132:135], v[68:71], v[32:35], v[132:135]
    ds_read_b64_tr_b16 v[114:115], v13 offset:49152
    v_mfma_f32_16x16x32_bf16 v[136:139], v[72:75], v[32:35], v[136:139]
    ds_read_b64_tr_b16 v[116:117], v14 offset:49152
    v_mfma_f32_16x16x32_bf16 v[140:143], v[76:79], v[32:35], v[140:143]
    ds_read_b64_tr_b16 v[118:119], v15 offset:49152
    v_mfma_f32_16x16x32_bf16 v[144:147], v[64:67], v[36:39], v[144:147]
    ds_read_b64_tr_b16 v[120:121], v12 offset:57344
    v_mfma_f32_16x16x32_bf16 v[148:151], v[68:71], v[36:39], v[148:151]
    ds_read_b64_tr_b16 v[122:123], v13 offset:57344
    v_mfma_f32_16x16x32_bf16 v[152:155], v[72:75], v[36:39], v[152:155]
    ds_read_b64_tr_b16 v[124:125], v14 offset:57344
    v_mfma_f32_16x16x32_bf16 v[156:159], v[76:79], v[36:39], v[156:159]
    ds_read_b64_tr_b16 v[126:127], v15 offset:57344
    v_mfma_f32_16x16x32_bf16 v[160:163], v[64:67], v[40:43], v[160:163]
    ds_read_b128 v[80:83], v6 offset:32768
    v_mfma_f32_16x16x32_bf16 v[164:167], v[68:71], v[40:43], v[164:167]
    ds_read_b128 v[84:87], v6 offset:33792
    v_mfma_f32_16x16x32_bf16 v[168:171], v[72:75], v[40:43], v[168:171]
    ds_read_b128 v[88:91], v6 offset:34816
    v_mfma_f32_16x16x32_bf16 v[172:175], v[76:79], v[40:43], v[172:175]
    ds_read_b128 v[92:95], v6 offset:35840
    v_mfma_f32_16x16x32_bf16 v[176:179], v[64:67], v[44:47], v[176:179]
    ds_read_b128 v[96:99], v6 offset:36864
    v_mfma_f32_16x16x32_bf16 v[180:183], v[68:71], v[44:47], v[180:183]
    ds_read_b128 v[100:103], v6 offset:37888
    v_mfma_f32_16x16x32_bf16 v[184:187], v[72:75], v[44:47], v[184:187]
    ds_read_b128 v[104:107], v6 offset:38912
    v_mfma_f32_16x16x32_bf16 v[188:191], v[76:79], v[44:47], v[188:191]
    ds_read_b128 v[108:111], v6 offset:39936
    v_mfma_f32_16x16x32_bf16 v[192:195], v[64:67], v[48:51], v[192:195]
    v_mfma_f32_16x16x32_bf16 v[196:199], v[68:71], v[48:51], v[196:199]
    s_add_u32 m0, s21, 65536
    s_nop 0
    buffer_load_dwordx4 v1, s[4:7], s16 offen sc1 lds
    s_add_u32 s16, s16, s62
    v_mfma_f32_16x16x32_bf16 v[200:203], v[72:75], v[48:51], v[200:203]
    v_mfma_f32_16x16x32_bf16 v[204:207], v[76:79], v[48:51], v[204:207]
    v_mfma_f32_16x16x32_bf16 v[208:211], v[64:67], v[52:55], v[208:211]
    s_add_u32 m0, s21, 66560
    s_nop 0
    buffer_load_dwordx4 v1, s[4:7], s17 offen sc1 lds
    s_add_u32 s17, s17, s62
    v_mfma_f32_16x16x32_bf16 v[212:215], v[68:71], v[52:55], v[212:215]
    v_mfma_f32_16x16x32_bf16 v[216:219], v[72:75], v[52:55], v[216:219]
    v_mfma_f32_16x16x32_bf16 v[220:223], v[76:79], v[52:55], v[220:223]
    s_add_u32 m0, s22, 65536
    s_nop 0
    buffer_load_dwordx4 v2, s[8:11], s18 offen lds
    s_add_u32 s18, s18, s20
    v_mfma_f32_16x16x32_bf16 v[224:227], v[64:67], v[56:59], v[224:227]
    v_mfma_f32_16x16x32_bf16 v[228:231], v[68:71], v[56:59], v[228:231]
    v_mfma_f32_16x16x32_bf16 v[232:235], v[72:75], v[56:59], v[232:235]
    s_add_u32 m0, s22, 73728
    s_nop 0
    buffer_load_dwordx4 v2, s[12:15], s19 offen lds
    s_add_u32 s19, s19, s20
    v_mfma_f32_16x16x32_bf16 v[236:239], v[76:79], v[56:59], v[236:239]
    v_mfma_f32_16x16x32_bf16 v[240:243], v[64:67], v[60:63], v[240:243]
    v_mfma_f32_16x16x32_bf16 v[244:247], v[68:71], v[60:63], v[244:247]
    v_mfma_f32_16x16x32_bf16 v[248:251], v[72:75], v[60:63], v[248:251]
    v_mfma_f32_16x16x32_bf16 v[252:255], v[76:79], v[60:63], v[252:255]
    s_waitcnt lgkmcnt(0)
    s_waitcnt vmcnt(8)
    s_barrier
    s_cmp_eq_u32 s28, 0
    s_cbranch_scc1 sig_3
    s_cmp_lg_u32 s3, 0
    s_cbranch_scc1 sig_3
    s_and_b32 s57, s28, 3
    v_mov_b32 v24, s57
    s_bfe_u32 s57, s28, 0x20002
    v_mov_b32 v25, s57
    s_andn2_b32 s28, s28, 15
    s_mov_b64 exec, 1
    buffer_atomic_add_x2 v[24:25], v17, s[4:7], s28 offen sc1
    s_mov_b64 exec, -1
sig_3:
    s_mov_b32 s28, 0
    v_mfma_f32_16x16x32_bf16 v[128:131], v[112:115], v[80:83], v[128:131]
    ds_read_b64_tr_b16 v[64:65], v8 offset:16384
    v_mfma_f32_16x16x32_bf16 v[132:135], v[116:119], v[80:83], v[132:135]
    ds_read_b64_tr_b16 v[66:67], v9 offset:16384
    v_mfma_f32_16x16x32_bf16 v[136:139], v[120:123], v[80:83], v[136:139]
    ds_read_b64_tr_b16 v[68:69], v10 offset:16384
    v_mfma_f32_16x16x32_bf16 v[140:143], v[124:127], v[80:83], v[140:143]
    ds_read_b64_tr_b16 v[70:71], v11 offset:16384
    v_mfma_f32_16x16x32_bf16 v[144:147], v[112:115], v[84:87], v[144:147]
    ds_read_b64_tr_b16 v[72:73], v8 offset:24576
    v_mfma_f32_16x16x32_bf16 v[148:151], v[116:119], v[84:87], v[148:151]
    ds_read_b64_tr_b16 v[74:75], v9 offset:24576
    v_mfma_f32_16x16x32_bf16 v[152:155], v[120:123], v[84:87], v[152:155]
    ds_read_b64_tr_b16 v[76:77], v10 offset:24576
    v_mfma_f32_16x16x32_bf16 v[156:159], v[124:127], v[84:87], v[156:159]
    ds_read_b64_tr_b16 v[78:79], v11 offset:24576
    v_mfma_f32_16x16x32_bf16 v[160:163], v[112:115], v[88:91], v[160:163]
    ds_read_b128 v[32:35], v5 offset:0
    v_mfma_f32_16x16x32_bf16 v[164:167], v[116:119], v[88:91], v[164:167]
    ds_read_b128 v[36:39], v5 offset:1024
    v_mfma_f32_16x16x32_bf16 v[168:171], v[120:123], v[88:91], v[168:171]
    ds_read_b128 v[40:43], v5 offset:2048
    v_mfma_f32_16x16x32_bf16 v[172:175], v[124:127], v[88:91], v[172:175]
    ds_read_b128 v[44:47], v5 offset:3072
    v_mfma_f32_16x16x32_bf16 v[176:179], v[112:115], v[92:95], v[176:179]
    ds_read_b128 v[48:51], v5 offset:4096
    v_mfma_f32_16x16x32_bf16 v[180:183], v[116:119], v[92:95], v[180:183]
    ds_read_b128 v[52:55], v5 offset:5120
    v_mfma_f32_16x16x32_bf16 v[184:187], v[120:123], v[92:95], v[184:187]
    ds_read_b128 v[56:59], v5 offset:6144
    v_mfma_f32_16x16x32_bf16 v[188:191], v[124:127], v[92:95], v[188:191]
    ds_read_b128 v[60:63], v5 offset:7168
    v_mfma_f32_16x16x32_bf16 v[192:195], v[112:115], v[96:99], v[192:195]
    v_mfma_f32_16x16x32_bf16 v[196:199], v[116:119], v[96:99], v[196:199]
    s_add_u32 m0, s21, 98304
    s_nop 0
    buffer_load_dwordx4 v1, s[4:7], s16 offen sc1 lds
    s_add_u32 s16, s16, s62
    v_mfma_f32_16x16x32_bf16 v[200:203], v[120:123], v[96:99], v[200:203]
    v_mfma_f32_16x16x32_bf16 v[204:207], v[124:127], v[96:99], v[204:207]
    v_mfma_f32_16x16x32_bf16 v[208:211], v[112:115], v[100:103], v[208:211]
    s_add_u32 m0, s21, 99328
    s_nop 0
    buffer_load_dwordx4 v1, s[4:7], s17 offen sc1 lds
    s_add_u32 s17, s17, s62
    v_mfma_f32_16x16x32_bf16 v[212:215], v[116:119], v[100:103], v[212:215]
    v_mfma_f32_16x16x32_bf16 v[216:219], v[120:123], v[100:103], v[216:219]
    v_mfma_f32_16x16x32_bf16 v[220:223], v[124:127], v[100:103], v[220:223]
    s_add_u32 m0, s22, 98304
    s_nop 0
    buffer_load_dwordx4 v2, s[8:11], s18 offen lds
    s_add_u32 s18, s18, s20
    v_mfma_f32_16x16x32_bf16 v[224:227], v[112:115], v[104:107], v[224:227]
    v_mfma_f32_16x16x32_bf16 v[228:231], v[116:119], v[104:107], v[228:231]
    v_mfma_f32_16x16x32_bf16 v[232:235], v[120:123], v[104:107], v[232:235]
    s_add_u32 m0, s22, 106496
    s_nop 0
    buffer_load_dwordx4 v2, s[12:15], s19 offen lds
    s_add_u32 s19, s19, s20
    v_mfma_f32_16x16x32_bf16 v[236:239], v[124:127], v[104:107], v[236:239]
    v_mfma_f32_16x16x32_bf16 v[240:243], v[112:115], v[108:111], v[240:243]
    v_mfma_f32_16x16x32_bf16 v[244:247], v[116:119], v[108:111], v[244:247]
    v_mfma_f32_16x16x32_bf16 v[248:251], v[120:123], v[108:111], v[248:251]
    v_mfma_f32_16x16x32_bf16 v[252:255], v[124:127], v[108:111], v[252:255]
    s_waitcnt lgkmcnt(0)
    s_branch w_loop_chk
w_first16:
    s_waitcnt vmcnt(24)
    s_barrier
    v_mfma_f32_16x16x32_bf16 v[128:131], v[64:67], v[32:35], 0
    ds_read_b64_tr_b16 v[112:113], v8 offset:49152
    v_mfma_f32_16x16x32_bf16 v[132:135], v[68:71], v[32:35], 0
    ds_read_b64_tr_b16 v[114:115], v9 offset:49152
    v_mfma_f32_16x16x32_bf16 v[136:139], v[72:75], v[32:35], 0
    ds_read_b64_tr_b16 v[116:117], v10 offset:49152
    v_mfma_f32_16x16x32_bf16 v[140:143], v[76:79], v[32:35], 0
    ds_read_b64_tr_b16 v[118:119], v11 offset:49152
    v_mfma_f32_16x16x32_bf16 v[144:147], v[64:67], v[36:39], 0
    ds_read_b64_tr_b16 v[120:121], v8 offset:57344
    v_mfma_f32_16x16x32_bf16 v[148:151], v[68:71], v[36:39], 0
    ds_read_b64_tr_b16 v[122:123], v9 offset:57344
    v_mfma_f32_16x16x32_bf16 v[152:155], v[72:75], v[36:39], 0
    ds_read_b64_tr_b16 v[124:125], v10 offset:57344
    v_mfma_f32_16x16x32_bf16 v[156:159], v[76:79], v[36:39], 0
    ds_read_b64_tr_b16 v[126:127], v11 offset:57344
    v_mfma_f32_16x16x32_bf16 v[160:163], v[64:67], v[40:43], 0
    ds_read_b128 v[80:83], v5 offset:32768
    v_mfma_f32_16x16x32_bf16 v[164:167], v[68:71], v[40:43], 0
    ds_read_b128 v[84:87], v5 offset:33792
    v_mfma_f32_16x16x32_bf16 v[168:171], v[72:75], v[40:43], 0
    ds_read_b128 v[88:91], v5 offset:34816
    v_mfma_f32_16x16x32_bf16 v[172:175], v[76:79], v[40:43], 0
    ds_read_b128 v[92:95], v5 offset:35840
    v_mfma_f32_16x16x32_bf16 v[176:179], v[64:67], v[44:47], 0
    ds_read_b128 v[96:99], v5 offset:36864
    v_mfma_f32_16x16x32_bf16 v[180:183], v[68:71], v[44:47], 0
    ds_read_b128 v[100:103], v5 offset:37888
    v_mfma_f32_16x16x32_bf16 v[184:187], v[72:75], v[44:47], 0
    ds_read_b128 v[104:107], v5 offset:38912
    v_mfma_f32_16x16x32_bf16 v[188:191], v[76:79], v[44:47], 0
    ds_read_b128 v[108:111], v5 offset:39936
    v_mfma_f32_16x16x32_bf16 v[192:195], v[64:67], v[48:51], 0
    v_mfma_f32_16x16x32_bf16 v[196:199], v[68:71], v[48:51], 0
    s_add_u32 m0, s21, 0
    s_nop 0
    buffer_load_dwordx4 v1, s[4:7], s16 offen sc1 lds
    s_add_u32 s16, s16, s62
    v_mfma_f32_16x16x32_bf16 v[200:203], v[72:75], v[48:51], 0
    v_mfma_f32_16x16x32_bf16 v[204:207], v[76:79], v[48:51], 0
    v_mfma_f32_16x16x32_bf16 v[208:211], v[64:67], v[52:55], 0
    s_add_u32 m0, s21, 1024
    s_nop 0
    buffer_load_dwordx4 v1, s[4:7], s17 offen sc1 lds
    s_add_u32 s17, s17, s62
    v_mfma_f32_16x16x32_bf16 v[212:215], v[68:71], v[52:55], 0
    v_mfma_f32_16x16x32_bf16 v[216:219], v[72:75], v[52:55], 0
    v_mfma_f32_16x16x32_bf16 v[220:223], v[76:79], v[52:55], 0
    s_add_u32 m0, s22, 0
    s_nop 0
    buffer_load_dwordx4 v2, s[8:11], s18 offen lds
    s_add_u32 s18, s18, s20
    v_mfma_f32_16x16x32_bf16 v[224:227], v[64:67], v[56:59], 0
    v_mfma_f32_16x16x32_bf16 v[228:231], v[68:71], v[56:59], 0
    v_mfma_f32_16x16x32_bf16 v[232:235], v[72:75], v[56:59], 0
    s_add_u32 m0, s22, 8192
    s_nop 0
    buffer_load_dwordx4 v2, s[12:15], s19 offen lds
    s_add_u32 s19, s19, s20
    v_mfma_f32_16x16x32_bf16 v[236:239], v[76:79], v[56:59], 0
    v_mfma_f32_16x16x32_bf16 v[240:243], v[64:67], v[60:63], 0
    v_mfma_f32_16x16x32_bf16 v[244:247], v[68:71], v[60:63], 0
    v_mfma_f32_16x16x32_bf16 v[248:251], v[72:75], v[60:63], 0
    v_mfma_f32_16x16x32_bf16 v[252:255], v[76:79], v[60:63], 0
    s_waitcnt lgkmcnt(0)
    s_waitcnt vmcnt(24)
    s_barrier
    v_mfma_f32_16x16x32_bf16 v[128:131], v[112:115], v[80:83], v[128:131]
    ds_read_b64_tr_b16 v[64:65], v12 offset:16384
    v_mfma_f32_16x16x32_bf16 v[132:135], v[116:119], v[80:83], v[132:135]
    ds_read_b64_tr_b16 v[66:67], v13 offset:16384
    v_mfma_f32_16x16x32_bf16 v[136:139], v[120:123], v[80:83], v[136:139]
    ds_read_b64_tr_b16 v[68:69], v14 offset:16384
    v_mfma_f32_16x16x32_bf16 v[140:143], v[124:127], v[80:83], v[140:143]
    ds_read_b64_tr_b16 v[70:71], v15 offset:16384
    v_mfma_f32_16x16x32_bf16 v[144:147], v[112:115], v[84:87], v[144:147]
    ds_read_b64_tr_b16 v[72:73], v12 offset:24576
    v_mfma_f32_16x16x32_bf16 v[148:151], v[116:119], v[84:87], v[148:151]
    ds_read_b64_tr_b16 v[74:75], v13 offset:24576
    v_mfma_f32_16x16x32_bf16 v[152:155], v[120:123], v[84:87], v[152:155]
    ds_read_b64_tr_b16 v[76:77], v14 offset:24576
    v_mfma_f32_16x16x32_bf16 v[156:159], v[124:127], v[84:87], v[156:159]
    ds_read_b64_tr_b16 v[78:79], v15 offset:24576
    v_mfma_f32_16x16x32_bf16 v[160:163], v[112:115], v[88:91], v[160:163]
    ds_read_b128 v[32:35], v6 offset:0
    v_mfma_f32_16x16x32_bf16 v[164:167], v[116:119], v[88:91], v[164:167]
    ds_read_b128 v[36:39], v6 offset:1024
    v_mfma_f32_16x16x32_bf16 v[168:171], v[120:123], v[88:91], v[168:171]
    ds_read_b128 v[40:43], v6 offset:2048
    v_mfma_f32_16x16x32_bf16 v[172:175], v[124:127], v[88:91], v[172:175]
    ds_read_b128 v[44:47], v6 offset:3072
    v_mfma_f32_16x16x32_bf16 v[176:179], v[112:115], v[92:95], v[176:179]
    ds_read_b128 v[48:51], v6 offset:4096
    v_mfma_f32_16x16x32_bf16 v[180:183], v[116:119], v[92:95], v[180:183]
    ds_read_b128 v[52:55], v6 offset:5120
    v_mfma_f32_16x16x32_bf16 v[184:187], v[120:123], v[92:95], v[184:187]
    ds_read_b128 v[56:59], v6 offset:6144
    v_mfma_f32_16x16x32_bf16 v[188:191], v[124:127], v[92:95], v[188:191]
    ds_read_b128 v[60:63], v6 offset:7168
    v_mfma_f32_16x16x32_bf16 v[192:195], v[112:115], v[96:99], v[192:195]
    v_mfma_f32_16x16x32_bf16 v[196:199], v[116:119], v[96:99], v[196:199]
    s_add_u32 m0, s21, 32768
    s_nop 0
    buffer_load_dwordx4 v1, s[4:7], s16 offen sc1 lds
    s_add_u32 s16, s16, s62
    v_mfma_f32_16x16x32_bf16 v[200:203], v[120:123], v[96:99], v[200:203]
    v_mfma_f32_16x16x32_bf16 v[204:207], v[124:127], v[96:99], v[204:207]
    v_mfma_f32_16x16x32_bf16 v[208:211], v[112:115], v[100:103], v[208:211]
    s_add_u32 m0, s21, 33792
    s_nop 0
    buffer_load_dwordx4 v1, s[4:7], s17 offen sc1 lds
    s_add_u32 s17, s17, s62
    v_mfma_f32_16x16x32_bf16 v[212:215], v[116:119], v[100:103], v[212:215]
    v_mfma_f32_16x16x32_bf16 v[216:219], v[120:123], v[100:103], v[216:219]
    v_mfma_f32_16x16x32_bf16 v[220:223], v[124:127], v[100:103], v[220:223]
    s_add_u32 m0, s22, 32768
    s_nop 0
    buffer_load_dwordx4 v2, s[8:11], s18 offen lds
    s_add_u32 s18, s18, s20
    v_mfma_f32_16x16x32_bf16 v[224:227], v[112:115], v[104:107], v[224:227]
    v_mfma_f32_16x16x32_bf16 v[228:231], v[116:119], v[104:107], v[228:231]
    v_mfma_f32_16x16x32_bf16 v[232:235], v[120:123], v[104:107], v[232:235]
    s_add_u32 m0, s22, 40960
    s_nop 0
    buffer_load_dwordx4 v2, s[12:15], s19 offen lds
    s_add_u32 s19, s19, s20
    v_mfma_f32_16x16x32_bf16 v[236:239], v[124:127], v[104:107], v[236:239]
    v_mfma_f32_16x16x32_bf16 v[240:243], v[112:115], v[108:111], v[240:243]
    v_mfma_f32_16x16x32_bf16 v[244:247], v[116:119], v[108:111], v[244:247]
    v_mfma_f32_16x16x32_bf16 v[248:251], v[120:123], v[108:111], v[248:251]
    v_mfma_f32_16x16x32_bf16 v[252:255], v[124:127], v[108:111], v[252:255]
    s_waitcnt lgkmcnt(0)
    s_waitcnt vmcnt(24)
    s_barrier
    v_mfma_f32_16x16x32_bf16 v[128:131], v[64:67], v[32:35], v[128:131]
    ds_read_b64_tr_b16 v[112:113], v12 offset:49152
    v_mfma_f32_16x16x32_bf16 v[132:135], v[68:71], v[32:35], v[132:135]
    ds_read_b64_tr_b16 v[114:115], v13 offset:49152
    v_mfma_f32_16x16x32_bf16 v[136:139], v[72:75], v[32:35], v[136:139]
    ds_read_b64_tr_b16 v[116:117], v14 offset:49152
    v_mfma_f32_16x16x32_bf16 v[140:143], v[76:79], v[32:35], v[140:143]
    ds_read_b64_tr_b16 v[118:119], v15 offset:49152
    v_mfma_f32_16x16x32_bf16 v[144:147], v[64:67], v[36:39], v[144:147]
    ds_read_b64_tr_b16 v[120:121], v12 offset:57344
    v_mfma_f32_16x16x32_bf16 v[148:151], v[68:71], v[36:39], v[148:151]
    ds_read_b64_tr_b16 v[122:123], v13 offset:57344
    v_mfma_f32_16x16x32_bf16 v[152:155], v[72:75], v[36:39], v[152:155]
    ds_read_b64_tr_b16 v[124:125], v14 offset:57344
    v_mfma_f32_16x16x32_bf16 v[156:159], v[76:79], v[36:39], v[156:159]
    ds_read_b64_tr_b16 v[126:127], v15 offset:57344
    v_mfma_f32_16x16x32_bf16 v[160:163], v[64:67], v[40:43], v[160:163]
    ds_read_b128 v[80:83], v6 offset:32768
    v_mfma_f32_16x16x32_bf16 v[164:167], v[68:71], v[40:43], v[164:167]
    ds_read_b128 v[84:87], v6 offset:33792
    v_mfma_f32_16x16x32_bf16 v[168:171], v[72:75], v[40:43], v[168:171]
    ds_read_b128 v[88:91], v6 offset:34816
    v_mfma_f32_16x16x32_bf16 v[172:175], v[76:79], v[40:43], v[172:175]
    ds_read_b128 v[92:95], v6 offset:35840
    v_mfma_f32_16x16x32_bf16 v[176:179], v[64:67], v[44:47], v[176:179]
    ds_read_b128 v[96:99], v6 offset:36864
    v_mfma_f32_16x16x32_bf16 v[180:183], v[68:71], v[44:47], v[180:183]
    ds_read_b128 v[100:103], v6 offset:37888
    v_mfma_f32_16x16x32_bf16 v[184:187], v[72:75], v[44:47], v[184:187]
    ds_read_b128 v[104:107], v6 offset:38912
    v_mfma_f32_16x16x32_bf16 v[188:191], v[76:79], v[44:47], v[188:191]
    ds_read_b128 v[108:111], v6 offset:39936
    v_mfma_f32_16x16x32_bf16 v[192:195], v[64:67], v[48:51], v[192:195]
    v_mfma_f32_16x16x32_bf16 v[196:199], v[68:71], v[48:51], v[196:199]
    s_add_u32 m0, s21, 65536
    s_nop 0
    buffer_load_dwordx4 v1, s[4:7], s16 offen sc1 lds
    s_add_u32 s16, s16, s62
    v_mfma_f32_16x16x32_bf16 v[200:203], v[72:75], v[48:51], v[200:203]
    v_mfma_f32_16x16x32_bf16 v[204:207], v[76:79], v[48:51], v[204:207]
    v_mfma_f32_16x16x32_bf16 v[208:211], v[64:67], v[52:55], v[208:211]
    s_add_u32 m0, s21, 66560
    s_nop 0
    buffer_load_dwordx4 v1, s[4:7], s17 offen sc1 lds
    s_add_u32 s17, s17, s62
    v_mfma_f32_16x16x32_bf16 v[212:215], v[68:71], v[52:55], v[212:215]
    v_mfma_f32_16x16x32_bf16 v[216:219], v[72:75], v[52:55], v[216:219]
    v_mfma_f32_16x16x32_bf16 v[220:223], v[76:79], v[52:55], v[220:223]
    s_add_u32 m0, s22, 65536
    s_nop 0
    buffer_load_dwordx4 v2, s[8:11], s18 offen lds
    s_add_u32 s18, s18, s20
    v_mfma_f32_16x16x32_bf16 v[224:227], v[64:67], v[56:59], v[224:227]
    v_mfma_f32_16x16x32_bf16 v[228:231], v[68:71], v[56:59], v[228:231]
    v_mfma_f32_16x16x32_bf16 v[232:235], v[72:75], v[56:59], v[232:235]
    s_add_u32 m0, s22, 73728
    s_nop 0
    buffer_load_dwordx4 v2, s[12:15], s19 offen lds
    s_add_u32 s19, s19, s20
    v_mfma_f32_16x16x32_bf16 v[236:239], v[76:79], v[56:59], v[236:239]
    v_mfma_f32_16x16x32_bf16 v[240:243], v[64:67], v[60:63], v[240:243]
    v_mfma_f32_16x16x32_bf16 v[244:247], v[68:71], v[60:63], v[244:247]
    v_mfma_f32_16x16x32_bf16 v[248:251], v[72:75], v[60:63], v[248:251]
    v_mfma_f32_16x16x32_bf16 v[252:255], v[76:79], v[60:63], v[252:255]
    s_waitcnt lgkmcnt(0)
    s_waitcnt vmcnt(8)
    s_barrier
    s_cmp_eq_u32 s28, 0
    s_cbranch_scc1 sig_4
    s_cmp_lg_u32 s3, 0
    s_cbranch_scc1 sig_4
    s_and_b32 s57, s28, 3
    v_mov_b32 v24, s57
    s_bfe_u32 s57, s28, 0x20002
    v_mov_b32 v25, s57
    s_andn2_b32 s28, s28, 15
    s_mov_b64 exec, 1
    buffer_atomic_add_x2 v[24:25], v17, s[4:7], s28 offen sc1
    s_mov_b64 exec, -1
sig_4:
    s_mov_b32 s28, 0
    v_mfma_f32_16x16x32_bf16 v[128:131], v[112:115], v[80:83], v[128:131]
    ds_read_b64_tr_b16 v[64:65], v8 offset:16384
    v_mfma_f32_16x16x32_bf16 v[132:135], v[116:119], v[80:83], v[132:135]
    ds_read_b64_tr_b16 v[66:67], v9 offset:16384
    v_mfma_f32_16x16x32_bf16 v[136:139], v[120:123], v[80:83], v[136:139]
    ds_read_b64_tr_b16 v[68:69], v10 offset:16384
    v_mfma_f32_16x16x32_bf16 v[140:143], v[124:127], v[80:83], v[140:143]
    ds_read_b64_tr_b16 v[70:71], v11 offset:16384
    v_mfma_f32_16x16x32_bf16 v[144:147], v[112:115], v[84:87], v[144:147]
    ds_read_b64_tr_b16 v[72:73], v8 offset:24576
    v_mfma_f32_16x16x32_bf16 v[148:151], v[116:119], v[84:87], v[148:151]
    ds_read_b64_tr_b16 v[74:75], v9 offset:24576
    v_mfma_f32_16x16x32_bf16 v[152:155], v[120:123], v[84:87], v[152:155]
    ds_read_b64_tr_b16 v[76:77], v10 offset:24576
    v_mfma_f32_16x16x32_bf16 v[156:159], v[124:127], v[84:87], v[156:159]
    ds_read_b64_tr_b16 v[78:79], v11 offset:24576
    v_mfma_f32_16x16x32_bf16 v[160:163], v[112:115], v[88:91], v[160:163]
    ds_read_b128 v[32:35], v5 offset:0
    v_mfma_f32_16x16x32_bf16 v[164:167], v[116:119], v[88:91], v[164:167]
    ds_read_b128 v[36:39], v5 offset:1024
    v_mfma_f32_16x16x32_bf16 v[168:171], v[120:123], v[88:91], v[168:171]
    ds_read_b128 v[40:43], v5 offset:2048
    v_mfma_f32_16x16x32_bf16 v[172:175], v[124:127], v[88:91], v[172:175]
    ds_read_b128 v[44:47], v5 offset:3072
    v_mfma_f32_16x16x32_bf16 v[176:179], v[112:115], v[92:95], v[176:179]
    ds_read_b128 v[48:51], v5 offset:4096
    v_mfma_f32_16x16x32_bf16 v[180:183], v[116:119], v[92:95], v[180:183]
    ds_read_b128 v[52:55], v5 offset:5120
    v_mfma_f32_16x16x32_bf16 v[184:187], v[120:123], v[92:95], v[184:187]
    ds_read_b128 v[56:59], v5 offset:6144
    v_mfma_f32_16x16x32_bf16 v[188:191], v[124:127], v[92:95], v[188:191]
    ds_read_b128 v[60:63], v5 offset:7168
    v_mfma_f32_16x16x32_bf16 v[192:195], v[112:115], v[96:99], v[192:195]
    v_mfma_f32_16x16x32_bf16 v[196:199], v[116:119], v[96:99], v[196:199]
    s_add_u32 m0, s21, 98304
    s_nop 0
    buffer_load_dwordx4 v1, s[4:7], s16 offen sc1 lds
    s_add_u32 s16, s16, s62
    v_mfma_f32_16x16x32_bf16 v[200:203], v[120:123], v[96:99], v[200:203]
    v_mfma_f32_16x16x32_bf16 v[204:207], v[124:127], v[96:99], v[204:207]
    v_mfma_f32_16x16x32_bf16 v[208:211], v[112:115], v[100:103], v[208:211]
    s_add_u32 m0, s21, 99328
    s_nop 0
    buffer_load_dwordx4 v1, s[4:7], s17 offen sc1 lds
    s_add_u32 s17, s17, s62
    v_mfma_f32_16x16x32_bf16 v[212:215], v[116:119], v[100:103], v[212:215]
    v_mfma_f32_16x16x32_bf16 v[216:219], v[120:123], v[100:103], v[216:219]
    v_mfma_f32_16x16x32_bf16 v[220:223], v[124:127], v[100:103], v[220:223]
    s_add_u32 m0, s22, 98304
    s_nop 0
    buffer_load_dwordx4 v2, s[8:11], s18 offen lds
    s_add_u32 s18, s18, s20
    v_mfma_f32_16x16x32_bf16 v[224:227], v[112:115], v[104:107], v[224:227]
    v_mfma_f32_16x16x32_bf16 v[228:231], v[116:119], v[104:107], v[228:231]
    v_mfma_f32_16x16x32_bf16 v[232:235], v[120:123], v[104:107], v[232:235]
    s_add_u32 m0, s22, 106496
    s_nop 0
    buffer_load_dwordx4 v2, s[12:15], s19 offen lds
    s_add_u32 s19, s19, s20
    v_mfma_f32_16x16x32_bf16 v[236:239], v[124:127], v[104:107], v[236:239]
    v_mfma_f32_16x16x32_bf16 v[240:243], v[112:115], v[108:111], v[240:243]
    v_mfma_f32_16x16x32_bf16 v[244:247], v[116:119], v[108:111], v[244:247]
    v_mfma_f32_16x16x32_bf16 v[248:251], v[120:123], v[108:111], v[248:251]
    v_mfma_f32_16x16x32_bf16 v[252:255], v[124:127], v[108:111], v[252:255]
    s_waitcnt lgkmcnt(0)
w_loop_chk:
    s_sub_u32 s23, s23, 1
w_loop:
    s_cmp_lg_u32 s23, 1
    s_cbranch_scc1 w_body
    v_readfirstlane_b32 s30, v16
    s_cmp_ge_u32 s30, s45
    s_cselect_b32 s30, 0, 1
    s_or_b32 s30, s30, s70
    s_cmp_eq_u32 s32, 4
    s_cselect_b32 s30, 1, s30
    s_cmp_eq_u32 s32, 0
    s_cselect_b32 s30, 1, s30
    v_mov_b32 v20, s30
    ds_write_b32 v7, v20
    s_cbranch_scc1 w_body
    s_load_dwordx2 s[8:9], s[0:1], s33
    s_load_dwordx2 s[12:13], s[0:1], s34
    s_mov_b32 s10, s38
    s_mov_b32 s14, s38
    s_cmp_eq_u32 s32, 4
    s_cselect_b32 s31, 0, 1
    s_lshl_b32 s30, s3, s31
    s_mul_i32 s30, s30, s40
    s_add_u32 s16, s39, s30
    s_cmp_eq_u32 s32, 4
    s_cselect_b32 s30, 1024, s40
    s_cselect_b32 s31, 6, 5
    s_lshl_b32 s62, 32, s31
    s_add_u32 s17, s16, s30
    s_lshl_b32 s30, s3, 2
    s_mul_i32 s30, s30, s35
    s_add_u32 s18, s36, s30
    s_add_u32 s19, s37, s30
    s_lshl_b32 s20, s35, s31
    v_mul_u32_u24 v2, s35, v4
    v_add_u32 v2, v2, v3
    s_waitcnt lgkmcnt(0)
w_body:
    s_waitcnt vmcnt(8)
    s_barrier
    v_mfma_f32_16x16x32_bf16 v[128:131], v[64:67], v[32:35], v[128:131]
    ds_read_b64_tr_b16 v[112:113], v8 offset:49152
    v_mfma_f32_16x16x32_bf16 v[132:135], v[68:71], v[32:35], v[132:135]
    ds_read_b64_tr_b16 v[114:115], v9 offset:49152
    v_mfma_f32_16x16x32_bf16 v[136:139], v[72:75], v[32:35], v[136:139]
    ds_read_b64_tr_b16 v[116:117], v10 offset:49152
    v_mfma_f32_16x16x32_bf16 v[140:143], v[76:79], v[32:35], v[140:143]
    ds_read_b64_tr_b16 v[118:119], v11 offset:49152
    v_mfma_f32_16x16x32_bf16 v[144:147], v[64:67], v[36:39], v[144:147]
    ds_read_b64_tr_b16 v[120:121], v8 offset:57344
    v_mfma_f32_16x16x32_bf16 v[148:151], v[68:71], v[36:39], v[148:151]
    ds_read_b64_tr_b16 v[122:123], v9 offset:57344
    v_mfma_f32_16x16x32_bf16 v[152:155], v[72:75], v[36:39], v[152:155]
    ds_read_b64_tr_b16 v[124:125], v10 offset:57344
    v_mfma_f32_16x16x32_bf16 v[156:159], v[76:79], v[36:39], v[156:159]
    ds_read_b64_tr_b16 v[126:127], v11 offset:57344
    v_mfma_f32_16x16x32_bf16 v[160:163], v[64:67], v[40:43], v[160:163]
    ds_read_b128 v[80:83], v5 offset:32768
    v_mfma_f32_16x16x32_bf16 v[164:167], v[68:71], v[40:43], v[164:167]
    ds_read_b128 v[84:87], v5 offset:33792
    v_mfma_f32_16x16x32_bf16 v[168:171], v[72:75], v[40:43], v[168:171]
    ds_read_b128 v[88:91], v5 offset:34816
    v_mfma_f32_16x16x32_bf16 v[172:175], v[76:79], v[40:43], v[172:175]
    ds_read_b128 v[92:95], v5 offset:35840
    v_mfma_f32_16x16x32_bf16 v[176:179], v[64:67], v[44:47], v[176:179]
    ds_read_b128 v[96:99], v5 offset:36864
    v_mfma_f32_16x16x32_bf16 v[180:183], v[68:71], v[44:47], v[180:183]
    ds_read_b128 v[100:103], v5 offset:37888
    v_mfma_f32_16x16x32_bf16 v[184:187], v[72:75], v[44:47], v[184:187]
    ds_read_b128 v[104:107], v5 offset:38912
    v_mfma_f32_16x16x32_bf16 v[188:191], v[76:79], v[44:47], v[188:191]
    ds_read_b128 v[108:111], v5 offset:39936
    v_mfma_f32_16x16x32_bf16 v[192:195], v[64:67], v[48:51], v[192:195]
    v_mfma_f32_16x16x32_bf16 v[196:199], v[68:71], v[48:51], v[196:199]
    s_add_u32 m0, s21, 0
    s_nop 0
    buffer_load_dwordx4 v1, s[4:7], s16 offen sc1 lds
    s_add_u32 s16, s16, s62
    v_mfma_f32_16x16x32_bf16 v[200:203], v[72:75], v[48:51], v[200:203]
    v_mfma_f32_16x16x32_bf16 v[204:207], v[76:79], v[48:51], v[204:207]
    v_mfma_f32_16x16x32_bf16 v[208:211], v[64:67], v[52:55], v[208:211]
    s_add_u32 m0, s21, 1024
    s_nop 0
    buffer_load_dwordx4 v1, s[4:7], s17 offen sc1 lds
    s_add_u32 s17, s17, s62
    v_mfma_f32_16x16x32_bf16 v[212:215], v[68:71], v[52:55], v[212:215]
    v_mfma_f32_16x16x32_bf16 v[216:219], v[72:75], v[52:55], v[216:219]
    v_mfma_f32_16x16x32_bf16 v[220:223], v[76:79], v[52:55], v[220:223]
    s_add_u32 m0, s22, 0
    s_nop 0
    buffer_load_dwordx4 v2, s[8:11], s18 offen lds
    s_add_u32 s18, s18, s20
    v_mfma_f32_16x16x32_bf16 v[224:227], v[64:67], v[56:59], v[224:227]
    v_mfma_f32_16x16x32_bf16 v[228:231], v[68:71], v[56:59], v[228:231]
    v_mfma_f32_16x16x32_bf16 v[232:235], v[72:75], v[56:59], v[232:235]
    s_add_u32 m0, s22, 8192
    s_nop 0
    buffer_load_dwordx4 v2, s[12:15], s19 offen lds
    s_add_u32 s19, s19, s20
    v_mfma_f32_16x16x32_bf16 v[236:239], v[76:79], v[56:59], v[236:239]
    v_mfma_f32_16x16x32_bf16 v[240:243], v[64:67], v[60:63], v[240:243]
    v_mfma_f32_16x16x32_bf16 v[244:247], v[68:71], v[60:63], v[244:247]
    buffer_load_dword v16, v17, s[4:7], s44 offen sc1
    v_mfma_f32_16x16x32_bf16 v[248:251], v[72:75], v[60:63], v[248:251]
    v_mfma_f32_16x16x32_bf16 v[252:255], v[76:79], v[60:63], v[252:255]
    s_waitcnt lgkmcnt(0)
    s_waitcnt vmcnt(8)
    s_barrier
    v_mfma_f32_16x16x32_bf16 v[128:131], v[112:115], v[80:83], v[128:131]
    ds_read_b64_tr_b16 v[64:65], v12 offset:16384
    v_mfma_f32_16x16x32_bf16 v[132:135], v[116:119], v[80:83], v[132:135]
    ds_read_b64_tr_b16 v[66:67], v13 offset:16384
    v_mfma_f32_16x16x32_bf16 v[136:139], v[120:123], v[80:83], v[136:139]
    ds_read_b64_tr_b16 v[68:69], v14 offset:16384
    v_mfma_f32_16x16x32_bf16 v[140:143], v[124:127], v[80:83], v[140:143]
    ds_read_b64_tr_b16 v[70:71], v15 offset:16384
    v_mfma_f32_16x16x32_bf16 v[144:147], v[112:115], v[84:87], v[144:147]
    ds_read_b64_tr_b16 v[72:73], v12 offset:24576
    v_mfma_f32_16x16x32_bf16 v[148:151], v[116:119], v[84:87], v[148:151]
    ds_read_b64_tr_b16 v[74:75], v13 offset:24576
    v_mfma_f32_16x16x32_bf16 v[152:155], v[120:123], v[84:87], v[152:155]
    ds_read_b64_tr_b16 v[76:77], v14 offset:24576
    v_mfma_f32_16x16x32_bf16 v[156:159], v[124:127], v[84:87], v[156:159]
    ds_read_b64_tr_b16 v[78:79], v15 offset:24576
    v_mfma_f32_16x16x32_bf16 v[160:163], v[112:115], v[88:91], v[160:163]
    ds_read_b128 v[32:35], v6 offset:0
    v_mfma_f32_16x16x32_bf16 v[164:167], v[116:119], v[88:91], v[164:167]
    ds_read_b128 v[36:39], v6 offset:1024
    v_mfma_f32_16x16x32_bf16 v[168:171], v[120:123], v[88:91], v[168:171]
    ds_read_b128 v[40:43], v6 offset:2048
    v_mfma_f32_16x16x32_bf16 v[172:175], v[124:127], v[88:91], v[172:175]
    ds_read_b128 v[44:47], v6 offset:3072
    v_mfma_f32_16x16x32_bf16 v[176:179], v[112:115], v[92:95], v[176:179]
    ds_read_b128 v[48:51], v6 offset:4096
    v_mfma_f32_16x16x32_bf16 v[180:183], v[116:119], v[92:95], v[180:183]
    ds_read_b128 v[52:55], v6 offset:5120
    v_mfma_f32_16x16x32_bf16 v[184:187], v[120:123], v[92:95], v[184:187]
    ds_read_b128 v[56:59], v6 offset:6144
    v_mfma_f32_16x16x32_bf16 v[188:191], v[124:127], v[92:95], v[188:191]
    ds_read_b128 v[60:63], v6 offset:7168
    v_mfma_f32_16x16x32_bf16 v[192:195], v[112:115], v[96:99], v[192:195]
    v_mfma_f32_16x16x32_bf16 v[196:199], v[116:119], v[96:99], v[196:199]
    s_add_u32 m0, s21, 32768
    s_nop 0
    buffer_load_dwordx4 v1, s[4:7], s16 offen sc1 lds
    s_add_u32 s16, s16, s62
    v_mfma_f32_16x16x32_bf16 v[200:203], v[120:123], v[96:99], v[200:203]
    v_mfma_f32_16x16x32_bf16 v[204:207], v[124:127], v[96:99], v[204:207]
    v_mfma_f32_16x16x32_bf16 v[208:211], v[112:115], v[100:103], v[208:211]
    s_add_u32 m0, s21, 33792
    s_nop 0
    buffer_load_dwordx4 v1, s[4:7], s17 offen sc1 lds
    s_add_u32 s17, s17, s62
    v_mfma_f32_16x16x32_bf16 v[212:215], v[116:119], v[100:103], v[212:215]
    v_mfma_f32_16x16x32_bf16 v[216:219], v[120:123], v[100:103], v[216:219]
    v_mfma_f32_16x16x32_bf16 v[220:223], v[124:127], v[100:103], v[220:223]
    s_add_u32 m0, s22, 32768
    s_nop 0
    buffer_load_dwordx4 v2, s[8:11], s18 offen lds
    s_add_u32 s18, s18, s20
    v_mfma_f32_16x16x32_bf16 v[224:227], v[112:115], v[104:107], v[224:227]
    v_mfma_f32_16x16x32_bf16 v[228:231], v[116:119], v[104:107], v[228:231]
    v_mfma_f32_16x16x32_bf16 v[232:235], v[120:123], v[104:107], v[232:235]
    s_add_u32 m0, s22, 40960
    s_nop 0
    buffer_load_dwordx4 v2, s[12:15], s19 offen lds
    s_add_u32 s19, s19, s20
    v_mfma_f32_16x16x32_bf16 v[236:239], v[124:127], v[104:107], v[236:239]
    v_mfma_f32_16x16x32_bf16 v[240:243], v[112:115], v[108:111], v[240:243]
    v_mfma_f32_16x16x32_bf16 v[244:247], v[116:119], v[108:111], v[244:247]
    v_mfma_f32_16x16x32_bf16 v[248:251], v[120:123], v[108:111], v[248:251]
    v_mfma_f32_16x16x32_bf16 v[252:255], v[124:127], v[108:111], v[252:255]
    s_waitcnt lgkmcnt(0)
    s_waitcnt vmcnt(8)
    s_barrier
    v_mfma_f32_16x16x32_bf16 v[128:131], v[64:67], v[32:35], v[128:131]
    ds_read_b64_tr_b16 v[112:113], v12 offset:49152
    v_mfma_f32_16x16x32_bf16 v[132:135], v[68:71], v[32:35], v[132:135]
    ds_read_b64_tr_b16 v[114:115], v13 offset:49152
    v_mfma_f32_16x16x32_bf16 v[136:139], v[72:75], v[32:35], v[136:139]
    ds_read_b64_tr_b16 v[116:117], v14 offset:49152
    v_mfma_f32_16x16x32_bf16 v[140:143], v[76:79], v[32:35], v[140:143]
    ds_read_b64_tr_b16 v[118:119], v15 offset:49152
    v_mfma_f32_16x16x32_bf16 v[144:147], v[64:67], v[36:39], v[144:147]
    ds_read_b64_tr_b16 v[120:121], v12 offset:57344
    v_mfma_f32_16x16x32_bf16 v[148:151], v[68:71], v[36:39], v[148:151]
    ds_read_b64_tr_b16 v[122:123], v13 offset:57344
    v_mfma_f32_16x16x32_bf16 v[152:155], v[72:75], v[36:39], v[152:155]
    ds_read_b64_tr_b16 v[124:125], v14 offset:57344
    v_mfma_f32_16x16x32_bf16 v[156:159], v[76:79], v[36:39], v[156:159]
    ds_read_b64_tr_b16 v[126:127], v15 offset:57344
    v_mfma_f32_16x16x32_bf16 v[160:163], v[64:67], v[40:43], v[160:163]
    ds_read_b128 v[80:83], v6 offset:32768
    v_mfma_f32_16x16x32_bf16 v[164:167], v[68:71], v[40:43], v[164:167]
    ds_read_b128 v[84:87], v6 offset:33792
    v_mfma_f32_16x16x32_bf16 v[168:171], v[72:75], v[40:43], v[168:171]
    ds_read_b128 v[88:91], v6 offset:34816
    v_mfma_f32_16x16x32_bf16 v[172:175], v[76:79], v[40:43], v[172:175]
    ds_read_b128 v[92:95], v6 offset:35840
    v_mfma_f32_16x16x32_bf16 v[176:179], v[64:67], v[44:47], v[176:179]
    ds_read_b128 v[96:99], v6 offset:36864
    v_mfma_f32_16x16x32_bf16 v[180:183], v[68:71], v[44:47], v[180:183]
    ds_read_b128 v[100:103], v6 offset:37888
    v_mfma_f32_16x16x32_bf16 v[184:187], v[72:75], v[44:47], v[184:187]
    ds_read_b128 v[104:107], v6 offset:38912
    v_mfma_f32_16x16x32_bf16 v[188:191], v[76:79], v[44:47], v[188:191]
    ds_read_b128 v[108:111], v6 offset:39936
    v_mfma_f32_16x16x32_bf16 v[192:195], v[64:67], v[48:51], v[192:195]
    v_mfma_f32_16x16x32_bf16 v[196:199], v[68:71], v[48:51], v[196:199]
    s_add_u32 m0, s21, 65536
    s_nop 0
    buffer_load_dwordx4 v1, s[4:7], s16 offen sc1 lds
    s_add_u32 s16, s16, s62
    v_mfma_f32_16x16x32_bf16 v[200:203], v[72:75], v[48:51], v[200:203]
    v_mfma_f32_16x16x32_bf16 v[204:207], v[76:79], v[48:51], v[204:207]
    v_mfma_f32_16x16x32_bf16 v[208:211], v[64:67], v[52:55], v[208:211]
    s_add_u32 m0, s21, 66560
    s_nop 0
    buffer_load_dwordx4 v1, s[4:7], s17 offen sc1 lds
    s_add_u32 s17, s17, s62
    v_mfma_f32_16x16x32_bf16 v[212:215], v[68:71], v[52:55], v[212:215]
    v_mfma_f32_16x16x32_bf16 v[216:219], v[72:75], v[52:55], v[216:219]
    v_mfma_f32_16x16x32_bf16 v[220:223], v[76:79], v[52:55], v[220:223]
    s_add_u32 m0, s22, 65536
    s_nop 0
    buffer_load_dwordx4 v2, s[8:11], s18 offen lds
    s_add_u32 s18, s18, s20
    v_mfma_f32_16x16x32_bf16 v[224:227], v[64:67], v[56:59], v[224:227]
    v_mfma_f32_16x16x32_bf16 v[228:231], v[68:71], v[56:59], v[228:231]
    v_mfma_f32_16x16x32_bf16 v[232:235], v[72:75], v[56:59], v[232:235]
    s_add_u32 m0, s22, 73728
    s_nop 0
    buffer_load_dwordx4 v2, s[12:15], s19 offen lds
    s_add_u32 s19, s19, s20
    v_mfma_f32_16x16x32_bf16 v[236:239], v[76:79], v[56:59], v[236:239]
    v_mfma_f32_16x16x32_bf16 v[240:243], v[64:67], v[60:63], v[240:243]
    v_mfma_f32_16x16x32_bf16 v[244:247], v[68:71], v[60:63], v[244:247]
    v_mfma_f32_16x16x32_bf16 v[248:251], v[72:75], v[60:63], v[248:251]
    v_mfma_f32_16x16x32_bf16 v[252:255], v[76:79], v[60:63], v[252:255]
    s_waitcnt lgkmcnt(0)
    s_waitcnt vmcnt(8)
    s_barrier
    v_mfma_f32_16x16x32_bf16 v[128:131], v[112:115], v[80:83], v[128:131]
    ds_read_b64_tr_b16 v[64:65], v8 offset:16384
    v_mfma_f32_16x16x32_bf16 v[132:135], v[116:119], v[80:83], v[132:135]
    ds_read_b64_tr_b16 v[66:67], v9 offset:16384
    v_mfma_f32_16x16x32_bf16 v[136:139], v[120:123], v[80:83], v[136:139]
    ds_read_b64_tr_b16 v[68:69], v10 offset:16384
    v_mfma_f32_16x16x32_bf16 v[140:143], v[124:127], v[80:83], v[140:143]
    ds_read_b64_tr_b16 v[70:71], v11 offset:16384
    v_mfma_f32_16x16x32_bf16 v[144:147], v[112:115], v[84:87], v[144:147]
    ds_read_b64_tr_b16 v[72:73], v8 offset:24576
    v_mfma_f32_16x16x32_bf16 v[148:151], v[116:119], v[84:87], v[148:151]
    ds_read_b64_tr_b16 v[74:75], v9 offset:24576
    v_mfma_f32_16x16x32_bf16 v[152:155], v[120:123], v[84:87], v[152:155]
    ds_read_b64_tr_b16 v[76:77], v10 offset:24576
    v_mfma_f32_16x16x32_bf16 v[156:159], v[124:127], v[84:87], v[156:159]
    ds_read_b64_tr_b16 v[78:79], v11 offset:24576
    v_mfma_f32_16x16x32_bf16 v[160:163], v[112:115], v[88:91], v[160:163]
    ds_read_b128 v[32:35], v5 offset:0
    v_mfma_f32_16x16x32_bf16 v[164:167], v[116:119], v[88:91], v[164:167]
    ds_read_b128 v[36:39], v5 offset:1024
    v_mfma_f32_16x16x32_bf16 v[168:171], v[120:123], v[88:91], v[168:171]
    ds_read_b128 v[40:43], v5 offset:2048
    v_mfma_f32_16x16x32_bf16 v[172:175], v[124:127], v[88:91], v[172:175]
    ds_read_b128 v[44:47], v5 offset:3072
    v_mfma_f32_16x16x32_bf16 v[176:179], v[112:115], v[92:95], v[176:179]
    ds_read_b128 v[48:51], v5 offset:4096
    v_mfma_f32_16x16x32_bf16 v[180:183], v[116:119], v[92:95], v[180:183]
    ds_read_b128 v[52:55], v5 offset:5120
    v_mfma_f32_16x16x32_bf16 v[184:187], v[120:123], v[92:95], v[184:187]
    ds_read_b128 v[56:59], v5 offset:6144
    v_mfma_f32_16x16x32_bf16 v[188:191], v[124:127], v[92:95], v[188:191]
    ds_read_b128 v[60:63], v5 offset:7168
    v_mfma_f32_16x16x32_bf16 v[192:195], v[112:115], v[96:99], v[192:195]
    v_mfma_f32_16x16x32_bf16 v[196:199], v[116:119], v[96:99], v[196:199]
    s_add_u32 m0, s21, 98304
    s_nop 0
    buffer_load_dwordx4 v1, s[4:7], s16 offen sc1 lds
    s_add_u32 s16, s16, s62
    v_mfma_f32_16x16x32_bf16 v[200:203], v[120:123], v[96:99], v[200:203]
    v_mfma_f32_16x16x32_bf16 v[204:207], v[124:127], v[96:99], v[204:207]
    v_mfma_f32_16x16x32_bf16 v[208:211], v[112:115], v[100:103], v[208:211]
    s_add_u32 m0, s21, 99328
    s_nop 0
    buffer_load_dwordx4 v1, s[4:7], s17 offen sc1 lds
    s_add_u32 s17, s17, s62
    v_mfma_f32_16x16x32_bf16 v[212:215], v[116:119], v[100:103], v[212:215]
    v_mfma_f32_16x16x32_bf16 v[216:219], v[120:123], v[100:103], v[216:219]
    v_mfma_f32_16x16x32_bf16 v[220:223], v[124:127], v[100:103], v[220:223]
    s_add_u32 m0, s22, 98304
    s_nop 0
    buffer_load_dwordx4 v2, s[8:11], s18 offen lds
    s_add_u32 s18, s18, s20
    v_mfma_f32_16x16x32_bf16 v[224:227], v[112:115], v[104:107], v[224:227]
    v_mfma_f32_16x16x32_bf16 v[228:231], v[116:119], v[104:107], v[228:231]
    v_mfma_f32_16x16x32_bf16 v[232:235], v[120:123], v[104:107], v[232:235]
    s_add_u32 m0, s22, 106496
    s_nop 0
    buffer_load_dwordx4 v2, s[12:15], s19 offen lds
    s_add_u32 s19, s19, s20
    v_mfma_f32_16x16x32_bf16 v[236:239], v[124:127], v[104:107], v[236:239]
    v_mfma_f32_16x16x32_bf16 v[240:243], v[112:115], v[108:111], v[240:243]
    v_mfma_f32_16x16x32_bf16 v[244:247], v[116:119], v[108:111], v[244:247]
    v_mfma_f32_16x16x32_bf16 v[248:251], v[120:123], v[108:111], v[248:251]
    v_mfma_f32_16x16x32_bf16 v[252:255], v[124:127], v[108:111], v[252:255]
    s_waitcnt lgkmcnt(0)
    s_sub_u32 s23, s23, 1
    s_cmp_lg_u32 s23, 0
    s_cbranch_scc1 w_loop
    v_mov_b32 v20, 131072
    ds_read_b128 v[24:27], v20
    ds_read_b128 v[28:31], v20 offset:16
    s_cmp_eq_u32 s48, 2
    s_cbranch_scc1 w_epi_glu
    s_lshl_b32 s30, s27, 10
    s_add_u32 s30, s30, s49
    s_nop 7
    v_cvt_pk_bf16_f32 v80, v128, v129
    v_cvt_pk_bf16_f32 v81, v130, v131
    v_cvt_pk_bf16_f32 v82, v132, v133
    v_cvt_pk_bf16_f32 v83, v134, v135
    buffer_store_dwordx4 v[80:83], v1, s[4:7], s30 offen sc1
    v_cvt_pk_bf16_f32 v84, v136, v137
    v_cvt_pk_bf16_f32 v85, v138, v139
    v_cvt_pk_bf16_f32 v86, v140, v141
    v_cvt_pk_bf16_f32 v87, v142, v143
    buffer_store_dwordx4 v[84:87], v19, s[4:7], s30 offen sc1
    s_add_u32 s30, s30, s50
    v_cvt_pk_bf16_f32 v88, v144, v145
    v_cvt_pk_bf16_f32 v89, v146, v147
    v_cvt_pk_bf16_f32 v90, v148, v149
    v_cvt_pk_bf16_f32 v91, v150, v151
    buffer_store_dwordx4 v[88:91], v1, s[4:7], s30 offen sc1
    v_cvt_pk_bf16_f32 v92, v152, v153
    v_cvt_pk_bf16_f32 v93, v154, v155
    v_cvt_pk_bf16_f32 v94, v156, v157
    v_cvt_pk_bf16_f32 v95, v158, v159
    buffer_store_dwordx4 v[92:95], v19, s[4:7], s30 offen sc1
    s_add_u32 s30, s30, s50
    v_cvt_pk_bf16_f32 v80, v160, v161
    v_cvt_pk_bf16_f32 v81, v162, v163
    v_cvt_pk_bf16_f32 v82, v164, v165
    v_cvt_pk_bf16_f32 v83, v166, v167
    buffer_store_dwordx4 v[80:83], v1, s[4:7], s30 offen sc1
    v_cvt_pk_bf16_f32 v84, v168, v169
    v_cvt_pk_bf16_f32 v85, v170, v171
    v_cvt_pk_bf16_f32 v86, v172, v173
    v_cvt_pk_bf16_f32 v87, v174, v175
    buffer_store_dwordx4 v[84:87], v19, s[4:7], s30 offen sc1
    s_add_u32 s30, s30, s50
    v_cvt_pk_bf16_f32 v88, v176, v177
    v_cvt_pk_bf16_f32 v89, v178, v179
    v_cvt_pk_bf16_f32 v90, v180, v181
    v_cvt_pk_bf16_f32 v91, v182, v183
    buffer_store_dwordx4 v[88:91], v1, s[4:7], s30 offen sc1
    v_cvt_pk_bf16_f32 v92, v184, v185
    v_cvt_pk_bf16_f32 v93, v186, v187
    v_cvt_pk_bf16_f32 v94, v188, v189
    v_cvt_pk_bf16_f32 v95, v190, v191
    buffer_store_dwordx4 v[92:95], v19, s[4:7], s30 offen sc1
    s_add_u32 s30, s30, s50
    v_cvt_pk_bf16_f32 v80, v192, v193
    v_cvt_pk_bf16_f32 v81, v194, v195
    v_cvt_pk_bf16_f32 v82, v196, v197
    v_cvt_pk_bf16_f32 v83, v198, v199
    buffer_store_dwordx4 v[80:83], v1, s[4:7], s30 offen sc1
    v_cvt_pk_bf16_f32 v84, v200, v201
    v_cvt_pk_bf16_f32 v85, v202, v203
    v_cvt_pk_bf16_f32 v86, v204, v205
    v_cvt_pk_bf16_f32 v87, v206, v207
    buffer_store_dwordx4 v[84:87], v19, s[4:7], s30 offen sc1
    s_add_u32 s30, s30, s50
    v_cvt_pk_bf16_f32 v88, v208, v209
    v_cvt_pk_bf16_f32 v89, v210, v211
    v_cvt_pk_bf16_f32 v90, v212, v213
    v_cvt_pk_bf16_f32 v91, v214, v215
    buffer_store_dwordx4 v[88:91], v1, s[4:7], s30 offen sc1
    v_cvt_pk_bf16_f32 v92, v216, v217
    v_cvt_pk_bf16_f32 v93, v218, v219
    v_cvt_pk_bf16_f32 v94, v220, v221
    v_cvt_pk_bf16_f32 v95, v222, v223
    buffer_store_dwordx4 v[92:95], v19, s[4:7], s30 offen sc1
    s_add_u32 s30, s30, s50
    v_cvt_pk_bf16_f32 v80, v224, v225
    v_cvt_pk_bf16_f32 v81, v226, v227
    v_cvt_pk_bf16_f32 v82, v228, v229
    v_cvt_pk_bf16_f32 v83, v230, v231
    buffer_store_dwordx4 v[80:83], v1, s[4:7], s30 offen sc1
    v_cvt_pk_bf16_f32 v84, v232, v233
    v_cvt_pk_bf16_f32 v85, v234, v235
    v_cvt_pk_bf16_f32 v86, v236, v237
    v_cvt_pk_bf16_f32 v87, v238, v239
    buffer_store_dwordx4 v[84:87], v19, s[4:7], s30 offen sc1
    s_add_u32 s30, s30, s50
    v_cvt_pk_bf16_f32 v88, v240, v241
    v_cvt_pk_bf16_f32 v89, v242, v243
    v_cvt_pk_bf16_f32 v90, v244, v245
    v_cvt_pk_bf16_f32 v91, v246, v247
    buffer_store_dwordx4 v[88:91], v1, s[4:7], s30 offen sc1
    v_cvt_pk_bf16_f32 v92, v248, v249
    v_cvt_pk_bf16_f32 v93, v250, v251
    v_cvt_pk_bf16_f32 v94, v252, v253
    v_cvt_pk_bf16_f32 v95, v254, v255
    buffer_store_dwordx4 v[92:95], v19, s[4:7], s30 offen sc1
    s_waitcnt lgkmcnt(0)
    v_or3_b32 v24, v24, v25, v26
    v_or3_b32 v28, v28, v29, v30
    v_or3_b32 v24, v24, v27, v31
    v_or_b32 v24, v24, v28
    s_mov_b32 s28, s51
    v_readfirstlane_b32 s30, v24
    s_cmp_lg_u32 s30, 0
    s_cbranch_scc1 w_drain
    s_mov_b32 s48, s32
    s_cmp_eq_u32 s32, 4
    s_cselect_b32 s30, 2, 3
    s_lshl_b32 s30, s26, s30
    s_mul_i32 s30, s30, s43
    s_add_u32 s49, s42, s30
    s_mov_b32 s50, s43
    s_mov_b32 s51, s46
    s_mov_b32 s23, s41
    s_mov_b32 s53, s47
    s_nop 0
    s_load_dwordx16 s[32:47], s[24:25], 0
    s_add_u32 s24, s24, 64
    s_addc_u32 s25, s25, 0
    s_branch w_first16
w_epi_glu:
    s_lshl_b32 s30, s27, 10
    s_add_u32 s30, s30, s49
    s_mov_b32 s54, 0xbfb8aa3b
    s_nop 7
    v_cvt_pk_bf16_f32 v80, v128, v129
    v_cvt_pk_bf16_f32 v81, v130, v131
    v_cvt_pk_bf16_f32 v82, v132, v133
    v_cvt_pk_bf16_f32 v83, v134, v135
    v_lshlrev_b32 v96, 16, v80
    v_and_b32 v97, 0xffff0000, v80
    v_lshlrev_b32 v98, 16, v81
    v_and_b32 v99, 0xffff0000, v81
    v_lshlrev_b32 v100, 16, v82
    v_and_b32 v101, 0xffff0000, v82
    v_lshlrev_b32 v102, 16, v83
    v_and_b32 v103, 0xffff0000, v83
    v_mul_f32 v96, s54, v96
    v_mul_f32 v97, s54, v97
    v_mul_f32 v98, s54, v98
    v_mul_f32 v99, s54, v99
    v_mul_f32 v100, s54, v100
    v_mul_f32 v101, s54, v101
    v_mul_f32 v102, s54, v102
    v_mul_f32 v103, s54, v103
    v_exp_f32 v96, v96
    v_exp_f32 v97, v97
    v_exp_f32 v98, v98
    v_exp_f32 v99, v99
    v_exp_f32 v100, v100
    v_exp_f32 v101, v101
    v_exp_f32 v102, v102
    v_exp_f32 v103, v103
    v_add_f32 v96, 1.0, v96
    v_add_f32 v97, 1.0, v97
    v_add_f32 v98, 1.0, v98
    v_add_f32 v99, 1.0, v99
    v_add_f32 v100, 1.0, v100
    v_add_f32 v101, 1.0, v101
    v_add_f32 v102, 1.0, v102
    v_add_f32 v103, 1.0, v103
    v_rcp_f32 v96, v96
    v_rcp_f32 v97, v97
    v_rcp_f32 v98, v98
    v_rcp_f32 v99, v99
    v_rcp_f32 v100, v100
    v_rcp_f32 v101, v101
    v_rcp_f32 v102, v102
    v_rcp_f32 v103, v103
    v_mul_f32 v96, v96, v136
    v_mul_f32 v97, v97, v137
    v_mul_f32 v98, v98, v138
    v_mul_f32 v99, v99, v139
    v_mul_f32 v100, v100, v140
    v_mul_f32 v101, v101, v141
    v_mul_f32 v102, v102, v142
    v_mul_f32 v103, v103, v143
    v_cvt_pk_bf16_f32 v80, v96, v97
    v_cvt_pk_bf16_f32 v81, v98, v99
    v_cvt_pk_bf16_f32 v82, v100, v101
    v_cvt_pk_bf16_f32 v83, v102, v103
    buffer_store_dwordx4 v[80:83], v1, s[4:7], s30 offen sc1
    s_add_u32 s30, s30, s50
    v_cvt_pk_bf16_f32 v84, v144, v145
    v_cvt_pk_bf16_f32 v85, v146, v147
    v_cvt_pk_bf16_f32 v86, v148, v149
    v_cvt_pk_bf16_f32 v87, v150, v151
    v_lshlrev_b32 v104, 16, v84
    v_and_b32 v105, 0xffff0000, v84
    v_lshlrev_b32 v106, 16, v85
    v_and_b32 v107, 0xffff0000, v85
    v_lshlrev_b32 v108, 16, v86
    v_and_b32 v109, 0xffff0000, v86
    v_lshlrev_b32 v110, 16, v87
    v_and_b32 v111, 0xffff0000, v87
    v_mul_f32 v104, s54, v104
    v_mul_f32 v105, s54, v105
    v_mul_f32 v106, s54, v106
    v_mul_f32 v107, s54, v107
    v_mul_f32 v108, s54, v108
    v_mul_f32 v109, s54, v109
    v_mul_f32 v110, s54, v110
    v_mul_f32 v111, s54, v111
    v_exp_f32 v104, v104
    v_exp_f32 v105, v105
    v_exp_f32 v106, v106
    v_exp_f32 v107, v107
    v_exp_f32 v108, v108
    v_exp_f32 v109, v109
    v_exp_f32 v110, v110
    v_exp_f32 v111, v111
    v_add_f32 v104, 1.0, v104
    v_add_f32 v105, 1.0, v105
    v_add_f32 v106, 1.0, v106
    v_add_f32 v107, 1.0, v107
    v_add_f32 v108, 1.0, v108
    v_add_f32 v109, 1.0, v109
    v_add_f32 v110, 1.0, v110
    v_add_f32 v111, 1.0, v111
    v_rcp_f32 v104, v104
    v_rcp_f32 v105, v105
    v_rcp_f32 v106, v106
    v_rcp_f32 v107, v107
    v_rcp_f32 v108, v108
    v_rcp_f32 v109, v109
    v_rcp_f32 v110, v110
    v_rcp_f32 v111, v111
    v_mul_f32 v104, v104, v152
    v_mul_f32 v105, v105, v153
    v_mul_f32 v106, v106, v154
    v_mul_f32 v107, v107, v155
    v_mul_f32 v108, v108, v156
    v_mul_f32 v109, v109, v157
    v_mul_f32 v110, v110, v158
    v_mul_f32 v111, v111, v159
    v_cvt_pk_bf16_f32 v84, v104, v105
    v_cvt_pk_bf16_f32 v85, v106, v107
    v_cvt_pk_bf16_f32 v86, v108, v109
    v_cvt_pk_bf16_f32 v87, v110, v111
    buffer_store_dwordx4 v[84:87], v1, s[4:7], s30 offen sc1
    s_add_u32 s30, s30, s50
    v_cvt_pk_bf16_f32 v88, v160, v161
    v_cvt_pk_bf16_f32 v89, v162, v163
    v_cvt_pk_bf16_f32 v90, v164, v165
    v_cvt_pk_bf16_f32 v91, v166, v167
    v_lshlrev_b32 v96, 16, v88
    v_and_b32 v97, 0xffff0000, v88
    v_lshlrev_b32 v98, 16, v89
    v_and_b32 v99, 0xffff0000, v89
    v_lshlrev_b32 v100, 16, v90
    v_and_b32 v101, 0xffff0000, v90
    v_lshlrev_b32 v102, 16, v91
    v_and_b32 v103, 0xffff0000, v91
    v_mul_f32 v96, s54, v96
    v_mul_f32 v97, s54, v97
    v_mul_f32 v98, s54, v98
    v_mul_f32 v99, s54, v99
    v_mul_f32 v100, s54, v100
    v_mul_f32 v101, s54, v101
    v_mul_f32 v102, s54, v102
    v_mul_f32 v103, s54, v103
    v_exp_f32 v96, v96
    v_exp_f32 v97, v97
    v_exp_f32 v98, v98
    v_exp_f32 v99, v99
    v_exp_f32 v100, v100
    v_exp_f32 v101, v101
    v_exp_f32 v102, v102
    v_exp_f32 v103, v103
    v_add_f32 v96, 1.0, v96
    v_add_f32 v97, 1.0, v97
    v_add_f32 v98, 1.0, v98
    v_add_f32 v99, 1.0, v99
    v_add_f32 v100, 1.0, v100
    v_add_f32 v101, 1.0, v101
    v_add_f32 v102, 1.0, v102
    v_add_f32 v103, 1.0, v103
    v_rcp_f32 v96, v96
    v_rcp_f32 v97, v97
    v_rcp_f32 v98, v98
    v_rcp_f32 v99, v99
    v_rcp_f32 v100, v100
    v_rcp_f32 v101, v101
    v_rcp_f32 v102, v102
    v_rcp_f32 v103, v103
    v_mul_f32 v96, v96, v168
    v_mul_f32 v97, v97, v169
    v_mul_f32 v98, v98, v170
    v_mul_f32 v99, v99, v171
    v_mul_f32 v100, v100, v172
    v_mul_f32 v101, v101, v173
    v_mul_f32 v102, v102, v174
    v_mul_f32 v103, v103, v175
    v_cvt_pk_bf16_f32 v88, v96, v97
    v_cvt_pk_bf16_f32 v89, v98, v99
    v_cvt_pk_bf16_f32 v90, v100, v101
    v_cvt_pk_bf16_f32 v91, v102, v103
    buffer_store_dwordx4 v[88:91], v1, s[4:7], s30 offen sc1
    s_add_u32 s30, s30, s50
    v_cvt_pk_bf16_f32 v92, v176, v177
    v_cvt_pk_bf16_f32 v93, v178, v179
    v_cvt_pk_bf16_f32 v94, v180, v181
    v_cvt_pk_bf16_f32 v95, v182, v183
    v_lshlrev_b32 v104, 16, v92
    v_and_b32 v105, 0xffff0000, v92
    v_lshlrev_b32 v106, 16, v93
    v_and_b32 v107, 0xffff0000, v93
    v_lshlrev_b32 v108, 16, v94
    v_and_b32 v109, 0xffff0000, v94
    v_lshlrev_b32 v110, 16, v95
    v_and_b32 v111, 0xffff0000, v95
    v_mul_f32 v104, s54, v104
    v_mul_f32 v105, s54, v105
    v_mul_f32 v106, s54, v106
    v_mul_f32 v107, s54, v107
    v_mul_f32 v108, s54, v108
    v_mul_f32 v109, s54, v109
    v_mul_f32 v110, s54, v110
    v_mul_f32 v111, s54, v111
    v_exp_f32 v104, v104
    v_exp_f32 v105, v105
    v_exp_f32 v106, v106
    v_exp_f32 v107, v107
    v_exp_f32 v108, v108
    v_exp_f32 v109, v109
    v_exp_f32 v110, v110
    v_exp_f32 v111, v111
    v_add_f32 v104, 1.0, v104
    v_add_f32 v105, 1.0, v105
    v_add_f32 v106, 1.0, v106
    v_add_f32 v107, 1.0, v107
    v_add_f32 v108, 1.0, v108
    v_add_f32 v109, 1.0, v109
    v_add_f32 v110, 1.0, v110
    v_add_f32 v111, 1.0, v111
    v_rcp_f32 v104, v104
    v_rcp_f32 v105, v105
    v_rcp_f32 v106, v106
    v_rcp_f32 v107, v107
    v_rcp_f32 v108, v108
    v_rcp_f32 v109, v109
    v_rcp_f32 v110, v110
    v_rcp_f32 v111, v111
    v_mul_f32 v104, v104, v184
    v_mul_f32 v105, v105, v185
    v_mul_f32 v106, v106, v186
    v_mul_f32 v107, v107, v187
    v_mul_f32 v108, v108, v188
    v_mul_f32 v109, v109, v189
    v_mul_f32 v110, v110, v190
    v_mul_f32 v111, v111, v191
    v_cvt_pk_bf16_f32 v92, v104, v105
    v_cvt_pk_bf16_f32 v93, v106, v107
    v_cvt_pk_bf16_f32 v94, v108, v109
    v_cvt_pk_bf16_f32 v95, v110, v111
    buffer_store_dwordx4 v[92:95], v1, s[4:7], s30 offen sc1
    s_add_u32 s30, s30, s50
    v_cvt_pk_bf16_f32 v80, v192, v193
    v_cvt_pk_bf16_f32 v81, v194, v195
    v_cvt_pk_bf16_f32 v82, v196, v197
    v_cvt_pk_bf16_f32 v83, v198, v199
    v_lshlrev_b32 v96, 16, v80
    v_and_b32 v97, 0xffff0000, v80
    v_lshlrev_b32 v98, 16, v81
    v_and_b32 v99, 0xffff0000, v81
    v_lshlrev_b32 v100, 16, v82
    v_and_b32 v101, 0xffff0000, v82
    v_lshlrev_b32 v102, 16, v83
    v_and_b32 v103, 0xffff0000, v83
    v_mul_f32 v96, s54, v96
    v_mul_f32 v97, s54, v97
    v_mul_f32 v98, s54, v98
    v_mul_f32 v99, s54, v99
    v_mul_f32 v100, s54, v100
    v_mul_f32 v101, s54, v101
    v_mul_f32 v102, s54, v102
    v_mul_f32 v103, s54, v103
    v_exp_f32 v96, v96
    v_exp_f32 v97, v97
    v_exp_f32 v98, v98
    v_exp_f32 v99, v99
    v_exp_f32 v100, v100
    v_exp_f32 v101, v101
    v_exp_f32 v102, v102
    v_exp_f32 v103, v103
    v_add_f32 v96, 1.0, v96
    v_add_f32 v97, 1.0, v97
    v_add_f32 v98, 1.0, v98
    v_add_f32 v99, 1.0, v99
    v_add_f32 v100, 1.0, v100
    v_add_f32 v101, 1.0, v101
    v_add_f32 v102, 1.0, v102
    v_add_f32 v103, 1.0, v103
    v_rcp_f32 v96, v96
    v_rcp_f32 v97, v97
    v_rcp_f32 v98, v98
    v_rcp_f32 v99, v99
    v_rcp_f32 v100, v100
    v_rcp_f32 v101, v101
    v_rcp_f32 v102, v102
    v_rcp_f32 v103, v103
    v_mul_f32 v96, v96, v200
    v_mul_f32 v97, v97, v201
    v_mul_f32 v98, v98, v202
    v_mul_f32 v99, v99, v203
    v_mul_f32 v100, v100, v204
    v_mul_f32 v101, v101, v205
    v_mul_f32 v102, v102, v206
    v_mul_f32 v103, v103, v207
    v_cvt_pk_bf16_f32 v80, v96, v97
    v_cvt_pk_bf16_f32 v81, v98, v99
    v_cvt_pk_bf16_f32 v82, v100, v101
    v_cvt_pk_bf16_f32 v83, v102, v103
    buffer_store_dwordx4 v[80:83], v1, s[4:7], s30 offen sc1
    s_add_u32 s30, s30, s50
    v_cvt_pk_bf16_f32 v84, v208, v209
    v_cvt_pk_bf16_f32 v85, v210, v211
    v_cvt_pk_bf16_f32 v86, v212, v213
    v_cvt_pk_bf16_f32 v87, v214, v215
    v_lshlrev_b32 v104, 16, v84
    v_and_b32 v105, 0xffff0000, v84
    v_lshlrev_b32 v106, 16, v85
    v_and_b32 v107, 0xffff0000, v85
    v_lshlrev_b32 v108, 16, v86
    v_and_b32 v109, 0xffff0000, v86
    v_lshlrev_b32 v110, 16, v87
    v_and_b32 v111, 0xffff0000, v87
    v_mul_f32 v104, s54, v104
    v_mul_f32 v105, s54, v105
    v_mul_f32 v106, s54, v106
    v_mul_f32 v107, s54, v107
    v_mul_f32 v108, s54, v108
    v_mul_f32 v109, s54, v109
    v_mul_f32 v110, s54, v110
    v_mul_f32 v111, s54, v111
    v_exp_f32 v104, v104
    v_exp_f32 v105, v105
    v_exp_f32 v106, v106
    v_exp_f32 v107, v107
    v_exp_f32 v108, v108
    v_exp_f32 v109, v109
    v_exp_f32 v110, v110
    v_exp_f32 v111, v111
    v_add_f32 v104, 1.0, v104
    v_add_f32 v105, 1.0, v105
    v_add_f32 v106, 1.0, v106
    v_add_f32 v107, 1.0, v107
    v_add_f32 v108, 1.0, v108
    v_add_f32 v109, 1.0, v109
    v_add_f32 v110, 1.0, v110
    v_add_f32 v111, 1.0, v111
    v_rcp_f32 v104, v104
    v_rcp_f32 v105, v105
    v_rcp_f32 v106, v106
    v_rcp_f32 v107, v107
    v_rcp_f32 v108, v108
    v_rcp_f32 v109, v109
    v_rcp_f32 v110, v110
    v_rcp_f32 v111, v111
    v_mul_f32 v104, v104, v216
    v_mul_f32 v105, v105, v217
    v_mul_f32 v106, v106, v218
    v_mul_f32 v107, v107, v219
    v_mul_f32 v108, v108, v220
    v_mul_f32 v109, v109, v221
    v_mul_f32 v110, v110, v222
    v_mul_f32 v111, v111, v223
    v_cvt_pk_bf16_f32 v84, v104, v105
    v_cvt_pk_bf16_f32 v85, v106, v107
    v_cvt_pk_bf16_f32 v86, v108, v109
    v_cvt_pk_bf16_f32 v87, v110, v111
    buffer_store_dwordx4 v[84:87], v1, s[4:7], s30 offen sc1
    s_add_u32 s30, s30, s50
    v_cvt_pk_bf16_f32 v88, v224, v225
    v_cvt_pk_bf16_f32 v89, v226, v227
    v_cvt_pk_bf16_f32 v90, v228, v229
    v_cvt_pk_bf16_f32 v91, v230, v231
    v_lshlrev_b32 v96, 16, v88
    v_and_b32 v97, 0xffff0000, v88
    v_lshlrev_b32 v98, 16, v89
    v_and_b32 v99, 0xffff0000, v89
    v_lshlrev_b32 v100, 16, v90
    v_and_b32 v101, 0xffff0000, v90
    v_lshlrev_b32 v102, 16, v91
    v_and_b32 v103, 0xffff0000, v91
    v_mul_f32 v96, s54, v96
    v_mul_f32 v97, s54, v97
    v_mul_f32 v98, s54, v98
    v_mul_f32 v99, s54, v99
    v_mul_f32 v100, s54, v100
    v_mul_f32 v101, s54, v101
    v_mul_f32 v102, s54, v102
    v_mul_f32 v103, s54, v103
    v_exp_f32 v96, v96
    v_exp_f32 v97, v97
    v_exp_f32 v98, v98
    v_exp_f32 v99, v99
    v_exp_f32 v100, v100
    v_exp_f32 v101, v101
    v_exp_f32 v102, v102
    v_exp_f32 v103, v103
    v_add_f32 v96, 1.0, v96
    v_add_f32 v97, 1.0, v97
    v_add_f32 v98, 1.0, v98
    v_add_f32 v99, 1.0, v99
    v_add_f32 v100, 1.0, v100
    v_add_f32 v101, 1.0, v101
    v_add_f32 v102, 1.0, v102
    v_add_f32 v103, 1.0, v103
    v_rcp_f32 v96, v96
    v_rcp_f32 v97, v97
    v_rcp_f32 v98, v98
    v_rcp_f32 v99, v99
    v_rcp_f32 v100, v100
    v_rcp_f32 v101, v101
    v_rcp_f32 v102, v102
    v_rcp_f32 v103, v103
    v_mul_f32 v96, v96, v232
    v_mul_f32 v97, v97, v233
    v_mul_f32 v98, v98, v234
    v_mul_f32 v99, v99, v235
    v_mul_f32 v100, v100, v236
    v_mul_f32 v101, v101, v237
    v_mul_f32 v102, v102, v238
    v_mul_f32 v103, v103, v239
    v_cvt_pk_bf16_f32 v88, v96, v97
    v_cvt_pk_bf16_f32 v89, v98, v99
    v_cvt_pk_bf16_f32 v90, v100, v101
    v_cvt_pk_bf16_f32 v91, v102, v103
    buffer_store_dwordx4 v[88:91], v1, s[4:7], s30 offen sc1
    s_add_u32 s30, s30, s50
    v_cvt_pk_bf16_f32 v92, v240, v241
    v_cvt_pk_bf16_f32 v93, v242, v243
    v_cvt_pk_bf16_f32 v94, v244, v245
    v_cvt_pk_bf16_f32 v95, v246, v247
    v_lshlrev_b32 v104, 16, v92
    v_and_b32 v105, 0xffff0000, v92
    v_lshlrev_b32 v106, 16, v93
    v_and_b32 v107, 0xffff0000, v93
    v_lshlrev_b32 v108, 16, v94
    v_and_b32 v109, 0xffff0000, v94
    v_lshlrev_b32 v110, 16, v95
    v_and_b32 v111, 0xffff0000, v95
    v_mul_f32 v104, s54, v104
    v_mul_f32 v105, s54, v105
    v_mul_f32 v106, s54, v106
    v_mul_f32 v107, s54, v107
    v_mul_f32 v108, s54, v108
    v_mul_f32 v109, s54, v109
    v_mul_f32 v110, s54, v110
    v_mul_f32 v111, s54, v111
    v_exp_f32 v104, v104
    v_exp_f32 v105, v105
    v_exp_f32 v106, v106
    v_exp_f32 v107, v107
    v_exp_f32 v108, v108
    v_exp_f32 v109, v109
    v_exp_f32 v110, v110
    v_exp_f32 v111, v111
    v_add_f32 v104, 1.0, v104
    v_add_f32 v105, 1.0, v105
    v_add_f32 v106, 1.0, v106
    v_add_f32 v107, 1.0, v107
    v_add_f32 v108, 1.0, v108
    v_add_f32 v109, 1.0, v109
    v_add_f32 v110, 1.0, v110
    v_add_f32 v111, 1.0, v111
    v_rcp_f32 v104, v104
    v_rcp_f32 v105, v105
    v_rcp_f32 v106, v106
    v_rcp_f32 v107, v107
    v_rcp_f32 v108, v108
    v_rcp_f32 v109, v109
    v_rcp_f32 v110, v110
    v_rcp_f32 v111, v111
    v_mul_f32 v104, v104, v248
    v_mul_f32 v105, v105, v249
    v_mul_f32 v106, v106, v250
    v_mul_f32 v107, v107, v251
    v_mul_f32 v108, v108, v252
    v_mul_f32 v109, v109, v253
    v_mul_f32 v110, v110, v254
    v_mul_f32 v111, v111, v255
    v_cvt_pk_bf16_f32 v92, v104, v105
    v_cvt_pk_bf16_f32 v93, v106, v107
    v_cvt_pk_bf16_f32 v94, v108, v109
    v_cvt_pk_bf16_f32 v95, v110, v111
    buffer_store_dwordx4 v[92:95], v1, s[4:7], s30 offen sc1
    s_waitcnt lgkmcnt(0)
    v_or3_b32 v24, v24, v25, v26
    v_or3_b32 v28, v28, v29, v30
    v_or3_b32 v24, v24, v27, v31
    v_or_b32 v24, v24, v28
    s_mov_b32 s28, s51
    v_readfirstlane_b32 s30, v24
    s_cmp_lg_u32 s30, 0
    s_cbranch_scc1 w_drain
    s_mov_b32 s48, s32
    s_cmp_eq_u32 s32, 4
    s_cselect_b32 s30, 2, 3
    s_lshl_b32 s30, s26, s30
    s_mul_i32 s30, s30, s43
    s_add_u32 s49, s42, s30
    s_mov_b32 s50, s43
    s_mov_b32 s51, s46
    s_mov_b32 s23, s41
    s_mov_b32 s53, s47
    s_nop 0
    s_load_dwordx16 s[32:47], s[24:25], 0
    s_add_u32 s24, s24, 64
    s_addc_u32 s25, s25, 0
    s_branch w_first8
w_firstH:
    s_waitcnt vmcnt(8)
    s_barrier
    s_add_u32 m0, s21, 0
    s_nop 0
    buffer_load_dwordx4 v1, s[4:7], s16 offen sc1 lds
    s_add_u32 s16, s16, s62
    s_add_u32 m0, s21, 1024
    s_nop 0
    buffer_load_dwordx4 v1, s[4:7], s17 offen sc1 lds
    s_add_u32 s17, s17, s62
    s_add_u32 m0, s22, 0
    s_nop 0
    buffer_load_dwordx4 v2, s[8:11], s18 offen lds
    s_add_u32 s18, s18, s20
    s_add_u32 m0, s22, 8192
    s_nop 0
    buffer_load_dwordx4 v2, s[12:15], s19 offen lds
    s_add_u32 s19, s19, s20
    v_mfma_f32_16x16x32_bf16 v[128:131], v[64:67], v[32:35], 0
    ds_read_b64_tr_b16 v[112:113], v8 offset:49152
    v_mfma_f32_16x16x32_bf16 v[132:135], v[68:71], v[32:35], 0
    ds_read_b64_tr_b16 v[114:115], v9 offset:49152
    v_mfma_f32_16x16x32_bf16 v[144:147], v[64:67], v[40:43], 0
    ds_read_b64_tr_b16 v[116:117], v10 offset:49152
    v_mfma_f32_16x16x32_bf16 v[148:151], v[68:71], v[40:43], 0
    ds_read_b64_tr_b16 v[118:119], v11 offset:49152
    v_mfma_f32_16x16x32_bf16 v[160:163], v[64:67], v[48:51], 0
    ds_read_b64_tr_b16 v[120:121], v8 offset:57344
    v_mfma_f32_16x16x32_bf16 v[164:167], v[68:71], v[48:51], 0
    ds_read_b64_tr_b16 v[122:123], v9 offset:57344
    v_mfma_f32_16x16x32_bf16 v[176:179], v[64:67], v[56:59], 0
    ds_read_b64_tr_b16 v[124:125], v10 offset:57344
    v_mfma_f32_16x16x32_bf16 v[180:183], v[68:71], v[56:59], 0
    ds_read_b64_tr_b16 v[126:127], v11 offset:57344
    v_mfma_f32_16x16x32_bf16 v[128:131], v[72:75], v[36:39], v[128:131]
    ds_read_b128 v[80:83], v5 offset:32768
    v_mfma_f32_16x16x32_bf16 v[132:135], v[76:79], v[36:39], v[132:135]
    ds_read_b128 v[84:87], v5 offset:33792
    v_mfma_f32_16x16x32_bf16 v[144:147], v[72:75], v[44:47], v[144:147]
    ds_read_b128 v[88:91], v5 offset:34816
    v_mfma_f32_16x16x32_bf16 v[148:151], v[76:79], v[44:47], v[148:151]
    ds_read_b128 v[92:95], v5 offset:35840
    v_mfma_f32_16x16x32_bf16 v[160:163], v[72:75], v[52:55], v[160:163]
    ds_read_b128 v[96:99], v5 offset:36864
    v_mfma_f32_16x16x32_bf16 v[164:167], v[76:79], v[52:55], v[164:167]
    ds_read_b128 v[100:103], v5 offset:37888
    v_mfma_f32_16x16x32_bf16 v[176:179], v[72:75], v[60:63], v[176:179]
    ds_read_b128 v[104:107], v5 offset:38912
    v_mfma_f32_16x16x32_bf16 v[180:183], v[76:79], v[60:63], v[180:183]
    ds_read_b128 v[108:111], v5 offset:39936
    s_waitcnt lgkmcnt(0)
    s_waitcnt vmcnt(8)
    s_barrier
    s_add_u32 m0, s21, 32768
    s_nop 0
    buffer_load_dwordx4 v1, s[4:7], s16 offen sc1 lds
    s_add_u32 s16, s16, s62
    s_add_u32 m0, s21, 33792
    s_nop 0
    buffer_load_dwordx4 v1, s[4:7], s17 offen sc1 lds
    s_add_u32 s17, s17, s62
    s_add_u32 m0, s22, 32768
    s_nop 0
    buffer_load_dwordx4 v2, s[8:11], s18 offen lds
    s_add_u32 s18, s18, s20
    s_add_u32 m0, s22, 40960
    s_nop 0
    buffer_load_dwordx4 v2, s[12:15], s19 offen lds
    s_add_u32 s19, s19, s20
    v_mfma_f32_16x16x32_bf16 v[128:131], v[112:115], v[80:83], v[128:131]
    ds_read_b64_tr_b16 v[64:65], v12 offset:16384
    v_mfma_f32_16x16x32_bf16 v[132:135], v[116:119], v[80:83], v[132:135]
    ds_read_b64_tr_b16 v[66:67], v13 offset:16384
    v_mfma_f32_16x16x32_bf16 v[144:147], v[112:115], v[88:91], v[144:147]
    ds_read_b64_tr_b16 v[68:69], v14 offset:16384
    v_mfma_f32_16x16x32_bf16 v[148:151], v[116:119], v[88:91], v[148:151]
    ds_read_b64_tr_b16 v[70:71], v15 offset:16384
    v_mfma_f32_16x16x32_bf16 v[160:163], v[112:115], v[96:99], v[160:163]
    ds_read_b64_tr_b16 v[72:73], v12 offset:24576
    v_mfma_f32_16x16x32_bf16 v[164:167], v[116:119], v[96:99], v[164:167]
    ds_read_b64_tr_b16 v[74:75], v13 offset:24576
    v_mfma_f32_16x16x32_bf16 v[176:179], v[112:115], v[104:107], v[176:179]
    ds_read_b64_tr_b16 v[76:77], v14 offset:24576
    v_mfma_f32_16x16x32_bf16 v[180:183], v[116:119], v[104:107], v[180:183]
    ds_read_b64_tr_b16 v[78:79], v15 offset:24576
    v_mfma_f32_16x16x32_bf16 v[128:131], v[120:123], v[84:87], v[128:131]
    ds_read_b128 v[32:35], v6 offset:0
    v_mfma_f32_16x16x32_bf16 v[132:135], v[124:127], v[84:87], v[132:135]
    ds_read_b128 v[36:39], v6 offset:1024
    v_mfma_f32_16x16x32_bf16 v[144:147], v[120:123], v[92:95], v[144:147]
    ds_read_b128 v[40:43], v6 offset:2048
    v_mfma_f32_16x16x32_bf16 v[148:151], v[124:127], v[92:95], v[148:151]
    ds_read_b128 v[44:47], v6 offset:3072
    v_mfma_f32_16x16x32_bf16 v[160:163], v[120:123], v[100:103], v[160:163]
    ds_read_b128 v[48:51], v6 offset:4096
    v_mfma_f32_16x16x32_bf16 v[164:167], v[124:127], v[100:103], v[164:167]
    ds_read_b128 v[52:55], v6 offset:5120
    v_mfma_f32_16x16x32_bf16 v[176:179], v[120:123], v[108:111], v[176:179]
    ds_read_b128 v[56:59], v6 offset:6144
    v_mfma_f32_16x16x32_bf16 v[180:183], v[124:127], v[108:111], v[180:183]
    ds_read_b128 v[60:63], v6 offset:7168
    s_waitcnt lgkmcnt(0)
    s_waitcnt vmcnt(8)
    s_barrier
    s_add_u32 m0, s21, 65536
    s_nop 0
    buffer_load_dwordx4 v1, s[4:7], s16 offen sc1 lds
    s_add_u32 s16, s16, s62
    s_add_u32 m0, s21, 66560
    s_nop 0
    buffer_load_dwordx4 v1, s[4:7], s17 offen sc1 lds
    s_add_u32 s17, s17, s62
    s_add_u32 m0, s22, 65536
    s_nop 0
    buffer_load_dwordx4 v2, s[8:11], s18 offen lds
    s_add_u32 s18, s18, s20
    s_add_u32 m0, s22, 73728
    s_nop 0
    buffer_load_dwordx4 v2, s[12:15], s19 offen lds
    s_add_u32 s19, s19, s20
    v_mfma_f32_16x16x32_bf16 v[128:131], v[64:67], v[32:35], v[128:131]
    ds_read_b64_tr_b16 v[112:113], v12 offset:49152
    v_mfma_f32_16x16x32_bf16 v[132:135], v[68:71], v[32:35], v[132:135]
    ds_read_b64_tr_b16 v[114:115], v13 offset:49152
    v_mfma_f32_16x16x32_bf16 v[144:147], v[64:67], v[40:43], v[144:147]
    ds_read_b64_tr_b16 v[116:117], v14 offset:49152
    v_mfma_f32_16x16x32_bf16 v[148:151], v[68:71], v[40:43], v[148:151]
    ds_read_b64_tr_b16 v[118:119], v15 offset:49152
    v_mfma_f32_16x16x32_bf16 v[160:163], v[64:67], v[48:51], v[160:163]
    ds_read_b64_tr_b16 v[120:121], v12 offset:57344
    v_mfma_f32_16x16x32_bf16 v[164:167], v[68:71], v[48:51], v[164:167]
    ds_read_b64_tr_b16 v[122:123], v13 offset:57344
    v_mfma_f32_16x16x32_bf16 v[176:179], v[64:67], v[56:59], v[176:179]
    ds_read_b64_tr_b16 v[124:125], v14 offset:57344
    v_mfma_f32_16x16x32_bf16 v[180:183], v[68:71], v[56:59], v[180:183]
    ds_read_b64_tr_b16 v[126:127], v15 offset:57344
    v_mfma_f32_16x16x32_bf16 v[128:131], v[72:75], v[36:39], v[128:131]
    ds_read_b128 v[80:83], v6 offset:32768
    v_mfma_f32_16x16x32_bf16 v[132:135], v[76:79], v[36:39], v[132:135]
    ds_read_b128 v[84:87], v6 offset:33792
    v_mfma_f32_16x16x32_bf16 v[144:147], v[72:75], v[44:47], v[144:147]
    ds_read_b128 v[88:91], v6 offset:34816
    v_mfma_f32_16x16x32_bf16 v[148:151], v[76:79], v[44:47], v[148:151]
    ds_read_b128 v[92:95], v6 offset:35840
    v_mfma_f32_16x16x32_bf16 v[160:163], v[72:75], v[52:55], v[160:163]
    ds_read_b128 v[96:99], v6 offset:36864
    v_mfma_f32_16x16x32_bf16 v[164:167], v[76:79], v[52:55], v[164:167]
    ds_read_b128 v[100:103], v6 offset:37888
    v_mfma_f32_16x16x32_bf16 v[176:179], v[72:75], v[60:63], v[176:179]
    ds_read_b128 v[104:107], v6 offset:38912
    v_mfma_f32_16x16x32_bf16 v[180:183], v[76:79], v[60:63], v[180:183]
    ds_read_b128 v[108:111], v6 offset:39936
    s_waitcnt lgkmcnt(0)
    s_waitcnt vmcnt(8)
    s_barrier
    s_add_u32 m0, s21, 98304
    s_nop 0
    buffer_load_dwordx4 v1, s[4:7], s16 offen sc1 lds
    s_add_u32 s16, s16, s62
    s_add_u32 m0, s21, 99328
    s_nop 0
    buffer_load_dwordx4 v1, s[4:7], s17 offen sc1 lds
    s_add_u32 s17, s17, s62
    s_add_u32 m0, s22, 98304
    s_nop 0
    buffer_load_dwordx4 v2, s[8:11], s18 offen lds
    s_add_u32 s18, s18, s20
    s_add_u32 m0, s22, 106496
    s_nop 0
    buffer_load_dwordx4 v2, s[12:15], s19 offen lds
    s_add_u32 s19, s19, s20
    v_mfma_f32_16x16x32_bf16 v[128:131], v[112:115], v[80:83], v[128:131]
    ds_read_b64_tr_b16 v[64:65], v8 offset:16384
    v_mfma_f32_16x16x32_bf16 v[132:135], v[116:119], v[80:83], v[132:135]
    ds_read_b64_tr_b16 v[66:67], v9 offset:16384
    v_mfma_f32_16x16x32_bf16 v[144:147], v[112:115], v[88:91], v[144:147]
    ds_read_b64_tr_b16 v[68:69], v10 offset:16384
    v_mfma_f32_16x16x32_bf16 v[148:151], v[116:119], v[88:91], v[148:151]
    ds_read_b64_tr_b16 v[70:71], v11 offset:16384
    v_mfma_f32_16x16x32_bf16 v[160:163], v[112:115], v[96:99], v[160:163]
    ds_read_b64_tr_b16 v[72:73], v8 offset:24576
    v_mfma_f32_16x16x32_bf16 v[164:167], v[116:119], v[96:99], v[164:167]
    ds_read_b64_tr_b16 v[74:75], v9 offset:24576
    v_mfma_f32_16x16x32_bf16 v[176:179], v[112:115], v[104:107], v[176:179]
    ds_read_b64_tr_b16 v[76:77], v10 offset:24576
    v_mfma_f32_16x16x32_bf16 v[180:183], v[116:119], v[104:107], v[180:183]
    ds_read_b64_tr_b16 v[78:79], v11 offset:24576
    v_mfma_f32_16x16x32_bf16 v[128:131], v[120:123], v[84:87], v[128:131]
    ds_read_b128 v[32:35], v5 offset:0
    v_mfma_f32_16x16x32_bf16 v[132:135], v[124:127], v[84:87], v[132:135]
    ds_read_b128 v[36:39], v5 offset:1024
    v_mfma_f32_16x16x32_bf16 v[144:147], v[120:123], v[92:95], v[144:147]
    ds_read_b128 v[40:43], v5 offset:2048
    v_mfma_f32_16x16x32_bf16 v[148:151], v[124:127], v[92:95], v[148:151]
    ds_read_b128 v[44:47], v5 offset:3072
    v_mfma_f32_16x16x32_bf16 v[160:163], v[120:123], v[100:103], v[160:163]
    ds_read_b128 v[48:51], v5 offset:4096
    v_mfma_f32_16x16x32_bf16 v[164:167], v[124:127], v[100:103], v[164:167]
    ds_read_b128 v[52:55], v5 offset:5120
    v_mfma_f32_16x16x32_bf16 v[176:179], v[120:123], v[108:111], v[176:179]
    ds_read_b128 v[56:59], v5 offset:6144
    v_mfma_f32_16x16x32_bf16 v[180:183], v[124:127], v[108:111], v[180:183]
    ds_read_b128 v[60:63], v5 offset:7168
    s_waitcnt lgkmcnt(0)
w_loop_chkH:
    s_sub_u32 s23, s23, 1
w_loopH:
    s_cmp_lg_u32 s23, 1
    s_cbranch_scc1 w_bodyH
    buffer_load_dword v22, off, s[64:67], 0 sc1
    v_readfirstlane_b32 s30, v16
    s_cmp_ge_u32 s30, s45
    s_cselect_b32 s30, 0, 1
    s_or_b32 s30, s30, s70
    s_cmp_eq_u32 s32, 4
    s_cselect_b32 s30, 1, s30
    s_cmp_eq_u32 s32, 0
    s_cselect_b32 s30, 1, s30
    v_mov_b32 v20, s30
    ds_write_b32 v7, v20
    s_cbranch_scc1 w_bodyH
    s_load_dwordx2 s[8:9], s[0:1], s33
    s_load_dwordx2 s[12:13], s[0:1], s34
    s_mov_b32 s10, s38
    s_mov_b32 s14, s38
    s_cmp_eq_u32 s32, 4
    s_cselect_b32 s31, 0, 1
    s_lshl_b32 s30, s3, s31
    s_mul_i32 s30, s30, s40
    s_add_u32 s16, s39, s30
    s_cmp_eq_u32 s32, 4
    s_cselect_b32 s30, 1024, s40
    s_cselect_b32 s31, 6, 5
    s_lshl_b32 s62, 32, s31
    s_add_u32 s17, s16, s30
    s_lshl_b32 s30, s3, 2
    s_mul_i32 s30, s30, s35
    s_add_u32 s18, s36, s30
    s_add_u32 s19, s37, s30
    s_lshl_b32 s20, s35, s31
    v_mul_u32_u24 v2, s35, v4
    v_add_u32 v2, v2, v3
    s_waitcnt lgkmcnt(0)
w_bodyH:
    s_waitcnt vmcnt(8)
    s_barrier
    s_add_u32 m0, s21, 0
    s_nop 0
    buffer_load_dwordx4 v1, s[4:7], s16 offen sc1 lds
    s_add_u32 s16, s16, s62
    s_add_u32 m0, s21, 1024
    s_nop 0
    buffer_load_dwordx4 v1, s[4:7], s17 offen sc1 lds
    s_add_u32 s17, s17, s62
    s_add_u32 m0, s22, 0
    s_nop 0
    buffer_load_dwordx4 v2, s[8:11], s18 offen lds
    s_add_u32 s18, s18, s20
    s_add_u32 m0, s22, 8192
    s_nop 0
    buffer_load_dwordx4 v2, s[12:15], s19 offen lds
    s_add_u32 s19, s19, s20
    v_mfma_f32_16x16x32_bf16 v[128:131], v[64:67], v[32:35], v[128:131]
    ds_read_b64_tr_b16 v[112:113], v8 offset:49152
    v_mfma_f32_16x16x32_bf16 v[132:135], v[68:71], v[32:35], v[132:135]
    ds_read_b64_tr_b16 v[114:115], v9 offset:49152
    v_mfma_f32_16x16x32_bf16 v[144:147], v[64:67], v[40:43], v[144:147]
    ds_read_b64_tr_b16 v[116:117], v10 offset:49152
    v_mfma_f32_16x16x32_bf16 v[148:151], v[68:71], v[40:43], v[148:151]
    ds_read_b64_tr_b16 v[118:119], v11 offset:49152
    v_mfma_f32_16x16x32_bf16 v[160:163], v[64:67], v[48:51], v[160:163]
    ds_read_b64_tr_b16 v[120:121], v8 offset:57344
    v_mfma_f32_16x16x32_bf16 v[164:167], v[68:71], v[48:51], v[164:167]
    ds_read_b64_tr_b16 v[122:123], v9 offset:57344
    v_mfma_f32_16x16x32_bf16 v[176:179], v[64:67], v[56:59], v[176:179]
    ds_read_b64_tr_b16 v[124:125], v10 offset:57344
    v_mfma_f32_16x16x32_bf16 v[180:183], v[68:71], v[56:59], v[180:183]
    ds_read_b64_tr_b16 v[126:127], v11 offset:57344
    v_mfma_f32_16x16x32_bf16 v[128:131], v[72:75], v[36:39], v[128:131]
    ds_read_b128 v[80:83], v5 offset:32768
    v_mfma_f32_16x16x32_bf16 v[132:135], v[76:79], v[36:39], v[132:135]
    ds_read_b128 v[84:87], v5 offset:33792
    v_mfma_f32_16x16x32_bf16 v[144:147], v[72:75], v[44:47], v[144:147]
    ds_read_b128 v[88:91], v5 offset:34816
    v_mfma_f32_16x16x32_bf16 v[148:151], v[76:79], v[44:47], v[148:151]
    ds_read_b128 v[92:95], v5 offset:35840
    v_mfma_f32_16x16x32_bf16 v[160:163], v[72:75], v[52:55], v[160:163]
    ds_read_b128 v[96:99], v5 offset:36864
    v_mfma_f32_16x16x32_bf16 v[164:167], v[76:79], v[52:55], v[164:167]
    ds_read_b128 v[100:103], v5 offset:37888
    v_mfma_f32_16x16x32_bf16 v[176:179], v[72:75], v[60:63], v[176:179]
    ds_read_b128 v[104:107], v5 offset:38912
    v_mfma_f32_16x16x32_bf16 v[180:183], v[76:79], v[60:63], v[180:183]
    ds_read_b128 v[108:111], v5 offset:39936
    buffer_load_dword v16, v17, s[4:7], s44 offen sc1
    s_waitcnt lgkmcnt(0)
    s_waitcnt vmcnt(8)
    s_barrier
    s_add_u32 m0, s21, 32768
    s_nop 0
    buffer_load_dwordx4 v1, s[4:7], s16 offen sc1 lds
    s_add_u32 s16, s16, s62
    s_add_u32 m0, s21, 33792
    s_nop 0
    buffer_load_dwordx4 v1, s[4:7], s17 offen sc1 lds
    s_add_u32 s17, s17, s62
    s_add_u32 m0, s22, 32768
    s_nop 0
    buffer_load_dwordx4 v2, s[8:11], s18 offen lds
    s_add_u32 s18, s18, s20
    s_add_u32 m0, s22, 40960
    s_nop 0
    buffer_load_dwordx4 v2, s[12:15], s19 offen lds
    s_add_u32 s19, s19, s20
    v_mfma_f32_16x16x32_bf16 v[128:131], v[112:115], v[80:83], v[128:131]
    ds_read_b64_tr_b16 v[64:65], v12 offset:16384
    v_mfma_f32_16x16x32_bf16 v[132:135], v[116:119], v[80:83], v[132:135]
    ds_read_b64_tr_b16 v[66:67], v13 offset:16384
    v_mfma_f32_16x16x32_bf16 v[144:147], v[112:115], v[88:91], v[144:147]
    ds_read_b64_tr_b16 v[68:69], v14 offset:16384
    v_mfma_f32_16x16x32_bf16 v[148:151], v[116:119], v[88:91], v[148:151]
    ds_read_b64_tr_b16 v[70:71], v15 offset:16384
    v_mfma_f32_16x16x32_bf16 v[160:163], v[112:115], v[96:99], v[160:163]
    ds_read_b64_tr_b16 v[72:73], v12 offset:24576
    v_mfma_f32_16x16x32_bf16 v[164:167], v[116:119], v[96:99], v[164:167]
    ds_read_b64_tr_b16 v[74:75], v13 offset:24576
    v_mfma_f32_16x16x32_bf16 v[176:179], v[112:115], v[104:107], v[176:179]
    ds_read_b64_tr_b16 v[76:77], v14 offset:24576
    v_mfma_f32_16x16x32_bf16 v[180:183], v[116:119], v[104:107], v[180:183]
    ds_read_b64_tr_b16 v[78:79], v15 offset:24576
    v_mfma_f32_16x16x32_bf16 v[128:131], v[120:123], v[84:87], v[128:131]
    ds_read_b128 v[32:35], v6 offset:0
    v_mfma_f32_16x16x32_bf16 v[132:135], v[124:127], v[84:87], v[132:135]
    ds_read_b128 v[36:39], v6 offset:1024
    v_mfma_f32_16x16x32_bf16 v[144:147], v[120:123], v[92:95], v[144:147]
    ds_read_b128 v[40:43], v6 offset:2048
    v_mfma_f32_16x16x32_bf16 v[148:151], v[124:127], v[92:95], v[148:151]
    ds_read_b128 v[44:47], v6 offset:3072
    v_mfma_f32_16x16x32_bf16 v[160:163], v[120:123], v[100:103], v[160:163]
    ds_read_b128 v[48:51], v6 offset:4096
    v_mfma_f32_16x16x32_bf16 v[164:167], v[124:127], v[100:103], v[164:167]
    ds_read_b128 v[52:55], v6 offset:5120
    v_mfma_f32_16x16x32_bf16 v[176:179], v[120:123], v[108:111], v[176:179]
    ds_read_b128 v[56:59], v6 offset:6144
    v_mfma_f32_16x16x32_bf16 v[180:183], v[124:127], v[108:111], v[180:183]
    ds_read_b128 v[60:63], v6 offset:7168
    s_waitcnt lgkmcnt(0)
    s_waitcnt vmcnt(8)
    s_barrier
    s_add_u32 m0, s21, 65536
    s_nop 0
    buffer_load_dwordx4 v1, s[4:7], s16 offen sc1 lds
    s_add_u32 s16, s16, s62
    s_add_u32 m0, s21, 66560
    s_nop 0
    buffer_load_dwordx4 v1, s[4:7], s17 offen sc1 lds
    s_add_u32 s17, s17, s62
    s_add_u32 m0, s22, 65536
    s_nop 0
    buffer_load_dwordx4 v2, s[8:11], s18 offen lds
    s_add_u32 s18, s18, s20
    s_add_u32 m0, s22, 73728
    s_nop 0
    buffer_load_dwordx4 v2, s[12:15], s19 offen lds
    s_add_u32 s19, s19, s20
    v_mfma_f32_16x16x32_bf16 v[128:131], v[64:67], v[32:35], v[128:131]
    ds_read_b64_tr_b16 v[112:113], v12 offset:49152
    v_mfma_f32_16x16x32_bf16 v[132:135], v[68:71], v[32:35], v[132:135]
    ds_read_b64_tr_b16 v[114:115], v13 offset:49152
    v_mfma_f32_16x16x32_bf16 v[144:147], v[64:67], v[40:43], v[144:147]
    ds_read_b64_tr_b16 v[116:117], v14 offset:49152
    v_mfma_f32_16x16x32_bf16 v[148:151], v[68:71], v[40:43], v[148:151]
    ds_read_b64_tr_b16 v[118:119], v15 offset:49152
    v_mfma_f32_16x16x32_bf16 v[160:163], v[64:67], v[48:51], v[160:163]
    ds_read_b64_tr_b16 v[120:121], v12 offset:57344
    v_mfma_f32_16x16x32_bf16 v[164:167], v[68:71], v[48:51], v[164:167]
    ds_read_b64_tr_b16 v[122:123], v13 offset:57344
    v_mfma_f32_16x16x32_bf16 v[176:179], v[64:67], v[56:59], v[176:179]
    ds_read_b64_tr_b16 v[124:125], v14 offset:57344
    v_mfma_f32_16x16x32_bf16 v[180:183], v[68:71], v[56:59], v[180:183]
    ds_read_b64_tr_b16 v[126:127], v15 offset:57344
    v_mfma_f32_16x16x32_bf16 v[128:131], v[72:75], v[36:39], v[128:131]
    ds_read_b128 v[80:83], v6 offset:32768
    v_mfma_f32_16x16x32_bf16 v[132:135], v[76:79], v[36:39], v[132:135]
    ds_read_b128 v[84:87], v6 offset:33792
    v_mfma_f32_16x16x32_bf16 v[144:147], v[72:75], v[44:47], v[144:147]
    ds_read_b128 v[88:91], v6 offset:34816
    v_mfma_f32_16x16x32_bf16 v[148:151], v[76:79], v[44:47], v[148:151]
    ds_read_b128 v[92:95], v6 offset:35840
    v_mfma_f32_16x16x32_bf16 v[160:163], v[72:75], v[52:55], v[160:163]
    ds_read_b128 v[96:99], v6 offset:36864
    v_mfma_f32_16x16x32_bf16 v[164:167], v[76:79], v[52:55], v[164:167]
    ds_read_b128 v[100:103], v6 offset:37888
    v_mfma_f32_16x16x32_bf16 v[176:179], v[72:75], v[60:63], v[176:179]
    ds_read_b128 v[104:107], v6 offset:38912
    v_mfma_f32_16x16x32_bf16 v[180:183], v[76:79], v[60:63], v[180:183]
    ds_read_b128 v[108:111], v6 offset:39936
    s_waitcnt lgkmcnt(0)
    s_waitcnt vmcnt(8)
    s_barrier
    s_add_u32 m0, s21, 98304
    s_nop 0
    buffer_load_dwordx4 v1, s[4:7], s16 offen sc1 lds
    s_add_u32 s16, s16, s62
    s_add_u32 m0, s21, 99328
    s_nop 0
    buffer_load_dwordx4 v1, s[4:7], s17 offen sc1 lds
    s_add_u32 s17, s17, s62
    s_add_u32 m0, s22, 98304
    s_nop 0
    buffer_load_dwordx4 v2, s[8:11], s18 offen lds
    s_add_u32 s18, s18, s20
    s_add_u32 m0, s22, 106496
    s_nop 0
    buffer_load_dwordx4 v2, s[12:15], s19 offen lds
    s_add_u32 s19, s19, s20
    v_mfma_f32_16x16x32_bf16 v[128:131], v[112:115], v[80:83], v[128:131]
    ds_read_b64_tr_b16 v[64:65], v8 offset:16384
    v_mfma_f32_16x16x32_bf16 v[132:135], v[116:119], v[80:83], v[132:135]
    ds_read_b64_tr_b16 v[66:67], v9 offset:16384
    v_mfma_f32_16x16x32_bf16 v[144:147], v[112:115], v[88:91], v[144:147]
    ds_read_b64_tr_b16 v[68:69], v10 offset:16384
    v_mfma_f32_16x16x32_bf16 v[148:151], v[116:119], v[88:91], v[148:151]
    ds_read_b64_tr_b16 v[70:71], v11 offset:16384
    v_mfma_f32_16x16x32_bf16 v[160:163], v[112:115], v[96:99], v[160:163]
    ds_read_b64_tr_b16 v[72:73], v8 offset:24576
    v_mfma_f32_16x16x32_bf16 v[164:167], v[116:119], v[96:99], v[164:167]
    ds_read_b64_tr_b16 v[74:75], v9 offset:24576
    v_mfma_f32_16x16x32_bf16 v[176:179], v[112:115], v[104:107], v[176:179]
    ds_read_b64_tr_b16 v[76:77], v10 offset:24576
    v_mfma_f32_16x16x32_bf16 v[180:183], v[116:119], v[104:107], v[180:183]
    ds_read_b64_tr_b16 v[78:79], v11 offset:24576
    v_mfma_f32_16x16x32_bf16 v[128:131], v[120:123], v[84:87], v[128:131]
    ds_read_b128 v[32:35], v5 offset:0
    v_mfma_f32_16x16x32_bf16 v[132:135], v[124:127], v[84:87], v[132:135]
    ds_read_b128 v[36:39], v5 offset:1024
    v_mfma_f32_16x16x32_bf16 v[144:147], v[120:123], v[92:95], v[144:147]
    ds_read_b128 v[40:43], v5 offset:2048
    v_mfma_f32_16x16x32_bf16 v[148:151], v[124:127], v[92:95], v[148:151]
    ds_read_b128 v[44:47], v5 offset:3072
    v_mfma_f32_16x16x32_bf16 v[160:163], v[120:123], v[100:103], v[160:163]
    ds_read_b128 v[48:51], v5 offset:4096
    v_mfma_f32_16x16x32_bf16 v[164:167], v[124:127], v[100:103], v[164:167]
    ds_read_b128 v[52:55], v5 offset:5120
    v_mfma_f32_16x16x32_bf16 v[176:179], v[120:123], v[108:111], v[176:179]
    ds_read_b128 v[56:59], v5 offset:6144
    v_mfma_f32_16x16x32_bf16 v[180:183], v[124:127], v[108:111], v[180:183]
    ds_read_b128 v[60:63], v5 offset:7168
    s_waitcnt lgkmcnt(0)
    s_sub_u32 s23, s23, 1
    s_cmp_lg_u32 s23, 0
    s_cbranch_scc1 w_loopH
    v_mov_b32 v20, 131072
    ds_read_b128 v[24:27], v20
    ds_read_b128 v[28:31], v20 offset:16
    s_lshl_b32 s30, s27, 10
    s_add_u32 s30, s30, s49
    s_nop 7
    v_cvt_pk_bf16_f32 v80, v128, v129
    v_cvt_pk_bf16_f32 v81, v130, v131
    v_cvt_pk_bf16_f32 v82, v132, v133
    v_cvt_pk_bf16_f32 v83, v134, v135
    buffer_store_dwordx4 v[80:83], v1, s[4:7], s30 offen sc1
    s_add_u32 s30, s30, s50
    v_cvt_pk_bf16_f32 v84, v144, v145
    v_cvt_pk_bf16_f32 v85, v146, v147
    v_cvt_pk_bf16_f32 v86, v148, v149
    v_cvt_pk_bf16_f32 v87, v150, v151
    buffer_store_dwordx4 v[84:87], v1, s[4:7], s30 offen sc1
    s_add_u32 s30, s30, s50
    v_cvt_pk_bf16_f32 v88, v160, v161
    v_cvt_pk_bf16_f32 v89, v162, v163
    v_cvt_pk_bf16_f32 v90, v164, v165
    v_cvt_pk_bf16_f32 v91, v166, v167
    buffer_store_dwordx4 v[88:91], v1, s[4:7], s30 offen sc1
    s_add_u32 s30, s30, s50
    v_cvt_pk_bf16_f32 v92, v176, v177
    v_cvt_pk_bf16_f32 v93, v178, v179
    v_cvt_pk_bf16_f32 v94, v180, v181
    v_cvt_pk_bf16_f32 v95, v182, v183
    buffer_store_dwordx4 v[92:95], v1, s[4:7], s30 offen sc1
    s_add_u32 s30, s30, s50
    s_waitcnt lgkmcnt(0)
    v_or3_b32 v24, v24, v25, v26
    v_or3_b32 v28, v28, v29, v30
    v_or3_b32 v24, v24, v27, v31
    v_or_b32 v24, v24, v28
    s_mov_b32 s28, s51
    v_readfirstlane_b32 s30, v24
    s_cmp_lg_u32 s30, 0
    s_cbranch_scc1 w_drain
    s_mov_b32 s48, s32
    s_cmp_eq_u32 s32, 4
    s_cselect_b32 s30, 2, 3
    s_lshl_b32 s30, s26, s30
    s_mul_i32 s30, s30, s43
    s_add_u32 s49, s42, s30
    s_mov_b32 s50, s43
    s_mov_b32 s51, s46
    s_mov_b32 s23, s41
    s_mov_b32 s53, s47
    s_nop 0
    s_load_dwordx16 s[32:47], s[24:25], 0
    s_add_u32 s24, s24, 64
    s_addc_u32 s25, s25, 0
    s_branch w_first4
w_drain:
    s_waitcnt vmcnt(0)
    s_barrier
    s_cmp_eq_u32 s70, 0
    s_cbranch_scc1 drw_ok
    s_mov_b32 s70, 0
    s_cmp_lg_u32 s3, 0
    s_cbranch_scc1 drw_ok
    v_readfirstlane_b32 s68, v22
    s_cmp_ge_u32 s68, 128
    s_cbranch_scc1 drw_ok
    s_mov_b32 s69, 65536
drw:
    buffer_load_dword v20, off, s[64:67], 0 offset:0 sc1
    s_waitcnt vmcnt(0)
    v_readfirstlane_b32 s68, v20
    s_cmp_ge_u32 s68, 128
    s_cbranch_scc1 drw_ok
    s_sleep 8
    s_sub_u32 s69, s69, 1
    s_cbranch_scc0 drw
drw_ok:
    s_cmp_eq_u32 s28, 0
    s_cbranch_scc1 sig_5
    s_cmp_lg_u32 s3, 0
    s_cbranch_scc1 sig_5
    s_and_b32 s57, s28, 3
    v_mov_b32 v24, s57
    s_bfe_u32 s57, s28, 0x20002
    v_mov_b32 v25, s57
    s_andn2_b32 s28, s28, 15
    s_mov_b64 exec, 1
    buffer_atomic_add_x2 v[24:25], v17, s[4:7], s28 offen sc1
    s_mov_b64 exec, -1
sig_5:
    s_mov_b32 s28, 0
    s_branch w_cold
fin_entry:
    s_load_dwordx2 s[8:9], s[0:1], 0
    s_load_dwordx2 s[12:13], s[0:1], 88
    v_mbcnt_lo_u32_b32 v1, -1, 0
    v_mbcnt_hi_u32_b32 v1, -1, v1
    s_mov_b32 s10, 4194304
    s_mov_b32 s11, 131072
    s_mov_b32 s14, 4194304
    s_mov_b32 s15, 131072
    s_mov_b32 s35, 0xbfb8aa3b
    v_lshlrev_b32 v3, 4, v1
    v_and_b32 v4, 15, v1
    v_lshrrev_b32 v5, 4, v1
    v_lshlrev_b32 v4, 11, v4
    v_lshl_add_u32 v4, v5, 4, v4
    v_and_b32 v5, 1, v5
    v_cmp_eq_u32 s[20:21], 1, v5
    v_and_b32 v6, 3, v1
    v_lshlrev_b32 v6, 7, v6
    s_lshr_b32 s24, s63, 2
    s_and_b32 s25, s63, 3
    s_lshl_b32 s25, s25, 2
    s_and_b32 s26, s3, 3
    s_add_u32 s25, s25, s26
    s_lshr_b32 s26, s3, 2
    s_mov_b32 s28, 65536
    s_mov_b32 s30, 218112000
    s_waitcnt lgkmcnt(0)
fin_job:
    s_lshl_b32 s16, s24, 1
    s_add_u32 s16, s16, s26
    s_lshl_b32 s18, s16, 15
    s_lshl_b32 s17, s25, 11
    s_add_u32 s17, s17, s18
    s_lshl_b32 s19, s25, 7
    s_add_u32 s18, s18, s19
    s_add_u32 s22, s17, 117440512
    s_add_u32 s23, s17, 75497472
    s_lshr_b32 s27, s24, 3
    s_lshl_b32 s27, s27, 6
    s_add_u32 s27, s27, 218106368
    s_add_u32 s32, s24, 1
    buffer_load_dwordx4 v[88:91], v4, s[8:11], s18 offen offset:0
    buffer_load_dwordx4 v[92:95], v4, s[8:11], s18 offen offset:64
    s_cmp_lg_u32 s3, 0
    s_cbranch_scc1 fin_ws_ok
fin_wd:
    buffer_load_dword v7, off, s[4:7], s27 sc1
    s_waitcnt vmcnt(0)
    v_readfirstlane_b32 s31, v7
    s_cmp_ge_u32 s31, 16
    s_cbranch_scc1 fin_ws
    s_sleep 64
    s_sub_u32 s28, s28, 1
    s_cbranch_scc0 fin_wd
    s_mov_b32 s28, 0
fin_ws:
    buffer_load_dword v7, v6, s[4:7], s30 offen sc1
    s_waitcnt vmcnt(0)
    v_cmp_gt_u32 vcc, s32, v7
    s_cbranch_vccz fin_ws_ok
    s_sleep 12
    s_sub_u32 s31, s32, 2
    v_cmp_gt_i32 vcc, s31, v7
    s_cbranch_vccz fin_ws_f
    s_sleep 64
    s_sub_u32 s31, s32, 6
    v_cmp_gt_i32 vcc, s31, v7
    s_cbranch_vccz fin_ws_f
    s_sleep 127
    s_sleep 127
fin_ws_f:
    s_sub_u32 s28, s28, 1
    s_cbranch_scc0 fin_ws
    s_mov_b32 s28, 0
fin_ws_ok:
    s_barrier
    buffer_load_dwordx4 v[136:139], v3, s[4:7], s22 offen offset:0 sc1
    buffer_load_dwordx4 v[140:143], v3, s[4:7], s22 offen offset:1024 sc1
    s_add_u32 s22, s22, 4194304
    buffer_load_dwordx4 v[144:147], v3, s[4:7], s22 offen offset:0 sc1
    buffer_load_dwordx4 v[148:151], v3, s[4:7], s22 offen offset:1024 sc1
    s_add_u32 s22, s22, 4194304
    buffer_load_dwordx4 v[152:155], v3, s[4:7], s22 offen offset:0 sc1
    buffer_load_dwordx4 v[156:159], v3, s[4:7], s22 offen offset:1024 sc1
    s_add_u32 s22, s22, 4194304
    buffer_load_dwordx4 v[160:163], v3, s[4:7], s22 offen offset:0 sc1
    buffer_load_dwordx4 v[164:167], v3, s[4:7], s22 offen offset:1024 sc1
    s_add_u32 s22, s22, 4194304
    buffer_load_dwordx4 v[16:19], v3, s[4:7], s23 offen offset:0 sc1
    buffer_load_dwordx4 v[48:51], v3, s[4:7], s23 offen offset:1024 sc1
    s_add_u32 s23, s23, 4194304
    buffer_load_dwordx4 v[20:23], v3, s[4:7], s23 offen offset:0 sc1
    buffer_load_dwordx4 v[52:55], v3, s[4:7], s23 offen offset:1024 sc1
    s_add_u32 s23, s23, 4194304
    buffer_load_dwordx4 v[24:27], v3, s[4:7], s23 offen offset:0 sc1
    buffer_load_dwordx4 v[56:59], v3, s[4:7], s23 offen offset:1024 sc1
    s_add_u32 s23, s23, 4194304
    buffer_load_dwordx4 v[28:31], v3, s[4:7], s23 offen offset:0 sc1
    buffer_load_dwordx4 v[60:63], v3, s[4:7], s23 offen offset:1024 sc1
    s_add_u32 s23, s23, 4194304
    buffer_load_dwordx4 v[32:35], v3, s[4:7], s23 offen offset:0 sc1
    buffer_load_dwordx4 v[64:67], v3, s[4:7], s23 offen offset:1024 sc1
    s_add_u32 s23, s23, 4194304
    buffer_load_dwordx4 v[36:39], v3, s[4:7], s23 offen offset:0 sc1
    buffer_load_dwordx4 v[68:71], v3, s[4:7], s23 offen offset:1024 sc1
    s_add_u32 s23, s23, 4194304
    buffer_load_dwordx4 v[40:43], v3, s[4:7], s23 offen offset:0 sc1
    buffer_load_dwordx4 v[72:75], v3, s[4:7], s23 offen offset:1024 sc1
    s_add_u32 s23, s23, 4194304
    buffer_load_dwordx4 v[44:47], v3, s[4:7], s23 offen offset:0 sc1
    buffer_load_dwordx4 v[76:79], v3, s[4:7], s23 offen offset:1024 sc1
    s_add_u32 s23, s23, 4194304
    s_waitcnt vmcnt(16)
    v_lshlrev_b32 v120, 16, v136
    v_and_b32 v121, 0xffff0000, v136
    v_lshlrev_b32 v136, 16, v144
    v_and_b32 v144, 0xffff0000, v144
    v_add_f32 v120, v120, v136
    v_add_f32 v121, v121, v144
    v_lshlrev_b32 v136, 16, v152
    v_and_b32 v152, 0xffff0000, v152
    v_add_f32 v120, v120, v136
    v_add_f32 v121, v121, v152
    v_lshlrev_b32 v136, 16, v160
    v_and_b32 v160, 0xffff0000, v160
    v_add_f32 v120, v120, v136
    v_add_f32 v121, v121, v160
    v_cvt_pk_bf16_f32 v136, v120, v121
    v_lshlrev_b32 v120, 16, v136
    v_and_b32 v121, 0xffff0000, v136
    v_mul_f32 v136, s35, v120
    v_mul_f32 v144, s35, v121
    v_lshlrev_b32 v122, 16, v137
    v_and_b32 v123, 0xffff0000, v137
    v_lshlrev_b32 v137, 16, v145
    v_and_b32 v145, 0xffff0000, v145
    v_add_f32 v122, v122, v137
    v_add_f32 v123, v123, v145
    v_lshlrev_b32 v137, 16, v153
    v_and_b32 v153, 0xffff0000, v153
    v_add_f32 v122, v122, v137
    v_add_f32 v123, v123, v153
    v_lshlrev_b32 v137, 16, v161
    v_and_b32 v161, 0xffff0000, v161
    v_add_f32 v122, v122, v137
    v_add_f32 v123, v123, v161
    v_cvt_pk_bf16_f32 v137, v122, v123
    v_lshlrev_b32 v122, 16, v137
    v_and_b32 v123, 0xffff0000, v137
    v_mul_f32 v137, s35, v122
    v_mul_f32 v145, s35, v123
    v_lshlrev_b32 v124, 16, v138
    v_and_b32 v125, 0xffff0000, v138
    v_lshlrev_b32 v138, 16, v146
    v_and_b32 v146, 0xffff0000, v146
    v_add_f32 v124, v124, v138
    v_add_f32 v125, v125, v146
    v_lshlrev_b32 v138, 16, v154
    v_and_b32 v154, 0xffff0000, v154
    v_add_f32 v124, v124, v138
    v_add_f32 v125, v125, v154
    v_lshlrev_b32 v138, 16, v162
    v_and_b32 v162, 0xffff0000, v162
    v_add_f32 v124, v124, v138
    v_add_f32 v125, v125, v162
    v_cvt_pk_bf16_f32 v138, v124, v125
    v_lshlrev_b32 v124, 16, v138
    v_and_b32 v125, 0xffff0000, v138
    v_mul_f32 v138, s35, v124
    v_mul_f32 v146, s35, v125
    v_lshlrev_b32 v126, 16, v139
    v_and_b32 v127, 0xffff0000, v139
    v_lshlrev_b32 v139, 16, v147
    v_and_b32 v147, 0xffff0000, v147
    v_add_f32 v126, v126, v139
    v_add_f32 v127, v127, v147
    v_lshlrev_b32 v139, 16, v155
    v_and_b32 v155, 0xffff0000, v155
    v_add_f32 v126, v126, v139
    v_add_f32 v127, v127, v155
    v_lshlrev_b32 v139, 16, v163
    v_and_b32 v163, 0xffff0000, v163
    v_add_f32 v126, v126, v139
    v_add_f32 v127, v127, v163
    v_cvt_pk_bf16_f32 v139, v126, v127
    v_lshlrev_b32 v126, 16, v139
    v_and_b32 v127, 0xffff0000, v139
    v_mul_f32 v139, s35, v126
    v_mul_f32 v147, s35, v127
    v_exp_f32 v136, v136
    v_exp_f32 v144, v144
    v_exp_f32 v137, v137
    v_exp_f32 v145, v145
    v_exp_f32 v138, v138
    v_exp_f32 v146, v146
    v_exp_f32 v139, v139
    v_exp_f32 v147, v147
    s_nop 0
    v_add_f32 v136, 1.0, v136
    v_add_f32 v144, 1.0, v144
    v_add_f32 v137, 1.0, v137
    v_add_f32 v145, 1.0, v145
    v_add_f32 v138, 1.0, v138
    v_add_f32 v146, 1.0, v146
    v_add_f32 v139, 1.0, v139
    v_add_f32 v147, 1.0, v147
    v_rcp_f32 v136, v136
    v_rcp_f32 v144, v144
    v_rcp_f32 v137, v137
    v_rcp_f32 v145, v145
    v_rcp_f32 v138, v138
    v_rcp_f32 v146, v146
    v_rcp_f32 v139, v139
    v_rcp_f32 v147, v147
    s_nop 0
    v_mul_f32 v120, v120, v136
    v_mul_f32 v121, v121, v144
    v_cvt_pk_bf16_f32 v136, v120, v121
    v_mul_f32 v122, v122, v137
    v_mul_f32 v123, v123, v145
    v_cvt_pk_bf16_f32 v137, v122, v123
    v_mul_f32 v124, v124, v138
    v_mul_f32 v125, v125, v146
    v_cvt_pk_bf16_f32 v138, v124, v125
    v_mul_f32 v126, v126, v139
    v_mul_f32 v127, v127, v147
    v_cvt_pk_bf16_f32 v139, v126, v127
    v_lshlrev_b32 v120, 16, v140
    v_and_b32 v121, 0xffff0000, v140
    v_lshlrev_b32 v140, 16, v148
    v_and_b32 v148, 0xffff0000, v148
    v_add_f32 v120, v120, v140
    v_add_f32 v121, v121, v148
    v_lshlrev_b32 v140, 16, v156
    v_and_b32 v156, 0xffff0000, v156
    v_add_f32 v120, v120, v140
    v_add_f32 v121, v121, v156
    v_lshlrev_b32 v140, 16, v164
    v_and_b32 v164, 0xffff0000, v164
    v_add_f32 v120, v120, v140
    v_add_f32 v121, v121, v164
    v_cvt_pk_bf16_f32 v140, v120, v121
    v_lshlrev_b32 v120, 16, v140
    v_and_b32 v121, 0xffff0000, v140
    v_mul_f32 v140, s35, v120
    v_mul_f32 v148, s35, v121
    v_lshlrev_b32 v122, 16, v141
    v_and_b32 v123, 0xffff0000, v141
    v_lshlrev_b32 v141, 16, v149
    v_and_b32 v149, 0xffff0000, v149
    v_add_f32 v122, v122, v141
    v_add_f32 v123, v123, v149
    v_lshlrev_b32 v141, 16, v157
    v_and_b32 v157, 0xffff0000, v157
    v_add_f32 v122, v122, v141
    v_add_f32 v123, v123, v157
    v_lshlrev_b32 v141, 16, v165
    v_and_b32 v165, 0xffff0000, v165
    v_add_f32 v122, v122, v141
    v_add_f32 v123, v123, v165
    v_cvt_pk_bf16_f32 v141, v122, v123
    v_lshlrev_b32 v122, 16, v141
    v_and_b32 v123, 0xffff0000, v141
    v_mul_f32 v141, s35, v122
    v_mul_f32 v149, s35, v123
    v_lshlrev_b32 v124, 16, v142
    v_and_b32 v125, 0xffff0000, v142
    v_lshlrev_b32 v142, 16, v150
    v_and_b32 v150, 0xffff0000, v150
    v_add_f32 v124, v124, v142
    v_add_f32 v125, v125, v150
    v_lshlrev_b32 v142, 16, v158
    v_and_b32 v158, 0xffff0000, v158
    v_add_f32 v124, v124, v142
    v_add_f32 v125, v125, v158
    v_lshlrev_b32 v142, 16, v166
    v_and_b32 v166, 0xffff0000, v166
    v_add_f32 v124, v124, v142
    v_add_f32 v125, v125, v166
    v_cvt_pk_bf16_f32 v142, v124, v125
    v_lshlrev_b32 v124, 16, v142
    v_and_b32 v125, 0xffff0000, v142
    v_mul_f32 v142, s35, v124
    v_mul_f32 v150, s35, v125
    v_lshlrev_b32 v126, 16, v143
    v_and_b32 v127, 0xffff0000, v143
    v_lshlrev_b32 v143, 16, v151
    v_and_b32 v151, 0xffff0000, v151
    v_add_f32 v126, v126, v143
    v_add_f32 v127, v127, v151
    v_lshlrev_b32 v143, 16, v159
    v_and_b32 v159, 0xffff0000, v159
    v_add_f32 v126, v126, v143
    v_add_f32 v127, v127, v159
    v_lshlrev_b32 v143, 16, v167
    v_and_b32 v167, 0xffff0000, v167
    v_add_f32 v126, v126, v143
    v_add_f32 v127, v127, v167
    v_cvt_pk_bf16_f32 v143, v126, v127
    v_lshlrev_b32 v126, 16, v143
    v_and_b32 v127, 0xffff0000, v143
    v_mul_f32 v143, s35, v126
    v_mul_f32 v151, s35, v127
    v_exp_f32 v140, v140
    v_exp_f32 v148, v148
    v_exp_f32 v141, v141
    v_exp_f32 v149, v149
    v_exp_f32 v142, v142
    v_exp_f32 v150, v150
    v_exp_f32 v143, v143
    v_exp_f32 v151, v151
    s_nop 0
    v_add_f32 v140, 1.0, v140
    v_add_f32 v148, 1.0, v148
    v_add_f32 v141, 1.0, v141
    v_add_f32 v149, 1.0, v149
    v_add_f32 v142, 1.0, v142
    v_add_f32 v150, 1.0, v150
    v_add_f32 v143, 1.0, v143
    v_add_f32 v151, 1.0, v151
    v_rcp_f32 v140, v140
    v_rcp_f32 v148, v148
    v_rcp_f32 v141, v141
    v_rcp_f32 v149, v149
    v_rcp_f32 v142, v142
    v_rcp_f32 v150, v150
    v_rcp_f32 v143, v143
    v_rcp_f32 v151, v151
    s_nop 0
    v_mul_f32 v120, v120, v140
    v_mul_f32 v121, v121, v148
    v_cvt_pk_bf16_f32 v140, v120, v121
    v_mul_f32 v122, v122, v141
    v_mul_f32 v123, v123, v149
    v_cvt_pk_bf16_f32 v141, v122, v123
    v_mul_f32 v124, v124, v142
    v_mul_f32 v125, v125, v150
    v_cvt_pk_bf16_f32 v142, v124, v125
    v_mul_f32 v126, v126, v143
    v_mul_f32 v127, v127, v151
    v_cvt_pk_bf16_f32 v143, v126, v127
    s_waitcnt vmcnt(0)
    v_lshlrev_b32 v96, 16, v16
    v_and_b32 v97, 0xffff0000, v16
    v_lshlrev_b32 v98, 16, v17
    v_and_b32 v99, 0xffff0000, v17
    v_lshlrev_b32 v100, 16, v18
    v_and_b32 v101, 0xffff0000, v18
    v_lshlrev_b32 v102, 16, v19
    v_and_b32 v103, 0xffff0000, v19
    v_lshlrev_b32 v120, 16, v20
    v_and_b32 v121, 0xffff0000, v20
    v_lshlrev_b32 v122, 16, v21
    v_and_b32 v123, 0xffff0000, v21
    v_lshlrev_b32 v124, 16, v22
    v_and_b32 v125, 0xffff0000, v22
    v_lshlrev_b32 v126, 16, v23
    v_and_b32 v127, 0xffff0000, v23
    v_add_f32 v96, v96, v120
    v_add_f32 v97, v97, v121
    v_add_f32 v98, v98, v122
    v_add_f32 v99, v99, v123
    v_add_f32 v100, v100, v124
    v_add_f32 v101, v101, v125
    v_add_f32 v102, v102, v126
    v_add_f32 v103, v103, v127
    v_lshlrev_b32 v120, 16, v24
    v_and_b32 v121, 0xffff0000, v24
    v_lshlrev_b32 v122, 16, v25
    v_and_b32 v123, 0xffff0000, v25
    v_lshlrev_b32 v124, 16, v26
    v_and_b32 v125, 0xffff0000, v26
    v_lshlrev_b32 v126, 16, v27
    v_and_b32 v127, 0xffff0000, v27
    v_add_f32 v96, v96, v120
    v_add_f32 v97, v97, v121
    v_add_f32 v98, v98, v122
    v_add_f32 v99, v99, v123
    v_add_f32 v100, v100, v124
    v_add_f32 v101, v101, v125
    v_add_f32 v102, v102, v126
    v_add_f32 v103, v103, v127
    v_lshlrev_b32 v120, 16, v28
    v_and_b32 v121, 0xffff0000, v28
    v_lshlrev_b32 v122, 16, v29
    v_and_b32 v123, 0xffff0000, v29
    v_lshlrev_b32 v124, 16, v30
    v_and_b32 v125, 0xffff0000, v30
    v_lshlrev_b32 v126, 16, v31
    v_and_b32 v127, 0xffff0000, v31
    v_add_f32 v96, v96, v120
    v_add_f32 v97, v97, v121
    v_add_f32 v98, v98, v122
    v_add_f32 v99, v99, v123
    v_add_f32 v100, v100, v124
    v_add_f32 v101, v101, v125
    v_add_f32 v102, v102, v126
    v_add_f32 v103, v103, v127
    v_lshlrev_b32 v120, 16, v32
    v_and_b32 v121, 0xffff0000, v32
    v_lshlrev_b32 v122, 16, v33
    v_and_b32 v123, 0xffff0000, v33
    v_lshlrev_b32 v124, 16, v34
    v_and_b32 v125, 0xffff0000, v34
    v_lshlrev_b32 v126, 16, v35
    v_and_b32 v127, 0xffff0000, v35
    v_add_f32 v96, v96, v120
    v_add_f32 v97, v97, v121
    v_add_f32 v98, v98, v122
    v_add_f32 v99, v99, v123
    v_add_f32 v100, v100, v124
    v_add_f32 v101, v101, v125
    v_add_f32 v102, v102, v126
    v_add_f32 v103, v103, v127
    v_lshlrev_b32 v120, 16, v36
    v_and_b32 v121, 0xffff0000, v36
    v_lshlrev_b32 v122, 16, v37
    v_and_b32 v123, 0xffff0000, v37
    v_lshlrev_b32 v124, 16, v38
    v_and_b32 v125, 0xffff0000, v38
    v_lshlrev_b32 v126, 16, v39
    v_and_b32 v127, 0xffff0000, v39
    v_add_f32 v96, v96, v120
    v_add_f32 v97, v97, v121
    v_add_f32 v98, v98, v122
    v_add_f32 v99, v99, v123
    v_add_f32 v100, v100, v124
    v_add_f32 v101, v101, v125
    v_add_f32 v102, v102, v126
    v_add_f32 v103, v103, v127
    v_lshlrev_b32 v120, 16, v40
    v_and_b32 v121, 0xffff0000, v40
    v_lshlrev_b32 v122, 16, v41
    v_and_b32 v123, 0xffff0000, v41
    v_lshlrev_b32 v124, 16, v42
    v_and_b32 v125, 0xffff0000, v42
    v_lshlrev_b32 v126, 16, v43
    v_and_b32 v127, 0xffff0000, v43
    v_add_f32 v96, v96, v120
    v_add_f32 v97, v97, v121
    v_add_f32 v98, v98, v122
    v_add_f32 v99, v99, v123
    v_add_f32 v100, v100, v124
    v_add_f32 v101, v101, v125
    v_add_f32 v102, v102, v126
    v_add_f32 v103, v103, v127
    v_lshlrev_b32 v120, 16, v44
    v_and_b32 v121, 0xffff0000, v44
    v_lshlrev_b32 v122, 16, v45
    v_and_b32 v123, 0xffff0000, v45
    v_lshlrev_b32 v124, 16, v46
    v_and_b32 v125, 0xffff0000, v46
    v_lshlrev_b32 v126, 16, v47
    v_and_b32 v127, 0xffff0000, v47
    v_add_f32 v96, v96, v120
    v_add_f32 v97, v97, v121
    v_add_f32 v98, v98, v122
    v_add_f32 v99, v99, v123
    v_add_f32 v100, v100, v124
    v_add_f32 v101, v101, v125
    v_add_f32 v102, v102, v126
    v_add_f32 v103, v103, v127
    v_cndmask_b32 v108, v88, v90, s[20:21]
    v_cndmask_b32 v109, v89, v91, s[20:21]
    v_cndmask_b32 v110, v90, v88, s[20:21]
    v_cndmask_b32 v111, v91, v89, s[20:21]
    v_cvt_pk_bf16_f32 v104, v96, v97
    v_lshlrev_b32 v96, 16, v104
    v_and_b32 v97, 0xffff0000, v104
    v_lshlrev_b32 v104, 16, v136
    v_and_b32 v105, 0xffff0000, v136
    v_mul_f32 v96, v96, v104
    v_mul_f32 v97, v97, v105
    v_cvt_pk_bf16_f32 v104, v96, v97
    v_lshlrev_b32 v96, 16, v104
    v_and_b32 v97, 0xffff0000, v104
    v_lshlrev_b32 v104, 16, v108
    v_and_b32 v105, 0xffff0000, v108
    v_add_f32 v96, v96, v104
    v_add_f32 v97, v97, v105
    v_cvt_pk_bf16_f32 v112, v96, v97
    v_cvt_pk_bf16_f32 v104, v98, v99
    v_lshlrev_b32 v98, 16, v104
    v_and_b32 v99, 0xffff0000, v104
    v_lshlrev_b32 v104, 16, v137
    v_and_b32 v105, 0xffff0000, v137
    v_mul_f32 v98, v98, v104
    v_mul_f32 v99, v99, v105
    v_cvt_pk_bf16_f32 v104, v98, v99
    v_lshlrev_b32 v98, 16, v104
    v_and_b32 v99, 0xffff0000, v104
    v_lshlrev_b32 v104, 16, v109
    v_and_b32 v105, 0xffff0000, v109
    v_add_f32 v98, v98, v104
    v_add_f32 v99, v99, v105
    v_cvt_pk_bf16_f32 v113, v98, v99
    v_cvt_pk_bf16_f32 v104, v100, v101
    v_lshlrev_b32 v100, 16, v104
    v_and_b32 v101, 0xffff0000, v104
    v_lshlrev_b32 v104, 16, v138
    v_and_b32 v105, 0xffff0000, v138
    v_mul_f32 v100, v100, v104
    v_mul_f32 v101, v101, v105
    v_cvt_pk_bf16_f32 v104, v100, v101
    v_lshlrev_b32 v100, 16, v104
    v_and_b32 v101, 0xffff0000, v104
    v_lshlrev_b32 v104, 16, v110
    v_and_b32 v105, 0xffff0000, v110
    v_add_f32 v100, v100, v104
    v_add_f32 v101, v101, v105
    v_cvt_pk_bf16_f32 v114, v100, v101
    v_cvt_pk_bf16_f32 v104, v102, v103
    v_lshlrev_b32 v102, 16, v104
    v_and_b32 v103, 0xffff0000, v104
    v_lshlrev_b32 v104, 16, v139
    v_and_b32 v105, 0xffff0000, v139
    v_mul_f32 v102, v102, v104
    v_mul_f32 v103, v103, v105
    v_cvt_pk_bf16_f32 v104, v102, v103
    v_lshlrev_b32 v102, 16, v104
    v_and_b32 v103, 0xffff0000, v104
    v_lshlrev_b32 v104, 16, v111
    v_and_b32 v105, 0xffff0000, v111
    v_add_f32 v102, v102, v104
    v_add_f32 v103, v103, v105
    v_cvt_pk_bf16_f32 v115, v102, v103
    v_cndmask_b32 v128, v112, v114, s[20:21]
    v_cndmask_b32 v129, v113, v115, s[20:21]
    v_cndmask_b32 v130, v114, v112, s[20:21]
    v_cndmask_b32 v131, v115, v113, s[20:21]
    buffer_store_dwordx4 v[128:131], v4, s[12:15], s18 offen offset:0
    v_lshlrev_b32 v96, 16, v48
    v_and_b32 v97, 0xffff0000, v48
    v_lshlrev_b32 v98, 16, v49
    v_and_b32 v99, 0xffff0000, v49
    v_lshlrev_b32 v100, 16, v50
    v_and_b32 v101, 0xffff0000, v50
    v_lshlrev_b32 v102, 16, v51
    v_and_b32 v103, 0xffff0000, v51
    v_lshlrev_b32 v120, 16, v52
    v_and_b32 v121, 0xffff0000, v52
    v_lshlrev_b32 v122, 16, v53
    v_and_b32 v123, 0xffff0000, v53
    v_lshlrev_b32 v124, 16, v54
    v_and_b32 v125, 0xffff0000, v54
    v_lshlrev_b32 v126, 16, v55
    v_and_b32 v127, 0xffff0000, v55
    v_add_f32 v96, v96, v120
    v_add_f32 v97, v97, v121
    v_add_f32 v98, v98, v122
    v_add_f32 v99, v99, v123
    v_add_f32 v100, v100, v124
    v_add_f32 v101, v101, v125
    v_add_f32 v102, v102, v126
    v_add_f32 v103, v103, v127
    v_lshlrev_b32 v120, 16, v56
    v_and_b32 v121, 0xffff0000, v56
    v_lshlrev_b32 v122, 16, v57
    v_and_b32 v123, 0xffff0000, v57
    v_lshlrev_b32 v124, 16, v58
    v_and_b32 v125, 0xffff0000, v58
    v_lshlrev_b32 v126, 16, v59
    v_and_b32 v127, 0xffff0000, v59
    v_add_f32 v96, v96, v120
    v_add_f32 v97, v97, v121
    v_add_f32 v98, v98, v122
    v_add_f32 v99, v99, v123
    v_add_f32 v100, v100, v124
    v_add_f32 v101, v101, v125
    v_add_f32 v102, v102, v126
    v_add_f32 v103, v103, v127
    v_lshlrev_b32 v120, 16, v60
    v_and_b32 v121, 0xffff0000, v60
    v_lshlrev_b32 v122, 16, v61
    v_and_b32 v123, 0xffff0000, v61
    v_lshlrev_b32 v124, 16, v62
    v_and_b32 v125, 0xffff0000, v62
    v_lshlrev_b32 v126, 16, v63
    v_and_b32 v127, 0xffff0000, v63
    v_add_f32 v96, v96, v120
    v_add_f32 v97, v97, v121
    v_add_f32 v98, v98, v122
    v_add_f32 v99, v99, v123
    v_add_f32 v100, v100, v124
    v_add_f32 v101, v101, v125
    v_add_f32 v102, v102, v126
    v_add_f32 v103, v103, v127
    v_lshlrev_b32 v120, 16, v64
    v_and_b32 v121, 0xffff0000, v64
    v_lshlrev_b32 v122, 16, v65
    v_and_b32 v123, 0xffff0000, v65
    v_lshlrev_b32 v124, 16, v66
    v_and_b32 v125, 0xffff0000, v66
    v_lshlrev_b32 v126, 16, v67
    v_and_b32 v127, 0xffff0000, v67
    v_add_f32 v96, v96, v120
    v_add_f32 v97, v97, v121
    v_add_f32 v98, v98, v122
    v_add_f32 v99, v99, v123
    v_add_f32 v100, v100, v124
    v_add_f32 v101, v101, v125
    v_add_f32 v102, v102, v126
    v_add_f32 v103, v103, v127
    v_lshlrev_b32 v120, 16, v68
    v_and_b32 v121, 0xffff0000, v68
    v_lshlrev_b32 v122, 16, v69
    v_and_b32 v123, 0xffff0000, v69
    v_lshlrev_b32 v124, 16, v70
    v_and_b32 v125, 0xffff0000, v70
    v_lshlrev_b32 v126, 16, v71
    v_and_b32 v127, 0xffff0000, v71
    v_add_f32 v96, v96, v120
    v_add_f32 v97, v97, v121
    v_add_f32 v98, v98, v122
    v_add_f32 v99, v99, v123
    v_add_f32 v100, v100, v124
    v_add_f32 v101, v101, v125
    v_add_f32 v102, v102, v126
    v_add_f32 v103, v103, v127
    v_lshlrev_b32 v120, 16, v72
    v_and_b32 v121, 0xffff0000, v72
    v_lshlrev_b32 v122, 16, v73
    v_and_b32 v123, 0xffff0000, v73
    v_lshlrev_b32 v124, 16, v74
    v_and_b32 v125, 0xffff0000, v74
    v_lshlrev_b32 v126, 16, v75
    v_and_b32 v127, 0xffff0000, v75
    v_add_f32 v96, v96, v120
    v_add_f32 v97, v97, v121
    v_add_f32 v98, v98, v122
    v_add_f32 v99, v99, v123
    v_add_f32 v100, v100, v124
    v_add_f32 v101, v101, v125
    v_add_f32 v102, v102, v126
    v_add_f32 v103, v103, v127
    v_lshlrev_b32 v120, 16, v76
    v_and_b32 v121, 0xffff0000, v76
    v_lshlrev_b32 v122, 16, v77
    v_and_b32 v123, 0xffff0000, v77
    v_lshlrev_b32 v124, 16, v78
    v_and_b32 v125, 0xffff0000, v78
    v_lshlrev_b32 v126, 16, v79
    v_and_b32 v127, 0xffff0000, v79
    v_add_f32 v96, v96, v120
    v_add_f32 v97, v97, v121
    v_add_f32 v98, v98, v122
    v_add_f32 v99, v99, v123
    v_add_f32 v100, v100, v124
    v_add_f32 v101, v101, v125
    v_add_f32 v102, v102, v126
    v_add_f32 v103, v103, v127
    v_cndmask_b32 v108, v92, v94, s[20:21]
    v_cndmask_b32 v109, v93, v95, s[20:21]
    v_cndmask_b32 v110, v94, v92, s[20:21]
    v_cndmask_b32 v111, v95, v93, s[20:21]
    v_cvt_pk_bf16_f32 v104, v96, v97
    v_lshlrev_b32 v96, 16, v104
    v_and_b32 v97, 0xffff0000, v104
    v_lshlrev_b32 v104, 16, v140
    v_and_b32 v105, 0xffff0000, v140
    v_mul_f32 v96, v96, v104
    v_mul_f32 v97, v97, v105
    v_cvt_pk_bf16_f32 v104, v96, v97
    v_lshlrev_b32 v96, 16, v104
    v_and_b32 v97, 0xffff0000, v104
    v_lshlrev_b32 v104, 16, v108
    v_and_b32 v105, 0xffff0000, v108
    v_add_f32 v96, v96, v104
    v_add_f32 v97, v97, v105
    v_cvt_pk_bf16_f32 v112, v96, v97
    v_cvt_pk_bf16_f32 v104, v98, v99
    v_lshlrev_b32 v98, 16, v104
    v_and_b32 v99, 0xffff0000, v104
    v_lshlrev_b32 v104, 16, v141
    v_and_b32 v105, 0xffff0000, v141
    v_mul_f32 v98, v98, v104
    v_mul_f32 v99, v99, v105
    v_cvt_pk_bf16_f32 v104, v98, v99
    v_lshlrev_b32 v98, 16, v104
    v_and_b32 v99, 0xffff0000, v104
    v_lshlrev_b32 v104, 16, v109
    v_and_b32 v105, 0xffff0000, v109
    v_add_f32 v98, v98, v104
    v_add_f32 v99, v99, v105
    v_cvt_pk_bf16_f32 v113, v98, v99
    v_cvt_pk_bf16_f32 v104, v100, v101
    v_lshlrev_b32 v100, 16, v104
    v_and_b32 v101, 0xffff0000, v104
    v_lshlrev_b32 v104, 16, v142
    v_and_b32 v105, 0xffff0000, v142
    v_mul_f32 v100, v100, v104
    v_mul_f32 v101, v101, v105
    v_cvt_pk_bf16_f32 v104, v100, v101
    v_lshlrev_b32 v100, 16, v104
    v_and_b32 v101, 0xffff0000, v104
    v_lshlrev_b32 v104, 16, v110
    v_and_b32 v105, 0xffff0000, v110
    v_add_f32 v100, v100, v104
    v_add_f32 v101, v101, v105
    v_cvt_pk_bf16_f32 v114, v100, v101
    v_cvt_pk_bf16_f32 v104, v102, v103
    v_lshlrev_b32 v102, 16, v104
    v_and_b32 v103, 0xffff0000, v104
    v_lshlrev_b32 v104, 16, v143
    v_and_b32 v105, 0xffff0000, v143
    v_mul_f32 v102, v102, v104
    v_mul_f32 v103, v103, v105
    v_cvt_pk_bf16_f32 v104, v102, v103
    v_lshlrev_b32 v102, 16, v104
    v_and_b32 v103, 0xffff0000, v104
    v_lshlrev_b32 v104, 16, v111
    v_and_b32 v105, 0xffff0000, v111
    v_add_f32 v102, v102, v104
    v_add_f32 v103, v103, v105
    v_cvt_pk_bf16_f32 v115, v102, v103
    v_cndmask_b32 v132, v112, v114, s[20:21]
    v_cndmask_b32 v133, v113, v115, s[20:21]
    v_cndmask_b32 v134, v114, v112, s[20:21]
    v_cndmask_b32 v135, v115, v113, s[20:21]
    buffer_store_dwordx4 v[132:135], v4, s[12:15], s18 offen offset:64
    s_add_u32 s24, s24, 32
    s_cmp_lt_u32 s24, 61
    s_cbranch_scc1 fin_job
    s_cmp_ge_u32 s63, 48
    s_cbranch_scc1 k_end
    s_lshr_b32 s24, s63, 4
    s_sub_u32 s24, 63, s24
    s_and_b32 s25, s63, 15
    s_lshl_b32 s25, s25, 2
    s_and_b32 s26, s3, 3
    s_add_u32 s25, s25, s26
    s_lshr_b32 s26, s25, 5
    s_and_b32 s25, s25, 31
    s_lshl_b32 s16, s24, 1
    s_add_u32 s16, s16, s26
    s_lshl_b32 s18, s16, 15
    s_lshl_b32 s17, s25, 10
    s_add_u32 s17, s17, s18
    s_lshl_b32 s19, s25, 6
    s_add_u32 s18, s18, s19
    s_add_u32 s22, s17, 117440512
    s_add_u32 s23, s17, 75497472
    s_mov_b32 s27, 218106816
    s_mov_b32 s28, 65536
    s_min_u32 s32, s24, 62
    v_and_b32 v8, 7, v1
    v_lshlrev_b32 v8, 22, v8
    s_cmp_lg_u32 s3, 0
    s_cbranch_scc1 ft_ok
ft_wd:
    buffer_load_dword v7, off, s[4:7], s27 sc1
    s_waitcnt vmcnt(0)
    v_readfirstlane_b32 s31, v7
    s_cmp_ge_u32 s31, 16
    s_cbranch_scc1 ft_wdok
    s_sleep 32
    s_sub_u32 s28, s28, 1
    s_cbranch_scc0 ft_wd
    s_mov_b32 s28, 0
ft_wdok:
ft_ok:
    s_barrier
    s_cmp_ge_u32 s3, 4
    s_cbranch_scc1 k_end
    buffer_load_dwordx4 v[88:91], v4, s[8:11], s18 offen
    buffer_load_dwordx4 v[136:139], v3, s[4:7], s22 offen sc1
    s_add_u32 s22, s22, 4194304
    buffer_load_dwordx4 v[144:147], v3, s[4:7], s22 offen sc1
    s_add_u32 s22, s22, 4194304
    buffer_load_dwordx4 v[152:155], v3, s[4:7], s22 offen sc1
    s_add_u32 s22, s22, 4194304
    buffer_load_dwordx4 v[160:163], v3, s[4:7], s22 offen sc1
    s_add_u32 s22, s22, 4194304
    s_waitcnt vmcnt(0)
    v_lshlrev_b32 v120, 16, v136
    v_and_b32 v121, 0xffff0000, v136
    v_lshlrev_b32 v136, 16, v144
    v_and_b32 v144, 0xffff0000, v144
    v_add_f32 v120, v120, v136
    v_add_f32 v121, v121, v144
    v_lshlrev_b32 v136, 16, v152
    v_and_b32 v152, 0xffff0000, v152
    v_add_f32 v120, v120, v136
    v_add_f32 v121, v121, v152
    v_lshlrev_b32 v136, 16, v160
    v_and_b32 v160, 0xffff0000, v160
    v_add_f32 v120, v120, v136
    v_add_f32 v121, v121, v160
    v_cvt_pk_bf16_f32 v136, v120, v121
    v_lshlrev_b32 v120, 16, v136
    v_and_b32 v121, 0xffff0000, v136
    v_mul_f32 v136, s35, v120
    v_mul_f32 v144, s35, v121
    v_lshlrev_b32 v122, 16, v137
    v_and_b32 v123, 0xffff0000, v137
    v_lshlrev_b32 v137, 16, v145
    v_and_b32 v145, 0xffff0000, v145
    v_add_f32 v122, v122, v137
    v_add_f32 v123, v123, v145
    v_lshlrev_b32 v137, 16, v153
    v_and_b32 v153, 0xffff0000, v153
    v_add_f32 v122, v122, v137
    v_add_f32 v123, v123, v153
    v_lshlrev_b32 v137, 16, v161
    v_and_b32 v161, 0xffff0000, v161
    v_add_f32 v122, v122, v137
    v_add_f32 v123, v123, v161
    v_cvt_pk_bf16_f32 v137, v122, v123
    v_lshlrev_b32 v122, 16, v137
    v_and_b32 v123, 0xffff0000, v137
    v_mul_f32 v137, s35, v122
    v_mul_f32 v145, s35, v123
    v_lshlrev_b32 v124, 16, v138
    v_and_b32 v125, 0xffff0000, v138
    v_lshlrev_b32 v138, 16, v146
    v_and_b32 v146, 0xffff0000, v146
    v_add_f32 v124, v124, v138
    v_add_f32 v125, v125, v146
    v_lshlrev_b32 v138, 16, v154
    v_and_b32 v154, 0xffff0000, v154
    v_add_f32 v124, v124, v138
    v_add_f32 v125, v125, v154
    v_lshlrev_b32 v138, 16, v162
    v_and_b32 v162, 0xffff0000, v162
    v_add_f32 v124, v124, v138
    v_add_f32 v125, v125, v162
    v_cvt_pk_bf16_f32 v138, v124, v125
    v_lshlrev_b32 v124, 16, v138
    v_and_b32 v125, 0xffff0000, v138
    v_mul_f32 v138, s35, v124
    v_mul_f32 v146, s35, v125
    v_lshlrev_b32 v126, 16, v139
    v_and_b32 v127, 0xffff0000, v139
    v_lshlrev_b32 v139, 16, v147
    v_and_b32 v147, 0xffff0000, v147
    v_add_f32 v126, v126, v139
    v_add_f32 v127, v127, v147
    v_lshlrev_b32 v139, 16, v155
    v_and_b32 v155, 0xffff0000, v155
    v_add_f32 v126, v126, v139
    v_add_f32 v127, v127, v155
    v_lshlrev_b32 v139, 16, v163
    v_and_b32 v163, 0xffff0000, v163
    v_add_f32 v126, v126, v139
    v_add_f32 v127, v127, v163
    v_cvt_pk_bf16_f32 v139, v126, v127
    v_lshlrev_b32 v126, 16, v139
    v_and_b32 v127, 0xffff0000, v139
    v_mul_f32 v139, s35, v126
    v_mul_f32 v147, s35, v127
    v_exp_f32 v136, v136
    v_exp_f32 v144, v144
    v_exp_f32 v137, v137
    v_exp_f32 v145, v145
    v_exp_f32 v138, v138
    v_exp_f32 v146, v146
    v_exp_f32 v139, v139
    v_exp_f32 v147, v147
    s_nop 0
    v_add_f32 v136, 1.0, v136
    v_add_f32 v144, 1.0, v144
    v_add_f32 v137, 1.0, v137
    v_add_f32 v145, 1.0, v145
    v_add_f32 v138, 1.0, v138
    v_add_f32 v146, 1.0, v146
    v_add_f32 v139, 1.0, v139
    v_add_f32 v147, 1.0, v147
    v_rcp_f32 v136, v136
    v_rcp_f32 v144, v144
    v_rcp_f32 v137, v137
    v_rcp_f32 v145, v145
    v_rcp_f32 v138, v138
    v_rcp_f32 v146, v146
    v_rcp_f32 v139, v139
    v_rcp_f32 v147, v147
    s_nop 0
    v_mul_f32 v120, v120, v136
    v_mul_f32 v121, v121, v144
    v_cvt_pk_bf16_f32 v136, v120, v121
    v_mul_f32 v122, v122, v137
    v_mul_f32 v123, v123, v145
    v_cvt_pk_bf16_f32 v137, v122, v123
    v_mul_f32 v124, v124, v138
    v_mul_f32 v125, v125, v146
    v_cvt_pk_bf16_f32 v138, v124, v125
    v_mul_f32 v126, v126, v139
    v_mul_f32 v127, v127, v147
    v_cvt_pk_bf16_f32 v139, v126, v127
ft_ws:
    buffer_load_dword v7, v6, s[4:7], s30 offen sc1
    s_waitcnt vmcnt(0)
    v_cmp_gt_u32 vcc, s32, v7
    s_cbranch_vccz ft_p
    s_sleep 12
    v_cmp_gt_u32 vcc, 59, v7
    s_cbranch_vccz ft_wsf
    s_sleep 64
    v_cmp_gt_u32 vcc, 56, v7
    s_cbranch_vccz ft_wsf
    s_sleep 127
    s_sleep 127
ft_wsf:
    s_sub_u32 s28, s28, 1
    s_cbranch_scc0 ft_ws
    s_mov_b32 s28, 0
ft_p:
    buffer_load_dword v7, v8, s[4:7], s23 offen offset:1008 sc1
    s_waitcnt vmcnt(0)
    v_cmp_eq_u32 vcc, -1, v7
    s_cbranch_vccz ft_l
    s_sleep 4
    s_sub_u32 s28, s28, 1
    s_cbranch_scc0 ft_p
    s_mov_b32 s28, 0
ft_l:
    s_mov_b32 s31, s23
    buffer_load_dwordx4 v[16:19], v3, s[4:7], s31 offen sc1
    s_add_u32 s31, s31, 4194304
    buffer_load_dwordx4 v[20:23], v3, s[4:7], s31 offen sc1
    s_add_u32 s31, s31, 4194304
    buffer_load_dwordx4 v[24:27], v3, s[4:7], s31 offen sc1
    s_add_u32 s31, s31, 4194304
    buffer_load_dwordx4 v[28:31], v3, s[4:7], s31 offen sc1
    s_add_u32 s31, s31, 4194304
    buffer_load_dwordx4 v[32:35], v3, s[4:7], s31 offen sc1
    s_add_u32 s31, s31, 4194304
    buffer_load_dwordx4 v[36:39], v3, s[4:7], s31 offen sc1
    s_add_u32 s31, s31, 4194304
    buffer_load_dwordx4 v[40:43], v3, s[4:7], s31 offen sc1
    s_add_u32 s31, s31, 4194304
    buffer_load_dwordx4 v[44:47], v3, s[4:7], s31 offen sc1
    s_waitcnt vmcnt(0)
    v_max3_u32 v7, v16, v20, v24
    v_max3_u32 v7, v7, v28, v32
    v_max3_u32 v7, v7, v36, v40
    v_max_u32 v7, v7, v44
    v_cmp_eq_u32 vcc, -1, v7
    s_cbranch_vccz ft_go
    s_sub_u32 s28, s28, 1
    s_cbranch_scc0 ft_l
ft_go:
    v_lshlrev_b32 v96, 16, v16
    v_and_b32 v97, 0xffff0000, v16
    v_lshlrev_b32 v98, 16, v17
    v_and_b32 v99, 0xffff0000, v17
    v_lshlrev_b32 v100, 16, v18
    v_and_b32 v101, 0xffff0000, v18
    v_lshlrev_b32 v102, 16, v19
    v_and_b32 v103, 0xffff0000, v19
    v_lshlrev_b32 v120, 16, v20
    v_and_b32 v121, 0xffff0000, v20
    v_lshlrev_b32 v122, 16, v21
    v_and_b32 v123, 0xffff0000, v21
    v_lshlrev_b32 v124, 16, v22
    v_and_b32 v125, 0xffff0000, v22
    v_lshlrev_b32 v126, 16, v23
    v_and_b32 v127, 0xffff0000, v23
    v_add_f32 v96, v96, v120
    v_add_f32 v97, v97, v121
    v_add_f32 v98, v98, v122
    v_add_f32 v99, v99, v123
    v_add_f32 v100, v100, v124
    v_add_f32 v101, v101, v125
    v_add_f32 v102, v102, v126
    v_add_f32 v103, v103, v127
    v_lshlrev_b32 v120, 16, v24
    v_and_b32 v121, 0xffff0000, v24
    v_lshlrev_b32 v122, 16, v25
    v_and_b32 v123, 0xffff0000, v25
    v_lshlrev_b32 v124, 16, v26
    v_and_b32 v125, 0xffff0000, v26
    v_lshlrev_b32 v126, 16, v27
    v_and_b32 v127, 0xffff0000, v27
    v_add_f32 v96, v96, v120
    v_add_f32 v97, v97, v121
    v_add_f32 v98, v98, v122
    v_add_f32 v99, v99, v123
    v_add_f32 v100, v100, v124
    v_add_f32 v101, v101, v125
    v_add_f32 v102, v102, v126
    v_add_f32 v103, v103, v127
    v_lshlrev_b32 v120, 16, v28
    v_and_b32 v121, 0xffff0000, v28
    v_lshlrev_b32 v122, 16, v29
    v_and_b32 v123, 0xffff0000, v29
    v_lshlrev_b32 v124, 16, v30
    v_and_b32 v125, 0xffff0000, v30
    v_lshlrev_b32 v126, 16, v31
    v_and_b32 v127, 0xffff0000, v31
    v_add_f32 v96, v96, v120
    v_add_f32 v97, v97, v121
    v_add_f32 v98, v98, v122
    v_add_f32 v99, v99, v123
    v_add_f32 v100, v100, v124
    v_add_f32 v101, v101, v125
    v_add_f32 v102, v102, v126
    v_add_f32 v103, v103, v127
    v_lshlrev_b32 v120, 16, v32
    v_and_b32 v121, 0xffff0000, v32
    v_lshlrev_b32 v122, 16, v33
    v_and_b32 v123, 0xffff0000, v33
    v_lshlrev_b32 v124, 16, v34
    v_and_b32 v125, 0xffff0000, v34
    v_lshlrev_b32 v126, 16, v35
    v_and_b32 v127, 0xffff0000, v35
    v_add_f32 v96, v96, v120
    v_add_f32 v97, v97, v121
    v_add_f32 v98, v98, v122
    v_add_f32 v99, v99, v123
    v_add_f32 v100, v100, v124
    v_add_f32 v101, v101, v125
    v_add_f32 v102, v102, v126
    v_add_f32 v103, v103, v127
    v_lshlrev_b32 v120, 16, v36
    v_and_b32 v121, 0xffff0000, v36
    v_lshlrev_b32 v122, 16, v37
    v_and_b32 v123, 0xffff0000, v37
    v_lshlrev_b32 v124, 16, v38
    v_and_b32 v125, 0xffff0000, v38
    v_lshlrev_b32 v126, 16, v39
    v_and_b32 v127, 0xffff0000, v39
    v_add_f32 v96, v96, v120
    v_add_f32 v97, v97, v121
    v_add_f32 v98, v98, v122
    v_add_f32 v99, v99, v123
    v_add_f32 v100, v100, v124
    v_add_f32 v101, v101, v125
    v_add_f32 v102, v102, v126
    v_add_f32 v103, v103, v127
    v_lshlrev_b32 v120, 16, v40
    v_and_b32 v121, 0xffff0000, v40
    v_lshlrev_b32 v122, 16, v41
    v_and_b32 v123, 0xffff0000, v41
    v_lshlrev_b32 v124, 16, v42
    v_and_b32 v125, 0xffff0000, v42
    v_lshlrev_b32 v126, 16, v43
    v_and_b32 v127, 0xffff0000, v43
    v_add_f32 v96, v96, v120
    v_add_f32 v97, v97, v121
    v_add_f32 v98, v98, v122
    v_add_f32 v99, v99, v123
    v_add_f32 v100, v100, v124
    v_add_f32 v101, v101, v125
    v_add_f32 v102, v102, v126
    v_add_f32 v103, v103, v127
    v_lshlrev_b32 v120, 16, v44
    v_and_b32 v121, 0xffff0000, v44
    v_lshlrev_b32 v122, 16, v45
    v_and_b32 v123, 0xffff0000, v45
    v_lshlrev_b32 v124, 16, v46
    v_and_b32 v125, 0xffff0000, v46
    v_lshlrev_b32 v126, 16, v47
    v_and_b32 v127, 0xffff0000, v47
    v_add_f32 v96, v96, v120
    v_add_f32 v97, v97, v121
    v_add_f32 v98, v98, v122
    v_add_f32 v99, v99, v123
    v_add_f32 v100, v100, v124
    v_add_f32 v101, v101, v125
    v_add_f32 v102, v102, v126
    v_add_f32 v103, v103, v127
    v_cndmask_b32 v108, v88, v90, s[20:21]
    v_cndmask_b32 v109, v89, v91, s[20:21]
    v_cndmask_b32 v110, v90, v88, s[20:21]
    v_cndmask_b32 v111, v91, v89, s[20:21]
    v_cvt_pk_bf16_f32 v104, v96, v97
    v_lshlrev_b32 v96, 16, v104
    v_and_b32 v97, 0xffff0000, v104
    v_lshlrev_b32 v104, 16, v136
    v_and_b32 v105, 0xffff0000, v136
    v_mul_f32 v96, v96, v104
    v_mul_f32 v97, v97, v105
    v_cvt_pk_bf16_f32 v104, v96, v97
    v_lshlrev_b32 v96, 16, v104
    v_and_b32 v97, 0xffff0000, v104
    v_lshlrev_b32 v104, 16, v108
    v_and_b32 v105, 0xffff0000, v108
    v_add_f32 v96, v96, v104
    v_add_f32 v97, v97, v105
    v_cvt_pk_bf16_f32 v112, v96, v97
    v_cvt_pk_bf16_f32 v104, v98, v99
    v_lshlrev_b32 v98, 16, v104
    v_and_b32 v99, 0xffff0000, v104
    v_lshlrev_b32 v104, 16, v137
    v_and_b32 v105, 0xffff0000, v137
    v_mul_f32 v98, v98, v104
    v_mul_f32 v99, v99, v105
    v_cvt_pk_bf16_f32 v104, v98, v99
    v_lshlrev_b32 v98, 16, v104
    v_and_b32 v99, 0xffff0000, v104
    v_lshlrev_b32 v104, 16, v109
    v_and_b32 v105, 0xffff0000, v109
    v_add_f32 v98, v98, v104
    v_add_f32 v99, v99, v105
    v_cvt_pk_bf16_f32 v113, v98, v99
    v_cvt_pk_bf16_f32 v104, v100, v101
    v_lshlrev_b32 v100, 16, v104
    v_and_b32 v101, 0xffff0000, v104
    v_lshlrev_b32 v104, 16, v138
    v_and_b32 v105, 0xffff0000, v138
    v_mul_f32 v100, v100, v104
    v_mul_f32 v101, v101, v105
    v_cvt_pk_bf16_f32 v104, v100, v101
    v_lshlrev_b32 v100, 16, v104
    v_and_b32 v101, 0xffff0000, v104
    v_lshlrev_b32 v104, 16, v110
    v_and_b32 v105, 0xffff0000, v110
    v_add_f32 v100, v100, v104
    v_add_f32 v101, v101, v105
    v_cvt_pk_bf16_f32 v114, v100, v101
    v_cvt_pk_bf16_f32 v104, v102, v103
    v_lshlrev_b32 v102, 16, v104
    v_and_b32 v103, 0xffff0000, v104
    v_lshlrev_b32 v104, 16, v139
    v_and_b32 v105, 0xffff0000, v139
    v_mul_f32 v102, v102, v104
    v_mul_f32 v103, v103, v105
    v_cvt_pk_bf16_f32 v104, v102, v103
    v_lshlrev_b32 v102, 16, v104
    v_and_b32 v103, 0xffff0000, v104
    v_lshlrev_b32 v104, 16, v111
    v_and_b32 v105, 0xffff0000, v111
    v_add_f32 v102, v102, v104
    v_add_f32 v103, v103, v105
    v_cvt_pk_bf16_f32 v115, v102, v103
    v_cndmask_b32 v128, v112, v114, s[20:21]
    v_cndmask_b32 v129, v113, v115, s[20:21]
    v_cndmask_b32 v130, v114, v112, s[20:21]
    v_cndmask_b32 v131, v115, v113, s[20:21]
    buffer_store_dwordx4 v[128:131], v4, s[12:15], s18 offen offset:0
    s_branch k_end
chain_map:
    s_lshl_b32 s52, s12, 5
    s_add_u32 s52, s52, s13
    s_lshr_b32 s15, s52, 2
    s_lshr_b32 s14, s52, 4
    s_and_b32 s34, s13, 15
    s_and_b32 s53, s13, 3
    s_mov_b32 s16, 0
    s_mov_b32 s22, 131072
    s_mov_b32 s100, 131072
    s_getreg_b32 s40, hwreg(HW_REG_XCC_ID)
    s_and_b32 s40, s40, 15
    s_mul_i32 s19, s40, s40
    s_lshl_b32 s19, s19, 18
    s_lshl_b32 s40, s40, 8
    s_add_u32 s40, s40, s19
    s_add_u32 s40, s40, 1
    s_lshl_b32 s35, s14, 4
    s_add_u32 s35, s35, 218104320
    s_and_b32 s21, s3, 3
    s_mul_i32 s42, s21, 24576
    s_add_u32 s42, s42, 65536
    s_lshl_b32 s41, s14, 2
    s_add_u32 s41, s41, s21
    s_lshl_b32 s41, s41, 12
    s_cmp_ge_u32 s3, 4
    s_cbranch_scc1 ch_a_pro
    s_add_u32 s41, s41, 262144
    s_lshl_b32 s38, s15, 13
    s_add_u32 s38, s38, 214958080
    s_lshl_b32 s17, s13, 1
    s_and_b32 s18, s3, 1
    s_add_u32 s17, s17, s18
    s_lshl_b32 s17, s17, 1
    s_cmp_lt_u32 s3, 2
    s_cselect_b32 s56, 0xff, 0
    s_mov_b32 s57, s56
    s_lshr_b32 s18, s17, 1
    s_and_b32 s19, s17, 1
    s_lshl_b32 s20, s12, 14
    s_add_u32 s20, s20, 213909504
    s_lshl_b32 s36, s3, 12
    s_add_u32 s36, s36, s20
    s_lshl_b32 s37, s18, 8
    s_add_u32 s37, s37, s20
    s_lshl_b32 s20, s19, 5
    s_add_u32 s37, s37, s20
    s_lshr_b32 s39, s17, 3
    s_lshl_b32 s39, s39, 14
    s_and_b32 s20, s17, 7
    s_lshl_b32 s20, s20, 10
    s_add_u32 s39, s39, s20
    s_add_u32 s39, s39, 209715200
    s_lshl_b32 s30, s14, 22
    s_lshl_b32 s20, s34, 11
    s_add_u32 s30, s30, s20
    s_lshl_b32 s20, s3, 9
    s_add_u32 s30, s30, s20
    s_add_u32 s30, s30, 75497472
    s_mov_b32 s26, s38
    s_mov_b32 s54, s30
    s_mov_b32 s29, 2
    s_mov_b32 s31, 786432
    v_and_b32 v20, 63, v0
    v_lshlrev_b32 v1, 4, v20
    v_mov_b32 v10, -1
    v_mov_b32 v11, -1
    v_lshrrev_b32 v21, 2, v20
    v_and_b32 v22, 3, v20
    v_lshlrev_b32 v21, 13, v21
    v_lshl_add_u32 v21, v22, 4, v21
    s_lshl_b32 s17, s3, 21
    s_lshl_b32 s18, s52, 6
    s_add_u32 s17, s17, s18
    s_lshl_b32 s19, s3, 15
    s_mov_b32 s10, 8388608
    s_mov_b32 s11, 131072
    v_lshrrev_b32 v24, 5, v20
    v_bfe_u32 v25, v20, 3, 1
    v_lshl_add_u32 v24, v24, 1, v25
    v_bfe_u32 v26, v20, 4, 1
    v_xor_b32 v26, v26, v25
    v_lshl_add_u32 v24, v24, 1, v26
    v_bfe_u32 v25, v20, 2, 1
    v_lshl_add_u32 v24, v24, 2, v25
    v_lshlrev_b32 v24, 6, v24
    v_lshl_add_u32 v24, v22, 3, v24
    v_add_u32 v24, s19, v24
    s_load_dwordx2 s[8:9], s[0:1], 16
    s_mov_b32 s20, s17
    s_waitcnt lgkmcnt(0)
    s_add_u32 m0, s19, 0
    s_nop 0
    buffer_load_dwordx4 v21, s[8:11], s20 offen lds
    s_add_u32 s20, s20, 131072
    s_add_u32 m0, s19, 1024
    s_nop 0
    buffer_load_dwordx4 v21, s[8:11], s20 offen lds
    s_add_u32 s20, s20, 131072
    s_add_u32 m0, s19, 2048
    s_nop 0
    buffer_load_dwordx4 v21, s[8:11], s20 offen lds
    s_add_u32 s20, s20, 131072
    s_add_u32 m0, s19, 3072
    s_nop 0
    buffer_load_dwordx4 v21, s[8:11], s20 offen lds
    s_add_u32 s20, s20, 131072
    s_add_u32 m0, s19, 4096
    s_nop 0
    buffer_load_dwordx4 v21, s[8:11], s20 offen lds
    s_add_u32 s20, s20, 131072
    s_add_u32 m0, s19, 5120
    s_nop 0
    buffer_load_dwordx4 v21, s[8:11], s20 offen lds
    s_add_u32 s20, s20, 131072
    s_add_u32 m0, s19, 6144
    s_nop 0
    buffer_load_dwordx4 v21, s[8:11], s20 offen lds
    s_add_u32 s20, s20, 131072
    s_add_u32 m0, s19, 7168
    s_nop 0
    buffer_load_dwordx4 v21, s[8:11], s20 offen lds
    s_add_u32 s20, s20, 131072
    s_add_u32 m0, s19, 8192
    s_nop 0
    buffer_load_dwordx4 v21, s[8:11], s20 offen lds
    s_add_u32 s20, s20, 131072
    s_add_u32 m0, s19, 9216
    s_nop 0
    buffer_load_dwordx4 v21, s[8:11], s20 offen lds
    s_add_u32 s20, s20, 131072
    s_add_u32 m0, s19, 10240
    s_nop 0
    buffer_load_dwordx4 v21, s[8:11], s20 offen lds
    s_add_u32 s20, s20, 131072
    s_add_u32 m0, s19, 11264
    s_nop 0
    buffer_load_dwordx4 v21, s[8:11], s20 offen lds
    s_add_u32 s20, s20, 131072
    s_add_u32 m0, s19, 12288
    s_nop 0
    buffer_load_dwordx4 v21, s[8:11], s20 offen lds
    s_add_u32 s20, s20, 131072
    s_add_u32 m0, s19, 13312
    s_nop 0
    buffer_load_dwordx4 v21, s[8:11], s20 offen lds
    s_add_u32 s20, s20, 131072
    s_add_u32 m0, s19, 14336
    s_nop 0
    buffer_load_dwordx4 v21, s[8:11], s20 offen lds
    s_add_u32 s20, s20, 131072
    s_add_u32 m0, s19, 15360
    s_nop 0
    buffer_load_dwordx4 v21, s[8:11], s20 offen lds
    s_add_u32 s20, s20, 131072
    s_load_dwordx2 s[8:9], s[0:1], 24
    s_mov_b32 s20, s17
    s_waitcnt lgkmcnt(0)
    s_add_u32 m0, s19, 16384
    s_nop 0
    buffer_load_dwordx4 v21, s[8:11], s20 offen lds
    s_add_u32 s20, s20, 131072
    s_add_u32 m0, s19, 17408
    s_nop 0
    buffer_load_dwordx4 v21, s[8:11], s20 offen lds
    s_add_u32 s20, s20, 131072
    s_add_u32 m0, s19, 18432
    s_nop 0
    buffer_load_dwordx4 v21, s[8:11], s20 offen lds
    s_add_u32 s20, s20, 131072
    s_add_u32 m0, s19, 19456
    s_nop 0
    buffer_load_dwordx4 v21, s[8:11], s20 offen lds
    s_add_u32 s20, s20, 131072
    s_add_u32 m0, s19, 20480
    s_nop 0
    buffer_load_dwordx4 v21, s[8:11], s20 offen lds
    s_add_u32 s20, s20, 131072
    s_add_u32 m0, s19, 21504
    s_nop 0
    buffer_load_dwordx4 v21, s[8:11], s20 offen lds
    s_add_u32 s20, s20, 131072
    s_add_u32 m0, s19, 22528
    s_nop 0
    buffer_load_dwordx4 v21, s[8:11], s20 offen lds
    s_add_u32 s20, s20, 131072
    s_add_u32 m0, s19, 23552
    s_nop 0
    buffer_load_dwordx4 v21, s[8:11], s20 offen lds
    s_add_u32 s20, s20, 131072
    s_add_u32 m0, s19, 24576
    s_nop 0
    buffer_load_dwordx4 v21, s[8:11], s20 offen lds
    s_add_u32 s20, s20, 131072
    s_add_u32 m0, s19, 25600
    s_nop 0
    buffer_load_dwordx4 v21, s[8:11], s20 offen lds
    s_add_u32 s20, s20, 131072
    s_add_u32 m0, s19, 26624
    s_nop 0
    buffer_load_dwordx4 v21, s[8:11], s20 offen lds
    s_add_u32 s20, s20, 131072
    s_add_u32 m0, s19, 27648
    s_nop 0
    buffer_load_dwordx4 v21, s[8:11], s20 offen lds
    s_add_u32 s20, s20, 131072
    s_add_u32 m0, s19, 28672
    s_nop 0
    buffer_load_dwordx4 v21, s[8:11], s20 offen lds
    s_add_u32 s20, s20, 131072
    s_add_u32 m0, s19, 29696
    s_nop 0
    buffer_load_dwordx4 v21, s[8:11], s20 offen lds
    s_add_u32 s20, s20, 131072
    s_add_u32 m0, s19, 30720
    s_nop 0
    buffer_load_dwordx4 v21, s[8:11], s20 offen lds
    s_add_u32 s20, s20, 131072
    s_add_u32 m0, s19, 31744
    s_nop 0
    buffer_load_dwordx4 v21, s[8:11], s20 offen lds
    s_add_u32 s20, s20, 131072
    s_load_dwordx2 s[8:9], s[0:1], 32
    s_mov_b32 s20, s17
    s_waitcnt lgkmcnt(0)
    buffer_load_dwordx4 v[96:99], v21, s[8:11], s20 offen
    s_add_u32 s20, s20, 131072
    buffer_load_dwordx4 v[100:103], v21, s[8:11], s20 offen
    s_add_u32 s20, s20, 131072
    buffer_load_dwordx4 v[104:107], v21, s[8:11], s20 offen
    s_add_u32 s20, s20, 131072
    buffer_load_dwordx4 v[108:111], v21, s[8:11], s20 offen
    s_add_u32 s20, s20, 131072
    buffer_load_dwordx4 v[144:147], v21, s[8:11], s20 offen
    s_add_u32 s20, s20, 131072
    buffer_load_dwordx4 v[148:151], v21, s[8:11], s20 offen
    s_add_u32 s20, s20, 131072
    buffer_load_dwordx4 v[152:155], v21, s[8:11], s20 offen
    s_add_u32 s20, s20, 131072
    buffer_load_dwordx4 v[156:159], v21, s[8:11], s20 offen
    s_add_u32 s20, s20, 131072
    buffer_load_dwordx4 v[192:195], v21, s[8:11], s20 offen
    s_add_u32 s20, s20, 131072
    buffer_load_dwordx4 v[196:199], v21, s[8:11], s20 offen
    s_add_u32 s20, s20, 131072
    buffer_load_dwordx4 v[200:203], v21, s[8:11], s20 offen
    s_add_u32 s20, s20, 131072
    buffer_load_dwordx4 v[204:207], v21, s[8:11], s20 offen
    s_add_u32 s20, s20, 131072
    buffer_load_dwordx4 v[240:243], v21, s[8:11], s20 offen
    s_add_u32 s20, s20, 131072
    buffer_load_dwordx4 v[244:247], v21, s[8:11], s20 offen
    s_add_u32 s20, s20, 131072
    buffer_load_dwordx4 v[248:251], v21, s[8:11], s20 offen
    s_add_u32 s20, s20, 131072
    buffer_load_dwordx4 v[252:255], v21, s[8:11], s20 offen
    s_add_u32 s20, s20, 131072
    s_load_dwordx2 s[8:9], s[0:1], 8
    s_mov_b32 s10, 16384
    v_bfe_u32 v57, v20, 2, 2
    v_and_b32 v58, 1, v20
    v_lshl_add_u32 v57, v57, 1, v58
    v_lshlrev_b32 v57, 11, v57
    v_lshrrev_b32 v58, 4, v20
    v_lshl_add_u32 v57, v58, 5, v57
    v_bfe_u32 v58, v20, 1, 1
    v_lshl_add_u32 v57, v58, 4, v57
    v_lshl_add_u32 v59, v58, 3, v57
    v_xor_b32 v60, 8, v59
    s_lshl_b32 s20, s3, 9
    s_waitcnt lgkmcnt(0)
    buffer_load_dwordx2 v[32:33], v59, s[8:11], s20 offen offset:0
    buffer_load_dwordx2 v[34:35], v60, s[8:11], s20 offen offset:0
    buffer_load_dwordx2 v[36:37], v59, s[8:11], s20 offen offset:128
    buffer_load_dwordx2 v[38:39], v60, s[8:11], s20 offen offset:128
    buffer_load_dwordx2 v[40:41], v59, s[8:11], s20 offen offset:256
    buffer_load_dwordx2 v[42:43], v60, s[8:11], s20 offen offset:256
    buffer_load_dwordx2 v[44:45], v59, s[8:11], s20 offen offset:384
    buffer_load_dwordx2 v[46:47], v60, s[8:11], s20 offen offset:384
    s_barrier
    v_add_u32 v56, s19, v1
    s_waitcnt vmcnt(40)
    ds_read_b64_tr_b16 v[64:65], v24 offset:0
    ds_read_b64_tr_b16 v[66:67], v24 offset:128
    ds_read_b64_tr_b16 v[68:69], v24 offset:2048
    ds_read_b64_tr_b16 v[70:71], v24 offset:2176
    ds_read_b64_tr_b16 v[72:73], v24 offset:32
    ds_read_b64_tr_b16 v[74:75], v24 offset:160
    ds_read_b64_tr_b16 v[76:77], v24 offset:2080
    ds_read_b64_tr_b16 v[78:79], v24 offset:2208
    s_waitcnt lgkmcnt(0)
    ds_read_b64_tr_b16 v[112:113], v24 offset:4096
    ds_read_b64_tr_b16 v[114:115], v24 offset:4224
    ds_read_b64_tr_b16 v[116:117], v24 offset:6144
    ds_read_b64_tr_b16 v[118:119], v24 offset:6272
    ds_read_b64_tr_b16 v[120:121], v24 offset:4128
    ds_read_b64_tr_b16 v[122:123], v24 offset:4256
    ds_read_b64_tr_b16 v[124:125], v24 offset:6176
    ds_read_b64_tr_b16 v[126:127], v24 offset:6304
    s_waitcnt lgkmcnt(0)
    ds_read_b64_tr_b16 v[160:161], v24 offset:8192
    ds_read_b64_tr_b16 v[162:163], v24 offset:8320
    ds_read_b64_tr_b16 v[164:165], v24 offset:10240
    ds_read_b64_tr_b16 v[166:167], v24 offset:10368
    ds_read_b64_tr_b16 v[168:169], v24 offset:8224
    ds_read_b64_tr_b16 v[170:171], v24 offset:8352
    ds_read_b64_tr_b16 v[172:173], v24 offset:10272
    ds_read_b64_tr_b16 v[174:175], v24 offset:10400
    s_waitcnt lgkmcnt(0)
    ds_read_b64_tr_b16 v[208:209], v24 offset:12288
    ds_read_b64_tr_b16 v[210:211], v24 offset:12416
    ds_read_b64_tr_b16 v[212:213], v24 offset:14336
    ds_read_b64_tr_b16 v[214:215], v24 offset:14464
    ds_read_b64_tr_b16 v[216:217], v24 offset:12320
    ds_read_b64_tr_b16 v[218:219], v24 offset:12448
    ds_read_b64_tr_b16 v[220:221], v24 offset:14368
    ds_read_b64_tr_b16 v[222:223], v24 offset:14496
    s_waitcnt lgkmcnt(0)
    s_waitcnt vmcnt(24)
    ds_read_b64_tr_b16 v[80:81], v24 offset:16384
    ds_read_b64_tr_b16 v[82:83], v24 offset:16512
    ds_read_b64_tr_b16 v[84:85], v24 offset:18432
    ds_read_b64_tr_b16 v[86:87], v24 offset:18560
    ds_read_b64_tr_b16 v[88:89], v24 offset:16416
    ds_read_b64_tr_b16 v[90:91], v24 offset:16544
    ds_read_b64_tr_b16 v[92:93], v24 offset:18464
    ds_read_b64_tr_b16 v[94:95], v24 offset:18592
    s_waitcnt lgkmcnt(0)
    ds_read_b64_tr_b16 v[128:129], v24 offset:20480
    ds_read_b64_tr_b16 v[130:131], v24 offset:20608
    ds_read_b64_tr_b16 v[132:133], v24 offset:22528
    ds_read_b64_tr_b16 v[134:135], v24 offset:22656
    ds_read_b64_tr_b16 v[136:137], v24 offset:20512
    ds_read_b64_tr_b16 v[138:139], v24 offset:20640
    ds_read_b64_tr_b16 v[140:141], v24 offset:22560
    ds_read_b64_tr_b16 v[142:143], v24 offset:22688
    s_waitcnt lgkmcnt(0)
    ds_read_b64_tr_b16 v[176:177], v24 offset:24576
    ds_read_b64_tr_b16 v[178:179], v24 offset:24704
    ds_read_b64_tr_b16 v[180:181], v24 offset:26624
    ds_read_b64_tr_b16 v[182:183], v24 offset:26752
    ds_read_b64_tr_b16 v[184:185], v24 offset:24608
    ds_read_b64_tr_b16 v[186:187], v24 offset:24736
    ds_read_b64_tr_b16 v[188:189], v24 offset:26656
    ds_read_b64_tr_b16 v[190:191], v24 offset:26784
    s_waitcnt lgkmcnt(0)
    ds_read_b64_tr_b16 v[224:225], v24 offset:28672
    ds_read_b64_tr_b16 v[226:227], v24 offset:28800
    ds_read_b64_tr_b16 v[228:229], v24 offset:30720
    ds_read_b64_tr_b16 v[230:231], v24 offset:30848
    ds_read_b64_tr_b16 v[232:233], v24 offset:28704
    ds_read_b64_tr_b16 v[234:235], v24 offset:28832
    ds_read_b64_tr_b16 v[236:237], v24 offset:30752
    ds_read_b64_tr_b16 v[238:239], v24 offset:30880
    s_waitcnt lgkmcnt(0)
    s_waitcnt vmcnt(8)
    ds_write_b128 v56, v[96:99] offset:0
    ds_write_b128 v56, v[100:103] offset:1024
    ds_write_b128 v56, v[104:107] offset:2048
    ds_write_b128 v56, v[108:111] offset:3072
    ds_write_b128 v56, v[144:147] offset:4096
    ds_write_b128 v56, v[148:151] offset:5120
    ds_write_b128 v56, v[152:155] offset:6144
    ds_write_b128 v56, v[156:159] offset:7168
    ds_write_b128 v56, v[192:195] offset:8192
    ds_write_b128 v56, v[196:199] offset:9216
    ds_write_b128 v56, v[200:203] offset:10240
    ds_write_b128 v56, v[204:207] offset:11264
    ds_write_b128 v56, v[240:243] offset:12288
    ds_write_b128 v56, v[244:247] offset:13312
    ds_write_b128 v56, v[248:251] offset:14336
    ds_write_b128 v56, v[252:255] offset:15360
    s_waitcnt lgkmcnt(0)
    ds_read_b64_tr_b16 v[96:97], v24 offset:0
    ds_read_b64_tr_b16 v[98:99], v24 offset:128
    ds_read_b64_tr_b16 v[100:101], v24 offset:2048
    ds_read_b64_tr_b16 v[102:103], v24 offset:2176
    ds_read_b64_tr_b16 v[104:105], v24 offset:32
    ds_read_b64_tr_b16 v[106:107], v24 offset:160
    ds_read_b64_tr_b16 v[108:109], v24 offset:2080
    ds_read_b64_tr_b16 v[110:111], v24 offset:2208
    s_waitcnt lgkmcnt(0)
    ds_read_b64_tr_b16 v[144:145], v24 offset:4096
    ds_read_b64_tr_b16 v[146:147], v24 offset:4224
    ds_read_b64_tr_b16 v[148:149], v24 offset:6144
    ds_read_b64_tr_b16 v[150:151], v24 offset:6272
    ds_read_b64_tr_b16 v[152:153], v24 offset:4128
    ds_read_b64_tr_b16 v[154:155], v24 offset:4256
    ds_read_b64_tr_b16 v[156:157], v24 offset:6176
    ds_read_b64_tr_b16 v[158:159], v24 offset:6304
    s_waitcnt lgkmcnt(0)
    ds_read_b64_tr_b16 v[192:193], v24 offset:8192
    ds_read_b64_tr_b16 v[194:195], v24 offset:8320
    ds_read_b64_tr_b16 v[196:197], v24 offset:10240
    ds_read_b64_tr_b16 v[198:199], v24 offset:10368
    ds_read_b64_tr_b16 v[200:201], v24 offset:8224
    ds_read_b64_tr_b16 v[202:203], v24 offset:8352
    ds_read_b64_tr_b16 v[204:205], v24 offset:10272
    ds_read_b64_tr_b16 v[206:207], v24 offset:10400
    s_waitcnt lgkmcnt(0)
    ds_read_b64_tr_b16 v[240:241], v24 offset:12288
    ds_read_b64_tr_b16 v[242:243], v24 offset:12416
    ds_read_b64_tr_b16 v[244:245], v24 offset:14336
    ds_read_b64_tr_b16 v[246:247], v24 offset:14464
    ds_read_b64_tr_b16 v[248:249], v24 offset:12320
    ds_read_b64_tr_b16 v[250:251], v24 offset:12448
    ds_read_b64_tr_b16 v[252:253], v24 offset:14368
    ds_read_b64_tr_b16 v[254:255], v24 offset:14496
    s_waitcnt lgkmcnt(0)
    v_mov_b32 v21, 0x44444444
    v_mov_b32 v22, 0xeeeeeeee
    v_and_b32 v23, 2, v20
    v_cmp_eq_u32 vcc, 0, v23
    s_nop 1
    v_cndmask_b32 v8, v22, v21, vcc
    v_bfe_u32 v21, v20, 2, 3
    v_lshrrev_b32 v22, 5, v20
    v_mul_u32_u24 v23, 160, v21
    v_mul_u32_u24 v24, 1280, v22
    v_add_u32 v23, v23, v24
    v_and_b32 v24, 3, v20
    v_lshl_add_u32 v27, v24, 4, v23
    v_lshrrev_b32 v23, 1, v21
    v_and_b32 v21, 1, v21
    v_lshl_add_u32 v21, v23, 2, v21
    v_xor_b32 v22, 1, v22
    v_lshl_add_u32 v21, v22, 1, v21
    v_bfe_u32 v22, v20, 1, 1
    v_lshl_add_u32 v21, v22, 4, v21
    v_xor_b32 v22, v20, v22
    v_and_b32 v22, 1, v22
    v_lshlrev_b32 v21, 4, v21
    v_lshl_add_u32 v25, v22, 3, v21
    v_lshrrev_b32 v21, 3, v20
    v_mul_u32_u24 v23, 160, v21
    v_and_b32 v24, 7, v20
    v_lshl_add_u32 v28, v24, 4, v23
    v_lshrrev_b32 v23, 1, v21
    v_and_b32 v21, 1, v21
    v_lshl_add_u32 v21, v23, 2, v21
    v_and_b32 v22, 1, v20
    v_lshl_add_u32 v21, v22, 1, v21
    v_bfe_u32 v22, v20, 2, 1
    v_lshl_add_u32 v21, v22, 4, v21
    v_bfe_u32 v22, v20, 1, 1
    v_lshlrev_b32 v21, 4, v21
    v_lshl_add_u32 v26, v22, 3, v21
    s_lshl_b32 s17, s53, 10
    s_lshl_b32 s18, s3, 9
    s_add_u32 s17, s17, s18
    s_lshl_b32 s18, s3, 6
    s_lshl_b32 s19, s53, 9
    s_add_u32 s19, s19, 4096
    s_cmp_ge_u32 s3, 2
    s_cselect_b32 s17, s19, s17
    s_cselect_b32 s18, 2560, s18
    s_cselect_b64 vcc, -1, 0
    v_cndmask_b32 v22, v25, v26, vcc
    v_cndmask_b32 v23, v27, v28, vcc
    v_add_u32 v2, s17, v22
    v_add_u32 v4, s18, v23
    v_lshrrev_b32 v21, 4, v20
    v_and_b32 v22, 15, v20
    v_mul_u32_u24 v23, 320, v21
    v_lshl_add_u32 v23, v22, 2, v23
    s_mul_i32 s17, s3, 3840
    v_add_u32 v3, s17, v23
    v_add_u32 v61, 1280, v3
    v_bfe_u32 v24, v20, 3, 1
    v_bfe_u32 v25, v20, 2, 1
    v_xor_b32 v25, v25, v24
    v_bfe_u32 v26, v20, 1, 1
    v_lshl_add_u32 v25, v26, 1, v25
    v_lshl_add_u32 v25, v24, 2, v25
    v_and_b32 v26, 1, v20
    v_lshl_add_u32 v25, v25, 1, v26
    v_sub_u32 v25, v25, v22
    v_lshl_add_u32 v25, v25, 2, v3
    v_add_u32 v62, 2560, v25
    v_lshlrev_b32 v23, 4, v22
    v_lshl_add_u32 v6, v21, 12, v23
    s_lshl_b32 s17, s3, 10
    s_add_u32 s17, s17, 32768
    v_add_u32 v6, s17, v6
    v_lshrrev_b32 v24, 1, v21
    v_lshl_add_u32 v23, v24, 15, v23
    v_and_b32 v24, 1, v21
    v_lshl_add_u32 v7, v24, 8, v23
    v_mov_b32 v58, 15872
    v_bfe_u32 v23, v20, 1, 2
    v_lshlrev_b32 v23, 6, v23
    v_and_b32 v25, 1, v20
    v_lshl_add_u32 v23, v25, 4, v23
    v_lshrrev_b32 v24, 5, v20
    v_lshl_add_u32 v5, v24, 5, v23
    v_and_b32 v23, 7, v20
    v_lshlrev_b32 v23, 7, v23
    v_bfe_u32 v24, v20, 3, 1
    v_lshl_add_u32 v23, v24, 17, v23
    v_lshrrev_b32 v24, 4, v20
    v_lshl_add_u32 v23, v24, 24, v23
    s_lshl_b32 s17, s14, 14
    s_lshl_b32 s18, s34, 10
    s_add_u32 s17, s17, s18
    s_add_u32 s17, s17, 4194304
    v_add_u32 v0, s17, v23
    s_lshl_b32 s17, s3, 2
    s_add_u32 s17, s17, 15872
    v_mov_b32 v63, s17
    v_and_b32 v21, 15, v20
    v_and_b32 v22, 1, v21
    v_lshlrev_b32 v22, 4, v22
    v_mov_b32 v12, 0x3f80
    v_lshlrev_b32 v22, v22, v12
    v_lshrrev_b32 v21, 1, v21
    v_cmp_eq_u32 vcc, 0, v21
    s_nop 1
    v_cndmask_b32 v12, 0, v22, vcc
    v_cmp_eq_u32 vcc, 1, v21
    s_nop 1
    v_cndmask_b32 v13, 0, v22, vcc
    v_cmp_eq_u32 vcc, 2, v21
    s_nop 1
    v_cndmask_b32 v14, 0, v22, vcc
    v_cmp_eq_u32 vcc, 3, v21
    s_nop 1
    v_cndmask_b32 v15, 0, v22, vcc
    s_waitcnt vmcnt(0)
    v_mov_b32 v16, v32
    v_mov_b32 v17, v33
    v_mov_b32 v18, v34
    v_mov_b32 v19, v35
    v_mov_b32 v20, v36
    v_mov_b32 v21, v37
    v_mov_b32 v22, v38
    v_mov_b32 v23, v39
    v_mov_b32 v24, v40
    v_mov_b32 v25, v41
    v_mov_b32 v26, v42
    v_mov_b32 v27, v43
    v_mov_b32 v28, v44
    v_mov_b32 v29, v45
    v_mov_b32 v30, v46
    v_mov_b32 v31, v47
    v_mov_b32 v52, -1
    v_mov_b32 v53, -1
    v_mov_b32 v54, -1
    v_mov_b32 v55, -1
    s_add_u32 s17, s30, 3997696
    buffer_store_dwordx4 v[52:55], v7, s[4:7], s17 offen sc1
    s_add_u32 s17, s30, 4063232
    buffer_store_dwordx4 v[52:55], v7, s[4:7], s17 offen sc1
    s_add_u32 s17, s30, 4128768
    buffer_store_dwordx4 v[52:55], v7, s[4:7], s17 offen sc1
    s_lshl_b32 s40, s40, 5
    s_barrier
    ds_write_b32 v63, v10
    ds_write_b32 v63, v10 offset:16
    ds_write_b32 v63, v10 offset:32
    ds_write_b32 v63, v10 offset:48
    v_mov_b32 v60, 12
    v_mov_b32 v56, 15968
    s_waitcnt lgkmcnt(0)
    s_barrier
    ds_read_b64 v[32:33], v56
    s_waitcnt lgkmcnt(0)
    v_cmp_ne_u32 vcc, s40, v32
    s_setprio 3
    v_readfirstlane_b32 s17, v33
    s_add_u32 s39, s39, s17
    s_cbranch_vccnz ch_p_slow
    v_mov_b32 v32, 0
    v_mov_b32 v33, 0
    v_mov_b32 v34, 0
    v_mov_b32 v35, 0
    v_mov_b32 v36, 0
    v_mov_b32 v37, 0
    v_mov_b32 v38, 0
    v_mov_b32 v39, 0
    v_mov_b32 v40, 0
    v_mov_b32 v41, 0
    v_mov_b32 v42, 0
    v_mov_b32 v43, 0
    v_mov_b32 v44, 0
    v_mov_b32 v45, 0
    v_mov_b32 v46, 0
    v_mov_b32 v47, 0
    v_mov_b32 v48, 0
    v_mov_b32 v49, 0
    v_mov_b32 v50, 0
    v_mov_b32 v51, 0
    v_mov_b32 v52, 0
    v_mov_b32 v53, 0
    v_mov_b32 v54, 0
    v_mov_b32 v55, 0
    v_mov_b32 v59, 0
    s_nop 1
    s_branch pnc_7
.p2align 6
    s_nop 0
    s_nop 0
    s_nop 0
    s_nop 0
    s_nop 0
    s_nop 0
    s_nop 0
    s_nop 0
    s_nop 0
    s_nop 0
    s_nop 0
ploop_6:
    v_mov_b32 v32, 0
    v_mov_b32 v33, 0
    v_mov_b32 v34, 0
    v_mov_b32 v35, 0
    v_mov_b32 v36, 0
    v_mov_b32 v37, 0
    v_mov_b32 v38, 0
    v_mov_b32 v39, 0
    v_mov_b32 v40, 0
    v_mov_b32 v41, 0
    v_mov_b32 v42, 0
    v_mov_b32 v43, 0
    v_mov_b32 v44, 0
    v_mov_b32 v45, 0
    v_mov_b32 v46, 0
    v_mov_b32 v47, 0
    v_mov_b32 v48, 0
    v_mov_b32 v49, 0
    v_mov_b32 v50, 0
    v_mov_b32 v51, 0
    v_mov_b32 v52, 0
    v_mov_b32 v53, 0
    v_mov_b32 v54, 0
    v_mov_b32 v55, 0
    s_sleep 1
    buffer_load_dwordx4 v[16:19], v1, s[4:7], s23 offen offset:0 sc1
    buffer_load_dwordx4 v[20:23], v1, s[4:7], s23 offen offset:1024 sc1
    buffer_load_dwordx4 v[24:27], v1, s[4:7], s23 offen offset:2048 sc1
    buffer_load_dwordx4 v[28:31], v1, s[4:7], s23 offen offset:3072 sc1
    s_waitcnt vmcnt(3)
    v_cmp_eq_u32 vcc, -1, v16
    s_cbranch_vccnz prm_8_0
prm_8_0ok:
    v_smfmac_f32_16x16x64_bf16 v[32:35], v[16:19], v[64:71], v8
    v_smfmac_f32_16x16x64_bf16 v[36:39], v[16:19], v[72:79], v8
    s_waitcnt vmcnt(2)
    v_cmp_eq_u32 vcc, -1, v20
    v_smfmac_f32_16x16x64_bf16 v[40:43], v[16:19], v[80:87], v8
    v_smfmac_f32_16x16x64_bf16 v[44:47], v[16:19], v[88:95], v8
    v_smfmac_f32_16x16x64_bf16 v[48:51], v[16:19], v[96:103], v8
    v_smfmac_f32_16x16x64_bf16 v[52:55], v[16:19], v[104:111], v8
    s_cbranch_vccnz prm_8_1
prm_8_1ok:
    v_smfmac_f32_16x16x64_bf16 v[32:35], v[20:23], v[112:119], v8
    v_smfmac_f32_16x16x64_bf16 v[36:39], v[20:23], v[120:127], v8
    s_waitcnt vmcnt(1)
    v_cmp_eq_u32 vcc, -1, v24
    v_smfmac_f32_16x16x64_bf16 v[40:43], v[20:23], v[128:135], v8
    v_smfmac_f32_16x16x64_bf16 v[44:47], v[20:23], v[136:143], v8
    v_smfmac_f32_16x16x64_bf16 v[48:51], v[20:23], v[144:151], v8
    v_smfmac_f32_16x16x64_bf16 v[52:55], v[20:23], v[152:159], v8
    s_cbranch_vccnz prm_8_2
prm_8_2ok:
    v_smfmac_f32_16x16x64_bf16 v[32:35], v[24:27], v[160:167], v8
    v_smfmac_f32_16x16x64_bf16 v[36:39], v[24:27], v[168:175], v8
    s_waitcnt vmcnt(0)
    v_cmp_eq_u32 vcc, -1, v28
    v_smfmac_f32_16x16x64_bf16 v[40:43], v[24:27], v[176:183], v8
    v_smfmac_f32_16x16x64_bf16 v[44:47], v[24:27], v[184:191], v8
    v_smfmac_f32_16x16x64_bf16 v[48:51], v[24:27], v[192:199], v8
    v_smfmac_f32_16x16x64_bf16 v[52:55], v[24:27], v[200:207], v8
    s_cbranch_vccnz prm_8_3
prm_8_3ok:
    v_smfmac_f32_16x16x64_bf16 v[32:35], v[28:31], v[208:215], v8
    ds_write_b32 v63, v59 offset:32
    v_smfmac_f32_16x16x64_bf16 v[36:39], v[28:31], v[216:223], v8
    v_smfmac_f32_16x16x64_bf16 v[40:43], v[28:31], v[224:231], v8
    v_smfmac_f32_16x16x64_bf16 v[44:47], v[28:31], v[232:239], v8
    v_smfmac_f32_16x16x64_bf16 v[48:51], v[28:31], v[240:247], v8
    v_smfmac_f32_16x16x64_bf16 v[52:55], v[28:31], v[248:255], v8
    s_branch pnc_7_done
pnc_7:
    v_smfmac_f32_16x16x64_bf16 v[32:35], v[16:19], v[64:71], v8
    v_smfmac_f32_16x16x64_bf16 v[36:39], v[16:19], v[72:79], v8
    v_smfmac_f32_16x16x64_bf16 v[40:43], v[16:19], v[80:87], v8
    v_smfmac_f32_16x16x64_bf16 v[44:47], v[16:19], v[88:95], v8
    v_smfmac_f32_16x16x64_bf16 v[48:51], v[16:19], v[96:103], v8
    v_smfmac_f32_16x16x64_bf16 v[52:55], v[16:19], v[104:111], v8
    v_smfmac_f32_16x16x64_bf16 v[32:35], v[20:23], v[112:119], v8
    v_smfmac_f32_16x16x64_bf16 v[36:39], v[20:23], v[120:127], v8
    v_smfmac_f32_16x16x64_bf16 v[40:43], v[20:23], v[128:135], v8
    v_smfmac_f32_16x16x64_bf16 v[44:47], v[20:23], v[136:143], v8
    v_smfmac_f32_16x16x64_bf16 v[48:51], v[20:23], v[144:151], v8
    v_smfmac_f32_16x16x64_bf16 v[52:55], v[20:23], v[152:159], v8
    v_smfmac_f32_16x16x64_bf16 v[32:35], v[24:27], v[160:167], v8
    v_smfmac_f32_16x16x64_bf16 v[36:39], v[24:27], v[168:175], v8
    v_smfmac_f32_16x16x64_bf16 v[40:43], v[24:27], v[176:183], v8
    v_smfmac_f32_16x16x64_bf16 v[44:47], v[24:27], v[184:191], v8
    v_smfmac_f32_16x16x64_bf16 v[48:51], v[24:27], v[192:199], v8
    v_smfmac_f32_16x16x64_bf16 v[52:55], v[24:27], v[200:207], v8
    v_smfmac_f32_16x16x64_bf16 v[32:35], v[28:31], v[208:215], v8
    ds_write_b32 v63, v59 offset:32
    v_smfmac_f32_16x16x64_bf16 v[36:39], v[28:31], v[216:223], v8
    v_smfmac_f32_16x16x64_bf16 v[40:43], v[28:31], v[224:231], v8
    v_smfmac_f32_16x16x64_bf16 v[44:47], v[28:31], v[232:239], v8
    v_smfmac_f32_16x16x64_bf16 v[48:51], v[28:31], v[240:247], v8
    v_smfmac_f32_16x16x64_bf16 v[52:55], v[28:31], v[248:255], v8
pnc_7_done:
    s_cmp_eq_u32 s3, 3
    s_nop 1
    v_add_f32 v32, v32, v34
    v_add_f32 v33, v33, v35
    ds_write2_b32 v3, v32, v33 offset0:0 offset1:40
    v_add_f32 v36, v36, v38
    v_add_f32 v37, v37, v39
    ds_write2_b32 v3, v36, v37 offset0:16 offset1:56
    v_add_f32 v40, v40, v42
    v_add_f32 v41, v41, v43
    ds_write2_b32 v61, v40, v41 offset0:0 offset1:40
    v_add_f32 v44, v44, v46
    v_add_f32 v45, v45, v47
    ds_write2_b32 v61, v44, v45 offset0:16 offset1:56
    v_add_f32 v48, v48, v50
    v_add_f32 v49, v49, v51
    ds_write2_b32 v62, v48, v49 offset0:0 offset1:40
    v_add_f32 v52, v52, v54
    v_add_f32 v53, v53, v55
    ds_write2_b32 v62, v52, v53 offset0:16 offset1:56
    s_waitcnt lgkmcnt(0)
    s_barrier
    s_cbranch_scc1 pskip_10
    ds_read_b128 v[32:35], v4 offset:0
    ds_read_b128 v[36:39], v4 offset:3840
    ds_read_b128 v[40:43], v4 offset:7680
    ds_read_b128 v[44:47], v4 offset:11520
    s_waitcnt lgkmcnt(2)
    v_add_f32 v32, v32, v36
    v_add_f32 v33, v33, v37
    v_add_f32 v34, v34, v38
    v_add_f32 v35, v35, v39
    s_waitcnt lgkmcnt(0)
    v_add_f32 v40, v40, v44
    v_add_f32 v41, v41, v45
    v_add_f32 v42, v42, v46
    v_add_f32 v43, v43, v47
    v_add_f32 v32, v32, v40
    v_add_f32 v33, v33, v41
    v_add_f32 v34, v34, v42
    v_add_f32 v35, v35, v43
    v_cvt_pk_bf16_f32 v56, v32, v33
    v_cvt_pk_bf16_f32 v57, v34, v35
    v_min_u32 v56, -2, v56
    buffer_store_dwordx2 v[56:57], v2, s[4:7], s26 offen
pskip_10:
    s_setprio 0
    s_add_u32 s27, s16, 2
    s_and_b32 s27, s27, 3
    s_lshl_b32 s27, s27, 18
    s_add_u32 s27, s27, s38
    s_add_u32 s25, s16, 3
    s_and_b32 s25, s25, 3
    s_lshl_b32 s25, s25, 16
    s_add_u32 s25, s25, s37
    s_cmp_eq_u32 s3, 3
    s_cbranch_scc1 pskip_11
    buffer_store_dwordx2 v[10:11], v2, s[4:7], s27 offen
pskip_11:
    v_mov_b32 v44, -1
    v_mov_b32 v45, -1
    v_mov_b32 v46, -1
    v_mov_b32 v47, -1
    s_mov_b64 exec, s[56:57]
    buffer_store_dwordx4 v[44:47], v5, s[4:7], s25 offen
    s_mov_b64 exec, -1
    v_mov_b32_dpp v48, v12 row_ror:8 row_mask:0xf bank_mask:0xf
    v_mov_b32_dpp v49, v13 row_ror:8 row_mask:0xf bank_mask:0xf
    v_mov_b32_dpp v50, v14 row_ror:8 row_mask:0xf bank_mask:0xf
    v_mov_b32_dpp v51, v15 row_ror:8 row_mask:0xf bank_mask:0xf
    s_and_b32 s28, s16, 3
    s_lshl_b32 s28, s28, 18
    s_add_u32 s28, s28, s39
    s_add_u32 s24, s16, 1
    s_and_b32 s24, s24, 3
    s_lshl_b32 s24, s24, 16
    s_add_u32 s24, s24, s37
    s_add_u32 s23, s16, 1
    s_and_b32 s23, s23, 3
    s_lshl_b32 s23, s23, 16
    s_add_u32 s23, s23, s36
    s_add_u32 s26, s16, 1
    s_and_b32 s26, s26, 3
    s_lshl_b32 s26, s26, 18
    s_add_u32 s26, s26, s38
    s_cmp_eq_u32 s16, 63
    s_cbranch_scc1 ploop_6_tail
    s_cmp_eq_u32 s30, s54
    s_cbranch_scc1 pnoseg_12
    ds_read_b128 v[16:19], v6 offset:0
    ds_read_b128 v[20:23], v6 offset:256
    ds_read_b128 v[24:27], v6 offset:512
    ds_read_b128 v[28:31], v6 offset:768
    v_xor_b32 v6, 0x4000, v6
    s_waitcnt lgkmcnt(2)
    v_mfma_f32_16x16x32_bf16 v[40:43], v[12:15], v[16:19], 0
    v_mfma_f32_16x16x32_bf16 v[40:43], v[48:51], v[20:23], v[40:43]
    s_waitcnt lgkmcnt(0)
    v_mfma_f32_16x16x32_bf16 v[44:47], v[12:15], v[24:27], 0
    v_mfma_f32_16x16x32_bf16 v[44:47], v[48:51], v[28:31], v[44:47]
    s_nop 7
    v_cvt_pk_bf16_f32 v40, v40, v41
    v_cvt_pk_bf16_f32 v41, v42, v43
    v_cvt_pk_bf16_f32 v42, v44, v45
    v_cvt_pk_bf16_f32 v43, v46, v47
    s_nop 1
    v_permlane16_swap_b32 v40, v42
    v_permlane16_swap_b32 v41, v43
    s_nop 1
    v_min_u32 v40, -2, v40
pnoseg_12:
    s_bitcmp1_b32 s29, 0
    s_cbranch_scc1 gate_13_ok
    s_add_u32 s21, s16, 1
    s_min_u32 s21, s21, 63
    s_and_b32 s32, s21, 4
    s_lshr_b32 s21, s21, 3
    s_lshl_b32 s21, s21, 8
    s_add_u32 s32, s32, s21
    s_add_u32 s32, s32, s35
gate_13:
    buffer_load_dword v9, off, s[4:7], s32 sc1
    s_waitcnt vmcnt(0)
    v_readfirstlane_b32 s21, v9
    s_cmp_ge_u32 s21, 12
    s_cbranch_scc1 gate_13_ok
    s_sleep 8
    s_sub_u32 s22, s22, 1
    s_cbranch_scc0 gate_13
    s_mov_b32 s22, 0
gate_13_ok:
    v_readfirstlane_b32 s21, v60
    s_lshr_b32 s29, s29, 1
    s_cmp_ge_u32 s21, 12
    s_cselect_b32 s21, 2, 0
    s_or_b32 s29, s29, s21
    s_cmp_eq_u32 s3, 3
    s_cselect_b32 s20, s21, 0
    s_add_u32 s21, s16, 4
    s_min_u32 s21, s21, 63
    s_and_b32 s33, s21, 4
    s_lshr_b32 s21, s21, 3
    s_lshl_b32 s21, s21, 8
    s_add_u32 s33, s33, s21
    s_add_u32 s33, s33, s35
    s_setprio 3
ploop_6_fs:
    ds_read_b128 v[32:35], v58 offset:0
    s_waitcnt lgkmcnt(0)
    v_min3_i32 v32, v32, v33, v34
    v_min_i32 v32, v32, v35
    s_nop 0
    v_readfirstlane_b32 s18, v32
    s_cmp_ge_i32 s18, s16
    s_cbranch_scc1 ploop_6_fsok
    s_sleep 1
    s_branch ploop_6_fs
ploop_6_fsok:
    s_setprio 1
    s_add_u32 m0, s42, 0
    s_add_u32 s17, s41, 20971520
    buffer_load_dwordx4 v1, s[4:7], s17 offen offset:0 sc1 lds
    buffer_load_dwordx4 v1, s[4:7], s17 offen offset:1024 sc1 lds
    buffer_load_dwordx4 v1, s[4:7], s17 offen offset:2048 sc1 lds
    buffer_load_dwordx4 v1, s[4:7], s17 offen offset:3072 sc1 lds
    s_add_u32 m0, s42, 4096
    s_add_u32 s17, s41, 21102592
    buffer_load_dwordx4 v1, s[4:7], s17 offen offset:0 sc1 lds
    buffer_load_dwordx4 v1, s[4:7], s17 offen offset:1024 sc1 lds
    buffer_load_dwordx4 v1, s[4:7], s17 offen offset:2048 sc1 lds
    buffer_load_dwordx4 v1, s[4:7], s17 offen offset:3072 sc1 lds
    s_cmp_eq_u32 s20, 0
    s_cbranch_scc1 tch_14
    s_mov_b32 exec_hi, 0xffff
    buffer_load_dword v60, v0, s[4:7], s31 offen sc1
    s_mov_b32 exec_hi, -1
    s_mov_b32 s20, 0
tch_14:
    s_cmp_eq_u32 s30, s54
    s_cbranch_scc1 pnoseg_15
    buffer_store_dwordx4 v[40:43], v7, s[4:7], s30 offen sc1
    s_add_u32 s30, s30, 65536
pnoseg_15:
    s_barrier
    buffer_load_dword v60, off, s[4:7], s33 sc1
    s_sleep 6
    s_add_u32 m0, s42, 8192
    s_add_u32 s17, s41, 37748736
    buffer_load_dwordx4 v1, s[4:7], s17 offen offset:0 sc1 lds
    buffer_load_dwordx4 v1, s[4:7], s17 offen offset:1024 sc1 lds
    buffer_load_dwordx4 v1, s[4:7], s17 offen offset:2048 sc1 lds
    buffer_load_dwordx4 v1, s[4:7], s17 offen offset:3072 sc1 lds
    s_add_u32 m0, s42, 12288
    s_add_u32 s17, s41, 37879808
    buffer_load_dwordx4 v1, s[4:7], s17 offen offset:0 sc1 lds
    buffer_load_dwordx4 v1, s[4:7], s17 offen offset:1024 sc1 lds
    buffer_load_dwordx4 v1, s[4:7], s17 offen offset:2048 sc1 lds
    buffer_load_dwordx4 v1, s[4:7], s17 offen offset:3072 sc1 lds
    s_add_u32 s16, s16, 1
    v_mov_b32 v59, s16
    s_setprio 3
    s_sleep 1
    buffer_load_dwordx4 v[16:19], v1, s[4:7], s28 offen offset:0 sc1
    buffer_load_dwordx4 v[20:23], v1, s[4:7], s28 offen offset:1024 sc1
    s_add_u32 s41, s41, 262144
    s_branch ploop_6_nt
ploop_6_pagain:
    buffer_load_dwordx4 v[16:19], v1, s[4:7], s28 offen offset:0 sc1
    buffer_load_dwordx4 v[20:23], v1, s[4:7], s28 offen offset:1024 sc1
    s_waitcnt vmcnt(0)
    s_branch ploop_6_pw
ploop_6_nt:
    s_add_u32 s31, s31, 262144
    s_waitcnt vmcnt(0)
ploop_6_pw:
    v_mfma_f32_16x16x32_bf16 v[32:35], v[12:15], v[16:19], 0
    v_mfma_f32_16x16x32_bf16 v[32:35], v[48:51], v[20:23], v[32:35]
    v_max_u32 v9, v16, v20
    v_cmp_eq_u32 vcc, -1, v9
    s_cbranch_vccnz prp_9
ploop_6_pgo:
    s_nop 4
    v_add_f32_dpp v36, v32, v32 row_ror:8 row_mask:0xf bank_mask:0xf
    v_add_f32_dpp v37, v33, v33 row_ror:8 row_mask:0xf bank_mask:0xf
    v_add_f32_dpp v38, v34, v34 row_ror:8 row_mask:0xf bank_mask:0xf
    v_add_f32_dpp v39, v35, v35 row_ror:8 row_mask:0xf bank_mask:0xf
    v_cvt_pk_bf16_f32 v52, v36, v37
    v_cvt_pk_bf16_f32 v53, v38, v39
    s_nop 0
    v_permlane16_swap_b32 v52, v54
    v_permlane16_swap_b32 v53, v55
    s_mov_b64 exec, s[56:57]
    v_min_u32 v52, -2, v52
    buffer_store_dwordx4 v[52:55], v5, s[4:7], s24 offen
    s_mov_b64 exec, -1
    ds_write_b32 v63, v59 offset:16
ploop_6_j23:
    s_mov_b32 s54, 0
    s_branch ploop_6
prm_8_0:
    s_sub_u32 s22, s22, 1
    s_cbranch_scc1 prm_8_0_g
    buffer_load_dwordx4 v[16:19], v1, s[4:7], s23 offen offset:0 sc1
    buffer_load_dwordx4 v[20:23], v1, s[4:7], s23 offen offset:1024 sc1
    buffer_load_dwordx4 v[24:27], v1, s[4:7], s23 offen offset:2048 sc1
    buffer_load_dwordx4 v[28:31], v1, s[4:7], s23 offen offset:3072 sc1
    s_waitcnt vmcnt(3)
    v_cmp_eq_u32 vcc, -1, v16
    s_cbranch_vccnz prm_8_0
    s_branch prm_8_0ok
prm_8_0_g:
    s_mov_b32 s22, 0
    s_waitcnt vmcnt(0)
    s_branch prm_8_0ok
prm_8_1:
    s_sub_u32 s22, s22, 1
    s_cbranch_scc1 prm_8_1_g
    buffer_load_dwordx4 v[20:23], v1, s[4:7], s23 offen offset:1024 sc1
    buffer_load_dwordx4 v[24:27], v1, s[4:7], s23 offen offset:2048 sc1
    buffer_load_dwordx4 v[28:31], v1, s[4:7], s23 offen offset:3072 sc1
    s_waitcnt vmcnt(2)
    v_cmp_eq_u32 vcc, -1, v20
    s_cbranch_vccnz prm_8_1
    s_branch prm_8_1ok
prm_8_1_g:
    s_mov_b32 s22, 0
    s_waitcnt vmcnt(0)
    s_branch prm_8_1ok
prm_8_2:
    s_sub_u32 s22, s22, 1
    s_cbranch_scc1 prm_8_2_g
    buffer_load_dwordx4 v[24:27], v1, s[4:7], s23 offen offset:2048 sc1
    buffer_load_dwordx4 v[28:31], v1, s[4:7], s23 offen offset:3072 sc1
    s_waitcnt vmcnt(1)
    v_cmp_eq_u32 vcc, -1, v24
    s_cbranch_vccnz prm_8_2
    s_branch prm_8_2ok
prm_8_2_g:
    s_mov_b32 s22, 0
    s_waitcnt vmcnt(0)
    s_branch prm_8_2ok
prm_8_3:
    s_sub_u32 s22, s22, 1
    s_cbranch_scc1 prm_8_3_g
    buffer_load_dwordx4 v[28:31], v1, s[4:7], s23 offen offset:3072 sc1
    s_waitcnt vmcnt(0)
    v_cmp_eq_u32 vcc, -1, v28
    s_cbranch_vccnz prm_8_3
    s_branch prm_8_3ok
prm_8_3_g:
    s_mov_b32 s22, 0
    s_waitcnt vmcnt(0)
    s_branch prm_8_3ok
prp_9:
    s_sub_u32 s22, s22, 1
    s_cbranch_scc0 ploop_6_pagain
    s_mov_b32 s22, 0
    s_branch ploop_6_pgo
ploop_6_tail:
    ds_read_b128 v[16:19], v6 offset:0
    ds_read_b128 v[20:23], v6 offset:256
    ds_read_b128 v[24:27], v6 offset:512
    ds_read_b128 v[28:31], v6 offset:768
    v_xor_b32 v6, 0x4000, v6
    s_waitcnt lgkmcnt(2)
    v_mfma_f32_16x16x32_bf16 v[40:43], v[12:15], v[16:19], 0
    v_mfma_f32_16x16x32_bf16 v[40:43], v[48:51], v[20:23], v[40:43]
    s_waitcnt lgkmcnt(0)
    v_mfma_f32_16x16x32_bf16 v[44:47], v[12:15], v[24:27], 0
    v_mfma_f32_16x16x32_bf16 v[44:47], v[48:51], v[28:31], v[44:47]
    s_nop 7
    v_cvt_pk_bf16_f32 v40, v40, v41
    v_cvt_pk_bf16_f32 v41, v42, v43
    v_cvt_pk_bf16_f32 v42, v44, v45
    v_cvt_pk_bf16_f32 v43, v46, v47
    s_nop 1
    v_permlane16_swap_b32 v40, v42
    v_permlane16_swap_b32 v41, v43
    s_nop 1
    v_min_u32 v40, -2, v40
    buffer_store_dwordx4 v[40:43], v7, s[4:7], s30 offen sc1
    s_add_u32 s30, s30, 65536
    s_barrier
    ds_read_b128 v[16:19], v6 offset:0
    ds_read_b128 v[20:23], v6 offset:256
    ds_read_b128 v[24:27], v6 offset:512
    ds_read_b128 v[28:31], v6 offset:768
    v_xor_b32 v6, 0x4000, v6
    s_waitcnt lgkmcnt(2)
    v_mfma_f32_16x16x32_bf16 v[40:43], v[12:15], v[16:19], 0
    v_mfma_f32_16x16x32_bf16 v[40:43], v[48:51], v[20:23], v[40:43]
    s_waitcnt lgkmcnt(0)
    v_mfma_f32_16x16x32_bf16 v[44:47], v[12:15], v[24:27], 0
    v_mfma_f32_16x16x32_bf16 v[44:47], v[48:51], v[28:31], v[44:47]
    s_nop 7
    v_cvt_pk_bf16_f32 v40, v40, v41
    v_cvt_pk_bf16_f32 v41, v42, v43
    v_cvt_pk_bf16_f32 v42, v44, v45
    v_cvt_pk_bf16_f32 v43, v46, v47
    s_nop 1
    v_permlane16_swap_b32 v40, v42
    v_permlane16_swap_b32 v41, v43
    s_nop 1
    v_min_u32 v40, -2, v40
    buffer_store_dwordx4 v[40:43], v7, s[4:7], s30 offen sc1
    s_add_u32 s30, s30, 65536
    s_branch k_end
ch_p_slow:
    v_mov_b32 v32, 0
    v_mov_b32 v33, 0
    v_mov_b32 v34, 0
    v_mov_b32 v35, 0
    v_mov_b32 v36, 0
    v_mov_b32 v37, 0
    v_mov_b32 v38, 0
    v_mov_b32 v39, 0
    v_mov_b32 v40, 0
    v_mov_b32 v41, 0
    v_mov_b32 v42, 0
    v_mov_b32 v43, 0
    v_mov_b32 v44, 0
    v_mov_b32 v45, 0
    v_mov_b32 v46, 0
    v_mov_b32 v47, 0
    v_mov_b32 v48, 0
    v_mov_b32 v49, 0
    v_mov_b32 v50, 0
    v_mov_b32 v51, 0
    v_mov_b32 v52, 0
    v_mov_b32 v53, 0
    v_mov_b32 v54, 0
    v_mov_b32 v55, 0
    v_mov_b32 v59, 0
    s_nop 1
    s_branch pnc_17
.p2align 6
    s_nop 0
    s_nop 0
    s_nop 0
    s_nop 0
    s_nop 0
    s_nop 0
    s_nop 0
    s_nop 0
    s_nop 0
    s_nop 0
    s_nop 0
ploop_16:
    v_mov_b32 v32, 0
    v_mov_b32 v33, 0
    v_mov_b32 v34, 0
    v_mov_b32 v35, 0
    v_mov_b32 v36, 0
    v_mov_b32 v37, 0
    v_mov_b32 v38, 0
    v_mov_b32 v39, 0
    v_mov_b32 v40, 0
    v_mov_b32 v41, 0
    v_mov_b32 v42, 0
    v_mov_b32 v43, 0
    v_mov_b32 v44, 0
    v_mov_b32 v45, 0
    v_mov_b32 v46, 0
    v_mov_b32 v47, 0
    v_mov_b32 v48, 0
    v_mov_b32 v49, 0
    v_mov_b32 v50, 0
    v_mov_b32 v51, 0
    v_mov_b32 v52, 0
    v_mov_b32 v53, 0
    v_mov_b32 v54, 0
    v_mov_b32 v55, 0
    s_sleep 1
    buffer_load_dwordx4 v[16:19], v1, s[4:7], s23 offen offset:0 sc1
    buffer_load_dwordx4 v[20:23], v1, s[4:7], s23 offen offset:1024 sc1
    buffer_load_dwordx4 v[24:27], v1, s[4:7], s23 offen offset:2048 sc1
    buffer_load_dwordx4 v[28:31], v1, s[4:7], s23 offen offset:3072 sc1
    s_waitcnt vmcnt(3)
    v_cmp_eq_u32 vcc, -1, v16
    s_cbranch_vccnz prm_18_0
prm_18_0ok:
    v_smfmac_f32_16x16x64_bf16 v[32:35], v[16:19], v[64:71], v8
    v_smfmac_f32_16x16x64_bf16 v[36:39], v[16:19], v[72:79], v8
    s_waitcnt vmcnt(2)
    v_cmp_eq_u32 vcc, -1, v20
    v_smfmac_f32_16x16x64_bf16 v[40:43], v[16:19], v[80:87], v8
    v_smfmac_f32_16x16x64_bf16 v[44:47], v[16:19], v[88:95], v8
    v_smfmac_f32_16x16x64_bf16 v[48:51], v[16:19], v[96:103], v8
    v_smfmac_f32_16x16x64_bf16 v[52:55], v[16:19], v[104:111], v8
    s_cbranch_vccnz prm_18_1
prm_18_1ok:
    v_smfmac_f32_16x16x64_bf16 v[32:35], v[20:23], v[112:119], v8
    v_smfmac_f32_16x16x64_bf16 v[36:39], v[20:23], v[120:127], v8
    s_waitcnt vmcnt(1)
    v_cmp_eq_u32 vcc, -1, v24
    v_smfmac_f32_16x16x64_bf16 v[40:43], v[20:23], v[128:135], v8
    v_smfmac_f32_16x16x64_bf16 v[44:47], v[20:23], v[136:143], v8
    v_smfmac_f32_16x16x64_bf16 v[48:51], v[20:23], v[144:151], v8
    v_smfmac_f32_16x16x64_bf16 v[52:55], v[20:23], v[152:159], v8
    s_cbranch_vccnz prm_18_2
prm_18_2ok:
    v_smfmac_f32_16x16x64_bf16 v[32:35], v[24:27], v[160:167], v8
    v_smfmac_f32_16x16x64_bf16 v[36:39], v[24:27], v[168:175], v8
    s_waitcnt vmcnt(0)
    v_cmp_eq_u32 vcc, -1, v28
    v_smfmac_f32_16x16x64_bf16 v[40:43], v[24:27], v[176:183], v8
    v_smfmac_f32_16x16x64_bf16 v[44:47], v[24:27], v[184:191], v8
    v_smfmac_f32_16x16x64_bf16 v[48:51], v[24:27], v[192:199], v8
    v_smfmac_f32_16x16x64_bf16 v[52:55], v[24:27], v[200:207], v8
    s_cbranch_vccnz prm_18_3
prm_18_3ok:
    v_smfmac_f32_16x16x64_bf16 v[32:35], v[28:31], v[208:215], v8
    ds_write_b32 v63, v59 offset:32
    v_smfmac_f32_16x16x64_bf16 v[36:39], v[28:31], v[216:223], v8
    v_smfmac_f32_16x16x64_bf16 v[40:43], v[28:31], v[224:231], v8
    v_smfmac_f32_16x16x64_bf16 v[44:47], v[28:31], v[232:239], v8
    v_smfmac_f32_16x16x64_bf16 v[48:51], v[28:31], v[240:247], v8
    v_smfmac_f32_16x16x64_bf16 v[52:55], v[28:31], v[248:255], v8
    s_branch pnc_17_done
pnc_17:
    v_smfmac_f32_16x16x64_bf16 v[32:35], v[16:19], v[64:71], v8
    v_smfmac_f32_16x16x64_bf16 v[36:39], v[16:19], v[72:79], v8
    v_smfmac_f32_16x16x64_bf16 v[40:43], v[16:19], v[80:87], v8
    v_smfmac_f32_16x16x64_bf16 v[44:47], v[16:19], v[88:95], v8
    v_smfmac_f32_16x16x64_bf16 v[48:51], v[16:19], v[96:103], v8
    v_smfmac_f32_16x16x64_bf16 v[52:55], v[16:19], v[104:111], v8
    v_smfmac_f32_16x16x64_bf16 v[32:35], v[20:23], v[112:119], v8
    v_smfmac_f32_16x16x64_bf16 v[36:39], v[20:23], v[120:127], v8
    v_smfmac_f32_16x16x64_bf16 v[40:43], v[20:23], v[128:135], v8
    v_smfmac_f32_16x16x64_bf16 v[44:47], v[20:23], v[136:143], v8
    v_smfmac_f32_16x16x64_bf16 v[48:51], v[20:23], v[144:151], v8
    v_smfmac_f32_16x16x64_bf16 v[52:55], v[20:23], v[152:159], v8
    v_smfmac_f32_16x16x64_bf16 v[32:35], v[24:27], v[160:167], v8
    v_smfmac_f32_16x16x64_bf16 v[36:39], v[24:27], v[168:175], v8
    v_smfmac_f32_16x16x64_bf16 v[40:43], v[24:27], v[176:183], v8
    v_smfmac_f32_16x16x64_bf16 v[44:47], v[24:27], v[184:191], v8
    v_smfmac_f32_16x16x64_bf16 v[48:51], v[24:27], v[192:199], v8
    v_smfmac_f32_16x16x64_bf16 v[52:55], v[24:27], v[200:207], v8
    v_smfmac_f32_16x16x64_bf16 v[32:35], v[28:31], v[208:215], v8
    ds_write_b32 v63, v59 offset:32
    v_smfmac_f32_16x16x64_bf16 v[36:39], v[28:31], v[216:223], v8
    v_smfmac_f32_16x16x64_bf16 v[40:43], v[28:31], v[224:231], v8
    v_smfmac_f32_16x16x64_bf16 v[44:47], v[28:31], v[232:239], v8
    v_smfmac_f32_16x16x64_bf16 v[48:51], v[28:31], v[240:247], v8
    v_smfmac_f32_16x16x64_bf16 v[52:55], v[28:31], v[248:255], v8
pnc_17_done:
    s_cmp_eq_u32 s3, 3
    s_nop 1
    v_add_f32 v32, v32, v34
    v_add_f32 v33, v33, v35
    ds_write2_b32 v3, v32, v33 offset0:0 offset1:40
    v_add_f32 v36, v36, v38
    v_add_f32 v37, v37, v39
    ds_write2_b32 v3, v36, v37 offset0:16 offset1:56
    v_add_f32 v40, v40, v42
    v_add_f32 v41, v41, v43
    ds_write2_b32 v61, v40, v41 offset0:0 offset1:40
    v_add_f32 v44, v44, v46
    v_add_f32 v45, v45, v47
    ds_write2_b32 v61, v44, v45 offset0:16 offset1:56
    v_add_f32 v48, v48, v50
    v_add_f32 v49, v49, v51
    ds_write2_b32 v62, v48, v49 offset0:0 offset1:40
    v_add_f32 v52, v52, v54
    v_add_f32 v53, v53, v55
    ds_write2_b32 v62, v52, v53 offset0:16 offset1:56
    s_waitcnt lgkmcnt(0)
    s_barrier
    s_cbranch_scc1 pskip_20
    ds_read_b128 v[32:35], v4 offset:0
    ds_read_b128 v[36:39], v4 offset:3840
    ds_read_b128 v[40:43], v4 offset:7680
    ds_read_b128 v[44:47], v4 offset:11520
    s_waitcnt lgkmcnt(2)
    v_add_f32 v32, v32, v36
    v_add_f32 v33, v33, v37
    v_add_f32 v34, v34, v38
    v_add_f32 v35, v35, v39
    s_waitcnt lgkmcnt(0)
    v_add_f32 v40, v40, v44
    v_add_f32 v41, v41, v45
    v_add_f32 v42, v42, v46
    v_add_f32 v43, v43, v47
    v_add_f32 v32, v32, v40
    v_add_f32 v33, v33, v41
    v_add_f32 v34, v34, v42
    v_add_f32 v35, v35, v43
    v_cvt_pk_bf16_f32 v56, v32, v33
    v_cvt_pk_bf16_f32 v57, v34, v35
    v_min_u32 v56, -2, v56
    buffer_store_dwordx2 v[56:57], v2, s[4:7], s26 offen sc1
pskip_20:
    s_setprio 0
    s_add_u32 s27, s16, 2
    s_and_b32 s27, s27, 3
    s_lshl_b32 s27, s27, 18
    s_add_u32 s27, s27, s38
    s_add_u32 s25, s16, 3
    s_and_b32 s25, s25, 3
    s_lshl_b32 s25, s25, 16
    s_add_u32 s25, s25, s37
    s_cmp_eq_u32 s3, 3
    s_cbranch_scc1 pskip_21
    buffer_store_dwordx2 v[10:11], v2, s[4:7], s27 offen sc1
pskip_21:
    v_mov_b32 v44, -1
    v_mov_b32 v45, -1
    v_mov_b32 v46, -1
    v_mov_b32 v47, -1
    s_mov_b64 exec, s[56:57]
    buffer_store_dwordx4 v[44:47], v5, s[4:7], s25 offen sc1
    s_mov_b64 exec, -1
    v_mov_b32_dpp v48, v12 row_ror:8 row_mask:0xf bank_mask:0xf
    v_mov_b32_dpp v49, v13 row_ror:8 row_mask:0xf bank_mask:0xf
    v_mov_b32_dpp v50, v14 row_ror:8 row_mask:0xf bank_mask:0xf
    v_mov_b32_dpp v51, v15 row_ror:8 row_mask:0xf bank_mask:0xf
    s_and_b32 s28, s16, 3
    s_lshl_b32 s28, s28, 18
    s_add_u32 s28, s28, s39
    s_add_u32 s24, s16, 1
    s_and_b32 s24, s24, 3
    s_lshl_b32 s24, s24, 16
    s_add_u32 s24, s24, s37
    s_add_u32 s23, s16, 1
    s_and_b32 s23, s23, 3
    s_lshl_b32 s23, s23, 16
    s_add_u32 s23, s23, s36
    s_add_u32 s26, s16, 1
    s_and_b32 s26, s26, 3
    s_lshl_b32 s26, s26, 18
    s_add_u32 s26, s26, s38
    s_cmp_eq_u32 s16, 63
    s_cbranch_scc1 ploop_16_tail
    s_cmp_eq_u32 s30, s54
    s_cbranch_scc1 pnoseg_22
    ds_read_b128 v[16:19], v6 offset:0
    ds_read_b128 v[20:23], v6 offset:256
    ds_read_b128 v[24:27], v6 offset:512
    ds_read_b128 v[28:31], v6 offset:768
    v_xor_b32 v6, 0x4000, v6
    s_waitcnt lgkmcnt(2)
    v_mfma_f32_16x16x32_bf16 v[40:43], v[12:15], v[16:19], 0
    v_mfma_f32_16x16x32_bf16 v[40:43], v[48:51], v[20:23], v[40:43]
    s_waitcnt lgkmcnt(0)
    v_mfma_f32_16x16x32_bf16 v[44:47], v[12:15], v[24:27], 0
    v_mfma_f32_16x16x32_bf16 v[44:47], v[48:51], v[28:31], v[44:47]
    s_nop 7
    v_cvt_pk_bf16_f32 v40, v40, v41
    v_cvt_pk_bf16_f32 v41, v42, v43
    v_cvt_pk_bf16_f32 v42, v44, v45
    v_cvt_pk_bf16_f32 v43, v46, v47
    s_nop 1
    v_permlane16_swap_b32 v40, v42
    v_permlane16_swap_b32 v41, v43
    s_nop 1
    v_min_u32 v40, -2, v40
pnoseg_22:
    s_bitcmp1_b32 s29, 0
    s_cbranch_scc1 gate_23_ok
    s_add_u32 s21, s16, 1
    s_min_u32 s21, s21, 63
    s_and_b32 s32, s21, 4
    s_lshr_b32 s21, s21, 3
    s_lshl_b32 s21, s21, 8
    s_add_u32 s32, s32, s21
    s_add_u32 s32, s32, s35
gate_23:
    buffer_load_dword v9, off, s[4:7], s32 sc1
    s_waitcnt vmcnt(0)
    v_readfirstlane_b32 s21, v9
    s_cmp_ge_u32 s21, 12
    s_cbranch_scc1 gate_23_ok
    s_sleep 8
    s_sub_u32 s22, s22, 1
    s_cbranch_scc0 gate_23
    s_mov_b32 s22, 0
gate_23_ok:
    v_readfirstlane_b32 s21, v60
    s_lshr_b32 s29, s29, 1
    s_cmp_ge_u32 s21, 12
    s_cselect_b32 s21, 2, 0
    s_or_b32 s29, s29, s21
    s_cmp_eq_u32 s3, 3
    s_cselect_b32 s20, s21, 0
    s_add_u32 s21, s16, 4
    s_min_u32 s21, s21, 63
    s_and_b32 s33, s21, 4
    s_lshr_b32 s21, s21, 3
    s_lshl_b32 s21, s21, 8
    s_add_u32 s33, s33, s21
    s_add_u32 s33, s33, s35
    s_setprio 3
ploop_16_fs:
    ds_read_b128 v[32:35], v58 offset:0
    s_waitcnt lgkmcnt(0)
    v_min3_i32 v32, v32, v33, v34
    v_min_i32 v32, v32, v35
    s_nop 0
    v_readfirstlane_b32 s18, v32
    s_cmp_ge_i32 s18, s16
    s_cbranch_scc1 ploop_16_fsok
    s_sleep 1
    s_branch ploop_16_fs
ploop_16_fsok:
    s_setprio 1
    s_add_u32 m0, s42, 0
    s_add_u32 s17, s41, 20971520
    buffer_load_dwordx4 v1, s[4:7], s17 offen offset:0 sc1 lds
    buffer_load_dwordx4 v1, s[4:7], s17 offen offset:1024 sc1 lds
    buffer_load_dwordx4 v1, s[4:7], s17 offen offset:2048 sc1 lds
    buffer_load_dwordx4 v1, s[4:7], s17 offen offset:3072 sc1 lds
    s_add_u32 m0, s42, 4096
    s_add_u32 s17, s41, 21102592
    buffer_load_dwordx4 v1, s[4:7], s17 offen offset:0 sc1 lds
    buffer_load_dwordx4 v1, s[4:7], s17 offen offset:1024 sc1 lds
    buffer_load_dwordx4 v1, s[4:7], s17 offen offset:2048 sc1 lds
    buffer_load_dwordx4 v1, s[4:7], s17 offen offset:3072 sc1 lds
    s_cmp_eq_u32 s20, 0
    s_cbranch_scc1 tch_24
    s_mov_b32 exec_hi, 0xffff
    buffer_load_dword v60, v0, s[4:7], s31 offen sc1
    s_mov_b32 exec_hi, -1
    s_mov_b32 s20, 0
tch_24:
    s_cmp_eq_u32 s30, s54
    s_cbranch_scc1 pnoseg_25
    buffer_store_dwordx4 v[40:43], v7, s[4:7], s30 offen sc1
    s_add_u32 s30, s30, 65536
pnoseg_25:
    s_barrier
    buffer_load_dword v60, off, s[4:7], s33 sc1
    s_sleep 6
    s_add_u32 m0, s42, 8192
    s_add_u32 s17, s41, 37748736
    buffer_load_dwordx4 v1, s[4:7], s17 offen offset:0 sc1 lds
    buffer_load_dwordx4 v1, s[4:7], s17 offen offset:1024 sc1 lds
    buffer_load_dwordx4 v1, s[4:7], s17 offen offset:2048 sc1 lds
    buffer_load_dwordx4 v1, s[4:7], s17 offen offset:3072 sc1 lds
    s_add_u32 m0, s42, 12288
    s_add_u32 s17, s41, 37879808
    buffer_load_dwordx4 v1, s[4:7], s17 offen offset:0 sc1 lds
    buffer_load_dwordx4 v1, s[4:7], s17 offen offset:1024 sc1 lds
    buffer_load_dwordx4 v1, s[4:7], s17 offen offset:2048 sc1 lds
    buffer_load_dwordx4 v1, s[4:7], s17 offen offset:3072 sc1 lds
    s_add_u32 s16, s16, 1
    v_mov_b32 v59, s16
    s_setprio 3
    s_sleep 1
    buffer_load_dwordx4 v[16:19], v1, s[4:7], s28 offen offset:0 sc1
    buffer_load_dwordx4 v[20:23], v1, s[4:7], s28 offen offset:1024 sc1
    s_add_u32 s41, s41, 262144
    s_branch ploop_16_nt
ploop_16_pagain:
    buffer_load_dwordx4 v[16:19], v1, s[4:7], s28 offen offset:0 sc1
    buffer_load_dwordx4 v[20:23], v1, s[4:7], s28 offen offset:1024 sc1
    s_waitcnt vmcnt(0)
    s_branch ploop_16_pw
ploop_16_nt:
    s_add_u32 s31, s31, 262144
    s_waitcnt vmcnt(0)
ploop_16_pw:
    v_mfma_f32_16x16x32_bf16 v[32:35], v[12:15], v[16:19], 0
    v_mfma_f32_16x16x32_bf16 v[32:35], v[48:51], v[20:23], v[32:35]
    v_max_u32 v9, v16, v20
    v_cmp_eq_u32 vcc, -1, v9
    s_cbranch_vccnz prp_19
ploop_16_pgo:
    s_nop 4
    v_add_f32_dpp v36, v32, v32 row_ror:8 row_mask:0xf bank_mask:0xf
    v_add_f32_dpp v37, v33, v33 row_ror:8 row_mask:0xf bank_mask:0xf
    v_add_f32_dpp v38, v34, v34 row_ror:8 row_mask:0xf bank_mask:0xf
    v_add_f32_dpp v39, v35, v35 row_ror:8 row_mask:0xf bank_mask:0xf
    v_cvt_pk_bf16_f32 v52, v36, v37
    v_cvt_pk_bf16_f32 v53, v38, v39
    s_nop 0
    v_permlane16_swap_b32 v52, v54
    v_permlane16_swap_b32 v53, v55
    s_mov_b64 exec, s[56:57]
    v_min_u32 v52, -2, v52
    buffer_store_dwordx4 v[52:55], v5, s[4:7], s24 offen sc1
    s_mov_b64 exec, -1
    ds_write_b32 v63, v59 offset:16
ploop_16_j23:
    s_mov_b32 s54, 0
    s_branch ploop_16
prm_18_0:
    s_sub_u32 s22, s22, 1
    s_cbranch_scc1 prm_18_0_g
    buffer_load_dwordx4 v[16:19], v1, s[4:7], s23 offen offset:0 sc1
    buffer_load_dwordx4 v[20:23], v1, s[4:7], s23 offen offset:1024 sc1
    buffer_load_dwordx4 v[24:27], v1, s[4:7], s23 offen offset:2048 sc1
    buffer_load_dwordx4 v[28:31], v1, s[4:7], s23 offen offset:3072 sc1
    s_waitcnt vmcnt(3)
    v_cmp_eq_u32 vcc, -1, v16
    s_cbranch_vccnz prm_18_0
    s_branch prm_18_0ok
prm_18_0_g:
    s_mov_b32 s22, 0
    s_waitcnt vmcnt(0)
    s_branch prm_18_0ok
prm_18_1:
    s_sub_u32 s22, s22, 1
    s_cbranch_scc1 prm_18_1_g
    buffer_load_dwordx4 v[20:23], v1, s[4:7], s23 offen offset:1024 sc1
    buffer_load_dwordx4 v[24:27], v1, s[4:7], s23 offen offset:2048 sc1
    buffer_load_dwordx4 v[28:31], v1, s[4:7], s23 offen offset:3072 sc1
    s_waitcnt vmcnt(2)
    v_cmp_eq_u32 vcc, -1, v20
    s_cbranch_vccnz prm_18_1
    s_branch prm_18_1ok
prm_18_1_g:
    s_mov_b32 s22, 0
    s_waitcnt vmcnt(0)
    s_branch prm_18_1ok
prm_18_2:
    s_sub_u32 s22, s22, 1
    s_cbranch_scc1 prm_18_2_g
    buffer_load_dwordx4 v[24:27], v1, s[4:7], s23 offen offset:2048 sc1
    buffer_load_dwordx4 v[28:31], v1, s[4:7], s23 offen offset:3072 sc1
    s_waitcnt vmcnt(1)
    v_cmp_eq_u32 vcc, -1, v24
    s_cbranch_vccnz prm_18_2
    s_branch prm_18_2ok
prm_18_2_g:
    s_mov_b32 s22, 0
    s_waitcnt vmcnt(0)
    s_branch prm_18_2ok
prm_18_3:
    s_sub_u32 s22, s22, 1
    s_cbranch_scc1 prm_18_3_g
    buffer_load_dwordx4 v[28:31], v1, s[4:7], s23 offen offset:3072 sc1
    s_waitcnt vmcnt(0)
    v_cmp_eq_u32 vcc, -1, v28
    s_cbranch_vccnz prm_18_3
    s_branch prm_18_3ok
prm_18_3_g:
    s_mov_b32 s22, 0
    s_waitcnt vmcnt(0)
    s_branch prm_18_3ok
prp_19:
    s_sub_u32 s22, s22, 1
    s_cbranch_scc0 ploop_16_pagain
    s_mov_b32 s22, 0
    s_branch ploop_16_pgo
ploop_16_tail:
    ds_read_b128 v[16:19], v6 offset:0
    ds_read_b128 v[20:23], v6 offset:256
    ds_read_b128 v[24:27], v6 offset:512
    ds_read_b128 v[28:31], v6 offset:768
    v_xor_b32 v6, 0x4000, v6
    s_waitcnt lgkmcnt(2)
    v_mfma_f32_16x16x32_bf16 v[40:43], v[12:15], v[16:19], 0
    v_mfma_f32_16x16x32_bf16 v[40:43], v[48:51], v[20:23], v[40:43]
    s_waitcnt lgkmcnt(0)
    v_mfma_f32_16x16x32_bf16 v[44:47], v[12:15], v[24:27], 0
    v_mfma_f32_16x16x32_bf16 v[44:47], v[48:51], v[28:31], v[44:47]
    s_nop 7
    v_cvt_pk_bf16_f32 v40, v40, v41
    v_cvt_pk_bf16_f32 v41, v42, v43
    v_cvt_pk_bf16_f32 v42, v44, v45
    v_cvt_pk_bf16_f32 v43, v46, v47
    s_nop 1
    v_permlane16_swap_b32 v40, v42
    v_permlane16_swap_b32 v41, v43
    s_nop 1
    v_min_u32 v40, -2, v40
    buffer_store_dwordx4 v[40:43], v7, s[4:7], s30 offen sc1
    s_add_u32 s30, s30, 65536
    s_barrier
    ds_read_b128 v[16:19], v6 offset:0
    ds_read_b128 v[20:23], v6 offset:256
    ds_read_b128 v[24:27], v6 offset:512
    ds_read_b128 v[28:31], v6 offset:768
    v_xor_b32 v6, 0x4000, v6
    s_waitcnt lgkmcnt(2)
    v_mfma_f32_16x16x32_bf16 v[40:43], v[12:15], v[16:19], 0
    v_mfma_f32_16x16x32_bf16 v[40:43], v[48:51], v[20:23], v[40:43]
    s_waitcnt lgkmcnt(0)
    v_mfma_f32_16x16x32_bf16 v[44:47], v[12:15], v[24:27], 0
    v_mfma_f32_16x16x32_bf16 v[44:47], v[48:51], v[28:31], v[44:47]
    s_nop 7
    v_cvt_pk_bf16_f32 v40, v40, v41
    v_cvt_pk_bf16_f32 v41, v42, v43
    v_cvt_pk_bf16_f32 v42, v44, v45
    v_cvt_pk_bf16_f32 v43, v46, v47
    s_nop 1
    v_permlane16_swap_b32 v40, v42
    v_permlane16_swap_b32 v41, v43
    s_nop 1
    v_min_u32 v40, -2, v40
    buffer_store_dwordx4 v[40:43], v7, s[4:7], s30 offen sc1
    s_add_u32 s30, s30, 65536
    s_branch k_end
ch_a_pro:
    s_sub_u32 s21, s3, 4
    s_lshl_b32 s15, s14, 2
    s_add_u32 s15, s15, s21
    s_lshl_b32 s38, s15, 13
    s_add_u32 s38, s38, 214958080
    s_min_u32 s20, s21, 2
    s_lshl_b32 s18, s20, 3
    s_add_u32 s18, s18, 16
    s_load_dwordx2 s[8:9], s[0:1], s18
    s_mov_b32 s10, 8388608
    s_mov_b32 s11, 131072
    v_and_b32 v20, 63, v0
    v_lshlrev_b32 v21, 13, v20
    s_lshl_b32 s17, s34, 19
    s_lshl_b32 s18, s14, 10
    s_add_u32 s17, s17, s18
    s_waitcnt lgkmcnt(0)
    buffer_load_dword v26, v21, s[8:11], s17 offen offset:384
    v_and_b32 v20, 63, v0
    v_lshrrev_b32 v21, 4, v20
    v_bfe_u32 v22, v20, 1, 1
    v_xor_b32 v22, 1, v22
    v_lshl_add_u32 v23, v22, 2, v21
    v_bfe_u32 v22, v20, 2, 2
    v_and_b32 v24, 1, v20
    v_lshl_add_u32 v22, v22, 1, v24
    v_lshl_add_u32 v23, v23, 3, v22
    v_and_b32 v22, 7, v20
    v_lshlrev_b32 v23, 4, v23
    s_lshl_b32 s17, s21, 10
    s_add_u32 s17, s17, 16384
    v_add_u32 v160, s17, v23
    v_and_b32 v24, 15, v20
    v_lshlrev_b32 v24, 4, v24
    v_lshl_add_u32 v23, v21, 10, v24
    s_lshl_b32 s17, s21, 8
    s_add_u32 s17, s17, 16384
    v_add_u32 v161, s17, v23
    v_lshl_add_u32 v23, v21, 9, v24
    s_lshl_b32 s17, s21, 12
    s_add_u32 s17, s17, 32768
    v_add_u32 v162, s17, v23
    v_bfe_u32 v23, v20, 3, 1
    v_lshlrev_b32 v23, 10, v23
    v_lshl_add_u32 v23, v22, 4, v23
    v_mov_b32 v1, v23
    s_lshl_b32 s39, s34, 14
    s_lshl_b32 s17, s21, 11
    s_add_u32 s39, s39, s17
    s_lshl_b32 s17, s14, 7
    s_add_u32 s39, s39, s17
    s_add_u32 s39, s39, 209715200
    v_mov_b32 v176, -1
    v_mov_b32 v177, -1
    v_mov_b32 v178, -1
    v_mov_b32 v179, -1
    v_lshlrev_b32 v24, 4, v0
    s_lshl_b32 s17, s52, 13
    s_add_u32 s19, s17, 209711104
    s_add_u32 s17, s17, 214953984
    s_lshl_b32 s18, s52, 12
    s_add_u32 s18, s18, 213905408
    buffer_store_dwordx4 v[176:179], v24, s[4:7], s19 offen sc1
    s_add_u32 s19, s19, 4096
    buffer_store_dwordx4 v[176:179], v24, s[4:7], s19 offen sc1
    buffer_store_dwordx4 v[176:179], v24, s[4:7], s17 offen sc1
    s_add_u32 s17, s17, 4096
    buffer_store_dwordx4 v[176:179], v24, s[4:7], s17 offen sc1
    buffer_store_dwordx4 v[176:179], v24, s[4:7], s18 offen sc1
    s_and_b32 s17, s13, 7
    s_sub_u32 s18, s21, 1
    s_cmp_lt_u32 s18, 2
    s_cselect_b32 s54, s17, 1
    s_lshr_b32 s19, s52, 3
    s_lshl_b32 s19, s19, 8
    s_lshl_b32 s18, s18, 7
    s_add_u32 s19, s19, s18
    s_add_u32 s55, s19, 210763776
    s_cmp_lg_u32 s54, 0
    s_cbranch_scc1 ch_nv0
    v_lshlrev_b32 v24, 13, v20
    s_mov_b64 exec, 0xffff
    buffer_store_dword v176, v24, s[4:7], s55 offen sc1
    s_mov_b64 exec, -1
ch_nv0:
    v_mov_b32 v2, s40
    s_lshl_b32 s17, s12, 2
    s_add_u32 s17, s17, 128
    s_waitcnt vmcnt(0)
    s_barrier
    s_cmp_lg_u32 s3, 4
    s_cbranch_scc1 ch_nox
    s_mov_b64 exec, 1
    buffer_atomic_add v2, off, s[64:67], s17 sc1
    s_mov_b64 exec, -1
ch_nox:
    v_and_b32 v20, 63, v0
    v_lshlrev_b32 v0, 4, v20
    s_lshl_b32 s17, s15, 18
    s_lshl_b32 s18, s34, 7
    s_add_u32 s17, s17, s18
    s_lshl_b32 s19, s21, 13
    s_add_u32 s19, s19, 131072
    s_load_dwordx2 s[8:9], s[0:1], 40
    s_mov_b32 s10, 8388608
    s_mov_b32 s11, 131072
    v_lshrrev_b32 v21, 3, v20
    v_and_b32 v22, 7, v20
    v_lshlrev_b32 v21, 11, v21
    v_lshl_add_u32 v21, v22, 4, v21
    v_lshrrev_b32 v28, 4, v20
    v_and_b32 v29, 1, v28
    v_xor_b32 v29, 0, v29
    v_lshlrev_b32 v29, 2, v29
    v_lshl_add_u32 v29, v28, 3, v29
    v_bfe_u32 v28, v20, 2, 2
    v_add_u32 v29, v29, v28
    v_lshlrev_b32 v29, 7, v29
    v_and_b32 v28, 3, v20
    v_lshl_add_u32 v29, v28, 4, v29
    v_and_b32 v28, 1, v28
    v_xor_b32 v28, 0, v28
    v_lshl_add_u32 v24, v28, 3, v29
    v_add_u32 v24, s19, v24
    v_lshrrev_b32 v28, 4, v20
    v_and_b32 v29, 1, v28
    v_xor_b32 v29, 1, v29
    v_lshlrev_b32 v29, 2, v29
    v_lshl_add_u32 v29, v28, 3, v29
    v_bfe_u32 v28, v20, 2, 2
    v_add_u32 v29, v29, v28
    v_lshlrev_b32 v29, 7, v29
    v_and_b32 v28, 3, v20
    v_lshl_add_u32 v29, v28, 4, v29
    v_and_b32 v28, 1, v28
    v_xor_b32 v28, 0, v28
    v_lshl_add_u32 v25, v28, 3, v29
    v_add_u32 v25, s19, v25
    v_lshrrev_b32 v28, 4, v20
    v_and_b32 v29, 1, v28
    v_xor_b32 v29, 0, v29
    v_lshlrev_b32 v29, 2, v29
    v_lshl_add_u32 v29, v28, 3, v29
    v_bfe_u32 v28, v20, 2, 2
    v_add_u32 v29, v29, v28
    v_lshlrev_b32 v29, 7, v29
    v_and_b32 v28, 3, v20
    v_lshl_add_u32 v29, v28, 4, v29
    v_and_b32 v28, 1, v28
    v_xor_b32 v28, 1, v28
    v_lshl_add_u32 v26, v28, 3, v29
    v_add_u32 v26, s19, v26
    v_lshrrev_b32 v28, 4, v20
    v_and_b32 v29, 1, v28
    v_xor_b32 v29, 1, v29
    v_lshlrev_b32 v29, 2, v29
    v_lshl_add_u32 v29, v28, 3, v29
    v_bfe_u32 v28, v20, 2, 2
    v_add_u32 v29, v29, v28
    v_lshlrev_b32 v29, 7, v29
    v_and_b32 v28, 3, v20
    v_lshl_add_u32 v29, v28, 4, v29
    v_and_b32 v28, 1, v28
    v_xor_b32 v28, 1, v28
    v_lshl_add_u32 v27, v28, 3, v29
    v_add_u32 v27, s19, v27
    s_waitcnt lgkmcnt(0)
    s_add_u32 m0, s19, 0
    s_nop 0
    buffer_load_dwordx4 v21, s[8:11], s17 offen lds
    s_add_u32 s17, s17, 16384
    s_add_u32 m0, s19, 1024
    s_nop 0
    buffer_load_dwordx4 v21, s[8:11], s17 offen lds
    s_add_u32 s17, s17, 16384
    s_add_u32 m0, s19, 2048
    s_nop 0
    buffer_load_dwordx4 v21, s[8:11], s17 offen lds
    s_add_u32 s17, s17, 16384
    s_add_u32 m0, s19, 3072
    s_nop 0
    buffer_load_dwordx4 v21, s[8:11], s17 offen lds
    s_add_u32 s17, s17, 16384
    s_add_u32 m0, s19, 4096
    s_nop 0
    buffer_load_dwordx4 v21, s[8:11], s17 offen lds
    s_add_u32 s17, s17, 16384
    s_add_u32 m0, s19, 5120
    s_nop 0
    buffer_load_dwordx4 v21, s[8:11], s17 offen lds
    s_add_u32 s17, s17, 16384
    s_add_u32 m0, s19, 6144
    s_nop 0
    buffer_load_dwordx4 v21, s[8:11], s17 offen lds
    s_add_u32 s17, s17, 16384
    s_add_u32 m0, s19, 7168
    s_nop 0
    buffer_load_dwordx4 v21, s[8:11], s17 offen lds
    s_add_u32 s17, s17, 16384
    buffer_load_dwordx4 v[96:99], v21, s[8:11], s17 offen
    s_add_u32 s17, s17, 16384
    buffer_load_dwordx4 v[100:103], v21, s[8:11], s17 offen
    s_add_u32 s17, s17, 16384
    buffer_load_dwordx4 v[104:107], v21, s[8:11], s17 offen
    s_add_u32 s17, s17, 16384
    buffer_load_dwordx4 v[108:111], v21, s[8:11], s17 offen
    s_add_u32 s17, s17, 16384
    buffer_load_dwordx4 v[112:115], v21, s[8:11], s17 offen
    s_add_u32 s17, s17, 16384
    buffer_load_dwordx4 v[116:119], v21, s[8:11], s17 offen
    s_add_u32 s17, s17, 16384
    buffer_load_dwordx4 v[120:123], v21, s[8:11], s17 offen
    s_add_u32 s17, s17, 16384
    buffer_load_dwordx4 v[124:127], v21, s[8:11], s17 offen
    s_add_u32 s17, s17, 16384
    s_cmp_lg_u32 s54, 0
    s_cbranch_scc1 ch_nv1
    s_mov_b32 s58, -1
    s_mov_b32 s59, -1
    s_memtime s[60:61]
    s_add_u32 s56, s55, 0
    s_waitcnt lgkmcnt(0)
    s_load_dword s57, s[4:5], s56 glc
    s_waitcnt lgkmcnt(0)
    s_memtime s[62:63]
    s_waitcnt lgkmcnt(0)
    s_sub_u32 s57, s62, s60
    s_min_u32 s58, s58, s57
    s_memtime s[60:61]
    s_add_u32 s56, s55, 8192
    s_waitcnt lgkmcnt(0)
    s_load_dword s57, s[4:5], s56 glc
    s_waitcnt lgkmcnt(0)
    s_memtime s[62:63]
    s_waitcnt lgkmcnt(0)
    s_sub_u32 s57, s62, s60
    s_min_u32 s59, s59, s57
    s_memtime s[60:61]
    s_add_u32 s56, s55, 16384
    s_waitcnt lgkmcnt(0)
    s_load_dword s57, s[4:5], s56 glc
    s_waitcnt lgkmcnt(0)
    s_memtime s[62:63]
    s_waitcnt lgkmcnt(0)
    s_sub_u32 s57, s62, s60
    s_min_u32 s58, s58, s57
    s_memtime s[60:61]
    s_add_u32 s56, s55, 24576
    s_waitcnt lgkmcnt(0)
    s_load_dword s57, s[4:5], s56 glc
    s_waitcnt lgkmcnt(0)
    s_memtime s[62:63]
    s_waitcnt lgkmcnt(0)
    s_sub_u32 s57, s62, s60
    s_min_u32 s59, s59, s57
    s_memtime s[60:61]
    s_add_u32 s56, s55, 32768
    s_waitcnt lgkmcnt(0)
    s_load_dword s57, s[4:5], s56 glc
    s_waitcnt lgkmcnt(0)
    s_memtime s[62:63]
    s_waitcnt lgkmcnt(0)
    s_sub_u32 s57, s62, s60
    s_min_u32 s58, s58, s57
    s_memtime s[60:61]
    s_add_u32 s56, s55, 40960
    s_waitcnt lgkmcnt(0)
    s_load_dword s57, s[4:5], s56 glc
    s_waitcnt lgkmcnt(0)
    s_memtime s[62:63]
    s_waitcnt lgkmcnt(0)
    s_sub_u32 s57, s62, s60
    s_min_u32 s59, s59, s57
    s_memtime s[60:61]
    s_add_u32 s56, s55, 49152
    s_waitcnt lgkmcnt(0)
    s_load_dword s57, s[4:5], s56 glc
    s_waitcnt lgkmcnt(0)
    s_memtime s[62:63]
    s_waitcnt lgkmcnt(0)
    s_sub_u32 s57, s62, s60
    s_min_u32 s58, s58, s57
    s_memtime s[60:61]
    s_add_u32 s56, s55, 57344
    s_waitcnt lgkmcnt(0)
    s_load_dword s57, s[4:5], s56 glc
    s_waitcnt lgkmcnt(0)
    s_memtime s[62:63]
    s_waitcnt lgkmcnt(0)
    s_sub_u32 s57, s62, s60
    s_min_u32 s59, s59, s57
    s_memtime s[60:61]
    s_add_u32 s56, s55, 65536
    s_waitcnt lgkmcnt(0)
    s_load_dword s57, s[4:5], s56 glc
    s_waitcnt lgkmcnt(0)
    s_memtime s[62:63]
    s_waitcnt lgkmcnt(0)
    s_sub_u32 s57, s62, s60
    s_min_u32 s58, s58, s57
    s_memtime s[60:61]
    s_add_u32 s56, s55, 73728
    s_waitcnt lgkmcnt(0)
    s_load_dword s57, s[4:5], s56 glc
    s_waitcnt lgkmcnt(0)
    s_memtime s[62:63]
    s_waitcnt lgkmcnt(0)
    s_sub_u32 s57, s62, s60
    s_min_u32 s59, s59, s57
    s_memtime s[60:61]
    s_add_u32 s56, s55, 81920
    s_waitcnt lgkmcnt(0)
    s_load_dword s57, s[4:5], s56 glc
    s_waitcnt lgkmcnt(0)
    s_memtime s[62:63]
    s_waitcnt lgkmcnt(0)
    s_sub_u32 s57, s62, s60
    s_min_u32 s58, s58, s57
    s_memtime s[60:61]
    s_add_u32 s56, s55, 90112
    s_waitcnt lgkmcnt(0)
    s_load_dword s57, s[4:5], s56 glc
    s_waitcnt lgkmcnt(0)
    s_memtime s[62:63]
    s_waitcnt lgkmcnt(0)
    s_sub_u32 s57, s62, s60
    s_min_u32 s59, s59, s57
    s_memtime s[60:61]
    s_add_u32 s56, s55, 98304
    s_waitcnt lgkmcnt(0)
    s_load_dword s57, s[4:5], s56 glc
    s_waitcnt lgkmcnt(0)
    s_memtime s[62:63]
    s_waitcnt lgkmcnt(0)
    s_sub_u32 s57, s62, s60
    s_min_u32 s58, s58, s57
    s_memtime s[60:61]
    s_add_u32 s56, s55, 106496
    s_waitcnt lgkmcnt(0)
    s_load_dword s57, s[4:5], s56 glc
    s_waitcnt lgkmcnt(0)
    s_memtime s[62:63]
    s_waitcnt lgkmcnt(0)
    s_sub_u32 s57, s62, s60
    s_min_u32 s59, s59, s57
    s_memtime s[60:61]
    s_add_u32 s56, s55, 114688
    s_waitcnt lgkmcnt(0)
    s_load_dword s57, s[4:5], s56 glc
    s_waitcnt lgkmcnt(0)
    s_memtime s[62:63]
    s_waitcnt lgkmcnt(0)
    s_sub_u32 s57, s62, s60
    s_min_u32 s58, s58, s57
    s_memtime s[60:61]
    s_add_u32 s56, s55, 122880
    s_waitcnt lgkmcnt(0)
    s_load_dword s57, s[4:5], s56 glc
    s_waitcnt lgkmcnt(0)
    s_memtime s[62:63]
    s_waitcnt lgkmcnt(0)
    s_sub_u32 s57, s62, s60
    s_min_u32 s59, s59, s57
    s_sub_i32 s57, s58, s59
    s_min_i32 s57, s57, 400
    s_max_i32 s57, s57, -400
    s_add_u32 s57, s57, 16777616
    s_getreg_b32 s56, hwreg(HW_REG_XCC_ID)
    s_and_b32 s56, s56, 0
    v_mov_b32 v2, s57
    s_mov_b64 exec, 1
    buffer_atomic_add v2, off, s[64:67], s56 offset:160 sc1
    s_mov_b64 exec, -1
    s_waitcnt vmcnt(0)
ch_nv1:
    s_lshl_b32 s19, s21, 13
    s_add_u32 s19, s19, 131072
    v_add_u32 v30, s19, v0
    s_waitcnt vmcnt(8)
    ds_read_b64_tr_b16 v[192:193], v24 offset:0
    ds_read_b64_tr_b16 v[194:195], v25 offset:0
    ds_read_b64_tr_b16 v[208:209], v26 offset:0
    ds_read_b64_tr_b16 v[210:211], v27 offset:0
    ds_read_b64_tr_b16 v[224:225], v24 offset:64
    ds_read_b64_tr_b16 v[226:227], v25 offset:64
    ds_read_b64_tr_b16 v[240:241], v26 offset:64
    ds_read_b64_tr_b16 v[242:243], v27 offset:64
    s_waitcnt lgkmcnt(0)
    ds_read_b64_tr_b16 v[196:197], v24 offset:4096
    ds_read_b64_tr_b16 v[198:199], v25 offset:4096
    ds_read_b64_tr_b16 v[212:213], v26 offset:4096
    ds_read_b64_tr_b16 v[214:215], v27 offset:4096
    ds_read_b64_tr_b16 v[228:229], v24 offset:4160
    ds_read_b64_tr_b16 v[230:231], v25 offset:4160
    ds_read_b64_tr_b16 v[244:245], v26 offset:4160
    ds_read_b64_tr_b16 v[246:247], v27 offset:4160
    s_waitcnt lgkmcnt(0)
    s_waitcnt vmcnt(0)
    ds_write_b128 v30, v[96:99] offset:0
    ds_write_b128 v30, v[100:103] offset:1024
    ds_write_b128 v30, v[104:107] offset:2048
    ds_write_b128 v30, v[108:111] offset:3072
    ds_write_b128 v30, v[112:115] offset:4096
    ds_write_b128 v30, v[116:119] offset:5120
    ds_write_b128 v30, v[120:123] offset:6144
    ds_write_b128 v30, v[124:127] offset:7168
    s_waitcnt lgkmcnt(0)
    ds_read_b64_tr_b16 v[200:201], v24 offset:0
    ds_read_b64_tr_b16 v[202:203], v25 offset:0
    ds_read_b64_tr_b16 v[216:217], v26 offset:0
    ds_read_b64_tr_b16 v[218:219], v27 offset:0
    ds_read_b64_tr_b16 v[232:233], v24 offset:64
    ds_read_b64_tr_b16 v[234:235], v25 offset:64
    ds_read_b64_tr_b16 v[248:249], v26 offset:64
    ds_read_b64_tr_b16 v[250:251], v27 offset:64
    s_waitcnt lgkmcnt(0)
    ds_read_b64_tr_b16 v[204:205], v24 offset:4096
    ds_read_b64_tr_b16 v[206:207], v25 offset:4096
    ds_read_b64_tr_b16 v[220:221], v26 offset:4096
    ds_read_b64_tr_b16 v[222:223], v27 offset:4096
    ds_read_b64_tr_b16 v[236:237], v24 offset:4160
    ds_read_b64_tr_b16 v[238:239], v25 offset:4160
    ds_read_b64_tr_b16 v[252:253], v26 offset:4160
    ds_read_b64_tr_b16 v[254:255], v27 offset:4160
    s_waitcnt lgkmcnt(0)
    v_lshrrev_b32 v21, 4, v20
    v_and_b32 v22, 2, v20
    v_cmp_eq_u32 s[56:57], 2, v22
    v_and_b32 v23, 15, v20
    v_lshlrev_b32 v21, 2, v21
    v_mov_b32 v8, 0x44444444
    v_mov_b32 v9, 0xeeeeeeee
    v_cndmask_b32 v166, v8, v9, s[56:57]
    v_mov_b32 v8, 0x3f803f80
    v_mov_b32 v9, 0
    v_mov_b32 v10, 0
    v_mov_b32 v11, 0
    v_mov_b32 v4, 0x3f803f80
    v_mov_b32 v5, 0x3f803f80
    v_mov_b32 v6, 0x3f803f80
    v_mov_b32 v7, 0x3f803f80
    s_mov_b32 s29, 0x3e0293ee
    s_lshl_b32 s27, s13, 2
    s_add_u32 s27, s27, s21
    s_lshl_b32 s28, s12, 7
    s_add_u32 s28, s28, 218112000
    v_add_u32 v163, s42, v0
    s_lshl_b32 s17, s21, 2
    s_add_u32 s17, s17, 15872
    v_mov_b32 v164, s17
    v_mov_b32 v167, 15872
    v_and_b32 v24, 15, v20
    v_and_b32 v25, 1, v24
    v_lshlrev_b32 v25, 4, v25
    v_mov_b32 v184, 0x3f80
    v_lshlrev_b32 v25, v25, v184
    v_lshrrev_b32 v24, 1, v24
    v_cmp_eq_u32 vcc, 0, v24
    s_nop 1
    v_cndmask_b32 v184, 0, v25, vcc
    v_cmp_eq_u32 vcc, 1, v24
    s_nop 1
    v_cndmask_b32 v185, 0, v25, vcc
    v_cmp_eq_u32 vcc, 2, v24
    s_nop 1
    v_cndmask_b32 v186, 0, v25, vcc
    v_cmp_eq_u32 vcc, 3, v24
    s_nop 1
    v_cndmask_b32 v187, 0, v25, vcc
    v_add_u32 v24, 0, v21
    v_cmp_gt_u32 s[44:45], v24, v23
    v_add_u32 v24, 1, v21
    v_cmp_gt_u32 s[46:47], v24, v23
    v_add_u32 v24, 2, v21
    v_cmp_gt_u32 s[48:49], v24, v23
    v_add_u32 v24, 3, v21
    v_cmp_gt_u32 s[50:51], v24, v23
    s_cmp_lg_u32 s3, 4
    s_cbranch_scc1 ch_xcc_skip
    v_lshrrev_b32 v56, 2, v0
    v_add_u32 v56, 128, v56
    v_writelane_b32 v56, 0, 10
    v_mov_b32 v59, 63
    v_mov_b32 v60, 32
    v_writelane_b32 v59, 0, 8
    v_writelane_b32 v60, 0, 8
    v_writelane_b32 v59, 0, 9
    v_writelane_b32 v60, 0, 9
    v_writelane_b32 v59, -1, 10
    s_movk_i32 s17, 128
    v_writelane_b32 v60, s17, 10
    s_mov_b64 exec, 1807
ch_xcc:
    buffer_load_dword v57, v56, s[64:67], 0 offen sc1
    s_waitcnt vmcnt(0)
    v_and_b32 v62, v59, v57
    v_cmp_ne_u32 vcc, v62, v60
    v_readlane_b32 s18, v57, 8
    v_readlane_b32 s19, v57, 9
    s_add_u32 s17, s18, s19
    s_lshr_b32 s17, s17, 24
    s_cmp_lg_u32 s17, 32
    s_cbranch_scc1 ch_xcc_w
    s_cbranch_vccz ch_xcc_ok
ch_xcc_w:
    s_sleep 16
    s_sub_u32 s22, s22, 1
    s_cbranch_scc0 ch_xcc
    s_mov_b32 s22, 0
ch_xcc_ok:
    s_getreg_b32 s17, hwreg(HW_REG_XCC_ID)
    s_bitcmp1_b32 s17, 2
    s_cselect_b32 s18, s18, s18
    v_readlane_b32 s17, v57, s12
    s_mov_b64 exec, -1
    s_lshr_b32 s19, s18, 24
    s_mul_i32 s19, s19, 400
    s_and_b32 s18, s18, 0xffffff
    s_cmp_gt_u32 s18, s19
    s_cselect_b32 s18, 8192, 0
    v_mov_b32 v58, 15968
    v_mov_b32 v60, s17
    v_mov_b32 v61, s18
    s_barrier
    ds_write_b64 v58, v[60:61]
    s_waitcnt lgkmcnt(0)
    s_branch ch_xcc_b3
ch_xcc_skip:
    s_barrier
ch_xcc_b3:
    s_barrier
    v_mov_b32 v58, 15968
    ds_read_b64 v[60:61], v58
    v_and_b32 v23, 7, v20
    v_lshlrev_b32 v23, 7, v23
    v_bfe_u32 v24, v20, 3, 1
    v_lshl_add_u32 v23, v24, 17, v23
    v_lshrrev_b32 v24, 4, v20
    v_lshl_add_u32 v23, v24, 24, v23
    s_lshl_b32 s19, s14, 14
    s_lshl_b32 s18, s34, 10
    s_add_u32 s19, s19, s18
    s_and_b32 s18, s21, 1
    s_lshl_b32 s18, s18, 18
    s_add_u32 s19, s19, s18
    s_add_u32 s19, s19, 4456448
    s_waitcnt lgkmcnt(0)
    v_readfirstlane_b32 s17, v61
    s_add_u32 s39, s39, s17
ch_g0:
    buffer_load_dword v57, off, s[4:7], s35 sc1
    s_waitcnt vmcnt(0)
    v_readfirstlane_b32 s17, v57
    s_cmp_ge_u32 s17, 12
    s_cbranch_scc1 ch_g0b
    s_sleep 12
    s_sub_u32 s22, s22, 1
    s_cbranch_scc0 ch_g0
    s_mov_b32 s22, 0
ch_g0b:
    s_add_u32 m0, s42, 8192
    s_add_u32 s18, s41, 37748736
    buffer_load_dwordx4 v0, s[4:7], s18 offen offset:0 sc1 lds
    buffer_load_dwordx4 v0, s[4:7], s18 offen offset:1024 sc1 lds
    buffer_load_dwordx4 v0, s[4:7], s18 offen offset:2048 sc1 lds
    buffer_load_dwordx4 v0, s[4:7], s18 offen offset:3072 sc1 lds
    s_add_u32 m0, s42, 12288
    s_add_u32 s18, s41, 37879808
    buffer_load_dwordx4 v0, s[4:7], s18 offen offset:0 sc1 lds
    buffer_load_dwordx4 v0, s[4:7], s18 offen offset:1024 sc1 lds
    buffer_load_dwordx4 v0, s[4:7], s18 offen offset:2048 sc1 lds
    buffer_load_dwordx4 v0, s[4:7], s18 offen offset:3072 sc1 lds
    s_add_u32 m0, s42, 0
    s_add_u32 s18, s41, 20971520
    buffer_load_dwordx4 v0, s[4:7], s18 offen offset:0 sc1 lds
    buffer_load_dwordx4 v0, s[4:7], s18 offen offset:1024 sc1 lds
    buffer_load_dwordx4 v0, s[4:7], s18 offen offset:2048 sc1 lds
    buffer_load_dwordx4 v0, s[4:7], s18 offen offset:3072 sc1 lds
    s_add_u32 m0, s42, 4096
    s_add_u32 s18, s41, 21102592
    buffer_load_dwordx4 v0, s[4:7], s18 offen offset:0 sc1 lds
    buffer_load_dwordx4 v0, s[4:7], s18 offen offset:1024 sc1 lds
    buffer_load_dwordx4 v0, s[4:7], s18 offen offset:2048 sc1 lds
    buffer_load_dwordx4 v0, s[4:7], s18 offen offset:3072 sc1 lds
    s_mov_b32 exec_hi, 0xffff
    buffer_load_dword v175, v23, s[4:7], s19 offen sc1
    s_mov_b32 exec_hi, -1
    v_mov_b32 v165, 0
    s_waitcnt vmcnt(1)
    ds_write_b32 v164, v165 offset:16
.p2align 6
aloop_26:
    s_and_b32 s23, s16, 3
    s_lshl_b32 s23, s23, 18
    s_add_u32 s23, s23, s38
    s_add_u32 s24, s23, 4096
    s_and_b32 s25, s16, 3
    s_lshl_b32 s25, s25, 18
    s_add_u32 s25, s25, s39
    s_add_u32 s26, s16, 2
    s_and_b32 s26, s26, 3
    s_lshl_b32 s26, s26, 18
    s_add_u32 s26, s26, s39
    s_xor_b32 s30, s25, 0x2000
    v_mov_b32 v165, s16
aloop_26_wkv:
    ds_read_b32 v188, v164 offset:16
    s_waitcnt lgkmcnt(0)
    v_readfirstlane_b32 s19, v188
    s_cmp_ge_i32 s19, s16
    s_cbranch_scc1 aloop_26_wkvok
    s_sleep 1
    s_branch aloop_26_wkv
aloop_26_wkvok:
    ds_read_b128 v[128:131], v163 offset:8192
    ds_read_b128 v[144:147], v163 offset:12288
    ds_read_b128 v[132:135], v163 offset:9216
    ds_read_b128 v[148:151], v163 offset:13312
    ds_read_b128 v[136:139], v163 offset:10240
    ds_read_b128 v[152:155], v163 offset:14336
    ds_read_b128 v[140:143], v163 offset:11264
    ds_read_b128 v[156:159], v163 offset:15360
    ds_read_b128 v[96:99], v163 offset:0
    ds_read_b128 v[100:103], v163 offset:1024
    ds_read_b128 v[104:107], v163 offset:2048
    ds_read_b128 v[108:111], v163 offset:3072
    ds_read_b128 v[112:115], v163 offset:4096
    ds_read_b128 v[116:119], v163 offset:5120
    ds_read_b128 v[120:123], v163 offset:6144
    ds_read_b128 v[124:127], v163 offset:7168
    s_waitcnt lgkmcnt(14)
    v_mfma_f32_16x16x32_bf16 v[48:51], v[128:131], v[192:195], 0
    v_mfma_f32_16x16x32_bf16 v[52:55], v[128:131], v[208:211], 0
    v_mfma_f32_16x16x32_bf16 v[56:59], v[128:131], v[224:227], 0
    v_mfma_f32_16x16x32_bf16 v[60:63], v[128:131], v[240:243], 0
    v_mfma_f32_16x16x32_bf16 v[64:67], v[144:147], v[192:195], 0
    v_mfma_f32_16x16x32_bf16 v[68:71], v[144:147], v[208:211], 0
    v_mfma_f32_16x16x32_bf16 v[72:75], v[144:147], v[224:227], 0
    v_mfma_f32_16x16x32_bf16 v[76:79], v[144:147], v[240:243], 0
    s_setprio 2
aloop_26_wm:
    ds_read_b32 v188, v164 offset:32
    s_waitcnt lgkmcnt(0)
    v_readfirstlane_b32 s19, v188
    s_cmp_ge_i32 s19, s16
    s_cbranch_scc1 aloop_26_wmok
    s_sleep 1
    s_branch aloop_26_wm
aloop_26_wmok:
    s_add_u32 m0, s42, 16384
    s_add_u32 s17, s41, 4194304
    buffer_load_dwordx4 v0, s[4:7], s17 offen offset:0 sc1 lds
    buffer_load_dwordx4 v0, s[4:7], s17 offen offset:1024 sc1 lds
    buffer_load_dwordx4 v0, s[4:7], s17 offen offset:2048 sc1 lds
    buffer_load_dwordx4 v0, s[4:7], s17 offen offset:3072 sc1 lds
    s_add_u32 m0, s42, 20480
    s_add_u32 s17, s41, 4325376
    buffer_load_dwordx4 v0, s[4:7], s17 offen offset:0 sc1 lds
    buffer_load_dwordx4 v0, s[4:7], s17 offen offset:1024 sc1 lds
    buffer_load_dwordx4 v0, s[4:7], s17 offen offset:2048 sc1 lds
    buffer_load_dwordx4 v0, s[4:7], s17 offen offset:3072 sc1 lds
    s_add_u32 s41, s41, 262144
    s_barrier
    s_waitcnt lgkmcnt(12)
    v_mfma_f32_16x16x32_bf16 v[48:51], v[132:135], v[196:199], v[48:51]
    v_mfma_f32_16x16x32_bf16 v[52:55], v[132:135], v[212:215], v[52:55]
    v_mfma_f32_16x16x32_bf16 v[56:59], v[132:135], v[228:231], v[56:59]
    v_mfma_f32_16x16x32_bf16 v[60:63], v[132:135], v[244:247], v[60:63]
    v_mfma_f32_16x16x32_bf16 v[64:67], v[148:151], v[196:199], v[64:67]
    v_mfma_f32_16x16x32_bf16 v[68:71], v[148:151], v[212:215], v[68:71]
    v_mfma_f32_16x16x32_bf16 v[72:75], v[148:151], v[228:231], v[72:75]
    v_mfma_f32_16x16x32_bf16 v[76:79], v[148:151], v[244:247], v[76:79]
    s_waitcnt lgkmcnt(10)
    v_mfma_f32_16x16x32_bf16 v[48:51], v[136:139], v[200:203], v[48:51]
    v_mfma_f32_16x16x32_bf16 v[52:55], v[136:139], v[216:219], v[52:55]
    v_mfma_f32_16x16x32_bf16 v[56:59], v[136:139], v[232:235], v[56:59]
    v_mfma_f32_16x16x32_bf16 v[60:63], v[136:139], v[248:251], v[60:63]
    v_mfma_f32_16x16x32_bf16 v[64:67], v[152:155], v[200:203], v[64:67]
    v_mfma_f32_16x16x32_bf16 v[68:71], v[152:155], v[216:219], v[68:71]
    v_mfma_f32_16x16x32_bf16 v[72:75], v[152:155], v[232:235], v[72:75]
    v_mfma_f32_16x16x32_bf16 v[76:79], v[152:155], v[248:251], v[76:79]
    s_waitcnt lgkmcnt(8)
    v_mfma_f32_16x16x32_bf16 v[48:51], v[140:143], v[204:207], v[48:51]
    v_mfma_f32_16x16x32_bf16 v[52:55], v[140:143], v[220:223], v[52:55]
    v_mfma_f32_16x16x32_bf16 v[56:59], v[140:143], v[236:239], v[56:59]
    v_mfma_f32_16x16x32_bf16 v[60:63], v[140:143], v[252:255], v[60:63]
    v_mfma_f32_16x16x32_bf16 v[64:67], v[156:159], v[204:207], v[64:67]
    v_mfma_f32_16x16x32_bf16 v[68:71], v[156:159], v[220:223], v[68:71]
    v_mfma_f32_16x16x32_bf16 v[72:75], v[156:159], v[236:239], v[72:75]
    v_mfma_f32_16x16x32_bf16 v[76:79], v[156:159], v[252:255], v[76:79]
    s_nop 2
    v_cvt_pk_bf16_f32 v80, v48, v49
    v_cvt_pk_bf16_f32 v81, v50, v51
    v_cvt_pk_bf16_f32 v82, v64, v65
    v_cvt_pk_bf16_f32 v83, v66, v67
    v_cvt_pk_bf16_f32 v84, v52, v53
    v_cvt_pk_bf16_f32 v85, v54, v55
    v_cvt_pk_bf16_f32 v86, v68, v69
    v_cvt_pk_bf16_f32 v87, v70, v71
    v_cvt_pk_bf16_f32 v88, v56, v57
    v_cvt_pk_bf16_f32 v89, v58, v59
    v_cvt_pk_bf16_f32 v90, v72, v73
    v_cvt_pk_bf16_f32 v91, v74, v75
    v_cvt_pk_bf16_f32 v92, v60, v61
    v_cvt_pk_bf16_f32 v93, v62, v63
    v_cvt_pk_bf16_f32 v94, v76, v77
    v_cvt_pk_bf16_f32 v95, v78, v79
    v_mov_b32 v24, 0
    v_mov_b32 v25, 0
    v_mov_b32 v26, 0
    v_mov_b32 v27, 0
    v_mov_b32 v28, 0
    v_mov_b32 v29, 0
    v_mov_b32 v30, 0
    v_mov_b32 v31, 0
    v_mov_b32 v32, 0
    v_mov_b32 v33, 0
    v_mov_b32 v34, 0
    v_mov_b32 v35, 0
    v_mov_b32 v36, 0
    v_mov_b32 v37, 0
    v_mov_b32 v38, 0
    v_mov_b32 v39, 0
    s_waitcnt lgkmcnt(0)
    buffer_load_dwordx4 v[48:51], v0, s[4:7], s23 offen offset:0 sc1
    buffer_load_dwordx4 v[52:55], v0, s[4:7], s23 offen offset:1024 sc1
    buffer_load_dwordx4 v[56:59], v0, s[4:7], s23 offen offset:2048 sc1
    buffer_load_dwordx4 v[60:63], v0, s[4:7], s23 offen offset:3072 sc1
    s_sleep 2
    buffer_load_dwordx4 v[64:67], v0, s[4:7], s24 offen offset:0 sc1
    buffer_load_dwordx4 v[68:71], v0, s[4:7], s24 offen offset:1024 sc1
    s_waitcnt vmcnt(5)
    v_mfma_f32_16x16x32_bf16 v[12:15], v[96:99], v[48:51], 0
    v_mfma_f32_16x16x32_bf16 v[16:19], v[112:115], v[48:51], 0
    v_max_u32 v3, v48, v50
    v_cmp_eq_u32 vcc, -1, v3
    v_mfma_f32_16x16x32_bf16 v[20:23], v[48:51], v[48:51], 0
    s_cbranch_vccnz arq_27_0
    s_waitcnt vmcnt(4)
    v_mfma_f32_16x16x32_bf16 v[12:15], v[100:103], v[52:55], v[12:15]
    v_mfma_f32_16x16x32_bf16 v[16:19], v[116:119], v[52:55], v[16:19]
    v_max_u32 v3, v52, v54
    v_cmp_eq_u32 vcc, -1, v3
    v_mfma_f32_16x16x32_bf16 v[20:23], v[52:55], v[52:55], v[20:23]
    s_cbranch_vccnz arq_27_1
    s_waitcnt vmcnt(3)
    v_mfma_f32_16x16x32_bf16 v[12:15], v[104:107], v[56:59], v[12:15]
    v_mfma_f32_16x16x32_bf16 v[16:19], v[120:123], v[56:59], v[16:19]
    v_max_u32 v3, v56, v58
    v_cmp_eq_u32 vcc, -1, v3
    v_mfma_f32_16x16x32_bf16 v[20:23], v[56:59], v[56:59], v[20:23]
    s_cbranch_vccnz arq_27_2
    s_waitcnt vmcnt(2)
    v_mfma_f32_16x16x32_bf16 v[12:15], v[108:111], v[60:63], v[12:15]
    v_mfma_f32_16x16x32_bf16 v[16:19], v[124:127], v[60:63], v[16:19]
    v_max_u32 v3, v60, v62
    v_cmp_eq_u32 vcc, -1, v3
    v_mfma_f32_16x16x32_bf16 v[20:23], v[60:63], v[60:63], v[20:23]
    s_cbranch_vccnz arq_27_3
aloop_26_sdone:
    s_cmp_eq_u32 s16, 63
    s_cbranch_scc1 aloop_26_lsk
    ds_write_b32 v164, v165
    s_nop 0
    v_max3_f32 v2, v12, v13, v14
    v_max3_f32 v3, v15, v16, v17
    v_max3_f32 v2, v2, v18, v19
    v_max3_f32 v3, v3, v20, v21
    v_max_f32 v2, v2, v3
    v_mov_b32 v3, v2
    s_nop 1
    v_permlane16_swap_b32 v3, v2
    v_max_f32 v2, v2, v3
    v_mov_b32 v3, v2
    s_waitcnt vmcnt(0)
    v_max3_u32 v188, v64, v66, v68
    v_permlane32_swap_b32 v3, v2
    v_max_f32 v2, v2, v3
    v_max_u32 v188, v188, v70
    v_mul_f32 v2, s29, v2
    v_cmp_eq_u32 vcc, -1, v188
    v_fma_f32 v12, v12, s29, -v2
    v_fma_f32 v13, v13, s29, -v2
    s_cbranch_vccnz arq_27_v
aloop_26_vok:
    v_smfmac_f32_16x16x64_bf16 v[24:27], v[64:67], v[192:199], v166
    v_fma_f32 v14, v14, s29, -v2
    v_exp_f32 v12, v12
    v_smfmac_f32_16x16x64_bf16 v[32:35], v[64:67], v[224:231], v166
    v_fma_f32 v15, v15, s29, -v2
    v_exp_f32 v13, v13
    v_smfmac_f32_16x16x64_bf16 v[28:31], v[64:67], v[208:215], v166
    v_fma_f32 v16, v16, s29, -v2
    v_exp_f32 v14, v14
    v_smfmac_f32_16x16x64_bf16 v[36:39], v[64:67], v[240:247], v166
    v_fma_f32 v17, v17, s29, -v2
    v_exp_f32 v15, v15
    v_smfmac_f32_16x16x64_bf16 v[24:27], v[68:71], v[200:207], v166
    v_fma_f32 v18, v18, s29, -v2
    v_exp_f32 v16, v16
    v_smfmac_f32_16x16x64_bf16 v[32:35], v[68:71], v[232:239], v166
    v_fma_f32 v19, v19, s29, -v2
    v_exp_f32 v17, v17
    v_smfmac_f32_16x16x64_bf16 v[28:31], v[68:71], v[216:223], v166
    v_fma_f32 v20, v20, s29, -v2
    v_exp_f32 v18, v18
    v_smfmac_f32_16x16x64_bf16 v[36:39], v[68:71], v[248:255], v166
    v_fma_f32 v21, v21, s29, -v2
    v_exp_f32 v19, v19
    v_exp_f32 v20, v20
    v_exp_f32 v21, v21
    v_cvt_pk_bf16_f32 v12, v12, v13
    v_cvt_pk_bf16_f32 v13, v14, v15
    v_cvt_pk_bf16_f32 v14, v16, v17
    v_cvt_pk_bf16_f32 v15, v18, v19
    v_cvt_pk_bf16_f32 v20, v20, v21
    v_mov_b32 v22, 0
    v_mfma_f32_16x16x32_bf16 v[16:19], v[4:7], v[12:15], 0
    v_mov_b32 v21, v20
    v_mov_b32 v23, 0
    v_cvt_pk_bf16_f32 v40, v24, v25
    v_cvt_pk_bf16_f32 v41, v26, v27
    v_mfma_f32_16x16x32_bf16 v[16:19], v[8:11], v[20:23], v[16:19]
    v_mfma_f32_16x16x32_bf16 v[24:27], v[80:83], v[12:15], 0
    v_cvt_pk_bf16_f32 v44, v32, v33
    v_cvt_pk_bf16_f32 v45, v34, v35
    v_mfma_f32_16x16x32_bf16 v[32:35], v[88:91], v[12:15], 0
    v_cvt_pk_bf16_f32 v42, v28, v29
    v_cvt_pk_bf16_f32 v43, v30, v31
    v_mfma_f32_16x16x32_bf16 v[28:31], v[84:87], v[12:15], 0
    v_cvt_pk_bf16_f32 v46, v36, v37
    v_cvt_pk_bf16_f32 v47, v38, v39
    v_mfma_f32_16x16x32_bf16 v[36:39], v[92:95], v[12:15], 0
    s_mov_b64 vcc, s[56:57]
    v_rcp_f32 v3, v16
    v_mfma_f32_16x16x32_bf16 v[24:27], v[40:43], v[20:23], v[24:27]
    v_mfma_f32_16x16x32_bf16 v[32:35], v[44:47], v[20:23], v[32:35]
    v_mfma_f32_16x16x32_bf16 v[28:31], v[42:45], v[20:23], v[28:31]
    v_mfma_f32_16x16x32_bf16 v[36:39], v[46:49], v[20:23], v[36:39]
    v_mov_b32_dpp v3, v3 quad_perm:[2,3,2,3] row_mask:0xf bank_mask:0xf
    s_nop 4
    v_cndmask_b32_dpp v24, v32, v24, vcc quad_perm:[2,3,2,3] row_mask:0xf bank_mask:0xf
    v_cndmask_b32_dpp v25, v33, v25, vcc quad_perm:[2,3,2,3] row_mask:0xf bank_mask:0xf
    v_cndmask_b32_dpp v26, v34, v26, vcc quad_perm:[2,3,2,3] row_mask:0xf bank_mask:0xf
    v_cndmask_b32_dpp v27, v35, v27, vcc quad_perm:[2,3,2,3] row_mask:0xf bank_mask:0xf
    v_cndmask_b32_dpp v28, v36, v28, vcc quad_perm:[2,3,2,3] row_mask:0xf bank_mask:0xf
    v_cndmask_b32_dpp v29, v37, v29, vcc quad_perm:[2,3,2,3] row_mask:0xf bank_mask:0xf
    v_cndmask_b32_dpp v30, v38, v30, vcc quad_perm:[2,3,2,3] row_mask:0xf bank_mask:0xf
    v_cndmask_b32_dpp v31, v39, v31, vcc quad_perm:[2,3,2,3] row_mask:0xf bank_mask:0xf
    v_mul_f32 v24, v24, v3
    v_mul_f32 v25, v25, v3
    v_mul_f32 v26, v26, v3
    v_mul_f32 v27, v27, v3
    v_mul_f32 v28, v28, v3
    v_mul_f32 v29, v29, v3
    v_mul_f32 v30, v30, v3
    v_mul_f32 v31, v31, v3
    v_cvt_pk_bf16_f32 v168, v24, v25
    v_cvt_pk_bf16_f32 v169, v26, v27
    v_cvt_pk_bf16_f32 v170, v28, v29
    v_cvt_pk_bf16_f32 v171, v30, v31
    ds_write_b128 v160, v[168:171]
    s_waitcnt lgkmcnt(0)
    s_barrier
    ds_read_b128 v[172:175], v161
    s_waitcnt lgkmcnt(0)
    v_mfma_f32_16x16x32_bf16 v[24:27], v[184:187], v[172:175], 0
    s_nop 7
    v_cvt_pk_bf16_f32 v168, v24, v25
    v_cvt_pk_bf16_f32 v169, v26, v27
    s_nop 0
    v_permlane16_swap_b32 v168, v170
    v_permlane16_swap_b32 v169, v171
    s_mov_b64 exec, 0xffff
    v_min_u32 v168, -2, v168
    buffer_store_dwordx4 v[168:171], v1, s[4:7], s25 offen sc1
    s_setprio 0
    buffer_store_dwordx4 v[176:179], v1, s[4:7], s26 offen sc1
    s_mov_b64 exec, -1
    s_cmp_lg_u32 s27, 0
    s_cbranch_scc1 pg_28
    s_sub_u32 s21, s16, 1
    s_cbranch_scc1 pg_28
    s_and_b32 s17, s16, 7
    s_cmp_ge_u32 s16, 58
    s_cselect_b32 s17, 0, s17
    s_cmp_lg_u32 s17, 0
    s_cbranch_scc1 pg_28
    v_mov_b32 v3, s21
    s_mov_b64 exec, 1
    buffer_store_dword v3, off, s[4:7], s28 sc1
    s_mov_b64 exec, -1
pg_28:
aloop_26_lskb:
    v_mov_b32 v64, 0xff61b1e6
    ds_read_b128 v[128:131], v163 offset:16384
    ds_read_b128 v[132:135], v163 offset:17408
    ds_read_b128 v[136:139], v163 offset:18432
    ds_read_b128 v[140:143], v163 offset:19456
    ds_read_b128 v[144:147], v163 offset:20480
    ds_read_b128 v[148:151], v163 offset:21504
    ds_read_b128 v[152:155], v163 offset:22528
    ds_read_b128 v[156:159], v163 offset:23552
    s_waitcnt lgkmcnt(4)
    v_mfma_f32_16x16x32_bf16 v[12:15], v[96:99], v[128:131], 0
    v_mfma_f32_16x16x32_bf16 v[20:23], v[48:51], v[128:131], 0
    v_mfma_f32_16x16x32_bf16 v[12:15], v[100:103], v[132:135], v[12:15]
    v_mfma_f32_16x16x32_bf16 v[20:23], v[52:55], v[132:135], v[20:23]
    v_mfma_f32_16x16x32_bf16 v[12:15], v[104:107], v[136:139], v[12:15]
    v_mfma_f32_16x16x32_bf16 v[20:23], v[56:59], v[136:139], v[20:23]
    v_mfma_f32_16x16x32_bf16 v[12:15], v[108:111], v[140:143], v[12:15]
    v_mfma_f32_16x16x32_bf16 v[20:23], v[60:63], v[140:143], v[20:23]
    s_waitcnt lgkmcnt(0)
    v_mfma_f32_16x16x32_bf16 v[68:71], v[96:99], v[144:147], 0
    v_mfma_f32_16x16x32_bf16 v[72:75], v[112:115], v[144:147], 0
    v_mfma_f32_16x16x32_bf16 v[76:79], v[48:51], v[144:147], 0
    v_mfma_f32_16x16x32_bf16 v[68:71], v[100:103], v[148:151], v[68:71]
    v_mfma_f32_16x16x32_bf16 v[72:75], v[116:119], v[148:151], v[72:75]
    v_mfma_f32_16x16x32_bf16 v[76:79], v[52:55], v[148:151], v[76:79]
    v_mfma_f32_16x16x32_bf16 v[68:71], v[104:107], v[152:155], v[68:71]
    v_mfma_f32_16x16x32_bf16 v[72:75], v[120:123], v[152:155], v[72:75]
    v_mfma_f32_16x16x32_bf16 v[76:79], v[56:59], v[152:155], v[76:79]
    v_mfma_f32_16x16x32_bf16 v[68:71], v[108:111], v[156:159], v[68:71]
    v_mfma_f32_16x16x32_bf16 v[72:75], v[124:127], v[156:159], v[72:75]
    v_mfma_f32_16x16x32_bf16 v[76:79], v[60:63], v[156:159], v[76:79]
    v_cndmask_b32 v12, v12, v64, s[44:45]
    v_cndmask_b32 v13, v13, v64, s[46:47]
    v_cndmask_b32 v14, v14, v64, s[48:49]
    v_cndmask_b32 v15, v15, v64, s[50:51]
    v_max3_f32 v2, v12, v13, v14
    v_max3_f32 v3, v15, v20, v21
    v_max_f32 v2, v2, v3
    v_mov_b32 v3, v2
    s_nop 1
    v_permlane16_swap_b32 v3, v2
    v_max_f32 v2, v2, v3
    v_mov_b32 v3, v2
    s_nop 1
    v_permlane32_swap_b32 v3, v2
    v_max_f32 v2, v2, v3
    v_mul_f32 v2, s29, v2
    v_fma_f32 v12, v12, s29, -v2
    v_fma_f32 v13, v13, s29, -v2
    v_fma_f32 v14, v14, s29, -v2
    v_exp_f32 v12, v12
    v_fma_f32 v15, v15, s29, -v2
    v_exp_f32 v13, v13
    v_fma_f32 v20, v20, s29, -v2
    v_exp_f32 v14, v14
    v_fma_f32 v21, v21, s29, -v2
    v_exp_f32 v15, v15
    v_exp_f32 v20, v20
    v_exp_f32 v21, v21
    v_cvt_pk_bf16_f32 v12, v12, v13
    v_cvt_pk_bf16_f32 v13, v14, v15
    v_mov_b32 v14, 0
    v_mov_b32 v15, 0
    v_cvt_pk_bf16_f32 v20, v20, v21
    v_mov_b32 v22, 0
    v_mov_b32 v21, v20
    v_mov_b32 v23, 0
    s_nop 1
    v_cndmask_b32 v72, v72, v64, s[44:45]
    v_mfma_f32_16x16x32_bf16 v[16:19], v[4:7], v[12:15], 0
    v_cndmask_b32 v73, v73, v64, s[46:47]
    v_cndmask_b32 v74, v74, v64, s[48:49]
    v_mfma_f32_16x16x32_bf16 v[16:19], v[8:11], v[20:23], v[16:19]
    v_cndmask_b32 v75, v75, v64, s[50:51]
    v_max3_f32 v2, v68, v69, v70
    v_mfma_f32_16x16x32_bf16 v[24:27], v[80:83], v[12:15], 0
    v_max3_f32 v3, v71, v72, v73
    v_max3_f32 v2, v2, v74, v75
    v_mfma_f32_16x16x32_bf16 v[24:27], v[40:43], v[20:23], v[24:27]
    v_max3_f32 v3, v3, v76, v77
    v_max_f32 v2, v2, v3
    v_mfma_f32_16x16x32_bf16 v[28:31], v[84:87], v[12:15], 0
    v_mov_b32 v3, v2
    s_nop 1
    v_mfma_f32_16x16x32_bf16 v[28:31], v[42:45], v[20:23], v[28:31]
    v_permlane16_swap_b32 v3, v2
    v_max_f32 v2, v2, v3
    v_mfma_f32_16x16x32_bf16 v[32:35], v[88:91], v[12:15], 0
    v_mov_b32 v3, v2
    s_nop 1
    v_mfma_f32_16x16x32_bf16 v[32:35], v[44:47], v[20:23], v[32:35]
    v_permlane32_swap_b32 v3, v2
    v_max_f32 v2, v2, v3
    v_mfma_f32_16x16x32_bf16 v[36:39], v[92:95], v[12:15], 0
    v_mul_f32 v2, s29, v2
    v_fma_f32 v68, v68, s29, -v2
    v_mfma_f32_16x16x32_bf16 v[36:39], v[46:49], v[20:23], v[36:39]
    v_fma_f32 v69, v69, s29, -v2
    v_fma_f32 v70, v70, s29, -v2
    v_exp_f32 v68, v68
    v_fma_f32 v71, v71, s29, -v2
    v_exp_f32 v69, v69
    v_fma_f32 v72, v72, s29, -v2
    v_exp_f32 v70, v70
    v_fma_f32 v73, v73, s29, -v2
    v_exp_f32 v71, v71
    v_fma_f32 v74, v74, s29, -v2
    v_exp_f32 v72, v72
    v_fma_f32 v75, v75, s29, -v2
    v_exp_f32 v73, v73
    v_fma_f32 v76, v76, s29, -v2
    v_exp_f32 v74, v74
    v_fma_f32 v77, v77, s29, -v2
    v_exp_f32 v75, v75
    v_exp_f32 v76, v76
    v_exp_f32 v77, v77
    v_cvt_pk_bf16_f32 v68, v68, v69
    v_cvt_pk_bf16_f32 v69, v70, v71
    v_cvt_pk_bf16_f32 v70, v72, v73
    v_cvt_pk_bf16_f32 v71, v74, v75
    v_cvt_pk_bf16_f32 v76, v76, v77
    v_mov_b32 v78, 0
    v_mov_b32 v77, v76
    v_mov_b32 v79, 0
    v_rcp_f32 v66, v16
    s_nop 0
    v_mul_f32 v24, v24, v66
    v_mul_f32 v25, v25, v66
    v_mul_f32 v26, v26, v66
    v_mul_f32 v27, v27, v66
    v_cvt_pk_bf16_f32 v168, v24, v25
    v_cvt_pk_bf16_f32 v169, v26, v27
    v_mul_f32 v28, v28, v66
    v_mul_f32 v29, v29, v66
    v_mul_f32 v30, v30, v66
    v_mul_f32 v31, v31, v66
    v_cvt_pk_bf16_f32 v170, v28, v29
    v_cvt_pk_bf16_f32 v171, v30, v31
    v_mul_f32 v32, v32, v66
    v_mul_f32 v33, v33, v66
    v_mul_f32 v34, v34, v66
    v_mul_f32 v35, v35, v66
    v_cvt_pk_bf16_f32 v172, v32, v33
    v_cvt_pk_bf16_f32 v173, v34, v35
    v_mul_f32 v36, v36, v66
    v_mul_f32 v37, v37, v66
    v_mul_f32 v38, v38, v66
    v_mul_f32 v39, v39, v66
    v_cvt_pk_bf16_f32 v174, v36, v37
    v_cvt_pk_bf16_f32 v175, v38, v39
    ds_write_b128 v162, v[168:171] offset:0
    ds_write_b128 v162, v[172:175] offset:2048
    v_mfma_f32_16x16x32_bf16 v[72:75], v[4:7], v[68:71], 0
    v_mfma_f32_16x16x32_bf16 v[72:75], v[8:11], v[76:79], v[72:75]
    v_mfma_f32_16x16x32_bf16 v[24:27], v[80:83], v[68:71], 0
    v_mfma_f32_16x16x32_bf16 v[24:27], v[40:43], v[76:79], v[24:27]
    v_mfma_f32_16x16x32_bf16 v[28:31], v[84:87], v[68:71], 0
    v_mfma_f32_16x16x32_bf16 v[28:31], v[42:45], v[76:79], v[28:31]
    v_mfma_f32_16x16x32_bf16 v[32:35], v[88:91], v[68:71], 0
    v_mfma_f32_16x16x32_bf16 v[32:35], v[44:47], v[76:79], v[32:35]
    v_mfma_f32_16x16x32_bf16 v[36:39], v[92:95], v[68:71], 0
    v_mfma_f32_16x16x32_bf16 v[36:39], v[46:49], v[76:79], v[36:39]
    v_rcp_f32 v3, v72
    s_nop 0
    v_mul_f32 v24, v24, v3
    v_mul_f32 v25, v25, v3
    v_mul_f32 v26, v26, v3
    v_mul_f32 v27, v27, v3
    v_cvt_pk_bf16_f32 v168, v24, v25
    v_cvt_pk_bf16_f32 v169, v26, v27
    v_mul_f32 v28, v28, v3
    v_mul_f32 v29, v29, v3
    v_mul_f32 v30, v30, v3
    v_mul_f32 v31, v31, v3
    v_cvt_pk_bf16_f32 v170, v28, v29
    v_cvt_pk_bf16_f32 v171, v30, v31
    v_mul_f32 v32, v32, v3
    v_mul_f32 v33, v33, v3
    v_mul_f32 v34, v34, v3
    v_mul_f32 v35, v35, v3
    v_cvt_pk_bf16_f32 v172, v32, v33
    v_cvt_pk_bf16_f32 v173, v34, v35
    v_mul_f32 v36, v36, v3
    v_mul_f32 v37, v37, v3
    v_mul_f32 v38, v38, v3
    v_mul_f32 v39, v39, v3
    v_cvt_pk_bf16_f32 v174, v36, v37
    v_cvt_pk_bf16_f32 v175, v38, v39
    ds_write_b128 v162, v[168:171] offset:256
    ds_write_b128 v162, v[172:175] offset:2304
    v_xor_b32 v162, 0x4000, v162
    s_add_u32 s16, s16, 1
    s_cmp_le_u32 s16, 63
    s_cbranch_scc1 aloop_26
    s_waitcnt lgkmcnt(0)
    s_barrier
    s_waitcnt vmcnt(0)
    s_branch k_end
arq_27_0:
    s_sub_u32 s22, s22, 1
    s_cbranch_scc1 arq_27_0_g
    buffer_load_dwordx4 v[48:51], v0, s[4:7], s23 offen offset:0 sc1
    buffer_load_dwordx4 v[52:55], v0, s[4:7], s23 offen offset:1024 sc1
    buffer_load_dwordx4 v[56:59], v0, s[4:7], s23 offen offset:2048 sc1
    buffer_load_dwordx4 v[60:63], v0, s[4:7], s23 offen offset:3072 sc1
    buffer_load_dwordx4 v[64:67], v0, s[4:7], s24 offen offset:0 sc1
    buffer_load_dwordx4 v[68:71], v0, s[4:7], s24 offen offset:1024 sc1
    s_waitcnt vmcnt(5)
    v_max_u32 v3, v48, v50
    v_cmp_eq_u32 vcc, -1, v3
    s_cbranch_vccnz arq_27_0
    s_branch aloop_26_again
arq_27_0_g:
    s_mov_b32 s22, 0
    s_waitcnt vmcnt(0)
    s_branch aloop_26_nochk
arq_27_1:
    s_sub_u32 s22, s22, 1
    s_cbranch_scc1 arq_27_1_g
    buffer_load_dwordx4 v[52:55], v0, s[4:7], s23 offen offset:1024 sc1
    buffer_load_dwordx4 v[56:59], v0, s[4:7], s23 offen offset:2048 sc1
    buffer_load_dwordx4 v[60:63], v0, s[4:7], s23 offen offset:3072 sc1
    buffer_load_dwordx4 v[64:67], v0, s[4:7], s24 offen offset:0 sc1
    buffer_load_dwordx4 v[68:71], v0, s[4:7], s24 offen offset:1024 sc1
    s_waitcnt vmcnt(4)
    v_max_u32 v3, v52, v54
    v_cmp_eq_u32 vcc, -1, v3
    s_cbranch_vccnz arq_27_1
    s_branch aloop_26_again
arq_27_1_g:
    s_mov_b32 s22, 0
    s_waitcnt vmcnt(0)
    s_branch aloop_26_nochk
arq_27_2:
    s_sub_u32 s22, s22, 1
    s_cbranch_scc1 arq_27_2_g
    buffer_load_dwordx4 v[56:59], v0, s[4:7], s23 offen offset:2048 sc1
    buffer_load_dwordx4 v[60:63], v0, s[4:7], s23 offen offset:3072 sc1
    buffer_load_dwordx4 v[64:67], v0, s[4:7], s24 offen offset:0 sc1
    buffer_load_dwordx4 v[68:71], v0, s[4:7], s24 offen offset:1024 sc1
    s_waitcnt vmcnt(3)
    v_max_u32 v3, v56, v58
    v_cmp_eq_u32 vcc, -1, v3
    s_cbranch_vccnz arq_27_2
    s_branch aloop_26_again
arq_27_2_g:
    s_mov_b32 s22, 0
    s_waitcnt vmcnt(0)
    s_branch aloop_26_nochk
arq_27_3:
    s_sub_u32 s22, s22, 1
    s_cbranch_scc1 arq_27_3_g
    buffer_load_dwordx4 v[60:63], v0, s[4:7], s23 offen offset:3072 sc1
    buffer_load_dwordx4 v[64:67], v0, s[4:7], s24 offen offset:0 sc1
    buffer_load_dwordx4 v[68:71], v0, s[4:7], s24 offen offset:1024 sc1
    s_waitcnt vmcnt(2)
    v_max_u32 v3, v60, v62
    v_cmp_eq_u32 vcc, -1, v3
    s_cbranch_vccnz arq_27_3
    s_branch aloop_26_again
arq_27_3_g:
    s_mov_b32 s22, 0
    s_waitcnt vmcnt(0)
    s_branch aloop_26_nochk
aloop_26_again:
    s_waitcnt vmcnt(5)
    v_mfma_f32_16x16x32_bf16 v[12:15], v[96:99], v[48:51], 0
    v_mfma_f32_16x16x32_bf16 v[16:19], v[112:115], v[48:51], 0
    v_max_u32 v3, v48, v50
    v_cmp_eq_u32 vcc, -1, v3
    v_mfma_f32_16x16x32_bf16 v[20:23], v[48:51], v[48:51], 0
    s_cbranch_vccnz arq_27_0
    s_waitcnt vmcnt(4)
    v_mfma_f32_16x16x32_bf16 v[12:15], v[100:103], v[52:55], v[12:15]
    v_mfma_f32_16x16x32_bf16 v[16:19], v[116:119], v[52:55], v[16:19]
    v_max_u32 v3, v52, v54
    v_cmp_eq_u32 vcc, -1, v3
    v_mfma_f32_16x16x32_bf16 v[20:23], v[52:55], v[52:55], v[20:23]
    s_cbranch_vccnz arq_27_1
    s_waitcnt vmcnt(3)
    v_mfma_f32_16x16x32_bf16 v[12:15], v[104:107], v[56:59], v[12:15]
    v_mfma_f32_16x16x32_bf16 v[16:19], v[120:123], v[56:59], v[16:19]
    v_max_u32 v3, v56, v58
    v_cmp_eq_u32 vcc, -1, v3
    v_mfma_f32_16x16x32_bf16 v[20:23], v[56:59], v[56:59], v[20:23]
    s_cbranch_vccnz arq_27_2
    s_waitcnt vmcnt(2)
    v_mfma_f32_16x16x32_bf16 v[12:15], v[108:111], v[60:63], v[12:15]
    v_mfma_f32_16x16x32_bf16 v[16:19], v[124:127], v[60:63], v[16:19]
    v_max_u32 v3, v60, v62
    v_cmp_eq_u32 vcc, -1, v3
    v_mfma_f32_16x16x32_bf16 v[20:23], v[60:63], v[60:63], v[20:23]
    s_cbranch_vccnz arq_27_3
    s_branch aloop_26_sdone
arq_27_v:
    s_sub_u32 s22, s22, 1
    s_cbranch_scc1 arq_27_vg
    buffer_load_dwordx4 v[64:67], v0, s[4:7], s24 offen offset:0 sc1
    buffer_load_dwordx4 v[68:71], v0, s[4:7], s24 offen offset:1024 sc1
    s_waitcnt vmcnt(0)
    v_max3_u32 v188, v64, v66, v68
    v_max_u32 v188, v188, v70
    v_cmp_eq_u32 vcc, -1, v188
    s_cbranch_vccnz arq_27_v
    s_branch aloop_26_vok
arq_27_vg:
    s_mov_b32 s22, 0
    s_branch aloop_26_vok
arq_27_v2:
    s_sub_u32 s22, s22, 1
    s_cbranch_scc1 arq_27_v2g
    buffer_load_dwordx4 v[64:67], v0, s[4:7], s24 offen offset:0 sc1
    buffer_load_dwordx4 v[68:71], v0, s[4:7], s24 offen offset:1024 sc1
    s_waitcnt vmcnt(0)
    v_max3_u32 v188, v64, v66, v68
    v_max_u32 v188, v188, v70
    v_cmp_eq_u32 vcc, -1, v188
    s_cbranch_vccnz arq_27_v2
    s_branch aloop_26_lsk3
arq_27_v2g:
    s_mov_b32 s22, 0
    s_branch aloop_26_lsk3
aloop_26_nochk:
    v_mfma_f32_16x16x32_bf16 v[12:15], v[96:99], v[48:51], 0
    v_mfma_f32_16x16x32_bf16 v[16:19], v[112:115], v[48:51], 0
    v_mfma_f32_16x16x32_bf16 v[20:23], v[48:51], v[48:51], 0
    v_mfma_f32_16x16x32_bf16 v[12:15], v[100:103], v[52:55], v[12:15]
    v_mfma_f32_16x16x32_bf16 v[16:19], v[116:119], v[52:55], v[16:19]
    v_mfma_f32_16x16x32_bf16 v[20:23], v[52:55], v[52:55], v[20:23]
    v_mfma_f32_16x16x32_bf16 v[12:15], v[104:107], v[56:59], v[12:15]
    v_mfma_f32_16x16x32_bf16 v[16:19], v[120:123], v[56:59], v[16:19]
    v_mfma_f32_16x16x32_bf16 v[20:23], v[56:59], v[56:59], v[20:23]
    v_mfma_f32_16x16x32_bf16 v[12:15], v[108:111], v[60:63], v[12:15]
    v_mfma_f32_16x16x32_bf16 v[16:19], v[124:127], v[60:63], v[16:19]
    v_mfma_f32_16x16x32_bf16 v[20:23], v[60:63], v[60:63], v[20:23]
    s_nop 1
    s_branch aloop_26_sdone
aloop_26_lsk:
    s_cmp_lg_u32 s27, 0
    s_cbranch_scc1 aloop_26_lsk2
    v_mov_b32 v3, 62
    s_mov_b64 exec, 1
    buffer_store_dword v3, off, s[4:7], s28 sc1
    s_mov_b64 exec, -1
aloop_26_lsk2:
    s_waitcnt vmcnt(0)
    v_max3_u32 v188, v64, v66, v68
    v_max_u32 v188, v188, v70
    v_cmp_eq_u32 vcc, -1, v188
    s_cbranch_vccnz arq_27_v2
aloop_26_lsk3:
    v_smfmac_f32_16x16x64_bf16 v[24:27], v[64:67], v[192:199], v166
    v_smfmac_f32_16x16x64_bf16 v[32:35], v[64:67], v[224:231], v166
    v_smfmac_f32_16x16x64_bf16 v[28:31], v[64:67], v[208:215], v166
    v_smfmac_f32_16x16x64_bf16 v[36:39], v[64:67], v[240:247], v166
    v_smfmac_f32_16x16x64_bf16 v[24:27], v[68:71], v[200:207], v166
    v_smfmac_f32_16x16x64_bf16 v[32:35], v[68:71], v[232:239], v166
    v_smfmac_f32_16x16x64_bf16 v[28:31], v[68:71], v[216:223], v166
    v_smfmac_f32_16x16x64_bf16 v[36:39], v[68:71], v[248:255], v166
    s_nop 7
    s_nop 1
    v_cvt_pk_bf16_f32 v40, v24, v25
    v_cvt_pk_bf16_f32 v41, v26, v27
    v_cvt_pk_bf16_f32 v42, v28, v29
    v_cvt_pk_bf16_f32 v43, v30, v31
    v_cvt_pk_bf16_f32 v44, v32, v33
    v_cvt_pk_bf16_f32 v45, v34, v35
    v_cvt_pk_bf16_f32 v46, v36, v37
    v_cvt_pk_bf16_f32 v47, v38, v39
    s_waitcnt lgkmcnt(0)
    s_branch aloop_26_lskb
k_end:
k_exit:
    s_endpgm
.section .rodata,"a"
.p2align 6
jobtab:
    .long 4, 24, 24, 8192, 0, 262144, 8388608, 0, 32768, 4, 20971520, 131072, 0, 0, 218104321, 0
    .long 4, 24, 24, 8192, 0, 262144, 8388608, 262144, 32768, 4, 22020096, 131072, 0, 0, 218104324, 0
    .long 4, 32, 32, 8192, 4352, 266496, 8388608, 524288, 32768, 4, 39915520, 131072, 0, 0, 218104641, 0
    .long 1, 24, 24, 8192, 6144, 6400, 8388608, 1572864, 32768, 8, 27361280, 131072, 0, 0, 218105194, 0
    .long 2, 64, 72, 7168, 4096, 4096, 7340032, 524288, 32768, 8, 56426496, 114688, 0, 0, 218103889, 0
    .long 2, 64, 72, 7168, 3072, 3072, 7340032, 2097152, 32768, 8, 61915136, 114688, 0, 0, 218104068, 0
    .long 2, 64, 72, 7168, 3072, 3072, 7340032, 3670016, 32768, 8, 67420160, 114688, 0, 0, 218104260, 0
    .long 1, 80, 80, 2048, 5505024, 5505280, 7340032, 63787008, 114688, 7, 132644864, 32768, 218104148, 7, 218106689, 0
    .long 0, 0, 0, 0, 0, 0, 0, 0, 0, 0, 0, 0, 0, 0, 0, 0
    .long 0, 0, 0, 0, 0, 0, 0, 0, 0, 0, 0, 0, 0, 0, 0, 0
    .long 0, 0, 0, 0, 0, 0, 0, 0, 0, 0, 0, 0, 0, 0, 0, 0
    .long 4, 24, 24, 8192, 512, 262656, 8388608, 0, 32768, 4, 20979712, 131072, 0, 0, 218104321, 0
    .long 4, 24, 24, 8192, 512, 262656, 8388608, 262144, 32768, 4, 22028288, 131072, 0, 0, 218104324, 0
    .long 4, 32, 32, 8192, 4864, 267008, 8388608, 524288, 32768, 4, 39923712, 131072, 0, 0, 218104641, 0
    .long 1, 24, 24, 8192, 6656, 6912, 8388608, 1572864, 32768, 8, 27369472, 131072, 0, 0, 218105194, 0
    .long 2, 64, 72, 7168, 4352, 4352, 7340032, 524288, 32768, 8, 56430592, 114688, 0, 0, 218103889, 0
    .long 2, 64, 72, 7168, 3328, 3328, 7340032, 2097152, 32768, 8, 61919232, 114688, 0, 0, 218104068, 0
    .long 2, 64, 72, 7168, 3328, 3328, 7340032, 3670016, 32768, 8, 67424256, 114688, 0, 0, 218104260, 0
    .long 1, 80, 80, 2048, 5505536, 5505792, 7340032, 63787008, 114688, 7, 132653056, 32768, 218104148, 7, 218106689, 0
    .long 0, 0, 0, 0, 0, 0, 0, 0, 0, 0, 0, 0, 0, 0, 0, 0
    .long 0, 0, 0, 0, 0, 0, 0, 0, 0, 0, 0, 0, 0, 0, 0, 0
    .long 0, 0, 0, 0, 0, 0, 0, 0, 0, 0, 0, 0, 0, 0, 0, 0
    .long 4, 24, 24, 8192, 1024, 263168, 8388608, 0, 32768, 4, 20987904, 131072, 0, 0, 218104337, 0
    .long 4, 24, 24, 8192, 1024, 263168, 8388608, 262144, 32768, 4, 22036480, 131072, 0, 0, 218104340, 0
    .long 4, 32, 32, 8192, 5376, 267520, 8388608, 524288, 32768, 4, 39931904, 131072, 0, 0, 218104657, 0
    .long 1, 24, 24, 8192, 7168, 7424, 8388608, 1572864, 32768, 8, 27377664, 131072, 0, 0, 218105210, 0
    .long 2, 64, 72, 7168, 4608, 4608, 7340032, 524288, 32768, 8, 56434688, 114688, 0, 0, 218103889, 0
    .long 2, 64, 72, 7168, 3584, 3584, 7340032, 2097152, 32768, 8, 61923328, 114688, 0, 0, 218104081, 0
    .long 2, 64, 72, 7168, 3584, 3584, 7340032, 3670016, 32768, 8, 67428352, 114688, 0, 0, 218104273, 0
    .long 1, 80, 80, 2048, 5506048, 5506304, 7340032, 63787008, 114688, 7, 132661248, 32768, 218104148, 7, 218106689, 0
    .long 0, 0, 0, 0, 0, 0, 0, 0, 0, 0, 0, 0, 0, 0, 0, 0
    .long 0, 0, 0, 0, 0, 0, 0, 0, 0, 0, 0, 0, 0, 0, 0, 0
    .long 0, 0, 0, 0, 0, 0, 0, 0, 0, 0, 0, 0, 0, 0, 0, 0
    .long 4, 24, 24, 8192, 1536, 263680, 8388608, 0, 32768, 4, 20996096, 131072, 0, 0, 218104337, 0
    .long 4, 24, 24, 8192, 1536, 263680, 8388608, 262144, 32768, 4, 22044672, 131072, 0, 0, 218104340, 0
    .long 4, 32, 32, 8192, 5888, 268032, 8388608, 524288, 32768, 4, 39940096, 131072, 0, 0, 218104657, 0
    .long 1, 24, 24, 8192, 7680, 7936, 8388608, 1572864, 32768, 8, 27385856, 131072, 0, 0, 218105210, 0
    .long 2, 64, 72, 7168, 4864, 4864, 7340032, 524288, 32768, 8, 56438784, 114688, 0, 0, 218103889, 0
    .long 2, 64, 72, 7168, 4864, 4864, 7340032, 2097152, 32768, 8, 61943808, 114688, 0, 0, 218104081, 0
    .long 2, 64, 72, 7168, 4864, 4864, 7340032, 3670016, 32768, 8, 67448832, 114688, 0, 0, 218104273, 0
    .long 1, 80, 80, 2048, 1536, 1792, 7340032, 65536000, 114688, 7, 120610816, 32768, 218104192, 7, 218106753, 0
    .long 0, 0, 0, 0, 0, 0, 0, 0, 0, 0, 0, 0, 0, 0, 0, 0
    .long 0, 0, 0, 0, 0, 0, 0, 0, 0, 0, 0, 0, 0, 0, 0, 0
    .long 0, 0, 0, 0, 0, 0, 0, 0, 0, 0, 0, 0, 0, 0, 0, 0
    .long 4, 24, 24, 8192, 256, 262400, 8388608, 0, 32768, 4, 20975616, 131072, 0, 0, 218104321, 0
    .long 4, 24, 24, 8192, 256, 262400, 8388608, 262144, 32768, 4, 22024192, 131072, 0, 0, 218104324, 0
    .long 4, 32, 32, 8192, 6144, 268288, 8388608, 524288, 32768, 4, 39944192, 131072, 0, 0, 218104673, 0
    .long 1, 32, 32, 8192, 0, 256, 8388608, 1572864, 32768, 8, 44040192, 131072, 0, 0, 218105098, 0
    .long 2, 64, 72, 7168, 5120, 5120, 7340032, 524288, 32768, 8, 56442880, 114688, 0, 0, 218103889, 0
    .long 2, 64, 72, 7168, 4096, 4096, 7340032, 2097152, 32768, 8, 61931520, 114688, 0, 0, 218104081, 0
    .long 2, 64, 72, 7168, 4096, 4096, 7340032, 3670016, 32768, 8, 67436544, 114688, 0, 0, 218104273, 0
    .long 1, 80, 80, 2048, 0, 256, 7340032, 65536000, 114688, 7, 120586240, 32768, 218104192, 7, 218106753, 0
    .long 0, 0, 0, 0, 0, 0, 0, 0, 0, 0, 0, 0, 0, 0, 0, 0
    .long 0, 0, 0, 0, 0, 0, 0, 0, 0, 0, 0, 0, 0, 0, 0, 0
    .long 0, 0, 0, 0, 0, 0, 0, 0, 0, 0, 0, 0, 0, 0, 0, 0
    .long 4, 24, 24, 8192, 768, 262912, 8388608, 0, 32768, 4, 20983808, 131072, 0, 0, 218104321, 0
    .long 4, 24, 24, 8192, 768, 262912, 8388608, 262144, 32768, 4, 22032384, 131072, 0, 0, 218104324, 0
    .long 4, 32, 32, 8192, 6656, 268800, 8388608, 524288, 32768, 4, 39952384, 131072, 0, 0, 218104673, 0
    .long 1, 32, 32, 8192, 512, 768, 8388608, 1572864, 32768, 8, 44048384, 131072, 0, 0, 218105098, 0
    .long 2, 64, 72, 7168, 5376, 5376, 7340032, 524288, 32768, 8, 56446976, 114688, 0, 0, 218103892, 0
    .long 2, 64, 72, 7168, 4352, 4352, 7340032, 2097152, 32768, 8, 61935616, 114688, 0, 0, 218104081, 0
    .long 2, 64, 72, 7168, 4352, 4352, 7340032, 3670016, 32768, 8, 67440640, 114688, 0, 0, 218104273, 0
    .long 1, 80, 80, 2048, 512, 768, 7340032, 65536000, 114688, 7, 120594432, 32768, 218104192, 7, 218106753, 0
    .long 0, 0, 0, 0, 0, 0, 0, 0, 0, 0, 0, 0, 0, 0, 0, 0
    .long 0, 0, 0, 0, 0, 0, 0, 0, 0, 0, 0, 0, 0, 0, 0, 0
    .long 0, 0, 0, 0, 0, 0, 0, 0, 0, 0, 0, 0, 0, 0, 0, 0
    .long 4, 24, 24, 8192, 1280, 263424, 8388608, 0, 32768, 4, 20992000, 131072, 0, 0, 218104337, 0
    .long 4, 24, 24, 8192, 1280, 263424, 8388608, 262144, 32768, 4, 22040576, 131072, 0, 0, 218104340, 0
    .long 4, 32, 32, 8192, 7168, 269312, 8388608, 524288, 32768, 4, 39960576, 131072, 0, 0, 218104689, 0
    .long 1, 32, 32, 8192, 1024, 1280, 8388608, 1572864, 32768, 8, 44056576, 131072, 0, 0, 218105114, 0
    .long 2, 64, 72, 7168, 5632, 5632, 7340032, 524288, 32768, 8, 56451072, 114688, 0, 0, 218103892, 0
    .long 2, 64, 72, 7168, 4608, 4608, 7340032, 2097152, 32768, 8, 61939712, 114688, 0, 0, 218104081, 0
    .long 2, 64, 72, 7168, 4608, 4608, 7340032, 3670016, 32768, 8, 67444736, 114688, 0, 0, 218104273, 0
    .long 1, 80, 80, 2048, 1024, 1280, 7340032, 65536000, 114688, 7, 120602624, 32768, 218104192, 7, 218106753, 0
    .long 0, 0, 0, 0, 0, 0, 0, 0, 0, 0, 0, 0, 0, 0, 0, 0
    .long 0, 0, 0, 0, 0, 0, 0, 0, 0, 0, 0, 0, 0, 0, 0, 0
    .long 0, 0, 0, 0, 0, 0, 0, 0, 0, 0, 0, 0, 0, 0, 0, 0
    .long 4, 24, 24, 8192, 1792, 263936, 8388608, 0, 32768, 4, 21000192, 131072, 0, 0, 218104337, 0
    .long 4, 24, 24, 8192, 1792, 263936, 8388608, 262144, 32768, 4, 22048768, 131072, 0, 0, 218104340, 0
    .long 4, 32, 32, 8192, 7680, 269824, 8388608, 524288, 32768, 4, 39968768, 131072, 0, 0, 218104689, 0
    .long 1, 32, 32, 8192, 1536, 1792, 8388608, 1572864, 32768, 8, 44064768, 131072, 0, 0, 218105114, 0
    .long 2, 64, 72, 7168, 5888, 5888, 7340032, 524288, 32768, 8, 56455168, 114688, 0, 0, 218103892, 0
    .long 2, 64, 72, 7168, 5888, 5888, 7340032, 2097152, 32768, 8, 61960192, 114688, 0, 0, 218104084, 0
    .long 2, 64, 72, 7168, 5888, 5888, 7340032, 3670016, 32768, 8, 67465216, 114688, 0, 0, 218104276, 0
    .long 1, 80, 80, 2048, 1836544, 1836800, 7340032, 65564672, 114688, 7, 124805120, 32768, 218104196, 7, 218106753, 0
    .long 0, 0, 0, 0, 0, 0, 0, 0, 0, 0, 0, 0, 0, 0, 0, 0
    .long 0, 0, 0, 0, 0, 0, 0, 0, 0, 0, 0, 0, 0, 0, 0, 0
    .long 0, 0, 0, 0, 0, 0, 0, 0, 0, 0, 0, 0, 0, 0, 0, 0
    .long 4, 24, 24, 8192, 2048, 264192, 8388608, 0, 32768, 4, 21004288, 131072, 0, 0, 218104353, 0
    .long 4, 24, 24, 8192, 2048, 264192, 8388608, 262144, 32768, 4, 22052864, 131072, 0, 0, 218104356, 0
    .long 4, 32, 32, 8192, 6400, 268544, 8388608, 524288, 32768, 4, 39948288, 131072, 0, 0, 218104673, 0
    .long 1, 32, 32, 8192, 2048, 2304, 8388608, 1572864, 32768, 8, 44072960, 131072, 0, 0, 218105130, 0
    .long 2, 64, 72, 7168, 6144, 6144, 7340032, 524288, 32768, 8, 56459264, 114688, 0, 0, 218103892, 0
    .long 2, 64, 72, 7168, 5120, 5120, 7340032, 2097152, 32768, 8, 61947904, 114688, 0, 0, 218104081, 0
    .long 2, 64, 72, 7168, 5120, 5120, 7340032, 3670016, 32768, 8, 67452928, 114688, 0, 0, 218104273, 0
    .long 1, 80, 80, 2048, 1835008, 1835264, 7340032, 65564672, 114688, 7, 124780544, 32768, 218104196, 7, 218106753, 0
    .long 0, 0, 0, 0, 0, 0, 0, 0, 0, 0, 0, 0, 0, 0, 0, 0
    .long 0, 0, 0, 0, 0, 0, 0, 0, 0, 0, 0, 0, 0, 0, 0, 0
    .long 0, 0, 0, 0, 0, 0, 0, 0, 0, 0, 0, 0, 0, 0, 0, 0
    .long 4, 24, 24, 8192, 2560, 264704, 8388608, 0, 32768, 4, 21012480, 131072, 0, 0, 218104353, 0
    .long 4, 24, 24, 8192, 2560, 264704, 8388608, 262144, 32768, 4, 22061056, 131072, 0, 0, 218104356, 0
    .long 4, 32, 32, 8192, 6912, 269056, 8388608, 524288, 32768, 4, 39956480, 131072, 0, 0, 218104673, 0
    .long 1, 32, 32, 8192, 2560, 2816, 8388608, 1572864, 32768, 8, 44081152, 131072, 0, 0, 218105130, 0
    .long 2, 64, 72, 7168, 6400, 6400, 7340032, 524288, 32768, 8, 56463360, 114688, 0, 0, 218103892, 0
    .long 2, 64, 72, 7168, 5376, 5376, 7340032, 2097152, 32768, 8, 61952000, 114688, 0, 0, 218104084, 0
    .long 2, 64, 72, 7168, 5376, 5376, 7340032, 3670016, 32768, 8, 67457024, 114688, 0, 0, 218104276, 0
    .long 1, 80, 80, 2048, 1835520, 1835776, 7340032, 65564672, 114688, 7, 124788736, 32768, 218104196, 7, 218106753, 0
    .long 0, 0, 0, 0, 0, 0, 0, 0, 0, 0, 0, 0, 0, 0, 0, 0
    .long 0, 0, 0, 0, 0, 0, 0, 0, 0, 0, 0, 0, 0, 0, 0, 0
    .long 0, 0, 0, 0, 0, 0, 0, 0, 0, 0, 0, 0, 0, 0, 0, 0
    .long 4, 24, 24, 8192, 3072, 265216, 8388608, 0, 32768, 4, 21020672, 131072, 0, 0, 218104369, 0
    .long 4, 24, 24, 8192, 3072, 265216, 8388608, 262144, 32768, 4, 22069248, 131072, 0, 0, 218104372, 0
    .long 4, 32, 32, 8192, 7424, 269568, 8388608, 524288, 32768, 4, 39964672, 131072, 0, 0, 218104689, 0
    .long 1, 32, 32, 8192, 3072, 3328, 8388608, 1572864, 32768, 8, 44089344, 131072, 0, 0, 218105146, 0
    .long 2, 64, 72, 7168, 6656, 6656, 7340032, 524288, 32768, 8, 56467456, 114688, 0, 0, 218103892, 0
    .long 2, 64, 72, 7168, 5632, 5632, 7340032, 2097152, 32768, 8, 61956096, 114688, 0, 0, 218104084, 0
    .long 2, 64, 72, 7168, 5632, 5632, 7340032, 3670016, 32768, 8, 67461120, 114688, 0, 0, 218104276, 0
    .long 1, 80, 80, 2048, 1836032, 1836288, 7340032, 65564672, 114688, 7, 124796928, 32768, 218104196, 7, 218106753, 0
    .long 0, 0, 0, 0, 0, 0, 0, 0, 0, 0, 0, 0, 0, 0, 0, 0
    .long 0, 0, 0, 0, 0, 0, 0, 0, 0, 0, 0, 0, 0, 0, 0, 0
    .long 0, 0, 0, 0, 0, 0, 0, 0, 0, 0, 0, 0, 0, 0, 0, 0
    .long 4, 24, 24, 8192, 3584, 265728, 8388608, 0, 32768, 4, 21028864, 131072, 0, 0, 218104369, 0
    .long 4, 24, 24, 8192, 3584, 265728, 8388608, 262144, 32768, 4, 22077440, 131072, 0, 0, 218104372, 0
    .long 4, 32, 32, 8192, 7936, 270080, 8388608, 524288, 32768, 4, 39972864, 131072, 0, 0, 218104689, 0
    .long 1, 32, 32, 8192, 3584, 3840, 8388608, 1572864, 32768, 8, 44097536, 131072, 0, 0, 218105146, 0
    .long 2, 64, 72, 7168, 6912, 6912, 7340032, 524288, 32768, 8, 56471552, 114688, 0, 0, 218103892, 0
    .long 2, 64, 72, 7168, 6912, 6912, 7340032, 2097152, 32768, 8, 61976576, 114688, 0, 0, 218104084, 0
    .long 2, 64, 72, 7168, 6912, 6912, 7340032, 3670016, 32768, 8, 67481600, 114688, 0, 0, 218104276, 0
    .long 1, 80, 80, 2048, 3671552, 3671808, 7340032, 65593344, 114688, 7, 128999424, 32768, 218104208, 7, 218106753, 0
    .long 0, 0, 0, 0, 0, 0, 0, 0, 0, 0, 0, 0, 0, 0, 0, 0
    .long 0, 0, 0, 0, 0, 0, 0, 0, 0, 0, 0, 0, 0, 0, 0, 0
    .long 0, 0, 0, 0, 0, 0, 0, 0, 0, 0, 0, 0, 0, 0, 0, 0
    .long 4, 24, 24, 8192, 2304, 264448, 8388608, 0, 32768, 4, 21008384, 131072, 0, 0, 218104353, 0
    .long 4, 24, 24, 8192, 2304, 264448, 8388608, 262144, 32768, 4, 22056960, 131072, 0, 0, 218104356, 0
    .long 4, 16, 16, 8192, 4096, 266240, 8388608, 524288, 32768, 4, 6356992, 131072, 0, 0, 218104641, 0
    .long 1, 32, 32, 8192, 4096, 4352, 8388608, 1572864, 32768, 8, 44105728, 131072, 0, 0, 218105162, 0
    .long 2, 64, 72, 7168, 0, 0, 7340032, 1048576, 32768, 8, 58195968, 114688, 0, 0, 218103937, 0
    .long 2, 64, 72, 7168, 6144, 6144, 7340032, 2097152, 32768, 8, 61964288, 114688, 0, 0, 218104084, 0
    .long 2, 64, 72, 7168, 6144, 6144, 7340032, 3670016, 32768, 8, 67469312, 114688, 0, 0, 218104276, 0
    .long 1, 80, 80, 2048, 3670016, 3670272, 7340032, 65593344, 114688, 7, 128974848, 32768, 218104208, 7, 218106753, 0
    .long 0, 0, 0, 0, 0, 0, 0, 0, 0, 0, 0, 0, 0, 0, 0, 0
    .long 0, 0, 0, 0, 0, 0, 0, 0, 0, 0, 0, 0, 0, 0, 0, 0
    .long 0, 0, 0, 0, 0, 0, 0, 0, 0, 0, 0, 0, 0, 0, 0, 0
    .long 4, 24, 24, 8192, 2816, 264960, 8388608, 0, 32768, 4, 21016576, 131072, 0, 0, 218104353, 0
    .long 4, 24, 24, 8192, 2816, 264960, 8388608, 262144, 32768, 4, 22065152, 131072, 0, 0, 218104356, 0
    .long 4, 16, 16, 8192, 4608, 266752, 8388608, 524288, 32768, 4, 6365184, 131072, 0, 0, 218104641, 0
    .long 1, 32, 32, 8192, 4608, 4864, 8388608, 1572864, 32768, 8, 44113920, 131072, 0, 0, 218105162, 0
    .long 2, 64, 72, 7168, 256, 256, 7340032, 1048576, 32768, 8, 58200064, 114688, 0, 0, 218103937, 0
    .long 2, 64, 72, 7168, 6400, 6400, 7340032, 2097152, 32768, 8, 61968384, 114688, 0, 0, 218104084, 0
    .long 2, 64, 72, 7168, 6400, 6400, 7340032, 3670016, 32768, 8, 67473408, 114688, 0, 0, 218104276, 0
    .long 1, 80, 80, 2048, 3670528, 3670784, 7340032, 65593344, 114688, 7, 128983040, 32768, 218104208, 7, 218106753, 0
    .long 0, 0, 0, 0, 0, 0, 0, 0, 0, 0, 0, 0, 0, 0, 0, 0
    .long 0, 0, 0, 0, 0, 0, 0, 0, 0, 0, 0, 0, 0, 0, 0, 0
    .long 0, 0, 0, 0, 0, 0, 0, 0, 0, 0, 0, 0, 0, 0, 0, 0
    .long 4, 24, 24, 8192, 3328, 265472, 8388608, 0, 32768, 4, 21024768, 131072, 0, 0, 218104369, 0
    .long 4, 24, 24, 8192, 3328, 265472, 8388608, 262144, 32768, 4, 22073344, 131072, 0, 0, 218104372, 0
    .long 4, 16, 16, 8192, 5120, 267264, 8388608, 524288, 32768, 4, 6373376, 131072, 0, 0, 218104657, 0
    .long 1, 32, 32, 8192, 5120, 5376, 8388608, 1572864, 32768, 8, 44122112, 131072, 0, 0, 218105178, 0
    .long 2, 64, 72, 7168, 512, 512, 7340032, 1048576, 32768, 8, 58204160, 114688, 0, 0, 218103937, 0
    .long 2, 64, 72, 7168, 6656, 6656, 7340032, 2097152, 32768, 8, 61972480, 114688, 0, 0, 218104084, 0
    .long 2, 64, 72, 7168, 6656, 6656, 7340032, 3670016, 32768, 8, 67477504, 114688, 0, 0, 218104276, 0
    .long 1, 80, 80, 2048, 3671040, 3671296, 7340032, 65593344, 114688, 7, 128991232, 32768, 218104208, 7, 218106753, 0
    .long 0, 0, 0, 0, 0, 0, 0, 0, 0, 0, 0, 0, 0, 0, 0, 0
    .long 0, 0, 0, 0, 0, 0, 0, 0, 0, 0, 0, 0, 0, 0, 0, 0
    .long 0, 0, 0, 0, 0, 0, 0, 0, 0, 0, 0, 0, 0, 0, 0, 0
    .long 4, 24, 24, 8192, 3840, 265984, 8388608, 0, 32768, 4, 21032960, 131072, 0, 0, 218104369, 0
    .long 4, 24, 24, 8192, 3840, 265984, 8388608, 262144, 32768, 4, 22081536, 131072, 0, 0, 218104372, 0
    .long 4, 16, 16, 8192, 5632, 267776, 8388608, 524288, 32768, 4, 6381568, 131072, 0, 0, 218104657, 0
    .long 1, 32, 32, 8192, 5632, 5888, 8388608, 1572864, 32768, 8, 44130304, 131072, 0, 0, 218105178, 0
    .long 2, 64, 72, 7168, 768, 768, 7340032, 1048576, 32768, 8, 58208256, 114688, 0, 0, 218103937, 0
    .long 2, 64, 72, 7168, 768, 768, 7340032, 2621440, 32768, 8, 63713280, 114688, 0, 0, 218104129, 0
    .long 1, 24, 24, 8192, 1536, 1792, 8388608, 3670016, 32768, 8, 35676160, 131072, 0, 0, 218106138, 0
    .long 1, 80, 80, 2048, 1536, 1792, 7340032, 60030976, 114688, 7, 119037952, 32768, 218104000, 7, 218106561, 0
    .long 0, 0, 0, 0, 0, 0, 0, 0, 0, 0, 0, 0, 0, 0, 0, 0
    .long 0, 0, 0, 0, 0, 0, 0, 0, 0, 0, 0, 0, 0, 0, 0, 0
    .long 0, 0, 0, 0, 0, 0, 0, 0, 0, 0, 0, 0, 0, 0, 0, 0
    .long 4, 24, 24, 8192, 4096, 266240, 8388608, 0, 32768, 4, 21037056, 131072, 0, 0, 218104385, 0
    .long 4, 24, 24, 8192, 4096, 266240, 8388608, 262144, 32768, 4, 22085632, 131072, 0, 0, 218104388, 0
    .long 4, 16, 16, 8192, 4352, 266496, 8388608, 524288, 32768, 4, 6361088, 131072, 0, 0, 218104641, 0
    .long 1, 32, 32, 8192, 6144, 6400, 8388608, 1572864, 32768, 8, 44138496, 131072, 0, 0, 218105194, 0
    .long 2, 64, 72, 7168, 1024, 1024, 7340032, 1048576, 32768, 8, 58212352, 114688, 0, 0, 218103937, 0
    .long 2, 64, 72, 7168, 0, 0, 7340032, 2621440, 32768, 8, 63700992, 114688, 0, 0, 218104129, 0
    .long 1, 24, 24, 8192, 0, 256, 8388608, 3670016, 32768, 8, 35651584, 131072, 0, 0, 218106122, 0
    .long 1, 80, 80, 2048, 0, 256, 7340032, 60030976, 114688, 7, 119013376, 32768, 218104000, 7, 218106561, 0
    .long 0, 0, 0, 0, 0, 0, 0, 0, 0, 0, 0, 0, 0, 0, 0, 0
    .long 0, 0, 0, 0, 0, 0, 0, 0, 0, 0, 0, 0, 0, 0, 0, 0
    .long 0, 0, 0, 0, 0, 0, 0, 0, 0, 0, 0, 0, 0, 0, 0, 0
    .long 4, 24, 24, 8192, 4608, 266752, 8388608, 0, 32768, 4, 21045248, 131072, 0, 0, 218104385, 0
    .long 4, 24, 24, 8192, 4608, 266752, 8388608, 262144, 32768, 4, 22093824, 131072, 0, 0, 218104388, 0
    .long 4, 16, 16, 8192, 4864, 267008, 8388608, 524288, 32768, 4, 6369280, 131072, 0, 0, 218104641, 0
    .long 1, 32, 32, 8192, 6656, 6912, 8388608, 1572864, 32768, 8, 44146688, 131072, 0, 0, 218105194, 0
    .long 2, 64, 72, 7168, 1280, 1280, 7340032, 1048576, 32768, 8, 58216448, 114688, 0, 0, 218103937, 0
    .long 2, 64, 72, 7168, 256, 256, 7340032, 2621440, 32768, 8, 63705088, 114688, 0, 0, 218104129, 0
    .long 1, 24, 24, 8192, 512, 768, 8388608, 3670016, 32768, 8, 35659776, 131072, 0, 0, 218106122, 0
    .long 1, 80, 80, 2048, 512, 768, 7340032, 60030976, 114688, 7, 119021568, 32768, 218104000, 7, 218106561, 0
    .long 0, 0, 0, 0, 0, 0, 0, 0, 0, 0, 0, 0, 0, 0, 0, 0
    .long 0, 0, 0, 0, 0, 0, 0, 0, 0, 0, 0, 0, 0, 0, 0, 0
    .long 0, 0, 0, 0, 0, 0, 0, 0, 0, 0, 0, 0, 0, 0, 0, 0
    .long 4, 24, 24, 8192, 5120, 267264, 8388608, 0, 32768, 4, 21053440, 131072, 0, 0, 218104401, 0
    .long 4, 24, 24, 8192, 5120, 267264, 8388608, 262144, 32768, 4, 22102016, 131072, 0, 0, 218104404, 0
    .long 4, 16, 16, 8192, 5376, 267520, 8388608, 524288, 32768, 4, 6377472, 131072, 0, 0, 218104657, 0
    .long 1, 32, 32, 8192, 7168, 7424, 8388608, 1572864, 32768, 8, 44154880, 131072, 0, 0, 218105210, 0
    .long 2, 64, 72, 7168, 1536, 1536, 7340032, 1048576, 32768, 8, 58220544, 114688, 0, 0, 218103937, 0
    .long 2, 64, 72, 7168, 512, 512, 7340032, 2621440, 32768, 8, 63709184, 114688, 0, 0, 218104129, 0
    .long 1, 24, 24, 8192, 1024, 1280, 8388608, 3670016, 32768, 8, 35667968, 131072, 0, 0, 218106138, 0
    .long 1, 80, 80, 2048, 1024, 1280, 7340032, 60030976, 114688, 7, 119029760, 32768, 218104000, 7, 218106561, 0
    .long 0, 0, 0, 0, 0, 0, 0, 0, 0, 0, 0, 0, 0, 0, 0, 0
    .long 0, 0, 0, 0, 0, 0, 0, 0, 0, 0, 0, 0, 0, 0, 0, 0
    .long 0, 0, 0, 0, 0, 0, 0, 0, 0, 0, 0, 0, 0, 0, 0, 0
    .long 4, 24, 24, 8192, 5632, 267776, 8388608, 0, 32768, 4, 21061632, 131072, 0, 0, 218104401, 0
    .long 4, 24, 24, 8192, 5632, 267776, 8388608, 262144, 32768, 4, 22110208, 131072, 0, 0, 218104404, 0
    .long 4, 16, 16, 8192, 5888, 268032, 8388608, 524288, 32768, 4, 6385664, 131072, 0, 0, 218104657, 0
    .long 1, 32, 32, 8192, 7680, 7936, 8388608, 1572864, 32768, 8, 44163072, 131072, 0, 0, 218105210, 0
    .long 2, 64, 72, 7168, 1792, 1792, 7340032, 1048576, 32768, 8, 58224640, 114688, 0, 0, 218103940, 0
    .long 2, 64, 72, 7168, 1792, 1792, 7340032, 2621440, 32768, 8, 63729664, 114688, 0, 0, 218104132, 0
    .long 1, 24, 24, 8192, 3584, 3840, 8388608, 3670016, 32768, 8, 35708928, 131072, 0, 0, 218106170, 0
    .long 1, 80, 80, 2048, 1836544, 1836800, 7340032, 60059648, 114688, 7, 123232256, 32768, 218104004, 7, 218106561, 0
    .long 0, 0, 0, 0, 0, 0, 0, 0, 0, 0, 0, 0, 0, 0, 0, 0
    .long 0, 0, 0, 0, 0, 0, 0, 0, 0, 0, 0, 0, 0, 0, 0, 0
    .long 0, 0, 0, 0, 0, 0, 0, 0, 0, 0, 0, 0, 0, 0, 0, 0
    .long 4, 24, 24, 8192, 4352, 266496, 8388608, 0, 32768, 4, 21041152, 131072, 0, 0, 218104385, 0
    .long 4, 24, 24, 8192, 4352, 266496, 8388608, 262144, 32768, 4, 22089728, 131072, 0, 0, 218104388, 0
    .long 4, 16, 16, 8192, 6144, 268288, 8388608, 524288, 32768, 4, 6389760, 131072, 0, 0, 218104673, 0
    .long 1, 16, 16, 8192, 0, 256, 8388608, 1572864, 32768, 8, 10485760, 131072, 0, 0, 218105098, 0
    .long 2, 64, 72, 7168, 2048, 2048, 7340032, 1048576, 32768, 8, 58228736, 114688, 0, 0, 218103940, 0
    .long 2, 64, 72, 7168, 1024, 1024, 7340032, 2621440, 32768, 8, 63717376, 114688, 0, 0, 218104129, 0
    .long 1, 24, 24, 8192, 2048, 2304, 8388608, 3670016, 32768, 8, 35684352, 131072, 0, 0, 218106154, 0
    .long 1, 80, 80, 2048, 1835008, 1835264, 7340032, 60059648, 114688, 7, 123207680, 32768, 218104004, 7, 218106561, 0
    .long 0, 0, 0, 0, 0, 0, 0, 0, 0, 0, 0, 0, 0, 0, 0, 0
    .long 0, 0, 0, 0, 0, 0, 0, 0, 0, 0, 0, 0, 0, 0, 0, 0
    .long 0, 0, 0, 0, 0, 0, 0, 0, 0, 0, 0, 0, 0, 0, 0, 0
    .long 4, 24, 24, 8192, 4864, 267008, 8388608, 0, 32768, 4, 21049344, 131072, 0, 0, 218104385, 0
    .long 4, 24, 24, 8192, 4864, 267008, 8388608, 262144, 32768, 4, 22097920, 131072, 0, 0, 218104388, 0
    .long 4, 16, 16, 8192, 6656, 268800, 8388608, 524288, 32768, 4, 6397952, 131072, 0, 0, 218104673, 0
    .long 1, 16, 16, 8192, 512, 768, 8388608, 1572864, 32768, 8, 10493952, 131072, 0, 0, 218105098, 0
    .long 2, 64, 72, 7168, 2304, 2304, 7340032, 1048576, 32768, 8, 58232832, 114688, 0, 0, 218103940, 0
    .long 2, 64, 72, 7168, 1280, 1280, 7340032, 2621440, 32768, 8, 63721472, 114688, 0, 0, 218104129, 0
    .long 1, 24, 24, 8192, 2560, 2816, 8388608, 3670016, 32768, 8, 35692544, 131072, 0, 0, 218106154, 0
    .long 1, 80, 80, 2048, 1835520, 1835776, 7340032, 60059648, 114688, 7, 123215872, 32768, 218104004, 7, 218106561, 0
    .long 0, 0, 0, 0, 0, 0, 0, 0, 0, 0, 0, 0, 0, 0, 0, 0
    .long 0, 0, 0, 0, 0, 0, 0, 0, 0, 0, 0, 0, 0, 0, 0, 0
    .long 0, 0, 0, 0, 0, 0, 0, 0, 0, 0, 0, 0, 0, 0, 0, 0
    .long 4, 24, 24, 8192, 5376, 267520, 8388608, 0, 32768, 4, 21057536, 131072, 0, 0, 218104401, 0
    .long 4, 24, 24, 8192, 5376, 267520, 8388608, 262144, 32768, 4, 22106112, 131072, 0, 0, 218104404, 0
    .long 4, 16, 16, 8192, 7168, 269312, 8388608, 524288, 32768, 4, 6406144, 131072, 0, 0, 218104689, 0
    .long 1, 16, 16, 8192, 1024, 1280, 8388608, 1572864, 32768, 8, 10502144, 131072, 0, 0, 218105114, 0
    .long 2, 64, 72, 7168, 2560, 2560, 7340032, 1048576, 32768, 8, 58236928, 114688, 0, 0, 218103940, 0
    .long 2, 64, 72, 7168, 1536, 1536, 7340032, 2621440, 32768, 8, 63725568, 114688, 0, 0, 218104129, 0
    .long 1, 24, 24, 8192, 3072, 3328, 8388608, 3670016, 32768, 8, 35700736, 131072, 0, 0, 218106170, 0
    .long 1, 80, 80, 2048, 1836032, 1836288, 7340032, 60059648, 114688, 7, 123224064, 32768, 218104004, 7, 218106561, 0
    .long 0, 0, 0, 0, 0, 0, 0, 0, 0, 0, 0, 0, 0, 0, 0, 0
    .long 0, 0, 0, 0, 0, 0, 0, 0, 0, 0, 0, 0, 0, 0, 0, 0
    .long 0, 0, 0, 0, 0, 0, 0, 0, 0, 0, 0, 0, 0, 0, 0, 0
    .long 4, 24, 24, 8192, 5888, 268032, 8388608, 0, 32768, 4, 21065728, 131072, 0, 0, 218104401, 0
    .long 4, 24, 24, 8192, 5888, 268032, 8388608, 262144, 32768, 4, 22114304, 131072, 0, 0, 218104404, 0
    .long 4, 16, 16, 8192, 7680, 269824, 8388608, 524288, 32768, 4, 6414336, 131072, 0, 0, 218104689, 0
    .long 1, 16, 16, 8192, 1536, 1792, 8388608, 1572864, 32768, 8, 10510336, 131072, 0, 0, 218105114, 0
    .long 2, 64, 72, 7168, 2816, 2816, 7340032, 1048576, 32768, 8, 58241024, 114688, 0, 0, 218103940, 0
    .long 2, 64, 72, 7168, 2816, 2816, 7340032, 2621440, 32768, 8, 63746048, 114688, 0, 0, 218104132, 0
    .long 1, 24, 24, 8192, 5632, 5888, 8388608, 3670016, 32768, 8, 35741696, 131072, 0, 0, 218106202, 0
    .long 1, 80, 80, 2048, 3671552, 3671808, 7340032, 60088320, 114688, 7, 127426560, 32768, 218104016, 7, 218106561, 0
    .long 0, 0, 0, 0, 0, 0, 0, 0, 0, 0, 0, 0, 0, 0, 0, 0
    .long 0, 0, 0, 0, 0, 0, 0, 0, 0, 0, 0, 0, 0, 0, 0, 0
    .long 0, 0, 0, 0, 0, 0, 0, 0, 0, 0, 0, 0, 0, 0, 0, 0
    .long 4, 24, 24, 8192, 6144, 268288, 8388608, 0, 32768, 4, 21069824, 131072, 0, 0, 218104417, 0
    .long 4, 24, 24, 8192, 6144, 268288, 8388608, 262144, 32768, 4, 22118400, 131072, 0, 0, 218104420, 0
    .long 4, 16, 16, 8192, 6400, 268544, 8388608, 524288, 32768, 4, 6393856, 131072, 0, 0, 218104673, 0
    .long 1, 16, 16, 8192, 2048, 2304, 8388608, 1572864, 32768, 8, 10518528, 131072, 0, 0, 218105130, 0
    .long 2, 64, 72, 7168, 3072, 3072, 7340032, 1048576, 32768, 8, 58245120, 114688, 0, 0, 218103940, 0
    .long 2, 64, 72, 7168, 2048, 2048, 7340032, 2621440, 32768, 8, 63733760, 114688, 0, 0, 218104132, 0
    .long 1, 24, 24, 8192, 4096, 4352, 8388608, 3670016, 32768, 8, 35717120, 131072, 0, 0, 218106186, 0
    .long 1, 80, 80, 2048, 3670016, 3670272, 7340032, 60088320, 114688, 7, 127401984, 32768, 218104016, 7, 218106561, 0
    .long 0, 0, 0, 0, 0, 0, 0, 0, 0, 0, 0, 0, 0, 0, 0, 0
    .long 0, 0, 0, 0, 0, 0, 0, 0, 0, 0, 0, 0, 0, 0, 0, 0
    .long 0, 0, 0, 0, 0, 0, 0, 0, 0, 0, 0, 0, 0, 0, 0, 0
    .long 4, 24, 24, 8192, 6656, 268800, 8388608, 0, 32768, 4, 21078016, 131072, 0, 0, 218104417, 0
    .long 4, 24, 24, 8192, 6656, 268800, 8388608, 262144, 32768, 4, 22126592, 131072, 0, 0, 218104420, 0
    .long 4, 16, 16, 8192, 6912, 269056, 8388608, 524288, 32768, 4, 6402048, 131072, 0, 0, 218104673, 0
    .long 1, 16, 16, 8192, 2560, 2816, 8388608, 1572864, 32768, 8, 10526720, 131072, 0, 0, 218105130, 0
    .long 2, 64, 72, 7168, 3328, 3328, 7340032, 1048576, 32768, 8, 58249216, 114688, 0, 0, 218103940, 0
    .long 2, 64, 72, 7168, 2304, 2304, 7340032, 2621440, 32768, 8, 63737856, 114688, 0, 0, 218104132, 0
    .long 1, 24, 24, 8192, 4608, 4864, 8388608, 3670016, 32768, 8, 35725312, 131072, 0, 0, 218106186, 0
    .long 1, 80, 80, 2048, 3670528, 3670784, 7340032, 60088320, 114688, 7, 127410176, 32768, 218104016, 7, 218106561, 0
    .long 0, 0, 0, 0, 0, 0, 0, 0, 0, 0, 0, 0, 0, 0, 0, 0
    .long 0, 0, 0, 0, 0, 0, 0, 0, 0, 0, 0, 0, 0, 0, 0, 0
    .long 0, 0, 0, 0, 0, 0, 0, 0, 0, 0, 0, 0, 0, 0, 0, 0
    .long 4, 24, 24, 8192, 7168, 269312, 8388608, 0, 32768, 4, 21086208, 131072, 0, 0, 218104433, 0
    .long 4, 24, 24, 8192, 7168, 269312, 8388608, 262144, 32768, 4, 22134784, 131072, 0, 0, 218104436, 0
    .long 4, 16, 16, 8192, 7424, 269568, 8388608, 524288, 32768, 4, 6410240, 131072, 0, 0, 218104689, 0
    .long 1, 16, 16, 8192, 3072, 3328, 8388608, 1572864, 32768, 8, 10534912, 131072, 0, 0, 218105146, 0
    .long 2, 64, 72, 7168, 3584, 3584, 7340032, 1048576, 32768, 8, 58253312, 114688, 0, 0, 218103953, 0
    .long 2, 64, 72, 7168, 2560, 2560, 7340032, 2621440, 32768, 8, 63741952, 114688, 0, 0, 218104132, 0
    .long 1, 24, 24, 8192, 5120, 5376, 8388608, 3670016, 32768, 8, 35733504, 131072, 0, 0, 218106202, 0
    .long 1, 80, 80, 2048, 3671040, 3671296, 7340032, 60088320, 114688, 7, 127418368, 32768, 218104016, 7, 218106561, 0
    .long 0, 0, 0, 0, 0, 0, 0, 0, 0, 0, 0, 0, 0, 0, 0, 0
    .long 0, 0, 0, 0, 0, 0, 0, 0, 0, 0, 0, 0, 0, 0, 0, 0
    .long 0, 0, 0, 0, 0, 0, 0, 0, 0, 0, 0, 0, 0, 0, 0, 0
    .long 4, 24, 24, 8192, 7680, 269824, 8388608, 0, 32768, 4, 21094400, 131072, 0, 0, 218104433, 0
    .long 4, 24, 24, 8192, 7680, 269824, 8388608, 262144, 32768, 4, 22142976, 131072, 0, 0, 218104436, 0
    .long 4, 16, 16, 8192, 7936, 270080, 8388608, 524288, 32768, 4, 6418432, 131072, 0, 0, 218104689, 0
    .long 1, 16, 16, 8192, 3584, 3840, 8388608, 1572864, 32768, 8, 10543104, 131072, 0, 0, 218105146, 0
    .long 2, 64, 72, 7168, 3840, 3840, 7340032, 1048576, 32768, 8, 58257408, 114688, 0, 0, 218103953, 0
    .long 2, 64, 72, 7168, 3840, 3840, 7340032, 2621440, 32768, 8, 63762432, 114688, 0, 0, 218104145, 0
    .long 1, 24, 24, 8192, 7680, 7936, 8388608, 3670016, 32768, 8, 35774464, 131072, 0, 0, 218106234, 0
    .long 1, 80, 80, 2048, 5506560, 5506816, 7340032, 60116992, 114688, 7, 131620864, 32768, 218104020, 7, 218106561, 0
    .long 0, 0, 0, 0, 0, 0, 0, 0, 0, 0, 0, 0, 0, 0, 0, 0
    .long 0, 0, 0, 0, 0, 0, 0, 0, 0, 0, 0, 0, 0, 0, 0, 0
    .long 0, 0, 0, 0, 0, 0, 0, 0, 0, 0, 0, 0, 0, 0, 0, 0
    .long 4, 24, 24, 8192, 6400, 268544, 8388608, 0, 32768, 4, 21073920, 131072, 0, 0, 218104417, 0
    .long 4, 24, 24, 8192, 6400, 268544, 8388608, 262144, 32768, 4, 22122496, 131072, 0, 0, 218104420, 0
    .long 1, 24, 24, 8192, 0, 256, 8388608, 1048576, 32768, 8, 25165824, 131072, 0, 0, 218104842, 0
    .long 1, 32, 32, 8192, 4096, 4352, 8388608, 2097152, 32768, 8, 46202880, 131072, 0, 0, 218105418, 0
    .long 1, 32, 32, 8192, 6144, 6400, 8388608, 2621440, 32768, 8, 48332800, 131072, 0, 0, 218105706, 0
    .long 1, 32, 32, 8192, 4096, 4352, 8388608, 3145728, 32768, 8, 50397184, 131072, 0, 0, 218105930, 0
    .long 1, 80, 80, 2048, 0, 256, 7340032, 54525952, 114688, 7, 117440512, 32768, 218103808, 7, 218106369, 0
    .long 0, 0, 0, 0, 0, 0, 0, 0, 0, 0, 0, 0, 0, 0, 0, 0
    .long 0, 0, 0, 0, 0, 0, 0, 0, 0, 0, 0, 0, 0, 0, 0, 0
    .long 0, 0, 0, 0, 0, 0, 0, 0, 0, 0, 0, 0, 0, 0, 0, 0
    .long 0, 0, 0, 0, 0, 0, 0, 0, 0, 0, 0, 0, 0, 0, 0, 0
    .long 4, 24, 24, 8192, 6912, 269056, 8388608, 0, 32768, 4, 21082112, 131072, 0, 0, 218104417, 0
    .long 4, 24, 24, 8192, 6912, 269056, 8388608, 262144, 32768, 4, 22130688, 131072, 0, 0, 218104420, 0
    .long 1, 24, 24, 8192, 512, 768, 8388608, 1048576, 32768, 8, 25174016, 131072, 0, 0, 218104842, 0
    .long 1, 32, 32, 8192, 4608, 4864, 8388608, 2097152, 32768, 8, 46211072, 131072, 0, 0, 218105418, 0
    .long 1, 32, 32, 8192, 6656, 6912, 8388608, 2621440, 32768, 8, 48340992, 131072, 0, 0, 218105706, 0
    .long 1, 32, 32, 8192, 4608, 4864, 8388608, 3145728, 32768, 8, 50405376, 131072, 0, 0, 218105930, 0
    .long 1, 80, 80, 2048, 512, 768, 7340032, 54525952, 114688, 7, 117448704, 32768, 218103808, 7, 218106369, 0
    .long 0, 0, 0, 0, 0, 0, 0, 0, 0, 0, 0, 0, 0, 0, 0, 0
    .long 0, 0, 0, 0, 0, 0, 0, 0, 0, 0, 0, 0, 0, 0, 0, 0
    .long 0, 0, 0, 0, 0, 0, 0, 0, 0, 0, 0, 0, 0, 0, 0, 0
    .long 0, 0, 0, 0, 0, 0, 0, 0, 0, 0, 0, 0, 0, 0, 0, 0
    .long 4, 24, 24, 8192, 7424, 269568, 8388608, 0, 32768, 4, 21090304, 131072, 0, 0, 218104433, 0
    .long 4, 24, 24, 8192, 7424, 269568, 8388608, 262144, 32768, 4, 22138880, 131072, 0, 0, 218104436, 0
    .long 1, 24, 24, 8192, 1024, 1280, 8388608, 1048576, 32768, 8, 25182208, 131072, 0, 0, 218104858, 0
    .long 1, 32, 32, 8192, 5120, 5376, 8388608, 2097152, 32768, 8, 46219264, 131072, 0, 0, 218105434, 0
    .long 1, 32, 32, 8192, 7168, 7424, 8388608, 2621440, 32768, 8, 48349184, 131072, 0, 0, 218105722, 0
    .long 1, 32, 32, 8192, 5120, 5376, 8388608, 3145728, 32768, 8, 50413568, 131072, 0, 0, 218105946, 0
    .long 1, 80, 80, 2048, 1024, 1280, 7340032, 54525952, 114688, 7, 117456896, 32768, 218103808, 7, 218106369, 0
    .long 0, 0, 0, 0, 0, 0, 0, 0, 0, 0, 0, 0, 0, 0, 0, 0
    .long 0, 0, 0, 0, 0, 0, 0, 0, 0, 0, 0, 0, 0, 0, 0, 0
    .long 0, 0, 0, 0, 0, 0, 0, 0, 0, 0, 0, 0, 0, 0, 0, 0
    .long 0, 0, 0, 0, 0, 0, 0, 0, 0, 0, 0, 0, 0, 0, 0, 0
    .long 4, 24, 24, 8192, 7936, 270080, 8388608, 0, 32768, 4, 21098496, 131072, 0, 0, 218104433, 0
    .long 4, 24, 24, 8192, 7936, 270080, 8388608, 262144, 32768, 4, 22147072, 131072, 0, 0, 218104436, 0
    .long 1, 24, 24, 8192, 1536, 1792, 8388608, 1048576, 32768, 8, 25190400, 131072, 0, 0, 218104858, 0
    .long 1, 32, 32, 8192, 7680, 7936, 8388608, 2097152, 32768, 8, 46260224, 131072, 0, 0, 218105466, 0
    .long 1, 32, 32, 8192, 7680, 7936, 8388608, 2621440, 32768, 8, 48357376, 131072, 0, 0, 218105722, 0
    .long 1, 32, 32, 8192, 5632, 5888, 8388608, 3145728, 32768, 8, 50421760, 131072, 0, 0, 218105946, 0
    .long 1, 80, 80, 2048, 1536, 1792, 7340032, 54525952, 114688, 7, 117465088, 32768, 218103808, 7, 218106369, 0
    .long 0, 0, 0, 0, 0, 0, 0, 0, 0, 0, 0, 0, 0, 0, 0, 0
    .long 0, 0, 0, 0, 0, 0, 0, 0, 0, 0, 0, 0, 0, 0, 0, 0
    .long 0, 0, 0, 0, 0, 0, 0, 0, 0, 0, 0, 0, 0, 0, 0, 0
    .long 0, 0, 0, 0, 0, 0, 0, 0, 0, 0, 0, 0, 0, 0, 0, 0
    .long 4, 32, 32, 8192, 0, 262144, 8388608, 0, 32768, 4, 37748736, 131072, 0, 0, 218104321, 0
    .long 4, 32, 32, 8192, 0, 262144, 8388608, 262144, 32768, 4, 38797312, 131072, 0, 0, 218104324, 0
    .long 1, 24, 24, 8192, 2048, 2304, 8388608, 1048576, 32768, 8, 25198592, 131072, 0, 0, 218104874, 0
    .long 1, 32, 32, 8192, 6144, 6400, 8388608, 2097152, 32768, 8, 46235648, 131072, 0, 0, 218105450, 0
    .long 1, 16, 16, 8192, 0, 256, 8388608, 2621440, 32768, 8, 14680064, 131072, 0, 0, 218105610, 0
    .long 1, 32, 32, 8192, 6144, 6400, 8388608, 3145728, 32768, 8, 50429952, 131072, 0, 0, 218105962, 0
    .long 1, 80, 80, 2048, 1835008, 1835264, 7340032, 54554624, 114688, 7, 121634816, 32768, 218103812, 7, 218106369, 0
    .long 0, 0, 0, 0, 0, 0, 0, 0, 0, 0, 0, 0, 0, 0, 0, 0
    .long 0, 0, 0, 0, 0, 0, 0, 0, 0, 0, 0, 0, 0, 0, 0, 0
    .long 0, 0, 0, 0, 0, 0, 0, 0, 0, 0, 0, 0, 0, 0, 0, 0
    .long 0, 0, 0, 0, 0, 0, 0, 0, 0, 0, 0, 0, 0, 0, 0, 0
    .long 4, 32, 32, 8192, 512, 262656, 8388608, 0, 32768, 4, 37756928, 131072, 0, 0, 218104321, 0
    .long 4, 32, 32, 8192, 512, 262656, 8388608, 262144, 32768, 4, 38805504, 131072, 0, 0, 218104324, 0
    .long 1, 24, 24, 8192, 2560, 2816, 8388608, 1048576, 32768, 8, 25206784, 131072, 0, 0, 218104874, 0
    .long 1, 32, 32, 8192, 6656, 6912, 8388608, 2097152, 32768, 8, 46243840, 131072, 0, 0, 218105450, 0
    .long 1, 16, 16, 8192, 512, 768, 8388608, 2621440, 32768, 8, 14688256, 131072, 0, 0, 218105610, 0
    .long 1, 32, 32, 8192, 6656, 6912, 8388608, 3145728, 32768, 8, 50438144, 131072, 0, 0, 218105962, 0
    .long 1, 80, 80, 2048, 1835520, 1835776, 7340032, 54554624, 114688, 7, 121643008, 32768, 218103812, 7, 218106369, 0
    .long 0, 0, 0, 0, 0, 0, 0, 0, 0, 0, 0, 0, 0, 0, 0, 0
    .long 0, 0, 0, 0, 0, 0, 0, 0, 0, 0, 0, 0, 0, 0, 0, 0
    .long 0, 0, 0, 0, 0, 0, 0, 0, 0, 0, 0, 0, 0, 0, 0, 0
    .long 0, 0, 0, 0, 0, 0, 0, 0, 0, 0, 0, 0, 0, 0, 0, 0
    .long 4, 32, 32, 8192, 1024, 263168, 8388608, 0, 32768, 4, 37765120, 131072, 0, 0, 218104337, 0
    .long 4, 32, 32, 8192, 1024, 263168, 8388608, 262144, 32768, 4, 38813696, 131072, 0, 0, 218104340, 0
    .long 1, 24, 24, 8192, 3072, 3328, 8388608, 1048576, 32768, 8, 25214976, 131072, 0, 0, 218104890, 0
    .long 1, 32, 32, 8192, 7168, 7424, 8388608, 2097152, 32768, 8, 46252032, 131072, 0, 0, 218105466, 0
    .long 1, 16, 16, 8192, 1024, 1280, 8388608, 2621440, 32768, 8, 14696448, 131072, 0, 0, 218105626, 0
    .long 1, 32, 32, 8192, 7168, 7424, 8388608, 3145728, 32768, 8, 50446336, 131072, 0, 0, 218105978, 0
    .long 1, 80, 80, 2048, 1836032, 1836288, 7340032, 54554624, 114688, 7, 121651200, 32768, 218103812, 7, 218106369, 0
    .long 0, 0, 0, 0, 0, 0, 0, 0, 0, 0, 0, 0, 0, 0, 0, 0
    .long 0, 0, 0, 0, 0, 0, 0, 0, 0, 0, 0, 0, 0, 0, 0, 0
    .long 0, 0, 0, 0, 0, 0, 0, 0, 0, 0, 0, 0, 0, 0, 0, 0
    .long 0, 0, 0, 0, 0, 0, 0, 0, 0, 0, 0, 0, 0, 0, 0, 0
    .long 4, 32, 32, 8192, 1536, 263680, 8388608, 0, 32768, 4, 37773312, 131072, 0, 0, 218104337, 0
    .long 4, 32, 32, 8192, 1536, 263680, 8388608, 262144, 32768, 4, 38821888, 131072, 0, 0, 218104340, 0
    .long 1, 24, 24, 8192, 3584, 3840, 8388608, 1048576, 32768, 8, 25223168, 131072, 0, 0, 218104890, 0
    .long 1, 16, 16, 8192, 1536, 1792, 8388608, 2097152, 32768, 8, 12607488, 131072, 0, 0, 218105370, 0
    .long 1, 16, 16, 8192, 1536, 1792, 8388608, 2621440, 32768, 8, 14704640, 131072, 0, 0, 218105626, 0
    .long 1, 32, 32, 8192, 7680, 7936, 8388608, 3145728, 32768, 8, 50454528, 131072, 0, 0, 218105978, 0
    .long 1, 80, 80, 2048, 1836544, 1836800, 7340032, 54554624, 114688, 7, 121659392, 32768, 218103812, 7, 218106369, 0
    .long 0, 0, 0, 0, 0, 0, 0, 0, 0, 0, 0, 0, 0, 0, 0, 0
    .long 0, 0, 0, 0, 0, 0, 0, 0, 0, 0, 0, 0, 0, 0, 0, 0
    .long 0, 0, 0, 0, 0, 0, 0, 0, 0, 0, 0, 0, 0, 0, 0, 0
    .long 0, 0, 0, 0, 0, 0, 0, 0, 0, 0, 0, 0, 0, 0, 0, 0
    .long 4, 32, 32, 8192, 256, 262400, 8388608, 0, 32768, 4, 37752832, 131072, 0, 0, 218104321, 0
    .long 4, 32, 32, 8192, 256, 262400, 8388608, 262144, 32768, 4, 38801408, 131072, 0, 0, 218104324, 0
    .long 1, 24, 24, 8192, 4096, 4352, 8388608, 1048576, 32768, 8, 25231360, 131072, 0, 0, 218104906, 0
    .long 1, 16, 16, 8192, 0, 256, 8388608, 2097152, 32768, 8, 12582912, 131072, 0, 0, 218105354, 0
    .long 1, 16, 16, 8192, 2048, 2304, 8388608, 2621440, 32768, 8, 14712832, 131072, 0, 0, 218105642, 0
    .long 1, 16, 16, 8192, 0, 256, 8388608, 3145728, 32768, 8, 16777216, 131072, 0, 0, 218105866, 0
    .long 1, 80, 80, 2048, 3670016, 3670272, 7340032, 54583296, 114688, 7, 125829120, 32768, 218103824, 7, 218106369, 0
    .long 0, 0, 0, 0, 0, 0, 0, 0, 0, 0, 0, 0, 0, 0, 0, 0
    .long 0, 0, 0, 0, 0, 0, 0, 0, 0, 0, 0, 0, 0, 0, 0, 0
    .long 0, 0, 0, 0, 0, 0, 0, 0, 0, 0, 0, 0, 0, 0, 0, 0
    .long 0, 0, 0, 0, 0, 0, 0, 0, 0, 0, 0, 0, 0, 0, 0, 0
    .long 4, 32, 32, 8192, 768, 262912, 8388608, 0, 32768, 4, 37761024, 131072, 0, 0, 218104321, 0
    .long 4, 32, 32, 8192, 768, 262912, 8388608, 262144, 32768, 4, 38809600, 131072, 0, 0, 218104324, 0
    .long 1, 24, 24, 8192, 4608, 4864, 8388608, 1048576, 32768, 8, 25239552, 131072, 0, 0, 218104906, 0
    .long 1, 16, 16, 8192, 512, 768, 8388608, 2097152, 32768, 8, 12591104, 131072, 0, 0, 218105354, 0
    .long 1, 16, 16, 8192, 2560, 2816, 8388608, 2621440, 32768, 8, 14721024, 131072, 0, 0, 218105642, 0
    .long 1, 16, 16, 8192, 512, 768, 8388608, 3145728, 32768, 8, 16785408, 131072, 0, 0, 218105866, 0
    .long 1, 80, 80, 2048, 3670528, 3670784, 7340032, 54583296, 114688, 7, 125837312, 32768, 218103824, 7, 218106369, 0
    .long 0, 0, 0, 0, 0, 0, 0, 0, 0, 0, 0, 0, 0, 0, 0, 0
    .long 0, 0, 0, 0, 0, 0, 0, 0, 0, 0, 0, 0, 0, 0, 0, 0
    .long 0, 0, 0, 0, 0, 0, 0, 0, 0, 0, 0, 0, 0, 0, 0, 0
    .long 0, 0, 0, 0, 0, 0, 0, 0, 0, 0, 0, 0, 0, 0, 0, 0
    .long 4, 32, 32, 8192, 1280, 263424, 8388608, 0, 32768, 4, 37769216, 131072, 0, 0, 218104337, 0
    .long 4, 32, 32, 8192, 1280, 263424, 8388608, 262144, 32768, 4, 38817792, 131072, 0, 0, 218104340, 0
    .long 1, 24, 24, 8192, 5120, 5376, 8388608, 1048576, 32768, 8, 25247744, 131072, 0, 0, 218104922, 0
    .long 1, 16, 16, 8192, 1024, 1280, 8388608, 2097152, 32768, 8, 12599296, 131072, 0, 0, 218105370, 0
    .long 1, 16, 16, 8192, 3072, 3328, 8388608, 2621440, 32768, 8, 14729216, 131072, 0, 0, 218105658, 0
    .long 1, 16, 16, 8192, 1024, 1280, 8388608, 3145728, 32768, 8, 16793600, 131072, 0, 0, 218105882, 0
    .long 1, 80, 80, 2048, 3671040, 3671296, 7340032, 54583296, 114688, 7, 125845504, 32768, 218103824, 7, 218106369, 0
    .long 0, 0, 0, 0, 0, 0, 0, 0, 0, 0, 0, 0, 0, 0, 0, 0
    .long 0, 0, 0, 0, 0, 0, 0, 0, 0, 0, 0, 0, 0, 0, 0, 0
    .long 0, 0, 0, 0, 0, 0, 0, 0, 0, 0, 0, 0, 0, 0, 0, 0
    .long 0, 0, 0, 0, 0, 0, 0, 0, 0, 0, 0, 0, 0, 0, 0, 0
    .long 4, 32, 32, 8192, 1792, 263936, 8388608, 0, 32768, 4, 37777408, 131072, 0, 0, 218104337, 0
    .long 4, 32, 32, 8192, 1792, 263936, 8388608, 262144, 32768, 4, 38825984, 131072, 0, 0, 218104340, 0
    .long 1, 24, 24, 8192, 5632, 5888, 8388608, 1048576, 32768, 8, 25255936, 131072, 0, 0, 218104922, 0
    .long 1, 16, 16, 8192, 3584, 3840, 8388608, 2097152, 32768, 8, 12640256, 131072, 0, 0, 218105402, 0
    .long 1, 16, 16, 8192, 3584, 3840, 8388608, 2621440, 32768, 8, 14737408, 131072, 0, 0, 218105658, 0
    .long 1, 16, 16, 8192, 1536, 1792, 8388608, 3145728, 32768, 8, 16801792, 131072, 0, 0, 218105882, 0
    .long 1, 80, 80, 2048, 3671552, 3671808, 7340032, 54583296, 114688, 7, 125853696, 32768, 218103824, 7, 218106369, 0
    .long 0, 0, 0, 0, 0, 0, 0, 0, 0, 0, 0, 0, 0, 0, 0, 0
    .long 0, 0, 0, 0, 0, 0, 0, 0, 0, 0, 0, 0, 0, 0, 0, 0
    .long 0, 0, 0, 0, 0, 0, 0, 0, 0, 0, 0, 0, 0, 0, 0, 0
    .long 0, 0, 0, 0, 0, 0, 0, 0, 0, 0, 0, 0, 0, 0, 0, 0
    .long 4, 32, 32, 8192, 2048, 264192, 8388608, 0, 32768, 4, 37781504, 131072, 0, 0, 218104353, 0
    .long 4, 32, 32, 8192, 2048, 264192, 8388608, 262144, 32768, 4, 38830080, 131072, 0, 0, 218104356, 0
    .long 1, 24, 24, 8192, 6144, 6400, 8388608, 1048576, 32768, 8, 25264128, 131072, 0, 0, 218104938, 0
    .long 1, 16, 16, 8192, 2048, 2304, 8388608, 2097152, 32768, 8, 12615680, 131072, 0, 0, 218105386, 0
    .long 1, 16, 16, 8192, 4096, 4352, 8388608, 2621440, 32768, 8, 14745600, 131072, 0, 0, 218105674, 0
    .long 1, 16, 16, 8192, 2048, 2304, 8388608, 3145728, 32768, 8, 16809984, 131072, 0, 0, 218105898, 0
    .long 1, 80, 80, 2048, 5505024, 5505280, 7340032, 54611968, 114688, 7, 130023424, 32768, 218103828, 7, 218106369, 0
    .long 0, 0, 0, 0, 0, 0, 0, 0, 0, 0, 0, 0, 0, 0, 0, 0
    .long 0, 0, 0, 0, 0, 0, 0, 0, 0, 0, 0, 0, 0, 0, 0, 0
    .long 0, 0, 0, 0, 0, 0, 0, 0, 0, 0, 0, 0, 0, 0, 0, 0
    .long 0, 0, 0, 0, 0, 0, 0, 0, 0, 0, 0, 0, 0, 0, 0, 0
    .long 4, 32, 32, 8192, 2560, 264704, 8388608, 0, 32768, 4, 37789696, 131072, 0, 0, 218104353, 0
    .long 4, 32, 32, 8192, 2560, 264704, 8388608, 262144, 32768, 4, 38838272, 131072, 0, 0, 218104356, 0
    .long 1, 24, 24, 8192, 6656, 6912, 8388608, 1048576, 32768, 8, 25272320, 131072, 0, 0, 218104938, 0
    .long 1, 16, 16, 8192, 2560, 2816, 8388608, 2097152, 32768, 8, 12623872, 131072, 0, 0, 218105386, 0
    .long 1, 16, 16, 8192, 4608, 4864, 8388608, 2621440, 32768, 8, 14753792, 131072, 0, 0, 218105674, 0
    .long 1, 16, 16, 8192, 2560, 2816, 8388608, 3145728, 32768, 8, 16818176, 131072, 0, 0, 218105898, 0
    .long 1, 80, 80, 2048, 5505536, 5505792, 7340032, 54611968, 114688, 7, 130031616, 32768, 218103828, 7, 218106369, 0
    .long 0, 0, 0, 0, 0, 0, 0, 0, 0, 0, 0, 0, 0, 0, 0, 0
    .long 0, 0, 0, 0, 0, 0, 0, 0, 0, 0, 0, 0, 0, 0, 0, 0
    .long 0, 0, 0, 0, 0, 0, 0, 0, 0, 0, 0, 0, 0, 0, 0, 0
    .long 0, 0, 0, 0, 0, 0, 0, 0, 0, 0, 0, 0, 0, 0, 0, 0
    .long 4, 32, 32, 8192, 3072, 265216, 8388608, 0, 32768, 4, 37797888, 131072, 0, 0, 218104369, 0
    .long 4, 32, 32, 8192, 3072, 265216, 8388608, 262144, 32768, 4, 38846464, 131072, 0, 0, 218104372, 0
    .long 1, 24, 24, 8192, 7168, 7424, 8388608, 1048576, 32768, 8, 25280512, 131072, 0, 0, 218104954, 0
    .long 1, 16, 16, 8192, 3072, 3328, 8388608, 2097152, 32768, 8, 12632064, 131072, 0, 0, 218105402, 0
    .long 1, 16, 16, 8192, 5120, 5376, 8388608, 2621440, 32768, 8, 14761984, 131072, 0, 0, 218105690, 0
    .long 1, 16, 16, 8192, 3072, 3328, 8388608, 3145728, 32768, 8, 16826368, 131072, 0, 0, 218105914, 0
    .long 1, 80, 80, 2048, 5506048, 5506304, 7340032, 54611968, 114688, 7, 130039808, 32768, 218103828, 7, 218106369, 0
    .long 0, 0, 0, 0, 0, 0, 0, 0, 0, 0, 0, 0, 0, 0, 0, 0
    .long 0, 0, 0, 0, 0, 0, 0, 0, 0, 0, 0, 0, 0, 0, 0, 0
    .long 0, 0, 0, 0, 0, 0, 0, 0, 0, 0, 0, 0, 0, 0, 0, 0
    .long 0, 0, 0, 0, 0, 0, 0, 0, 0, 0, 0, 0, 0, 0, 0, 0
    .long 4, 32, 32, 8192, 3584, 265728, 8388608, 0, 32768, 4, 37806080, 131072, 0, 0, 218104369, 0
    .long 4, 32, 32, 8192, 3584, 265728, 8388608, 262144, 32768, 4, 38854656, 131072, 0, 0, 218104372, 0
    .long 1, 24, 24, 8192, 7680, 7936, 8388608, 1048576, 32768, 8, 25288704, 131072, 0, 0, 218104954, 0
    .long 1, 16, 16, 8192, 5632, 5888, 8388608, 2097152, 32768, 8, 12673024, 131072, 0, 0, 218105434, 0
    .long 1, 16, 16, 8192, 5632, 5888, 8388608, 2621440, 32768, 8, 14770176, 131072, 0, 0, 218105690, 0
    .long 1, 16, 16, 8192, 3584, 3840, 8388608, 3145728, 32768, 8, 16834560, 131072, 0, 0, 218105914, 0
    .long 1, 80, 80, 2048, 5506560, 5506816, 7340032, 54611968, 114688, 7, 130048000, 32768, 218103828, 7, 218106369, 0
    .long 0, 0, 0, 0, 0, 0, 0, 0, 0, 0, 0, 0, 0, 0, 0, 0
    .long 0, 0, 0, 0, 0, 0, 0, 0, 0, 0, 0, 0, 0, 0, 0, 0
    .long 0, 0, 0, 0, 0, 0, 0, 0, 0, 0, 0, 0, 0, 0, 0, 0
    .long 0, 0, 0, 0, 0, 0, 0, 0, 0, 0, 0, 0, 0, 0, 0, 0
    .long 4, 32, 32, 8192, 2304, 264448, 8388608, 0, 32768, 4, 37785600, 131072, 0, 0, 218104353, 0
    .long 4, 32, 32, 8192, 2304, 264448, 8388608, 262144, 32768, 4, 38834176, 131072, 0, 0, 218104356, 0
    .long 1, 32, 32, 8192, 0, 256, 8388608, 1048576, 32768, 8, 41943040, 131072, 0, 0, 218104842, 0
    .long 1, 16, 16, 8192, 4096, 4352, 8388608, 2097152, 32768, 8, 12648448, 131072, 0, 0, 218105418, 0
    .long 1, 16, 16, 8192, 6144, 6400, 8388608, 2621440, 32768, 8, 14778368, 131072, 0, 0, 218105706, 0
    .long 1, 16, 16, 8192, 4096, 4352, 8388608, 3145728, 32768, 8, 16842752, 131072, 0, 0, 218105930, 0
    .long 1, 80, 80, 2048, 0, 256, 7340032, 56360960, 114688, 7, 117964800, 32768, 218103872, 7, 218106433, 0
    .long 0, 0, 0, 0, 0, 0, 0, 0, 0, 0, 0, 0, 0, 0, 0, 0
    .long 0, 0, 0, 0, 0, 0, 0, 0, 0, 0, 0, 0, 0, 0, 0, 0
    .long 0, 0, 0, 0, 0, 0, 0, 0, 0, 0, 0, 0, 0, 0, 0, 0
    .long 0, 0, 0, 0, 0, 0, 0, 0, 0, 0, 0, 0, 0, 0, 0, 0
    .long 4, 32, 32, 8192, 2816, 264960, 8388608, 0, 32768, 4, 37793792, 131072, 0, 0, 218104353, 0
    .long 4, 32, 32, 8192, 2816, 264960, 8388608, 262144, 32768, 4, 38842368, 131072, 0, 0, 218104356, 0
    .long 1, 32, 32, 8192, 512, 768, 8388608, 1048576, 32768, 8, 41951232, 131072, 0, 0, 218104842, 0
    .long 1, 16, 16, 8192, 4608, 4864, 8388608, 2097152, 32768, 8, 12656640, 131072, 0, 0, 218105418, 0
    .long 1, 16, 16, 8192, 6656, 6912, 8388608, 2621440, 32768, 8, 14786560, 131072, 0, 0, 218105706, 0
    .long 1, 16, 16, 8192, 4608, 4864, 8388608, 3145728, 32768, 8, 16850944, 131072, 0, 0, 218105930, 0
    .long 1, 80, 80, 2048, 512, 768, 7340032, 56360960, 114688, 7, 117972992, 32768, 218103872, 7, 218106433, 0
    .long 0, 0, 0, 0, 0, 0, 0, 0, 0, 0, 0, 0, 0, 0, 0, 0
    .long 0, 0, 0, 0, 0, 0, 0, 0, 0, 0, 0, 0, 0, 0, 0, 0
    .long 0, 0, 0, 0, 0, 0, 0, 0, 0, 0, 0, 0, 0, 0, 0, 0
    .long 0, 0, 0, 0, 0, 0, 0, 0, 0, 0, 0, 0, 0, 0, 0, 0
    .long 4, 32, 32, 8192, 3328, 265472, 8388608, 0, 32768, 4, 37801984, 131072, 0, 0, 218104369, 0
    .long 4, 32, 32, 8192, 3328, 265472, 8388608, 262144, 32768, 4, 38850560, 131072, 0, 0, 218104372, 0
    .long 1, 32, 32, 8192, 1024, 1280, 8388608, 1048576, 32768, 8, 41959424, 131072, 0, 0, 218104858, 0
    .long 1, 16, 16, 8192, 5120, 5376, 8388608, 2097152, 32768, 8, 12664832, 131072, 0, 0, 218105434, 0
    .long 1, 16, 16, 8192, 7168, 7424, 8388608, 2621440, 32768, 8, 14794752, 131072, 0, 0, 218105722, 0
    .long 1, 16, 16, 8192, 5120, 5376, 8388608, 3145728, 32768, 8, 16859136, 131072, 0, 0, 218105946, 0
    .long 1, 80, 80, 2048, 1024, 1280, 7340032, 56360960, 114688, 7, 117981184, 32768, 218103872, 7, 218106433, 0
    .long 0, 0, 0, 0, 0, 0, 0, 0, 0, 0, 0, 0, 0, 0, 0, 0
    .long 0, 0, 0, 0, 0, 0, 0, 0, 0, 0, 0, 0, 0, 0, 0, 0
    .long 0, 0, 0, 0, 0, 0, 0, 0, 0, 0, 0, 0, 0, 0, 0, 0
    .long 0, 0, 0, 0, 0, 0, 0, 0, 0, 0, 0, 0, 0, 0, 0, 0
    .long 4, 32, 32, 8192, 3840, 265984, 8388608, 0, 32768, 4, 37810176, 131072, 0, 0, 218104369, 0
    .long 4, 32, 32, 8192, 3840, 265984, 8388608, 262144, 32768, 4, 38858752, 131072, 0, 0, 218104372, 0
    .long 1, 32, 32, 8192, 1536, 1792, 8388608, 1048576, 32768, 8, 41967616, 131072, 0, 0, 218104858, 0
    .long 1, 16, 16, 8192, 7680, 7936, 8388608, 2097152, 32768, 8, 12705792, 131072, 0, 0, 218105466, 0
    .long 1, 16, 16, 8192, 7680, 7936, 8388608, 2621440, 32768, 8, 14802944, 131072, 0, 0, 218105722, 0
    .long 1, 16, 16, 8192, 5632, 5888, 8388608, 3145728, 32768, 8, 16867328, 131072, 0, 0, 218105946, 0
    .long 1, 80, 80, 2048, 1536, 1792, 7340032, 56360960, 114688, 7, 117989376, 32768, 218103872, 7, 218106433, 0
    .long 0, 0, 0, 0, 0, 0, 0, 0, 0, 0, 0, 0, 0, 0, 0, 0
    .long 0, 0, 0, 0, 0, 0, 0, 0, 0, 0, 0, 0, 0, 0, 0, 0
    .long 0, 0, 0, 0, 0, 0, 0, 0, 0, 0, 0, 0, 0, 0, 0, 0
    .long 0, 0, 0, 0, 0, 0, 0, 0, 0, 0, 0, 0, 0, 0, 0, 0
    .long 4, 32, 32, 8192, 4096, 266240, 8388608, 0, 32768, 4, 37814272, 131072, 0, 0, 218104385, 0
    .long 4, 32, 32, 8192, 4096, 266240, 8388608, 262144, 32768, 4, 38862848, 131072, 0, 0, 218104388, 0
    .long 1, 32, 32, 8192, 2048, 2304, 8388608, 1048576, 32768, 8, 41975808, 131072, 0, 0, 218104874, 0
    .long 1, 16, 16, 8192, 6144, 6400, 8388608, 2097152, 32768, 8, 12681216, 131072, 0, 0, 218105450, 0
    .long 2, 64, 72, 7168, 0, 0, 7340032, 1572864, 32768, 8, 60030976, 114688, 0, 0, 218104001, 0
    .long 1, 16, 16, 8192, 6144, 6400, 8388608, 3145728, 32768, 8, 16875520, 131072, 0, 0, 218105962, 0
    .long 1, 80, 80, 2048, 1835008, 1835264, 7340032, 56389632, 114688, 7, 122159104, 32768, 218103876, 7, 218106433, 0
    .long 0, 0, 0, 0, 0, 0, 0, 0, 0, 0, 0, 0, 0, 0, 0, 0
    .long 0, 0, 0, 0, 0, 0, 0, 0, 0, 0, 0, 0, 0, 0, 0, 0
    .long 0, 0, 0, 0, 0, 0, 0, 0, 0, 0, 0, 0, 0, 0, 0, 0
    .long 0, 0, 0, 0, 0, 0, 0, 0, 0, 0, 0, 0, 0, 0, 0, 0
    .long 4, 32, 32, 8192, 4608, 266752, 8388608, 0, 32768, 4, 37822464, 131072, 0, 0, 218104385, 0
    .long 4, 32, 32, 8192, 4608, 266752, 8388608, 262144, 32768, 4, 38871040, 131072, 0, 0, 218104388, 0
    .long 1, 32, 32, 8192, 2560, 2816, 8388608, 1048576, 32768, 8, 41984000, 131072, 0, 0, 218104874, 0
    .long 1, 16, 16, 8192, 6656, 6912, 8388608, 2097152, 32768, 8, 12689408, 131072, 0, 0, 218105450, 0
    .long 2, 64, 72, 7168, 256, 256, 7340032, 1572864, 32768, 8, 60035072, 114688, 0, 0, 218104001, 0
    .long 1, 16, 16, 8192, 6656, 6912, 8388608, 3145728, 32768, 8, 16883712, 131072, 0, 0, 218105962, 0
    .long 1, 80, 80, 2048, 1835520, 1835776, 7340032, 56389632, 114688, 7, 122167296, 32768, 218103876, 7, 218106433, 0
    .long 0, 0, 0, 0, 0, 0, 0, 0, 0, 0, 0, 0, 0, 0, 0, 0
    .long 0, 0, 0, 0, 0, 0, 0, 0, 0, 0, 0, 0, 0, 0, 0, 0
    .long 0, 0, 0, 0, 0, 0, 0, 0, 0, 0, 0, 0, 0, 0, 0, 0
    .long 0, 0, 0, 0, 0, 0, 0, 0, 0, 0, 0, 0, 0, 0, 0, 0
    .long 4, 32, 32, 8192, 5120, 267264, 8388608, 0, 32768, 4, 37830656, 131072, 0, 0, 218104401, 0
    .long 4, 32, 32, 8192, 5120, 267264, 8388608, 262144, 32768, 4, 38879232, 131072, 0, 0, 218104404, 0
    .long 1, 32, 32, 8192, 3072, 3328, 8388608, 1048576, 32768, 8, 41992192, 131072, 0, 0, 218104890, 0
    .long 1, 16, 16, 8192, 7168, 7424, 8388608, 2097152, 32768, 8, 12697600, 131072, 0, 0, 218105466, 0
    .long 2, 64, 72, 7168, 512, 512, 7340032, 1572864, 32768, 8, 60039168, 114688, 0, 0, 218104001, 0
    .long 1, 16, 16, 8192, 7168, 7424, 8388608, 3145728, 32768, 8, 16891904, 131072, 0, 0, 218105978, 0
    .long 1, 80, 80, 2048, 1836032, 1836288, 7340032, 56389632, 114688, 7, 122175488, 32768, 218103876, 7, 218106433, 0
    .long 0, 0, 0, 0, 0, 0, 0, 0, 0, 0, 0, 0, 0, 0, 0, 0
    .long 0, 0, 0, 0, 0, 0, 0, 0, 0, 0, 0, 0, 0, 0, 0, 0
    .long 0, 0, 0, 0, 0, 0, 0, 0, 0, 0, 0, 0, 0, 0, 0, 0
    .long 0, 0, 0, 0, 0, 0, 0, 0, 0, 0, 0, 0, 0, 0, 0, 0
    .long 4, 32, 32, 8192, 5632, 267776, 8388608, 0, 32768, 4, 37838848, 131072, 0, 0, 218104401, 0
    .long 4, 32, 32, 8192, 5632, 267776, 8388608, 262144, 32768, 4, 38887424, 131072, 0, 0, 218104404, 0
    .long 1, 32, 32, 8192, 3584, 3840, 8388608, 1048576, 32768, 8, 42000384, 131072, 0, 0, 218104890, 0
    .long 2, 64, 72, 7168, 1792, 1792, 7340032, 0, 32768, 8, 54554624, 114688, 0, 0, 218103812, 0
    .long 2, 64, 72, 7168, 768, 768, 7340032, 1572864, 32768, 8, 60043264, 114688, 0, 0, 218104001, 0
    .long 1, 16, 16, 8192, 7680, 7936, 8388608, 3145728, 32768, 8, 16900096, 131072, 0, 0, 218105978, 0
    .long 1, 80, 80, 2048, 1836544, 1836800, 7340032, 56389632, 114688, 7, 122183680, 32768, 218103876, 7, 218106433, 0
    .long 0, 0, 0, 0, 0, 0, 0, 0, 0, 0, 0, 0, 0, 0, 0, 0
    .long 0, 0, 0, 0, 0, 0, 0, 0, 0, 0, 0, 0, 0, 0, 0, 0
    .long 0, 0, 0, 0, 0, 0, 0, 0, 0, 0, 0, 0, 0, 0, 0, 0
    .long 0, 0, 0, 0, 0, 0, 0, 0, 0, 0, 0, 0, 0, 0, 0, 0
    .long 4, 32, 32, 8192, 4352, 266496, 8388608, 0, 32768, 4, 37818368, 131072, 0, 0, 218104385, 0
    .long 4, 32, 32, 8192, 4352, 266496, 8388608, 262144, 32768, 4, 38866944, 131072, 0, 0, 218104388, 0
    .long 1, 32, 32, 8192, 4096, 4352, 8388608, 1048576, 32768, 8, 42008576, 131072, 0, 0, 218104906, 0
    .long 2, 64, 72, 7168, 2048, 2048, 7340032, 0, 32768, 8, 54558720, 114688, 0, 0, 218103812, 0
    .long 2, 64, 72, 7168, 1024, 1024, 7340032, 1572864, 32768, 8, 60047360, 114688, 0, 0, 218104001, 0
    .long 2, 64, 72, 7168, 0, 0, 7340032, 3145728, 32768, 8, 65536000, 114688, 0, 0, 218104193, 0
    .long 1, 80, 80, 2048, 3670016, 3670272, 7340032, 56418304, 114688, 7, 126353408, 32768, 218103888, 7, 218106433, 0
    .long 0, 0, 0, 0, 0, 0, 0, 0, 0, 0, 0, 0, 0, 0, 0, 0
    .long 0, 0, 0, 0, 0, 0, 0, 0, 0, 0, 0, 0, 0, 0, 0, 0
    .long 0, 0, 0, 0, 0, 0, 0, 0, 0, 0, 0, 0, 0, 0, 0, 0
    .long 0, 0, 0, 0, 0, 0, 0, 0, 0, 0, 0, 0, 0, 0, 0, 0
    .long 4, 32, 32, 8192, 4864, 267008, 8388608, 0, 32768, 4, 37826560, 131072, 0, 0, 218104385, 0
    .long 4, 32, 32, 8192, 4864, 267008, 8388608, 262144, 32768, 4, 38875136, 131072, 0, 0, 218104388, 0
    .long 1, 32, 32, 8192, 4608, 4864, 8388608, 1048576, 32768, 8, 42016768, 131072, 0, 0, 218104906, 0
    .long 2, 64, 72, 7168, 2304, 2304, 7340032, 0, 32768, 8, 54562816, 114688, 0, 0, 218103812, 0
    .long 2, 64, 72, 7168, 1280, 1280, 7340032, 1572864, 32768, 8, 60051456, 114688, 0, 0, 218104001, 0
    .long 2, 64, 72, 7168, 256, 256, 7340032, 3145728, 32768, 8, 65540096, 114688, 0, 0, 218104193, 0
    .long 1, 80, 80, 2048, 3670528, 3670784, 7340032, 56418304, 114688, 7, 126361600, 32768, 218103888, 7, 218106433, 0
    .long 0, 0, 0, 0, 0, 0, 0, 0, 0, 0, 0, 0, 0, 0, 0, 0
    .long 0, 0, 0, 0, 0, 0, 0, 0, 0, 0, 0, 0, 0, 0, 0, 0
    .long 0, 0, 0, 0, 0, 0, 0, 0, 0, 0, 0, 0, 0, 0, 0, 0
    .long 0, 0, 0, 0, 0, 0, 0, 0, 0, 0, 0, 0, 0, 0, 0, 0
    .long 4, 32, 32, 8192, 5376, 267520, 8388608, 0, 32768, 4, 37834752, 131072, 0, 0, 218104401, 0
    .long 4, 32, 32, 8192, 5376, 267520, 8388608, 262144, 32768, 4, 38883328, 131072, 0, 0, 218104404, 0
    .long 1, 32, 32, 8192, 5120, 5376, 8388608, 1048576, 32768, 8, 42024960, 131072, 0, 0, 218104922, 0
    .long 2, 64, 72, 7168, 2560, 2560, 7340032, 0, 32768, 8, 54566912, 114688, 0, 0, 218103812, 0
    .long 2, 64, 72, 7168, 1536, 1536, 7340032, 1572864, 32768, 8, 60055552, 114688, 0, 0, 218104001, 0
    .long 2, 64, 72, 7168, 512, 512, 7340032, 3145728, 32768, 8, 65544192, 114688, 0, 0, 218104193, 0
    .long 1, 80, 80, 2048, 3671040, 3671296, 7340032, 56418304, 114688, 7, 126369792, 32768, 218103888, 7, 218106433, 0
    .long 0, 0, 0, 0, 0, 0, 0, 0, 0, 0, 0, 0, 0, 0, 0, 0
    .long 0, 0, 0, 0, 0, 0, 0, 0, 0, 0, 0, 0, 0, 0, 0, 0
    .long 0, 0, 0, 0, 0, 0, 0, 0, 0, 0, 0, 0, 0, 0, 0, 0
    .long 0, 0, 0, 0, 0, 0, 0, 0, 0, 0, 0, 0, 0, 0, 0, 0
    .long 4, 32, 32, 8192, 5888, 268032, 8388608, 0, 32768, 4, 37842944, 131072, 0, 0, 218104401, 0
    .long 4, 32, 32, 8192, 5888, 268032, 8388608, 262144, 32768, 4, 38891520, 131072, 0, 0, 218104404, 0
    .long 1, 32, 32, 8192, 5632, 5888, 8388608, 1048576, 32768, 8, 42033152, 131072, 0, 0, 218104922, 0
    .long 2, 64, 72, 7168, 2816, 2816, 7340032, 0, 32768, 8, 54571008, 114688, 0, 0, 218103812, 0
    .long 2, 64, 72, 7168, 1792, 1792, 7340032, 1572864, 32768, 8, 60059648, 114688, 0, 0, 218104004, 0
    .long 2, 64, 72, 7168, 768, 768, 7340032, 3145728, 32768, 8, 65548288, 114688, 0, 0, 218104193, 0
    .long 1, 80, 80, 2048, 3671552, 3671808, 7340032, 56418304, 114688, 7, 126377984, 32768, 218103888, 7, 218106433, 0
    .long 0, 0, 0, 0, 0, 0, 0, 0, 0, 0, 0, 0, 0, 0, 0, 0
    .long 0, 0, 0, 0, 0, 0, 0, 0, 0, 0, 0, 0, 0, 0, 0, 0
    .long 0, 0, 0, 0, 0, 0, 0, 0, 0, 0, 0, 0, 0, 0, 0, 0
    .long 0, 0, 0, 0, 0, 0, 0, 0, 0, 0, 0, 0, 0, 0, 0, 0
    .long 4, 32, 32, 8192, 6144, 268288, 8388608, 0, 32768, 4, 37847040, 131072, 0, 0, 218104417, 0
    .long 4, 32, 32, 8192, 6144, 268288, 8388608, 262144, 32768, 4, 38895616, 131072, 0, 0, 218104420, 0
    .long 1, 32, 32, 8192, 6144, 6400, 8388608, 1048576, 32768, 8, 42041344, 131072, 0, 0, 218104938, 0
    .long 2, 64, 72, 7168, 3072, 3072, 7340032, 0, 32768, 8, 54575104, 114688, 0, 0, 218103812, 0
    .long 2, 64, 72, 7168, 2048, 2048, 7340032, 1572864, 32768, 8, 60063744, 114688, 0, 0, 218104004, 0
    .long 2, 64, 72, 7168, 1024, 1024, 7340032, 3145728, 32768, 8, 65552384, 114688, 0, 0, 218104193, 0
    .long 1, 80, 80, 2048, 5505024, 5505280, 7340032, 56446976, 114688, 7, 130547712, 32768, 218103892, 7, 218106433, 0
    .long 0, 0, 0, 0, 0, 0, 0, 0, 0, 0, 0, 0, 0, 0, 0, 0
    .long 0, 0, 0, 0, 0, 0, 0, 0, 0, 0, 0, 0, 0, 0, 0, 0
    .long 0, 0, 0, 0, 0, 0, 0, 0, 0, 0, 0, 0, 0, 0, 0, 0
    .long 0, 0, 0, 0, 0, 0, 0, 0, 0, 0, 0, 0, 0, 0, 0, 0
    .long 4, 32, 32, 8192, 6656, 268800, 8388608, 0, 32768, 4, 37855232, 131072, 0, 0, 218104417, 0
    .long 4, 32, 32, 8192, 6656, 268800, 8388608, 262144, 32768, 4, 38903808, 131072, 0, 0, 218104420, 0
    .long 1, 32, 32, 8192, 6656, 6912, 8388608, 1048576, 32768, 8, 42049536, 131072, 0, 0, 218104938, 0
    .long 2, 64, 72, 7168, 3328, 3328, 7340032, 0, 32768, 8, 54579200, 114688, 0, 0, 218103812, 0
    .long 2, 64, 72, 7168, 2304, 2304, 7340032, 1572864, 32768, 8, 60067840, 114688, 0, 0, 218104004, 0
    .long 2, 64, 72, 7168, 1280, 1280, 7340032, 3145728, 32768, 8, 65556480, 114688, 0, 0, 218104193, 0
    .long 1, 80, 80, 2048, 5505536, 5505792, 7340032, 56446976, 114688, 7, 130555904, 32768, 218103892, 7, 218106433, 0
    .long 0, 0, 0, 0, 0, 0, 0, 0, 0, 0, 0, 0, 0, 0, 0, 0
    .long 0, 0, 0, 0, 0, 0, 0, 0, 0, 0, 0, 0, 0, 0, 0, 0
    .long 0, 0, 0, 0, 0, 0, 0, 0, 0, 0, 0, 0, 0, 0, 0, 0
    .long 0, 0, 0, 0, 0, 0, 0, 0, 0, 0, 0, 0, 0, 0, 0, 0
    .long 4, 32, 32, 8192, 7168, 269312, 8388608, 0, 32768, 4, 37863424, 131072, 0, 0, 218104433, 0
    .long 4, 32, 32, 8192, 7168, 269312, 8388608, 262144, 32768, 4, 38912000, 131072, 0, 0, 218104436, 0
    .long 1, 32, 32, 8192, 7168, 7424, 8388608, 1048576, 32768, 8, 42057728, 131072, 0, 0, 218104954, 0
    .long 2, 64, 72, 7168, 3584, 3584, 7340032, 0, 32768, 8, 54583296, 114688, 0, 0, 218103825, 0
    .long 2, 64, 72, 7168, 2560, 2560, 7340032, 1572864, 32768, 8, 60071936, 114688, 0, 0, 218104004, 0
    .long 2, 64, 72, 7168, 1536, 1536, 7340032, 3145728, 32768, 8, 65560576, 114688, 0, 0, 218104193, 0
    .long 1, 80, 80, 2048, 5506048, 5506304, 7340032, 56446976, 114688, 7, 130564096, 32768, 218103892, 7, 218106433, 0
    .long 0, 0, 0, 0, 0, 0, 0, 0, 0, 0, 0, 0, 0, 0, 0, 0
    .long 0, 0, 0, 0, 0, 0, 0, 0, 0, 0, 0, 0, 0, 0, 0, 0
    .long 0, 0, 0, 0, 0, 0, 0, 0, 0, 0, 0, 0, 0, 0, 0, 0
    .long 0, 0, 0, 0, 0, 0, 0, 0, 0, 0, 0, 0, 0, 0, 0, 0
    .long 4, 32, 32, 8192, 7680, 269824, 8388608, 0, 32768, 4, 37871616, 131072, 0, 0, 218104433, 0
    .long 4, 32, 32, 8192, 7680, 269824, 8388608, 262144, 32768, 4, 38920192, 131072, 0, 0, 218104436, 0
    .long 1, 32, 32, 8192, 7680, 7936, 8388608, 1048576, 32768, 8, 42065920, 131072, 0, 0, 218104954, 0
    .long 2, 64, 72, 7168, 3840, 3840, 7340032, 0, 32768, 8, 54587392, 114688, 0, 0, 218103825, 0
    .long 2, 64, 72, 7168, 2816, 2816, 7340032, 1572864, 32768, 8, 60076032, 114688, 0, 0, 218104004, 0
    .long 2, 64, 72, 7168, 1792, 1792, 7340032, 3145728, 32768, 8, 65564672, 114688, 0, 0, 218104196, 0
    .long 1, 80, 80, 2048, 5506560, 5506816, 7340032, 56446976, 114688, 7, 130572288, 32768, 218103892, 7, 218106433, 0
    .long 0, 0, 0, 0, 0, 0, 0, 0, 0, 0, 0, 0, 0, 0, 0, 0
    .long 0, 0, 0, 0, 0, 0, 0, 0, 0, 0, 0, 0, 0, 0, 0, 0
    .long 0, 0, 0, 0, 0, 0, 0, 0, 0, 0, 0, 0, 0, 0, 0, 0
    .long 0, 0, 0, 0, 0, 0, 0, 0, 0, 0, 0, 0, 0, 0, 0, 0
    .long 4, 32, 32, 8192, 6400, 268544, 8388608, 0, 32768, 4, 37851136, 131072, 0, 0, 218104417, 0
    .long 4, 32, 32, 8192, 6400, 268544, 8388608, 262144, 32768, 4, 38899712, 131072, 0, 0, 218104420, 0
    .long 1, 16, 16, 8192, 0, 256, 8388608, 1048576, 32768, 8, 8388608, 131072, 0, 0, 218104842, 0
    .long 2, 64, 72, 7168, 4096, 4096, 7340032, 0, 32768, 8, 54591488, 114688, 0, 0, 218103825, 0
    .long 2, 64, 72, 7168, 3072, 3072, 7340032, 1572864, 32768, 8, 60080128, 114688, 0, 0, 218104004, 0
    .long 2, 64, 72, 7168, 2048, 2048, 7340032, 3145728, 32768, 8, 65568768, 114688, 0, 0, 218104196, 0
    .long 1, 80, 80, 2048, 0, 256, 7340032, 58195968, 114688, 7, 118489088, 32768, 218103936, 7, 218106497, 0
    .long 0, 0, 0, 0, 0, 0, 0, 0, 0, 0, 0, 0, 0, 0, 0, 0
    .long 0, 0, 0, 0, 0, 0, 0, 0, 0, 0, 0, 0, 0, 0, 0, 0
    .long 0, 0, 0, 0, 0, 0, 0, 0, 0, 0, 0, 0, 0, 0, 0, 0
    .long 0, 0, 0, 0, 0, 0, 0, 0, 0, 0, 0, 0, 0, 0, 0, 0
    .long 4, 32, 32, 8192, 6912, 269056, 8388608, 0, 32768, 4, 37859328, 131072, 0, 0, 218104417, 0
    .long 4, 32, 32, 8192, 6912, 269056, 8388608, 262144, 32768, 4, 38907904, 131072, 0, 0, 218104420, 0
    .long 1, 16, 16, 8192, 512, 768, 8388608, 1048576, 32768, 8, 8396800, 131072, 0, 0, 218104842, 0
    .long 2, 64, 72, 7168, 4352, 4352, 7340032, 0, 32768, 8, 54595584, 114688, 0, 0, 218103825, 0
    .long 2, 64, 72, 7168, 3328, 3328, 7340032, 1572864, 32768, 8, 60084224, 114688, 0, 0, 218104004, 0
    .long 2, 64, 72, 7168, 2304, 2304, 7340032, 3145728, 32768, 8, 65572864, 114688, 0, 0, 218104196, 0
    .long 1, 80, 80, 2048, 512, 768, 7340032, 58195968, 114688, 7, 118497280, 32768, 218103936, 7, 218106497, 0
    .long 0, 0, 0, 0, 0, 0, 0, 0, 0, 0, 0, 0, 0, 0, 0, 0
    .long 0, 0, 0, 0, 0, 0, 0, 0, 0, 0, 0, 0, 0, 0, 0, 0
    .long 0, 0, 0, 0, 0, 0, 0, 0, 0, 0, 0, 0, 0, 0, 0, 0
    .long 0, 0, 0, 0, 0, 0, 0, 0, 0, 0, 0, 0, 0, 0, 0, 0
    .long 4, 32, 32, 8192, 7424, 269568, 8388608, 0, 32768, 4, 37867520, 131072, 0, 0, 218104433, 0
    .long 4, 32, 32, 8192, 7424, 269568, 8388608, 262144, 32768, 4, 38916096, 131072, 0, 0, 218104436, 0
    .long 1, 16, 16, 8192, 1024, 1280, 8388608, 1048576, 32768, 8, 8404992, 131072, 0, 0, 218104858, 0
    .long 2, 64, 72, 7168, 4608, 4608, 7340032, 0, 32768, 8, 54599680, 114688, 0, 0, 218103825, 0
    .long 2, 64, 72, 7168, 3584, 3584, 7340032, 1572864, 32768, 8, 60088320, 114688, 0, 0, 218104017, 0
    .long 2, 64, 72, 7168, 2560, 2560, 7340032, 3145728, 32768, 8, 65576960, 114688, 0, 0, 218104196, 0
    .long 1, 80, 80, 2048, 1024, 1280, 7340032, 58195968, 114688, 7, 118505472, 32768, 218103936, 7, 218106497, 0
    .long 0, 0, 0, 0, 0, 0, 0, 0, 0, 0, 0, 0, 0, 0, 0, 0
    .long 0, 0, 0, 0, 0, 0, 0, 0, 0, 0, 0, 0, 0, 0, 0, 0
    .long 0, 0, 0, 0, 0, 0, 0, 0, 0, 0, 0, 0, 0, 0, 0, 0
    .long 0, 0, 0, 0, 0, 0, 0, 0, 0, 0, 0, 0, 0, 0, 0, 0
    .long 4, 32, 32, 8192, 7936, 270080, 8388608, 0, 32768, 4, 37875712, 131072, 0, 0, 218104433, 0
    .long 4, 32, 32, 8192, 7936, 270080, 8388608, 262144, 32768, 4, 38924288, 131072, 0, 0, 218104436, 0
    .long 1, 16, 16, 8192, 1536, 1792, 8388608, 1048576, 32768, 8, 8413184, 131072, 0, 0, 218104858, 0
    .long 2, 64, 72, 7168, 4864, 4864, 7340032, 0, 32768, 8, 54603776, 114688, 0, 0, 218103825, 0
    .long 2, 64, 72, 7168, 3840, 3840, 7340032, 1572864, 32768, 8, 60092416, 114688, 0, 0, 218104017, 0
    .long 2, 64, 72, 7168, 2816, 2816, 7340032, 3145728, 32768, 8, 65581056, 114688, 0, 0, 218104196, 0
    .long 1, 80, 80, 2048, 1536, 1792, 7340032, 58195968, 114688, 7, 118513664, 32768, 218103936, 7, 218106497, 0
    .long 0, 0, 0, 0, 0, 0, 0, 0, 0, 0, 0, 0, 0, 0, 0, 0
    .long 0, 0, 0, 0, 0, 0, 0, 0, 0, 0, 0, 0, 0, 0, 0, 0
    .long 0, 0, 0, 0, 0, 0, 0, 0, 0, 0, 0, 0, 0, 0, 0, 0
    .long 0, 0, 0, 0, 0, 0, 0, 0, 0, 0, 0, 0, 0, 0, 0, 0
    .long 4, 16, 16, 8192, 0, 262144, 8388608, 0, 32768, 4, 4194304, 131072, 0, 0, 218104321, 0
    .long 4, 16, 16, 8192, 0, 262144, 8388608, 262144, 32768, 4, 5242880, 131072, 0, 0, 218104324, 0
    .long 1, 16, 16, 8192, 2048, 2304, 8388608, 1048576, 32768, 8, 8421376, 131072, 0, 0, 218104874, 0
    .long 2, 64, 72, 7168, 5120, 5120, 7340032, 0, 32768, 8, 54607872, 114688, 0, 0, 218103825, 0
    .long 2, 64, 72, 7168, 4096, 4096, 7340032, 1572864, 32768, 8, 60096512, 114688, 0, 0, 218104017, 0
    .long 2, 64, 72, 7168, 3072, 3072, 7340032, 3145728, 32768, 8, 65585152, 114688, 0, 0, 218104196, 0
    .long 1, 80, 80, 2048, 1835008, 1835264, 7340032, 58224640, 114688, 7, 122683392, 32768, 218103940, 7, 218106497, 0
    .long 0, 0, 0, 0, 0, 0, 0, 0, 0, 0, 0, 0, 0, 0, 0, 0
    .long 0, 0, 0, 0, 0, 0, 0, 0, 0, 0, 0, 0, 0, 0, 0, 0
    .long 0, 0, 0, 0, 0, 0, 0, 0, 0, 0, 0, 0, 0, 0, 0, 0
    .long 0, 0, 0, 0, 0, 0, 0, 0, 0, 0, 0, 0, 0, 0, 0, 0
    .long 4, 16, 16, 8192, 512, 262656, 8388608, 0, 32768, 4, 4202496, 131072, 0, 0, 218104321, 0
    .long 4, 16, 16, 8192, 512, 262656, 8388608, 262144, 32768, 4, 5251072, 131072, 0, 0, 218104324, 0
    .long 1, 16, 16, 8192, 2560, 2816, 8388608, 1048576, 32768, 8, 8429568, 131072, 0, 0, 218104874, 0
    .long 2, 64, 72, 7168, 5376, 5376, 7340032, 0, 32768, 8, 54611968, 114688, 0, 0, 218103828, 0
    .long 2, 64, 72, 7168, 4352, 4352, 7340032, 1572864, 32768, 8, 60100608, 114688, 0, 0, 218104017, 0
    .long 2, 64, 72, 7168, 3328, 3328, 7340032, 3145728, 32768, 8, 65589248, 114688, 0, 0, 218104196, 0
    .long 1, 80, 80, 2048, 1835520, 1835776, 7340032, 58224640, 114688, 7, 122691584, 32768, 218103940, 7, 218106497, 0
    .long 0, 0, 0, 0, 0, 0, 0, 0, 0, 0, 0, 0, 0, 0, 0, 0
    .long 0, 0, 0, 0, 0, 0, 0, 0, 0, 0, 0, 0, 0, 0, 0, 0
    .long 0, 0, 0, 0, 0, 0, 0, 0, 0, 0, 0, 0, 0, 0, 0, 0
    .long 0, 0, 0, 0, 0, 0, 0, 0, 0, 0, 0, 0, 0, 0, 0, 0
    .long 4, 16, 16, 8192, 1024, 263168, 8388608, 0, 32768, 4, 4210688, 131072, 0, 0, 218104337, 0
    .long 4, 16, 16, 8192, 1024, 263168, 8388608, 262144, 32768, 4, 5259264, 131072, 0, 0, 218104340, 0
    .long 1, 16, 16, 8192, 3072, 3328, 8388608, 1048576, 32768, 8, 8437760, 131072, 0, 0, 218104890, 0
    .long 2, 64, 72, 7168, 5632, 5632, 7340032, 0, 32768, 8, 54616064, 114688, 0, 0, 218103828, 0
    .long 2, 64, 72, 7168, 4608, 4608, 7340032, 1572864, 32768, 8, 60104704, 114688, 0, 0, 218104017, 0
    .long 2, 64, 72, 7168, 3584, 3584, 7340032, 3145728, 32768, 8, 65593344, 114688, 0, 0, 218104209, 0
    .long 1, 80, 80, 2048, 1836032, 1836288, 7340032, 58224640, 114688, 7, 122699776, 32768, 218103940, 7, 218106497, 0
    .long 0, 0, 0, 0, 0, 0, 0, 0, 0, 0, 0, 0, 0, 0, 0, 0
    .long 0, 0, 0, 0, 0, 0, 0, 0, 0, 0, 0, 0, 0, 0, 0, 0
    .long 0, 0, 0, 0, 0, 0, 0, 0, 0, 0, 0, 0, 0, 0, 0, 0
    .long 0, 0, 0, 0, 0, 0, 0, 0, 0, 0, 0, 0, 0, 0, 0, 0
    .long 4, 16, 16, 8192, 1536, 263680, 8388608, 0, 32768, 4, 4218880, 131072, 0, 0, 218104337, 0
    .long 4, 16, 16, 8192, 1536, 263680, 8388608, 262144, 32768, 4, 5267456, 131072, 0, 0, 218104340, 0
    .long 1, 16, 16, 8192, 3584, 3840, 8388608, 1048576, 32768, 8, 8445952, 131072, 0, 0, 218104890, 0
    .long 2, 64, 72, 7168, 5888, 5888, 7340032, 0, 32768, 8, 54620160, 114688, 0, 0, 218103828, 0
    .long 2, 64, 72, 7168, 4864, 4864, 7340032, 1572864, 32768, 8, 60108800, 114688, 0, 0, 218104017, 0
    .long 2, 64, 72, 7168, 3840, 3840, 7340032, 3145728, 32768, 8, 65597440, 114688, 0, 0, 218104209, 0
    .long 1, 80, 80, 2048, 1836544, 1836800, 7340032, 58224640, 114688, 7, 122707968, 32768, 218103940, 7, 218106497, 0
    .long 0, 0, 0, 0, 0, 0, 0, 0, 0, 0, 0, 0, 0, 0, 0, 0
    .long 0, 0, 0, 0, 0, 0, 0, 0, 0, 0, 0, 0, 0, 0, 0, 0
    .long 0, 0, 0, 0, 0, 0, 0, 0, 0, 0, 0, 0, 0, 0, 0, 0
    .long 0, 0, 0, 0, 0, 0, 0, 0, 0, 0, 0, 0, 0, 0, 0, 0
    .long 4, 16, 16, 8192, 256, 262400, 8388608, 0, 32768, 4, 4198400, 131072, 0, 0, 218104321, 0
    .long 4, 16, 16, 8192, 256, 262400, 8388608, 262144, 32768, 4, 5246976, 131072, 0, 0, 218104324, 0
    .long 1, 16, 16, 8192, 4096, 4352, 8388608, 1048576, 32768, 8, 8454144, 131072, 0, 0, 218104906, 0
    .long 2, 64, 72, 7168, 6144, 6144, 7340032, 0, 32768, 8, 54624256, 114688, 0, 0, 218103828, 0
    .long 2, 64, 72, 7168, 5120, 5120, 7340032, 1572864, 32768, 8, 60112896, 114688, 0, 0, 218104017, 0
    .long 2, 64, 72, 7168, 4096, 4096, 7340032, 3145728, 32768, 8, 65601536, 114688, 0, 0, 218104209, 0
    .long 1, 80, 80, 2048, 3670016, 3670272, 7340032, 58253312, 114688, 7, 126877696, 32768, 218103952, 7, 218106497, 0
    .long 0, 0, 0, 0, 0, 0, 0, 0, 0, 0, 0, 0, 0, 0, 0, 0
    .long 0, 0, 0, 0, 0, 0, 0, 0, 0, 0, 0, 0, 0, 0, 0, 0
    .long 0, 0, 0, 0, 0, 0, 0, 0, 0, 0, 0, 0, 0, 0, 0, 0
    .long 0, 0, 0, 0, 0, 0, 0, 0, 0, 0, 0, 0, 0, 0, 0, 0
    .long 4, 16, 16, 8192, 768, 262912, 8388608, 0, 32768, 4, 4206592, 131072, 0, 0, 218104321, 0
    .long 4, 16, 16, 8192, 768, 262912, 8388608, 262144, 32768, 4, 5255168, 131072, 0, 0, 218104324, 0
    .long 1, 16, 16, 8192, 4608, 4864, 8388608, 1048576, 32768, 8, 8462336, 131072, 0, 0, 218104906, 0
    .long 2, 64, 72, 7168, 6400, 6400, 7340032, 0, 32768, 8, 54628352, 114688, 0, 0, 218103828, 0
    .long 2, 64, 72, 7168, 5376, 5376, 7340032, 1572864, 32768, 8, 60116992, 114688, 0, 0, 218104020, 0
    .long 2, 64, 72, 7168, 4352, 4352, 7340032, 3145728, 32768, 8, 65605632, 114688, 0, 0, 218104209, 0
    .long 1, 80, 80, 2048, 3670528, 3670784, 7340032, 58253312, 114688, 7, 126885888, 32768, 218103952, 7, 218106497, 0
    .long 0, 0, 0, 0, 0, 0, 0, 0, 0, 0, 0, 0, 0, 0, 0, 0
    .long 0, 0, 0, 0, 0, 0, 0, 0, 0, 0, 0, 0, 0, 0, 0, 0
    .long 0, 0, 0, 0, 0, 0, 0, 0, 0, 0, 0, 0, 0, 0, 0, 0
    .long 0, 0, 0, 0, 0, 0, 0, 0, 0, 0, 0, 0, 0, 0, 0, 0
    .long 4, 16, 16, 8192, 1280, 263424, 8388608, 0, 32768, 4, 4214784, 131072, 0, 0, 218104337, 0
    .long 4, 16, 16, 8192, 1280, 263424, 8388608, 262144, 32768, 4, 5263360, 131072, 0, 0, 218104340, 0
    .long 1, 16, 16, 8192, 5120, 5376, 8388608, 1048576, 32768, 8, 8470528, 131072, 0, 0, 218104922, 0
    .long 2, 64, 72, 7168, 6656, 6656, 7340032, 0, 32768, 8, 54632448, 114688, 0, 0, 218103828, 0
    .long 2, 64, 72, 7168, 5632, 5632, 7340032, 1572864, 32768, 8, 60121088, 114688, 0, 0, 218104020, 0
    .long 2, 64, 72, 7168, 4608, 4608, 7340032, 3145728, 32768, 8, 65609728, 114688, 0, 0, 218104209, 0
    .long 1, 80, 80, 2048, 3671040, 3671296, 7340032, 58253312, 114688, 7, 126894080, 32768, 218103952, 7, 218106497, 0
    .long 0, 0, 0, 0, 0, 0, 0, 0, 0, 0, 0, 0, 0, 0, 0, 0
    .long 0, 0, 0, 0, 0, 0, 0, 0, 0, 0, 0, 0, 0, 0, 0, 0
    .long 0, 0, 0, 0, 0, 0, 0, 0, 0, 0, 0, 0, 0, 0, 0, 0
    .long 0, 0, 0, 0, 0, 0, 0, 0, 0, 0, 0, 0, 0, 0, 0, 0
    .long 4, 16, 16, 8192, 1792, 263936, 8388608, 0, 32768, 4, 4222976, 131072, 0, 0, 218104337, 0
    .long 4, 16, 16, 8192, 1792, 263936, 8388608, 262144, 32768, 4, 5271552, 131072, 0, 0, 218104340, 0
    .long 1, 16, 16, 8192, 5632, 5888, 8388608, 1048576, 32768, 8, 8478720, 131072, 0, 0, 218104922, 0
    .long 2, 64, 72, 7168, 6912, 6912, 7340032, 0, 32768, 8, 54636544, 114688, 0, 0, 218103828, 0
    .long 2, 64, 72, 7168, 5888, 5888, 7340032, 1572864, 32768, 8, 60125184, 114688, 0, 0, 218104020, 0
    .long 2, 64, 72, 7168, 4864, 4864, 7340032, 3145728, 32768, 8, 65613824, 114688, 0, 0, 218104209, 0
    .long 1, 80, 80, 2048, 3671552, 3671808, 7340032, 58253312, 114688, 7, 126902272, 32768, 218103952, 7, 218106497, 0
    .long 0, 0, 0, 0, 0, 0, 0, 0, 0, 0, 0, 0, 0, 0, 0, 0
    .long 0, 0, 0, 0, 0, 0, 0, 0, 0, 0, 0, 0, 0, 0, 0, 0
    .long 0, 0, 0, 0, 0, 0, 0, 0, 0, 0, 0, 0, 0, 0, 0, 0
    .long 0, 0, 0, 0, 0, 0, 0, 0, 0, 0, 0, 0, 0, 0, 0, 0
    .long 4, 16, 16, 8192, 2048, 264192, 8388608, 0, 32768, 4, 4227072, 131072, 0, 0, 218104353, 0
    .long 4, 16, 16, 8192, 2048, 264192, 8388608, 262144, 32768, 4, 5275648, 131072, 0, 0, 218104356, 0
    .long 1, 16, 16, 8192, 6144, 6400, 8388608, 1048576, 32768, 8, 8486912, 131072, 0, 0, 218104938, 0
    .long 2, 64, 72, 7168, 0, 0, 7340032, 524288, 32768, 8, 56360960, 114688, 0, 0, 218103873, 0
    .long 2, 64, 72, 7168, 6144, 6144, 7340032, 1572864, 32768, 8, 60129280, 114688, 0, 0, 218104020, 0
    .long 2, 64, 72, 7168, 5120, 5120, 7340032, 3145728, 32768, 8, 65617920, 114688, 0, 0, 218104209, 0
    .long 1, 80, 80, 2048, 5505024, 5505280, 7340032, 58281984, 114688, 7, 131072000, 32768, 218103956, 7, 218106497, 0
    .long 0, 0, 0, 0, 0, 0, 0, 0, 0, 0, 0, 0, 0, 0, 0, 0
    .long 0, 0, 0, 0, 0, 0, 0, 0, 0, 0, 0, 0, 0, 0, 0, 0
    .long 0, 0, 0, 0, 0, 0, 0, 0, 0, 0, 0, 0, 0, 0, 0, 0
    .long 0, 0, 0, 0, 0, 0, 0, 0, 0, 0, 0, 0, 0, 0, 0, 0
    .long 4, 16, 16, 8192, 2560, 264704, 8388608, 0, 32768, 4, 4235264, 131072, 0, 0, 218104353, 0
    .long 4, 16, 16, 8192, 2560, 264704, 8388608, 262144, 32768, 4, 5283840, 131072, 0, 0, 218104356, 0
    .long 1, 16, 16, 8192, 6656, 6912, 8388608, 1048576, 32768, 8, 8495104, 131072, 0, 0, 218104938, 0
    .long 2, 64, 72, 7168, 256, 256, 7340032, 524288, 32768, 8, 56365056, 114688, 0, 0, 218103873, 0
    .long 2, 64, 72, 7168, 6400, 6400, 7340032, 1572864, 32768, 8, 60133376, 114688, 0, 0, 218104020, 0
    .long 2, 64, 72, 7168, 5376, 5376, 7340032, 3145728, 32768, 8, 65622016, 114688, 0, 0, 218104212, 0
    .long 1, 80, 80, 2048, 5505536, 5505792, 7340032, 58281984, 114688, 7, 131080192, 32768, 218103956, 7, 218106497, 0
    .long 0, 0, 0, 0, 0, 0, 0, 0, 0, 0, 0, 0, 0, 0, 0, 0
    .long 0, 0, 0, 0, 0, 0, 0, 0, 0, 0, 0, 0, 0, 0, 0, 0
    .long 0, 0, 0, 0, 0, 0, 0, 0, 0, 0, 0, 0, 0, 0, 0, 0
    .long 0, 0, 0, 0, 0, 0, 0, 0, 0, 0, 0, 0, 0, 0, 0, 0
    .long 4, 16, 16, 8192, 3072, 265216, 8388608, 0, 32768, 4, 4243456, 131072, 0, 0, 218104369, 0
    .long 4, 16, 16, 8192, 3072, 265216, 8388608, 262144, 32768, 4, 5292032, 131072, 0, 0, 218104372, 0
    .long 1, 16, 16, 8192, 7168, 7424, 8388608, 1048576, 32768, 8, 8503296, 131072, 0, 0, 218104954, 0
    .long 2, 64, 72, 7168, 512, 512, 7340032, 524288, 32768, 8, 56369152, 114688, 0, 0, 218103873, 0
    .long 2, 64, 72, 7168, 6656, 6656, 7340032, 1572864, 32768, 8, 60137472, 114688, 0, 0, 218104020, 0
    .long 2, 64, 72, 7168, 5632, 5632, 7340032, 3145728, 32768, 8, 65626112, 114688, 0, 0, 218104212, 0
    .long 1, 80, 80, 2048, 5506048, 5506304, 7340032, 58281984, 114688, 7, 131088384, 32768, 218103956, 7, 218106497, 0
    .long 0, 0, 0, 0, 0, 0, 0, 0, 0, 0, 0, 0, 0, 0, 0, 0
    .long 0, 0, 0, 0, 0, 0, 0, 0, 0, 0, 0, 0, 0, 0, 0, 0
    .long 0, 0, 0, 0, 0, 0, 0, 0, 0, 0, 0, 0, 0, 0, 0, 0
    .long 0, 0, 0, 0, 0, 0, 0, 0, 0, 0, 0, 0, 0, 0, 0, 0
    .long 4, 16, 16, 8192, 3584, 265728, 8388608, 0, 32768, 4, 4251648, 131072, 0, 0, 218104369, 0
    .long 4, 16, 16, 8192, 3584, 265728, 8388608, 262144, 32768, 4, 5300224, 131072, 0, 0, 218104372, 0
    .long 1, 16, 16, 8192, 7680, 7936, 8388608, 1048576, 32768, 8, 8511488, 131072, 0, 0, 218104954, 0
    .long 2, 64, 72, 7168, 768, 768, 7340032, 524288, 32768, 8, 56373248, 114688, 0, 0, 218103873, 0
    .long 2, 64, 72, 7168, 6912, 6912, 7340032, 1572864, 32768, 8, 60141568, 114688, 0, 0, 218104020, 0
    .long 2, 64, 72, 7168, 5888, 5888, 7340032, 3145728, 32768, 8, 65630208, 114688, 0, 0, 218104212, 0
    .long 1, 80, 80, 2048, 5506560, 5506816, 7340032, 58281984, 114688, 7, 131096576, 32768, 218103956, 7, 218106497, 0
    .long 0, 0, 0, 0, 0, 0, 0, 0, 0, 0, 0, 0, 0, 0, 0, 0
    .long 0, 0, 0, 0, 0, 0, 0, 0, 0, 0, 0, 0, 0, 0, 0, 0
    .long 0, 0, 0, 0, 0, 0, 0, 0, 0, 0, 0, 0, 0, 0, 0, 0
    .long 0, 0, 0, 0, 0, 0, 0, 0, 0, 0, 0, 0, 0, 0, 0, 0
    .long 4, 16, 16, 8192, 2304, 264448, 8388608, 0, 32768, 4, 4231168, 131072, 0, 0, 218104353, 0
    .long 4, 16, 16, 8192, 2304, 264448, 8388608, 262144, 32768, 4, 5279744, 131072, 0, 0, 218104356, 0
    .long 4, 24, 24, 8192, 6144, 268288, 8388608, 786432, 32768, 4, 24215552, 131072, 0, 0, 218104676, 0
    .long 1, 16, 16, 8192, 4096, 4352, 8388608, 1572864, 32768, 8, 10551296, 131072, 0, 0, 218105162, 0
    .long 2, 64, 72, 7168, 4096, 4096, 7340032, 1048576, 32768, 8, 58261504, 114688, 0, 0, 218103953, 0
    .long 2, 64, 72, 7168, 3072, 3072, 7340032, 2621440, 32768, 8, 63750144, 114688, 0, 0, 218104132, 0
    .long 1, 24, 24, 8192, 6144, 6400, 8388608, 3670016, 32768, 8, 35749888, 131072, 0, 0, 218106218, 0
    .long 1, 80, 80, 2048, 5505024, 5505280, 7340032, 60116992, 114688, 7, 131596288, 32768, 218104020, 7, 218106561, 0
    .long 0, 0, 0, 0, 0, 0, 0, 0, 0, 0, 0, 0, 0, 0, 0, 0
    .long 0, 0, 0, 0, 0, 0, 0, 0, 0, 0, 0, 0, 0, 0, 0, 0
    .long 0, 0, 0, 0, 0, 0, 0, 0, 0, 0, 0, 0, 0, 0, 0, 0
    .long 4, 16, 16, 8192, 2816, 264960, 8388608, 0, 32768, 4, 4239360, 131072, 0, 0, 218104353, 0
    .long 4, 16, 16, 8192, 2816, 264960, 8388608, 262144, 32768, 4, 5287936, 131072, 0, 0, 218104356, 0
    .long 4, 24, 24, 8192, 6656, 268800, 8388608, 786432, 32768, 4, 24223744, 131072, 0, 0, 218104676, 0
    .long 1, 16, 16, 8192, 4608, 4864, 8388608, 1572864, 32768, 8, 10559488, 131072, 0, 0, 218105162, 0
    .long 2, 64, 72, 7168, 4352, 4352, 7340032, 1048576, 32768, 8, 58265600, 114688, 0, 0, 218103953, 0
    .long 2, 64, 72, 7168, 3328, 3328, 7340032, 2621440, 32768, 8, 63754240, 114688, 0, 0, 218104132, 0
    .long 1, 24, 24, 8192, 6656, 6912, 8388608, 3670016, 32768, 8, 35758080, 131072, 0, 0, 218106218, 0
    .long 1, 80, 80, 2048, 5505536, 5505792, 7340032, 60116992, 114688, 7, 131604480, 32768, 218104020, 7, 218106561, 0
    .long 0, 0, 0, 0, 0, 0, 0, 0, 0, 0, 0, 0, 0, 0, 0, 0
    .long 0, 0, 0, 0, 0, 0, 0, 0, 0, 0, 0, 0, 0, 0, 0, 0
    .long 0, 0, 0, 0, 0, 0, 0, 0, 0, 0, 0, 0, 0, 0, 0, 0
    .long 4, 16, 16, 8192, 3328, 265472, 8388608, 0, 32768, 4, 4247552, 131072, 0, 0, 218104369, 0
    .long 4, 16, 16, 8192, 3328, 265472, 8388608, 262144, 32768, 4, 5296128, 131072, 0, 0, 218104372, 0
    .long 4, 24, 24, 8192, 7168, 269312, 8388608, 786432, 32768, 4, 24231936, 131072, 0, 0, 218104692, 0
    .long 1, 16, 16, 8192, 5120, 5376, 8388608, 1572864, 32768, 8, 10567680, 131072, 0, 0, 218105178, 0
    .long 2, 64, 72, 7168, 4608, 4608, 7340032, 1048576, 32768, 8, 58269696, 114688, 0, 0, 218103953, 0
    .long 2, 64, 72, 7168, 3584, 3584, 7340032, 2621440, 32768, 8, 63758336, 114688, 0, 0, 218104145, 0
    .long 1, 24, 24, 8192, 7168, 7424, 8388608, 3670016, 32768, 8, 35766272, 131072, 0, 0, 218106234, 0
    .long 1, 80, 80, 2048, 5506048, 5506304, 7340032, 60116992, 114688, 7, 131612672, 32768, 218104020, 7, 218106561, 0
    .long 0, 0, 0, 0, 0, 0, 0, 0, 0, 0, 0, 0, 0, 0, 0, 0
    .long 0, 0, 0, 0, 0, 0, 0, 0, 0, 0, 0, 0, 0, 0, 0, 0
    .long 0, 0, 0, 0, 0, 0, 0, 0, 0, 0, 0, 0, 0, 0, 0, 0
    .long 4, 16, 16, 8192, 3840, 265984, 8388608, 0, 32768, 4, 4255744, 131072, 0, 0, 218104369, 0
    .long 4, 16, 16, 8192, 3840, 265984, 8388608, 262144, 32768, 4, 5304320, 131072, 0, 0, 218104372, 0
    .long 4, 24, 24, 8192, 7680, 269824, 8388608, 786432, 32768, 4, 24240128, 131072, 0, 0, 218104692, 0
    .long 1, 16, 16, 8192, 5632, 5888, 8388608, 1572864, 32768, 8, 10575872, 131072, 0, 0, 218105178, 0
    .long 2, 64, 72, 7168, 4864, 4864, 7340032, 1048576, 32768, 8, 58273792, 114688, 0, 0, 218103953, 0
    .long 2, 64, 72, 7168, 4864, 4864, 7340032, 2621440, 32768, 8, 63778816, 114688, 0, 0, 218104145, 0
    .long 1, 32, 32, 8192, 1536, 1792, 8388608, 3670016, 32768, 8, 52453376, 131072, 0, 0, 218106138, 0
    .long 1, 80, 80, 2048, 1536, 1792, 7340032, 61865984, 114688, 7, 119562240, 32768, 218104064, 7, 218106625, 0
    .long 0, 0, 0, 0, 0, 0, 0, 0, 0, 0, 0, 0, 0, 0, 0, 0
    .long 0, 0, 0, 0, 0, 0, 0, 0, 0, 0, 0, 0, 0, 0, 0, 0
    .long 0, 0, 0, 0, 0, 0, 0, 0, 0, 0, 0, 0, 0, 0, 0, 0
    .long 4, 16, 16, 8192, 4096, 266240, 8388608, 0, 32768, 4, 4259840, 131072, 0, 0, 218104385, 0
    .long 4, 16, 16, 8192, 4096, 266240, 8388608, 262144, 32768, 4, 5308416, 131072, 0, 0, 218104388, 0
    .long 4, 24, 24, 8192, 6400, 268544, 8388608, 786432, 32768, 4, 24219648, 131072, 0, 0, 218104676, 0
    .long 1, 16, 16, 8192, 6144, 6400, 8388608, 1572864, 32768, 8, 10584064, 131072, 0, 0, 218105194, 0
    .long 2, 64, 72, 7168, 5120, 5120, 7340032, 1048576, 32768, 8, 58277888, 114688, 0, 0, 218103953, 0
    .long 2, 64, 72, 7168, 4096, 4096, 7340032, 2621440, 32768, 8, 63766528, 114688, 0, 0, 218104145, 0
    .long 1, 32, 32, 8192, 0, 256, 8388608, 3670016, 32768, 8, 52428800, 131072, 0, 0, 218106122, 0
    .long 1, 80, 80, 2048, 0, 256, 7340032, 61865984, 114688, 7, 119537664, 32768, 218104064, 7, 218106625, 0
    .long 0, 0, 0, 0, 0, 0, 0, 0, 0, 0, 0, 0, 0, 0, 0, 0
    .long 0, 0, 0, 0, 0, 0, 0, 0, 0, 0, 0, 0, 0, 0, 0, 0
    .long 0, 0, 0, 0, 0, 0, 0, 0, 0, 0, 0, 0, 0, 0, 0, 0
    .long 4, 16, 16, 8192, 4608, 266752, 8388608, 0, 32768, 4, 4268032, 131072, 0, 0, 218104385, 0
    .long 4, 16, 16, 8192, 4608, 266752, 8388608, 262144, 32768, 4, 5316608, 131072, 0, 0, 218104388, 0
    .long 4, 24, 24, 8192, 6912, 269056, 8388608, 786432, 32768, 4, 24227840, 131072, 0, 0, 218104676, 0
    .long 1, 16, 16, 8192, 6656, 6912, 8388608, 1572864, 32768, 8, 10592256, 131072, 0, 0, 218105194, 0
    .long 2, 64, 72, 7168, 5376, 5376, 7340032, 1048576, 32768, 8, 58281984, 114688, 0, 0, 218103956, 0
    .long 2, 64, 72, 7168, 4352, 4352, 7340032, 2621440, 32768, 8, 63770624, 114688, 0, 0, 218104145, 0
    .long 1, 32, 32, 8192, 512, 768, 8388608, 3670016, 32768, 8, 52436992, 131072, 0, 0, 218106122, 0
    .long 1, 80, 80, 2048, 512, 768, 7340032, 61865984, 114688, 7, 119545856, 32768, 218104064, 7, 218106625, 0
    .long 0, 0, 0, 0, 0, 0, 0, 0, 0, 0, 0, 0, 0, 0, 0, 0
    .long 0, 0, 0, 0, 0, 0, 0, 0, 0, 0, 0, 0, 0, 0, 0, 0
    .long 0, 0, 0, 0, 0, 0, 0, 0, 0, 0, 0, 0, 0, 0, 0, 0
    .long 4, 16, 16, 8192, 5120, 267264, 8388608, 0, 32768, 4, 4276224, 131072, 0, 0, 218104401, 0
    .long 4, 16, 16, 8192, 5120, 267264, 8388608, 262144, 32768, 4, 5324800, 131072, 0, 0, 218104404, 0
    .long 4, 24, 24, 8192, 7424, 269568, 8388608, 786432, 32768, 4, 24236032, 131072, 0, 0, 218104692, 0
    .long 1, 16, 16, 8192, 7168, 7424, 8388608, 1572864, 32768, 8, 10600448, 131072, 0, 0, 218105210, 0
    .long 2, 64, 72, 7168, 5632, 5632, 7340032, 1048576, 32768, 8, 58286080, 114688, 0, 0, 218103956, 0
    .long 2, 64, 72, 7168, 4608, 4608, 7340032, 2621440, 32768, 8, 63774720, 114688, 0, 0, 218104145, 0
    .long 1, 32, 32, 8192, 1024, 1280, 8388608, 3670016, 32768, 8, 52445184, 131072, 0, 0, 218106138, 0
    .long 1, 80, 80, 2048, 1024, 1280, 7340032, 61865984, 114688, 7, 119554048, 32768, 218104064, 7, 218106625, 0
    .long 0, 0, 0, 0, 0, 0, 0, 0, 0, 0, 0, 0, 0, 0, 0, 0
    .long 0, 0, 0, 0, 0, 0, 0, 0, 0, 0, 0, 0, 0, 0, 0, 0
    .long 0, 0, 0, 0, 0, 0, 0, 0, 0, 0, 0, 0, 0, 0, 0, 0
    .long 4, 16, 16, 8192, 5632, 267776, 8388608, 0, 32768, 4, 4284416, 131072, 0, 0, 218104401, 0
    .long 4, 16, 16, 8192, 5632, 267776, 8388608, 262144, 32768, 4, 5332992, 131072, 0, 0, 218104404, 0
    .long 4, 24, 24, 8192, 7936, 270080, 8388608, 786432, 32768, 4, 24244224, 131072, 0, 0, 218104692, 0
    .long 1, 16, 16, 8192, 7680, 7936, 8388608, 1572864, 32768, 8, 10608640, 131072, 0, 0, 218105210, 0
    .long 2, 64, 72, 7168, 5888, 5888, 7340032, 1048576, 32768, 8, 58290176, 114688, 0, 0, 218103956, 0
    .long 2, 64, 72, 7168, 5888, 5888, 7340032, 2621440, 32768, 8, 63795200, 114688, 0, 0, 218104148, 0
    .long 1, 32, 32, 8192, 3584, 3840, 8388608, 3670016, 32768, 8, 52486144, 131072, 0, 0, 218106170, 0
    .long 1, 80, 80, 2048, 1836544, 1836800, 7340032, 61894656, 114688, 7, 123756544, 32768, 218104068, 7, 218106625, 0
    .long 0, 0, 0, 0, 0, 0, 0, 0, 0, 0, 0, 0, 0, 0, 0, 0
    .long 0, 0, 0, 0, 0, 0, 0, 0, 0, 0, 0, 0, 0, 0, 0, 0
    .long 0, 0, 0, 0, 0, 0, 0, 0, 0, 0, 0, 0, 0, 0, 0, 0
    .long 4, 16, 16, 8192, 4352, 266496, 8388608, 0, 32768, 4, 4263936, 131072, 0, 0, 218104385, 0
    .long 4, 16, 16, 8192, 4352, 266496, 8388608, 262144, 32768, 4, 5312512, 131072, 0, 0, 218104388, 0
    .long 4, 32, 32, 8192, 4096, 266240, 8388608, 786432, 32768, 4, 40960000, 131072, 0, 0, 218104644, 0
    .long 2, 64, 72, 7168, 0, 0, 7340032, 0, 32768, 8, 54525952, 114688, 0, 0, 218103809, 0
    .long 1, 24, 24, 8192, 0, 256, 8388608, 2621440, 32768, 8, 31457280, 131072, 0, 0, 218105610, 0
    .long 2, 64, 72, 7168, 5120, 5120, 7340032, 2621440, 32768, 8, 63782912, 114688, 0, 0, 218104145, 0
    .long 1, 32, 32, 8192, 2048, 2304, 8388608, 3670016, 32768, 8, 52461568, 131072, 0, 0, 218106154, 0
    .long 1, 80, 80, 2048, 1835008, 1835264, 7340032, 61894656, 114688, 7, 123731968, 32768, 218104068, 7, 218106625, 0
    .long 0, 0, 0, 0, 0, 0, 0, 0, 0, 0, 0, 0, 0, 0, 0, 0
    .long 0, 0, 0, 0, 0, 0, 0, 0, 0, 0, 0, 0, 0, 0, 0, 0
    .long 0, 0, 0, 0, 0, 0, 0, 0, 0, 0, 0, 0, 0, 0, 0, 0
    .long 4, 16, 16, 8192, 4864, 267008, 8388608, 0, 32768, 4, 4272128, 131072, 0, 0, 218104385, 0
    .long 4, 16, 16, 8192, 4864, 267008, 8388608, 262144, 32768, 4, 5320704, 131072, 0, 0, 218104388, 0
    .long 4, 32, 32, 8192, 4608, 266752, 8388608, 786432, 32768, 4, 40968192, 131072, 0, 0, 218104644, 0
    .long 2, 64, 72, 7168, 256, 256, 7340032, 0, 32768, 8, 54530048, 114688, 0, 0, 218103809, 0
    .long 1, 24, 24, 8192, 512, 768, 8388608, 2621440, 32768, 8, 31465472, 131072, 0, 0, 218105610, 0
    .long 2, 64, 72, 7168, 5376, 5376, 7340032, 2621440, 32768, 8, 63787008, 114688, 0, 0, 218104148, 0
    .long 1, 32, 32, 8192, 2560, 2816, 8388608, 3670016, 32768, 8, 52469760, 131072, 0, 0, 218106154, 0
    .long 1, 80, 80, 2048, 1835520, 1835776, 7340032, 61894656, 114688, 7, 123740160, 32768, 218104068, 7, 218106625, 0
    .long 0, 0, 0, 0, 0, 0, 0, 0, 0, 0, 0, 0, 0, 0, 0, 0
    .long 0, 0, 0, 0, 0, 0, 0, 0, 0, 0, 0, 0, 0, 0, 0, 0
    .long 0, 0, 0, 0, 0, 0, 0, 0, 0, 0, 0, 0, 0, 0, 0, 0
    .long 4, 16, 16, 8192, 5376, 267520, 8388608, 0, 32768, 4, 4280320, 131072, 0, 0, 218104401, 0
    .long 4, 16, 16, 8192, 5376, 267520, 8388608, 262144, 32768, 4, 5328896, 131072, 0, 0, 218104404, 0
    .long 4, 32, 32, 8192, 5120, 267264, 8388608, 786432, 32768, 4, 40976384, 131072, 0, 0, 218104660, 0
    .long 2, 64, 72, 7168, 512, 512, 7340032, 0, 32768, 8, 54534144, 114688, 0, 0, 218103809, 0
    .long 1, 24, 24, 8192, 1024, 1280, 8388608, 2621440, 32768, 8, 31473664, 131072, 0, 0, 218105626, 0
    .long 2, 64, 72, 7168, 5632, 5632, 7340032, 2621440, 32768, 8, 63791104, 114688, 0, 0, 218104148, 0
    .long 1, 32, 32, 8192, 3072, 3328, 8388608, 3670016, 32768, 8, 52477952, 131072, 0, 0, 218106170, 0
    .long 1, 80, 80, 2048, 1836032, 1836288, 7340032, 61894656, 114688, 7, 123748352, 32768, 218104068, 7, 218106625, 0
    .long 0, 0, 0, 0, 0, 0, 0, 0, 0, 0, 0, 0, 0, 0, 0, 0
    .long 0, 0, 0, 0, 0, 0, 0, 0, 0, 0, 0, 0, 0, 0, 0, 0
    .long 0, 0, 0, 0, 0, 0, 0, 0, 0, 0, 0, 0, 0, 0, 0, 0
    .long 4, 16, 16, 8192, 5888, 268032, 8388608, 0, 32768, 4, 4288512, 131072, 0, 0, 218104401, 0
    .long 4, 16, 16, 8192, 5888, 268032, 8388608, 262144, 32768, 4, 5337088, 131072, 0, 0, 218104404, 0
    .long 4, 32, 32, 8192, 5632, 267776, 8388608, 786432, 32768, 4, 40984576, 131072, 0, 0, 218104660, 0
    .long 2, 64, 72, 7168, 768, 768, 7340032, 0, 32768, 8, 54538240, 114688, 0, 0, 218103809, 0
    .long 1, 24, 24, 8192, 3584, 3840, 8388608, 2621440, 32768, 8, 31514624, 131072, 0, 0, 218105658, 0
    .long 2, 64, 72, 7168, 6912, 6912, 7340032, 2621440, 32768, 8, 63811584, 114688, 0, 0, 218104148, 0
    .long 1, 32, 32, 8192, 5632, 5888, 8388608, 3670016, 32768, 8, 52518912, 131072, 0, 0, 218106202, 0
    .long 1, 80, 80, 2048, 3671552, 3671808, 7340032, 61923328, 114688, 7, 127950848, 32768, 218104080, 7, 218106625, 0
    .long 0, 0, 0, 0, 0, 0, 0, 0, 0, 0, 0, 0, 0, 0, 0, 0
    .long 0, 0, 0, 0, 0, 0, 0, 0, 0, 0, 0, 0, 0, 0, 0, 0
    .long 0, 0, 0, 0, 0, 0, 0, 0, 0, 0, 0, 0, 0, 0, 0, 0
    .long 4, 16, 16, 8192, 6144, 268288, 8388608, 0, 32768, 4, 4292608, 131072, 0, 0, 218104417, 0
    .long 4, 16, 16, 8192, 6144, 268288, 8388608, 262144, 32768, 4, 5341184, 131072, 0, 0, 218104420, 0
    .long 4, 32, 32, 8192, 4352, 266496, 8388608, 786432, 32768, 4, 40964096, 131072, 0, 0, 218104644, 0
    .long 2, 64, 72, 7168, 1024, 1024, 7340032, 0, 32768, 8, 54542336, 114688, 0, 0, 218103809, 0
    .long 1, 24, 24, 8192, 2048, 2304, 8388608, 2621440, 32768, 8, 31490048, 131072, 0, 0, 218105642, 0
    .long 2, 64, 72, 7168, 6144, 6144, 7340032, 2621440, 32768, 8, 63799296, 114688, 0, 0, 218104148, 0
    .long 1, 32, 32, 8192, 4096, 4352, 8388608, 3670016, 32768, 8, 52494336, 131072, 0, 0, 218106186, 0
    .long 1, 80, 80, 2048, 3670016, 3670272, 7340032, 61923328, 114688, 7, 127926272, 32768, 218104080, 7, 218106625, 0
    .long 0, 0, 0, 0, 0, 0, 0, 0, 0, 0, 0, 0, 0, 0, 0, 0
    .long 0, 0, 0, 0, 0, 0, 0, 0, 0, 0, 0, 0, 0, 0, 0, 0
    .long 0, 0, 0, 0, 0, 0, 0, 0, 0, 0, 0, 0, 0, 0, 0, 0
    .long 4, 16, 16, 8192, 6656, 268800, 8388608, 0, 32768, 4, 4300800, 131072, 0, 0, 218104417, 0
    .long 4, 16, 16, 8192, 6656, 268800, 8388608, 262144, 32768, 4, 5349376, 131072, 0, 0, 218104420, 0
    .long 4, 32, 32, 8192, 4864, 267008, 8388608, 786432, 32768, 4, 40972288, 131072, 0, 0, 218104644, 0
    .long 2, 64, 72, 7168, 1280, 1280, 7340032, 0, 32768, 8, 54546432, 114688, 0, 0, 218103809, 0
    .long 1, 24, 24, 8192, 2560, 2816, 8388608, 2621440, 32768, 8, 31498240, 131072, 0, 0, 218105642, 0
    .long 2, 64, 72, 7168, 6400, 6400, 7340032, 2621440, 32768, 8, 63803392, 114688, 0, 0, 218104148, 0
    .long 1, 32, 32, 8192, 4608, 4864, 8388608, 3670016, 32768, 8, 52502528, 131072, 0, 0, 218106186, 0
    .long 1, 80, 80, 2048, 3670528, 3670784, 7340032, 61923328, 114688, 7, 127934464, 32768, 218104080, 7, 218106625, 0
    .long 0, 0, 0, 0, 0, 0, 0, 0, 0, 0, 0, 0, 0, 0, 0, 0
    .long 0, 0, 0, 0, 0, 0, 0, 0, 0, 0, 0, 0, 0, 0, 0, 0
    .long 0, 0, 0, 0, 0, 0, 0, 0, 0, 0, 0, 0, 0, 0, 0, 0
    .long 4, 16, 16, 8192, 7168, 269312, 8388608, 0, 32768, 4, 4308992, 131072, 0, 0, 218104433, 0
    .long 4, 16, 16, 8192, 7168, 269312, 8388608, 262144, 32768, 4, 5357568, 131072, 0, 0, 218104436, 0
    .long 4, 32, 32, 8192, 5376, 267520, 8388608, 786432, 32768, 4, 40980480, 131072, 0, 0, 218104660, 0
    .long 2, 64, 72, 7168, 1536, 1536, 7340032, 0, 32768, 8, 54550528, 114688, 0, 0, 218103809, 0
    .long 1, 24, 24, 8192, 3072, 3328, 8388608, 2621440, 32768, 8, 31506432, 131072, 0, 0, 218105658, 0
    .long 2, 64, 72, 7168, 6656, 6656, 7340032, 2621440, 32768, 8, 63807488, 114688, 0, 0, 218104148, 0
    .long 1, 32, 32, 8192, 5120, 5376, 8388608, 3670016, 32768, 8, 52510720, 131072, 0, 0, 218106202, 0
    .long 1, 80, 80, 2048, 3671040, 3671296, 7340032, 61923328, 114688, 7, 127942656, 32768, 218104080, 7, 218106625, 0
    .long 0, 0, 0, 0, 0, 0, 0, 0, 0, 0, 0, 0, 0, 0, 0, 0
    .long 0, 0, 0, 0, 0, 0, 0, 0, 0, 0, 0, 0, 0, 0, 0, 0
    .long 0, 0, 0, 0, 0, 0, 0, 0, 0, 0, 0, 0, 0, 0, 0, 0
    .long 4, 16, 16, 8192, 7680, 269824, 8388608, 0, 32768, 4, 4317184, 131072, 0, 0, 218104433, 0
    .long 4, 16, 16, 8192, 7680, 269824, 8388608, 262144, 32768, 4, 5365760, 131072, 0, 0, 218104436, 0
    .long 4, 32, 32, 8192, 5888, 268032, 8388608, 786432, 32768, 4, 40988672, 131072, 0, 0, 218104660, 0
    .long 1, 24, 24, 8192, 1536, 1792, 8388608, 2097152, 32768, 8, 29384704, 131072, 0, 0, 218105370, 0
    .long 2, 64, 72, 7168, 6912, 6912, 7340032, 1048576, 32768, 8, 58306560, 114688, 0, 0, 218103956, 0
    .long 1, 24, 24, 8192, 1536, 1792, 8388608, 3145728, 32768, 8, 33579008, 131072, 0, 0, 218105882, 0
    .long 2, 64, 72, 7168, 6912, 6912, 7340032, 3145728, 32768, 8, 65646592, 114688, 0, 0, 218104212, 0
    .long 1, 80, 80, 2048, 5506560, 5506816, 7340032, 61952000, 114688, 7, 132145152, 32768, 218104084, 7, 218106625, 0
    .long 0, 0, 0, 0, 0, 0, 0, 0, 0, 0, 0, 0, 0, 0, 0, 0
    .long 0, 0, 0, 0, 0, 0, 0, 0, 0, 0, 0, 0, 0, 0, 0, 0
    .long 0, 0, 0, 0, 0, 0, 0, 0, 0, 0, 0, 0, 0, 0, 0, 0
    .long 4, 16, 16, 8192, 6400, 268544, 8388608, 0, 32768, 4, 4296704, 131072, 0, 0, 218104417, 0
    .long 4, 16, 16, 8192, 6400, 268544, 8388608, 262144, 32768, 4, 5345280, 131072, 0, 0, 218104420, 0
    .long 4, 32, 32, 8192, 6144, 268288, 8388608, 786432, 32768, 4, 40992768, 131072, 0, 0, 218104676, 0
    .long 1, 24, 24, 8192, 0, 256, 8388608, 2097152, 32768, 8, 29360128, 131072, 0, 0, 218105354, 0
    .long 2, 64, 72, 7168, 6144, 6144, 7340032, 1048576, 32768, 8, 58294272, 114688, 0, 0, 218103956, 0
    .long 1, 24, 24, 8192, 0, 256, 8388608, 3145728, 32768, 8, 33554432, 131072, 0, 0, 218105866, 0
    .long 2, 64, 72, 7168, 6144, 6144, 7340032, 3145728, 32768, 8, 65634304, 114688, 0, 0, 218104212, 0
    .long 1, 80, 80, 2048, 5505024, 5505280, 7340032, 61952000, 114688, 7, 132120576, 32768, 218104084, 7, 218106625, 0
    .long 0, 0, 0, 0, 0, 0, 0, 0, 0, 0, 0, 0, 0, 0, 0, 0
    .long 0, 0, 0, 0, 0, 0, 0, 0, 0, 0, 0, 0, 0, 0, 0, 0
    .long 0, 0, 0, 0, 0, 0, 0, 0, 0, 0, 0, 0, 0, 0, 0, 0
    .long 4, 16, 16, 8192, 6912, 269056, 8388608, 0, 32768, 4, 4304896, 131072, 0, 0, 218104417, 0
    .long 4, 16, 16, 8192, 6912, 269056, 8388608, 262144, 32768, 4, 5353472, 131072, 0, 0, 218104420, 0
    .long 4, 32, 32, 8192, 6656, 268800, 8388608, 786432, 32768, 4, 41000960, 131072, 0, 0, 218104676, 0
    .long 1, 24, 24, 8192, 512, 768, 8388608, 2097152, 32768, 8, 29368320, 131072, 0, 0, 218105354, 0
    .long 2, 64, 72, 7168, 6400, 6400, 7340032, 1048576, 32768, 8, 58298368, 114688, 0, 0, 218103956, 0
    .long 1, 24, 24, 8192, 512, 768, 8388608, 3145728, 32768, 8, 33562624, 131072, 0, 0, 218105866, 0
    .long 2, 64, 72, 7168, 6400, 6400, 7340032, 3145728, 32768, 8, 65638400, 114688, 0, 0, 218104212, 0
    .long 1, 80, 80, 2048, 5505536, 5505792, 7340032, 61952000, 114688, 7, 132128768, 32768, 218104084, 7, 218106625, 0
    .long 0, 0, 0, 0, 0, 0, 0, 0, 0, 0, 0, 0, 0, 0, 0, 0
    .long 0, 0, 0, 0, 0, 0, 0, 0, 0, 0, 0, 0, 0, 0, 0, 0
    .long 0, 0, 0, 0, 0, 0, 0, 0, 0, 0, 0, 0, 0, 0, 0, 0
    .long 4, 16, 16, 8192, 7424, 269568, 8388608, 0, 32768, 4, 4313088, 131072, 0, 0, 218104433, 0
    .long 4, 16, 16, 8192, 7424, 269568, 8388608, 262144, 32768, 4, 5361664, 131072, 0, 0, 218104436, 0
    .long 4, 32, 32, 8192, 7168, 269312, 8388608, 786432, 32768, 4, 41009152, 131072, 0, 0, 218104692, 0
    .long 1, 24, 24, 8192, 1024, 1280, 8388608, 2097152, 32768, 8, 29376512, 131072, 0, 0, 218105370, 0
    .long 2, 64, 72, 7168, 6656, 6656, 7340032, 1048576, 32768, 8, 58302464, 114688, 0, 0, 218103956, 0
    .long 1, 24, 24, 8192, 1024, 1280, 8388608, 3145728, 32768, 8, 33570816, 131072, 0, 0, 218105882, 0
    .long 2, 64, 72, 7168, 6656, 6656, 7340032, 3145728, 32768, 8, 65642496, 114688, 0, 0, 218104212, 0
    .long 1, 80, 80, 2048, 5506048, 5506304, 7340032, 61952000, 114688, 7, 132136960, 32768, 218104084, 7, 218106625, 0
    .long 0, 0, 0, 0, 0, 0, 0, 0, 0, 0, 0, 0, 0, 0, 0, 0
    .long 0, 0, 0, 0, 0, 0, 0, 0, 0, 0, 0, 0, 0, 0, 0, 0
    .long 0, 0, 0, 0, 0, 0, 0, 0, 0, 0, 0, 0, 0, 0, 0, 0
    .long 4, 16, 16, 8192, 7936, 270080, 8388608, 0, 32768, 4, 4321280, 131072, 0, 0, 218104433, 0
    .long 4, 16, 16, 8192, 7936, 270080, 8388608, 262144, 32768, 4, 5369856, 131072, 0, 0, 218104436, 0
    .long 4, 32, 32, 8192, 7680, 269824, 8388608, 786432, 32768, 4, 41017344, 131072, 0, 0, 218104692, 0
    .long 1, 24, 24, 8192, 3584, 3840, 8388608, 2097152, 32768, 8, 29417472, 131072, 0, 0, 218105402, 0
    .long 1, 24, 24, 8192, 1536, 1792, 8388608, 2621440, 32768, 8, 31481856, 131072, 0, 0, 218105626, 0
    .long 2, 64, 72, 7168, 768, 768, 7340032, 2097152, 32768, 8, 61878272, 114688, 0, 0, 218104065, 0
    .long 2, 64, 72, 7168, 768, 768, 7340032, 3670016, 32768, 8, 67383296, 114688, 0, 0, 218104257, 0
    .long 1, 80, 80, 2048, 1536, 1792, 7340032, 63700992, 114688, 7, 120086528, 32768, 218104128, 7, 218106689, 0
    .long 0, 0, 0, 0, 0, 0, 0, 0, 0, 0, 0, 0, 0, 0, 0, 0
    .long 0, 0, 0, 0, 0, 0, 0, 0, 0, 0, 0, 0, 0, 0, 0, 0
    .long 0, 0, 0, 0, 0, 0, 0, 0, 0, 0, 0, 0, 0, 0, 0, 0
    .long 1, 24, 24, 8192, 0, 256, 8388608, 524288, 32768, 8, 23068672, 131072, 0, 0, 218104586, 0
    .long 4, 16, 16, 8192, 4096, 266240, 8388608, 786432, 32768, 4, 7405568, 131072, 0, 0, 218104644, 0
    .long 1, 24, 24, 8192, 4096, 4352, 8388608, 2097152, 32768, 8, 29425664, 131072, 0, 0, 218105418, 0
    .long 1, 24, 24, 8192, 6144, 6400, 8388608, 2621440, 32768, 8, 31555584, 131072, 0, 0, 218105706, 0
    .long 1, 24, 24, 8192, 4096, 4352, 8388608, 3145728, 32768, 8, 33619968, 131072, 0, 0, 218105930, 0
    .long 1, 16, 16, 8192, 0, 256, 8388608, 3670016, 32768, 8, 18874368, 131072, 0, 0, 218106122, 0
    .long 1, 80, 80, 2048, 0, 256, 7340032, 67371008, 114688, 7, 121110528, 32768, 218104256, 7, 218106817, 0
    .long 0, 0, 0, 0, 0, 0, 0, 0, 0, 0, 0, 0, 0, 0, 0, 0
    .long 0, 0, 0, 0, 0, 0, 0, 0, 0, 0, 0, 0, 0, 0, 0, 0
    .long 0, 0, 0, 0, 0, 0, 0, 0, 0, 0, 0, 0, 0, 0, 0, 0
    .long 0, 0, 0, 0, 0, 0, 0, 0, 0, 0, 0, 0, 0, 0, 0, 0
    .long 1, 24, 24, 8192, 512, 768, 8388608, 524288, 32768, 8, 23076864, 131072, 0, 0, 218104586, 0
    .long 4, 16, 16, 8192, 4608, 266752, 8388608, 786432, 32768, 4, 7413760, 131072, 0, 0, 218104644, 0
    .long 1, 24, 24, 8192, 4608, 4864, 8388608, 2097152, 32768, 8, 29433856, 131072, 0, 0, 218105418, 0
    .long 1, 24, 24, 8192, 6656, 6912, 8388608, 2621440, 32768, 8, 31563776, 131072, 0, 0, 218105706, 0
    .long 1, 24, 24, 8192, 4608, 4864, 8388608, 3145728, 32768, 8, 33628160, 131072, 0, 0, 218105930, 0
    .long 1, 16, 16, 8192, 512, 768, 8388608, 3670016, 32768, 8, 18882560, 131072, 0, 0, 218106122, 0
    .long 1, 80, 80, 2048, 512, 768, 7340032, 67371008, 114688, 7, 121118720, 32768, 218104256, 7, 218106817, 0
    .long 0, 0, 0, 0, 0, 0, 0, 0, 0, 0, 0, 0, 0, 0, 0, 0
    .long 0, 0, 0, 0, 0, 0, 0, 0, 0, 0, 0, 0, 0, 0, 0, 0
    .long 0, 0, 0, 0, 0, 0, 0, 0, 0, 0, 0, 0, 0, 0, 0, 0
    .long 0, 0, 0, 0, 0, 0, 0, 0, 0, 0, 0, 0, 0, 0, 0, 0
    .long 1, 24, 24, 8192, 1024, 1280, 8388608, 524288, 32768, 8, 23085056, 131072, 0, 0, 218104602, 0
    .long 4, 16, 16, 8192, 5120, 267264, 8388608, 786432, 32768, 4, 7421952, 131072, 0, 0, 218104660, 0
    .long 1, 24, 24, 8192, 5120, 5376, 8388608, 2097152, 32768, 8, 29442048, 131072, 0, 0, 218105434, 0
    .long 1, 24, 24, 8192, 7168, 7424, 8388608, 2621440, 32768, 8, 31571968, 131072, 0, 0, 218105722, 0
    .long 1, 24, 24, 8192, 5120, 5376, 8388608, 3145728, 32768, 8, 33636352, 131072, 0, 0, 218105946, 0
    .long 1, 16, 16, 8192, 1024, 1280, 8388608, 3670016, 32768, 8, 18890752, 131072, 0, 0, 218106138, 0
    .long 1, 80, 80, 2048, 1024, 1280, 7340032, 67371008, 114688, 7, 121126912, 32768, 218104256, 7, 218106817, 0
    .long 0, 0, 0, 0, 0, 0, 0, 0, 0, 0, 0, 0, 0, 0, 0, 0
    .long 0, 0, 0, 0, 0, 0, 0, 0, 0, 0, 0, 0, 0, 0, 0, 0
    .long 0, 0, 0, 0, 0, 0, 0, 0, 0, 0, 0, 0, 0, 0, 0, 0
    .long 0, 0, 0, 0, 0, 0, 0, 0, 0, 0, 0, 0, 0, 0, 0, 0
    .long 1, 24, 24, 8192, 1536, 1792, 8388608, 524288, 32768, 8, 23093248, 131072, 0, 0, 218104602, 0
    .long 4, 16, 16, 8192, 5632, 267776, 8388608, 786432, 32768, 4, 7430144, 131072, 0, 0, 218104660, 0
    .long 1, 24, 24, 8192, 7680, 7936, 8388608, 2097152, 32768, 8, 29483008, 131072, 0, 0, 218105466, 0
    .long 1, 24, 24, 8192, 7680, 7936, 8388608, 2621440, 32768, 8, 31580160, 131072, 0, 0, 218105722, 0
    .long 1, 24, 24, 8192, 5632, 5888, 8388608, 3145728, 32768, 8, 33644544, 131072, 0, 0, 218105946, 0
    .long 1, 16, 16, 8192, 1536, 1792, 8388608, 3670016, 32768, 8, 18898944, 131072, 0, 0, 218106138, 0
    .long 1, 80, 80, 2048, 1536, 1792, 7340032, 67371008, 114688, 7, 121135104, 32768, 218104256, 7, 218106817, 0
    .long 0, 0, 0, 0, 0, 0, 0, 0, 0, 0, 0, 0, 0, 0, 0, 0
    .long 0, 0, 0, 0, 0, 0, 0, 0, 0, 0, 0, 0, 0, 0, 0, 0
    .long 0, 0, 0, 0, 0, 0, 0, 0, 0, 0, 0, 0, 0, 0, 0, 0
    .long 0, 0, 0, 0, 0, 0, 0, 0, 0, 0, 0, 0, 0, 0, 0, 0
    .long 1, 32, 32, 8192, 0, 256, 8388608, 524288, 32768, 8, 39845888, 131072, 0, 0, 218104586, 0
    .long 4, 16, 16, 8192, 4352, 266496, 8388608, 786432, 32768, 4, 7409664, 131072, 0, 0, 218104644, 0
    .long 1, 24, 24, 8192, 6144, 6400, 8388608, 2097152, 32768, 8, 29458432, 131072, 0, 0, 218105450, 0
    .long 1, 32, 32, 8192, 0, 256, 8388608, 2621440, 32768, 8, 48234496, 131072, 0, 0, 218105610, 0
    .long 1, 24, 24, 8192, 6144, 6400, 8388608, 3145728, 32768, 8, 33652736, 131072, 0, 0, 218105962, 0
    .long 1, 16, 16, 8192, 2048, 2304, 8388608, 3670016, 32768, 8, 18907136, 131072, 0, 0, 218106154, 0
    .long 1, 80, 80, 2048, 1835008, 1835264, 7340032, 67399680, 114688, 7, 125304832, 32768, 218104260, 7, 218106817, 0
    .long 0, 0, 0, 0, 0, 0, 0, 0, 0, 0, 0, 0, 0, 0, 0, 0
    .long 0, 0, 0, 0, 0, 0, 0, 0, 0, 0, 0, 0, 0, 0, 0, 0
    .long 0, 0, 0, 0, 0, 0, 0, 0, 0, 0, 0, 0, 0, 0, 0, 0
    .long 0, 0, 0, 0, 0, 0, 0, 0, 0, 0, 0, 0, 0, 0, 0, 0
    .long 1, 32, 32, 8192, 512, 768, 8388608, 524288, 32768, 8, 39854080, 131072, 0, 0, 218104586, 0
    .long 4, 16, 16, 8192, 4864, 267008, 8388608, 786432, 32768, 4, 7417856, 131072, 0, 0, 218104644, 0
    .long 1, 24, 24, 8192, 6656, 6912, 8388608, 2097152, 32768, 8, 29466624, 131072, 0, 0, 218105450, 0
    .long 1, 32, 32, 8192, 512, 768, 8388608, 2621440, 32768, 8, 48242688, 131072, 0, 0, 218105610, 0
    .long 1, 24, 24, 8192, 6656, 6912, 8388608, 3145728, 32768, 8, 33660928, 131072, 0, 0, 218105962, 0
    .long 1, 16, 16, 8192, 2560, 2816, 8388608, 3670016, 32768, 8, 18915328, 131072, 0, 0, 218106154, 0
    .long 1, 80, 80, 2048, 1835520, 1835776, 7340032, 67399680, 114688, 7, 125313024, 32768, 218104260, 7, 218106817, 0
    .long 0, 0, 0, 0, 0, 0, 0, 0, 0, 0, 0, 0, 0, 0, 0, 0
    .long 0, 0, 0, 0, 0, 0, 0, 0, 0, 0, 0, 0, 0, 0, 0, 0
    .long 0, 0, 0, 0, 0, 0, 0, 0, 0, 0, 0, 0, 0, 0, 0, 0
    .long 0, 0, 0, 0, 0, 0, 0, 0, 0, 0, 0, 0, 0, 0, 0, 0
    .long 1, 32, 32, 8192, 1024, 1280, 8388608, 524288, 32768, 8, 39862272, 131072, 0, 0, 218104602, 0
    .long 4, 16, 16, 8192, 5376, 267520, 8388608, 786432, 32768, 4, 7426048, 131072, 0, 0, 218104660, 0
    .long 1, 24, 24, 8192, 7168, 7424, 8388608, 2097152, 32768, 8, 29474816, 131072, 0, 0, 218105466, 0
    .long 1, 32, 32, 8192, 1024, 1280, 8388608, 2621440, 32768, 8, 48250880, 131072, 0, 0, 218105626, 0
    .long 1, 24, 24, 8192, 7168, 7424, 8388608, 3145728, 32768, 8, 33669120, 131072, 0, 0, 218105978, 0
    .long 1, 16, 16, 8192, 3072, 3328, 8388608, 3670016, 32768, 8, 18923520, 131072, 0, 0, 218106170, 0
    .long 1, 80, 80, 2048, 1836032, 1836288, 7340032, 67399680, 114688, 7, 125321216, 32768, 218104260, 7, 218106817, 0
    .long 0, 0, 0, 0, 0, 0, 0, 0, 0, 0, 0, 0, 0, 0, 0, 0
    .long 0, 0, 0, 0, 0, 0, 0, 0, 0, 0, 0, 0, 0, 0, 0, 0
    .long 0, 0, 0, 0, 0, 0, 0, 0, 0, 0, 0, 0, 0, 0, 0, 0
    .long 0, 0, 0, 0, 0, 0, 0, 0, 0, 0, 0, 0, 0, 0, 0, 0
    .long 1, 32, 32, 8192, 1536, 1792, 8388608, 524288, 32768, 8, 39870464, 131072, 0, 0, 218104602, 0
    .long 4, 16, 16, 8192, 5888, 268032, 8388608, 786432, 32768, 4, 7434240, 131072, 0, 0, 218104660, 0
    .long 1, 32, 32, 8192, 1536, 1792, 8388608, 2097152, 32768, 8, 46161920, 131072, 0, 0, 218105370, 0
    .long 1, 32, 32, 8192, 1536, 1792, 8388608, 2621440, 32768, 8, 48259072, 131072, 0, 0, 218105626, 0
    .long 1, 24, 24, 8192, 7680, 7936, 8388608, 3145728, 32768, 8, 33677312, 131072, 0, 0, 218105978, 0
    .long 1, 16, 16, 8192, 3584, 3840, 8388608, 3670016, 32768, 8, 18931712, 131072, 0, 0, 218106170, 0
    .long 1, 80, 80, 2048, 1836544, 1836800, 7340032, 67399680, 114688, 7, 125329408, 32768, 218104260, 7, 218106817, 0
    .long 0, 0, 0, 0, 0, 0, 0, 0, 0, 0, 0, 0, 0, 0, 0, 0
    .long 0, 0, 0, 0, 0, 0, 0, 0, 0, 0, 0, 0, 0, 0, 0, 0
    .long 0, 0, 0, 0, 0, 0, 0, 0, 0, 0, 0, 0, 0, 0, 0, 0
    .long 0, 0, 0, 0, 0, 0, 0, 0, 0, 0, 0, 0, 0, 0, 0, 0
    .long 1, 16, 16, 8192, 0, 256, 8388608, 524288, 32768, 8, 6291456, 131072, 0, 0, 218104586, 0
    .long 4, 16, 16, 8192, 6144, 268288, 8388608, 786432, 32768, 4, 7438336, 131072, 0, 0, 218104676, 0
    .long 1, 32, 32, 8192, 0, 256, 8388608, 2097152, 32768, 8, 46137344, 131072, 0, 0, 218105354, 0
    .long 1, 32, 32, 8192, 2048, 2304, 8388608, 2621440, 32768, 8, 48267264, 131072, 0, 0, 218105642, 0
    .long 1, 32, 32, 8192, 0, 256, 8388608, 3145728, 32768, 8, 50331648, 131072, 0, 0, 218105866, 0
    .long 1, 16, 16, 8192, 4096, 4352, 8388608, 3670016, 32768, 8, 18939904, 131072, 0, 0, 218106186, 0
    .long 1, 80, 80, 2048, 3670016, 3670272, 7340032, 67428352, 114688, 7, 129499136, 32768, 218104272, 7, 218106817, 0
    .long 0, 0, 0, 0, 0, 0, 0, 0, 0, 0, 0, 0, 0, 0, 0, 0
    .long 0, 0, 0, 0, 0, 0, 0, 0, 0, 0, 0, 0, 0, 0, 0, 0
    .long 0, 0, 0, 0, 0, 0, 0, 0, 0, 0, 0, 0, 0, 0, 0, 0
    .long 0, 0, 0, 0, 0, 0, 0, 0, 0, 0, 0, 0, 0, 0, 0, 0
    .long 1, 16, 16, 8192, 512, 768, 8388608, 524288, 32768, 8, 6299648, 131072, 0, 0, 218104586, 0
    .long 4, 16, 16, 8192, 6656, 268800, 8388608, 786432, 32768, 4, 7446528, 131072, 0, 0, 218104676, 0
    .long 1, 32, 32, 8192, 512, 768, 8388608, 2097152, 32768, 8, 46145536, 131072, 0, 0, 218105354, 0
    .long 1, 32, 32, 8192, 2560, 2816, 8388608, 2621440, 32768, 8, 48275456, 131072, 0, 0, 218105642, 0
    .long 1, 32, 32, 8192, 512, 768, 8388608, 3145728, 32768, 8, 50339840, 131072, 0, 0, 218105866, 0
    .long 1, 16, 16, 8192, 4608, 4864, 8388608, 3670016, 32768, 8, 18948096, 131072, 0, 0, 218106186, 0
    .long 1, 80, 80, 2048, 3670528, 3670784, 7340032, 67428352, 114688, 7, 129507328, 32768, 218104272, 7, 218106817, 0
    .long 0, 0, 0, 0, 0, 0, 0, 0, 0, 0, 0, 0, 0, 0, 0, 0
    .long 0, 0, 0, 0, 0, 0, 0, 0, 0, 0, 0, 0, 0, 0, 0, 0
    .long 0, 0, 0, 0, 0, 0, 0, 0, 0, 0, 0, 0, 0, 0, 0, 0
    .long 0, 0, 0, 0, 0, 0, 0, 0, 0, 0, 0, 0, 0, 0, 0, 0
    .long 1, 16, 16, 8192, 1024, 1280, 8388608, 524288, 32768, 8, 6307840, 131072, 0, 0, 218104602, 0
    .long 4, 16, 16, 8192, 7168, 269312, 8388608, 786432, 32768, 4, 7454720, 131072, 0, 0, 218104692, 0
    .long 1, 32, 32, 8192, 1024, 1280, 8388608, 2097152, 32768, 8, 46153728, 131072, 0, 0, 218105370, 0
    .long 1, 32, 32, 8192, 3072, 3328, 8388608, 2621440, 32768, 8, 48283648, 131072, 0, 0, 218105658, 0
    .long 1, 32, 32, 8192, 1024, 1280, 8388608, 3145728, 32768, 8, 50348032, 131072, 0, 0, 218105882, 0
    .long 1, 16, 16, 8192, 5120, 5376, 8388608, 3670016, 32768, 8, 18956288, 131072, 0, 0, 218106202, 0
    .long 1, 80, 80, 2048, 3671040, 3671296, 7340032, 67428352, 114688, 7, 129515520, 32768, 218104272, 7, 218106817, 0
    .long 0, 0, 0, 0, 0, 0, 0, 0, 0, 0, 0, 0, 0, 0, 0, 0
    .long 0, 0, 0, 0, 0, 0, 0, 0, 0, 0, 0, 0, 0, 0, 0, 0
    .long 0, 0, 0, 0, 0, 0, 0, 0, 0, 0, 0, 0, 0, 0, 0, 0
    .long 0, 0, 0, 0, 0, 0, 0, 0, 0, 0, 0, 0, 0, 0, 0, 0
    .long 1, 16, 16, 8192, 1536, 1792, 8388608, 524288, 32768, 8, 6316032, 131072, 0, 0, 218104602, 0
    .long 4, 16, 16, 8192, 7680, 269824, 8388608, 786432, 32768, 4, 7462912, 131072, 0, 0, 218104692, 0
    .long 1, 32, 32, 8192, 3584, 3840, 8388608, 2097152, 32768, 8, 46194688, 131072, 0, 0, 218105402, 0
    .long 1, 32, 32, 8192, 3584, 3840, 8388608, 2621440, 32768, 8, 48291840, 131072, 0, 0, 218105658, 0
    .long 1, 32, 32, 8192, 1536, 1792, 8388608, 3145728, 32768, 8, 50356224, 131072, 0, 0, 218105882, 0
    .long 1, 16, 16, 8192, 5632, 5888, 8388608, 3670016, 32768, 8, 18964480, 131072, 0, 0, 218106202, 0
    .long 1, 80, 80, 2048, 3671552, 3671808, 7340032, 67428352, 114688, 7, 129523712, 32768, 218104272, 7, 218106817, 0
    .long 0, 0, 0, 0, 0, 0, 0, 0, 0, 0, 0, 0, 0, 0, 0, 0
    .long 0, 0, 0, 0, 0, 0, 0, 0, 0, 0, 0, 0, 0, 0, 0, 0
    .long 0, 0, 0, 0, 0, 0, 0, 0, 0, 0, 0, 0, 0, 0, 0, 0
    .long 0, 0, 0, 0, 0, 0, 0, 0, 0, 0, 0, 0, 0, 0, 0, 0
    .long 1, 24, 24, 8192, 2048, 2304, 8388608, 524288, 32768, 8, 23101440, 131072, 0, 0, 218104618, 0
    .long 4, 16, 16, 8192, 6400, 268544, 8388608, 786432, 32768, 4, 7442432, 131072, 0, 0, 218104676, 0
    .long 1, 32, 32, 8192, 2048, 2304, 8388608, 2097152, 32768, 8, 46170112, 131072, 0, 0, 218105386, 0
    .long 1, 32, 32, 8192, 4096, 4352, 8388608, 2621440, 32768, 8, 48300032, 131072, 0, 0, 218105674, 0
    .long 1, 32, 32, 8192, 2048, 2304, 8388608, 3145728, 32768, 8, 50364416, 131072, 0, 0, 218105898, 0
    .long 1, 16, 16, 8192, 6144, 6400, 8388608, 3670016, 32768, 8, 18972672, 131072, 0, 0, 218106218, 0
    .long 1, 80, 80, 2048, 5505024, 5505280, 7340032, 67457024, 114688, 7, 133693440, 32768, 218104276, 7, 218106817, 0
    .long 0, 0, 0, 0, 0, 0, 0, 0, 0, 0, 0, 0, 0, 0, 0, 0
    .long 0, 0, 0, 0, 0, 0, 0, 0, 0, 0, 0, 0, 0, 0, 0, 0
    .long 0, 0, 0, 0, 0, 0, 0, 0, 0, 0, 0, 0, 0, 0, 0, 0
    .long 0, 0, 0, 0, 0, 0, 0, 0, 0, 0, 0, 0, 0, 0, 0, 0
    .long 1, 24, 24, 8192, 2560, 2816, 8388608, 524288, 32768, 8, 23109632, 131072, 0, 0, 218104618, 0
    .long 4, 16, 16, 8192, 6912, 269056, 8388608, 786432, 32768, 4, 7450624, 131072, 0, 0, 218104676, 0
    .long 1, 32, 32, 8192, 2560, 2816, 8388608, 2097152, 32768, 8, 46178304, 131072, 0, 0, 218105386, 0
    .long 1, 32, 32, 8192, 4608, 4864, 8388608, 2621440, 32768, 8, 48308224, 131072, 0, 0, 218105674, 0
    .long 1, 32, 32, 8192, 2560, 2816, 8388608, 3145728, 32768, 8, 50372608, 131072, 0, 0, 218105898, 0
    .long 1, 16, 16, 8192, 6656, 6912, 8388608, 3670016, 32768, 8, 18980864, 131072, 0, 0, 218106218, 0
    .long 1, 80, 80, 2048, 5505536, 5505792, 7340032, 67457024, 114688, 7, 133701632, 32768, 218104276, 7, 218106817, 0
    .long 0, 0, 0, 0, 0, 0, 0, 0, 0, 0, 0, 0, 0, 0, 0, 0
    .long 0, 0, 0, 0, 0, 0, 0, 0, 0, 0, 0, 0, 0, 0, 0, 0
    .long 0, 0, 0, 0, 0, 0, 0, 0, 0, 0, 0, 0, 0, 0, 0, 0
    .long 0, 0, 0, 0, 0, 0, 0, 0, 0, 0, 0, 0, 0, 0, 0, 0
    .long 1, 24, 24, 8192, 3072, 3328, 8388608, 524288, 32768, 8, 23117824, 131072, 0, 0, 218104634, 0
    .long 4, 16, 16, 8192, 7424, 269568, 8388608, 786432, 32768, 4, 7458816, 131072, 0, 0, 218104692, 0
    .long 1, 32, 32, 8192, 3072, 3328, 8388608, 2097152, 32768, 8, 46186496, 131072, 0, 0, 218105402, 0
    .long 1, 32, 32, 8192, 5120, 5376, 8388608, 2621440, 32768, 8, 48316416, 131072, 0, 0, 218105690, 0
    .long 1, 32, 32, 8192, 3072, 3328, 8388608, 3145728, 32768, 8, 50380800, 131072, 0, 0, 218105914, 0
    .long 1, 16, 16, 8192, 7168, 7424, 8388608, 3670016, 32768, 8, 18989056, 131072, 0, 0, 218106234, 0
    .long 1, 80, 80, 2048, 5506048, 5506304, 7340032, 67457024, 114688, 7, 133709824, 32768, 218104276, 7, 218106817, 0
    .long 0, 0, 0, 0, 0, 0, 0, 0, 0, 0, 0, 0, 0, 0, 0, 0
    .long 0, 0, 0, 0, 0, 0, 0, 0, 0, 0, 0, 0, 0, 0, 0, 0
    .long 0, 0, 0, 0, 0, 0, 0, 0, 0, 0, 0, 0, 0, 0, 0, 0
    .long 0, 0, 0, 0, 0, 0, 0, 0, 0, 0, 0, 0, 0, 0, 0, 0
    .long 1, 24, 24, 8192, 3584, 3840, 8388608, 524288, 32768, 8, 23126016, 131072, 0, 0, 218104634, 0
    .long 4, 16, 16, 8192, 7936, 270080, 8388608, 786432, 32768, 4, 7467008, 131072, 0, 0, 218104692, 0
    .long 1, 32, 32, 8192, 5632, 5888, 8388608, 2097152, 32768, 8, 46227456, 131072, 0, 0, 218105434, 0
    .long 1, 32, 32, 8192, 5632, 5888, 8388608, 2621440, 32768, 8, 48324608, 131072, 0, 0, 218105690, 0
    .long 1, 32, 32, 8192, 3584, 3840, 8388608, 3145728, 32768, 8, 50388992, 131072, 0, 0, 218105914, 0
    .long 1, 16, 16, 8192, 7680, 7936, 8388608, 3670016, 32768, 8, 18997248, 131072, 0, 0, 218106234, 0
    .long 1, 80, 80, 2048, 5506560, 5506816, 7340032, 67457024, 114688, 7, 133718016, 32768, 218104276, 7, 218106817, 0
    .long 0, 0, 0, 0, 0, 0, 0, 0, 0, 0, 0, 0, 0, 0, 0, 0
    .long 0, 0, 0, 0, 0, 0, 0, 0, 0, 0, 0, 0, 0, 0, 0, 0
    .long 0, 0, 0, 0, 0, 0, 0, 0, 0, 0, 0, 0, 0, 0, 0, 0
    .long 0, 0, 0, 0, 0, 0, 0, 0, 0, 0, 0, 0, 0, 0, 0, 0
    .long 1, 32, 32, 8192, 2048, 2304, 8388608, 524288, 32768, 8, 39878656, 131072, 0, 0, 218104618, 0
    .long 1, 24, 24, 8192, 0, 256, 8388608, 1572864, 32768, 8, 27262976, 131072, 0, 0, 218105098, 0
    .long 2, 64, 72, 7168, 1024, 1024, 7340032, 524288, 32768, 8, 56377344, 114688, 0, 0, 218103873, 0
    .long 2, 64, 72, 7168, 0, 0, 7340032, 2097152, 32768, 8, 61865984, 114688, 0, 0, 218104065, 0
    .long 2, 64, 72, 7168, 0, 0, 7340032, 3670016, 32768, 8, 67371008, 114688, 0, 0, 218104257, 0
    .long 1, 80, 80, 2048, 0, 256, 7340032, 63700992, 114688, 7, 120061952, 32768, 218104128, 7, 218106689, 0
    .long 0, 0, 0, 0, 0, 0, 0, 0, 0, 0, 0, 0, 0, 0, 0, 0
    .long 0, 0, 0, 0, 0, 0, 0, 0, 0, 0, 0, 0, 0, 0, 0, 0
    .long 0, 0, 0, 0, 0, 0, 0, 0, 0, 0, 0, 0, 0, 0, 0, 0
    .long 0, 0, 0, 0, 0, 0, 0, 0, 0, 0, 0, 0, 0, 0, 0, 0
    .long 0, 0, 0, 0, 0, 0, 0, 0, 0, 0, 0, 0, 0, 0, 0, 0
    .long 1, 32, 32, 8192, 2560, 2816, 8388608, 524288, 32768, 8, 39886848, 131072, 0, 0, 218104618, 0
    .long 1, 24, 24, 8192, 512, 768, 8388608, 1572864, 32768, 8, 27271168, 131072, 0, 0, 218105098, 0
    .long 2, 64, 72, 7168, 1280, 1280, 7340032, 524288, 32768, 8, 56381440, 114688, 0, 0, 218103873, 0
    .long 2, 64, 72, 7168, 256, 256, 7340032, 2097152, 32768, 8, 61870080, 114688, 0, 0, 218104065, 0
    .long 2, 64, 72, 7168, 256, 256, 7340032, 3670016, 32768, 8, 67375104, 114688, 0, 0, 218104257, 0
    .long 1, 80, 80, 2048, 512, 768, 7340032, 63700992, 114688, 7, 120070144, 32768, 218104128, 7, 218106689, 0
    .long 0, 0, 0, 0, 0, 0, 0, 0, 0, 0, 0, 0, 0, 0, 0, 0
    .long 0, 0, 0, 0, 0, 0, 0, 0, 0, 0, 0, 0, 0, 0, 0, 0
    .long 0, 0, 0, 0, 0, 0, 0, 0, 0, 0, 0, 0, 0, 0, 0, 0
    .long 0, 0, 0, 0, 0, 0, 0, 0, 0, 0, 0, 0, 0, 0, 0, 0
    .long 0, 0, 0, 0, 0, 0, 0, 0, 0, 0, 0, 0, 0, 0, 0, 0
    .long 1, 32, 32, 8192, 3072, 3328, 8388608, 524288, 32768, 8, 39895040, 131072, 0, 0, 218104634, 0
    .long 1, 24, 24, 8192, 1024, 1280, 8388608, 1572864, 32768, 8, 27279360, 131072, 0, 0, 218105114, 0
    .long 2, 64, 72, 7168, 1536, 1536, 7340032, 524288, 32768, 8, 56385536, 114688, 0, 0, 218103873, 0
    .long 2, 64, 72, 7168, 512, 512, 7340032, 2097152, 32768, 8, 61874176, 114688, 0, 0, 218104065, 0
    .long 2, 64, 72, 7168, 512, 512, 7340032, 3670016, 32768, 8, 67379200, 114688, 0, 0, 218104257, 0
    .long 1, 80, 80, 2048, 1024, 1280, 7340032, 63700992, 114688, 7, 120078336, 32768, 218104128, 7, 218106689, 0
    .long 0, 0, 0, 0, 0, 0, 0, 0, 0, 0, 0, 0, 0, 0, 0, 0
    .long 0, 0, 0, 0, 0, 0, 0, 0, 0, 0, 0, 0, 0, 0, 0, 0
    .long 0, 0, 0, 0, 0, 0, 0, 0, 0, 0, 0, 0, 0, 0, 0, 0
    .long 0, 0, 0, 0, 0, 0, 0, 0, 0, 0, 0, 0, 0, 0, 0, 0
    .long 0, 0, 0, 0, 0, 0, 0, 0, 0, 0, 0, 0, 0, 0, 0, 0
    .long 1, 32, 32, 8192, 3584, 3840, 8388608, 524288, 32768, 8, 39903232, 131072, 0, 0, 218104634, 0
    .long 1, 24, 24, 8192, 1536, 1792, 8388608, 1572864, 32768, 8, 27287552, 131072, 0, 0, 218105114, 0
    .long 2, 64, 72, 7168, 1792, 1792, 7340032, 524288, 32768, 8, 56389632, 114688, 0, 0, 218103876, 0
    .long 2, 64, 72, 7168, 1792, 1792, 7340032, 2097152, 32768, 8, 61894656, 114688, 0, 0, 218104068, 0
    .long 2, 64, 72, 7168, 1792, 1792, 7340032, 3670016, 32768, 8, 67399680, 114688, 0, 0, 218104260, 0
    .long 1, 80, 80, 2048, 1836544, 1836800, 7340032, 63729664, 114688, 7, 124280832, 32768, 218104132, 7, 218106689, 0
    .long 0, 0, 0, 0, 0, 0, 0, 0, 0, 0, 0, 0, 0, 0, 0, 0
    .long 0, 0, 0, 0, 0, 0, 0, 0, 0, 0, 0, 0, 0, 0, 0, 0
    .long 0, 0, 0, 0, 0, 0, 0, 0, 0, 0, 0, 0, 0, 0, 0, 0
    .long 0, 0, 0, 0, 0, 0, 0, 0, 0, 0, 0, 0, 0, 0, 0, 0
    .long 0, 0, 0, 0, 0, 0, 0, 0, 0, 0, 0, 0, 0, 0, 0, 0
    .long 1, 16, 16, 8192, 2048, 2304, 8388608, 524288, 32768, 8, 6324224, 131072, 0, 0, 218104618, 0
    .long 1, 24, 24, 8192, 2048, 2304, 8388608, 1572864, 32768, 8, 27295744, 131072, 0, 0, 218105130, 0
    .long 2, 64, 72, 7168, 2048, 2048, 7340032, 524288, 32768, 8, 56393728, 114688, 0, 0, 218103876, 0
    .long 2, 64, 72, 7168, 1024, 1024, 7340032, 2097152, 32768, 8, 61882368, 114688, 0, 0, 218104065, 0
    .long 2, 64, 72, 7168, 1024, 1024, 7340032, 3670016, 32768, 8, 67387392, 114688, 0, 0, 218104257, 0
    .long 1, 80, 80, 2048, 1835008, 1835264, 7340032, 63729664, 114688, 7, 124256256, 32768, 218104132, 7, 218106689, 0
    .long 0, 0, 0, 0, 0, 0, 0, 0, 0, 0, 0, 0, 0, 0, 0, 0
    .long 0, 0, 0, 0, 0, 0, 0, 0, 0, 0, 0, 0, 0, 0, 0, 0
    .long 0, 0, 0, 0, 0, 0, 0, 0, 0, 0, 0, 0, 0, 0, 0, 0
    .long 0, 0, 0, 0, 0, 0, 0, 0, 0, 0, 0, 0, 0, 0, 0, 0
    .long 0, 0, 0, 0, 0, 0, 0, 0, 0, 0, 0, 0, 0, 0, 0, 0
    .long 1, 16, 16, 8192, 2560, 2816, 8388608, 524288, 32768, 8, 6332416, 131072, 0, 0, 218104618, 0
    .long 1, 24, 24, 8192, 2560, 2816, 8388608, 1572864, 32768, 8, 27303936, 131072, 0, 0, 218105130, 0
    .long 2, 64, 72, 7168, 2304, 2304, 7340032, 524288, 32768, 8, 56397824, 114688, 0, 0, 218103876, 0
    .long 2, 64, 72, 7168, 1280, 1280, 7340032, 2097152, 32768, 8, 61886464, 114688, 0, 0, 218104065, 0
    .long 2, 64, 72, 7168, 1280, 1280, 7340032, 3670016, 32768, 8, 67391488, 114688, 0, 0, 218104257, 0
    .long 1, 80, 80, 2048, 1835520, 1835776, 7340032, 63729664, 114688, 7, 124264448, 32768, 218104132, 7, 218106689, 0
    .long 0, 0, 0, 0, 0, 0, 0, 0, 0, 0, 0, 0, 0, 0, 0, 0
    .long 0, 0, 0, 0, 0, 0, 0, 0, 0, 0, 0, 0, 0, 0, 0, 0
    .long 0, 0, 0, 0, 0, 0, 0, 0, 0, 0, 0, 0, 0, 0, 0, 0
    .long 0, 0, 0, 0, 0, 0, 0, 0, 0, 0, 0, 0, 0, 0, 0, 0
    .long 0, 0, 0, 0, 0, 0, 0, 0, 0, 0, 0, 0, 0, 0, 0, 0
    .long 1, 16, 16, 8192, 3072, 3328, 8388608, 524288, 32768, 8, 6340608, 131072, 0, 0, 218104634, 0
    .long 1, 24, 24, 8192, 3072, 3328, 8388608, 1572864, 32768, 8, 27312128, 131072, 0, 0, 218105146, 0
    .long 2, 64, 72, 7168, 2560, 2560, 7340032, 524288, 32768, 8, 56401920, 114688, 0, 0, 218103876, 0
    .long 2, 64, 72, 7168, 1536, 1536, 7340032, 2097152, 32768, 8, 61890560, 114688, 0, 0, 218104065, 0
    .long 2, 64, 72, 7168, 1536, 1536, 7340032, 3670016, 32768, 8, 67395584, 114688, 0, 0, 218104257, 0
    .long 1, 80, 80, 2048, 1836032, 1836288, 7340032, 63729664, 114688, 7, 124272640, 32768, 218104132, 7, 218106689, 0
    .long 0, 0, 0, 0, 0, 0, 0, 0, 0, 0, 0, 0, 0, 0, 0, 0
    .long 0, 0, 0, 0, 0, 0, 0, 0, 0, 0, 0, 0, 0, 0, 0, 0
    .long 0, 0, 0, 0, 0, 0, 0, 0, 0, 0, 0, 0, 0, 0, 0, 0
    .long 0, 0, 0, 0, 0, 0, 0, 0, 0, 0, 0, 0, 0, 0, 0, 0
    .long 0, 0, 0, 0, 0, 0, 0, 0, 0, 0, 0, 0, 0, 0, 0, 0
    .long 1, 16, 16, 8192, 3584, 3840, 8388608, 524288, 32768, 8, 6348800, 131072, 0, 0, 218104634, 0
    .long 1, 24, 24, 8192, 3584, 3840, 8388608, 1572864, 32768, 8, 27320320, 131072, 0, 0, 218105146, 0
    .long 2, 64, 72, 7168, 2816, 2816, 7340032, 524288, 32768, 8, 56406016, 114688, 0, 0, 218103876, 0
    .long 2, 64, 72, 7168, 2816, 2816, 7340032, 2097152, 32768, 8, 61911040, 114688, 0, 0, 218104068, 0
    .long 2, 64, 72, 7168, 2816, 2816, 7340032, 3670016, 32768, 8, 67416064, 114688, 0, 0, 218104260, 0
    .long 1, 80, 80, 2048, 3671552, 3671808, 7340032, 63758336, 114688, 7, 128475136, 32768, 218104144, 7, 218106689, 0
    .long 0, 0, 0, 0, 0, 0, 0, 0, 0, 0, 0, 0, 0, 0, 0, 0
    .long 0, 0, 0, 0, 0, 0, 0, 0, 0, 0, 0, 0, 0, 0, 0, 0
    .long 0, 0, 0, 0, 0, 0, 0, 0, 0, 0, 0, 0, 0, 0, 0, 0
    .long 0, 0, 0, 0, 0, 0, 0, 0, 0, 0, 0, 0, 0, 0, 0, 0
    .long 0, 0, 0, 0, 0, 0, 0, 0, 0, 0, 0, 0, 0, 0, 0, 0
    .long 1, 24, 24, 8192, 4096, 4352, 8388608, 524288, 32768, 8, 23134208, 131072, 0, 0, 218104650, 0
    .long 1, 24, 24, 8192, 4096, 4352, 8388608, 1572864, 32768, 8, 27328512, 131072, 0, 0, 218105162, 0
    .long 2, 64, 72, 7168, 3072, 3072, 7340032, 524288, 32768, 8, 56410112, 114688, 0, 0, 218103876, 0
    .long 2, 64, 72, 7168, 2048, 2048, 7340032, 2097152, 32768, 8, 61898752, 114688, 0, 0, 218104068, 0
    .long 2, 64, 72, 7168, 2048, 2048, 7340032, 3670016, 32768, 8, 67403776, 114688, 0, 0, 218104260, 0
    .long 1, 80, 80, 2048, 3670016, 3670272, 7340032, 63758336, 114688, 7, 128450560, 32768, 218104144, 7, 218106689, 0
    .long 0, 0, 0, 0, 0, 0, 0, 0, 0, 0, 0, 0, 0, 0, 0, 0
    .long 0, 0, 0, 0, 0, 0, 0, 0, 0, 0, 0, 0, 0, 0, 0, 0
    .long 0, 0, 0, 0, 0, 0, 0, 0, 0, 0, 0, 0, 0, 0, 0, 0
    .long 0, 0, 0, 0, 0, 0, 0, 0, 0, 0, 0, 0, 0, 0, 0, 0
    .long 0, 0, 0, 0, 0, 0, 0, 0, 0, 0, 0, 0, 0, 0, 0, 0
    .long 1, 24, 24, 8192, 4608, 4864, 8388608, 524288, 32768, 8, 23142400, 131072, 0, 0, 218104650, 0
    .long 1, 24, 24, 8192, 4608, 4864, 8388608, 1572864, 32768, 8, 27336704, 131072, 0, 0, 218105162, 0
    .long 2, 64, 72, 7168, 3328, 3328, 7340032, 524288, 32768, 8, 56414208, 114688, 0, 0, 218103876, 0
    .long 2, 64, 72, 7168, 2304, 2304, 7340032, 2097152, 32768, 8, 61902848, 114688, 0, 0, 218104068, 0
    .long 2, 64, 72, 7168, 2304, 2304, 7340032, 3670016, 32768, 8, 67407872, 114688, 0, 0, 218104260, 0
    .long 1, 80, 80, 2048, 3670528, 3670784, 7340032, 63758336, 114688, 7, 128458752, 32768, 218104144, 7, 218106689, 0
    .long 0, 0, 0, 0, 0, 0, 0, 0, 0, 0, 0, 0, 0, 0, 0, 0
    .long 0, 0, 0, 0, 0, 0, 0, 0, 0, 0, 0, 0, 0, 0, 0, 0
    .long 0, 0, 0, 0, 0, 0, 0, 0, 0, 0, 0, 0, 0, 0, 0, 0
    .long 0, 0, 0, 0, 0, 0, 0, 0, 0, 0, 0, 0, 0, 0, 0, 0
    .long 0, 0, 0, 0, 0, 0, 0, 0, 0, 0, 0, 0, 0, 0, 0, 0
    .long 1, 24, 24, 8192, 5120, 5376, 8388608, 524288, 32768, 8, 23150592, 131072, 0, 0, 218104666, 0
    .long 1, 24, 24, 8192, 5120, 5376, 8388608, 1572864, 32768, 8, 27344896, 131072, 0, 0, 218105178, 0
    .long 2, 64, 72, 7168, 3584, 3584, 7340032, 524288, 32768, 8, 56418304, 114688, 0, 0, 218103889, 0
    .long 2, 64, 72, 7168, 2560, 2560, 7340032, 2097152, 32768, 8, 61906944, 114688, 0, 0, 218104068, 0
    .long 2, 64, 72, 7168, 2560, 2560, 7340032, 3670016, 32768, 8, 67411968, 114688, 0, 0, 218104260, 0
    .long 1, 80, 80, 2048, 3671040, 3671296, 7340032, 63758336, 114688, 7, 128466944, 32768, 218104144, 7, 218106689, 0
    .long 0, 0, 0, 0, 0, 0, 0, 0, 0, 0, 0, 0, 0, 0, 0, 0
    .long 0, 0, 0, 0, 0, 0, 0, 0, 0, 0, 0, 0, 0, 0, 0, 0
    .long 0, 0, 0, 0, 0, 0, 0, 0, 0, 0, 0, 0, 0, 0, 0, 0
    .long 0, 0, 0, 0, 0, 0, 0, 0, 0, 0, 0, 0, 0, 0, 0, 0
    .long 0, 0, 0, 0, 0, 0, 0, 0, 0, 0, 0, 0, 0, 0, 0, 0
    .long 1, 24, 24, 8192, 5632, 5888, 8388608, 524288, 32768, 8, 23158784, 131072, 0, 0, 218104666, 0
    .long 1, 24, 24, 8192, 5632, 5888, 8388608, 1572864, 32768, 8, 27353088, 131072, 0, 0, 218105178, 0
    .long 2, 64, 72, 7168, 3840, 3840, 7340032, 524288, 32768, 8, 56422400, 114688, 0, 0, 218103889, 0
    .long 2, 64, 72, 7168, 3840, 3840, 7340032, 2097152, 32768, 8, 61927424, 114688, 0, 0, 218104081, 0
    .long 2, 64, 72, 7168, 3840, 3840, 7340032, 3670016, 32768, 8, 67432448, 114688, 0, 0, 218104273, 0
    .long 1, 80, 80, 2048, 5506560, 5506816, 7340032, 63787008, 114688, 7, 132669440, 32768, 218104148, 7, 218106689, 0
    .long 0, 0, 0, 0, 0, 0, 0, 0, 0, 0, 0, 0, 0, 0, 0, 0
    .long 0, 0, 0, 0, 0, 0, 0, 0, 0, 0, 0, 0, 0, 0, 0, 0
    .long 0, 0, 0, 0, 0, 0, 0, 0, 0, 0, 0, 0, 0, 0, 0, 0
    .long 0, 0, 0, 0, 0, 0, 0, 0, 0, 0, 0, 0, 0, 0, 0, 0
    .long 0, 0, 0, 0, 0, 0, 0, 0, 0, 0, 0, 0, 0, 0, 0, 0
    .long 4, 24, 24, 8192, 6144, 268288, 8388608, 524288, 32768, 4, 23166976, 131072, 0, 0, 218104673, 0
    .long 4, 24, 24, 8192, 6400, 268544, 8388608, 524288, 32768, 4, 23171072, 131072, 0, 0, 218104673, 0
    .long 4, 32, 32, 8192, 4096, 266240, 8388608, 524288, 32768, 4, 39911424, 131072, 0, 0, 218104641, 0
    .long 4, 32, 32, 8192, 6400, 268544, 8388608, 786432, 32768, 4, 40996864, 131072, 0, 0, 218104676, 0
    .long 1, 24, 24, 8192, 2048, 2304, 8388608, 2097152, 32768, 8, 29392896, 131072, 0, 0, 218105386, 0
    .long 1, 24, 24, 8192, 4096, 4352, 8388608, 2621440, 32768, 8, 31522816, 131072, 0, 0, 218105674, 0
    .long 1, 24, 24, 8192, 2048, 2304, 8388608, 3145728, 32768, 8, 33587200, 131072, 0, 0, 218105898, 0
    .long 1, 32, 32, 8192, 6144, 6400, 8388608, 3670016, 32768, 8, 52527104, 131072, 0, 0, 218106218, 0
    .long 1, 80, 80, 2048, 5505024, 5505280, 7340032, 65622016, 114688, 7, 133169152, 32768, 218104212, 7, 218106753, 0
    .long 0, 0, 0, 0, 0, 0, 0, 0, 0, 0, 0, 0, 0, 0, 0, 0
    .long 0, 0, 0, 0, 0, 0, 0, 0, 0, 0, 0, 0, 0, 0, 0, 0
    .long 4, 24, 24, 8192, 6656, 268800, 8388608, 524288, 32768, 4, 23175168, 131072, 0, 0, 218104673, 0
    .long 4, 24, 24, 8192, 6912, 269056, 8388608, 524288, 32768, 4, 23179264, 131072, 0, 0, 218104673, 0
    .long 4, 32, 32, 8192, 4608, 266752, 8388608, 524288, 32768, 4, 39919616, 131072, 0, 0, 218104641, 0
    .long 4, 32, 32, 8192, 6912, 269056, 8388608, 786432, 32768, 4, 41005056, 131072, 0, 0, 218104676, 0
    .long 1, 24, 24, 8192, 2560, 2816, 8388608, 2097152, 32768, 8, 29401088, 131072, 0, 0, 218105386, 0
    .long 1, 24, 24, 8192, 4608, 4864, 8388608, 2621440, 32768, 8, 31531008, 131072, 0, 0, 218105674, 0
    .long 1, 24, 24, 8192, 2560, 2816, 8388608, 3145728, 32768, 8, 33595392, 131072, 0, 0, 218105898, 0
    .long 1, 32, 32, 8192, 6656, 6912, 8388608, 3670016, 32768, 8, 52535296, 131072, 0, 0, 218106218, 0
    .long 1, 80, 80, 2048, 5505536, 5505792, 7340032, 65622016, 114688, 7, 133177344, 32768, 218104212, 7, 218106753, 0
    .long 0, 0, 0, 0, 0, 0, 0, 0, 0, 0, 0, 0, 0, 0, 0, 0
    .long 0, 0, 0, 0, 0, 0, 0, 0, 0, 0, 0, 0, 0, 0, 0, 0
    .long 4, 24, 24, 8192, 7168, 269312, 8388608, 524288, 32768, 4, 23183360, 131072, 0, 0, 218104689, 0
    .long 4, 24, 24, 8192, 7424, 269568, 8388608, 524288, 32768, 4, 23187456, 131072, 0, 0, 218104689, 0
    .long 4, 32, 32, 8192, 5120, 267264, 8388608, 524288, 32768, 4, 39927808, 131072, 0, 0, 218104657, 0
    .long 4, 32, 32, 8192, 7424, 269568, 8388608, 786432, 32768, 4, 41013248, 131072, 0, 0, 218104692, 0
    .long 1, 24, 24, 8192, 3072, 3328, 8388608, 2097152, 32768, 8, 29409280, 131072, 0, 0, 218105402, 0
    .long 1, 24, 24, 8192, 5120, 5376, 8388608, 2621440, 32768, 8, 31539200, 131072, 0, 0, 218105690, 0
    .long 1, 24, 24, 8192, 3072, 3328, 8388608, 3145728, 32768, 8, 33603584, 131072, 0, 0, 218105914, 0
    .long 1, 32, 32, 8192, 7168, 7424, 8388608, 3670016, 32768, 8, 52543488, 131072, 0, 0, 218106234, 0
    .long 1, 80, 80, 2048, 5506048, 5506304, 7340032, 65622016, 114688, 7, 133185536, 32768, 218104212, 7, 218106753, 0
    .long 0, 0, 0, 0, 0, 0, 0, 0, 0, 0, 0, 0, 0, 0, 0, 0
    .long 0, 0, 0, 0, 0, 0, 0, 0, 0, 0, 0, 0, 0, 0, 0, 0
    .long 4, 24, 24, 8192, 7680, 269824, 8388608, 524288, 32768, 4, 23191552, 131072, 0, 0, 218104689, 0
    .long 4, 24, 24, 8192, 7936, 270080, 8388608, 524288, 32768, 4, 23195648, 131072, 0, 0, 218104689, 0
    .long 4, 32, 32, 8192, 5632, 267776, 8388608, 524288, 32768, 4, 39936000, 131072, 0, 0, 218104657, 0
    .long 4, 32, 32, 8192, 7936, 270080, 8388608, 786432, 32768, 4, 41021440, 131072, 0, 0, 218104692, 0
    .long 1, 24, 24, 8192, 5632, 5888, 8388608, 2097152, 32768, 8, 29450240, 131072, 0, 0, 218105434, 0
    .long 1, 24, 24, 8192, 5632, 5888, 8388608, 2621440, 32768, 8, 31547392, 131072, 0, 0, 218105690, 0
    .long 1, 24, 24, 8192, 3584, 3840, 8388608, 3145728, 32768, 8, 33611776, 131072, 0, 0, 218105914, 0
    .long 1, 32, 32, 8192, 7680, 7936, 8388608, 3670016, 32768, 8, 52551680, 131072, 0, 0, 218106234, 0
    .long 1, 80, 80, 2048, 5506560, 5506816, 7340032, 65622016, 114688, 7, 133193728, 32768, 218104212, 7, 218106753, 0
    .long 0, 0, 0, 0, 0, 0, 0, 0, 0, 0, 0, 0, 0, 0, 0, 0
    .long 0, 0, 0, 0, 0, 0, 0, 0, 0, 0, 0, 0, 0, 0, 0, 0
.p2align 6
.amdhsa_kernel recurrent_scan__memory_aug_recurrent_mem_tr__glu_gated_glu__prompt_kernel
  .amdhsa_next_free_vgpr 256
  .amdhsa_next_free_sgpr 102
  .amdhsa_accum_offset 256
  .amdhsa_group_segment_fixed_size 0
  .amdhsa_kernarg_size 112
  .amdhsa_user_sgpr_count 2
  .amdhsa_user_sgpr_kernarg_segment_ptr 1
  .amdhsa_system_sgpr_workgroup_id_x 1
  .amdhsa_float_denorm_mode_32 3
.end_amdhsa_kernel
```

```asm
; @launch grid=(256,1,1) block=(512,1,1) lds=163840
.amdgcn_target "amdgcn-amd-amdhsa--gfx950"
.text
.globl recurrent_scan__memory_aug_recurrent_mem_tr__glu_gated_glu__prompt_kernel
.p2align 8
.type recurrent_scan__memory_aug_recurrent_mem_tr__glu_gated_glu__prompt_kernel,@function
recurrent_scan__memory_aug_recurrent_mem_tr__glu_gated_glu__prompt_kernel:
    s_cmp_ge_u32 s2, 256
    s_cbranch_scc1 k_exit
    s_mov_b32 s99, s2
    s_load_dwordx2 s[4:5], s[0:1], 104
    s_load_dwordx2 s[64:65], s[0:1], 96
    v_lshrrev_b32 v2, 6, v0
    s_mov_b32 s6, 268435456
    s_mov_b32 s7, 131072
    s_mov_b32 s66, 256
    s_mov_b32 s67, 131072
    v_readfirstlane_b32 s3, v2
    s_lshr_b32 s13, s2, 3
    s_and_b32 s12, s2, 3
    s_waitcnt lgkmcnt(0)
    s_bitcmp0_b32 s2, 2
    s_cbranch_scc1 chain_map
    s_lshl_b32 s63, s13, 2
    s_add_u32 s63, s63, s12
    s_cmp_ge_u32 s3, 4
    s_cbranch_scc1 ln_touch
    s_load_dwordx2 s[8:9], s[0:1], 0
    v_and_b32 v1, 63, v0
    s_mov_b32 s10, 4194304
    s_mov_b32 s11, 131072
    v_and_b32 v3, 15, v1
    v_lshrrev_b32 v4, 4, v1
    v_lshlrev_b32 v5, 11, v3
    v_lshl_add_u32 v5, v4, 4, v5
    s_lshl_b32 s12, s63, 15
    s_lshl_b32 s13, s3, 9
    s_add_u32 s12, s12, s13
    s_waitcnt lgkmcnt(0)
    buffer_load_dwordx4 v[16:19], v5, s[8:11], s12 offen offset:0
    buffer_load_dwordx4 v[20:23], v5, s[8:11], s12 offen offset:64
    buffer_load_dwordx4 v[24:27], v5, s[8:11], s12 offen offset:128
    buffer_load_dwordx4 v[28:31], v5, s[8:11], s12 offen offset:192
    buffer_load_dwordx4 v[32:35], v5, s[8:11], s12 offen offset:256
    buffer_load_dwordx4 v[36:39], v5, s[8:11], s12 offen offset:320
    buffer_load_dwordx4 v[40:43], v5, s[8:11], s12 offen offset:384
    buffer_load_dwordx4 v[44:47], v5, s[8:11], s12 offen offset:448
    v_mov_b32 v14, 0
    s_lshl_b32 s13, s63, 7
    s_add_u32 s13, s13, 218103808
    v_lshlrev_b32 v13, 2, v0
    v_cmp_gt_u32 vcc, 32, v0
    s_and_saveexec_b64 s[22:23], vcc
    s_cbranch_execz ln_nz
    buffer_store_dword v14, v13, s[4:7], s13 offen sc1
ln_nz:
    s_mov_b64 exec, -1
    v_lshlrev_b32 v6, 4, v3
    s_lshl_b32 s14, s3, 2
    v_add_u32 v7, s14, v6
    v_lshlrev_b32 v8, 4, v1
    s_lshl_b32 s15, s63, 15
    s_lshl_b32 s16, s3, 13
    s_add_u32 s15, s15, s16
    s_add_u32 s16, s15, 4096
    v_and_b32 v9, 1, v4
    v_cmp_eq_u32 s[20:21], 1, v9
    s_waitcnt vmcnt(1)
    v_lshlrev_b32 v48, 16, v16
    v_and_b32 v49, 0xffff0000, v16
    v_lshlrev_b32 v50, 16, v17
    v_and_b32 v51, 0xffff0000, v17
    v_lshlrev_b32 v52, 16, v18
    v_and_b32 v53, 0xffff0000, v18
    v_lshlrev_b32 v54, 16, v19
    v_and_b32 v55, 0xffff0000, v19
    v_lshlrev_b32 v56, 16, v20
    v_and_b32 v57, 0xffff0000, v20
    v_lshlrev_b32 v58, 16, v21
    v_and_b32 v59, 0xffff0000, v21
    v_lshlrev_b32 v60, 16, v22
    v_and_b32 v61, 0xffff0000, v22
    v_lshlrev_b32 v62, 16, v23
    v_and_b32 v63, 0xffff0000, v23
    v_lshlrev_b32 v64, 16, v24
    v_and_b32 v65, 0xffff0000, v24
    v_lshlrev_b32 v66, 16, v25
    v_and_b32 v67, 0xffff0000, v25
    v_lshlrev_b32 v68, 16, v26
    v_and_b32 v69, 0xffff0000, v26
    v_lshlrev_b32 v70, 16, v27
    v_and_b32 v71, 0xffff0000, v27
    v_lshlrev_b32 v72, 16, v28
    v_and_b32 v73, 0xffff0000, v28
    v_lshlrev_b32 v74, 16, v29
    v_and_b32 v75, 0xffff0000, v29
    v_lshlrev_b32 v76, 16, v30
    v_and_b32 v77, 0xffff0000, v30
    v_lshlrev_b32 v78, 16, v31
    v_and_b32 v79, 0xffff0000, v31
    v_lshlrev_b32 v80, 16, v32
    v_and_b32 v81, 0xffff0000, v32
    v_lshlrev_b32 v82, 16, v33
    v_and_b32 v83, 0xffff0000, v33
    v_lshlrev_b32 v84, 16, v34
    v_and_b32 v85, 0xffff0000, v34
    v_lshlrev_b32 v86, 16, v35
    v_and_b32 v87, 0xffff0000, v35
    v_lshlrev_b32 v88, 16, v36
    v_and_b32 v89, 0xffff0000, v36
    v_lshlrev_b32 v90, 16, v37
    v_and_b32 v91, 0xffff0000, v37
    v_lshlrev_b32 v92, 16, v38
    v_and_b32 v93, 0xffff0000, v38
    v_lshlrev_b32 v94, 16, v39
    v_and_b32 v95, 0xffff0000, v39
    v_lshlrev_b32 v96, 16, v40
    v_and_b32 v97, 0xffff0000, v40
    v_lshlrev_b32 v98, 16, v41
    v_and_b32 v99, 0xffff0000, v41
    v_lshlrev_b32 v100, 16, v42
    v_and_b32 v101, 0xffff0000, v42
    v_lshlrev_b32 v102, 16, v43
    v_and_b32 v103, 0xffff0000, v43
    v_lshlrev_b32 v104, 16, v44
    v_and_b32 v105, 0xffff0000, v44
    v_lshlrev_b32 v106, 16, v45
    v_and_b32 v107, 0xffff0000, v45
    v_lshlrev_b32 v108, 16, v46
    v_and_b32 v109, 0xffff0000, v46
    v_lshlrev_b32 v110, 16, v47
    v_and_b32 v111, 0xffff0000, v47
    v_add_f32 v112, v48, v80
    v_add_f32 v113, v49, v81
    v_add_f32 v114, v50, v82
    v_add_f32 v115, v51, v83
    v_add_f32 v116, v52, v84
    v_add_f32 v117, v53, v85
    v_add_f32 v118, v54, v86
    v_add_f32 v119, v55, v87
    v_add_f32 v120, v56, v88
    v_add_f32 v121, v57, v89
    v_add_f32 v122, v58, v90
    v_add_f32 v123, v59, v91
    v_add_f32 v124, v60, v92
    v_add_f32 v125, v61, v93
    v_add_f32 v126, v62, v94
    v_add_f32 v127, v63, v95
    v_add_f32 v128, v64, v96
    v_add_f32 v129, v65, v97
    v_add_f32 v130, v66, v98
    v_add_f32 v131, v67, v99
    v_add_f32 v132, v68, v100
    v_add_f32 v133, v69, v101
    v_add_f32 v134, v70, v102
    v_add_f32 v135, v71, v103
    v_add_f32 v136, v72, v104
    v_add_f32 v137, v73, v105
    v_add_f32 v138, v74, v106
    v_add_f32 v139, v75, v107
    v_add_f32 v140, v76, v108
    v_add_f32 v141, v77, v109
    v_add_f32 v142, v78, v110
    v_add_f32 v143, v79, v111
    v_add_f32 v112, v112, v128
    v_add_f32 v113, v113, v129
    v_add_f32 v114, v114, v130
    v_add_f32 v115, v115, v131
    v_add_f32 v116, v116, v132
    v_add_f32 v117, v117, v133
    v_add_f32 v118, v118, v134
    v_add_f32 v119, v119, v135
    v_add_f32 v120, v120, v136
    v_add_f32 v121, v121, v137
    v_add_f32 v122, v122, v138
    v_add_f32 v123, v123, v139
    v_add_f32 v124, v124, v140
    v_add_f32 v125, v125, v141
    v_add_f32 v126, v126, v142
    v_add_f32 v127, v127, v143
    v_add_f32 v112, v112, v120
    v_add_f32 v113, v113, v121
    v_add_f32 v114, v114, v122
    v_add_f32 v115, v115, v123
    v_add_f32 v116, v116, v124
    v_add_f32 v117, v117, v125
    v_add_f32 v118, v118, v126
    v_add_f32 v119, v119, v127
    v_add_f32 v112, v112, v116
    v_add_f32 v113, v113, v117
    v_add_f32 v114, v114, v118
    v_add_f32 v115, v115, v119
    v_add_f32 v112, v112, v114
    v_add_f32 v113, v113, v115
    v_add_f32 v112, v112, v113
    v_mov_b32 v113, v112
    s_nop 1
    v_permlane16_swap_b32 v113, v112
    v_add_f32 v112, v112, v113
    v_mov_b32 v113, v112
    s_nop 1
    v_permlane32_swap_b32 v113, v112
    v_add_f32 v112, v112, v113
    ds_write_b32 v7, v112
    s_waitcnt lgkmcnt(0)
    s_barrier
    ds_read_b128 v[112:115], v6
    s_waitcnt lgkmcnt(0)
    v_add_f32 v112, v112, v114
    v_add_f32 v113, v113, v115
    v_add_f32 v112, v112, v113
    v_mul_f32 v10, 0x3a800000, v112
    v_sub_f32 v176, v48, v10
    v_sub_f32 v177, v49, v10
    v_sub_f32 v178, v50, v10
    v_sub_f32 v179, v51, v10
    v_sub_f32 v180, v52, v10
    v_sub_f32 v181, v53, v10
    v_sub_f32 v182, v54, v10
    v_sub_f32 v183, v55, v10
    v_sub_f32 v184, v56, v10
    v_sub_f32 v185, v57, v10
    v_sub_f32 v186, v58, v10
    v_sub_f32 v187, v59, v10
    v_sub_f32 v188, v60, v10
    v_sub_f32 v189, v61, v10
    v_sub_f32 v190, v62, v10
    v_sub_f32 v191, v63, v10
    v_sub_f32 v192, v64, v10
    v_sub_f32 v193, v65, v10
    v_sub_f32 v194, v66, v10
    v_sub_f32 v195, v67, v10
    v_sub_f32 v196, v68, v10
    v_sub_f32 v197, v69, v10
    v_sub_f32 v198, v70, v10
    v_sub_f32 v199, v71, v10
    v_sub_f32 v200, v72, v10
    v_sub_f32 v201, v73, v10
    v_sub_f32 v202, v74, v10
    v_sub_f32 v203, v75, v10
    v_sub_f32 v204, v76, v10
    v_sub_f32 v205, v77, v10
    v_sub_f32 v206, v78, v10
    v_sub_f32 v207, v79, v10
    v_sub_f32 v208, v80, v10
    v_sub_f32 v209, v81, v10
    v_sub_f32 v210, v82, v10
    v_sub_f32 v211, v83, v10
    v_sub_f32 v212, v84, v10
    v_sub_f32 v213, v85, v10
    v_sub_f32 v214, v86, v10
    v_sub_f32 v215, v87, v10
    v_sub_f32 v216, v88, v10
    v_sub_f32 v217, v89, v10
    v_sub_f32 v218, v90, v10
    v_sub_f32 v219, v91, v10
    v_sub_f32 v220, v92, v10
    v_sub_f32 v221, v93, v10
    v_sub_f32 v222, v94, v10
    v_sub_f32 v223, v95, v10
    v_sub_f32 v224, v96, v10
    v_sub_f32 v225, v97, v10
    v_sub_f32 v226, v98, v10
    v_sub_f32 v227, v99, v10
    v_sub_f32 v228, v100, v10
    v_sub_f32 v229, v101, v10
    v_sub_f32 v230, v102, v10
    v_sub_f32 v231, v103, v10
    v_sub_f32 v232, v104, v10
    v_sub_f32 v233, v105, v10
    v_sub_f32 v234, v106, v10
    v_sub_f32 v235, v107, v10
    v_sub_f32 v236, v108, v10
    v_sub_f32 v237, v109, v10
    v_sub_f32 v238, v110, v10
    v_sub_f32 v239, v111, v10
    v_mul_f32 v112, v176, v176
    v_fmac_f32 v112, v208, v208
    v_mul_f32 v113, v177, v177
    v_fmac_f32 v113, v209, v209
    v_mul_f32 v114, v178, v178
    v_fmac_f32 v114, v210, v210
    v_mul_f32 v115, v179, v179
    v_fmac_f32 v115, v211, v211
    v_mul_f32 v116, v180, v180
    v_fmac_f32 v116, v212, v212
    v_mul_f32 v117, v181, v181
    v_fmac_f32 v117, v213, v213
    v_mul_f32 v118, v182, v182
    v_fmac_f32 v118, v214, v214
    v_mul_f32 v119, v183, v183
    v_fmac_f32 v119, v215, v215
    v_mul_f32 v120, v184, v184
    v_fmac_f32 v120, v216, v216
    v_mul_f32 v121, v185, v185
    v_fmac_f32 v121, v217, v217
    v_mul_f32 v122, v186, v186
    v_fmac_f32 v122, v218, v218
    v_mul_f32 v123, v187, v187
    v_fmac_f32 v123, v219, v219
    v_mul_f32 v124, v188, v188
    v_fmac_f32 v124, v220, v220
    v_mul_f32 v125, v189, v189
    v_fmac_f32 v125, v221, v221
    v_mul_f32 v126, v190, v190
    v_fmac_f32 v126, v222, v222
    v_mul_f32 v127, v191, v191
    v_fmac_f32 v127, v223, v223
    v_mul_f32 v128, v192, v192
    v_fmac_f32 v128, v224, v224
    v_mul_f32 v129, v193, v193
    v_fmac_f32 v129, v225, v225
    v_mul_f32 v130, v194, v194
    v_fmac_f32 v130, v226, v226
    v_mul_f32 v131, v195, v195
    v_fmac_f32 v131, v227, v227
    v_mul_f32 v132, v196, v196
    v_fmac_f32 v132, v228, v228
    v_mul_f32 v133, v197, v197
    v_fmac_f32 v133, v229, v229
    v_mul_f32 v134, v198, v198
    v_fmac_f32 v134, v230, v230
    v_mul_f32 v135, v199, v199
    v_fmac_f32 v135, v231, v231
    v_mul_f32 v136, v200, v200
    v_fmac_f32 v136, v232, v232
    v_mul_f32 v137, v201, v201
    v_fmac_f32 v137, v233, v233
    v_mul_f32 v138, v202, v202
    v_fmac_f32 v138, v234, v234
    v_mul_f32 v139, v203, v203
    v_fmac_f32 v139, v235, v235
    v_mul_f32 v140, v204, v204
    v_fmac_f32 v140, v236, v236
    v_mul_f32 v141, v205, v205
    v_fmac_f32 v141, v237, v237
    v_mul_f32 v142, v206, v206
    v_fmac_f32 v142, v238, v238
    v_mul_f32 v143, v207, v207
    v_fmac_f32 v143, v239, v239
    v_add_f32 v112, v112, v128
    v_add_f32 v113, v113, v129
    v_add_f32 v114, v114, v130
    v_add_f32 v115, v115, v131
    v_add_f32 v116, v116, v132
    v_add_f32 v117, v117, v133
    v_add_f32 v118, v118, v134
    v_add_f32 v119, v119, v135
    v_add_f32 v120, v120, v136
    v_add_f32 v121, v121, v137
    v_add_f32 v122, v122, v138
    v_add_f32 v123, v123, v139
    v_add_f32 v124, v124, v140
    v_add_f32 v125, v125, v141
    v_add_f32 v126, v126, v142
    v_add_f32 v127, v127, v143
    v_add_f32 v112, v112, v120
    v_add_f32 v113, v113, v121
    v_add_f32 v114, v114, v122
    v_add_f32 v115, v115, v123
    v_add_f32 v116, v116, v124
    v_add_f32 v117, v117, v125
    v_add_f32 v118, v118, v126
    v_add_f32 v119, v119, v127
    v_add_f32 v112, v112, v116
    v_add_f32 v113, v113, v117
    v_add_f32 v114, v114, v118
    v_add_f32 v115, v115, v119
    v_add_f32 v112, v112, v114
    v_add_f32 v113, v113, v115
    v_add_f32 v112, v112, v113
    v_mov_b32 v113, v112
    s_nop 1
    v_permlane16_swap_b32 v113, v112
    v_add_f32 v112, v112, v113
    v_mov_b32 v113, v112
    s_nop 1
    v_permlane32_swap_b32 v113, v112
    v_add_f32 v112, v112, v113
    ds_write_b32 v7, v112 offset:512
    s_waitcnt lgkmcnt(0)
    s_barrier
    ds_read_b128 v[112:115], v6 offset:512
    s_waitcnt lgkmcnt(0)
    v_add_f32 v112, v112, v114
    v_add_f32 v113, v113, v115
    v_add_f32 v112, v112, v113
    v_mul_f32 v11, 0x3a800000, v112
    v_cvt_pk_bf16_f32 v10, v10, v10
    v_lshlrev_b32 v10, 16, v10
    v_cvt_pk_bf16_f32 v11, v11, v11
    v_lshlrev_b32 v11, 16, v11
    v_add_f32 v11, 0x3727c5ac, v11
    v_cvt_pk_bf16_f32 v11, v11, v11
    v_lshlrev_b32 v11, 16, v11
    v_sqrt_f32 v11, v11
    s_nop 0
    v_cvt_pk_bf16_f32 v11, v11, v11
    v_lshlrev_b32 v11, 16, v11
    v_rcp_f32 v11, v11
    s_nop 0
    v_sub_f32 v48, v48, v10
    v_sub_f32 v49, v49, v10
    v_cvt_pk_bf16_f32 v16, v48, v49
    v_lshlrev_b32 v48, 16, v16
    v_and_b32 v49, 0xffff0000, v16
    v_mul_f32 v48, v48, v11
    v_mul_f32 v49, v49, v11
    v_cvt_pk_bf16_f32 v16, v48, v49
    v_sub_f32 v50, v50, v10
    v_sub_f32 v51, v51, v10
    v_cvt_pk_bf16_f32 v17, v50, v51
    v_lshlrev_b32 v50, 16, v17
    v_and_b32 v51, 0xffff0000, v17
    v_mul_f32 v50, v50, v11
    v_mul_f32 v51, v51, v11
    v_cvt_pk_bf16_f32 v17, v50, v51
    v_sub_f32 v52, v52, v10
    v_sub_f32 v53, v53, v10
    v_cvt_pk_bf16_f32 v18, v52, v53
    v_lshlrev_b32 v52, 16, v18
    v_and_b32 v53, 0xffff0000, v18
    v_mul_f32 v52, v52, v11
    v_mul_f32 v53, v53, v11
    v_cvt_pk_bf16_f32 v18, v52, v53
    v_sub_f32 v54, v54, v10
    v_sub_f32 v55, v55, v10
    v_cvt_pk_bf16_f32 v19, v54, v55
    v_lshlrev_b32 v54, 16, v19
    v_and_b32 v55, 0xffff0000, v19
    v_mul_f32 v54, v54, v11
    v_mul_f32 v55, v55, v11
    v_cvt_pk_bf16_f32 v19, v54, v55
    v_cndmask_b32 v112, v16, v18, s[20:21]
    v_cndmask_b32 v113, v17, v19, s[20:21]
    v_cndmask_b32 v114, v18, v16, s[20:21]
    v_cndmask_b32 v115, v19, v17, s[20:21]
    buffer_store_dwordx4 v[112:115], v8, s[4:7], s15 offen offset:0 sc1
    v_sub_f32 v56, v56, v10
    v_sub_f32 v57, v57, v10
    v_cvt_pk_bf16_f32 v20, v56, v57
    v_lshlrev_b32 v56, 16, v20
    v_and_b32 v57, 0xffff0000, v20
    v_mul_f32 v56, v56, v11
    v_mul_f32 v57, v57, v11
    v_cvt_pk_bf16_f32 v20, v56, v57
    v_sub_f32 v58, v58, v10
    v_sub_f32 v59, v59, v10
    v_cvt_pk_bf16_f32 v21, v58, v59
    v_lshlrev_b32 v58, 16, v21
    v_and_b32 v59, 0xffff0000, v21
    v_mul_f32 v58, v58, v11
    v_mul_f32 v59, v59, v11
    v_cvt_pk_bf16_f32 v21, v58, v59
    v_sub_f32 v60, v60, v10
    v_sub_f32 v61, v61, v10
    v_cvt_pk_bf16_f32 v22, v60, v61
    v_lshlrev_b32 v60, 16, v22
    v_and_b32 v61, 0xffff0000, v22
    v_mul_f32 v60, v60, v11
    v_mul_f32 v61, v61, v11
    v_cvt_pk_bf16_f32 v22, v60, v61
    v_sub_f32 v62, v62, v10
    v_sub_f32 v63, v63, v10
    v_cvt_pk_bf16_f32 v23, v62, v63
    v_lshlrev_b32 v62, 16, v23
    v_and_b32 v63, 0xffff0000, v23
    v_mul_f32 v62, v62, v11
    v_mul_f32 v63, v63, v11
    v_cvt_pk_bf16_f32 v23, v62, v63
    v_cndmask_b32 v116, v20, v22, s[20:21]
    v_cndmask_b32 v117, v21, v23, s[20:21]
    v_cndmask_b32 v118, v22, v20, s[20:21]
    v_cndmask_b32 v119, v23, v21, s[20:21]
    buffer_store_dwordx4 v[116:119], v8, s[4:7], s15 offen offset:1024 sc1
    v_sub_f32 v64, v64, v10
    v_sub_f32 v65, v65, v10
    v_cvt_pk_bf16_f32 v24, v64, v65
    v_lshlrev_b32 v64, 16, v24
    v_and_b32 v65, 0xffff0000, v24
    v_mul_f32 v64, v64, v11
    v_mul_f32 v65, v65, v11
    v_cvt_pk_bf16_f32 v24, v64, v65
    v_sub_f32 v66, v66, v10
    v_sub_f32 v67, v67, v10
    v_cvt_pk_bf16_f32 v25, v66, v67
    v_lshlrev_b32 v66, 16, v25
    v_and_b32 v67, 0xffff0000, v25
    v_mul_f32 v66, v66, v11
    v_mul_f32 v67, v67, v11
    v_cvt_pk_bf16_f32 v25, v66, v67
    v_sub_f32 v68, v68, v10
    v_sub_f32 v69, v69, v10
    v_cvt_pk_bf16_f32 v26, v68, v69
    v_lshlrev_b32 v68, 16, v26
    v_and_b32 v69, 0xffff0000, v26
    v_mul_f32 v68, v68, v11
    v_mul_f32 v69, v69, v11
    v_cvt_pk_bf16_f32 v26, v68, v69
    v_sub_f32 v70, v70, v10
    v_sub_f32 v71, v71, v10
    v_cvt_pk_bf16_f32 v27, v70, v71
    v_lshlrev_b32 v70, 16, v27
    v_and_b32 v71, 0xffff0000, v27
    v_mul_f32 v70, v70, v11
    v_mul_f32 v71, v71, v11
    v_cvt_pk_bf16_f32 v27, v70, v71
    v_cndmask_b32 v120, v24, v26, s[20:21]
    v_cndmask_b32 v121, v25, v27, s[20:21]
    v_cndmask_b32 v122, v26, v24, s[20:21]
    v_cndmask_b32 v123, v27, v25, s[20:21]
    buffer_store_dwordx4 v[120:123], v8, s[4:7], s15 offen offset:2048 sc1
    v_sub_f32 v72, v72, v10
    v_sub_f32 v73, v73, v10
    v_cvt_pk_bf16_f32 v28, v72, v73
    v_lshlrev_b32 v72, 16, v28
    v_and_b32 v73, 0xffff0000, v28
    v_mul_f32 v72, v72, v11
    v_mul_f32 v73, v73, v11
    v_cvt_pk_bf16_f32 v28, v72, v73
    v_sub_f32 v74, v74, v10
    v_sub_f32 v75, v75, v10
    v_cvt_pk_bf16_f32 v29, v74, v75
    v_lshlrev_b32 v74, 16, v29
    v_and_b32 v75, 0xffff0000, v29
    v_mul_f32 v74, v74, v11
    v_mul_f32 v75, v75, v11
    v_cvt_pk_bf16_f32 v29, v74, v75
    v_sub_f32 v76, v76, v10
    v_sub_f32 v77, v77, v10
    v_cvt_pk_bf16_f32 v30, v76, v77
    v_lshlrev_b32 v76, 16, v30
    v_and_b32 v77, 0xffff0000, v30
    v_mul_f32 v76, v76, v11
    v_mul_f32 v77, v77, v11
    v_cvt_pk_bf16_f32 v30, v76, v77
    v_sub_f32 v78, v78, v10
    v_sub_f32 v79, v79, v10
    v_cvt_pk_bf16_f32 v31, v78, v79
    v_lshlrev_b32 v78, 16, v31
    v_and_b32 v79, 0xffff0000, v31
    v_mul_f32 v78, v78, v11
    v_mul_f32 v79, v79, v11
    v_cvt_pk_bf16_f32 v31, v78, v79
    v_cndmask_b32 v124, v28, v30, s[20:21]
    v_cndmask_b32 v125, v29, v31, s[20:21]
    v_cndmask_b32 v126, v30, v28, s[20:21]
    v_cndmask_b32 v127, v31, v29, s[20:21]
    buffer_store_dwordx4 v[124:127], v8, s[4:7], s15 offen offset:3072 sc1
    v_sub_f32 v80, v80, v10
    v_sub_f32 v81, v81, v10
    v_cvt_pk_bf16_f32 v32, v80, v81
    v_lshlrev_b32 v80, 16, v32
    v_and_b32 v81, 0xffff0000, v32
    v_mul_f32 v80, v80, v11
    v_mul_f32 v81, v81, v11
    v_cvt_pk_bf16_f32 v32, v80, v81
    v_sub_f32 v82, v82, v10
    v_sub_f32 v83, v83, v10
    v_cvt_pk_bf16_f32 v33, v82, v83
    v_lshlrev_b32 v82, 16, v33
    v_and_b32 v83, 0xffff0000, v33
    v_mul_f32 v82, v82, v11
    v_mul_f32 v83, v83, v11
    v_cvt_pk_bf16_f32 v33, v82, v83
    v_sub_f32 v84, v84, v10
    v_sub_f32 v85, v85, v10
    v_cvt_pk_bf16_f32 v34, v84, v85
    v_lshlrev_b32 v84, 16, v34
    v_and_b32 v85, 0xffff0000, v34
    v_mul_f32 v84, v84, v11
    v_mul_f32 v85, v85, v11
    v_cvt_pk_bf16_f32 v34, v84, v85
    v_sub_f32 v86, v86, v10
    v_sub_f32 v87, v87, v10
    v_cvt_pk_bf16_f32 v35, v86, v87
    v_lshlrev_b32 v86, 16, v35
    v_and_b32 v87, 0xffff0000, v35
    v_mul_f32 v86, v86, v11
    v_mul_f32 v87, v87, v11
    v_cvt_pk_bf16_f32 v35, v86, v87
    v_cndmask_b32 v128, v32, v34, s[20:21]
    v_cndmask_b32 v129, v33, v35, s[20:21]
    v_cndmask_b32 v130, v34, v32, s[20:21]
    v_cndmask_b32 v131, v35, v33, s[20:21]
    buffer_store_dwordx4 v[128:131], v8, s[4:7], s16 offen offset:0 sc1
    v_sub_f32 v88, v88, v10
    v_sub_f32 v89, v89, v10
    v_cvt_pk_bf16_f32 v36, v88, v89
    v_lshlrev_b32 v88, 16, v36
    v_and_b32 v89, 0xffff0000, v36
    v_mul_f32 v88, v88, v11
    v_mul_f32 v89, v89, v11
    v_cvt_pk_bf16_f32 v36, v88, v89
    v_sub_f32 v90, v90, v10
    v_sub_f32 v91, v91, v10
    v_cvt_pk_bf16_f32 v37, v90, v91
    v_lshlrev_b32 v90, 16, v37
    v_and_b32 v91, 0xffff0000, v37
    v_mul_f32 v90, v90, v11
    v_mul_f32 v91, v91, v11
    v_cvt_pk_bf16_f32 v37, v90, v91
    v_sub_f32 v92, v92, v10
    v_sub_f32 v93, v93, v10
    v_cvt_pk_bf16_f32 v38, v92, v93
    v_lshlrev_b32 v92, 16, v38
    v_and_b32 v93, 0xffff0000, v38
    v_mul_f32 v92, v92, v11
    v_mul_f32 v93, v93, v11
    v_cvt_pk_bf16_f32 v38, v92, v93
    v_sub_f32 v94, v94, v10
    v_sub_f32 v95, v95, v10
    v_cvt_pk_bf16_f32 v39, v94, v95
    v_lshlrev_b32 v94, 16, v39
    v_and_b32 v95, 0xffff0000, v39
    v_mul_f32 v94, v94, v11
    v_mul_f32 v95, v95, v11
    v_cvt_pk_bf16_f32 v39, v94, v95
    v_cndmask_b32 v132, v36, v38, s[20:21]
    v_cndmask_b32 v133, v37, v39, s[20:21]
    v_cndmask_b32 v134, v38, v36, s[20:21]
    v_cndmask_b32 v135, v39, v37, s[20:21]
    buffer_store_dwordx4 v[132:135], v8, s[4:7], s16 offen offset:1024 sc1
    v_sub_f32 v96, v96, v10
    v_sub_f32 v97, v97, v10
    v_cvt_pk_bf16_f32 v40, v96, v97
    v_lshlrev_b32 v96, 16, v40
    v_and_b32 v97, 0xffff0000, v40
    v_mul_f32 v96, v96, v11
    v_mul_f32 v97, v97, v11
    v_cvt_pk_bf16_f32 v40, v96, v97
    v_sub_f32 v98, v98, v10
    v_sub_f32 v99, v99, v10
    v_cvt_pk_bf16_f32 v41, v98, v99
    v_lshlrev_b32 v98, 16, v41
    v_and_b32 v99, 0xffff0000, v41
    v_mul_f32 v98, v98, v11
    v_mul_f32 v99, v99, v11
    v_cvt_pk_bf16_f32 v41, v98, v99
    v_sub_f32 v100, v100, v10
    v_sub_f32 v101, v101, v10
    v_cvt_pk_bf16_f32 v42, v100, v101
    v_lshlrev_b32 v100, 16, v42
    v_and_b32 v101, 0xffff0000, v42
    v_mul_f32 v100, v100, v11
    v_mul_f32 v101, v101, v11
    v_cvt_pk_bf16_f32 v42, v100, v101
    v_sub_f32 v102, v102, v10
    v_sub_f32 v103, v103, v10
    v_cvt_pk_bf16_f32 v43, v102, v103
    v_lshlrev_b32 v102, 16, v43
    v_and_b32 v103, 0xffff0000, v43
    v_mul_f32 v102, v102, v11
    v_mul_f32 v103, v103, v11
    v_cvt_pk_bf16_f32 v43, v102, v103
    v_cndmask_b32 v136, v40, v42, s[20:21]
    v_cndmask_b32 v137, v41, v43, s[20:21]
    v_cndmask_b32 v138, v42, v40, s[20:21]
    v_cndmask_b32 v139, v43, v41, s[20:21]
    buffer_store_dwordx4 v[136:139], v8, s[4:7], s16 offen offset:2048 sc1
    v_sub_f32 v104, v104, v10
    v_sub_f32 v105, v105, v10
    v_cvt_pk_bf16_f32 v44, v104, v105
    v_lshlrev_b32 v104, 16, v44
    v_and_b32 v105, 0xffff0000, v44
    v_mul_f32 v104, v104, v11
    v_mul_f32 v105, v105, v11
    v_cvt_pk_bf16_f32 v44, v104, v105
    v_sub_f32 v106, v106, v10
    v_sub_f32 v107, v107, v10
    v_cvt_pk_bf16_f32 v45, v106, v107
    v_lshlrev_b32 v106, 16, v45
    v_and_b32 v107, 0xffff0000, v45
    v_mul_f32 v106, v106, v11
    v_mul_f32 v107, v107, v11
    v_cvt_pk_bf16_f32 v45, v106, v107
    v_sub_f32 v108, v108, v10
    v_sub_f32 v109, v109, v10
    v_cvt_pk_bf16_f32 v46, v108, v109
    v_lshlrev_b32 v108, 16, v46
    v_and_b32 v109, 0xffff0000, v46
    v_mul_f32 v108, v108, v11
    v_mul_f32 v109, v109, v11
    v_cvt_pk_bf16_f32 v46, v108, v109
    v_sub_f32 v110, v110, v10
    v_sub_f32 v111, v111, v10
    v_cvt_pk_bf16_f32 v47, v110, v111
    v_lshlrev_b32 v110, 16, v47
    v_and_b32 v111, 0xffff0000, v47
    v_mul_f32 v110, v110, v11
    v_mul_f32 v111, v111, v11
    v_cvt_pk_bf16_f32 v47, v110, v111
    v_cndmask_b32 v140, v44, v46, s[20:21]
    v_cndmask_b32 v141, v45, v47, s[20:21]
    v_cndmask_b32 v142, v46, v44, s[20:21]
    v_cndmask_b32 v143, v47, v45, s[20:21]
    buffer_store_dwordx4 v[140:143], v8, s[4:7], s16 offen offset:3072 sc1
    s_waitcnt vmcnt(0)
    s_barrier
    s_cmp_lg_u32 s3, 0
    s_cbranch_scc1 ln_sig
    v_mov_b32 v2, 1
    s_mov_b64 exec, 1
    s_cmp_ge_u32 s63, 8
    s_cbranch_scc1 ln_sb
    buffer_atomic_add v2, off, s[64:67], 0 offset:192 sc1
ln_sb:
    buffer_atomic_add v2, off, s[64:67], 0 offset:0 sc1
    s_mov_b64 exec, -1
    s_branch ln_sig
ln_touch:
    s_getpc_b64 s[24:25]
    s_add_u32 s24, s24, jobtab@rel32@lo+4
    s_addc_u32 s25, s25, jobtab@rel32@hi+12
    s_mul_i32 s30, s63, 960
    s_add_u32 s24, s24, s30
    s_addc_u32 s25, s25, 0
    s_load_dwordx16 s[32:47], s[24:25], 0
    s_mov_b32 s11, 131072
    v_and_b32 v20, 63, v0
    s_waitcnt lgkmcnt(0)
    s_load_dwordx2 s[8:9], s[0:1], s33
    s_mov_b32 s10, s38
    s_lshl_b32 s30, s35, 4
    v_mul_lo_u32 v21, s30, v20
    v_and_b32 v22, 15, v20
    v_mul_lo_u32 v22, s43, v22
    s_waitcnt lgkmcnt(0)
    s_cmp_eq_u32 s3, 4
    s_cbranch_scc0 tlb_1_1
    buffer_load_dword v23, v21, s[8:11], s36 offen
    s_branch tlb_1
tlb_1_1:
    s_cmp_eq_u32 s3, 5
    s_cbranch_scc0 tlb_1
    buffer_load_dword v23, v22, s[4:7], s42 offen
    buffer_load_dword v23, off, s[4:7], s46
tlb_1:
    s_barrier
    s_barrier
    s_barrier
ln_sig:
    s_mov_b32 s29, s63
    v_and_b32 v20, 63, v0
    v_lshlrev_b32 v1, 4, v20
    v_add_u32 v19, 0x1000, v1
    v_lshrrev_b32 v4, 4, v20
    v_mov_b32 v17, 0
    v_mov_b32 v18, 1
    s_lshr_b32 s26, s3, 2
    s_and_b32 s27, s3, 3
    s_lshl_b32 s21, s3, 11
    s_lshl_b32 s22, s3, 10
    s_add_u32 s22, s22, 16384
    s_mov_b32 s11, 131072
    s_mov_b32 s15, 131072
    s_mov_b32 s28, 0
    v_and_b32 v21, 15, v20
    v_lshlrev_b32 v22, 2, v4
    v_xor_b32 v21, v21, v22
    s_lshr_b32 s30, s3, 1
    s_and_b32 s30, s30, 1
    v_xor_b32 v21, s30, v21
    v_lshlrev_b32 v3, 4, v21
    s_lshl_b32 s30, s26, 13
    v_add_u32 v5, s30, v1
    v_add_u32 v6, 0x10000, v5
    v_bfe_u32 v21, v20, 2, 2
    v_and_b32 v22, 3, v20
    v_and_b32 v23, 1, v4
    v_xor_b32 v24, s27, v21
    v_xor_b32 v25, v22, v23
    v_lshl_add_u32 v24, v24, 2, v25
    v_lshlrev_b32 v24, 4, v24
    v_lshl_add_u32 v25, v4, 3, v21
    v_lshl_add_u32 v24, v25, 8, v24
    v_and_b32 v22, 1, v22
    v_xor_b32 v25, 0, v23
    v_lshl_add_u32 v8, v25, 10, v24
    v_xor_b32 v25, 0, v22
    v_lshl_add_u32 v8, v25, 3, v8
    v_add_u32 v12, 0x10000, v8
    v_xor_b32 v25, 1, v23
    v_lshl_add_u32 v9, v25, 10, v24
    v_xor_b32 v25, 0, v22
    v_lshl_add_u32 v9, v25, 3, v9
    v_add_u32 v13, 0x10000, v9
    v_xor_b32 v25, 0, v23
    v_lshl_add_u32 v10, v25, 10, v24
    v_xor_b32 v25, 1, v22
    v_lshl_add_u32 v10, v25, 3, v10
    v_add_u32 v14, 0x10000, v10
    v_xor_b32 v25, 1, v23
    v_lshl_add_u32 v11, v25, 10, v24
    v_xor_b32 v25, 1, v22
    v_lshl_add_u32 v11, v25, 3, v11
    v_add_u32 v15, 0x10000, v11
    s_lshl_b32 s30, s3, 2
    s_add_u32 s30, s30, 131072
    v_mov_b32 v7, s30
    s_getpc_b64 s[24:25]
    s_add_u32 s24, s24, jobtab@rel32@lo+4
    s_addc_u32 s25, s25, jobtab@rel32@hi+12
    s_mul_i32 s30, s29, 960
    s_add_u32 s24, s24, s30
    s_addc_u32 s25, s25, 0
    s_load_dwordx16 s[32:47], s[24:25], 0
    s_add_u32 s24, s24, 64
    s_addc_u32 s25, s25, 0
    s_waitcnt lgkmcnt(0)
    s_cmp_lg_u32 s32, 4
    s_cbranch_scc1 w_nopre
    s_load_dwordx2 s[8:9], s[0:1], s33
    s_load_dwordx2 s[12:13], s[0:1], s34
    s_mov_b32 s10, s38
    s_mov_b32 s14, s38
    s_cmp_eq_u32 s32, 4
    s_cselect_b32 s31, 0, 1
    s_lshl_b32 s30, s3, s31
    s_mul_i32 s30, s30, s40
    s_add_u32 s16, s39, s30
    s_cmp_eq_u32 s32, 4
    s_cselect_b32 s30, 1024, s40
    s_cselect_b32 s31, 6, 5
    s_lshl_b32 s62, 32, s31
    s_add_u32 s17, s16, s30
    s_lshl_b32 s30, s3, 2
    s_mul_i32 s30, s30, s35
    s_add_u32 s18, s36, s30
    s_add_u32 s19, s37, s30
    s_lshl_b32 s20, s35, s31
    v_mul_u32_u24 v2, s35, v4
    v_add_u32 v2, v2, v3
    s_waitcnt lgkmcnt(0)
    s_add_u32 m0, s22, 0
    s_nop 0
    buffer_load_dwordx4 v2, s[8:11], s18 offen lds
    s_add_u32 s18, s18, s20
    s_add_u32 m0, s22, 8192
    s_nop 0
    buffer_load_dwordx4 v2, s[12:15], s19 offen lds
    s_add_u32 s19, s19, s20
    s_add_u32 m0, s22, 32768
    s_nop 0
    buffer_load_dwordx4 v2, s[8:11], s18 offen lds
    s_add_u32 s18, s18, s20
    s_add_u32 m0, s22, 40960
    s_nop 0
    buffer_load_dwordx4 v2, s[12:15], s19 offen lds
    s_add_u32 s19, s19, s20
    s_add_u32 m0, s22, 65536
    s_nop 0
    buffer_load_dwordx4 v2, s[8:11], s18 offen lds
    s_add_u32 s18, s18, s20
    s_add_u32 m0, s22, 73728
    s_nop 0
    buffer_load_dwordx4 v2, s[12:15], s19 offen lds
    s_add_u32 s19, s19, s20
    s_add_u32 m0, s22, 98304
    s_nop 0
    buffer_load_dwordx4 v2, s[8:11], s18 offen lds
    s_add_u32 s18, s18, s20
    s_add_u32 m0, s22, 106496
    s_nop 0
    buffer_load_dwordx4 v2, s[12:15], s19 offen lds
    s_add_u32 s19, s19, s20
    s_cmp_eq_u32 s32, 4
    s_cselect_b32 s70, 1, 0
    s_cmp_eq_u32 s39, 0
    s_cselect_b32 s70, s70, 0
    s_cmp_lg_u32 s3, 0
    s_cbranch_scc1 lnwp_ok
    s_cmp_eq_u32 s70, 0
    s_cbranch_scc1 lnwp_full
    s_mov_b32 s69, 65536
lnwap:
    buffer_load_dword v20, off, s[64:67], 0 offset:192 sc1
    s_waitcnt vmcnt(0)
    v_readfirstlane_b32 s68, v20
    s_cmp_ge_u32 s68, 8
    s_cbranch_scc1 lnwap_ok
    s_sleep 8
    s_sub_u32 s69, s69, 1
    s_cbranch_scc0 lnwap
lnwap_ok:
    s_branch lnwp_ok
lnwp_full:
    s_mov_b32 s69, 65536
lnwp:
    buffer_load_dword v20, off, s[64:67], 0 offset:0 sc1
    s_waitcnt vmcnt(0)
    v_readfirstlane_b32 s68, v20
    s_cmp_ge_u32 s68, 128
    s_cbranch_scc1 lnwp_ok
    s_sleep 8
    s_sub_u32 s69, s69, 1
    s_cbranch_scc0 lnwp
lnwp_ok:
    s_barrier
    s_add_u32 m0, s21, 0
    s_nop 0
    buffer_load_dwordx4 v1, s[4:7], s16 offen sc1 lds
    s_add_u32 s16, s16, s62
    s_add_u32 m0, s21, 1024
    s_nop 0
    buffer_load_dwordx4 v1, s[4:7], s17 offen sc1 lds
    s_add_u32 s17, s17, s62
    s_add_u32 m0, s21, 32768
    s_nop 0
    buffer_load_dwordx4 v1, s[4:7], s16 offen sc1 lds
    s_add_u32 s16, s16, s62
    s_add_u32 m0, s21, 33792
    s_nop 0
    buffer_load_dwordx4 v1, s[4:7], s17 offen sc1 lds
    s_add_u32 s17, s17, s62
    s_add_u32 m0, s21, 65536
    s_nop 0
    buffer_load_dwordx4 v1, s[4:7], s16 offen sc1 lds
    s_add_u32 s16, s16, s62
    s_add_u32 m0, s21, 66560
    s_nop 0
    buffer_load_dwordx4 v1, s[4:7], s17 offen sc1 lds
    s_add_u32 s17, s17, s62
    s_add_u32 m0, s21, 98304
    s_nop 0
    buffer_load_dwordx4 v1, s[4:7], s16 offen sc1 lds
    s_add_u32 s16, s16, s62
    s_add_u32 m0, s21, 99328
    s_nop 0
    buffer_load_dwordx4 v1, s[4:7], s17 offen sc1 lds
    s_add_u32 s17, s17, s62
    s_branch w_adopt
w_nopre:
    s_cmp_eq_u32 s32, 4
    s_cselect_b32 s70, 1, 0
    s_cmp_eq_u32 s39, 0
    s_cselect_b32 s70, s70, 0
    s_cmp_lg_u32 s3, 0
    s_cbranch_scc1 lnw_ok
    s_cmp_eq_u32 s70, 0
    s_cbranch_scc1 lnw_full
    s_mov_b32 s69, 65536
lnwa:
    buffer_load_dword v20, off, s[64:67], 0 offset:192 sc1
    s_waitcnt vmcnt(0)
    v_readfirstlane_b32 s68, v20
    s_cmp_ge_u32 s68, 8
    s_cbranch_scc1 lnwa_ok
    s_sleep 8
    s_sub_u32 s69, s69, 1
    s_cbranch_scc0 lnwa
lnwa_ok:
    s_branch lnw_ok
lnw_full:
    s_mov_b32 s69, 65536
lnw:
    buffer_load_dword v20, off, s[64:67], 0 offset:0 sc1
    s_waitcnt vmcnt(0)
    v_readfirstlane_b32 s68, v20
    s_cmp_ge_u32 s68, 128
    s_cbranch_scc1 lnw_ok
    s_sleep 8
    s_sub_u32 s69, s69, 1
    s_cbranch_scc0 lnw
lnw_ok:
    s_barrier
w_cold:
    s_cmp_eq_u32 s32, 0
    s_cbranch_scc1 k_end
    s_cmp_ge_u32 s32, 6
    s_cbranch_scc1 w_fin
    s_cmp_lg_u32 s3, 0
    s_cbranch_scc1 w_depok
    s_cmp_eq_u32 s45, 0
    s_cbranch_scc1 w_depok
    s_mov_b32 s31, 0x40000
w_waitdep:
    buffer_load_dword v16, v17, s[4:7], s44 offen sc1
    s_waitcnt vmcnt(0)
    v_readfirstlane_b32 s30, v16
    s_cmp_ge_u32 s30, s45
    s_cbranch_scc1 w_depok
    s_sleep 16
    s_sub_u32 s31, s31, 1
    s_cbranch_scc0 w_waitdep
w_depok:
    s_cmp_eq_u32 s32, 5
    s_cbranch_scc1 w_att
    s_load_dwordx2 s[8:9], s[0:1], s33
    s_load_dwordx2 s[12:13], s[0:1], s34
    s_mov_b32 s10, s38
    s_mov_b32 s14, s38
    s_cmp_eq_u32 s32, 4
    s_cselect_b32 s31, 0, 1
    s_lshl_b32 s30, s3, s31
    s_mul_i32 s30, s30, s40
    s_add_u32 s16, s39, s30
    s_cmp_eq_u32 s32, 4
    s_cselect_b32 s30, 1024, s40
    s_cselect_b32 s31, 6, 5
    s_lshl_b32 s62, 32, s31
    s_add_u32 s17, s16, s30
    s_lshl_b32 s30, s3, 2
    s_mul_i32 s30, s30, s35
    s_add_u32 s18, s36, s30
    s_add_u32 s19, s37, s30
    s_lshl_b32 s20, s35, s31
    v_mul_u32_u24 v2, s35, v4
    v_add_u32 v2, v2, v3
    s_waitcnt lgkmcnt(0)
    s_barrier
    s_add_u32 m0, s21, 0
    s_nop 0
    buffer_load_dwordx4 v1, s[4:7], s16 offen sc1 lds
    s_add_u32 s16, s16, s62
    s_add_u32 m0, s21, 1024
    s_nop 0
    buffer_load_dwordx4 v1, s[4:7], s17 offen sc1 lds
    s_add_u32 s17, s17, s62
    s_add_u32 m0, s22, 0
    s_nop 0
    buffer_load_dwordx4 v2, s[8:11], s18 offen lds
    s_add_u32 s18, s18, s20
    s_add_u32 m0, s22, 8192
    s_nop 0
    buffer_load_dwordx4 v2, s[12:15], s19 offen lds
    s_add_u32 s19, s19, s20
    s_add_u32 m0, s21, 32768
    s_nop 0
    buffer_load_dwordx4 v1, s[4:7], s16 offen sc1 lds
    s_add_u32 s16, s16, s62
    s_add_u32 m0, s21, 33792
    s_nop 0
    buffer_load_dwordx4 v1, s[4:7], s17 offen sc1 lds
    s_add_u32 s17, s17, s62
    s_add_u32 m0, s22, 32768
    s_nop 0
    buffer_load_dwordx4 v2, s[8:11], s18 offen lds
    s_add_u32 s18, s18, s20
    s_add_u32 m0, s22, 40960
    s_nop 0
    buffer_load_dwordx4 v2, s[12:15], s19 offen lds
    s_add_u32 s19, s19, s20
    s_add_u32 m0, s21, 65536
    s_nop 0
    buffer_load_dwordx4 v1, s[4:7], s16 offen sc1 lds
    s_add_u32 s16, s16, s62
    s_add_u32 m0, s21, 66560
    s_nop 0
    buffer_load_dwordx4 v1, s[4:7], s17 offen sc1 lds
    s_add_u32 s17, s17, s62
    s_add_u32 m0, s22, 65536
    s_nop 0
    buffer_load_dwordx4 v2, s[8:11], s18 offen lds
    s_add_u32 s18, s18, s20
    s_add_u32 m0, s22, 73728
    s_nop 0
    buffer_load_dwordx4 v2, s[12:15], s19 offen lds
    s_add_u32 s19, s19, s20
    s_add_u32 m0, s21, 98304
    s_nop 0
    buffer_load_dwordx4 v1, s[4:7], s16 offen sc1 lds
    s_add_u32 s16, s16, s62
    s_add_u32 m0, s21, 99328
    s_nop 0
    buffer_load_dwordx4 v1, s[4:7], s17 offen sc1 lds
    s_add_u32 s17, s17, s62
    s_add_u32 m0, s22, 98304
    s_nop 0
    buffer_load_dwordx4 v2, s[8:11], s18 offen lds
    s_add_u32 s18, s18, s20
    s_add_u32 m0, s22, 106496
    s_nop 0
    buffer_load_dwordx4 v2, s[12:15], s19 offen lds
    s_add_u32 s19, s19, s20
w_adopt:
    s_mov_b32 s48, s32
    s_cmp_eq_u32 s32, 4
    s_cselect_b32 s30, 2, 3
    s_lshl_b32 s30, s26, s30
    s_mul_i32 s30, s30, s43
    s_add_u32 s49, s42, s30
    s_mov_b32 s50, s43
    s_mov_b32 s51, s46
    s_mov_b32 s23, s41
    s_mov_b32 s53, s47
    s_nop 0
    s_load_dwordx16 s[32:47], s[24:25], 0
    s_add_u32 s24, s24, 64
    s_addc_u32 s25, s25, 0
    s_waitcnt vmcnt(0)
    s_barrier
    ds_read_b64_tr_b16 v[64:65], v8 offset:16384
    ds_read_b64_tr_b16 v[66:67], v9 offset:16384
    ds_read_b64_tr_b16 v[68:69], v10 offset:16384
    ds_read_b64_tr_b16 v[70:71], v11 offset:16384
    ds_read_b64_tr_b16 v[72:73], v8 offset:24576
    ds_read_b64_tr_b16 v[74:75], v9 offset:24576
    ds_read_b64_tr_b16 v[76:77], v10 offset:24576
    ds_read_b64_tr_b16 v[78:79], v11 offset:24576
    ds_read_b128 v[32:35], v5 offset:0
    ds_read_b128 v[36:39], v5 offset:1024
    ds_read_b128 v[40:43], v5 offset:2048
    ds_read_b128 v[44:47], v5 offset:3072
    ds_read_b128 v[48:51], v5 offset:4096
    ds_read_b128 v[52:55], v5 offset:5120
    ds_read_b128 v[56:59], v5 offset:6144
    ds_read_b128 v[60:63], v5 offset:7168
    s_waitcnt lgkmcnt(0)
    s_cmp_eq_u32 s48, 4
    s_cbranch_scc1 w_firstH
    s_branch w_first16
w_first4:
    s_waitcnt vmcnt(12)
    s_barrier
    v_mfma_f32_16x16x32_bf16 v[128:131], v[64:67], v[32:35], 0
    ds_read_b64_tr_b16 v[112:113], v8 offset:49152
    v_mfma_f32_16x16x32_bf16 v[132:135], v[68:71], v[32:35], 0
    ds_read_b64_tr_b16 v[114:115], v9 offset:49152
    v_mfma_f32_16x16x32_bf16 v[136:139], v[72:75], v[32:35], 0
    ds_read_b64_tr_b16 v[116:117], v10 offset:49152
    v_mfma_f32_16x16x32_bf16 v[140:143], v[76:79], v[32:35], 0
    ds_read_b64_tr_b16 v[118:119], v11 offset:49152
    v_mfma_f32_16x16x32_bf16 v[144:147], v[64:67], v[36:39], 0
    ds_read_b64_tr_b16 v[120:121], v8 offset:57344
    v_mfma_f32_16x16x32_bf16 v[148:151], v[68:71], v[36:39], 0
    ds_read_b64_tr_b16 v[122:123], v9 offset:57344
    v_mfma_f32_16x16x32_bf16 v[152:155], v[72:75], v[36:39], 0
    ds_read_b64_tr_b16 v[124:125], v10 offset:57344
    v_mfma_f32_16x16x32_bf16 v[156:159], v[76:79], v[36:39], 0
    ds_read_b64_tr_b16 v[126:127], v11 offset:57344
    v_mfma_f32_16x16x32_bf16 v[160:163], v[64:67], v[40:43], 0
    ds_read_b128 v[80:83], v5 offset:32768
    v_mfma_f32_16x16x32_bf16 v[164:167], v[68:71], v[40:43], 0
    ds_read_b128 v[84:87], v5 offset:33792
    v_mfma_f32_16x16x32_bf16 v[168:171], v[72:75], v[40:43], 0
    ds_read_b128 v[88:91], v5 offset:34816
    v_mfma_f32_16x16x32_bf16 v[172:175], v[76:79], v[40:43], 0
    ds_read_b128 v[92:95], v5 offset:35840
    v_mfma_f32_16x16x32_bf16 v[176:179], v[64:67], v[44:47], 0
    ds_read_b128 v[96:99], v5 offset:36864
    v_mfma_f32_16x16x32_bf16 v[180:183], v[68:71], v[44:47], 0
    ds_read_b128 v[100:103], v5 offset:37888
    v_mfma_f32_16x16x32_bf16 v[184:187], v[72:75], v[44:47], 0
    ds_read_b128 v[104:107], v5 offset:38912
    v_mfma_f32_16x16x32_bf16 v[188:191], v[76:79], v[44:47], 0
    ds_read_b128 v[108:111], v5 offset:39936
    v_mfma_f32_16x16x32_bf16 v[192:195], v[64:67], v[48:51], 0
    v_mfma_f32_16x16x32_bf16 v[196:199], v[68:71], v[48:51], 0
    s_add_u32 m0, s21, 0
    s_nop 0
    buffer_load_dwordx4 v1, s[4:7], s16 offen sc1 lds
    s_add_u32 s16, s16, s62
    v_mfma_f32_16x16x32_bf16 v[200:203], v[72:75], v[48:51], 0
    v_mfma_f32_16x16x32_bf16 v[204:207], v[76:79], v[48:51], 0
    v_mfma_f32_16x16x32_bf16 v[208:211], v[64:67], v[52:55], 0
    s_add_u32 m0, s21, 1024
    s_nop 0
    buffer_load_dwordx4 v1, s[4:7], s17 offen sc1 lds
    s_add_u32 s17, s17, s62
    v_mfma_f32_16x16x32_bf16 v[212:215], v[68:71], v[52:55], 0
    v_mfma_f32_16x16x32_bf16 v[216:219], v[72:75], v[52:55], 0
    v_mfma_f32_16x16x32_bf16 v[220:223], v[76:79], v[52:55], 0
    s_add_u32 m0, s22, 0
    s_nop 0
    buffer_load_dwordx4 v2, s[8:11], s18 offen lds
    s_add_u32 s18, s18, s20
    v_mfma_f32_16x16x32_bf16 v[224:227], v[64:67], v[56:59], 0
    v_mfma_f32_16x16x32_bf16 v[228:231], v[68:71], v[56:59], 0
    v_mfma_f32_16x16x32_bf16 v[232:235], v[72:75], v[56:59], 0
    s_add_u32 m0, s22, 8192
    s_nop 0
    buffer_load_dwordx4 v2, s[12:15], s19 offen lds
    s_add_u32 s19, s19, s20
    v_mfma_f32_16x16x32_bf16 v[236:239], v[76:79], v[56:59], 0
    v_mfma_f32_16x16x32_bf16 v[240:243], v[64:67], v[60:63], 0
    v_mfma_f32_16x16x32_bf16 v[244:247], v[68:71], v[60:63], 0
    v_mfma_f32_16x16x32_bf16 v[248:251], v[72:75], v[60:63], 0
    v_mfma_f32_16x16x32_bf16 v[252:255], v[76:79], v[60:63], 0
    s_waitcnt lgkmcnt(0)
    s_waitcnt vmcnt(12)
    s_barrier
    v_mfma_f32_16x16x32_bf16 v[128:131], v[112:115], v[80:83], v[128:131]
    ds_read_b64_tr_b16 v[64:65], v12 offset:16384
    v_mfma_f32_16x16x32_bf16 v[132:135], v[116:119], v[80:83], v[132:135]
    ds_read_b64_tr_b16 v[66:67], v13 offset:16384
    v_mfma_f32_16x16x32_bf16 v[136:139], v[120:123], v[80:83], v[136:139]
    ds_read_b64_tr_b16 v[68:69], v14 offset:16384
    v_mfma_f32_16x16x32_bf16 v[140:143], v[124:127], v[80:83], v[140:143]
    ds_read_b64_tr_b16 v[70:71], v15 offset:16384
    v_mfma_f32_16x16x32_bf16 v[144:147], v[112:115], v[84:87], v[144:147]
    ds_read_b64_tr_b16 v[72:73], v12 offset:24576
    v_mfma_f32_16x16x32_bf16 v[148:151], v[116:119], v[84:87], v[148:151]
    ds_read_b64_tr_b16 v[74:75], v13 offset:24576
    v_mfma_f32_16x16x32_bf16 v[152:155], v[120:123], v[84:87], v[152:155]
    ds_read_b64_tr_b16 v[76:77], v14 offset:24576
    v_mfma_f32_16x16x32_bf16 v[156:159], v[124:127], v[84:87], v[156:159]
    ds_read_b64_tr_b16 v[78:79], v15 offset:24576
    v_mfma_f32_16x16x32_bf16 v[160:163], v[112:115], v[88:91], v[160:163]
    ds_read_b128 v[32:35], v6 offset:0
    v_mfma_f32_16x16x32_bf16 v[164:167], v[116:119], v[88:91], v[164:167]
    ds_read_b128 v[36:39], v6 offset:1024
    v_mfma_f32_16x16x32_bf16 v[168:171], v[120:123], v[88:91], v[168:171]
    ds_read_b128 v[40:43], v6 offset:2048
    v_mfma_f32_16x16x32_bf16 v[172:175], v[124:127], v[88:91], v[172:175]
    ds_read_b128 v[44:47], v6 offset:3072
    v_mfma_f32_16x16x32_bf16 v[176:179], v[112:115], v[92:95], v[176:179]
    ds_read_b128 v[48:51], v6 offset:4096
    v_mfma_f32_16x16x32_bf16 v[180:183], v[116:119], v[92:95], v[180:183]
    ds_read_b128 v[52:55], v6 offset:5120
    v_mfma_f32_16x16x32_bf16 v[184:187], v[120:123], v[92:95], v[184:187]
    ds_read_b128 v[56:59], v6 offset:6144
    v_mfma_f32_16x16x32_bf16 v[188:191], v[124:127], v[92:95], v[188:191]
    ds_read_b128 v[60:63], v6 offset:7168
    v_mfma_f32_16x16x32_bf16 v[192:195], v[112:115], v[96:99], v[192:195]
    v_mfma_f32_16x16x32_bf16 v[196:199], v[116:119], v[96:99], v[196:199]
    s_add_u32 m0, s21, 32768
    s_nop 0
    buffer_load_dwordx4 v1, s[4:7], s16 offen sc1 lds
    s_add_u32 s16, s16, s62
    v_mfma_f32_16x16x32_bf16 v[200:203], v[120:123], v[96:99], v[200:203]
    v_mfma_f32_16x16x32_bf16 v[204:207], v[124:127], v[96:99], v[204:207]
    v_mfma_f32_16x16x32_bf16 v[208:211], v[112:115], v[100:103], v[208:211]
    s_add_u32 m0, s21, 33792
    s_nop 0
    buffer_load_dwordx4 v1, s[4:7], s17 offen sc1 lds
    s_add_u32 s17, s17, s62
    v_mfma_f32_16x16x32_bf16 v[212:215], v[116:119], v[100:103], v[212:215]
    v_mfma_f32_16x16x32_bf16 v[216:219], v[120:123], v[100:103], v[216:219]
    v_mfma_f32_16x16x32_bf16 v[220:223], v[124:127], v[100:103], v[220:223]
    s_add_u32 m0, s22, 32768
    s_nop 0
    buffer_load_dwordx4 v2, s[8:11], s18 offen lds
    s_add_u32 s18, s18, s20
    v_mfma_f32_16x16x32_bf16 v[224:227], v[112:115], v[104:107], v[224:227]
    v_mfma_f32_16x16x32_bf16 v[228:231], v[116:119], v[104:107], v[228:231]
    v_mfma_f32_16x16x32_bf16 v[232:235], v[120:123], v[104:107], v[232:235]
    s_add_u32 m0, s22, 40960
    s_nop 0
    buffer_load_dwordx4 v2, s[12:15], s19 offen lds
    s_add_u32 s19, s19, s20
    v_mfma_f32_16x16x32_bf16 v[236:239], v[124:127], v[104:107], v[236:239]
    v_mfma_f32_16x16x32_bf16 v[240:243], v[112:115], v[108:111], v[240:243]
    v_mfma_f32_16x16x32_bf16 v[244:247], v[116:119], v[108:111], v[244:247]
    v_mfma_f32_16x16x32_bf16 v[248:251], v[120:123], v[108:111], v[248:251]
    v_mfma_f32_16x16x32_bf16 v[252:255], v[124:127], v[108:111], v[252:255]
    s_waitcnt lgkmcnt(0)
    s_waitcnt vmcnt(12)
    s_barrier
    v_mfma_f32_16x16x32_bf16 v[128:131], v[64:67], v[32:35], v[128:131]
    ds_read_b64_tr_b16 v[112:113], v12 offset:49152
    v_mfma_f32_16x16x32_bf16 v[132:135], v[68:71], v[32:35], v[132:135]
    ds_read_b64_tr_b16 v[114:115], v13 offset:49152
    v_mfma_f32_16x16x32_bf16 v[136:139], v[72:75], v[32:35], v[136:139]
    ds_read_b64_tr_b16 v[116:117], v14 offset:49152
    v_mfma_f32_16x16x32_bf16 v[140:143], v[76:79], v[32:35], v[140:143]
    ds_read_b64_tr_b16 v[118:119], v15 offset:49152
    v_mfma_f32_16x16x32_bf16 v[144:147], v[64:67], v[36:39], v[144:147]
    ds_read_b64_tr_b16 v[120:121], v12 offset:57344
    v_mfma_f32_16x16x32_bf16 v[148:151], v[68:71], v[36:39], v[148:151]
    ds_read_b64_tr_b16 v[122:123], v13 offset:57344
    v_mfma_f32_16x16x32_bf16 v[152:155], v[72:75], v[36:39], v[152:155]
    ds_read_b64_tr_b16 v[124:125], v14 offset:57344
    v_mfma_f32_16x16x32_bf16 v[156:159], v[76:79], v[36:39], v[156:159]
    ds_read_b64_tr_b16 v[126:127], v15 offset:57344
    v_mfma_f32_16x16x32_bf16 v[160:163], v[64:67], v[40:43], v[160:163]
    ds_read_b128 v[80:83], v6 offset:32768
    v_mfma_f32_16x16x32_bf16 v[164:167], v[68:71], v[40:43], v[164:167]
    ds_read_b128 v[84:87], v6 offset:33792
    v_mfma_f32_16x16x32_bf16 v[168:171], v[72:75], v[40:43], v[168:171]
    ds_read_b128 v[88:91], v6 offset:34816
    v_mfma_f32_16x16x32_bf16 v[172:175], v[76:79], v[40:43], v[172:175]
    ds_read_b128 v[92:95], v6 offset:35840
    v_mfma_f32_16x16x32_bf16 v[176:179], v[64:67], v[44:47], v[176:179]
    ds_read_b128 v[96:99], v6 offset:36864
    v_mfma_f32_16x16x32_bf16 v[180:183], v[68:71], v[44:47], v[180:183]
    ds_read_b128 v[100:103], v6 offset:37888
    v_mfma_f32_16x16x32_bf16 v[184:187], v[72:75], v[44:47], v[184:187]
    ds_read_b128 v[104:107], v6 offset:38912
    v_mfma_f32_16x16x32_bf16 v[188:191], v[76:79], v[44:47], v[188:191]
    ds_read_b128 v[108:111], v6 offset:39936
    v_mfma_f32_16x16x32_bf16 v[192:195], v[64:67], v[48:51], v[192:195]
    v_mfma_f32_16x16x32_bf16 v[196:199], v[68:71], v[48:51], v[196:199]
    s_add_u32 m0, s21, 65536
    s_nop 0
    buffer_load_dwordx4 v1, s[4:7], s16 offen sc1 lds
    s_add_u32 s16, s16, s62
    v_mfma_f32_16x16x32_bf16 v[200:203], v[72:75], v[48:51], v[200:203]
    v_mfma_f32_16x16x32_bf16 v[204:207], v[76:79], v[48:51], v[204:207]
    v_mfma_f32_16x16x32_bf16 v[208:211], v[64:67], v[52:55], v[208:211]
    s_add_u32 m0, s21, 66560
    s_nop 0
    buffer_load_dwordx4 v1, s[4:7], s17 offen sc1 lds
    s_add_u32 s17, s17, s62
    v_mfma_f32_16x16x32_bf16 v[212:215], v[68:71], v[52:55], v[212:215]
    v_mfma_f32_16x16x32_bf16 v[216:219], v[72:75], v[52:55], v[216:219]
    v_mfma_f32_16x16x32_bf16 v[220:223], v[76:79], v[52:55], v[220:223]
    s_add_u32 m0, s22, 65536
    s_nop 0
    buffer_load_dwordx4 v2, s[8:11], s18 offen lds
    s_add_u32 s18, s18, s20
    v_mfma_f32_16x16x32_bf16 v[224:227], v[64:67], v[56:59], v[224:227]
    v_mfma_f32_16x16x32_bf16 v[228:231], v[68:71], v[56:59], v[228:231]
    v_mfma_f32_16x16x32_bf16 v[232:235], v[72:75], v[56:59], v[232:235]
    s_add_u32 m0, s22, 73728
    s_nop 0
    buffer_load_dwordx4 v2, s[12:15], s19 offen lds
    s_add_u32 s19, s19, s20
    v_mfma_f32_16x16x32_bf16 v[236:239], v[76:79], v[56:59], v[236:239]
    v_mfma_f32_16x16x32_bf16 v[240:243], v[64:67], v[60:63], v[240:243]
    v_mfma_f32_16x16x32_bf16 v[244:247], v[68:71], v[60:63], v[244:247]
    v_mfma_f32_16x16x32_bf16 v[248:251], v[72:75], v[60:63], v[248:251]
    v_mfma_f32_16x16x32_bf16 v[252:255], v[76:79], v[60:63], v[252:255]
    s_waitcnt lgkmcnt(0)
    s_waitcnt vmcnt(8)
    s_barrier
    s_cmp_eq_u32 s28, 0
    s_cbranch_scc1 sig_2
    s_cmp_lg_u32 s3, 0
    s_cbranch_scc1 sig_2
    s_and_b32 s57, s28, 3
    v_mov_b32 v24, s57
    s_bfe_u32 s57, s28, 0x20002
    v_mov_b32 v25, s57
    s_andn2_b32 s28, s28, 15
    s_mov_b64 exec, 1
    buffer_atomic_add_x2 v[24:25], v17, s[4:7], s28 offen sc1
    s_mov_b64 exec, -1
sig_2:
    s_mov_b32 s28, 0
    v_mfma_f32_16x16x32_bf16 v[128:131], v[112:115], v[80:83], v[128:131]
    ds_read_b64_tr_b16 v[64:65], v8 offset:16384
    v_mfma_f32_16x16x32_bf16 v[132:135], v[116:119], v[80:83], v[132:135]
    ds_read_b64_tr_b16 v[66:67], v9 offset:16384
    v_mfma_f32_16x16x32_bf16 v[136:139], v[120:123], v[80:83], v[136:139]
    ds_read_b64_tr_b16 v[68:69], v10 offset:16384
    v_mfma_f32_16x16x32_bf16 v[140:143], v[124:127], v[80:83], v[140:143]
    ds_read_b64_tr_b16 v[70:71], v11 offset:16384
    v_mfma_f32_16x16x32_bf16 v[144:147], v[112:115], v[84:87], v[144:147]
    ds_read_b64_tr_b16 v[72:73], v8 offset:24576
    v_mfma_f32_16x16x32_bf16 v[148:151], v[116:119], v[84:87], v[148:151]
    ds_read_b64_tr_b16 v[74:75], v9 offset:24576
    v_mfma_f32_16x16x32_bf16 v[152:155], v[120:123], v[84:87], v[152:155]
    ds_read_b64_tr_b16 v[76:77], v10 offset:24576
    v_mfma_f32_16x16x32_bf16 v[156:159], v[124:127], v[84:87], v[156:159]
    ds_read_b64_tr_b16 v[78:79], v11 offset:24576
    v_mfma_f32_16x16x32_bf16 v[160:163], v[112:115], v[88:91], v[160:163]
    ds_read_b128 v[32:35], v5 offset:0
    v_mfma_f32_16x16x32_bf16 v[164:167], v[116:119], v[88:91], v[164:167]
    ds_read_b128 v[36:39], v5 offset:1024
    v_mfma_f32_16x16x32_bf16 v[168:171], v[120:123], v[88:91], v[168:171]
    ds_read_b128 v[40:43], v5 offset:2048
    v_mfma_f32_16x16x32_bf16 v[172:175], v[124:127], v[88:91], v[172:175]
    ds_read_b128 v[44:47], v5 offset:3072
    v_mfma_f32_16x16x32_bf16 v[176:179], v[112:115], v[92:95], v[176:179]
    ds_read_b128 v[48:51], v5 offset:4096
    v_mfma_f32_16x16x32_bf16 v[180:183], v[116:119], v[92:95], v[180:183]
    ds_read_b128 v[52:55], v5 offset:5120
    v_mfma_f32_16x16x32_bf16 v[184:187], v[120:123], v[92:95], v[184:187]
    ds_read_b128 v[56:59], v5 offset:6144
    v_mfma_f32_16x16x32_bf16 v[188:191], v[124:127], v[92:95], v[188:191]
    ds_read_b128 v[60:63], v5 offset:7168
    v_mfma_f32_16x16x32_bf16 v[192:195], v[112:115], v[96:99], v[192:195]
    v_mfma_f32_16x16x32_bf16 v[196:199], v[116:119], v[96:99], v[196:199]
    s_add_u32 m0, s21, 98304
    s_nop 0
    buffer_load_dwordx4 v1, s[4:7], s16 offen sc1 lds
    s_add_u32 s16, s16, s62
    v_mfma_f32_16x16x32_bf16 v[200:203], v[120:123], v[96:99], v[200:203]
    v_mfma_f32_16x16x32_bf16 v[204:207], v[124:127], v[96:99], v[204:207]
    v_mfma_f32_16x16x32_bf16 v[208:211], v[112:115], v[100:103], v[208:211]
    s_add_u32 m0, s21, 99328
    s_nop 0
    buffer_load_dwordx4 v1, s[4:7], s17 offen sc1 lds
    s_add_u32 s17, s17, s62
    v_mfma_f32_16x16x32_bf16 v[212:215], v[116:119], v[100:103], v[212:215]
    v_mfma_f32_16x16x32_bf16 v[216:219], v[120:123], v[100:103], v[216:219]
    v_mfma_f32_16x16x32_bf16 v[220:223], v[124:127], v[100:103], v[220:223]
    s_add_u32 m0, s22, 98304
    s_nop 0
    buffer_load_dwordx4 v2, s[8:11], s18 offen lds
    s_add_u32 s18, s18, s20
    v_mfma_f32_16x16x32_bf16 v[224:227], v[112:115], v[104:107], v[224:227]
    v_mfma_f32_16x16x32_bf16 v[228:231], v[116:119], v[104:107], v[228:231]
    v_mfma_f32_16x16x32_bf16 v[232:235], v[120:123], v[104:107], v[232:235]
    s_add_u32 m0, s22, 106496
    s_nop 0
    buffer_load_dwordx4 v2, s[12:15], s19 offen lds
    s_add_u32 s19, s19, s20
    v_mfma_f32_16x16x32_bf16 v[236:239], v[124:127], v[104:107], v[236:239]
    v_mfma_f32_16x16x32_bf16 v[240:243], v[112:115], v[108:111], v[240:243]
    v_mfma_f32_16x16x32_bf16 v[244:247], v[116:119], v[108:111], v[244:247]
    v_mfma_f32_16x16x32_bf16 v[248:251], v[120:123], v[108:111], v[248:251]
    v_mfma_f32_16x16x32_bf16 v[252:255], v[124:127], v[108:111], v[252:255]
    s_waitcnt lgkmcnt(0)
    s_branch w_loop_chk
w_first8:
    s_waitcnt vmcnt(16)
    s_barrier
    v_mfma_f32_16x16x32_bf16 v[128:131], v[64:67], v[32:35], 0
    ds_read_b64_tr_b16 v[112:113], v8 offset:49152
    v_mfma_f32_16x16x32_bf16 v[132:135], v[68:71], v[32:35], 0
    ds_read_b64_tr_b16 v[114:115], v9 offset:49152
    v_mfma_f32_16x16x32_bf16 v[136:139], v[72:75], v[32:35], 0
    ds_read_b64_tr_b16 v[116:117], v10 offset:49152
    v_mfma_f32_16x16x32_bf16 v[140:143], v[76:79], v[32:35], 0
    ds_read_b64_tr_b16 v[118:119], v11 offset:49152
    v_mfma_f32_16x16x32_bf16 v[144:147], v[64:67], v[36:39], 0
    ds_read_b64_tr_b16 v[120:121], v8 offset:57344
    v_mfma_f32_16x16x32_bf16 v[148:151], v[68:71], v[36:39], 0
    ds_read_b64_tr_b16 v[122:123], v9 offset:57344
    v_mfma_f32_16x16x32_bf16 v[152:155], v[72:75], v[36:39], 0
    ds_read_b64_tr_b16 v[124:125], v10 offset:57344
    v_mfma_f32_16x16x32_bf16 v[156:159], v[76:79], v[36:39], 0
    ds_read_b64_tr_b16 v[126:127], v11 offset:57344
    v_mfma_f32_16x16x32_bf16 v[160:163], v[64:67], v[40:43], 0
    ds_read_b128 v[80:83], v5 offset:32768
    v_mfma_f32_16x16x32_bf16 v[164:167], v[68:71], v[40:43], 0
    ds_read_b128 v[84:87], v5 offset:33792
    v_mfma_f32_16x16x32_bf16 v[168:171], v[72:75], v[40:43], 0
    ds_read_b128 v[88:91], v5 offset:34816
    v_mfma_f32_16x16x32_bf16 v[172:175], v[76:79], v[40:43], 0
    ds_read_b128 v[92:95], v5 offset:35840
    v_mfma_f32_16x16x32_bf16 v[176:179], v[64:67], v[44:47], 0
    ds_read_b128 v[96:99], v5 offset:36864
    v_mfma_f32_16x16x32_bf16 v[180:183], v[68:71], v[44:47], 0
    ds_read_b128 v[100:103], v5 offset:37888
    v_mfma_f32_16x16x32_bf16 v[184:187], v[72:75], v[44:47], 0
    ds_read_b128 v[104:107], v5 offset:38912
    v_mfma_f32_16x16x32_bf16 v[188:191], v[76:79], v[44:47], 0
    ds_read_b128 v[108:111], v5 offset:39936
    v_mfma_f32_16x16x32_bf16 v[192:195], v[64:67], v[48:51], 0
    v_mfma_f32_16x16x32_bf16 v[196:199], v[68:71], v[48:51], 0
    s_add_u32 m0, s21, 0
    s_nop 0
    buffer_load_dwordx4 v1, s[4:7], s16 offen sc1 lds
    s_add_u32 s16, s16, s62
    v_mfma_f32_16x16x32_bf16 v[200:203], v[72:75], v[48:51], 0
    v_mfma_f32_16x16x32_bf16 v[204:207], v[76:79], v[48:51], 0
    v_mfma_f32_16x16x32_bf16 v[208:211], v[64:67], v[52:55], 0
    s_add_u32 m0, s21, 1024
    s_nop 0
    buffer_load_dwordx4 v1, s[4:7], s17 offen sc1 lds
    s_add_u32 s17, s17, s62
    v_mfma_f32_16x16x32_bf16 v[212:215], v[68:71], v[52:55], 0
    v_mfma_f32_16x16x32_bf16 v[216:219], v[72:75], v[52:55], 0
    v_mfma_f32_16x16x32_bf16 v[220:223], v[76:79], v[52:55], 0
    s_add_u32 m0, s22, 0
    s_nop 0
    buffer_load_dwordx4 v2, s[8:11], s18 offen lds
    s_add_u32 s18, s18, s20
    v_mfma_f32_16x16x32_bf16 v[224:227], v[64:67], v[56:59], 0
    v_mfma_f32_16x16x32_bf16 v[228:231], v[68:71], v[56:59], 0
    v_mfma_f32_16x16x32_bf16 v[232:235], v[72:75], v[56:59], 0
    s_add_u32 m0, s22, 8192
    s_nop 0
    buffer_load_dwordx4 v2, s[12:15], s19 offen lds
    s_add_u32 s19, s19, s20
    v_mfma_f32_16x16x32_bf16 v[236:239], v[76:79], v[56:59], 0
    v_mfma_f32_16x16x32_bf16 v[240:243], v[64:67], v[60:63], 0
    v_mfma_f32_16x16x32_bf16 v[244:247], v[68:71], v[60:63], 0
    v_mfma_f32_16x16x32_bf16 v[248:251], v[72:75], v[60:63], 0
    v_mfma_f32_16x16x32_bf16 v[252:255], v[76:79], v[60:63], 0
    s_waitcnt lgkmcnt(0)
    s_waitcnt vmcnt(16)
    s_barrier
    v_mfma_f32_16x16x32_bf16 v[128:131], v[112:115], v[80:83], v[128:131]
    ds_read_b64_tr_b16 v[64:65], v12 offset:16384
    v_mfma_f32_16x16x32_bf16 v[132:135], v[116:119], v[80:83], v[132:135]
    ds_read_b64_tr_b16 v[66:67], v13 offset:16384
    v_mfma_f32_16x16x32_bf16 v[136:139], v[120:123], v[80:83], v[136:139]
    ds_read_b64_tr_b16 v[68:69], v14 offset:16384
    v_mfma_f32_16x16x32_bf16 v[140:143], v[124:127], v[80:83], v[140:143]
    ds_read_b64_tr_b16 v[70:71], v15 offset:16384
    v_mfma_f32_16x16x32_bf16 v[144:147], v[112:115], v[84:87], v[144:147]
    ds_read_b64_tr_b16 v[72:73], v12 offset:24576
    v_mfma_f32_16x16x32_bf16 v[148:151], v[116:119], v[84:87], v[148:151]
    ds_read_b64_tr_b16 v[74:75], v13 offset:24576
    v_mfma_f32_16x16x32_bf16 v[152:155], v[120:123], v[84:87], v[152:155]
    ds_read_b64_tr_b16 v[76:77], v14 offset:24576
    v_mfma_f32_16x16x32_bf16 v[156:159], v[124:127], v[84:87], v[156:159]
    ds_read_b64_tr_b16 v[78:79], v15 offset:24576
    v_mfma_f32_16x16x32_bf16 v[160:163], v[112:115], v[88:91], v[160:163]
    ds_read_b128 v[32:35], v6 offset:0
    v_mfma_f32_16x16x32_bf16 v[164:167], v[116:119], v[88:91], v[164:167]
    ds_read_b128 v[36:39], v6 offset:1024
    v_mfma_f32_16x16x32_bf16 v[168:171], v[120:123], v[88:91], v[168:171]
    ds_read_b128 v[40:43], v6 offset:2048
    v_mfma_f32_16x16x32_bf16 v[172:175], v[124:127], v[88:91], v[172:175]
    ds_read_b128 v[44:47], v6 offset:3072
    v_mfma_f32_16x16x32_bf16 v[176:179], v[112:115], v[92:95], v[176:179]
    ds_read_b128 v[48:51], v6 offset:4096
    v_mfma_f32_16x16x32_bf16 v[180:183], v[116:119], v[92:95], v[180:183]
    ds_read_b128 v[52:55], v6 offset:5120
    v_mfma_f32_16x16x32_bf16 v[184:187], v[120:123], v[92:95], v[184:187]
    ds_read_b128 v[56:59], v6 offset:6144
    v_mfma_f32_16x16x32_bf16 v[188:191], v[124:127], v[92:95], v[188:191]
    ds_read_b128 v[60:63], v6 offset:7168
    v_mfma_f32_16x16x32_bf16 v[192:195], v[112:115], v[96:99], v[192:195]
    v_mfma_f32_16x16x32_bf16 v[196:199], v[116:119], v[96:99], v[196:199]
    s_add_u32 m0, s21, 32768
    s_nop 0
    buffer_load_dwordx4 v1, s[4:7], s16 offen sc1 lds
    s_add_u32 s16, s16, s62
    v_mfma_f32_16x16x32_bf16 v[200:203], v[120:123], v[96:99], v[200:203]
    v_mfma_f32_16x16x32_bf16 v[204:207], v[124:127], v[96:99], v[204:207]
    v_mfma_f32_16x16x32_bf16 v[208:211], v[112:115], v[100:103], v[208:211]
    s_add_u32 m0, s21, 33792
    s_nop 0
    buffer_load_dwordx4 v1, s[4:7], s17 offen sc1 lds
    s_add_u32 s17, s17, s62
    v_mfma_f32_16x16x32_bf16 v[212:215], v[116:119], v[100:103], v[212:215]
    v_mfma_f32_16x16x32_bf16 v[216:219], v[120:123], v[100:103], v[216:219]
    v_mfma_f32_16x16x32_bf16 v[220:223], v[124:127], v[100:103], v[220:223]
    s_add_u32 m0, s22, 32768
    s_nop 0
    buffer_load_dwordx4 v2, s[8:11], s18 offen lds
    s_add_u32 s18, s18, s20
    v_mfma_f32_16x16x32_bf16 v[224:227], v[112:115], v[104:107], v[224:227]
    v_mfma_f32_16x16x32_bf16 v[228:231], v[116:119], v[104:107], v[228:231]
    v_mfma_f32_16x16x32_bf16 v[232:235], v[120:123], v[104:107], v[232:235]
    s_add_u32 m0, s22, 40960
    s_nop 0
    buffer_load_dwordx4 v2, s[12:15], s19 offen lds
    s_add_u32 s19, s19, s20
    v_mfma_f32_16x16x32_bf16 v[236:239], v[124:127], v[104:107], v[236:239]
    v_mfma_f32_16x16x32_bf16 v[240:243], v[112:115], v[108:111], v[240:243]
    v_mfma_f32_16x16x32_bf16 v[244:247], v[116:119], v[108:111], v[244:247]
    v_mfma_f32_16x16x32_bf16 v[248:251], v[120:123], v[108:111], v[248:251]
    v_mfma_f32_16x16x32_bf16 v[252:255], v[124:127], v[108:111], v[252:255]
    s_waitcnt lgkmcnt(0)
    s_waitcnt vmcnt(16)
    s_barrier
    v_mfma_f32_16x16x32_bf16 v[128:131], v[64:67], v[32:35], v[128:131]
    ds_read_b64_tr_b16 v[112:113], v12 offset:49152
    v_mfma_f32_16x16x32_bf16 v[132:135], v[68:71], v[32:35], v[132:135]
    ds_read_b64_tr_b16 v[114:115], v13 offset:49152
    v_mfma_f32_16x16x32_bf16 v[136:139], v[72:75], v[32:35], v[136:139]
    ds_read_b64_tr_b16 v[116:117], v14 offset:49152
    v_mfma_f32_16x16x32_bf16 v[140:143], v[76:79], v[32:35], v[140:143]
    ds_read_b64_tr_b16 v[118:119], v15 offset:49152
    v_mfma_f32_16x16x32_bf16 v[144:147], v[64:67], v[36:39], v[144:147]
    ds_read_b64_tr_b16 v[120:121], v12 offset:57344
    v_mfma_f32_16x16x32_bf16 v[148:151], v[68:71], v[36:39], v[148:151]
    ds_read_b64_tr_b16 v[122:123], v13 offset:57344
    v_mfma_f32_16x16x32_bf16 v[152:155], v[72:75], v[36:39], v[152:155]
    ds_read_b64_tr_b16 v[124:125], v14 offset:57344
    v_mfma_f32_16x16x32_bf16 v[156:159], v[76:79], v[36:39], v[156:159]
    ds_read_b64_tr_b16 v[126:127], v15 offset:57344
    v_mfma_f32_16x16x32_bf16 v[160:163], v[64:67], v[40:43], v[160:163]
    ds_read_b128 v[80:83], v6 offset:32768
    v_mfma_f32_16x16x32_bf16 v[164:167], v[68:71], v[40:43], v[164:167]
    ds_read_b128 v[84:87], v6 offset:33792
    v_mfma_f32_16x16x32_bf16 v[168:171], v[72:75], v[40:43], v[168:171]
    ds_read_b128 v[88:91], v6 offset:34816
    v_mfma_f32_16x16x32_bf16 v[172:175], v[76:79], v[40:43], v[172:175]
    ds_read_b128 v[92:95], v6 offset:35840
    v_mfma_f32_16x16x32_bf16 v[176:179], v[64:67], v[44:47], v[176:179]
    ds_read_b128 v[96:99], v6 offset:36864
    v_mfma_f32_16x16x32_bf16 v[180:183], v[68:71], v[44:47], v[180:183]
    ds_read_b128 v[100:103], v6 offset:37888
    v_mfma_f32_16x16x32_bf16 v[184:187], v[72:75], v[44:47], v[184:187]
    ds_read_b128 v[104:107], v6 offset:38912
    v_mfma_f32_16x16x32_bf16 v[188:191], v[76:79], v[44:47], v[188:191]
    ds_read_b128 v[108:111], v6 offset:39936
    v_mfma_f32_16x16x32_bf16 v[192:195], v[64:67], v[48:51], v[192:195]
    v_mfma_f32_16x16x32_bf16 v[196:199], v[68:71], v[48:51], v[196:199]
    s_add_u32 m0, s21, 65536
    s_nop 0
    buffer_load_dwordx4 v1, s[4:7], s16 offen sc1 lds
    s_add_u32 s16, s16, s62
    v_mfma_f32_16x16x32_bf16 v[200:203], v[72:75], v[48:51], v[200:203]
    v_mfma_f32_16x16x32_bf16 v[204:207], v[76:79], v[48:51], v[204:207]
    v_mfma_f32_16x16x32_bf16 v[208:211], v[64:67], v[52:55], v[208:211]
    s_add_u32 m0, s21, 66560
    s_nop 0
    buffer_load_dwordx4 v1, s[4:7], s17 offen sc1 lds
    s_add_u32 s17, s17, s62
    v_mfma_f32_16x16x32_bf16 v[212:215], v[68:71], v[52:55], v[212:215]
    v_mfma_f32_16x16x32_bf16 v[216:219], v[72:75], v[52:55], v[216:219]
    v_mfma_f32_16x16x32_bf16 v[220:223], v[76:79], v[52:55], v[220:223]
    s_add_u32 m0, s22, 65536
    s_nop 0
    buffer_load_dwordx4 v2, s[8:11], s18 offen lds
    s_add_u32 s18, s18, s20
    v_mfma_f32_16x16x32_bf16 v[224:227], v[64:67], v[56:59], v[224:227]
    v_mfma_f32_16x16x32_bf16 v[228:231], v[68:71], v[56:59], v[228:231]
    v_mfma_f32_16x16x32_bf16 v[232:235], v[72:75], v[56:59], v[232:235]
    s_add_u32 m0, s22, 73728
    s_nop 0
    buffer_load_dwordx4 v2, s[12:15], s19 offen lds
    s_add_u32 s19, s19, s20
    v_mfma_f32_16x16x32_bf16 v[236:239], v[76:79], v[56:59], v[236:239]
    v_mfma_f32_16x16x32_bf16 v[240:243], v[64:67], v[60:63], v[240:243]
    v_mfma_f32_16x16x32_bf16 v[244:247], v[68:71], v[60:63], v[244:247]
    v_mfma_f32_16x16x32_bf16 v[248:251], v[72:75], v[60:63], v[248:251]
    v_mfma_f32_16x16x32_bf16 v[252:255], v[76:79], v[60:63], v[252:255]
    s_waitcnt lgkmcnt(0)
    s_waitcnt vmcnt(8)
    s_barrier
    s_cmp_eq_u32 s28, 0
    s_cbranch_scc1 sig_3
    s_cmp_lg_u32 s3, 0
    s_cbranch_scc1 sig_3
    s_and_b32 s57, s28, 3
    v_mov_b32 v24, s57
    s_bfe_u32 s57, s28, 0x20002
    v_mov_b32 v25, s57
    s_andn2_b32 s28, s28, 15
    s_mov_b64 exec, 1
    buffer_atomic_add_x2 v[24:25], v17, s[4:7], s28 offen sc1
    s_mov_b64 exec, -1
sig_3:
    s_mov_b32 s28, 0
    v_mfma_f32_16x16x32_bf16 v[128:131], v[112:115], v[80:83], v[128:131]
    ds_read_b64_tr_b16 v[64:65], v8 offset:16384
    v_mfma_f32_16x16x32_bf16 v[132:135], v[116:119], v[80:83], v[132:135]
    ds_read_b64_tr_b16 v[66:67], v9 offset:16384
    v_mfma_f32_16x16x32_bf16 v[136:139], v[120:123], v[80:83], v[136:139]
    ds_read_b64_tr_b16 v[68:69], v10 offset:16384
    v_mfma_f32_16x16x32_bf16 v[140:143], v[124:127], v[80:83], v[140:143]
    ds_read_b64_tr_b16 v[70:71], v11 offset:16384
    v_mfma_f32_16x16x32_bf16 v[144:147], v[112:115], v[84:87], v[144:147]
    ds_read_b64_tr_b16 v[72:73], v8 offset:24576
    v_mfma_f32_16x16x32_bf16 v[148:151], v[116:119], v[84:87], v[148:151]
    ds_read_b64_tr_b16 v[74:75], v9 offset:24576
    v_mfma_f32_16x16x32_bf16 v[152:155], v[120:123], v[84:87], v[152:155]
    ds_read_b64_tr_b16 v[76:77], v10 offset:24576
    v_mfma_f32_16x16x32_bf16 v[156:159], v[124:127], v[84:87], v[156:159]
    ds_read_b64_tr_b16 v[78:79], v11 offset:24576
    v_mfma_f32_16x16x32_bf16 v[160:163], v[112:115], v[88:91], v[160:163]
    ds_read_b128 v[32:35], v5 offset:0
    v_mfma_f32_16x16x32_bf16 v[164:167], v[116:119], v[88:91], v[164:167]
    ds_read_b128 v[36:39], v5 offset:1024
    v_mfma_f32_16x16x32_bf16 v[168:171], v[120:123], v[88:91], v[168:171]
    ds_read_b128 v[40:43], v5 offset:2048
    v_mfma_f32_16x16x32_bf16 v[172:175], v[124:127], v[88:91], v[172:175]
    ds_read_b128 v[44:47], v5 offset:3072
    v_mfma_f32_16x16x32_bf16 v[176:179], v[112:115], v[92:95], v[176:179]
    ds_read_b128 v[48:51], v5 offset:4096
    v_mfma_f32_16x16x32_bf16 v[180:183], v[116:119], v[92:95], v[180:183]
    ds_read_b128 v[52:55], v5 offset:5120
    v_mfma_f32_16x16x32_bf16 v[184:187], v[120:123], v[92:95], v[184:187]
    ds_read_b128 v[56:59], v5 offset:6144
    v_mfma_f32_16x16x32_bf16 v[188:191], v[124:127], v[92:95], v[188:191]
    ds_read_b128 v[60:63], v5 offset:7168
    v_mfma_f32_16x16x32_bf16 v[192:195], v[112:115], v[96:99], v[192:195]
    v_mfma_f32_16x16x32_bf16 v[196:199], v[116:119], v[96:99], v[196:199]
    s_add_u32 m0, s21, 98304
    s_nop 0
    buffer_load_dwordx4 v1, s[4:7], s16 offen sc1 lds
    s_add_u32 s16, s16, s62
    v_mfma_f32_16x16x32_bf16 v[200:203], v[120:123], v[96:99], v[200:203]
    v_mfma_f32_16x16x32_bf16 v[204:207], v[124:127], v[96:99], v[204:207]
    v_mfma_f32_16x16x32_bf16 v[208:211], v[112:115], v[100:103], v[208:211]
    s_add_u32 m0, s21, 99328
    s_nop 0
    buffer_load_dwordx4 v1, s[4:7], s17 offen sc1 lds
    s_add_u32 s17, s17, s62
    v_mfma_f32_16x16x32_bf16 v[212:215], v[116:119], v[100:103], v[212:215]
    v_mfma_f32_16x16x32_bf16 v[216:219], v[120:123], v[100:103], v[216:219]
    v_mfma_f32_16x16x32_bf16 v[220:223], v[124:127], v[100:103], v[220:223]
    s_add_u32 m0, s22, 98304
    s_nop 0
    buffer_load_dwordx4 v2, s[8:11], s18 offen lds
    s_add_u32 s18, s18, s20
    v_mfma_f32_16x16x32_bf16 v[224:227], v[112:115], v[104:107], v[224:227]
    v_mfma_f32_16x16x32_bf16 v[228:231], v[116:119], v[104:107], v[228:231]
    v_mfma_f32_16x16x32_bf16 v[232:235], v[120:123], v[104:107], v[232:235]
    s_add_u32 m0, s22, 106496
    s_nop 0
    buffer_load_dwordx4 v2, s[12:15], s19 offen lds
    s_add_u32 s19, s19, s20
    v_mfma_f32_16x16x32_bf16 v[236:239], v[124:127], v[104:107], v[236:239]
    v_mfma_f32_16x16x32_bf16 v[240:243], v[112:115], v[108:111], v[240:243]
    v_mfma_f32_16x16x32_bf16 v[244:247], v[116:119], v[108:111], v[244:247]
    v_mfma_f32_16x16x32_bf16 v[248:251], v[120:123], v[108:111], v[248:251]
    v_mfma_f32_16x16x32_bf16 v[252:255], v[124:127], v[108:111], v[252:255]
    s_waitcnt lgkmcnt(0)
    s_branch w_loop_chk
w_first16:
    s_waitcnt vmcnt(24)
    s_barrier
    v_mfma_f32_16x16x32_bf16 v[128:131], v[64:67], v[32:35], 0
    ds_read_b64_tr_b16 v[112:113], v8 offset:49152
    v_mfma_f32_16x16x32_bf16 v[132:135], v[68:71], v[32:35], 0
    ds_read_b64_tr_b16 v[114:115], v9 offset:49152
    v_mfma_f32_16x16x32_bf16 v[136:139], v[72:75], v[32:35], 0
    ds_read_b64_tr_b16 v[116:117], v10 offset:49152
    v_mfma_f32_16x16x32_bf16 v[140:143], v[76:79], v[32:35], 0
    ds_read_b64_tr_b16 v[118:119], v11 offset:49152
    v_mfma_f32_16x16x32_bf16 v[144:147], v[64:67], v[36:39], 0
    ds_read_b64_tr_b16 v[120:121], v8 offset:57344
    v_mfma_f32_16x16x32_bf16 v[148:151], v[68:71], v[36:39], 0
    ds_read_b64_tr_b16 v[122:123], v9 offset:57344
    v_mfma_f32_16x16x32_bf16 v[152:155], v[72:75], v[36:39], 0
    ds_read_b64_tr_b16 v[124:125], v10 offset:57344
    v_mfma_f32_16x16x32_bf16 v[156:159], v[76:79], v[36:39], 0
    ds_read_b64_tr_b16 v[126:127], v11 offset:57344
    v_mfma_f32_16x16x32_bf16 v[160:163], v[64:67], v[40:43], 0
    ds_read_b128 v[80:83], v5 offset:32768
    v_mfma_f32_16x16x32_bf16 v[164:167], v[68:71], v[40:43], 0
    ds_read_b128 v[84:87], v5 offset:33792
    v_mfma_f32_16x16x32_bf16 v[168:171], v[72:75], v[40:43], 0
    ds_read_b128 v[88:91], v5 offset:34816
    v_mfma_f32_16x16x32_bf16 v[172:175], v[76:79], v[40:43], 0
    ds_read_b128 v[92:95], v5 offset:35840
    v_mfma_f32_16x16x32_bf16 v[176:179], v[64:67], v[44:47], 0
    ds_read_b128 v[96:99], v5 offset:36864
    v_mfma_f32_16x16x32_bf16 v[180:183], v[68:71], v[44:47], 0
    ds_read_b128 v[100:103], v5 offset:37888
    v_mfma_f32_16x16x32_bf16 v[184:187], v[72:75], v[44:47], 0
    ds_read_b128 v[104:107], v5 offset:38912
    v_mfma_f32_16x16x32_bf16 v[188:191], v[76:79], v[44:47], 0
    ds_read_b128 v[108:111], v5 offset:39936
    v_mfma_f32_16x16x32_bf16 v[192:195], v[64:67], v[48:51], 0
    v_mfma_f32_16x16x32_bf16 v[196:199], v[68:71], v[48:51], 0
    s_add_u32 m0, s21, 0
    s_nop 0
    buffer_load_dwordx4 v1, s[4:7], s16 offen sc1 lds
    s_add_u32 s16, s16, s62
    v_mfma_f32_16x16x32_bf16 v[200:203], v[72:75], v[48:51], 0
    v_mfma_f32_16x16x32_bf16 v[204:207], v[76:79], v[48:51], 0
    v_mfma_f32_16x16x32_bf16 v[208:211], v[64:67], v[52:55], 0
    s_add_u32 m0, s21, 1024
    s_nop 0
    buffer_load_dwordx4 v1, s[4:7], s17 offen sc1 lds
    s_add_u32 s17, s17, s62
    v_mfma_f32_16x16x32_bf16 v[212:215], v[68:71], v[52:55], 0
    v_mfma_f32_16x16x32_bf16 v[216:219], v[72:75], v[52:55], 0
    v_mfma_f32_16x16x32_bf16 v[220:223], v[76:79], v[52:55], 0
    s_add_u32 m0, s22, 0
    s_nop 0
    buffer_load_dwordx4 v2, s[8:11], s18 offen lds
    s_add_u32 s18, s18, s20
    v_mfma_f32_16x16x32_bf16 v[224:227], v[64:67], v[56:59], 0
    v_mfma_f32_16x16x32_bf16 v[228:231], v[68:71], v[56:59], 0
    v_mfma_f32_16x16x32_bf16 v[232:235], v[72:75], v[56:59], 0
    s_add_u32 m0, s22, 8192
    s_nop 0
    buffer_load_dwordx4 v2, s[12:15], s19 offen lds
    s_add_u32 s19, s19, s20
    v_mfma_f32_16x16x32_bf16 v[236:239], v[76:79], v[56:59], 0
    v_mfma_f32_16x16x32_bf16 v[240:243], v[64:67], v[60:63], 0
    v_mfma_f32_16x16x32_bf16 v[244:247], v[68:71], v[60:63], 0
    v_mfma_f32_16x16x32_bf16 v[248:251], v[72:75], v[60:63], 0
    v_mfma_f32_16x16x32_bf16 v[252:255], v[76:79], v[60:63], 0
    s_waitcnt lgkmcnt(0)
    s_waitcnt vmcnt(24)
    s_barrier
    v_mfma_f32_16x16x32_bf16 v[128:131], v[112:115], v[80:83], v[128:131]
    ds_read_b64_tr_b16 v[64:65], v12 offset:16384
    v_mfma_f32_16x16x32_bf16 v[132:135], v[116:119], v[80:83], v[132:135]
    ds_read_b64_tr_b16 v[66:67], v13 offset:16384
    v_mfma_f32_16x16x32_bf16 v[136:139], v[120:123], v[80:83], v[136:139]
    ds_read_b64_tr_b16 v[68:69], v14 offset:16384
    v_mfma_f32_16x16x32_bf16 v[140:143], v[124:127], v[80:83], v[140:143]
    ds_read_b64_tr_b16 v[70:71], v15 offset:16384
    v_mfma_f32_16x16x32_bf16 v[144:147], v[112:115], v[84:87], v[144:147]
    ds_read_b64_tr_b16 v[72:73], v12 offset:24576
    v_mfma_f32_16x16x32_bf16 v[148:151], v[116:119], v[84:87], v[148:151]
    ds_read_b64_tr_b16 v[74:75], v13 offset:24576
    v_mfma_f32_16x16x32_bf16 v[152:155], v[120:123], v[84:87], v[152:155]
    ds_read_b64_tr_b16 v[76:77], v14 offset:24576
    v_mfma_f32_16x16x32_bf16 v[156:159], v[124:127], v[84:87], v[156:159]
    ds_read_b64_tr_b16 v[78:79], v15 offset:24576
    v_mfma_f32_16x16x32_bf16 v[160:163], v[112:115], v[88:91], v[160:163]
    ds_read_b128 v[32:35], v6 offset:0
    v_mfma_f32_16x16x32_bf16 v[164:167], v[116:119], v[88:91], v[164:167]
    ds_read_b128 v[36:39], v6 offset:1024
    v_mfma_f32_16x16x32_bf16 v[168:171], v[120:123], v[88:91], v[168:171]
    ds_read_b128 v[40:43], v6 offset:2048
    v_mfma_f32_16x16x32_bf16 v[172:175], v[124:127], v[88:91], v[172:175]
    ds_read_b128 v[44:47], v6 offset:3072
    v_mfma_f32_16x16x32_bf16 v[176:179], v[112:115], v[92:95], v[176:179]
    ds_read_b128 v[48:51], v6 offset:4096
    v_mfma_f32_16x16x32_bf16 v[180:183], v[116:119], v[92:95], v[180:183]
    ds_read_b128 v[52:55], v6 offset:5120
    v_mfma_f32_16x16x32_bf16 v[184:187], v[120:123], v[92:95], v[184:187]
    ds_read_b128 v[56:59], v6 offset:6144
    v_mfma_f32_16x16x32_bf16 v[188:191], v[124:127], v[92:95], v[188:191]
    ds_read_b128 v[60:63], v6 offset:7168
    v_mfma_f32_16x16x32_bf16 v[192:195], v[112:115], v[96:99], v[192:195]
    v_mfma_f32_16x16x32_bf16 v[196:199], v[116:119], v[96:99], v[196:199]
    s_add_u32 m0, s21, 32768
    s_nop 0
    buffer_load_dwordx4 v1, s[4:7], s16 offen sc1 lds
    s_add_u32 s16, s16, s62
    v_mfma_f32_16x16x32_bf16 v[200:203], v[120:123], v[96:99], v[200:203]
    v_mfma_f32_16x16x32_bf16 v[204:207], v[124:127], v[96:99], v[204:207]
    v_mfma_f32_16x16x32_bf16 v[208:211], v[112:115], v[100:103], v[208:211]
    s_add_u32 m0, s21, 33792
    s_nop 0
    buffer_load_dwordx4 v1, s[4:7], s17 offen sc1 lds
    s_add_u32 s17, s17, s62
    v_mfma_f32_16x16x32_bf16 v[212:215], v[116:119], v[100:103], v[212:215]
    v_mfma_f32_16x16x32_bf16 v[216:219], v[120:123], v[100:103], v[216:219]
    v_mfma_f32_16x16x32_bf16 v[220:223], v[124:127], v[100:103], v[220:223]
    s_add_u32 m0, s22, 32768
    s_nop 0
    buffer_load_dwordx4 v2, s[8:11], s18 offen lds
    s_add_u32 s18, s18, s20
    v_mfma_f32_16x16x32_bf16 v[224:227], v[112:115], v[104:107], v[224:227]
    v_mfma_f32_16x16x32_bf16 v[228:231], v[116:119], v[104:107], v[228:231]
    v_mfma_f32_16x16x32_bf16 v[232:235], v[120:123], v[104:107], v[232:235]
    s_add_u32 m0, s22, 40960
    s_nop 0
    buffer_load_dwordx4 v2, s[12:15], s19 offen lds
    s_add_u32 s19, s19, s20
    v_mfma_f32_16x16x32_bf16 v[236:239], v[124:127], v[104:107], v[236:239]
    v_mfma_f32_16x16x32_bf16 v[240:243], v[112:115], v[108:111], v[240:243]
    v_mfma_f32_16x16x32_bf16 v[244:247], v[116:119], v[108:111], v[244:247]
    v_mfma_f32_16x16x32_bf16 v[248:251], v[120:123], v[108:111], v[248:251]
    v_mfma_f32_16x16x32_bf16 v[252:255], v[124:127], v[108:111], v[252:255]
    s_waitcnt lgkmcnt(0)
    s_waitcnt vmcnt(24)
    s_barrier
    v_mfma_f32_16x16x32_bf16 v[128:131], v[64:67], v[32:35], v[128:131]
    ds_read_b64_tr_b16 v[112:113], v12 offset:49152
    v_mfma_f32_16x16x32_bf16 v[132:135], v[68:71], v[32:35], v[132:135]
    ds_read_b64_tr_b16 v[114:115], v13 offset:49152
    v_mfma_f32_16x16x32_bf16 v[136:139], v[72:75], v[32:35], v[136:139]
    ds_read_b64_tr_b16 v[116:117], v14 offset:49152
    v_mfma_f32_16x16x32_bf16 v[140:143], v[76:79], v[32:35], v[140:143]
    ds_read_b64_tr_b16 v[118:119], v15 offset:49152
    v_mfma_f32_16x16x32_bf16 v[144:147], v[64:67], v[36:39], v[144:147]
    ds_read_b64_tr_b16 v[120:121], v12 offset:57344
    v_mfma_f32_16x16x32_bf16 v[148:151], v[68:71], v[36:39], v[148:151]
    ds_read_b64_tr_b16 v[122:123], v13 offset:57344
    v_mfma_f32_16x16x32_bf16 v[152:155], v[72:75], v[36:39], v[152:155]
    ds_read_b64_tr_b16 v[124:125], v14 offset:57344
    v_mfma_f32_16x16x32_bf16 v[156:159], v[76:79], v[36:39], v[156:159]
    ds_read_b64_tr_b16 v[126:127], v15 offset:57344
    v_mfma_f32_16x16x32_bf16 v[160:163], v[64:67], v[40:43], v[160:163]
    ds_read_b128 v[80:83], v6 offset:32768
    v_mfma_f32_16x16x32_bf16 v[164:167], v[68:71], v[40:43], v[164:167]
    ds_read_b128 v[84:87], v6 offset:33792
    v_mfma_f32_16x16x32_bf16 v[168:171], v[72:75], v[40:43], v[168:171]
    ds_read_b128 v[88:91], v6 offset:34816
    v_mfma_f32_16x16x32_bf16 v[172:175], v[76:79], v[40:43], v[172:175]
    ds_read_b128 v[92:95], v6 offset:35840
    v_mfma_f32_16x16x32_bf16 v[176:179], v[64:67], v[44:47], v[176:179]
    ds_read_b128 v[96:99], v6 offset:36864
    v_mfma_f32_16x16x32_bf16 v[180:183], v[68:71], v[44:47], v[180:183]
    ds_read_b128 v[100:103], v6 offset:37888
    v_mfma_f32_16x16x32_bf16 v[184:187], v[72:75], v[44:47], v[184:187]
    ds_read_b128 v[104:107], v6 offset:38912
    v_mfma_f32_16x16x32_bf16 v[188:191], v[76:79], v[44:47], v[188:191]
    ds_read_b128 v[108:111], v6 offset:39936
    v_mfma_f32_16x16x32_bf16 v[192:195], v[64:67], v[48:51], v[192:195]
    v_mfma_f32_16x16x32_bf16 v[196:199], v[68:71], v[48:51], v[196:199]
    s_add_u32 m0, s21, 65536
    s_nop 0
    buffer_load_dwordx4 v1, s[4:7], s16 offen sc1 lds
    s_add_u32 s16, s16, s62
    v_mfma_f32_16x16x32_bf16 v[200:203], v[72:75], v[48:51], v[200:203]
    v_mfma_f32_16x16x32_bf16 v[204:207], v[76:79], v[48:51], v[204:207]
    v_mfma_f32_16x16x32_bf16 v[208:211], v[64:67], v[52:55], v[208:211]
    s_add_u32 m0, s21, 66560
    s_nop 0
    buffer_load_dwordx4 v1, s[4:7], s17 offen sc1 lds
    s_add_u32 s17, s17, s62
    v_mfma_f32_16x16x32_bf16 v[212:215], v[68:71], v[52:55], v[212:215]
    v_mfma_f32_16x16x32_bf16 v[216:219], v[72:75], v[52:55], v[216:219]
    v_mfma_f32_16x16x32_bf16 v[220:223], v[76:79], v[52:55], v[220:223]
    s_add_u32 m0, s22, 65536
    s_nop 0
    buffer_load_dwordx4 v2, s[8:11], s18 offen lds
    s_add_u32 s18, s18, s20
    v_mfma_f32_16x16x32_bf16 v[224:227], v[64:67], v[56:59], v[224:227]
    v_mfma_f32_16x16x32_bf16 v[228:231], v[68:71], v[56:59], v[228:231]
    v_mfma_f32_16x16x32_bf16 v[232:235], v[72:75], v[56:59], v[232:235]
    s_add_u32 m0, s22, 73728
    s_nop 0
    buffer_load_dwordx4 v2, s[12:15], s19 offen lds
    s_add_u32 s19, s19, s20
    v_mfma_f32_16x16x32_bf16 v[236:239], v[76:79], v[56:59], v[236:239]
    v_mfma_f32_16x16x32_bf16 v[240:243], v[64:67], v[60:63], v[240:243]
    v_mfma_f32_16x16x32_bf16 v[244:247], v[68:71], v[60:63], v[244:247]
    v_mfma_f32_16x16x32_bf16 v[248:251], v[72:75], v[60:63], v[248:251]
    v_mfma_f32_16x16x32_bf16 v[252:255], v[76:79], v[60:63], v[252:255]
    s_waitcnt lgkmcnt(0)
    s_waitcnt vmcnt(8)
    s_barrier
    s_cmp_eq_u32 s28, 0
    s_cbranch_scc1 sig_4
    s_cmp_lg_u32 s3, 0
    s_cbranch_scc1 sig_4
    s_and_b32 s57, s28, 3
    v_mov_b32 v24, s57
    s_bfe_u32 s57, s28, 0x20002
    v_mov_b32 v25, s57
    s_andn2_b32 s28, s28, 15
    s_mov_b64 exec, 1
    buffer_atomic_add_x2 v[24:25], v17, s[4:7], s28 offen sc1
    s_mov_b64 exec, -1
sig_4:
    s_mov_b32 s28, 0
    v_mfma_f32_16x16x32_bf16 v[128:131], v[112:115], v[80:83], v[128:131]
    ds_read_b64_tr_b16 v[64:65], v8 offset:16384
    v_mfma_f32_16x16x32_bf16 v[132:135], v[116:119], v[80:83], v[132:135]
    ds_read_b64_tr_b16 v[66:67], v9 offset:16384
    v_mfma_f32_16x16x32_bf16 v[136:139], v[120:123], v[80:83], v[136:139]
    ds_read_b64_tr_b16 v[68:69], v10 offset:16384
    v_mfma_f32_16x16x32_bf16 v[140:143], v[124:127], v[80:83], v[140:143]
    ds_read_b64_tr_b16 v[70:71], v11 offset:16384
    v_mfma_f32_16x16x32_bf16 v[144:147], v[112:115], v[84:87], v[144:147]
    ds_read_b64_tr_b16 v[72:73], v8 offset:24576
    v_mfma_f32_16x16x32_bf16 v[148:151], v[116:119], v[84:87], v[148:151]
    ds_read_b64_tr_b16 v[74:75], v9 offset:24576
    v_mfma_f32_16x16x32_bf16 v[152:155], v[120:123], v[84:87], v[152:155]
    ds_read_b64_tr_b16 v[76:77], v10 offset:24576
    v_mfma_f32_16x16x32_bf16 v[156:159], v[124:127], v[84:87], v[156:159]
    ds_read_b64_tr_b16 v[78:79], v11 offset:24576
    v_mfma_f32_16x16x32_bf16 v[160:163], v[112:115], v[88:91], v[160:163]
    ds_read_b128 v[32:35], v5 offset:0
    v_mfma_f32_16x16x32_bf16 v[164:167], v[116:119], v[88:91], v[164:167]
    ds_read_b128 v[36:39], v5 offset:1024
    v_mfma_f32_16x16x32_bf16 v[168:171], v[120:123], v[88:91], v[168:171]
    ds_read_b128 v[40:43], v5 offset:2048
    v_mfma_f32_16x16x32_bf16 v[172:175], v[124:127], v[88:91], v[172:175]
    ds_read_b128 v[44:47], v5 offset:3072
    v_mfma_f32_16x16x32_bf16 v[176:179], v[112:115], v[92:95], v[176:179]
    ds_read_b128 v[48:51], v5 offset:4096
    v_mfma_f32_16x16x32_bf16 v[180:183], v[116:119], v[92:95], v[180:183]
    ds_read_b128 v[52:55], v5 offset:5120
    v_mfma_f32_16x16x32_bf16 v[184:187], v[120:123], v[92:95], v[184:187]
    ds_read_b128 v[56:59], v5 offset:6144
    v_mfma_f32_16x16x32_bf16 v[188:191], v[124:127], v[92:95], v[188:191]
    ds_read_b128 v[60:63], v5 offset:7168
    v_mfma_f32_16x16x32_bf16 v[192:195], v[112:115], v[96:99], v[192:195]
    v_mfma_f32_16x16x32_bf16 v[196:199], v[116:119], v[96:99], v[196:199]
    s_add_u32 m0, s21, 98304
    s_nop 0
    buffer_load_dwordx4 v1, s[4:7], s16 offen sc1 lds
    s_add_u32 s16, s16, s62
    v_mfma_f32_16x16x32_bf16 v[200:203], v[120:123], v[96:99], v[200:203]
    v_mfma_f32_16x16x32_bf16 v[204:207], v[124:127], v[96:99], v[204:207]
    v_mfma_f32_16x16x32_bf16 v[208:211], v[112:115], v[100:103], v[208:211]
    s_add_u32 m0, s21, 99328
    s_nop 0
    buffer_load_dwordx4 v1, s[4:7], s17 offen sc1 lds
    s_add_u32 s17, s17, s62
    v_mfma_f32_16x16x32_bf16 v[212:215], v[116:119], v[100:103], v[212:215]
    v_mfma_f32_16x16x32_bf16 v[216:219], v[120:123], v[100:103], v[216:219]
    v_mfma_f32_16x16x32_bf16 v[220:223], v[124:127], v[100:103], v[220:223]
    s_add_u32 m0, s22, 98304
    s_nop 0
    buffer_load_dwordx4 v2, s[8:11], s18 offen lds
    s_add_u32 s18, s18, s20
    v_mfma_f32_16x16x32_bf16 v[224:227], v[112:115], v[104:107], v[224:227]
    v_mfma_f32_16x16x32_bf16 v[228:231], v[116:119], v[104:107], v[228:231]
    v_mfma_f32_16x16x32_bf16 v[232:235], v[120:123], v[104:107], v[232:235]
    s_add_u32 m0, s22, 106496
    s_nop 0
    buffer_load_dwordx4 v2, s[12:15], s19 offen lds
    s_add_u32 s19, s19, s20
    v_mfma_f32_16x16x32_bf16 v[236:239], v[124:127], v[104:107], v[236:239]
    v_mfma_f32_16x16x32_bf16 v[240:243], v[112:115], v[108:111], v[240:243]
    v_mfma_f32_16x16x32_bf16 v[244:247], v[116:119], v[108:111], v[244:247]
    v_mfma_f32_16x16x32_bf16 v[248:251], v[120:123], v[108:111], v[248:251]
    v_mfma_f32_16x16x32_bf16 v[252:255], v[124:127], v[108:111], v[252:255]
    s_waitcnt lgkmcnt(0)
w_loop_chk:
    s_sub_u32 s23, s23, 1
w_loop:
    s_cmp_lg_u32 s23, 1
    s_cbranch_scc1 w_body
    v_readfirstlane_b32 s30, v16
    s_cmp_ge_u32 s30, s45
    s_cselect_b32 s30, 0, 1
    s_or_b32 s30, s30, s70
    s_cmp_eq_u32 s32, 4
    s_cselect_b32 s30, 1, s30
    s_sub_u32 s57, s32, 1
    s_cmp_ge_u32 s57, 4
    s_cselect_b32 s30, 1, s30
    v_mov_b32 v20, s30
    ds_write_b32 v7, v20
    s_cbranch_scc1 w_body
    s_load_dwordx2 s[8:9], s[0:1], s33
    s_load_dwordx2 s[12:13], s[0:1], s34
    s_mov_b32 s10, s38
    s_mov_b32 s14, s38
    s_cmp_eq_u32 s32, 4
    s_cselect_b32 s31, 0, 1
    s_lshl_b32 s30, s3, s31
    s_mul_i32 s30, s30, s40
    s_add_u32 s16, s39, s30
    s_cmp_eq_u32 s32, 4
    s_cselect_b32 s30, 1024, s40
    s_cselect_b32 s31, 6, 5
    s_lshl_b32 s62, 32, s31
    s_add_u32 s17, s16, s30
    s_lshl_b32 s30, s3, 2
    s_mul_i32 s30, s30, s35
    s_add_u32 s18, s36, s30
    s_add_u32 s19, s37, s30
    s_lshl_b32 s20, s35, s31
    v_mul_u32_u24 v2, s35, v4
    v_add_u32 v2, v2, v3
    s_waitcnt lgkmcnt(0)
w_body:
    s_waitcnt vmcnt(8)
    s_barrier
    v_mfma_f32_16x16x32_bf16 v[128:131], v[64:67], v[32:35], v[128:131]
    ds_read_b64_tr_b16 v[112:113], v8 offset:49152
    v_mfma_f32_16x16x32_bf16 v[132:135], v[68:71], v[32:35], v[132:135]
    ds_read_b64_tr_b16 v[114:115], v9 offset:49152
    v_mfma_f32_16x16x32_bf16 v[136:139], v[72:75], v[32:35], v[136:139]
    ds_read_b64_tr_b16 v[116:117], v10 offset:49152
    v_mfma_f32_16x16x32_bf16 v[140:143], v[76:79], v[32:35], v[140:143]
    ds_read_b64_tr_b16 v[118:119], v11 offset:49152
    v_mfma_f32_16x16x32_bf16 v[144:147], v[64:67], v[36:39], v[144:147]
    ds_read_b64_tr_b16 v[120:121], v8 offset:57344
    v_mfma_f32_16x16x32_bf16 v[148:151], v[68:71], v[36:39], v[148:151]
    ds_read_b64_tr_b16 v[122:123], v9 offset:57344
    v_mfma_f32_16x16x32_bf16 v[152:155], v[72:75], v[36:39], v[152:155]
    ds_read_b64_tr_b16 v[124:125], v10 offset:57344
    v_mfma_f32_16x16x32_bf16 v[156:159], v[76:79], v[36:39], v[156:159]
    ds_read_b64_tr_b16 v[126:127], v11 offset:57344
    v_mfma_f32_16x16x32_bf16 v[160:163], v[64:67], v[40:43], v[160:163]
    ds_read_b128 v[80:83], v5 offset:32768
    v_mfma_f32_16x16x32_bf16 v[164:167], v[68:71], v[40:43], v[164:167]
    ds_read_b128 v[84:87], v5 offset:33792
    v_mfma_f32_16x16x32_bf16 v[168:171], v[72:75], v[40:43], v[168:171]
    ds_read_b128 v[88:91], v5 offset:34816
    v_mfma_f32_16x16x32_bf16 v[172:175], v[76:79], v[40:43], v[172:175]
    ds_read_b128 v[92:95], v5 offset:35840
    v_mfma_f32_16x16x32_bf16 v[176:179], v[64:67], v[44:47], v[176:179]
    ds_read_b128 v[96:99], v5 offset:36864
    v_mfma_f32_16x16x32_bf16 v[180:183], v[68:71], v[44:47], v[180:183]
    ds_read_b128 v[100:103], v5 offset:37888
    v_mfma_f32_16x16x32_bf16 v[184:187], v[72:75], v[44:47], v[184:187]
    ds_read_b128 v[104:107], v5 offset:38912
    v_mfma_f32_16x16x32_bf16 v[188:191], v[76:79], v[44:47], v[188:191]
    ds_read_b128 v[108:111], v5 offset:39936
    v_mfma_f32_16x16x32_bf16 v[192:195], v[64:67], v[48:51], v[192:195]
    v_mfma_f32_16x16x32_bf16 v[196:199], v[68:71], v[48:51], v[196:199]
    s_add_u32 m0, s21, 0
    s_nop 0
    buffer_load_dwordx4 v1, s[4:7], s16 offen sc1 lds
    s_add_u32 s16, s16, s62
    v_mfma_f32_16x16x32_bf16 v[200:203], v[72:75], v[48:51], v[200:203]
    v_mfma_f32_16x16x32_bf16 v[204:207], v[76:79], v[48:51], v[204:207]
    v_mfma_f32_16x16x32_bf16 v[208:211], v[64:67], v[52:55], v[208:211]
    s_add_u32 m0, s21, 1024
    s_nop 0
    buffer_load_dwordx4 v1, s[4:7], s17 offen sc1 lds
    s_add_u32 s17, s17, s62
    v_mfma_f32_16x16x32_bf16 v[212:215], v[68:71], v[52:55], v[212:215]
    v_mfma_f32_16x16x32_bf16 v[216:219], v[72:75], v[52:55], v[216:219]
    v_mfma_f32_16x16x32_bf16 v[220:223], v[76:79], v[52:55], v[220:223]
    s_add_u32 m0, s22, 0
    s_nop 0
    buffer_load_dwordx4 v2, s[8:11], s18 offen lds
    s_add_u32 s18, s18, s20
    v_mfma_f32_16x16x32_bf16 v[224:227], v[64:67], v[56:59], v[224:227]
    v_mfma_f32_16x16x32_bf16 v[228:231], v[68:71], v[56:59], v[228:231]
    v_mfma_f32_16x16x32_bf16 v[232:235], v[72:75], v[56:59], v[232:235]
    s_add_u32 m0, s22, 8192
    s_nop 0
    buffer_load_dwordx4 v2, s[12:15], s19 offen lds
    s_add_u32 s19, s19, s20
    v_mfma_f32_16x16x32_bf16 v[236:239], v[76:79], v[56:59], v[236:239]
    v_mfma_f32_16x16x32_bf16 v[240:243], v[64:67], v[60:63], v[240:243]
    v_mfma_f32_16x16x32_bf16 v[244:247], v[68:71], v[60:63], v[244:247]
    buffer_load_dword v16, v17, s[4:7], s44 offen sc1
    v_mfma_f32_16x16x32_bf16 v[248:251], v[72:75], v[60:63], v[248:251]
    v_mfma_f32_16x16x32_bf16 v[252:255], v[76:79], v[60:63], v[252:255]
    s_waitcnt lgkmcnt(0)
    s_waitcnt vmcnt(8)
    s_barrier
    v_mfma_f32_16x16x32_bf16 v[128:131], v[112:115], v[80:83], v[128:131]
    ds_read_b64_tr_b16 v[64:65], v12 offset:16384
    v_mfma_f32_16x16x32_bf16 v[132:135], v[116:119], v[80:83], v[132:135]
    ds_read_b64_tr_b16 v[66:67], v13 offset:16384
    v_mfma_f32_16x16x32_bf16 v[136:139], v[120:123], v[80:83], v[136:139]
    ds_read_b64_tr_b16 v[68:69], v14 offset:16384
    v_mfma_f32_16x16x32_bf16 v[140:143], v[124:127], v[80:83], v[140:143]
    ds_read_b64_tr_b16 v[70:71], v15 offset:16384
    v_mfma_f32_16x16x32_bf16 v[144:147], v[112:115], v[84:87], v[144:147]
    ds_read_b64_tr_b16 v[72:73], v12 offset:24576
    v_mfma_f32_16x16x32_bf16 v[148:151], v[116:119], v[84:87], v[148:151]
    ds_read_b64_tr_b16 v[74:75], v13 offset:24576
    v_mfma_f32_16x16x32_bf16 v[152:155], v[120:123], v[84:87], v[152:155]
    ds_read_b64_tr_b16 v[76:77], v14 offset:24576
    v_mfma_f32_16x16x32_bf16 v[156:159], v[124:127], v[84:87], v[156:159]
    ds_read_b64_tr_b16 v[78:79], v15 offset:24576
    v_mfma_f32_16x16x32_bf16 v[160:163], v[112:115], v[88:91], v[160:163]
    ds_read_b128 v[32:35], v6 offset:0
    v_mfma_f32_16x16x32_bf16 v[164:167], v[116:119], v[88:91], v[164:167]
    ds_read_b128 v[36:39], v6 offset:1024
    v_mfma_f32_16x16x32_bf16 v[168:171], v[120:123], v[88:91], v[168:171]
    ds_read_b128 v[40:43], v6 offset:2048
    v_mfma_f32_16x16x32_bf16 v[172:175], v[124:127], v[88:91], v[172:175]
    ds_read_b128 v[44:47], v6 offset:3072
    v_mfma_f32_16x16x32_bf16 v[176:179], v[112:115], v[92:95], v[176:179]
    ds_read_b128 v[48:51], v6 offset:4096
    v_mfma_f32_16x16x32_bf16 v[180:183], v[116:119], v[92:95], v[180:183]
    ds_read_b128 v[52:55], v6 offset:5120
    v_mfma_f32_16x16x32_bf16 v[184:187], v[120:123], v[92:95], v[184:187]
    ds_read_b128 v[56:59], v6 offset:6144
    v_mfma_f32_16x16x32_bf16 v[188:191], v[124:127], v[92:95], v[188:191]
    ds_read_b128 v[60:63], v6 offset:7168
    v_mfma_f32_16x16x32_bf16 v[192:195], v[112:115], v[96:99], v[192:195]
    v_mfma_f32_16x16x32_bf16 v[196:199], v[116:119], v[96:99], v[196:199]
    s_add_u32 m0, s21, 32768
    s_nop 0
    buffer_load_dwordx4 v1, s[4:7], s16 offen sc1 lds
    s_add_u32 s16, s16, s62
    v_mfma_f32_16x16x32_bf16 v[200:203], v[120:123], v[96:99], v[200:203]
    v_mfma_f32_16x16x32_bf16 v[204:207], v[124:127], v[96:99], v[204:207]
    v_mfma_f32_16x16x32_bf16 v[208:211], v[112:115], v[100:103], v[208:211]
    s_add_u32 m0, s21, 33792
    s_nop 0
    buffer_load_dwordx4 v1, s[4:7], s17 offen sc1 lds
    s_add_u32 s17, s17, s62
    v_mfma_f32_16x16x32_bf16 v[212:215], v[116:119], v[100:103], v[212:215]
    v_mfma_f32_16x16x32_bf16 v[216:219], v[120:123], v[100:103], v[216:219]
    v_mfma_f32_16x16x32_bf16 v[220:223], v[124:127], v[100:103], v[220:223]
    s_add_u32 m0, s22, 32768
    s_nop 0
    buffer_load_dwordx4 v2, s[8:11], s18 offen lds
    s_add_u32 s18, s18, s20
    v_mfma_f32_16x16x32_bf16 v[224:227], v[112:115], v[104:107], v[224:227]
    v_mfma_f32_16x16x32_bf16 v[228:231], v[116:119], v[104:107], v[228:231]
    v_mfma_f32_16x16x32_bf16 v[232:235], v[120:123], v[104:107], v[232:235]
    s_add_u32 m0, s22, 40960
    s_nop 0
    buffer_load_dwordx4 v2, s[12:15], s19 offen lds
    s_add_u32 s19, s19, s20
    v_mfma_f32_16x16x32_bf16 v[236:239], v[124:127], v[104:107], v[236:239]
    v_mfma_f32_16x16x32_bf16 v[240:243], v[112:115], v[108:111], v[240:243]
    v_mfma_f32_16x16x32_bf16 v[244:247], v[116:119], v[108:111], v[244:247]
    v_mfma_f32_16x16x32_bf16 v[248:251], v[120:123], v[108:111], v[248:251]
    v_mfma_f32_16x16x32_bf16 v[252:255], v[124:127], v[108:111], v[252:255]
    s_waitcnt lgkmcnt(0)
    s_waitcnt vmcnt(8)
    s_barrier
    v_mfma_f32_16x16x32_bf16 v[128:131], v[64:67], v[32:35], v[128:131]
    ds_read_b64_tr_b16 v[112:113], v12 offset:49152
    v_mfma_f32_16x16x32_bf16 v[132:135], v[68:71], v[32:35], v[132:135]
    ds_read_b64_tr_b16 v[114:115], v13 offset:49152
    v_mfma_f32_16x16x32_bf16 v[136:139], v[72:75], v[32:35], v[136:139]
    ds_read_b64_tr_b16 v[116:117], v14 offset:49152
    v_mfma_f32_16x16x32_bf16 v[140:143], v[76:79], v[32:35], v[140:143]
    ds_read_b64_tr_b16 v[118:119], v15 offset:49152
    v_mfma_f32_16x16x32_bf16 v[144:147], v[64:67], v[36:39], v[144:147]
    ds_read_b64_tr_b16 v[120:121], v12 offset:57344
    v_mfma_f32_16x16x32_bf16 v[148:151], v[68:71], v[36:39], v[148:151]
    ds_read_b64_tr_b16 v[122:123], v13 offset:57344
    v_mfma_f32_16x16x32_bf16 v[152:155], v[72:75], v[36:39], v[152:155]
    ds_read_b64_tr_b16 v[124:125], v14 offset:57344
    v_mfma_f32_16x16x32_bf16 v[156:159], v[76:79], v[36:39], v[156:159]
    ds_read_b64_tr_b16 v[126:127], v15 offset:57344
    v_mfma_f32_16x16x32_bf16 v[160:163], v[64:67], v[40:43], v[160:163]
    ds_read_b128 v[80:83], v6 offset:32768
    v_mfma_f32_16x16x32_bf16 v[164:167], v[68:71], v[40:43], v[164:167]
    ds_read_b128 v[84:87], v6 offset:33792
    v_mfma_f32_16x16x32_bf16 v[168:171], v[72:75], v[40:43], v[168:171]
    ds_read_b128 v[88:91], v6 offset:34816
    v_mfma_f32_16x16x32_bf16 v[172:175], v[76:79], v[40:43], v[172:175]
    ds_read_b128 v[92:95], v6 offset:35840
    v_mfma_f32_16x16x32_bf16 v[176:179], v[64:67], v[44:47], v[176:179]
    ds_read_b128 v[96:99], v6 offset:36864
    v_mfma_f32_16x16x32_bf16 v[180:183], v[68:71], v[44:47], v[180:183]
    ds_read_b128 v[100:103], v6 offset:37888
    v_mfma_f32_16x16x32_bf16 v[184:187], v[72:75], v[44:47], v[184:187]
    ds_read_b128 v[104:107], v6 offset:38912
    v_mfma_f32_16x16x32_bf16 v[188:191], v[76:79], v[44:47], v[188:191]
    ds_read_b128 v[108:111], v6 offset:39936
    v_mfma_f32_16x16x32_bf16 v[192:195], v[64:67], v[48:51], v[192:195]
    v_mfma_f32_16x16x32_bf16 v[196:199], v[68:71], v[48:51], v[196:199]
    s_add_u32 m0, s21, 65536
    s_nop 0
    buffer_load_dwordx4 v1, s[4:7], s16 offen sc1 lds
    s_add_u32 s16, s16, s62
    v_mfma_f32_16x16x32_bf16 v[200:203], v[72:75], v[48:51], v[200:203]
    v_mfma_f32_16x16x32_bf16 v[204:207], v[76:79], v[48:51], v[204:207]
    v_mfma_f32_16x16x32_bf16 v[208:211], v[64:67], v[52:55], v[208:211]
    s_add_u32 m0, s21, 66560
    s_nop 0
    buffer_load_dwordx4 v1, s[4:7], s17 offen sc1 lds
    s_add_u32 s17, s17, s62
    v_mfma_f32_16x16x32_bf16 v[212:215], v[68:71], v[52:55], v[212:215]
    v_mfma_f32_16x16x32_bf16 v[216:219], v[72:75], v[52:55], v[216:219]
    v_mfma_f32_16x16x32_bf16 v[220:223], v[76:79], v[52:55], v[220:223]
    s_add_u32 m0, s22, 65536
    s_nop 0
    buffer_load_dwordx4 v2, s[8:11], s18 offen lds
    s_add_u32 s18, s18, s20
    v_mfma_f32_16x16x32_bf16 v[224:227], v[64:67], v[56:59], v[224:227]
    v_mfma_f32_16x16x32_bf16 v[228:231], v[68:71], v[56:59], v[228:231]
    v_mfma_f32_16x16x32_bf16 v[232:235], v[72:75], v[56:59], v[232:235]
    s_add_u32 m0, s22, 73728
    s_nop 0
    buffer_load_dwordx4 v2, s[12:15], s19 offen lds
    s_add_u32 s19, s19, s20
    v_mfma_f32_16x16x32_bf16 v[236:239], v[76:79], v[56:59], v[236:239]
    v_mfma_f32_16x16x32_bf16 v[240:243], v[64:67], v[60:63], v[240:243]
    v_mfma_f32_16x16x32_bf16 v[244:247], v[68:71], v[60:63], v[244:247]
    v_mfma_f32_16x16x32_bf16 v[248:251], v[72:75], v[60:63], v[248:251]
    v_mfma_f32_16x16x32_bf16 v[252:255], v[76:79], v[60:63], v[252:255]
    s_waitcnt lgkmcnt(0)
    s_waitcnt vmcnt(8)
    s_barrier
    v_mfma_f32_16x16x32_bf16 v[128:131], v[112:115], v[80:83], v[128:131]
    ds_read_b64_tr_b16 v[64:65], v8 offset:16384
    v_mfma_f32_16x16x32_bf16 v[132:135], v[116:119], v[80:83], v[132:135]
    ds_read_b64_tr_b16 v[66:67], v9 offset:16384
    v_mfma_f32_16x16x32_bf16 v[136:139], v[120:123], v[80:83], v[136:139]
    ds_read_b64_tr_b16 v[68:69], v10 offset:16384
    v_mfma_f32_16x16x32_bf16 v[140:143], v[124:127], v[80:83], v[140:143]
    ds_read_b64_tr_b16 v[70:71], v11 offset:16384
    v_mfma_f32_16x16x32_bf16 v[144:147], v[112:115], v[84:87], v[144:147]
    ds_read_b64_tr_b16 v[72:73], v8 offset:24576
    v_mfma_f32_16x16x32_bf16 v[148:151], v[116:119], v[84:87], v[148:151]
    ds_read_b64_tr_b16 v[74:75], v9 offset:24576
    v_mfma_f32_16x16x32_bf16 v[152:155], v[120:123], v[84:87], v[152:155]
    ds_read_b64_tr_b16 v[76:77], v10 offset:24576
    v_mfma_f32_16x16x32_bf16 v[156:159], v[124:127], v[84:87], v[156:159]
    ds_read_b64_tr_b16 v[78:79], v11 offset:24576
    v_mfma_f32_16x16x32_bf16 v[160:163], v[112:115], v[88:91], v[160:163]
    ds_read_b128 v[32:35], v5 offset:0
    v_mfma_f32_16x16x32_bf16 v[164:167], v[116:119], v[88:91], v[164:167]
    ds_read_b128 v[36:39], v5 offset:1024
    v_mfma_f32_16x16x32_bf16 v[168:171], v[120:123], v[88:91], v[168:171]
    ds_read_b128 v[40:43], v5 offset:2048
    v_mfma_f32_16x16x32_bf16 v[172:175], v[124:127], v[88:91], v[172:175]
    ds_read_b128 v[44:47], v5 offset:3072
    v_mfma_f32_16x16x32_bf16 v[176:179], v[112:115], v[92:95], v[176:179]
    ds_read_b128 v[48:51], v5 offset:4096
    v_mfma_f32_16x16x32_bf16 v[180:183], v[116:119], v[92:95], v[180:183]
    ds_read_b128 v[52:55], v5 offset:5120
    v_mfma_f32_16x16x32_bf16 v[184:187], v[120:123], v[92:95], v[184:187]
    ds_read_b128 v[56:59], v5 offset:6144
    v_mfma_f32_16x16x32_bf16 v[188:191], v[124:127], v[92:95], v[188:191]
    ds_read_b128 v[60:63], v5 offset:7168
    v_mfma_f32_16x16x32_bf16 v[192:195], v[112:115], v[96:99], v[192:195]
    v_mfma_f32_16x16x32_bf16 v[196:199], v[116:119], v[96:99], v[196:199]
    s_add_u32 m0, s21, 98304
    s_nop 0
    buffer_load_dwordx4 v1, s[4:7], s16 offen sc1 lds
    s_add_u32 s16, s16, s62
    v_mfma_f32_16x16x32_bf16 v[200:203], v[120:123], v[96:99], v[200:203]
    v_mfma_f32_16x16x32_bf16 v[204:207], v[124:127], v[96:99], v[204:207]
    v_mfma_f32_16x16x32_bf16 v[208:211], v[112:115], v[100:103], v[208:211]
    s_add_u32 m0, s21, 99328
    s_nop 0
    buffer_load_dwordx4 v1, s[4:7], s17 offen sc1 lds
    s_add_u32 s17, s17, s62
    v_mfma_f32_16x16x32_bf16 v[212:215], v[116:119], v[100:103], v[212:215]
    v_mfma_f32_16x16x32_bf16 v[216:219], v[120:123], v[100:103], v[216:219]
    v_mfma_f32_16x16x32_bf16 v[220:223], v[124:127], v[100:103], v[220:223]
    s_add_u32 m0, s22, 98304
    s_nop 0
    buffer_load_dwordx4 v2, s[8:11], s18 offen lds
    s_add_u32 s18, s18, s20
    v_mfma_f32_16x16x32_bf16 v[224:227], v[112:115], v[104:107], v[224:227]
    v_mfma_f32_16x16x32_bf16 v[228:231], v[116:119], v[104:107], v[228:231]
    v_mfma_f32_16x16x32_bf16 v[232:235], v[120:123], v[104:107], v[232:235]
    s_add_u32 m0, s22, 106496
    s_nop 0
    buffer_load_dwordx4 v2, s[12:15], s19 offen lds
    s_add_u32 s19, s19, s20
    v_mfma_f32_16x16x32_bf16 v[236:239], v[124:127], v[104:107], v[236:239]
    v_mfma_f32_16x16x32_bf16 v[240:243], v[112:115], v[108:111], v[240:243]
    v_mfma_f32_16x16x32_bf16 v[244:247], v[116:119], v[108:111], v[244:247]
    v_mfma_f32_16x16x32_bf16 v[248:251], v[120:123], v[108:111], v[248:251]
    v_mfma_f32_16x16x32_bf16 v[252:255], v[124:127], v[108:111], v[252:255]
    s_waitcnt lgkmcnt(0)
    s_sub_u32 s23, s23, 1
    s_cmp_lg_u32 s23, 0
    s_cbranch_scc1 w_loop
    v_mov_b32 v20, 131072
    ds_read_b128 v[24:27], v20
    ds_read_b128 v[28:31], v20 offset:16
    s_cmp_eq_u32 s48, 2
    s_cbranch_scc1 w_epi_glu
    s_lshl_b32 s30, s27, 10
    s_add_u32 s30, s30, s49
    s_nop 7
    v_cvt_pk_bf16_f32 v80, v128, v129
    v_cvt_pk_bf16_f32 v81, v130, v131
    v_cvt_pk_bf16_f32 v82, v132, v133
    v_cvt_pk_bf16_f32 v83, v134, v135
    buffer_store_dwordx4 v[80:83], v1, s[4:7], s30 offen sc1
    v_cvt_pk_bf16_f32 v84, v136, v137
    v_cvt_pk_bf16_f32 v85, v138, v139
    v_cvt_pk_bf16_f32 v86, v140, v141
    v_cvt_pk_bf16_f32 v87, v142, v143
    buffer_store_dwordx4 v[84:87], v19, s[4:7], s30 offen sc1
    s_add_u32 s30, s30, s50
    v_cvt_pk_bf16_f32 v88, v144, v145
    v_cvt_pk_bf16_f32 v89, v146, v147
    v_cvt_pk_bf16_f32 v90, v148, v149
    v_cvt_pk_bf16_f32 v91, v150, v151
    buffer_store_dwordx4 v[88:91], v1, s[4:7], s30 offen sc1
    v_cvt_pk_bf16_f32 v92, v152, v153
    v_cvt_pk_bf16_f32 v93, v154, v155
    v_cvt_pk_bf16_f32 v94, v156, v157
    v_cvt_pk_bf16_f32 v95, v158, v159
    buffer_store_dwordx4 v[92:95], v19, s[4:7], s30 offen sc1
    s_add_u32 s30, s30, s50
    v_cvt_pk_bf16_f32 v80, v160, v161
    v_cvt_pk_bf16_f32 v81, v162, v163
    v_cvt_pk_bf16_f32 v82, v164, v165
    v_cvt_pk_bf16_f32 v83, v166, v167
    buffer_store_dwordx4 v[80:83], v1, s[4:7], s30 offen sc1
    v_cvt_pk_bf16_f32 v84, v168, v169
    v_cvt_pk_bf16_f32 v85, v170, v171
    v_cvt_pk_bf16_f32 v86, v172, v173
    v_cvt_pk_bf16_f32 v87, v174, v175
    buffer_store_dwordx4 v[84:87], v19, s[4:7], s30 offen sc1
    s_add_u32 s30, s30, s50
    v_cvt_pk_bf16_f32 v88, v176, v177
    v_cvt_pk_bf16_f32 v89, v178, v179
    v_cvt_pk_bf16_f32 v90, v180, v181
    v_cvt_pk_bf16_f32 v91, v182, v183
    buffer_store_dwordx4 v[88:91], v1, s[4:7], s30 offen sc1
    v_cvt_pk_bf16_f32 v92, v184, v185
    v_cvt_pk_bf16_f32 v93, v186, v187
    v_cvt_pk_bf16_f32 v94, v188, v189
    v_cvt_pk_bf16_f32 v95, v190, v191
    buffer_store_dwordx4 v[92:95], v19, s[4:7], s30 offen sc1
    s_add_u32 s30, s30, s50
    v_cvt_pk_bf16_f32 v80, v192, v193
    v_cvt_pk_bf16_f32 v81, v194, v195
    v_cvt_pk_bf16_f32 v82, v196, v197
    v_cvt_pk_bf16_f32 v83, v198, v199
    buffer_store_dwordx4 v[80:83], v1, s[4:7], s30 offen sc1
    v_cvt_pk_bf16_f32 v84, v200, v201
    v_cvt_pk_bf16_f32 v85, v202, v203
    v_cvt_pk_bf16_f32 v86, v204, v205
    v_cvt_pk_bf16_f32 v87, v206, v207
    buffer_store_dwordx4 v[84:87], v19, s[4:7], s30 offen sc1
    s_add_u32 s30, s30, s50
    v_cvt_pk_bf16_f32 v88, v208, v209
    v_cvt_pk_bf16_f32 v89, v210, v211
    v_cvt_pk_bf16_f32 v90, v212, v213
    v_cvt_pk_bf16_f32 v91, v214, v215
    buffer_store_dwordx4 v[88:91], v1, s[4:7], s30 offen sc1
    v_cvt_pk_bf16_f32 v92, v216, v217
    v_cvt_pk_bf16_f32 v93, v218, v219
    v_cvt_pk_bf16_f32 v94, v220, v221
    v_cvt_pk_bf16_f32 v95, v222, v223
    buffer_store_dwordx4 v[92:95], v19, s[4:7], s30 offen sc1
    s_add_u32 s30, s30, s50
    v_cvt_pk_bf16_f32 v80, v224, v225
    v_cvt_pk_bf16_f32 v81, v226, v227
    v_cvt_pk_bf16_f32 v82, v228, v229
    v_cvt_pk_bf16_f32 v83, v230, v231
    buffer_store_dwordx4 v[80:83], v1, s[4:7], s30 offen sc1
    v_cvt_pk_bf16_f32 v84, v232, v233
    v_cvt_pk_bf16_f32 v85, v234, v235
    v_cvt_pk_bf16_f32 v86, v236, v237
    v_cvt_pk_bf16_f32 v87, v238, v239
    buffer_store_dwordx4 v[84:87], v19, s[4:7], s30 offen sc1
    s_add_u32 s30, s30, s50
    v_cvt_pk_bf16_f32 v88, v240, v241
    v_cvt_pk_bf16_f32 v89, v242, v243
    v_cvt_pk_bf16_f32 v90, v244, v245
    v_cvt_pk_bf16_f32 v91, v246, v247
    buffer_store_dwordx4 v[88:91], v1, s[4:7], s30 offen sc1
    v_cvt_pk_bf16_f32 v92, v248, v249
    v_cvt_pk_bf16_f32 v93, v250, v251
    v_cvt_pk_bf16_f32 v94, v252, v253
    v_cvt_pk_bf16_f32 v95, v254, v255
    buffer_store_dwordx4 v[92:95], v19, s[4:7], s30 offen sc1
    s_waitcnt lgkmcnt(0)
    v_or3_b32 v24, v24, v25, v26
    v_or3_b32 v28, v28, v29, v30
    v_or3_b32 v24, v24, v27, v31
    v_or_b32 v24, v24, v28
    s_mov_b32 s28, s51
    v_readfirstlane_b32 s30, v24
    s_cmp_lg_u32 s30, 0
    s_cbranch_scc1 w_drain
    s_mov_b32 s48, s32
    s_cmp_eq_u32 s32, 4
    s_cselect_b32 s30, 2, 3
    s_lshl_b32 s30, s26, s30
    s_mul_i32 s30, s30, s43
    s_add_u32 s49, s42, s30
    s_mov_b32 s50, s43
    s_mov_b32 s51, s46
    s_mov_b32 s23, s41
    s_mov_b32 s53, s47
    s_nop 0
    s_load_dwordx16 s[32:47], s[24:25], 0
    s_add_u32 s24, s24, 64
    s_addc_u32 s25, s25, 0
    s_branch w_first16
w_epi_glu:
    s_lshl_b32 s30, s27, 10
    s_add_u32 s30, s30, s49
    s_mov_b32 s54, 0xbfb8aa3b
    s_nop 7
    v_cvt_pk_bf16_f32 v80, v128, v129
    v_cvt_pk_bf16_f32 v81, v130, v131
    v_cvt_pk_bf16_f32 v82, v132, v133
    v_cvt_pk_bf16_f32 v83, v134, v135
    v_lshlrev_b32 v96, 16, v80
    v_and_b32 v97, 0xffff0000, v80
    v_lshlrev_b32 v98, 16, v81
    v_and_b32 v99, 0xffff0000, v81
    v_lshlrev_b32 v100, 16, v82
    v_and_b32 v101, 0xffff0000, v82
    v_lshlrev_b32 v102, 16, v83
    v_and_b32 v103, 0xffff0000, v83
    v_mul_f32 v96, s54, v96
    v_mul_f32 v97, s54, v97
    v_mul_f32 v98, s54, v98
    v_mul_f32 v99, s54, v99
    v_mul_f32 v100, s54, v100
    v_mul_f32 v101, s54, v101
    v_mul_f32 v102, s54, v102
    v_mul_f32 v103, s54, v103
    v_exp_f32 v96, v96
    v_exp_f32 v97, v97
    v_exp_f32 v98, v98
    v_exp_f32 v99, v99
    v_exp_f32 v100, v100
    v_exp_f32 v101, v101
    v_exp_f32 v102, v102
    v_exp_f32 v103, v103
    v_add_f32 v96, 1.0, v96
    v_add_f32 v97, 1.0, v97
    v_add_f32 v98, 1.0, v98
    v_add_f32 v99, 1.0, v99
    v_add_f32 v100, 1.0, v100
    v_add_f32 v101, 1.0, v101
    v_add_f32 v102, 1.0, v102
    v_add_f32 v103, 1.0, v103
    v_rcp_f32 v96, v96
    v_rcp_f32 v97, v97
    v_rcp_f32 v98, v98
    v_rcp_f32 v99, v99
    v_rcp_f32 v100, v100
    v_rcp_f32 v101, v101
    v_rcp_f32 v102, v102
    v_rcp_f32 v103, v103
    v_mul_f32 v96, v96, v136
    v_mul_f32 v97, v97, v137
    v_mul_f32 v98, v98, v138
    v_mul_f32 v99, v99, v139
    v_mul_f32 v100, v100, v140
    v_mul_f32 v101, v101, v141
    v_mul_f32 v102, v102, v142
    v_mul_f32 v103, v103, v143
    v_cvt_pk_bf16_f32 v80, v96, v97
    v_cvt_pk_bf16_f32 v81, v98, v99
    v_cvt_pk_bf16_f32 v82, v100, v101
    v_cvt_pk_bf16_f32 v83, v102, v103
    buffer_store_dwordx4 v[80:83], v1, s[4:7], s30 offen sc1
    s_add_u32 s30, s30, s50
    v_cvt_pk_bf16_f32 v84, v144, v145
    v_cvt_pk_bf16_f32 v85, v146, v147
    v_cvt_pk_bf16_f32 v86, v148, v149
    v_cvt_pk_bf16_f32 v87, v150, v151
    v_lshlrev_b32 v104, 16, v84
    v_and_b32 v105, 0xffff0000, v84
    v_lshlrev_b32 v106, 16, v85
    v_and_b32 v107, 0xffff0000, v85
    v_lshlrev_b32 v108, 16, v86
    v_and_b32 v109, 0xffff0000, v86
    v_lshlrev_b32 v110, 16, v87
    v_and_b32 v111, 0xffff0000, v87
    v_mul_f32 v104, s54, v104
    v_mul_f32 v105, s54, v105
    v_mul_f32 v106, s54, v106
    v_mul_f32 v107, s54, v107
    v_mul_f32 v108, s54, v108
    v_mul_f32 v109, s54, v109
    v_mul_f32 v110, s54, v110
    v_mul_f32 v111, s54, v111
    v_exp_f32 v104, v104
    v_exp_f32 v105, v105
    v_exp_f32 v106, v106
    v_exp_f32 v107, v107
    v_exp_f32 v108, v108
    v_exp_f32 v109, v109
    v_exp_f32 v110, v110
    v_exp_f32 v111, v111
    v_add_f32 v104, 1.0, v104
    v_add_f32 v105, 1.0, v105
    v_add_f32 v106, 1.0, v106
    v_add_f32 v107, 1.0, v107
    v_add_f32 v108, 1.0, v108
    v_add_f32 v109, 1.0, v109
    v_add_f32 v110, 1.0, v110
    v_add_f32 v111, 1.0, v111
    v_rcp_f32 v104, v104
    v_rcp_f32 v105, v105
    v_rcp_f32 v106, v106
    v_rcp_f32 v107, v107
    v_rcp_f32 v108, v108
    v_rcp_f32 v109, v109
    v_rcp_f32 v110, v110
    v_rcp_f32 v111, v111
    v_mul_f32 v104, v104, v152
    v_mul_f32 v105, v105, v153
    v_mul_f32 v106, v106, v154
    v_mul_f32 v107, v107, v155
    v_mul_f32 v108, v108, v156
    v_mul_f32 v109, v109, v157
    v_mul_f32 v110, v110, v158
    v_mul_f32 v111, v111, v159
    v_cvt_pk_bf16_f32 v84, v104, v105
    v_cvt_pk_bf16_f32 v85, v106, v107
    v_cvt_pk_bf16_f32 v86, v108, v109
    v_cvt_pk_bf16_f32 v87, v110, v111
    buffer_store_dwordx4 v[84:87], v1, s[4:7], s30 offen sc1
    s_add_u32 s30, s30, s50
    v_cvt_pk_bf16_f32 v88, v160, v161
    v_cvt_pk_bf16_f32 v89, v162, v163
    v_cvt_pk_bf16_f32 v90, v164, v165
    v_cvt_pk_bf16_f32 v91, v166, v167
    v_lshlrev_b32 v96, 16, v88
    v_and_b32 v97, 0xffff0000, v88
    v_lshlrev_b32 v98, 16, v89
    v_and_b32 v99, 0xffff0000, v89
    v_lshlrev_b32 v100, 16, v90
    v_and_b32 v101, 0xffff0000, v90
    v_lshlrev_b32 v102, 16, v91
    v_and_b32 v103, 0xffff0000, v91
    v_mul_f32 v96, s54, v96
    v_mul_f32 v97, s54, v97
    v_mul_f32 v98, s54, v98
    v_mul_f32 v99, s54, v99
    v_mul_f32 v100, s54, v100
    v_mul_f32 v101, s54, v101
    v_mul_f32 v102, s54, v102
    v_mul_f32 v103, s54, v103
    v_exp_f32 v96, v96
    v_exp_f32 v97, v97
    v_exp_f32 v98, v98
    v_exp_f32 v99, v99
    v_exp_f32 v100, v100
    v_exp_f32 v101, v101
    v_exp_f32 v102, v102
    v_exp_f32 v103, v103
    v_add_f32 v96, 1.0, v96
    v_add_f32 v97, 1.0, v97
    v_add_f32 v98, 1.0, v98
    v_add_f32 v99, 1.0, v99
    v_add_f32 v100, 1.0, v100
    v_add_f32 v101, 1.0, v101
    v_add_f32 v102, 1.0, v102
    v_add_f32 v103, 1.0, v103
    v_rcp_f32 v96, v96
    v_rcp_f32 v97, v97
    v_rcp_f32 v98, v98
    v_rcp_f32 v99, v99
    v_rcp_f32 v100, v100
    v_rcp_f32 v101, v101
    v_rcp_f32 v102, v102
    v_rcp_f32 v103, v103
    v_mul_f32 v96, v96, v168
    v_mul_f32 v97, v97, v169
    v_mul_f32 v98, v98, v170
    v_mul_f32 v99, v99, v171
    v_mul_f32 v100, v100, v172
    v_mul_f32 v101, v101, v173
    v_mul_f32 v102, v102, v174
    v_mul_f32 v103, v103, v175
    v_cvt_pk_bf16_f32 v88, v96, v97
    v_cvt_pk_bf16_f32 v89, v98, v99
    v_cvt_pk_bf16_f32 v90, v100, v101
    v_cvt_pk_bf16_f32 v91, v102, v103
    buffer_store_dwordx4 v[88:91], v1, s[4:7], s30 offen sc1
    s_add_u32 s30, s30, s50
    v_cvt_pk_bf16_f32 v92, v176, v177
    v_cvt_pk_bf16_f32 v93, v178, v179
    v_cvt_pk_bf16_f32 v94, v180, v181
    v_cvt_pk_bf16_f32 v95, v182, v183
    v_lshlrev_b32 v104, 16, v92
    v_and_b32 v105, 0xffff0000, v92
    v_lshlrev_b32 v106, 16, v93
    v_and_b32 v107, 0xffff0000, v93
    v_lshlrev_b32 v108, 16, v94
    v_and_b32 v109, 0xffff0000, v94
    v_lshlrev_b32 v110, 16, v95
    v_and_b32 v111, 0xffff0000, v95
    v_mul_f32 v104, s54, v104
    v_mul_f32 v105, s54, v105
    v_mul_f32 v106, s54, v106
    v_mul_f32 v107, s54, v107
    v_mul_f32 v108, s54, v108
    v_mul_f32 v109, s54, v109
    v_mul_f32 v110, s54, v110
    v_mul_f32 v111, s54, v111
    v_exp_f32 v104, v104
    v_exp_f32 v105, v105
    v_exp_f32 v106, v106
    v_exp_f32 v107, v107
    v_exp_f32 v108, v108
    v_exp_f32 v109, v109
    v_exp_f32 v110, v110
    v_exp_f32 v111, v111
    v_add_f32 v104, 1.0, v104
    v_add_f32 v105, 1.0, v105
    v_add_f32 v106, 1.0, v106
    v_add_f32 v107, 1.0, v107
    v_add_f32 v108, 1.0, v108
    v_add_f32 v109, 1.0, v109
    v_add_f32 v110, 1.0, v110
    v_add_f32 v111, 1.0, v111
    v_rcp_f32 v104, v104
    v_rcp_f32 v105, v105
    v_rcp_f32 v106, v106
    v_rcp_f32 v107, v107
    v_rcp_f32 v108, v108
    v_rcp_f32 v109, v109
    v_rcp_f32 v110, v110
    v_rcp_f32 v111, v111
    v_mul_f32 v104, v104, v184
    v_mul_f32 v105, v105, v185
    v_mul_f32 v106, v106, v186
    v_mul_f32 v107, v107, v187
    v_mul_f32 v108, v108, v188
    v_mul_f32 v109, v109, v189
    v_mul_f32 v110, v110, v190
    v_mul_f32 v111, v111, v191
    v_cvt_pk_bf16_f32 v92, v104, v105
    v_cvt_pk_bf16_f32 v93, v106, v107
    v_cvt_pk_bf16_f32 v94, v108, v109
    v_cvt_pk_bf16_f32 v95, v110, v111
    buffer_store_dwordx4 v[92:95], v1, s[4:7], s30 offen sc1
    s_add_u32 s30, s30, s50
    v_cvt_pk_bf16_f32 v80, v192, v193
    v_cvt_pk_bf16_f32 v81, v194, v195
    v_cvt_pk_bf16_f32 v82, v196, v197
    v_cvt_pk_bf16_f32 v83, v198, v199
    v_lshlrev_b32 v96, 16, v80
    v_and_b32 v97, 0xffff0000, v80
    v_lshlrev_b32 v98, 16, v81
    v_and_b32 v99, 0xffff0000, v81
    v_lshlrev_b32 v100, 16, v82
    v_and_b32 v101, 0xffff0000, v82
    v_lshlrev_b32 v102, 16, v83
    v_and_b32 v103, 0xffff0000, v83
    v_mul_f32 v96, s54, v96
    v_mul_f32 v97, s54, v97
    v_mul_f32 v98, s54, v98
    v_mul_f32 v99, s54, v99
    v_mul_f32 v100, s54, v100
    v_mul_f32 v101, s54, v101
    v_mul_f32 v102, s54, v102
    v_mul_f32 v103, s54, v103
    v_exp_f32 v96, v96
    v_exp_f32 v97, v97
    v_exp_f32 v98, v98
    v_exp_f32 v99, v99
    v_exp_f32 v100, v100
    v_exp_f32 v101, v101
    v_exp_f32 v102, v102
    v_exp_f32 v103, v103
    v_add_f32 v96, 1.0, v96
    v_add_f32 v97, 1.0, v97
    v_add_f32 v98, 1.0, v98
    v_add_f32 v99, 1.0, v99
    v_add_f32 v100, 1.0, v100
    v_add_f32 v101, 1.0, v101
    v_add_f32 v102, 1.0, v102
    v_add_f32 v103, 1.0, v103
    v_rcp_f32 v96, v96
    v_rcp_f32 v97, v97
    v_rcp_f32 v98, v98
    v_rcp_f32 v99, v99
    v_rcp_f32 v100, v100
    v_rcp_f32 v101, v101
    v_rcp_f32 v102, v102
    v_rcp_f32 v103, v103
    v_mul_f32 v96, v96, v200
    v_mul_f32 v97, v97, v201
    v_mul_f32 v98, v98, v202
    v_mul_f32 v99, v99, v203
    v_mul_f32 v100, v100, v204
    v_mul_f32 v101, v101, v205
    v_mul_f32 v102, v102, v206
    v_mul_f32 v103, v103, v207
    v_cvt_pk_bf16_f32 v80, v96, v97
    v_cvt_pk_bf16_f32 v81, v98, v99
    v_cvt_pk_bf16_f32 v82, v100, v101
    v_cvt_pk_bf16_f32 v83, v102, v103
    buffer_store_dwordx4 v[80:83], v1, s[4:7], s30 offen sc1
    s_add_u32 s30, s30, s50
    v_cvt_pk_bf16_f32 v84, v208, v209
    v_cvt_pk_bf16_f32 v85, v210, v211
    v_cvt_pk_bf16_f32 v86, v212, v213
    v_cvt_pk_bf16_f32 v87, v214, v215
    v_lshlrev_b32 v104, 16, v84
    v_and_b32 v105, 0xffff0000, v84
    v_lshlrev_b32 v106, 16, v85
    v_and_b32 v107, 0xffff0000, v85
    v_lshlrev_b32 v108, 16, v86
    v_and_b32 v109, 0xffff0000, v86
    v_lshlrev_b32 v110, 16, v87
    v_and_b32 v111, 0xffff0000, v87
    v_mul_f32 v104, s54, v104
    v_mul_f32 v105, s54, v105
    v_mul_f32 v106, s54, v106
    v_mul_f32 v107, s54, v107
    v_mul_f32 v108, s54, v108
    v_mul_f32 v109, s54, v109
    v_mul_f32 v110, s54, v110
    v_mul_f32 v111, s54, v111
    v_exp_f32 v104, v104
    v_exp_f32 v105, v105
    v_exp_f32 v106, v106
    v_exp_f32 v107, v107
    v_exp_f32 v108, v108
    v_exp_f32 v109, v109
    v_exp_f32 v110, v110
    v_exp_f32 v111, v111
    v_add_f32 v104, 1.0, v104
    v_add_f32 v105, 1.0, v105
    v_add_f32 v106, 1.0, v106
    v_add_f32 v107, 1.0, v107
    v_add_f32 v108, 1.0, v108
    v_add_f32 v109, 1.0, v109
    v_add_f32 v110, 1.0, v110
    v_add_f32 v111, 1.0, v111
    v_rcp_f32 v104, v104
    v_rcp_f32 v105, v105
    v_rcp_f32 v106, v106
    v_rcp_f32 v107, v107
    v_rcp_f32 v108, v108
    v_rcp_f32 v109, v109
    v_rcp_f32 v110, v110
    v_rcp_f32 v111, v111
    v_mul_f32 v104, v104, v216
    v_mul_f32 v105, v105, v217
    v_mul_f32 v106, v106, v218
    v_mul_f32 v107, v107, v219
    v_mul_f32 v108, v108, v220
    v_mul_f32 v109, v109, v221
    v_mul_f32 v110, v110, v222
    v_mul_f32 v111, v111, v223
    v_cvt_pk_bf16_f32 v84, v104, v105
    v_cvt_pk_bf16_f32 v85, v106, v107
    v_cvt_pk_bf16_f32 v86, v108, v109
    v_cvt_pk_bf16_f32 v87, v110, v111
    buffer_store_dwordx4 v[84:87], v1, s[4:7], s30 offen sc1
    s_add_u32 s30, s30, s50
    v_cvt_pk_bf16_f32 v88, v224, v225
    v_cvt_pk_bf16_f32 v89, v226, v227
    v_cvt_pk_bf16_f32 v90, v228, v229
    v_cvt_pk_bf16_f32 v91, v230, v231
    v_lshlrev_b32 v96, 16, v88
    v_and_b32 v97, 0xffff0000, v88
    v_lshlrev_b32 v98, 16, v89
    v_and_b32 v99, 0xffff0000, v89
    v_lshlrev_b32 v100, 16, v90
    v_and_b32 v101, 0xffff0000, v90
    v_lshlrev_b32 v102, 16, v91
    v_and_b32 v103, 0xffff0000, v91
    v_mul_f32 v96, s54, v96
    v_mul_f32 v97, s54, v97
    v_mul_f32 v98, s54, v98
    v_mul_f32 v99, s54, v99
    v_mul_f32 v100, s54, v100
    v_mul_f32 v101, s54, v101
    v_mul_f32 v102, s54, v102
    v_mul_f32 v103, s54, v103
    v_exp_f32 v96, v96
    v_exp_f32 v97, v97
    v_exp_f32 v98, v98
    v_exp_f32 v99, v99
    v_exp_f32 v100, v100
    v_exp_f32 v101, v101
    v_exp_f32 v102, v102
    v_exp_f32 v103, v103
    v_add_f32 v96, 1.0, v96
    v_add_f32 v97, 1.0, v97
    v_add_f32 v98, 1.0, v98
    v_add_f32 v99, 1.0, v99
    v_add_f32 v100, 1.0, v100
    v_add_f32 v101, 1.0, v101
    v_add_f32 v102, 1.0, v102
    v_add_f32 v103, 1.0, v103
    v_rcp_f32 v96, v96
    v_rcp_f32 v97, v97
    v_rcp_f32 v98, v98
    v_rcp_f32 v99, v99
    v_rcp_f32 v100, v100
    v_rcp_f32 v101, v101
    v_rcp_f32 v102, v102
    v_rcp_f32 v103, v103
    v_mul_f32 v96, v96, v232
    v_mul_f32 v97, v97, v233
    v_mul_f32 v98, v98, v234
    v_mul_f32 v99, v99, v235
    v_mul_f32 v100, v100, v236
    v_mul_f32 v101, v101, v237
    v_mul_f32 v102, v102, v238
    v_mul_f32 v103, v103, v239
    v_cvt_pk_bf16_f32 v88, v96, v97
    v_cvt_pk_bf16_f32 v89, v98, v99
    v_cvt_pk_bf16_f32 v90, v100, v101
    v_cvt_pk_bf16_f32 v91, v102, v103
    buffer_store_dwordx4 v[88:91], v1, s[4:7], s30 offen sc1
    s_add_u32 s30, s30, s50
    v_cvt_pk_bf16_f32 v92, v240, v241
    v_cvt_pk_bf16_f32 v93, v242, v243
    v_cvt_pk_bf16_f32 v94, v244, v245
    v_cvt_pk_bf16_f32 v95, v246, v247
    v_lshlrev_b32 v104, 16, v92
    v_and_b32 v105, 0xffff0000, v92
    v_lshlrev_b32 v106, 16, v93
    v_and_b32 v107, 0xffff0000, v93
    v_lshlrev_b32 v108, 16, v94
    v_and_b32 v109, 0xffff0000, v94
    v_lshlrev_b32 v110, 16, v95
    v_and_b32 v111, 0xffff0000, v95
    v_mul_f32 v104, s54, v104
    v_mul_f32 v105, s54, v105
    v_mul_f32 v106, s54, v106
    v_mul_f32 v107, s54, v107
    v_mul_f32 v108, s54, v108
    v_mul_f32 v109, s54, v109
    v_mul_f32 v110, s54, v110
    v_mul_f32 v111, s54, v111
    v_exp_f32 v104, v104
    v_exp_f32 v105, v105
    v_exp_f32 v106, v106
    v_exp_f32 v107, v107
    v_exp_f32 v108, v108
    v_exp_f32 v109, v109
    v_exp_f32 v110, v110
    v_exp_f32 v111, v111
    v_add_f32 v104, 1.0, v104
    v_add_f32 v105, 1.0, v105
    v_add_f32 v106, 1.0, v106
    v_add_f32 v107, 1.0, v107
    v_add_f32 v108, 1.0, v108
    v_add_f32 v109, 1.0, v109
    v_add_f32 v110, 1.0, v110
    v_add_f32 v111, 1.0, v111
    v_rcp_f32 v104, v104
    v_rcp_f32 v105, v105
    v_rcp_f32 v106, v106
    v_rcp_f32 v107, v107
    v_rcp_f32 v108, v108
    v_rcp_f32 v109, v109
    v_rcp_f32 v110, v110
    v_rcp_f32 v111, v111
    v_mul_f32 v104, v104, v248
    v_mul_f32 v105, v105, v249
    v_mul_f32 v106, v106, v250
    v_mul_f32 v107, v107, v251
    v_mul_f32 v108, v108, v252
    v_mul_f32 v109, v109, v253
    v_mul_f32 v110, v110, v254
    v_mul_f32 v111, v111, v255
    v_cvt_pk_bf16_f32 v92, v104, v105
    v_cvt_pk_bf16_f32 v93, v106, v107
    v_cvt_pk_bf16_f32 v94, v108, v109
    v_cvt_pk_bf16_f32 v95, v110, v111
    buffer_store_dwordx4 v[92:95], v1, s[4:7], s30 offen sc1
    s_waitcnt lgkmcnt(0)
    v_or3_b32 v24, v24, v25, v26
    v_or3_b32 v28, v28, v29, v30
    v_or3_b32 v24, v24, v27, v31
    v_or_b32 v24, v24, v28
    s_mov_b32 s28, s51
    v_readfirstlane_b32 s30, v24
    s_cmp_lg_u32 s30, 0
    s_cbranch_scc1 w_drain
    s_mov_b32 s48, s32
    s_cmp_eq_u32 s32, 4
    s_cselect_b32 s30, 2, 3
    s_lshl_b32 s30, s26, s30
    s_mul_i32 s30, s30, s43
    s_add_u32 s49, s42, s30
    s_mov_b32 s50, s43
    s_mov_b32 s51, s46
    s_mov_b32 s23, s41
    s_mov_b32 s53, s47
    s_nop 0
    s_load_dwordx16 s[32:47], s[24:25], 0
    s_add_u32 s24, s24, 64
    s_addc_u32 s25, s25, 0
    s_branch w_first8
w_firstH:
    s_waitcnt vmcnt(8)
    s_barrier
    s_add_u32 m0, s21, 0
    s_nop 0
    buffer_load_dwordx4 v1, s[4:7], s16 offen sc1 lds
    s_add_u32 s16, s16, s62
    s_add_u32 m0, s21, 1024
    s_nop 0
    buffer_load_dwordx4 v1, s[4:7], s17 offen sc1 lds
    s_add_u32 s17, s17, s62
    s_add_u32 m0, s22, 0
    s_nop 0
    buffer_load_dwordx4 v2, s[8:11], s18 offen lds
    s_add_u32 s18, s18, s20
    s_add_u32 m0, s22, 8192
    s_nop 0
    buffer_load_dwordx4 v2, s[12:15], s19 offen lds
    s_add_u32 s19, s19, s20
    v_mfma_f32_16x16x32_bf16 v[128:131], v[64:67], v[32:35], 0
    ds_read_b64_tr_b16 v[112:113], v8 offset:49152
    v_mfma_f32_16x16x32_bf16 v[132:135], v[68:71], v[32:35], 0
    ds_read_b64_tr_b16 v[114:115], v9 offset:49152
    v_mfma_f32_16x16x32_bf16 v[144:147], v[64:67], v[40:43], 0
    ds_read_b64_tr_b16 v[116:117], v10 offset:49152
    v_mfma_f32_16x16x32_bf16 v[148:151], v[68:71], v[40:43], 0
    ds_read_b64_tr_b16 v[118:119], v11 offset:49152
    v_mfma_f32_16x16x32_bf16 v[160:163], v[64:67], v[48:51], 0
    ds_read_b64_tr_b16 v[120:121], v8 offset:57344
    v_mfma_f32_16x16x32_bf16 v[164:167], v[68:71], v[48:51], 0
    ds_read_b64_tr_b16 v[122:123], v9 offset:57344
    v_mfma_f32_16x16x32_bf16 v[176:179], v[64:67], v[56:59], 0
    ds_read_b64_tr_b16 v[124:125], v10 offset:57344
    v_mfma_f32_16x16x32_bf16 v[180:183], v[68:71], v[56:59], 0
    ds_read_b64_tr_b16 v[126:127], v11 offset:57344
    v_mfma_f32_16x16x32_bf16 v[128:131], v[72:75], v[36:39], v[128:131]
    ds_read_b128 v[80:83], v5 offset:32768
    v_mfma_f32_16x16x32_bf16 v[132:135], v[76:79], v[36:39], v[132:135]
    ds_read_b128 v[84:87], v5 offset:33792
    v_mfma_f32_16x16x32_bf16 v[144:147], v[72:75], v[44:47], v[144:147]
    ds_read_b128 v[88:91], v5 offset:34816
    v_mfma_f32_16x16x32_bf16 v[148:151], v[76:79], v[44:47], v[148:151]
    ds_read_b128 v[92:95], v5 offset:35840
    v_mfma_f32_16x16x32_bf16 v[160:163], v[72:75], v[52:55], v[160:163]
    ds_read_b128 v[96:99], v5 offset:36864
    v_mfma_f32_16x16x32_bf16 v[164:167], v[76:79], v[52:55], v[164:167]
    ds_read_b128 v[100:103], v5 offset:37888
    v_mfma_f32_16x16x32_bf16 v[176:179], v[72:75], v[60:63], v[176:179]
    ds_read_b128 v[104:107], v5 offset:38912
    v_mfma_f32_16x16x32_bf16 v[180:183], v[76:79], v[60:63], v[180:183]
    ds_read_b128 v[108:111], v5 offset:39936
    s_waitcnt lgkmcnt(0)
    s_waitcnt vmcnt(8)
    s_barrier
    s_add_u32 m0, s21, 32768
    s_nop 0
    buffer_load_dwordx4 v1, s[4:7], s16 offen sc1 lds
    s_add_u32 s16, s16, s62
    s_add_u32 m0, s21, 33792
    s_nop 0
    buffer_load_dwordx4 v1, s[4:7], s17 offen sc1 lds
    s_add_u32 s17, s17, s62
    s_add_u32 m0, s22, 32768
    s_nop 0
    buffer_load_dwordx4 v2, s[8:11], s18 offen lds
    s_add_u32 s18, s18, s20
    s_add_u32 m0, s22, 40960
    s_nop 0
    buffer_load_dwordx4 v2, s[12:15], s19 offen lds
    s_add_u32 s19, s19, s20
    v_mfma_f32_16x16x32_bf16 v[128:131], v[112:115], v[80:83], v[128:131]
    ds_read_b64_tr_b16 v[64:65], v12 offset:16384
    v_mfma_f32_16x16x32_bf16 v[132:135], v[116:119], v[80:83], v[132:135]
    ds_read_b64_tr_b16 v[66:67], v13 offset:16384
    v_mfma_f32_16x16x32_bf16 v[144:147], v[112:115], v[88:91], v[144:147]
    ds_read_b64_tr_b16 v[68:69], v14 offset:16384
    v_mfma_f32_16x16x32_bf16 v[148:151], v[116:119], v[88:91], v[148:151]
    ds_read_b64_tr_b16 v[70:71], v15 offset:16384
    v_mfma_f32_16x16x32_bf16 v[160:163], v[112:115], v[96:99], v[160:163]
    ds_read_b64_tr_b16 v[72:73], v12 offset:24576
    v_mfma_f32_16x16x32_bf16 v[164:167], v[116:119], v[96:99], v[164:167]
    ds_read_b64_tr_b16 v[74:75], v13 offset:24576
    v_mfma_f32_16x16x32_bf16 v[176:179], v[112:115], v[104:107], v[176:179]
    ds_read_b64_tr_b16 v[76:77], v14 offset:24576
    v_mfma_f32_16x16x32_bf16 v[180:183], v[116:119], v[104:107], v[180:183]
    ds_read_b64_tr_b16 v[78:79], v15 offset:24576
    v_mfma_f32_16x16x32_bf16 v[128:131], v[120:123], v[84:87], v[128:131]
    ds_read_b128 v[32:35], v6 offset:0
    v_mfma_f32_16x16x32_bf16 v[132:135], v[124:127], v[84:87], v[132:135]
    ds_read_b128 v[36:39], v6 offset:1024
    v_mfma_f32_16x16x32_bf16 v[144:147], v[120:123], v[92:95], v[144:147]
    ds_read_b128 v[40:43], v6 offset:2048
    v_mfma_f32_16x16x32_bf16 v[148:151], v[124:127], v[92:95], v[148:151]
    ds_read_b128 v[44:47], v6 offset:3072
    v_mfma_f32_16x16x32_bf16 v[160:163], v[120:123], v[100:103], v[160:163]
    ds_read_b128 v[48:51], v6 offset:4096
    v_mfma_f32_16x16x32_bf16 v[164:167], v[124:127], v[100:103], v[164:167]
    ds_read_b128 v[52:55], v6 offset:5120
    v_mfma_f32_16x16x32_bf16 v[176:179], v[120:123], v[108:111], v[176:179]
    ds_read_b128 v[56:59], v6 offset:6144
    v_mfma_f32_16x16x32_bf16 v[180:183], v[124:127], v[108:111], v[180:183]
    ds_read_b128 v[60:63], v6 offset:7168
    s_waitcnt lgkmcnt(0)
    s_waitcnt vmcnt(8)
    s_barrier
    s_add_u32 m0, s21, 65536
    s_nop 0
    buffer_load_dwordx4 v1, s[4:7], s16 offen sc1 lds
    s_add_u32 s16, s16, s62
    s_add_u32 m0, s21, 66560
    s_nop 0
    buffer_load_dwordx4 v1, s[4:7], s17 offen sc1 lds
    s_add_u32 s17, s17, s62
    s_add_u32 m0, s22, 65536
    s_nop 0
    buffer_load_dwordx4 v2, s[8:11], s18 offen lds
    s_add_u32 s18, s18, s20
    s_add_u32 m0, s22, 73728
    s_nop 0
    buffer_load_dwordx4 v2, s[12:15], s19 offen lds
    s_add_u32 s19, s19, s20
    v_mfma_f32_16x16x32_bf16 v[128:131], v[64:67], v[32:35], v[128:131]
    ds_read_b64_tr_b16 v[112:113], v12 offset:49152
    v_mfma_f32_16x16x32_bf16 v[132:135], v[68:71], v[32:35], v[132:135]
    ds_read_b64_tr_b16 v[114:115], v13 offset:49152
    v_mfma_f32_16x16x32_bf16 v[144:147], v[64:67], v[40:43], v[144:147]
    ds_read_b64_tr_b16 v[116:117], v14 offset:49152
    v_mfma_f32_16x16x32_bf16 v[148:151], v[68:71], v[40:43], v[148:151]
    ds_read_b64_tr_b16 v[118:119], v15 offset:49152
    v_mfma_f32_16x16x32_bf16 v[160:163], v[64:67], v[48:51], v[160:163]
    ds_read_b64_tr_b16 v[120:121], v12 offset:57344
    v_mfma_f32_16x16x32_bf16 v[164:167], v[68:71], v[48:51], v[164:167]
    ds_read_b64_tr_b16 v[122:123], v13 offset:57344
    v_mfma_f32_16x16x32_bf16 v[176:179], v[64:67], v[56:59], v[176:179]
    ds_read_b64_tr_b16 v[124:125], v14 offset:57344
    v_mfma_f32_16x16x32_bf16 v[180:183], v[68:71], v[56:59], v[180:183]
    ds_read_b64_tr_b16 v[126:127], v15 offset:57344
    v_mfma_f32_16x16x32_bf16 v[128:131], v[72:75], v[36:39], v[128:131]
    ds_read_b128 v[80:83], v6 offset:32768
    v_mfma_f32_16x16x32_bf16 v[132:135], v[76:79], v[36:39], v[132:135]
    ds_read_b128 v[84:87], v6 offset:33792
    v_mfma_f32_16x16x32_bf16 v[144:147], v[72:75], v[44:47], v[144:147]
    ds_read_b128 v[88:91], v6 offset:34816
    v_mfma_f32_16x16x32_bf16 v[148:151], v[76:79], v[44:47], v[148:151]
    ds_read_b128 v[92:95], v6 offset:35840
    v_mfma_f32_16x16x32_bf16 v[160:163], v[72:75], v[52:55], v[160:163]
    ds_read_b128 v[96:99], v6 offset:36864
    v_mfma_f32_16x16x32_bf16 v[164:167], v[76:79], v[52:55], v[164:167]
    ds_read_b128 v[100:103], v6 offset:37888
    v_mfma_f32_16x16x32_bf16 v[176:179], v[72:75], v[60:63], v[176:179]
    ds_read_b128 v[104:107], v6 offset:38912
    v_mfma_f32_16x16x32_bf16 v[180:183], v[76:79], v[60:63], v[180:183]
    ds_read_b128 v[108:111], v6 offset:39936
    s_waitcnt lgkmcnt(0)
    s_waitcnt vmcnt(8)
    s_barrier
    s_add_u32 m0, s21, 98304
    s_nop 0
    buffer_load_dwordx4 v1, s[4:7], s16 offen sc1 lds
    s_add_u32 s16, s16, s62
    s_add_u32 m0, s21, 99328
    s_nop 0
    buffer_load_dwordx4 v1, s[4:7], s17 offen sc1 lds
    s_add_u32 s17, s17, s62
    s_add_u32 m0, s22, 98304
    s_nop 0
    buffer_load_dwordx4 v2, s[8:11], s18 offen lds
    s_add_u32 s18, s18, s20
    s_add_u32 m0, s22, 106496
    s_nop 0
    buffer_load_dwordx4 v2, s[12:15], s19 offen lds
    s_add_u32 s19, s19, s20
    v_mfma_f32_16x16x32_bf16 v[128:131], v[112:115], v[80:83], v[128:131]
    ds_read_b64_tr_b16 v[64:65], v8 offset:16384
    v_mfma_f32_16x16x32_bf16 v[132:135], v[116:119], v[80:83], v[132:135]
    ds_read_b64_tr_b16 v[66:67], v9 offset:16384
    v_mfma_f32_16x16x32_bf16 v[144:147], v[112:115], v[88:91], v[144:147]
    ds_read_b64_tr_b16 v[68:69], v10 offset:16384
    v_mfma_f32_16x16x32_bf16 v[148:151], v[116:119], v[88:91], v[148:151]
    ds_read_b64_tr_b16 v[70:71], v11 offset:16384
    v_mfma_f32_16x16x32_bf16 v[160:163], v[112:115], v[96:99], v[160:163]
    ds_read_b64_tr_b16 v[72:73], v8 offset:24576
    v_mfma_f32_16x16x32_bf16 v[164:167], v[116:119], v[96:99], v[164:167]
    ds_read_b64_tr_b16 v[74:75], v9 offset:24576
    v_mfma_f32_16x16x32_bf16 v[176:179], v[112:115], v[104:107], v[176:179]
    ds_read_b64_tr_b16 v[76:77], v10 offset:24576
    v_mfma_f32_16x16x32_bf16 v[180:183], v[116:119], v[104:107], v[180:183]
    ds_read_b64_tr_b16 v[78:79], v11 offset:24576
    v_mfma_f32_16x16x32_bf16 v[128:131], v[120:123], v[84:87], v[128:131]
    ds_read_b128 v[32:35], v5 offset:0
    v_mfma_f32_16x16x32_bf16 v[132:135], v[124:127], v[84:87], v[132:135]
    ds_read_b128 v[36:39], v5 offset:1024
    v_mfma_f32_16x16x32_bf16 v[144:147], v[120:123], v[92:95], v[144:147]
    ds_read_b128 v[40:43], v5 offset:2048
    v_mfma_f32_16x16x32_bf16 v[148:151], v[124:127], v[92:95], v[148:151]
    ds_read_b128 v[44:47], v5 offset:3072
    v_mfma_f32_16x16x32_bf16 v[160:163], v[120:123], v[100:103], v[160:163]
    ds_read_b128 v[48:51], v5 offset:4096
    v_mfma_f32_16x16x32_bf16 v[164:167], v[124:127], v[100:103], v[164:167]
    ds_read_b128 v[52:55], v5 offset:5120
    v_mfma_f32_16x16x32_bf16 v[176:179], v[120:123], v[108:111], v[176:179]
    ds_read_b128 v[56:59], v5 offset:6144
    v_mfma_f32_16x16x32_bf16 v[180:183], v[124:127], v[108:111], v[180:183]
    ds_read_b128 v[60:63], v5 offset:7168
    s_waitcnt lgkmcnt(0)
w_loop_chkH:
    s_sub_u32 s23, s23, 1
w_loopH:
    s_cmp_lg_u32 s23, 1
    s_cbranch_scc1 w_bodyH
    buffer_load_dword v22, off, s[64:67], 0 sc1
    v_readfirstlane_b32 s30, v16
    s_cmp_ge_u32 s30, s45
    s_cselect_b32 s30, 0, 1
    s_or_b32 s30, s30, s70
    s_cmp_eq_u32 s32, 4
    s_cselect_b32 s30, 1, s30
    s_sub_u32 s57, s32, 1
    s_cmp_ge_u32 s57, 4
    s_cselect_b32 s30, 1, s30
    v_mov_b32 v20, s30
    ds_write_b32 v7, v20
    s_cbranch_scc1 w_bodyH
    s_load_dwordx2 s[8:9], s[0:1], s33
    s_load_dwordx2 s[12:13], s[0:1], s34
    s_mov_b32 s10, s38
    s_mov_b32 s14, s38
    s_cmp_eq_u32 s32, 4
    s_cselect_b32 s31, 0, 1
    s_lshl_b32 s30, s3, s31
    s_mul_i32 s30, s30, s40
    s_add_u32 s16, s39, s30
    s_cmp_eq_u32 s32, 4
    s_cselect_b32 s30, 1024, s40
    s_cselect_b32 s31, 6, 5
    s_lshl_b32 s62, 32, s31
    s_add_u32 s17, s16, s30
    s_lshl_b32 s30, s3, 2
    s_mul_i32 s30, s30, s35
    s_add_u32 s18, s36, s30
    s_add_u32 s19, s37, s30
    s_lshl_b32 s20, s35, s31
    v_mul_u32_u24 v2, s35, v4
    v_add_u32 v2, v2, v3
    s_waitcnt lgkmcnt(0)
w_bodyH:
    s_waitcnt vmcnt(8)
    s_barrier
    s_add_u32 m0, s21, 0
    s_nop 0
    buffer_load_dwordx4 v1, s[4:7], s16 offen sc1 lds
    s_add_u32 s16, s16, s62
    s_add_u32 m0, s21, 1024
    s_nop 0
    buffer_load_dwordx4 v1, s[4:7], s17 offen sc1 lds
    s_add_u32 s17, s17, s62
    s_add_u32 m0, s22, 0
    s_nop 0
    buffer_load_dwordx4 v2, s[8:11], s18 offen lds
    s_add_u32 s18, s18, s20
    s_add_u32 m0, s22, 8192
    s_nop 0
    buffer_load_dwordx4 v2, s[12:15], s19 offen lds
    s_add_u32 s19, s19, s20
    v_mfma_f32_16x16x32_bf16 v[128:131], v[64:67], v[32:35], v[128:131]
    ds_read_b64_tr_b16 v[112:113], v8 offset:49152
    v_mfma_f32_16x16x32_bf16 v[132:135], v[68:71], v[32:35], v[132:135]
    ds_read_b64_tr_b16 v[114:115], v9 offset:49152
    v_mfma_f32_16x16x32_bf16 v[144:147], v[64:67], v[40:43], v[144:147]
    ds_read_b64_tr_b16 v[116:117], v10 offset:49152
    v_mfma_f32_16x16x32_bf16 v[148:151], v[68:71], v[40:43], v[148:151]
    ds_read_b64_tr_b16 v[118:119], v11 offset:49152
    v_mfma_f32_16x16x32_bf16 v[160:163], v[64:67], v[48:51], v[160:163]
    ds_read_b64_tr_b16 v[120:121], v8 offset:57344
    v_mfma_f32_16x16x32_bf16 v[164:167], v[68:71], v[48:51], v[164:167]
    ds_read_b64_tr_b16 v[122:123], v9 offset:57344
    v_mfma_f32_16x16x32_bf16 v[176:179], v[64:67], v[56:59], v[176:179]
    ds_read_b64_tr_b16 v[124:125], v10 offset:57344
    v_mfma_f32_16x16x32_bf16 v[180:183], v[68:71], v[56:59], v[180:183]
    ds_read_b64_tr_b16 v[126:127], v11 offset:57344
    v_mfma_f32_16x16x32_bf16 v[128:131], v[72:75], v[36:39], v[128:131]
    ds_read_b128 v[80:83], v5 offset:32768
    v_mfma_f32_16x16x32_bf16 v[132:135], v[76:79], v[36:39], v[132:135]
    ds_read_b128 v[84:87], v5 offset:33792
    v_mfma_f32_16x16x32_bf16 v[144:147], v[72:75], v[44:47], v[144:147]
    ds_read_b128 v[88:91], v5 offset:34816
    v_mfma_f32_16x16x32_bf16 v[148:151], v[76:79], v[44:47], v[148:151]
    ds_read_b128 v[92:95], v5 offset:35840
    v_mfma_f32_16x16x32_bf16 v[160:163], v[72:75], v[52:55], v[160:163]
    ds_read_b128 v[96:99], v5 offset:36864
    v_mfma_f32_16x16x32_bf16 v[164:167], v[76:79], v[52:55], v[164:167]
    ds_read_b128 v[100:103], v5 offset:37888
    v_mfma_f32_16x16x32_bf16 v[176:179], v[72:75], v[60:63], v[176:179]
    ds_read_b128 v[104:107], v5 offset:38912
    v_mfma_f32_16x16x32_bf16 v[180:183], v[76:79], v[60:63], v[180:183]
    ds_read_b128 v[108:111], v5 offset:39936
    buffer_load_dword v16, v17, s[4:7], s44 offen sc1
    s_waitcnt lgkmcnt(0)
    s_waitcnt vmcnt(8)
    s_barrier
    s_add_u32 m0, s21, 32768
    s_nop 0
    buffer_load_dwordx4 v1, s[4:7], s16 offen sc1 lds
    s_add_u32 s16, s16, s62
    s_add_u32 m0, s21, 33792
    s_nop 0
    buffer_load_dwordx4 v1, s[4:7], s17 offen sc1 lds
    s_add_u32 s17, s17, s62
    s_add_u32 m0, s22, 32768
    s_nop 0
    buffer_load_dwordx4 v2, s[8:11], s18 offen lds
    s_add_u32 s18, s18, s20
    s_add_u32 m0, s22, 40960
    s_nop 0
    buffer_load_dwordx4 v2, s[12:15], s19 offen lds
    s_add_u32 s19, s19, s20
    v_mfma_f32_16x16x32_bf16 v[128:131], v[112:115], v[80:83], v[128:131]
    ds_read_b64_tr_b16 v[64:65], v12 offset:16384
    v_mfma_f32_16x16x32_bf16 v[132:135], v[116:119], v[80:83], v[132:135]
    ds_read_b64_tr_b16 v[66:67], v13 offset:16384
    v_mfma_f32_16x16x32_bf16 v[144:147], v[112:115], v[88:91], v[144:147]
    ds_read_b64_tr_b16 v[68:69], v14 offset:16384
    v_mfma_f32_16x16x32_bf16 v[148:151], v[116:119], v[88:91], v[148:151]
    ds_read_b64_tr_b16 v[70:71], v15 offset:16384
    v_mfma_f32_16x16x32_bf16 v[160:163], v[112:115], v[96:99], v[160:163]
    ds_read_b64_tr_b16 v[72:73], v12 offset:24576
    v_mfma_f32_16x16x32_bf16 v[164:167], v[116:119], v[96:99], v[164:167]
    ds_read_b64_tr_b16 v[74:75], v13 offset:24576
    v_mfma_f32_16x16x32_bf16 v[176:179], v[112:115], v[104:107], v[176:179]
    ds_read_b64_tr_b16 v[76:77], v14 offset:24576
    v_mfma_f32_16x16x32_bf16 v[180:183], v[116:119], v[104:107], v[180:183]
    ds_read_b64_tr_b16 v[78:79], v15 offset:24576
    v_mfma_f32_16x16x32_bf16 v[128:131], v[120:123], v[84:87], v[128:131]
    ds_read_b128 v[32:35], v6 offset:0
    v_mfma_f32_16x16x32_bf16 v[132:135], v[124:127], v[84:87], v[132:135]
    ds_read_b128 v[36:39], v6 offset:1024
    v_mfma_f32_16x16x32_bf16 v[144:147], v[120:123], v[92:95], v[144:147]
    ds_read_b128 v[40:43], v6 offset:2048
    v_mfma_f32_16x16x32_bf16 v[148:151], v[124:127], v[92:95], v[148:151]
    ds_read_b128 v[44:47], v6 offset:3072
    v_mfma_f32_16x16x32_bf16 v[160:163], v[120:123], v[100:103], v[160:163]
    ds_read_b128 v[48:51], v6 offset:4096
    v_mfma_f32_16x16x32_bf16 v[164:167], v[124:127], v[100:103], v[164:167]
    ds_read_b128 v[52:55], v6 offset:5120
    v_mfma_f32_16x16x32_bf16 v[176:179], v[120:123], v[108:111], v[176:179]
    ds_read_b128 v[56:59], v6 offset:6144
    v_mfma_f32_16x16x32_bf16 v[180:183], v[124:127], v[108:111], v[180:183]
    ds_read_b128 v[60:63], v6 offset:7168
    s_waitcnt lgkmcnt(0)
    s_waitcnt vmcnt(8)
    s_barrier
    s_add_u32 m0, s21, 65536
    s_nop 0
    buffer_load_dwordx4 v1, s[4:7], s16 offen sc1 lds
    s_add_u32 s16, s16, s62
    s_add_u32 m0, s21, 66560
    s_nop 0
    buffer_load_dwordx4 v1, s[4:7], s17 offen sc1 lds
    s_add_u32 s17, s17, s62
    s_add_u32 m0, s22, 65536
    s_nop 0
    buffer_load_dwordx4 v2, s[8:11], s18 offen lds
    s_add_u32 s18, s18, s20
    s_add_u32 m0, s22, 73728
    s_nop 0
    buffer_load_dwordx4 v2, s[12:15], s19 offen lds
    s_add_u32 s19, s19, s20
    v_mfma_f32_16x16x32_bf16 v[128:131], v[64:67], v[32:35], v[128:131]
    ds_read_b64_tr_b16 v[112:113], v12 offset:49152
    v_mfma_f32_16x16x32_bf16 v[132:135], v[68:71], v[32:35], v[132:135]
    ds_read_b64_tr_b16 v[114:115], v13 offset:49152
    v_mfma_f32_16x16x32_bf16 v[144:147], v[64:67], v[40:43], v[144:147]
    ds_read_b64_tr_b16 v[116:117], v14 offset:49152
    v_mfma_f32_16x16x32_bf16 v[148:151], v[68:71], v[40:43], v[148:151]
    ds_read_b64_tr_b16 v[118:119], v15 offset:49152
    v_mfma_f32_16x16x32_bf16 v[160:163], v[64:67], v[48:51], v[160:163]
    ds_read_b64_tr_b16 v[120:121], v12 offset:57344
    v_mfma_f32_16x16x32_bf16 v[164:167], v[68:71], v[48:51], v[164:167]
    ds_read_b64_tr_b16 v[122:123], v13 offset:57344
    v_mfma_f32_16x16x32_bf16 v[176:179], v[64:67], v[56:59], v[176:179]
    ds_read_b64_tr_b16 v[124:125], v14 offset:57344
    v_mfma_f32_16x16x32_bf16 v[180:183], v[68:71], v[56:59], v[180:183]
    ds_read_b64_tr_b16 v[126:127], v15 offset:57344
    v_mfma_f32_16x16x32_bf16 v[128:131], v[72:75], v[36:39], v[128:131]
    ds_read_b128 v[80:83], v6 offset:32768
    v_mfma_f32_16x16x32_bf16 v[132:135], v[76:79], v[36:39], v[132:135]
    ds_read_b128 v[84:87], v6 offset:33792
    v_mfma_f32_16x16x32_bf16 v[144:147], v[72:75], v[44:47], v[144:147]
    ds_read_b128 v[88:91], v6 offset:34816
    v_mfma_f32_16x16x32_bf16 v[148:151], v[76:79], v[44:47], v[148:151]
    ds_read_b128 v[92:95], v6 offset:35840
    v_mfma_f32_16x16x32_bf16 v[160:163], v[72:75], v[52:55], v[160:163]
    ds_read_b128 v[96:99], v6 offset:36864
    v_mfma_f32_16x16x32_bf16 v[164:167], v[76:79], v[52:55], v[164:167]
    ds_read_b128 v[100:103], v6 offset:37888
    v_mfma_f32_16x16x32_bf16 v[176:179], v[72:75], v[60:63], v[176:179]
    ds_read_b128 v[104:107], v6 offset:38912
    v_mfma_f32_16x16x32_bf16 v[180:183], v[76:79], v[60:63], v[180:183]
    ds_read_b128 v[108:111], v6 offset:39936
    s_waitcnt lgkmcnt(0)
    s_waitcnt vmcnt(8)
    s_barrier
    s_add_u32 m0, s21, 98304
    s_nop 0
    buffer_load_dwordx4 v1, s[4:7], s16 offen sc1 lds
    s_add_u32 s16, s16, s62
    s_add_u32 m0, s21, 99328
    s_nop 0
    buffer_load_dwordx4 v1, s[4:7], s17 offen sc1 lds
    s_add_u32 s17, s17, s62
    s_add_u32 m0, s22, 98304
    s_nop 0
    buffer_load_dwordx4 v2, s[8:11], s18 offen lds
    s_add_u32 s18, s18, s20
    s_add_u32 m0, s22, 106496
    s_nop 0
    buffer_load_dwordx4 v2, s[12:15], s19 offen lds
    s_add_u32 s19, s19, s20
    v_mfma_f32_16x16x32_bf16 v[128:131], v[112:115], v[80:83], v[128:131]
    ds_read_b64_tr_b16 v[64:65], v8 offset:16384
    v_mfma_f32_16x16x32_bf16 v[132:135], v[116:119], v[80:83], v[132:135]
    ds_read_b64_tr_b16 v[66:67], v9 offset:16384
    v_mfma_f32_16x16x32_bf16 v[144:147], v[112:115], v[88:91], v[144:147]
    ds_read_b64_tr_b16 v[68:69], v10 offset:16384
    v_mfma_f32_16x16x32_bf16 v[148:151], v[116:119], v[88:91], v[148:151]
    ds_read_b64_tr_b16 v[70:71], v11 offset:16384
    v_mfma_f32_16x16x32_bf16 v[160:163], v[112:115], v[96:99], v[160:163]
    ds_read_b64_tr_b16 v[72:73], v8 offset:24576
    v_mfma_f32_16x16x32_bf16 v[164:167], v[116:119], v[96:99], v[164:167]
    ds_read_b64_tr_b16 v[74:75], v9 offset:24576
    v_mfma_f32_16x16x32_bf16 v[176:179], v[112:115], v[104:107], v[176:179]
    ds_read_b64_tr_b16 v[76:77], v10 offset:24576
    v_mfma_f32_16x16x32_bf16 v[180:183], v[116:119], v[104:107], v[180:183]
    ds_read_b64_tr_b16 v[78:79], v11 offset:24576
    v_mfma_f32_16x16x32_bf16 v[128:131], v[120:123], v[84:87], v[128:131]
    ds_read_b128 v[32:35], v5 offset:0
    v_mfma_f32_16x16x32_bf16 v[132:135], v[124:127], v[84:87], v[132:135]
    ds_read_b128 v[36:39], v5 offset:1024
    v_mfma_f32_16x16x32_bf16 v[144:147], v[120:123], v[92:95], v[144:147]
    ds_read_b128 v[40:43], v5 offset:2048
    v_mfma_f32_16x16x32_bf16 v[148:151], v[124:127], v[92:95], v[148:151]
    ds_read_b128 v[44:47], v5 offset:3072
    v_mfma_f32_16x16x32_bf16 v[160:163], v[120:123], v[100:103], v[160:163]
    ds_read_b128 v[48:51], v5 offset:4096
    v_mfma_f32_16x16x32_bf16 v[164:167], v[124:127], v[100:103], v[164:167]
    ds_read_b128 v[52:55], v5 offset:5120
    v_mfma_f32_16x16x32_bf16 v[176:179], v[120:123], v[108:111], v[176:179]
    ds_read_b128 v[56:59], v5 offset:6144
    v_mfma_f32_16x16x32_bf16 v[180:183], v[124:127], v[108:111], v[180:183]
    ds_read_b128 v[60:63], v5 offset:7168
    s_waitcnt lgkmcnt(0)
    s_sub_u32 s23, s23, 1
    s_cmp_lg_u32 s23, 0
    s_cbranch_scc1 w_loopH
    v_mov_b32 v20, 131072
    ds_read_b128 v[24:27], v20
    ds_read_b128 v[28:31], v20 offset:16
    s_lshl_b32 s30, s27, 10
    s_add_u32 s30, s30, s49
    s_nop 7
    v_cvt_pk_bf16_f32 v80, v128, v129
    v_cvt_pk_bf16_f32 v81, v130, v131
    v_cvt_pk_bf16_f32 v82, v132, v133
    v_cvt_pk_bf16_f32 v83, v134, v135
    buffer_store_dwordx4 v[80:83], v1, s[4:7], s30 offen sc1
    s_add_u32 s30, s30, s50
    v_cvt_pk_bf16_f32 v84, v144, v145
    v_cvt_pk_bf16_f32 v85, v146, v147
    v_cvt_pk_bf16_f32 v86, v148, v149
    v_cvt_pk_bf16_f32 v87, v150, v151
    buffer_store_dwordx4 v[84:87], v1, s[4:7], s30 offen sc1
    s_add_u32 s30, s30, s50
    v_cvt_pk_bf16_f32 v88, v160, v161
    v_cvt_pk_bf16_f32 v89, v162, v163
    v_cvt_pk_bf16_f32 v90, v164, v165
    v_cvt_pk_bf16_f32 v91, v166, v167
    buffer_store_dwordx4 v[88:91], v1, s[4:7], s30 offen sc1
    s_add_u32 s30, s30, s50
    v_cvt_pk_bf16_f32 v92, v176, v177
    v_cvt_pk_bf16_f32 v93, v178, v179
    v_cvt_pk_bf16_f32 v94, v180, v181
    v_cvt_pk_bf16_f32 v95, v182, v183
    buffer_store_dwordx4 v[92:95], v1, s[4:7], s30 offen sc1
    s_add_u32 s30, s30, s50
    s_waitcnt lgkmcnt(0)
    v_or3_b32 v24, v24, v25, v26
    v_or3_b32 v28, v28, v29, v30
    v_or3_b32 v24, v24, v27, v31
    v_or_b32 v24, v24, v28
    s_mov_b32 s28, s51
    v_readfirstlane_b32 s30, v24
    s_cmp_lg_u32 s30, 0
    s_cbranch_scc1 w_drain
    s_mov_b32 s48, s32
    s_cmp_eq_u32 s32, 4
    s_cselect_b32 s30, 2, 3
    s_lshl_b32 s30, s26, s30
    s_mul_i32 s30, s30, s43
    s_add_u32 s49, s42, s30
    s_mov_b32 s50, s43
    s_mov_b32 s51, s46
    s_mov_b32 s23, s41
    s_mov_b32 s53, s47
    s_nop 0
    s_load_dwordx16 s[32:47], s[24:25], 0
    s_add_u32 s24, s24, 64
    s_addc_u32 s25, s25, 0
    s_branch w_first4
w_drain:
    s_waitcnt vmcnt(0)
    s_barrier
    s_cmp_eq_u32 s70, 0
    s_cbranch_scc1 drw_ok
    s_mov_b32 s70, 0
    s_cmp_lg_u32 s3, 0
    s_cbranch_scc1 drw_ok
    v_readfirstlane_b32 s68, v22
    s_cmp_ge_u32 s68, 128
    s_cbranch_scc1 drw_ok
    s_mov_b32 s69, 65536
drw:
    buffer_load_dword v20, off, s[64:67], 0 offset:0 sc1
    s_waitcnt vmcnt(0)
    v_readfirstlane_b32 s68, v20
    s_cmp_ge_u32 s68, 128
    s_cbranch_scc1 drw_ok
    s_sleep 8
    s_sub_u32 s69, s69, 1
    s_cbranch_scc0 drw
drw_ok:
    s_cmp_eq_u32 s28, 0
    s_cbranch_scc1 sig_5
    s_cmp_lg_u32 s3, 0
    s_cbranch_scc1 sig_5
    s_and_b32 s57, s28, 3
    v_mov_b32 v24, s57
    s_bfe_u32 s57, s28, 0x20002
    v_mov_b32 v25, s57
    s_andn2_b32 s28, s28, 15
    s_mov_b64 exec, 1
    buffer_atomic_add_x2 v[24:25], v17, s[4:7], s28 offen sc1
    s_mov_b64 exec, -1
sig_5:
    s_mov_b32 s28, 0
    s_branch w_cold
w_att:
    s_cmp_lg_u32 s3, 0
    s_cbranch_scc1 w_att_go
    s_mov_b32 s31, 0x40000
w_att_w:
    buffer_load_dwordx2 v[20:21], off, s[4:7], s33 sc1
    s_waitcnt vmcnt(0)
    v_add_u32 v20, v20, v21
    s_nop 0
    v_readfirstlane_b32 s30, v20
    s_cmp_ge_u32 s30, 8
    s_cbranch_scc1 w_att_go
    s_sleep 16
    s_sub_u32 s31, s31, 1
    s_cbranch_scc0 w_att_w
w_att_go:
    s_barrier
    v_lshrrev_b32 v20, 4, v1
    v_lshrrev_b32 v21, 4, v20
    v_and_b32 v22, 15, v20
    v_lshlrev_b32 v23, 2, v21
    v_add_u32 v24, 0, v23
    v_cmp_gt_u32 s[72:73], v24, v22
    v_add_u32 v24, 1, v23
    v_cmp_gt_u32 s[74:75], v24, v22
    v_add_u32 v24, 2, v23
    v_cmp_gt_u32 s[76:77], v24, v22
    v_add_u32 v24, 3, v23
    v_cmp_gt_u32 s[78:79], v24, v22
    s_mul_i32 s83, s3, 10240
    v_and_b32 v22, 3, v20
    v_bfe_u32 v24, v20, 2, 2
    v_add_u32 v23, v23, v24
    v_lshl_add_u32 v23, v22, 4, v23
    v_lshlrev_b32 v23, 4, v23
    v_add_u32 v25, s83, v23
    v_and_b32 v24, 1, v24
    v_lshl_add_u32 v24, v21, 1, v24
    v_lshl_add_u32 v24, v22, 3, v24
    v_lshlrev_b32 v24, 4, v24
    v_add_u32 v26, s83, v24
    v_mov_b32 v22, 0xff61b1e6
    v_mov_b32 v136, 0
    v_mov_b32 v137, 0
    v_mov_b32 v220, 0
    v_mov_b32 v221, 0
    s_mov_b32 s80, 0x3e0293ee
    s_lshr_b32 s85, s3, 2
    s_add_u32 s85, s85, s39
    s_lshl_b32 s81, s85, 18
    s_and_b32 s85, s3, 3
    s_add_u32 s85, s85, s36
    s_lshl_b32 s82, s85, 13
    s_add_u32 s82, s82, s81
    s_add_u32 s82, s82, 192937984
    s_lshl_b32 s85, s85, 12
    s_add_u32 s81, s81, s85
    v_mov_b32 v28, 0x3f803f80
    v_mov_b32 v29, 0x3f803f80
    v_mov_b32 v30, 0x3f803f80
    v_mov_b32 v31, 0x3f803f80
    s_add_u32 s86, s82, 0
    buffer_load_dwordx4 v[120:123], v1, s[4:7], s86 offen offset:0 sc1
    buffer_load_dwordx4 v[124:127], v1, s[4:7], s86 offen offset:1024 sc1
    buffer_load_dwordx4 v[128:131], v1, s[4:7], s86 offen offset:2048 sc1
    buffer_load_dwordx4 v[132:135], v1, s[4:7], s86 offen offset:3072 sc1
    s_add_u32 s85, s81, 4194304
    buffer_load_dwordx4 v[56:59], v1, s[4:7], s85 offen offset:0 sc1
    buffer_load_dwordx4 v[60:63], v1, s[4:7], s85 offen offset:1024 sc1
    buffer_load_dwordx4 v[64:67], v1, s[4:7], s85 offen offset:2048 sc1
    buffer_load_dwordx4 v[68:71], v1, s[4:7], s85 offen offset:3072 sc1
    s_add_u32 s85, s81, 4325376
    buffer_load_dwordx4 v[72:75], v1, s[4:7], s85 offen offset:0 sc1
    buffer_load_dwordx4 v[76:79], v1, s[4:7], s85 offen offset:1024 sc1
    buffer_load_dwordx4 v[80:83], v1, s[4:7], s85 offen offset:2048 sc1
    buffer_load_dwordx4 v[84:87], v1, s[4:7], s85 offen offset:3072 sc1
    s_add_u32 s85, s81, 20971520
    buffer_load_dwordx4 v[88:91], v1, s[4:7], s85 offen offset:0 sc1
    buffer_load_dwordx4 v[92:95], v1, s[4:7], s85 offen offset:1024 sc1
    buffer_load_dwordx4 v[96:99], v1, s[4:7], s85 offen offset:2048 sc1
    buffer_load_dwordx4 v[100:103], v1, s[4:7], s85 offen offset:3072 sc1
    s_add_u32 s85, s81, 21102592
    buffer_load_dwordx4 v[104:107], v1, s[4:7], s85 offen offset:0 sc1
    buffer_load_dwordx4 v[108:111], v1, s[4:7], s85 offen offset:1024 sc1
    buffer_load_dwordx4 v[112:115], v1, s[4:7], s85 offen offset:2048 sc1
    buffer_load_dwordx4 v[116:119], v1, s[4:7], s85 offen offset:3072 sc1
    s_add_u32 m0, s83, 0
    s_add_u32 s85, s81, 37748736
    buffer_load_dwordx4 v1, s[4:7], s85 offen offset:0 sc1 lds
    buffer_load_dwordx4 v1, s[4:7], s85 offen offset:1024 sc1 lds
    buffer_load_dwordx4 v1, s[4:7], s85 offen offset:2048 sc1 lds
    buffer_load_dwordx4 v1, s[4:7], s85 offen offset:3072 sc1 lds
    s_add_u32 m0, s83, 4096
    s_add_u32 s85, s81, 37879808
    buffer_load_dwordx4 v1, s[4:7], s85 offen offset:0 sc1 lds
    buffer_load_dwordx4 v1, s[4:7], s85 offen offset:1024 sc1 lds
    buffer_load_dwordx4 v1, s[4:7], s85 offen offset:2048 sc1 lds
    buffer_load_dwordx4 v1, s[4:7], s85 offen offset:3072 sc1 lds
    s_add_u32 m0, s83, 8192
    s_add_u32 s85, s82, 4096
    buffer_load_dwordx4 v1, s[4:7], s85 offen offset:0 sc1 lds
    buffer_load_dwordx4 v1, s[4:7], s85 offen offset:1024 sc1 lds
    s_add_u32 s86, s82, 524288
    buffer_load_dwordx4 v[204:207], v1, s[4:7], s86 offen offset:0 sc1
    buffer_load_dwordx4 v[208:211], v1, s[4:7], s86 offen offset:1024 sc1
    buffer_load_dwordx4 v[212:215], v1, s[4:7], s86 offen offset:2048 sc1
    buffer_load_dwordx4 v[216:219], v1, s[4:7], s86 offen offset:3072 sc1
    s_add_u32 s85, s81, 4718592
    buffer_load_dwordx4 v[140:143], v1, s[4:7], s85 offen offset:0 sc1
    buffer_load_dwordx4 v[144:147], v1, s[4:7], s85 offen offset:1024 sc1
    buffer_load_dwordx4 v[148:151], v1, s[4:7], s85 offen offset:2048 sc1
    buffer_load_dwordx4 v[152:155], v1, s[4:7], s85 offen offset:3072 sc1
    s_add_u32 s85, s81, 4849664
    buffer_load_dwordx4 v[156:159], v1, s[4:7], s85 offen offset:0 sc1
    buffer_load_dwordx4 v[160:163], v1, s[4:7], s85 offen offset:1024 sc1
    buffer_load_dwordx4 v[164:167], v1, s[4:7], s85 offen offset:2048 sc1
    buffer_load_dwordx4 v[168:171], v1, s[4:7], s85 offen offset:3072 sc1
    s_add_u32 s85, s81, 21495808
    buffer_load_dwordx4 v[172:175], v1, s[4:7], s85 offen offset:0 sc1
    buffer_load_dwordx4 v[176:179], v1, s[4:7], s85 offen offset:1024 sc1
    buffer_load_dwordx4 v[180:183], v1, s[4:7], s85 offen offset:2048 sc1
    buffer_load_dwordx4 v[184:187], v1, s[4:7], s85 offen offset:3072 sc1
    s_add_u32 s85, s81, 21626880
    buffer_load_dwordx4 v[188:191], v1, s[4:7], s85 offen offset:0 sc1
    buffer_load_dwordx4 v[192:195], v1, s[4:7], s85 offen offset:1024 sc1
    buffer_load_dwordx4 v[196:199], v1, s[4:7], s85 offen offset:2048 sc1
    buffer_load_dwordx4 v[200:203], v1, s[4:7], s85 offen offset:3072 sc1
    s_add_u32 m0, s83, 81920
    s_add_u32 s85, s81, 38273024
    buffer_load_dwordx4 v1, s[4:7], s85 offen offset:0 sc1 lds
    buffer_load_dwordx4 v1, s[4:7], s85 offen offset:1024 sc1 lds
    buffer_load_dwordx4 v1, s[4:7], s85 offen offset:2048 sc1 lds
    buffer_load_dwordx4 v1, s[4:7], s85 offen offset:3072 sc1 lds
    s_add_u32 m0, s83, 86016
    s_add_u32 s85, s81, 38404096
    buffer_load_dwordx4 v1, s[4:7], s85 offen offset:0 sc1 lds
    buffer_load_dwordx4 v1, s[4:7], s85 offen offset:1024 sc1 lds
    buffer_load_dwordx4 v1, s[4:7], s85 offen offset:2048 sc1 lds
    buffer_load_dwordx4 v1, s[4:7], s85 offen offset:3072 sc1 lds
    s_add_u32 m0, s83, 90112
    s_add_u32 s85, s82, 528384
    buffer_load_dwordx4 v1, s[4:7], s85 offen offset:0 sc1 lds
    buffer_load_dwordx4 v1, s[4:7], s85 offen offset:1024 sc1 lds
    s_waitcnt vmcnt(40)
    v_mfma_f32_16x16x32_bf16 v[32:35], v[88:91], v[56:59], 0
    v_mfma_f32_16x16x32_bf16 v[40:43], v[120:123], v[56:59], 0
    v_mfma_f32_16x16x32_bf16 v[32:35], v[92:95], v[60:63], v[32:35]
    v_mfma_f32_16x16x32_bf16 v[40:43], v[124:127], v[60:63], v[40:43]
    v_mfma_f32_16x16x32_bf16 v[32:35], v[96:99], v[64:67], v[32:35]
    v_mfma_f32_16x16x32_bf16 v[40:43], v[128:131], v[64:67], v[40:43]
    v_mfma_f32_16x16x32_bf16 v[32:35], v[100:103], v[68:71], v[32:35]
    v_mfma_f32_16x16x32_bf16 v[40:43], v[132:135], v[68:71], v[40:43]
    v_mfma_f32_16x16x32_bf16 v[44:47], v[88:91], v[72:75], 0
    v_mfma_f32_16x16x32_bf16 v[48:51], v[104:107], v[72:75], 0
    v_mfma_f32_16x16x32_bf16 v[52:55], v[120:123], v[72:75], 0
    v_mfma_f32_16x16x32_bf16 v[44:47], v[92:95], v[76:79], v[44:47]
    v_mfma_f32_16x16x32_bf16 v[48:51], v[108:111], v[76:79], v[48:51]
    v_mfma_f32_16x16x32_bf16 v[52:55], v[124:127], v[76:79], v[52:55]
    v_mfma_f32_16x16x32_bf16 v[44:47], v[96:99], v[80:83], v[44:47]
    v_mfma_f32_16x16x32_bf16 v[48:51], v[112:115], v[80:83], v[48:51]
    v_mfma_f32_16x16x32_bf16 v[52:55], v[128:131], v[80:83], v[52:55]
    v_mfma_f32_16x16x32_bf16 v[44:47], v[100:103], v[84:87], v[44:47]
    v_mfma_f32_16x16x32_bf16 v[48:51], v[116:119], v[84:87], v[48:51]
    v_mfma_f32_16x16x32_bf16 v[52:55], v[132:135], v[84:87], v[52:55]
    v_cndmask_b32 v32, v32, v22, s[72:73]
    v_cndmask_b32 v33, v33, v22, s[74:75]
    v_cndmask_b32 v34, v34, v22, s[76:77]
    v_cndmask_b32 v35, v35, v22, s[78:79]
    v_max3_f32 v20, v32, v33, v34
    v_max3_f32 v21, v35, v40, v41
    v_max_f32 v20, v20, v21
    v_mov_b32 v21, v20
    s_nop 1
    v_permlane16_swap_b32 v21, v20
    v_max_f32 v20, v20, v21
    v_mov_b32 v21, v20
    s_nop 1
    v_permlane32_swap_b32 v21, v20
    v_max_f32 v20, v20, v21
    v_mul_f32 v20, s80, v20
    v_fma_f32 v32, v32, s80, -v20
    v_fma_f32 v33, v33, s80, -v20
    v_fma_f32 v34, v34, s80, -v20
    v_fma_f32 v35, v35, s80, -v20
    v_fma_f32 v40, v40, s80, -v20
    v_fma_f32 v41, v41, s80, -v20
    v_exp_f32 v32, v32
    v_exp_f32 v33, v33
    v_exp_f32 v34, v34
    v_exp_f32 v35, v35
    v_exp_f32 v40, v40
    v_exp_f32 v41, v41
    s_nop 0
    v_cvt_pk_bf16_f32 v32, v32, v33
    v_cvt_pk_bf16_f32 v33, v34, v35
    v_mov_b32 v34, 0
    v_mov_b32 v35, 0
    v_cvt_pk_bf16_f32 v40, v40, v41
    v_mov_b32 v41, 0
    v_mov_b32 v42, 0
    v_mov_b32 v43, 0
    s_nop 1
    s_waitcnt vmcnt(30)
    ds_read_b64_tr_b16 v[56:57], v25 offset:0
    ds_read_b64_tr_b16 v[58:59], v25 offset:4096
    ds_read_b64_tr_b16 v[120:121], v26 offset:8192
    ds_read_b64_tr_b16 v[60:61], v25 offset:8
    ds_read_b64_tr_b16 v[62:63], v25 offset:4104
    ds_read_b64_tr_b16 v[122:123], v26 offset:8200
    ds_read_b64_tr_b16 v[64:65], v25 offset:1024
    ds_read_b64_tr_b16 v[66:67], v25 offset:5120
    ds_read_b64_tr_b16 v[124:125], v26 offset:8704
    ds_read_b64_tr_b16 v[68:69], v25 offset:1032
    ds_read_b64_tr_b16 v[70:71], v25 offset:5128
    ds_read_b64_tr_b16 v[126:127], v26 offset:8712
    ds_read_b64_tr_b16 v[72:73], v25 offset:2048
    ds_read_b64_tr_b16 v[74:75], v25 offset:6144
    ds_read_b64_tr_b16 v[128:129], v26 offset:9216
    ds_read_b64_tr_b16 v[76:77], v25 offset:2056
    ds_read_b64_tr_b16 v[78:79], v25 offset:6152
    ds_read_b64_tr_b16 v[130:131], v26 offset:9224
    ds_read_b64_tr_b16 v[80:81], v25 offset:3072
    ds_read_b64_tr_b16 v[82:83], v25 offset:7168
    ds_read_b64_tr_b16 v[132:133], v26 offset:9728
    ds_read_b64_tr_b16 v[84:85], v25 offset:3080
    ds_read_b64_tr_b16 v[86:87], v25 offset:7176
    ds_read_b64_tr_b16 v[134:135], v26 offset:9736
    v_cndmask_b32 v48, v48, v22, s[72:73]
    v_cndmask_b32 v49, v49, v22, s[74:75]
    v_cndmask_b32 v50, v50, v22, s[76:77]
    v_cndmask_b32 v51, v51, v22, s[78:79]
    v_max3_f32 v20, v44, v45, v46
    v_max3_f32 v21, v47, v48, v49
    v_max3_f32 v20, v20, v50, v51
    v_max3_f32 v21, v21, v52, v53
    v_max_f32 v20, v20, v21
    v_mov_b32 v21, v20
    s_nop 1
    v_permlane16_swap_b32 v21, v20
    v_max_f32 v20, v20, v21
    v_mov_b32 v21, v20
    s_nop 1
    v_permlane32_swap_b32 v21, v20
    v_max_f32 v20, v20, v21
    v_mul_f32 v20, s80, v20
    v_fma_f32 v44, v44, s80, -v20
    v_fma_f32 v45, v45, s80, -v20
    v_fma_f32 v46, v46, s80, -v20
    v_fma_f32 v47, v47, s80, -v20
    v_fma_f32 v48, v48, s80, -v20
    v_fma_f32 v49, v49, s80, -v20
    v_fma_f32 v50, v50, s80, -v20
    v_fma_f32 v51, v51, s80, -v20
    v_fma_f32 v52, v52, s80, -v20
    v_fma_f32 v53, v53, s80, -v20
    v_exp_f32 v44, v44
    v_exp_f32 v45, v45
    v_exp_f32 v46, v46
    v_exp_f32 v47, v47
    v_exp_f32 v48, v48
    v_exp_f32 v49, v49
    v_exp_f32 v50, v50
    v_exp_f32 v51, v51
    v_exp_f32 v52, v52
    v_exp_f32 v53, v53
    s_nop 0
    v_cvt_pk_bf16_f32 v44, v44, v45
    v_cvt_pk_bf16_f32 v45, v46, v47
    v_cvt_pk_bf16_f32 v46, v48, v49
    v_cvt_pk_bf16_f32 v47, v50, v51
    v_cvt_pk_bf16_f32 v52, v52, v53
    v_mov_b32 v53, 0
    v_mov_b32 v54, 0
    v_mov_b32 v55, 0
    s_nop 1
    s_waitcnt lgkmcnt(0)
    v_mfma_f32_16x16x32_bf16 v[36:39], v[28:31], v[32:35], 0
    v_mfma_f32_16x16x32_bf16 v[36:39], v[28:31], v[40:43], v[36:39]
    v_mfma_f32_16x16x32_bf16 v[88:91], v[56:59], v[32:35], 0
    v_mfma_f32_16x16x32_bf16 v[88:91], v[120:123], v[40:43], v[88:91]
    v_mfma_f32_16x16x32_bf16 v[92:95], v[60:63], v[32:35], 0
    v_mfma_f32_16x16x32_bf16 v[92:95], v[122:125], v[40:43], v[92:95]
    v_mfma_f32_16x16x32_bf16 v[96:99], v[64:67], v[32:35], 0
    v_mfma_f32_16x16x32_bf16 v[96:99], v[124:127], v[40:43], v[96:99]
    v_mfma_f32_16x16x32_bf16 v[100:103], v[68:71], v[32:35], 0
    v_mfma_f32_16x16x32_bf16 v[100:103], v[126:129], v[40:43], v[100:103]
    v_mfma_f32_16x16x32_bf16 v[104:107], v[72:75], v[32:35], 0
    v_mfma_f32_16x16x32_bf16 v[104:107], v[128:131], v[40:43], v[104:107]
    v_mfma_f32_16x16x32_bf16 v[108:111], v[76:79], v[32:35], 0
    v_mfma_f32_16x16x32_bf16 v[108:111], v[130:133], v[40:43], v[108:111]
    v_mfma_f32_16x16x32_bf16 v[112:115], v[80:83], v[32:35], 0
    v_mfma_f32_16x16x32_bf16 v[112:115], v[132:135], v[40:43], v[112:115]
    v_mfma_f32_16x16x32_bf16 v[116:119], v[84:87], v[32:35], 0
    v_mfma_f32_16x16x32_bf16 v[116:119], v[134:137], v[40:43], v[116:119]
    v_rcp_f32 v23, v36
    s_add_u32 s85, s81, 176160768
    v_mul_f32 v88, v88, v23
    v_mul_f32 v89, v89, v23
    v_mul_f32 v90, v90, v23
    v_mul_f32 v91, v91, v23
    v_mul_f32 v92, v92, v23
    v_mul_f32 v93, v93, v23
    v_mul_f32 v94, v94, v23
    v_mul_f32 v95, v95, v23
    v_cvt_pk_bf16_f32 v224, v88, v89
    v_cvt_pk_bf16_f32 v225, v90, v91
    v_cvt_pk_bf16_f32 v226, v92, v93
    v_cvt_pk_bf16_f32 v227, v94, v95
    buffer_store_dwordx4 v[224:227], v1, s[4:7], s85 offen offset:0 sc1
    v_mul_f32 v96, v96, v23
    v_mul_f32 v97, v97, v23
    v_mul_f32 v98, v98, v23
    v_mul_f32 v99, v99, v23
    v_mul_f32 v100, v100, v23
    v_mul_f32 v101, v101, v23
    v_mul_f32 v102, v102, v23
    v_mul_f32 v103, v103, v23
    v_cvt_pk_bf16_f32 v228, v96, v97
    v_cvt_pk_bf16_f32 v229, v98, v99
    v_cvt_pk_bf16_f32 v230, v100, v101
    v_cvt_pk_bf16_f32 v231, v102, v103
    buffer_store_dwordx4 v[228:231], v1, s[4:7], s85 offen offset:1024 sc1
    v_mul_f32 v104, v104, v23
    v_mul_f32 v105, v105, v23
    v_mul_f32 v106, v106, v23
    v_mul_f32 v107, v107, v23
    v_mul_f32 v108, v108, v23
    v_mul_f32 v109, v109, v23
    v_mul_f32 v110, v110, v23
    v_mul_f32 v111, v111, v23
    v_cvt_pk_bf16_f32 v232, v104, v105
    v_cvt_pk_bf16_f32 v233, v106, v107
    v_cvt_pk_bf16_f32 v234, v108, v109
    v_cvt_pk_bf16_f32 v235, v110, v111
    buffer_store_dwordx4 v[232:235], v1, s[4:7], s85 offen offset:2048 sc1
    v_mul_f32 v112, v112, v23
    v_mul_f32 v113, v113, v23
    v_mul_f32 v114, v114, v23
    v_mul_f32 v115, v115, v23
    v_mul_f32 v116, v116, v23
    v_mul_f32 v117, v117, v23
    v_mul_f32 v118, v118, v23
    v_mul_f32 v119, v119, v23
    v_cvt_pk_bf16_f32 v236, v112, v113
    v_cvt_pk_bf16_f32 v237, v114, v115
    v_cvt_pk_bf16_f32 v238, v116, v117
    v_cvt_pk_bf16_f32 v239, v118, v119
    buffer_store_dwordx4 v[236:239], v1, s[4:7], s85 offen offset:3072 sc1
    v_mfma_f32_16x16x32_bf16 v[48:51], v[28:31], v[44:47], 0
    v_mfma_f32_16x16x32_bf16 v[48:51], v[28:31], v[52:55], v[48:51]
    v_mfma_f32_16x16x32_bf16 v[88:91], v[56:59], v[44:47], 0
    v_mfma_f32_16x16x32_bf16 v[88:91], v[120:123], v[52:55], v[88:91]
    v_mfma_f32_16x16x32_bf16 v[92:95], v[60:63], v[44:47], 0
    v_mfma_f32_16x16x32_bf16 v[92:95], v[122:125], v[52:55], v[92:95]
    v_mfma_f32_16x16x32_bf16 v[96:99], v[64:67], v[44:47], 0
    v_mfma_f32_16x16x32_bf16 v[96:99], v[124:127], v[52:55], v[96:99]
    v_mfma_f32_16x16x32_bf16 v[100:103], v[68:71], v[44:47], 0
    v_mfma_f32_16x16x32_bf16 v[100:103], v[126:129], v[52:55], v[100:103]
    v_mfma_f32_16x16x32_bf16 v[104:107], v[72:75], v[44:47], 0
    v_mfma_f32_16x16x32_bf16 v[104:107], v[128:131], v[52:55], v[104:107]
    v_mfma_f32_16x16x32_bf16 v[108:111], v[76:79], v[44:47], 0
    v_mfma_f32_16x16x32_bf16 v[108:111], v[130:133], v[52:55], v[108:111]
    v_mfma_f32_16x16x32_bf16 v[112:115], v[80:83], v[44:47], 0
    v_mfma_f32_16x16x32_bf16 v[112:115], v[132:135], v[52:55], v[112:115]
    v_mfma_f32_16x16x32_bf16 v[116:119], v[84:87], v[44:47], 0
    v_mfma_f32_16x16x32_bf16 v[116:119], v[134:137], v[52:55], v[116:119]
    v_rcp_f32 v23, v48
    s_add_u32 s85, s81, 176291840
    v_mul_f32 v88, v88, v23
    v_mul_f32 v89, v89, v23
    v_mul_f32 v90, v90, v23
    v_mul_f32 v91, v91, v23
    v_mul_f32 v92, v92, v23
    v_mul_f32 v93, v93, v23
    v_mul_f32 v94, v94, v23
    v_mul_f32 v95, v95, v23
    v_cvt_pk_bf16_f32 v224, v88, v89
    v_cvt_pk_bf16_f32 v225, v90, v91
    v_cvt_pk_bf16_f32 v226, v92, v93
    v_cvt_pk_bf16_f32 v227, v94, v95
    buffer_store_dwordx4 v[224:227], v1, s[4:7], s85 offen offset:0 sc1
    v_mul_f32 v96, v96, v23
    v_mul_f32 v97, v97, v23
    v_mul_f32 v98, v98, v23
    v_mul_f32 v99, v99, v23
    v_mul_f32 v100, v100, v23
    v_mul_f32 v101, v101, v23
    v_mul_f32 v102, v102, v23
    v_mul_f32 v103, v103, v23
    v_cvt_pk_bf16_f32 v228, v96, v97
    v_cvt_pk_bf16_f32 v229, v98, v99
    v_cvt_pk_bf16_f32 v230, v100, v101
    v_cvt_pk_bf16_f32 v231, v102, v103
    buffer_store_dwordx4 v[228:231], v1, s[4:7], s85 offen offset:1024 sc1
    v_mul_f32 v104, v104, v23
    v_mul_f32 v105, v105, v23
    v_mul_f32 v106, v106, v23
    v_mul_f32 v107, v107, v23
    v_mul_f32 v108, v108, v23
    v_mul_f32 v109, v109, v23
    v_mul_f32 v110, v110, v23
    v_mul_f32 v111, v111, v23
    v_cvt_pk_bf16_f32 v232, v104, v105
    v_cvt_pk_bf16_f32 v233, v106, v107
    v_cvt_pk_bf16_f32 v234, v108, v109
    v_cvt_pk_bf16_f32 v235, v110, v111
    buffer_store_dwordx4 v[232:235], v1, s[4:7], s85 offen offset:2048 sc1
    v_mul_f32 v112, v112, v23
    v_mul_f32 v113, v113, v23
    v_mul_f32 v114, v114, v23
    v_mul_f32 v115, v115, v23
    v_mul_f32 v116, v116, v23
    v_mul_f32 v117, v117, v23
    v_mul_f32 v118, v118, v23
    v_mul_f32 v119, v119, v23
    v_cvt_pk_bf16_f32 v236, v112, v113
    v_cvt_pk_bf16_f32 v237, v114, v115
    v_cvt_pk_bf16_f32 v238, v116, v117
    v_cvt_pk_bf16_f32 v239, v118, v119
    buffer_store_dwordx4 v[236:239], v1, s[4:7], s85 offen offset:3072 sc1
    s_waitcnt vmcnt(18)
    v_mfma_f32_16x16x32_bf16 v[32:35], v[172:175], v[140:143], 0
    v_mfma_f32_16x16x32_bf16 v[40:43], v[204:207], v[140:143], 0
    v_mfma_f32_16x16x32_bf16 v[32:35], v[176:179], v[144:147], v[32:35]
    v_mfma_f32_16x16x32_bf16 v[40:43], v[208:211], v[144:147], v[40:43]
    v_mfma_f32_16x16x32_bf16 v[32:35], v[180:183], v[148:151], v[32:35]
    v_mfma_f32_16x16x32_bf16 v[40:43], v[212:215], v[148:151], v[40:43]
    v_mfma_f32_16x16x32_bf16 v[32:35], v[184:187], v[152:155], v[32:35]
    v_mfma_f32_16x16x32_bf16 v[40:43], v[216:219], v[152:155], v[40:43]
    v_mfma_f32_16x16x32_bf16 v[44:47], v[172:175], v[156:159], 0
    v_mfma_f32_16x16x32_bf16 v[48:51], v[188:191], v[156:159], 0
    v_mfma_f32_16x16x32_bf16 v[52:55], v[204:207], v[156:159], 0
    v_mfma_f32_16x16x32_bf16 v[44:47], v[176:179], v[160:163], v[44:47]
    v_mfma_f32_16x16x32_bf16 v[48:51], v[192:195], v[160:163], v[48:51]
    v_mfma_f32_16x16x32_bf16 v[52:55], v[208:211], v[160:163], v[52:55]
    v_mfma_f32_16x16x32_bf16 v[44:47], v[180:183], v[164:167], v[44:47]
    v_mfma_f32_16x16x32_bf16 v[48:51], v[196:199], v[164:167], v[48:51]
    v_mfma_f32_16x16x32_bf16 v[52:55], v[212:215], v[164:167], v[52:55]
    v_mfma_f32_16x16x32_bf16 v[44:47], v[184:187], v[168:171], v[44:47]
    v_mfma_f32_16x16x32_bf16 v[48:51], v[200:203], v[168:171], v[48:51]
    v_mfma_f32_16x16x32_bf16 v[52:55], v[216:219], v[168:171], v[52:55]
    v_cndmask_b32 v32, v32, v22, s[72:73]
    v_cndmask_b32 v33, v33, v22, s[74:75]
    v_cndmask_b32 v34, v34, v22, s[76:77]
    v_cndmask_b32 v35, v35, v22, s[78:79]
    v_max3_f32 v20, v32, v33, v34
    v_max3_f32 v21, v35, v40, v41
    v_max_f32 v20, v20, v21
    v_mov_b32 v21, v20
    s_nop 1
    v_permlane16_swap_b32 v21, v20
    v_max_f32 v20, v20, v21
    v_mov_b32 v21, v20
    s_nop 1
    v_permlane32_swap_b32 v21, v20
    v_max_f32 v20, v20, v21
    v_mul_f32 v20, s80, v20
    v_fma_f32 v32, v32, s80, -v20
    v_fma_f32 v33, v33, s80, -v20
    v_fma_f32 v34, v34, s80, -v20
    v_fma_f32 v35, v35, s80, -v20
    v_fma_f32 v40, v40, s80, -v20
    v_fma_f32 v41, v41, s80, -v20
    v_exp_f32 v32, v32
    v_exp_f32 v33, v33
    v_exp_f32 v34, v34
    v_exp_f32 v35, v35
    v_exp_f32 v40, v40
    v_exp_f32 v41, v41
    s_nop 0
    v_cvt_pk_bf16_f32 v32, v32, v33
    v_cvt_pk_bf16_f32 v33, v34, v35
    v_mov_b32 v34, 0
    v_mov_b32 v35, 0
    v_cvt_pk_bf16_f32 v40, v40, v41
    v_mov_b32 v41, 0
    v_mov_b32 v42, 0
    v_mov_b32 v43, 0
    s_nop 1
    s_waitcnt vmcnt(8)
    v_add_u32 v25, 81920, v25
    v_add_u32 v26, 81920, v26
    ds_read_b64_tr_b16 v[140:141], v25 offset:0
    ds_read_b64_tr_b16 v[142:143], v25 offset:4096
    ds_read_b64_tr_b16 v[204:205], v26 offset:8192
    ds_read_b64_tr_b16 v[144:145], v25 offset:8
    ds_read_b64_tr_b16 v[146:147], v25 offset:4104
    ds_read_b64_tr_b16 v[206:207], v26 offset:8200
    ds_read_b64_tr_b16 v[148:149], v25 offset:1024
    ds_read_b64_tr_b16 v[150:151], v25 offset:5120
    ds_read_b64_tr_b16 v[208:209], v26 offset:8704
    ds_read_b64_tr_b16 v[152:153], v25 offset:1032
    ds_read_b64_tr_b16 v[154:155], v25 offset:5128
    ds_read_b64_tr_b16 v[210:211], v26 offset:8712
    ds_read_b64_tr_b16 v[156:157], v25 offset:2048
    ds_read_b64_tr_b16 v[158:159], v25 offset:6144
    ds_read_b64_tr_b16 v[212:213], v26 offset:9216
    ds_read_b64_tr_b16 v[160:161], v25 offset:2056
    ds_read_b64_tr_b16 v[162:163], v25 offset:6152
    ds_read_b64_tr_b16 v[214:215], v26 offset:9224
    ds_read_b64_tr_b16 v[164:165], v25 offset:3072
    ds_read_b64_tr_b16 v[166:167], v25 offset:7168
    ds_read_b64_tr_b16 v[216:217], v26 offset:9728
    ds_read_b64_tr_b16 v[168:169], v25 offset:3080
    ds_read_b64_tr_b16 v[170:171], v25 offset:7176
    ds_read_b64_tr_b16 v[218:219], v26 offset:9736
    v_cndmask_b32 v48, v48, v22, s[72:73]
    v_cndmask_b32 v49, v49, v22, s[74:75]
    v_cndmask_b32 v50, v50, v22, s[76:77]
    v_cndmask_b32 v51, v51, v22, s[78:79]
    v_max3_f32 v20, v44, v45, v46
    v_max3_f32 v21, v47, v48, v49
    v_max3_f32 v20, v20, v50, v51
    v_max3_f32 v21, v21, v52, v53
    v_max_f32 v20, v20, v21
    v_mov_b32 v21, v20
    s_nop 1
    v_permlane16_swap_b32 v21, v20
    v_max_f32 v20, v20, v21
    v_mov_b32 v21, v20
    s_nop 1
    v_permlane32_swap_b32 v21, v20
    v_max_f32 v20, v20, v21
    v_mul_f32 v20, s80, v20
    v_fma_f32 v44, v44, s80, -v20
    v_fma_f32 v45, v45, s80, -v20
    v_fma_f32 v46, v46, s80, -v20
    v_fma_f32 v47, v47, s80, -v20
    v_fma_f32 v48, v48, s80, -v20
    v_fma_f32 v49, v49, s80, -v20
    v_fma_f32 v50, v50, s80, -v20
    v_fma_f32 v51, v51, s80, -v20
    v_fma_f32 v52, v52, s80, -v20
    v_fma_f32 v53, v53, s80, -v20
    v_exp_f32 v44, v44
    v_exp_f32 v45, v45
    v_exp_f32 v46, v46
    v_exp_f32 v47, v47
    v_exp_f32 v48, v48
    v_exp_f32 v49, v49
    v_exp_f32 v50, v50
    v_exp_f32 v51, v51
    v_exp_f32 v52, v52
    v_exp_f32 v53, v53
    s_nop 0
    v_cvt_pk_bf16_f32 v44, v44, v45
    v_cvt_pk_bf16_f32 v45, v46, v47
    v_cvt_pk_bf16_f32 v46, v48, v49
    v_cvt_pk_bf16_f32 v47, v50, v51
    v_cvt_pk_bf16_f32 v52, v52, v53
    v_mov_b32 v53, 0
    v_mov_b32 v54, 0
    v_mov_b32 v55, 0
    s_nop 1
    s_waitcnt lgkmcnt(0)
    v_mfma_f32_16x16x32_bf16 v[36:39], v[28:31], v[32:35], 0
    v_mfma_f32_16x16x32_bf16 v[36:39], v[28:31], v[40:43], v[36:39]
    v_mfma_f32_16x16x32_bf16 v[172:175], v[140:143], v[32:35], 0
    v_mfma_f32_16x16x32_bf16 v[172:175], v[204:207], v[40:43], v[172:175]
    v_mfma_f32_16x16x32_bf16 v[176:179], v[144:147], v[32:35], 0
    v_mfma_f32_16x16x32_bf16 v[176:179], v[206:209], v[40:43], v[176:179]
    v_mfma_f32_16x16x32_bf16 v[180:183], v[148:151], v[32:35], 0
    v_mfma_f32_16x16x32_bf16 v[180:183], v[208:211], v[40:43], v[180:183]
    v_mfma_f32_16x16x32_bf16 v[184:187], v[152:155], v[32:35], 0
    v_mfma_f32_16x16x32_bf16 v[184:187], v[210:213], v[40:43], v[184:187]
    v_mfma_f32_16x16x32_bf16 v[188:191], v[156:159], v[32:35], 0
    v_mfma_f32_16x16x32_bf16 v[188:191], v[212:215], v[40:43], v[188:191]
    v_mfma_f32_16x16x32_bf16 v[192:195], v[160:163], v[32:35], 0
    v_mfma_f32_16x16x32_bf16 v[192:195], v[214:217], v[40:43], v[192:195]
    v_mfma_f32_16x16x32_bf16 v[196:199], v[164:167], v[32:35], 0
    v_mfma_f32_16x16x32_bf16 v[196:199], v[216:219], v[40:43], v[196:199]
    v_mfma_f32_16x16x32_bf16 v[200:203], v[168:171], v[32:35], 0
    v_mfma_f32_16x16x32_bf16 v[200:203], v[218:221], v[40:43], v[200:203]
    v_rcp_f32 v23, v36
    s_add_u32 s85, s81, 176685056
    v_mul_f32 v172, v172, v23
    v_mul_f32 v173, v173, v23
    v_mul_f32 v174, v174, v23
    v_mul_f32 v175, v175, v23
    v_mul_f32 v176, v176, v23
    v_mul_f32 v177, v177, v23
    v_mul_f32 v178, v178, v23
    v_mul_f32 v179, v179, v23
    v_cvt_pk_bf16_f32 v224, v172, v173
    v_cvt_pk_bf16_f32 v225, v174, v175
    v_cvt_pk_bf16_f32 v226, v176, v177
    v_cvt_pk_bf16_f32 v227, v178, v179
    buffer_store_dwordx4 v[224:227], v1, s[4:7], s85 offen offset:0 sc1
    v_mul_f32 v180, v180, v23
    v_mul_f32 v181, v181, v23
    v_mul_f32 v182, v182, v23
    v_mul_f32 v183, v183, v23
    v_mul_f32 v184, v184, v23
    v_mul_f32 v185, v185, v23
    v_mul_f32 v186, v186, v23
    v_mul_f32 v187, v187, v23
    v_cvt_pk_bf16_f32 v228, v180, v181
    v_cvt_pk_bf16_f32 v229, v182, v183
    v_cvt_pk_bf16_f32 v230, v184, v185
    v_cvt_pk_bf16_f32 v231, v186, v187
    buffer_store_dwordx4 v[228:231], v1, s[4:7], s85 offen offset:1024 sc1
    v_mul_f32 v188, v188, v23
    v_mul_f32 v189, v189, v23
    v_mul_f32 v190, v190, v23
    v_mul_f32 v191, v191, v23
    v_mul_f32 v192, v192, v23
    v_mul_f32 v193, v193, v23
    v_mul_f32 v194, v194, v23
    v_mul_f32 v195, v195, v23
    v_cvt_pk_bf16_f32 v232, v188, v189
    v_cvt_pk_bf16_f32 v233, v190, v191
    v_cvt_pk_bf16_f32 v234, v192, v193
    v_cvt_pk_bf16_f32 v235, v194, v195
    buffer_store_dwordx4 v[232:235], v1, s[4:7], s85 offen offset:2048 sc1
    v_mul_f32 v196, v196, v23
    v_mul_f32 v197, v197, v23
    v_mul_f32 v198, v198, v23
    v_mul_f32 v199, v199, v23
    v_mul_f32 v200, v200, v23
    v_mul_f32 v201, v201, v23
    v_mul_f32 v202, v202, v23
    v_mul_f32 v203, v203, v23
    v_cvt_pk_bf16_f32 v236, v196, v197
    v_cvt_pk_bf16_f32 v237, v198, v199
    v_cvt_pk_bf16_f32 v238, v200, v201
    v_cvt_pk_bf16_f32 v239, v202, v203
    buffer_store_dwordx4 v[236:239], v1, s[4:7], s85 offen offset:3072 sc1
    v_mfma_f32_16x16x32_bf16 v[48:51], v[28:31], v[44:47], 0
    v_mfma_f32_16x16x32_bf16 v[48:51], v[28:31], v[52:55], v[48:51]
    v_mfma_f32_16x16x32_bf16 v[172:175], v[140:143], v[44:47], 0
    v_mfma_f32_16x16x32_bf16 v[172:175], v[204:207], v[52:55], v[172:175]
    v_mfma_f32_16x16x32_bf16 v[176:179], v[144:147], v[44:47], 0
    v_mfma_f32_16x16x32_bf16 v[176:179], v[206:209], v[52:55], v[176:179]
    v_mfma_f32_16x16x32_bf16 v[180:183], v[148:151], v[44:47], 0
    v_mfma_f32_16x16x32_bf16 v[180:183], v[208:211], v[52:55], v[180:183]
    v_mfma_f32_16x16x32_bf16 v[184:187], v[152:155], v[44:47], 0
    v_mfma_f32_16x16x32_bf16 v[184:187], v[210:213], v[52:55], v[184:187]
    v_mfma_f32_16x16x32_bf16 v[188:191], v[156:159], v[44:47], 0
    v_mfma_f32_16x16x32_bf16 v[188:191], v[212:215], v[52:55], v[188:191]
    v_mfma_f32_16x16x32_bf16 v[192:195], v[160:163], v[44:47], 0
    v_mfma_f32_16x16x32_bf16 v[192:195], v[214:217], v[52:55], v[192:195]
    v_mfma_f32_16x16x32_bf16 v[196:199], v[164:167], v[44:47], 0
    v_mfma_f32_16x16x32_bf16 v[196:199], v[216:219], v[52:55], v[196:199]
    v_mfma_f32_16x16x32_bf16 v[200:203], v[168:171], v[44:47], 0
    v_mfma_f32_16x16x32_bf16 v[200:203], v[218:221], v[52:55], v[200:203]
    v_rcp_f32 v23, v48
    s_add_u32 s85, s81, 176816128
    v_mul_f32 v172, v172, v23
    v_mul_f32 v173, v173, v23
    v_mul_f32 v174, v174, v23
    v_mul_f32 v175, v175, v23
    v_mul_f32 v176, v176, v23
    v_mul_f32 v177, v177, v23
    v_mul_f32 v178, v178, v23
    v_mul_f32 v179, v179, v23
    v_cvt_pk_bf16_f32 v224, v172, v173
    v_cvt_pk_bf16_f32 v225, v174, v175
    v_cvt_pk_bf16_f32 v226, v176, v177
    v_cvt_pk_bf16_f32 v227, v178, v179
    buffer_store_dwordx4 v[224:227], v1, s[4:7], s85 offen offset:0 sc1
    v_mul_f32 v180, v180, v23
    v_mul_f32 v181, v181, v23
    v_mul_f32 v182, v182, v23
    v_mul_f32 v183, v183, v23
    v_mul_f32 v184, v184, v23
    v_mul_f32 v185, v185, v23
    v_mul_f32 v186, v186, v23
    v_mul_f32 v187, v187, v23
    v_cvt_pk_bf16_f32 v228, v180, v181
    v_cvt_pk_bf16_f32 v229, v182, v183
    v_cvt_pk_bf16_f32 v230, v184, v185
    v_cvt_pk_bf16_f32 v231, v186, v187
    buffer_store_dwordx4 v[228:231], v1, s[4:7], s85 offen offset:1024 sc1
    v_mul_f32 v188, v188, v23
    v_mul_f32 v189, v189, v23
    v_mul_f32 v190, v190, v23
    v_mul_f32 v191, v191, v23
    v_mul_f32 v192, v192, v23
    v_mul_f32 v193, v193, v23
    v_mul_f32 v194, v194, v23
    v_mul_f32 v195, v195, v23
    v_cvt_pk_bf16_f32 v232, v188, v189
    v_cvt_pk_bf16_f32 v233, v190, v191
    v_cvt_pk_bf16_f32 v234, v192, v193
    v_cvt_pk_bf16_f32 v235, v194, v195
    buffer_store_dwordx4 v[232:235], v1, s[4:7], s85 offen offset:2048 sc1
    v_mul_f32 v196, v196, v23
    v_mul_f32 v197, v197, v23
    v_mul_f32 v198, v198, v23
    v_mul_f32 v199, v199, v23
    v_mul_f32 v200, v200, v23
    v_mul_f32 v201, v201, v23
    v_mul_f32 v202, v202, v23
    v_mul_f32 v203, v203, v23
    v_cvt_pk_bf16_f32 v236, v196, v197
    v_cvt_pk_bf16_f32 v237, v198, v199
    v_cvt_pk_bf16_f32 v238, v200, v201
    v_cvt_pk_bf16_f32 v239, v202, v203
    buffer_store_dwordx4 v[236:239], v1, s[4:7], s85 offen offset:3072 sc1
    s_mov_b32 s28, s46
    s_nop 0
    s_load_dwordx16 s[32:47], s[24:25], 0
    s_add_u32 s24, s24, 64
    s_addc_u32 s25, s25, 0
    s_waitcnt lgkmcnt(0)
    s_branch w_drain
w_fin:
    s_load_dwordx2 s[8:9], s[0:1], 0
    s_load_dwordx2 s[12:13], s[0:1], 88
    v_mbcnt_lo_u32_b32 v1, -1, 0
    v_mbcnt_hi_u32_b32 v1, -1, v1
    s_mov_b32 s10, 4194304
    s_mov_b32 s11, 131072
    s_mov_b32 s14, 4194304
    s_mov_b32 s15, 131072
    s_mov_b32 s89, 0xbfb8aa3b
    v_lshlrev_b32 v3, 4, v1
    v_and_b32 v4, 15, v1
    v_lshrrev_b32 v5, 4, v1
    v_lshlrev_b32 v4, 11, v4
    v_lshl_add_u32 v4, v5, 4, v4
    v_and_b32 v5, 1, v5
    v_cmp_eq_u32 s[76:77], 1, v5
    v_and_b32 v6, 3, v1
    v_lshlrev_b32 v6, 7, v6
    s_mov_b32 s80, s39
    s_lshl_b32 s81, s36, 2
    s_and_b32 s82, s3, 3
    s_add_u32 s81, s81, s82
    s_lshr_b32 s82, s3, 2
    s_mov_b32 s84, 65536
    s_mov_b32 s85, 218112000
    s_waitcnt lgkmcnt(0)
    s_cmp_eq_u32 s32, 7
    s_cbranch_scc1 fin_tail
fin_job:
    s_lshl_b32 s72, s80, 1
    s_add_u32 s72, s72, s82
    s_lshl_b32 s74, s72, 15
    s_lshl_b32 s73, s81, 11
    s_add_u32 s73, s73, s74
    s_lshl_b32 s75, s81, 7
    s_add_u32 s74, s74, s75
    s_add_u32 s78, s73, 117440512
    s_add_u32 s79, s73, 75497472
    s_lshr_b32 s83, s80, 3
    s_lshl_b32 s83, s83, 6
    s_add_u32 s83, s83, 218106368
    s_add_u32 s87, s80, 1
    buffer_load_dwordx4 v[88:91], v4, s[8:11], s74 offen offset:0
    buffer_load_dwordx4 v[92:95], v4, s[8:11], s74 offen offset:64
    s_cmp_lg_u32 s3, 0
    s_cbranch_scc1 fin_ws_ok
fin_wd:
    buffer_load_dwordx2 v[8:9], off, s[4:7], s83 sc1
    s_waitcnt vmcnt(0)
    v_readfirstlane_b32 s86, v8
    v_readfirstlane_b32 s88, v9
    s_cmp_ge_u32 s80, 48
    s_cselect_b32 s88, 16, s88
    s_min_u32 s86, s86, s88
    s_cmp_ge_u32 s86, 16
    s_cbranch_scc1 fin_wd2
    s_sleep 64
    s_sub_u32 s84, s84, 1
    s_cbranch_scc0 fin_wd
    s_mov_b32 s84, 0
fin_wd2:
    s_cmp_lt_u32 s80, 48
    s_cbranch_scc1 fin_ws_ok
fin_ws:
    buffer_load_dword v7, v6, s[4:7], s85 offen sc1
    s_waitcnt vmcnt(0)
    v_cmp_gt_u32 vcc, s87, v7
    s_cbranch_vccz fin_ws_ok
    s_sleep 12
    s_sub_u32 s86, s87, 2
    v_cmp_gt_i32 vcc, s86, v7
    s_cbranch_vccz fin_ws_f
    s_sleep 64
    s_sub_u32 s86, s87, 6
    v_cmp_gt_i32 vcc, s86, v7
    s_cbranch_vccz fin_ws_f
    s_sleep 127
    s_sleep 127
fin_ws_f:
    s_sub_u32 s84, s84, 1
    s_cbranch_scc0 fin_ws
    s_mov_b32 s84, 0
fin_ws_ok:
    s_barrier
    buffer_load_dwordx4 v[136:139], v3, s[4:7], s78 offen offset:0 sc1
    buffer_load_dwordx4 v[140:143], v3, s[4:7], s78 offen offset:1024 sc1
    s_add_u32 s78, s78, 4194304
    buffer_load_dwordx4 v[144:147], v3, s[4:7], s78 offen offset:0 sc1
    buffer_load_dwordx4 v[148:151], v3, s[4:7], s78 offen offset:1024 sc1
    s_add_u32 s78, s78, 4194304
    buffer_load_dwordx4 v[152:155], v3, s[4:7], s78 offen offset:0 sc1
    buffer_load_dwordx4 v[156:159], v3, s[4:7], s78 offen offset:1024 sc1
    s_add_u32 s78, s78, 4194304
    buffer_load_dwordx4 v[160:163], v3, s[4:7], s78 offen offset:0 sc1
    buffer_load_dwordx4 v[164:167], v3, s[4:7], s78 offen offset:1024 sc1
    s_add_u32 s78, s78, 4194304
    buffer_load_dwordx4 v[16:19], v3, s[4:7], s79 offen offset:0 sc1
    buffer_load_dwordx4 v[48:51], v3, s[4:7], s79 offen offset:1024 sc1
    s_add_u32 s79, s79, 4194304
    buffer_load_dwordx4 v[20:23], v3, s[4:7], s79 offen offset:0 sc1
    buffer_load_dwordx4 v[52:55], v3, s[4:7], s79 offen offset:1024 sc1
    s_add_u32 s79, s79, 4194304
    buffer_load_dwordx4 v[24:27], v3, s[4:7], s79 offen offset:0 sc1
    buffer_load_dwordx4 v[56:59], v3, s[4:7], s79 offen offset:1024 sc1
    s_add_u32 s79, s79, 4194304
    buffer_load_dwordx4 v[28:31], v3, s[4:7], s79 offen offset:0 sc1
    buffer_load_dwordx4 v[60:63], v3, s[4:7], s79 offen offset:1024 sc1
    s_add_u32 s79, s79, 4194304
    s_cmp_lt_u32 s80, 48
    s_cbranch_scc1 fin_4p
    buffer_load_dwordx4 v[32:35], v3, s[4:7], s79 offen offset:0 sc1
    buffer_load_dwordx4 v[64:67], v3, s[4:7], s79 offen offset:1024 sc1
    s_add_u32 s79, s79, 4194304
    buffer_load_dwordx4 v[36:39], v3, s[4:7], s79 offen offset:0 sc1
    buffer_load_dwordx4 v[68:71], v3, s[4:7], s79 offen offset:1024 sc1
    s_add_u32 s79, s79, 4194304
    buffer_load_dwordx4 v[40:43], v3, s[4:7], s79 offen offset:0 sc1
    buffer_load_dwordx4 v[72:75], v3, s[4:7], s79 offen offset:1024 sc1
    s_add_u32 s79, s79, 4194304
    buffer_load_dwordx4 v[44:47], v3, s[4:7], s79 offen offset:0 sc1
    buffer_load_dwordx4 v[76:79], v3, s[4:7], s79 offen offset:1024 sc1
    s_add_u32 s79, s79, 4194304
    s_waitcnt vmcnt(16)
    s_branch fin_8p
fin_4p:
    v_mov_b32 v32, 0
    v_mov_b32 v33, 0
    v_mov_b32 v34, 0
    v_mov_b32 v35, 0
    v_mov_b32 v36, 0
    v_mov_b32 v37, 0
    v_mov_b32 v38, 0
    v_mov_b32 v39, 0
    v_mov_b32 v40, 0
    v_mov_b32 v41, 0
    v_mov_b32 v42, 0
    v_mov_b32 v43, 0
    v_mov_b32 v44, 0
    v_mov_b32 v45, 0
    v_mov_b32 v46, 0
    v_mov_b32 v47, 0
    v_mov_b32 v64, 0
    v_mov_b32 v65, 0
    v_mov_b32 v66, 0
    v_mov_b32 v67, 0
    v_mov_b32 v68, 0
    v_mov_b32 v69, 0
    v_mov_b32 v70, 0
    v_mov_b32 v71, 0
    v_mov_b32 v72, 0
    v_mov_b32 v73, 0
    v_mov_b32 v74, 0
    v_mov_b32 v75, 0
    v_mov_b32 v76, 0
    v_mov_b32 v77, 0
    v_mov_b32 v78, 0
    v_mov_b32 v79, 0
    s_waitcnt vmcnt(8)
fin_8p:
    v_lshlrev_b32 v120, 16, v136
    v_and_b32 v121, 0xffff0000, v136
    v_lshlrev_b32 v136, 16, v144
    v_and_b32 v144, 0xffff0000, v144
    v_add_f32 v120, v120, v136
    v_add_f32 v121, v121, v144
    v_lshlrev_b32 v136, 16, v152
    v_and_b32 v152, 0xffff0000, v152
    v_add_f32 v120, v120, v136
    v_add_f32 v121, v121, v152
    v_lshlrev_b32 v136, 16, v160
    v_and_b32 v160, 0xffff0000, v160
    v_add_f32 v120, v120, v136
    v_add_f32 v121, v121, v160
    v_cvt_pk_bf16_f32 v136, v120, v121
    v_lshlrev_b32 v120, 16, v136
    v_and_b32 v121, 0xffff0000, v136
    v_mul_f32 v136, s89, v120
    v_mul_f32 v144, s89, v121
    v_lshlrev_b32 v122, 16, v137
    v_and_b32 v123, 0xffff0000, v137
    v_lshlrev_b32 v137, 16, v145
    v_and_b32 v145, 0xffff0000, v145
    v_add_f32 v122, v122, v137
    v_add_f32 v123, v123, v145
    v_lshlrev_b32 v137, 16, v153
    v_and_b32 v153, 0xffff0000, v153
    v_add_f32 v122, v122, v137
    v_add_f32 v123, v123, v153
    v_lshlrev_b32 v137, 16, v161
    v_and_b32 v161, 0xffff0000, v161
    v_add_f32 v122, v122, v137
    v_add_f32 v123, v123, v161
    v_cvt_pk_bf16_f32 v137, v122, v123
    v_lshlrev_b32 v122, 16, v137
    v_and_b32 v123, 0xffff0000, v137
    v_mul_f32 v137, s89, v122
    v_mul_f32 v145, s89, v123
    v_lshlrev_b32 v124, 16, v138
    v_and_b32 v125, 0xffff0000, v138
    v_lshlrev_b32 v138, 16, v146
    v_and_b32 v146, 0xffff0000, v146
    v_add_f32 v124, v124, v138
    v_add_f32 v125, v125, v146
    v_lshlrev_b32 v138, 16, v154
    v_and_b32 v154, 0xffff0000, v154
    v_add_f32 v124, v124, v138
    v_add_f32 v125, v125, v154
    v_lshlrev_b32 v138, 16, v162
    v_and_b32 v162, 0xffff0000, v162
    v_add_f32 v124, v124, v138
    v_add_f32 v125, v125, v162
    v_cvt_pk_bf16_f32 v138, v124, v125
    v_lshlrev_b32 v124, 16, v138
    v_and_b32 v125, 0xffff0000, v138
    v_mul_f32 v138, s89, v124
    v_mul_f32 v146, s89, v125
    v_lshlrev_b32 v126, 16, v139
    v_and_b32 v127, 0xffff0000, v139
    v_lshlrev_b32 v139, 16, v147
    v_and_b32 v147, 0xffff0000, v147
    v_add_f32 v126, v126, v139
    v_add_f32 v127, v127, v147
    v_lshlrev_b32 v139, 16, v155
    v_and_b32 v155, 0xffff0000, v155
    v_add_f32 v126, v126, v139
    v_add_f32 v127, v127, v155
    v_lshlrev_b32 v139, 16, v163
    v_and_b32 v163, 0xffff0000, v163
    v_add_f32 v126, v126, v139
    v_add_f32 v127, v127, v163
    v_cvt_pk_bf16_f32 v139, v126, v127
    v_lshlrev_b32 v126, 16, v139
    v_and_b32 v127, 0xffff0000, v139
    v_mul_f32 v139, s89, v126
    v_mul_f32 v147, s89, v127
    v_exp_f32 v136, v136
    v_exp_f32 v144, v144
    v_exp_f32 v137, v137
    v_exp_f32 v145, v145
    v_exp_f32 v138, v138
    v_exp_f32 v146, v146
    v_exp_f32 v139, v139
    v_exp_f32 v147, v147
    s_nop 0
    v_add_f32 v136, 1.0, v136
    v_add_f32 v144, 1.0, v144
    v_add_f32 v137, 1.0, v137
    v_add_f32 v145, 1.0, v145
    v_add_f32 v138, 1.0, v138
    v_add_f32 v146, 1.0, v146
    v_add_f32 v139, 1.0, v139
    v_add_f32 v147, 1.0, v147
    v_rcp_f32 v136, v136
    v_rcp_f32 v144, v144
    v_rcp_f32 v137, v137
    v_rcp_f32 v145, v145
    v_rcp_f32 v138, v138
    v_rcp_f32 v146, v146
    v_rcp_f32 v139, v139
    v_rcp_f32 v147, v147
    s_nop 0
    v_mul_f32 v120, v120, v136
    v_mul_f32 v121, v121, v144
    v_cvt_pk_bf16_f32 v136, v120, v121
    v_mul_f32 v122, v122, v137
    v_mul_f32 v123, v123, v145
    v_cvt_pk_bf16_f32 v137, v122, v123
    v_mul_f32 v124, v124, v138
    v_mul_f32 v125, v125, v146
    v_cvt_pk_bf16_f32 v138, v124, v125
    v_mul_f32 v126, v126, v139
    v_mul_f32 v127, v127, v147
    v_cvt_pk_bf16_f32 v139, v126, v127
    v_lshlrev_b32 v120, 16, v140
    v_and_b32 v121, 0xffff0000, v140
    v_lshlrev_b32 v140, 16, v148
    v_and_b32 v148, 0xffff0000, v148
    v_add_f32 v120, v120, v140
    v_add_f32 v121, v121, v148
    v_lshlrev_b32 v140, 16, v156
    v_and_b32 v156, 0xffff0000, v156
    v_add_f32 v120, v120, v140
    v_add_f32 v121, v121, v156
    v_lshlrev_b32 v140, 16, v164
    v_and_b32 v164, 0xffff0000, v164
    v_add_f32 v120, v120, v140
    v_add_f32 v121, v121, v164
    v_cvt_pk_bf16_f32 v140, v120, v121
    v_lshlrev_b32 v120, 16, v140
    v_and_b32 v121, 0xffff0000, v140
    v_mul_f32 v140, s89, v120
    v_mul_f32 v148, s89, v121
    v_lshlrev_b32 v122, 16, v141
    v_and_b32 v123, 0xffff0000, v141
    v_lshlrev_b32 v141, 16, v149
    v_and_b32 v149, 0xffff0000, v149
    v_add_f32 v122, v122, v141
    v_add_f32 v123, v123, v149
    v_lshlrev_b32 v141, 16, v157
    v_and_b32 v157, 0xffff0000, v157
    v_add_f32 v122, v122, v141
    v_add_f32 v123, v123, v157
    v_lshlrev_b32 v141, 16, v165
    v_and_b32 v165, 0xffff0000, v165
    v_add_f32 v122, v122, v141
    v_add_f32 v123, v123, v165
    v_cvt_pk_bf16_f32 v141, v122, v123
    v_lshlrev_b32 v122, 16, v141
    v_and_b32 v123, 0xffff0000, v141
    v_mul_f32 v141, s89, v122
    v_mul_f32 v149, s89, v123
    v_lshlrev_b32 v124, 16, v142
    v_and_b32 v125, 0xffff0000, v142
    v_lshlrev_b32 v142, 16, v150
    v_and_b32 v150, 0xffff0000, v150
    v_add_f32 v124, v124, v142
    v_add_f32 v125, v125, v150
    v_lshlrev_b32 v142, 16, v158
    v_and_b32 v158, 0xffff0000, v158
    v_add_f32 v124, v124, v142
    v_add_f32 v125, v125, v158
    v_lshlrev_b32 v142, 16, v166
    v_and_b32 v166, 0xffff0000, v166
    v_add_f32 v124, v124, v142
    v_add_f32 v125, v125, v166
    v_cvt_pk_bf16_f32 v142, v124, v125
    v_lshlrev_b32 v124, 16, v142
    v_and_b32 v125, 0xffff0000, v142
    v_mul_f32 v142, s89, v124
    v_mul_f32 v150, s89, v125
    v_lshlrev_b32 v126, 16, v143
    v_and_b32 v127, 0xffff0000, v143
    v_lshlrev_b32 v143, 16, v151
    v_and_b32 v151, 0xffff0000, v151
    v_add_f32 v126, v126, v143
    v_add_f32 v127, v127, v151
    v_lshlrev_b32 v143, 16, v159
    v_and_b32 v159, 0xffff0000, v159
    v_add_f32 v126, v126, v143
    v_add_f32 v127, v127, v159
    v_lshlrev_b32 v143, 16, v167
    v_and_b32 v167, 0xffff0000, v167
    v_add_f32 v126, v126, v143
    v_add_f32 v127, v127, v167
    v_cvt_pk_bf16_f32 v143, v126, v127
    v_lshlrev_b32 v126, 16, v143
    v_and_b32 v127, 0xffff0000, v143
    v_mul_f32 v143, s89, v126
    v_mul_f32 v151, s89, v127
    v_exp_f32 v140, v140
    v_exp_f32 v148, v148
    v_exp_f32 v141, v141
    v_exp_f32 v149, v149
    v_exp_f32 v142, v142
    v_exp_f32 v150, v150
    v_exp_f32 v143, v143
    v_exp_f32 v151, v151
    s_nop 0
    v_add_f32 v140, 1.0, v140
    v_add_f32 v148, 1.0, v148
    v_add_f32 v141, 1.0, v141
    v_add_f32 v149, 1.0, v149
    v_add_f32 v142, 1.0, v142
    v_add_f32 v150, 1.0, v150
    v_add_f32 v143, 1.0, v143
    v_add_f32 v151, 1.0, v151
    v_rcp_f32 v140, v140
    v_rcp_f32 v148, v148
    v_rcp_f32 v141, v141
    v_rcp_f32 v149, v149
    v_rcp_f32 v142, v142
    v_rcp_f32 v150, v150
    v_rcp_f32 v143, v143
    v_rcp_f32 v151, v151
    s_nop 0
    v_mul_f32 v120, v120, v140
    v_mul_f32 v121, v121, v148
    v_cvt_pk_bf16_f32 v140, v120, v121
    v_mul_f32 v122, v122, v141
    v_mul_f32 v123, v123, v149
    v_cvt_pk_bf16_f32 v141, v122, v123
    v_mul_f32 v124, v124, v142
    v_mul_f32 v125, v125, v150
    v_cvt_pk_bf16_f32 v142, v124, v125
    v_mul_f32 v126, v126, v143
    v_mul_f32 v127, v127, v151
    v_cvt_pk_bf16_f32 v143, v126, v127
    s_waitcnt vmcnt(0)
    v_lshlrev_b32 v96, 16, v16
    v_and_b32 v97, 0xffff0000, v16
    v_lshlrev_b32 v98, 16, v17
    v_and_b32 v99, 0xffff0000, v17
    v_lshlrev_b32 v100, 16, v18
    v_and_b32 v101, 0xffff0000, v18
    v_lshlrev_b32 v102, 16, v19
    v_and_b32 v103, 0xffff0000, v19
    v_lshlrev_b32 v120, 16, v20
    v_and_b32 v121, 0xffff0000, v20
    v_lshlrev_b32 v122, 16, v21
    v_and_b32 v123, 0xffff0000, v21
    v_lshlrev_b32 v124, 16, v22
    v_and_b32 v125, 0xffff0000, v22
    v_lshlrev_b32 v126, 16, v23
    v_and_b32 v127, 0xffff0000, v23
    v_add_f32 v96, v96, v120
    v_add_f32 v97, v97, v121
    v_add_f32 v98, v98, v122
    v_add_f32 v99, v99, v123
    v_add_f32 v100, v100, v124
    v_add_f32 v101, v101, v125
    v_add_f32 v102, v102, v126
    v_add_f32 v103, v103, v127
    v_lshlrev_b32 v120, 16, v24
    v_and_b32 v121, 0xffff0000, v24
    v_lshlrev_b32 v122, 16, v25
    v_and_b32 v123, 0xffff0000, v25
    v_lshlrev_b32 v124, 16, v26
    v_and_b32 v125, 0xffff0000, v26
    v_lshlrev_b32 v126, 16, v27
    v_and_b32 v127, 0xffff0000, v27
    v_add_f32 v96, v96, v120
    v_add_f32 v97, v97, v121
    v_add_f32 v98, v98, v122
    v_add_f32 v99, v99, v123
    v_add_f32 v100, v100, v124
    v_add_f32 v101, v101, v125
    v_add_f32 v102, v102, v126
    v_add_f32 v103, v103, v127
    v_lshlrev_b32 v120, 16, v28
    v_and_b32 v121, 0xffff0000, v28
    v_lshlrev_b32 v122, 16, v29
    v_and_b32 v123, 0xffff0000, v29
    v_lshlrev_b32 v124, 16, v30
    v_and_b32 v125, 0xffff0000, v30
    v_lshlrev_b32 v126, 16, v31
    v_and_b32 v127, 0xffff0000, v31
    v_add_f32 v96, v96, v120
    v_add_f32 v97, v97, v121
    v_add_f32 v98, v98, v122
    v_add_f32 v99, v99, v123
    v_add_f32 v100, v100, v124
    v_add_f32 v101, v101, v125
    v_add_f32 v102, v102, v126
    v_add_f32 v103, v103, v127
    v_lshlrev_b32 v120, 16, v32
    v_and_b32 v121, 0xffff0000, v32
    v_lshlrev_b32 v122, 16, v33
    v_and_b32 v123, 0xffff0000, v33
    v_lshlrev_b32 v124, 16, v34
    v_and_b32 v125, 0xffff0000, v34
    v_lshlrev_b32 v126, 16, v35
    v_and_b32 v127, 0xffff0000, v35
    v_add_f32 v96, v96, v120
    v_add_f32 v97, v97, v121
    v_add_f32 v98, v98, v122
    v_add_f32 v99, v99, v123
    v_add_f32 v100, v100, v124
    v_add_f32 v101, v101, v125
    v_add_f32 v102, v102, v126
    v_add_f32 v103, v103, v127
    v_lshlrev_b32 v120, 16, v36
    v_and_b32 v121, 0xffff0000, v36
    v_lshlrev_b32 v122, 16, v37
    v_and_b32 v123, 0xffff0000, v37
    v_lshlrev_b32 v124, 16, v38
    v_and_b32 v125, 0xffff0000, v38
    v_lshlrev_b32 v126, 16, v39
    v_and_b32 v127, 0xffff0000, v39
    v_add_f32 v96, v96, v120
    v_add_f32 v97, v97, v121
    v_add_f32 v98, v98, v122
    v_add_f32 v99, v99, v123
    v_add_f32 v100, v100, v124
    v_add_f32 v101, v101, v125
    v_add_f32 v102, v102, v126
    v_add_f32 v103, v103, v127
    v_lshlrev_b32 v120, 16, v40
    v_and_b32 v121, 0xffff0000, v40
    v_lshlrev_b32 v122, 16, v41
    v_and_b32 v123, 0xffff0000, v41
    v_lshlrev_b32 v124, 16, v42
    v_and_b32 v125, 0xffff0000, v42
    v_lshlrev_b32 v126, 16, v43
    v_and_b32 v127, 0xffff0000, v43
    v_add_f32 v96, v96, v120
    v_add_f32 v97, v97, v121
    v_add_f32 v98, v98, v122
    v_add_f32 v99, v99, v123
    v_add_f32 v100, v100, v124
    v_add_f32 v101, v101, v125
    v_add_f32 v102, v102, v126
    v_add_f32 v103, v103, v127
    v_lshlrev_b32 v120, 16, v44
    v_and_b32 v121, 0xffff0000, v44
    v_lshlrev_b32 v122, 16, v45
    v_and_b32 v123, 0xffff0000, v45
    v_lshlrev_b32 v124, 16, v46
    v_and_b32 v125, 0xffff0000, v46
    v_lshlrev_b32 v126, 16, v47
    v_and_b32 v127, 0xffff0000, v47
    v_add_f32 v96, v96, v120
    v_add_f32 v97, v97, v121
    v_add_f32 v98, v98, v122
    v_add_f32 v99, v99, v123
    v_add_f32 v100, v100, v124
    v_add_f32 v101, v101, v125
    v_add_f32 v102, v102, v126
    v_add_f32 v103, v103, v127
    v_cndmask_b32 v108, v88, v90, s[76:77]
    v_cndmask_b32 v109, v89, v91, s[76:77]
    v_cndmask_b32 v110, v90, v88, s[76:77]
    v_cndmask_b32 v111, v91, v89, s[76:77]
    v_cvt_pk_bf16_f32 v104, v96, v97
    v_lshlrev_b32 v96, 16, v104
    v_and_b32 v97, 0xffff0000, v104
    v_lshlrev_b32 v104, 16, v136
    v_and_b32 v105, 0xffff0000, v136
    v_mul_f32 v96, v96, v104
    v_mul_f32 v97, v97, v105
    v_cvt_pk_bf16_f32 v104, v96, v97
    v_lshlrev_b32 v96, 16, v104
    v_and_b32 v97, 0xffff0000, v104
    v_lshlrev_b32 v104, 16, v108
    v_and_b32 v105, 0xffff0000, v108
    v_add_f32 v96, v96, v104
    v_add_f32 v97, v97, v105
    v_cvt_pk_bf16_f32 v112, v96, v97
    v_cvt_pk_bf16_f32 v104, v98, v99
    v_lshlrev_b32 v98, 16, v104
    v_and_b32 v99, 0xffff0000, v104
    v_lshlrev_b32 v104, 16, v137
    v_and_b32 v105, 0xffff0000, v137
    v_mul_f32 v98, v98, v104
    v_mul_f32 v99, v99, v105
    v_cvt_pk_bf16_f32 v104, v98, v99
    v_lshlrev_b32 v98, 16, v104
    v_and_b32 v99, 0xffff0000, v104
    v_lshlrev_b32 v104, 16, v109
    v_and_b32 v105, 0xffff0000, v109
    v_add_f32 v98, v98, v104
    v_add_f32 v99, v99, v105
    v_cvt_pk_bf16_f32 v113, v98, v99
    v_cvt_pk_bf16_f32 v104, v100, v101
    v_lshlrev_b32 v100, 16, v104
    v_and_b32 v101, 0xffff0000, v104
    v_lshlrev_b32 v104, 16, v138
    v_and_b32 v105, 0xffff0000, v138
    v_mul_f32 v100, v100, v104
    v_mul_f32 v101, v101, v105
    v_cvt_pk_bf16_f32 v104, v100, v101
    v_lshlrev_b32 v100, 16, v104
    v_and_b32 v101, 0xffff0000, v104
    v_lshlrev_b32 v104, 16, v110
    v_and_b32 v105, 0xffff0000, v110
    v_add_f32 v100, v100, v104
    v_add_f32 v101, v101, v105
    v_cvt_pk_bf16_f32 v114, v100, v101
    v_cvt_pk_bf16_f32 v104, v102, v103
    v_lshlrev_b32 v102, 16, v104
    v_and_b32 v103, 0xffff0000, v104
    v_lshlrev_b32 v104, 16, v139
    v_and_b32 v105, 0xffff0000, v139
    v_mul_f32 v102, v102, v104
    v_mul_f32 v103, v103, v105
    v_cvt_pk_bf16_f32 v104, v102, v103
    v_lshlrev_b32 v102, 16, v104
    v_and_b32 v103, 0xffff0000, v104
    v_lshlrev_b32 v104, 16, v111
    v_and_b32 v105, 0xffff0000, v111
    v_add_f32 v102, v102, v104
    v_add_f32 v103, v103, v105
    v_cvt_pk_bf16_f32 v115, v102, v103
    v_cndmask_b32 v128, v112, v114, s[76:77]
    v_cndmask_b32 v129, v113, v115, s[76:77]
    v_cndmask_b32 v130, v114, v112, s[76:77]
    v_cndmask_b32 v131, v115, v113, s[76:77]
    buffer_store_dwordx4 v[128:131], v4, s[12:15], s74 offen offset:0
    v_lshlrev_b32 v96, 16, v48
    v_and_b32 v97, 0xffff0000, v48
    v_lshlrev_b32 v98, 16, v49
    v_and_b32 v99, 0xffff0000, v49
    v_lshlrev_b32 v100, 16, v50
    v_and_b32 v101, 0xffff0000, v50
    v_lshlrev_b32 v102, 16, v51
    v_and_b32 v103, 0xffff0000, v51
    v_lshlrev_b32 v120, 16, v52
    v_and_b32 v121, 0xffff0000, v52
    v_lshlrev_b32 v122, 16, v53
    v_and_b32 v123, 0xffff0000, v53
    v_lshlrev_b32 v124, 16, v54
    v_and_b32 v125, 0xffff0000, v54
    v_lshlrev_b32 v126, 16, v55
    v_and_b32 v127, 0xffff0000, v55
    v_add_f32 v96, v96, v120
    v_add_f32 v97, v97, v121
    v_add_f32 v98, v98, v122
    v_add_f32 v99, v99, v123
    v_add_f32 v100, v100, v124
    v_add_f32 v101, v101, v125
    v_add_f32 v102, v102, v126
    v_add_f32 v103, v103, v127
    v_lshlrev_b32 v120, 16, v56
    v_and_b32 v121, 0xffff0000, v56
    v_lshlrev_b32 v122, 16, v57
    v_and_b32 v123, 0xffff0000, v57
    v_lshlrev_b32 v124, 16, v58
    v_and_b32 v125, 0xffff0000, v58
    v_lshlrev_b32 v126, 16, v59
    v_and_b32 v127, 0xffff0000, v59
    v_add_f32 v96, v96, v120
    v_add_f32 v97, v97, v121
    v_add_f32 v98, v98, v122
    v_add_f32 v99, v99, v123
    v_add_f32 v100, v100, v124
    v_add_f32 v101, v101, v125
    v_add_f32 v102, v102, v126
    v_add_f32 v103, v103, v127
    v_lshlrev_b32 v120, 16, v60
    v_and_b32 v121, 0xffff0000, v60
    v_lshlrev_b32 v122, 16, v61
    v_and_b32 v123, 0xffff0000, v61
    v_lshlrev_b32 v124, 16, v62
    v_and_b32 v125, 0xffff0000, v62
    v_lshlrev_b32 v126, 16, v63
    v_and_b32 v127, 0xffff0000, v63
    v_add_f32 v96, v96, v120
    v_add_f32 v97, v97, v121
    v_add_f32 v98, v98, v122
    v_add_f32 v99, v99, v123
    v_add_f32 v100, v100, v124
    v_add_f32 v101, v101, v125
    v_add_f32 v102, v102, v126
    v_add_f32 v103, v103, v127
    v_lshlrev_b32 v120, 16, v64
    v_and_b32 v121, 0xffff0000, v64
    v_lshlrev_b32 v122, 16, v65
    v_and_b32 v123, 0xffff0000, v65
    v_lshlrev_b32 v124, 16, v66
    v_and_b32 v125, 0xffff0000, v66
    v_lshlrev_b32 v126, 16, v67
    v_and_b32 v127, 0xffff0000, v67
    v_add_f32 v96, v96, v120
    v_add_f32 v97, v97, v121
    v_add_f32 v98, v98, v122
    v_add_f32 v99, v99, v123
    v_add_f32 v100, v100, v124
    v_add_f32 v101, v101, v125
    v_add_f32 v102, v102, v126
    v_add_f32 v103, v103, v127
    v_lshlrev_b32 v120, 16, v68
    v_and_b32 v121, 0xffff0000, v68
    v_lshlrev_b32 v122, 16, v69
    v_and_b32 v123, 0xffff0000, v69
    v_lshlrev_b32 v124, 16, v70
    v_and_b32 v125, 0xffff0000, v70
    v_lshlrev_b32 v126, 16, v71
    v_and_b32 v127, 0xffff0000, v71
    v_add_f32 v96, v96, v120
    v_add_f32 v97, v97, v121
    v_add_f32 v98, v98, v122
    v_add_f32 v99, v99, v123
    v_add_f32 v100, v100, v124
    v_add_f32 v101, v101, v125
    v_add_f32 v102, v102, v126
    v_add_f32 v103, v103, v127
    v_lshlrev_b32 v120, 16, v72
    v_and_b32 v121, 0xffff0000, v72
    v_lshlrev_b32 v122, 16, v73
    v_and_b32 v123, 0xffff0000, v73
    v_lshlrev_b32 v124, 16, v74
    v_and_b32 v125, 0xffff0000, v74
    v_lshlrev_b32 v126, 16, v75
    v_and_b32 v127, 0xffff0000, v75
    v_add_f32 v96, v96, v120
    v_add_f32 v97, v97, v121
    v_add_f32 v98, v98, v122
    v_add_f32 v99, v99, v123
    v_add_f32 v100, v100, v124
    v_add_f32 v101, v101, v125
    v_add_f32 v102, v102, v126
    v_add_f32 v103, v103, v127
    v_lshlrev_b32 v120, 16, v76
    v_and_b32 v121, 0xffff0000, v76
    v_lshlrev_b32 v122, 16, v77
    v_and_b32 v123, 0xffff0000, v77
    v_lshlrev_b32 v124, 16, v78
    v_and_b32 v125, 0xffff0000, v78
    v_lshlrev_b32 v126, 16, v79
    v_and_b32 v127, 0xffff0000, v79
    v_add_f32 v96, v96, v120
    v_add_f32 v97, v97, v121
    v_add_f32 v98, v98, v122
    v_add_f32 v99, v99, v123
    v_add_f32 v100, v100, v124
    v_add_f32 v101, v101, v125
    v_add_f32 v102, v102, v126
    v_add_f32 v103, v103, v127
    v_cndmask_b32 v108, v92, v94, s[76:77]
    v_cndmask_b32 v109, v93, v95, s[76:77]
    v_cndmask_b32 v110, v94, v92, s[76:77]
    v_cndmask_b32 v111, v95, v93, s[76:77]
    v_cvt_pk_bf16_f32 v104, v96, v97
    v_lshlrev_b32 v96, 16, v104
    v_and_b32 v97, 0xffff0000, v104
    v_lshlrev_b32 v104, 16, v140
    v_and_b32 v105, 0xffff0000, v140
    v_mul_f32 v96, v96, v104
    v_mul_f32 v97, v97, v105
    v_cvt_pk_bf16_f32 v104, v96, v97
    v_lshlrev_b32 v96, 16, v104
    v_and_b32 v97, 0xffff0000, v104
    v_lshlrev_b32 v104, 16, v108
    v_and_b32 v105, 0xffff0000, v108
    v_add_f32 v96, v96, v104
    v_add_f32 v97, v97, v105
    v_cvt_pk_bf16_f32 v112, v96, v97
    v_cvt_pk_bf16_f32 v104, v98, v99
    v_lshlrev_b32 v98, 16, v104
    v_and_b32 v99, 0xffff0000, v104
    v_lshlrev_b32 v104, 16, v141
    v_and_b32 v105, 0xffff0000, v141
    v_mul_f32 v98, v98, v104
    v_mul_f32 v99, v99, v105
    v_cvt_pk_bf16_f32 v104, v98, v99
    v_lshlrev_b32 v98, 16, v104
    v_and_b32 v99, 0xffff0000, v104
    v_lshlrev_b32 v104, 16, v109
    v_and_b32 v105, 0xffff0000, v109
    v_add_f32 v98, v98, v104
    v_add_f32 v99, v99, v105
    v_cvt_pk_bf16_f32 v113, v98, v99
    v_cvt_pk_bf16_f32 v104, v100, v101
    v_lshlrev_b32 v100, 16, v104
    v_and_b32 v101, 0xffff0000, v104
    v_lshlrev_b32 v104, 16, v142
    v_and_b32 v105, 0xffff0000, v142
    v_mul_f32 v100, v100, v104
    v_mul_f32 v101, v101, v105
    v_cvt_pk_bf16_f32 v104, v100, v101
    v_lshlrev_b32 v100, 16, v104
    v_and_b32 v101, 0xffff0000, v104
    v_lshlrev_b32 v104, 16, v110
    v_and_b32 v105, 0xffff0000, v110
    v_add_f32 v100, v100, v104
    v_add_f32 v101, v101, v105
    v_cvt_pk_bf16_f32 v114, v100, v101
    v_cvt_pk_bf16_f32 v104, v102, v103
    v_lshlrev_b32 v102, 16, v104
    v_and_b32 v103, 0xffff0000, v104
    v_lshlrev_b32 v104, 16, v143
    v_and_b32 v105, 0xffff0000, v143
    v_mul_f32 v102, v102, v104
    v_mul_f32 v103, v103, v105
    v_cvt_pk_bf16_f32 v104, v102, v103
    v_lshlrev_b32 v102, 16, v104
    v_and_b32 v103, 0xffff0000, v104
    v_lshlrev_b32 v104, 16, v111
    v_and_b32 v105, 0xffff0000, v111
    v_add_f32 v102, v102, v104
    v_add_f32 v103, v103, v105
    v_cvt_pk_bf16_f32 v115, v102, v103
    v_cndmask_b32 v132, v112, v114, s[76:77]
    v_cndmask_b32 v133, v113, v115, s[76:77]
    v_cndmask_b32 v134, v114, v112, s[76:77]
    v_cndmask_b32 v135, v115, v113, s[76:77]
    buffer_store_dwordx4 v[132:135], v4, s[12:15], s74 offen offset:64
    s_branch w_fin_done
fin_tail:
    s_mov_b32 s81, s36
    s_lshl_b32 s81, s81, 2
    s_and_b32 s82, s3, 3
    s_add_u32 s81, s81, s82
    s_lshr_b32 s82, s81, 5
    s_and_b32 s81, s81, 31
    s_lshl_b32 s72, s80, 1
    s_add_u32 s72, s72, s82
    s_lshl_b32 s74, s72, 15
    s_lshl_b32 s73, s81, 10
    s_add_u32 s73, s73, s74
    s_lshl_b32 s75, s81, 6
    s_add_u32 s74, s74, s75
    s_add_u32 s78, s73, 117440512
    s_add_u32 s79, s73, 75497472
    s_mov_b32 s83, 218106816
    s_mov_b32 s84, 65536
    s_min_u32 s87, s80, 62
    v_and_b32 v8, 7, v1
    v_lshlrev_b32 v8, 22, v8
    s_cmp_lg_u32 s3, 0
    s_cbranch_scc1 ft_ok
ft_wd:
    buffer_load_dword v7, off, s[4:7], s83 sc1
    s_waitcnt vmcnt(0)
    v_readfirstlane_b32 s86, v7
    s_cmp_ge_u32 s86, 16
    s_cbranch_scc1 ft_wdok
    s_sleep 32
    s_sub_u32 s84, s84, 1
    s_cbranch_scc0 ft_wd
    s_mov_b32 s84, 0
ft_wdok:
ft_ok:
    s_barrier
    s_cmp_ge_u32 s3, 4
    s_cbranch_scc1 w_fin_done
    buffer_load_dwordx4 v[88:91], v4, s[8:11], s74 offen
    buffer_load_dwordx4 v[136:139], v3, s[4:7], s78 offen sc1
    s_add_u32 s78, s78, 4194304
    buffer_load_dwordx4 v[144:147], v3, s[4:7], s78 offen sc1
    s_add_u32 s78, s78, 4194304
    buffer_load_dwordx4 v[152:155], v3, s[4:7], s78 offen sc1
    s_add_u32 s78, s78, 4194304
    buffer_load_dwordx4 v[160:163], v3, s[4:7], s78 offen sc1
    s_add_u32 s78, s78, 4194304
    s_waitcnt vmcnt(0)
    v_lshlrev_b32 v120, 16, v136
    v_and_b32 v121, 0xffff0000, v136
    v_lshlrev_b32 v136, 16, v144
    v_and_b32 v144, 0xffff0000, v144
    v_add_f32 v120, v120, v136
    v_add_f32 v121, v121, v144
    v_lshlrev_b32 v136, 16, v152
    v_and_b32 v152, 0xffff0000, v152
    v_add_f32 v120, v120, v136
    v_add_f32 v121, v121, v152
    v_lshlrev_b32 v136, 16, v160
    v_and_b32 v160, 0xffff0000, v160
    v_add_f32 v120, v120, v136
    v_add_f32 v121, v121, v160
    v_cvt_pk_bf16_f32 v136, v120, v121
    v_lshlrev_b32 v120, 16, v136
    v_and_b32 v121, 0xffff0000, v136
    v_mul_f32 v136, s89, v120
    v_mul_f32 v144, s89, v121
    v_lshlrev_b32 v122, 16, v137
    v_and_b32 v123, 0xffff0000, v137
    v_lshlrev_b32 v137, 16, v145
    v_and_b32 v145, 0xffff0000, v145
    v_add_f32 v122, v122, v137
    v_add_f32 v123, v123, v145
    v_lshlrev_b32 v137, 16, v153
    v_and_b32 v153, 0xffff0000, v153
    v_add_f32 v122, v122, v137
    v_add_f32 v123, v123, v153
    v_lshlrev_b32 v137, 16, v161
    v_and_b32 v161, 0xffff0000, v161
    v_add_f32 v122, v122, v137
    v_add_f32 v123, v123, v161
    v_cvt_pk_bf16_f32 v137, v122, v123
    v_lshlrev_b32 v122, 16, v137
    v_and_b32 v123, 0xffff0000, v137
    v_mul_f32 v137, s89, v122
    v_mul_f32 v145, s89, v123
    v_lshlrev_b32 v124, 16, v138
    v_and_b32 v125, 0xffff0000, v138
    v_lshlrev_b32 v138, 16, v146
    v_and_b32 v146, 0xffff0000, v146
    v_add_f32 v124, v124, v138
    v_add_f32 v125, v125, v146
    v_lshlrev_b32 v138, 16, v154
    v_and_b32 v154, 0xffff0000, v154
    v_add_f32 v124, v124, v138
    v_add_f32 v125, v125, v154
    v_lshlrev_b32 v138, 16, v162
    v_and_b32 v162, 0xffff0000, v162
    v_add_f32 v124, v124, v138
    v_add_f32 v125, v125, v162
    v_cvt_pk_bf16_f32 v138, v124, v125
    v_lshlrev_b32 v124, 16, v138
    v_and_b32 v125, 0xffff0000, v138
    v_mul_f32 v138, s89, v124
    v_mul_f32 v146, s89, v125
    v_lshlrev_b32 v126, 16, v139
    v_and_b32 v127, 0xffff0000, v139
    v_lshlrev_b32 v139, 16, v147
    v_and_b32 v147, 0xffff0000, v147
    v_add_f32 v126, v126, v139
    v_add_f32 v127, v127, v147
    v_lshlrev_b32 v139, 16, v155
    v_and_b32 v155, 0xffff0000, v155
    v_add_f32 v126, v126, v139
    v_add_f32 v127, v127, v155
    v_lshlrev_b32 v139, 16, v163
    v_and_b32 v163, 0xffff0000, v163
    v_add_f32 v126, v126, v139
    v_add_f32 v127, v127, v163
    v_cvt_pk_bf16_f32 v139, v126, v127
    v_lshlrev_b32 v126, 16, v139
    v_and_b32 v127, 0xffff0000, v139
    v_mul_f32 v139, s89, v126
    v_mul_f32 v147, s89, v127
    v_exp_f32 v136, v136
    v_exp_f32 v144, v144
    v_exp_f32 v137, v137
    v_exp_f32 v145, v145
    v_exp_f32 v138, v138
    v_exp_f32 v146, v146
    v_exp_f32 v139, v139
    v_exp_f32 v147, v147
    s_nop 0
    v_add_f32 v136, 1.0, v136
    v_add_f32 v144, 1.0, v144
    v_add_f32 v137, 1.0, v137
    v_add_f32 v145, 1.0, v145
    v_add_f32 v138, 1.0, v138
    v_add_f32 v146, 1.0, v146
    v_add_f32 v139, 1.0, v139
    v_add_f32 v147, 1.0, v147
    v_rcp_f32 v136, v136
    v_rcp_f32 v144, v144
    v_rcp_f32 v137, v137
    v_rcp_f32 v145, v145
    v_rcp_f32 v138, v138
    v_rcp_f32 v146, v146
    v_rcp_f32 v139, v139
    v_rcp_f32 v147, v147
    s_nop 0
    v_mul_f32 v120, v120, v136
    v_mul_f32 v121, v121, v144
    v_cvt_pk_bf16_f32 v136, v120, v121
    v_mul_f32 v122, v122, v137
    v_mul_f32 v123, v123, v145
    v_cvt_pk_bf16_f32 v137, v122, v123
    v_mul_f32 v124, v124, v138
    v_mul_f32 v125, v125, v146
    v_cvt_pk_bf16_f32 v138, v124, v125
    v_mul_f32 v126, v126, v139
    v_mul_f32 v127, v127, v147
    v_cvt_pk_bf16_f32 v139, v126, v127
ft_ws:
    buffer_load_dword v7, v6, s[4:7], s85 offen sc1
    s_waitcnt vmcnt(0)
    v_cmp_gt_u32 vcc, s87, v7
    s_cbranch_vccz ft_p
    s_sleep 12
    v_cmp_gt_u32 vcc, 59, v7
    s_cbranch_vccz ft_wsf
    s_sleep 64
    v_cmp_gt_u32 vcc, 56, v7
    s_cbranch_vccz ft_wsf
    s_sleep 127
    s_sleep 127
ft_wsf:
    s_sub_u32 s84, s84, 1
    s_cbranch_scc0 ft_ws
    s_mov_b32 s84, 0
ft_p:
    buffer_load_dword v7, v8, s[4:7], s79 offen offset:1008 sc1
    s_waitcnt vmcnt(0)
    v_cmp_eq_u32 vcc, -1, v7
    s_cbranch_vccz ft_l
    s_sleep 4
    s_sub_u32 s84, s84, 1
    s_cbranch_scc0 ft_p
    s_mov_b32 s84, 0
ft_l:
    s_mov_b32 s86, s79
    buffer_load_dwordx4 v[16:19], v3, s[4:7], s86 offen sc1
    s_add_u32 s86, s86, 4194304
    buffer_load_dwordx4 v[20:23], v3, s[4:7], s86 offen sc1
    s_add_u32 s86, s86, 4194304
    buffer_load_dwordx4 v[24:27], v3, s[4:7], s86 offen sc1
    s_add_u32 s86, s86, 4194304
    buffer_load_dwordx4 v[28:31], v3, s[4:7], s86 offen sc1
    s_add_u32 s86, s86, 4194304
    buffer_load_dwordx4 v[32:35], v3, s[4:7], s86 offen sc1
    s_add_u32 s86, s86, 4194304
    buffer_load_dwordx4 v[36:39], v3, s[4:7], s86 offen sc1
    s_add_u32 s86, s86, 4194304
    buffer_load_dwordx4 v[40:43], v3, s[4:7], s86 offen sc1
    s_add_u32 s86, s86, 4194304
    buffer_load_dwordx4 v[44:47], v3, s[4:7], s86 offen sc1
    s_waitcnt vmcnt(0)
    v_max3_u32 v7, v16, v20, v24
    v_max3_u32 v7, v7, v28, v32
    v_max3_u32 v7, v7, v36, v40
    v_max_u32 v7, v7, v44
    v_cmp_eq_u32 vcc, -1, v7
    s_cbranch_vccz ft_go
    s_sub_u32 s84, s84, 1
    s_cbranch_scc0 ft_l
ft_go:
    v_lshlrev_b32 v96, 16, v16
    v_and_b32 v97, 0xffff0000, v16
    v_lshlrev_b32 v98, 16, v17
    v_and_b32 v99, 0xffff0000, v17
    v_lshlrev_b32 v100, 16, v18
    v_and_b32 v101, 0xffff0000, v18
    v_lshlrev_b32 v102, 16, v19
    v_and_b32 v103, 0xffff0000, v19
    v_lshlrev_b32 v120, 16, v20
    v_and_b32 v121, 0xffff0000, v20
    v_lshlrev_b32 v122, 16, v21
    v_and_b32 v123, 0xffff0000, v21
    v_lshlrev_b32 v124, 16, v22
    v_and_b32 v125, 0xffff0000, v22
    v_lshlrev_b32 v126, 16, v23
    v_and_b32 v127, 0xffff0000, v23
    v_add_f32 v96, v96, v120
    v_add_f32 v97, v97, v121
    v_add_f32 v98, v98, v122
    v_add_f32 v99, v99, v123
    v_add_f32 v100, v100, v124
    v_add_f32 v101, v101, v125
    v_add_f32 v102, v102, v126
    v_add_f32 v103, v103, v127
    v_lshlrev_b32 v120, 16, v24
    v_and_b32 v121, 0xffff0000, v24
    v_lshlrev_b32 v122, 16, v25
    v_and_b32 v123, 0xffff0000, v25
    v_lshlrev_b32 v124, 16, v26
    v_and_b32 v125, 0xffff0000, v26
    v_lshlrev_b32 v126, 16, v27
    v_and_b32 v127, 0xffff0000, v27
    v_add_f32 v96, v96, v120
    v_add_f32 v97, v97, v121
    v_add_f32 v98, v98, v122
    v_add_f32 v99, v99, v123
    v_add_f32 v100, v100, v124
    v_add_f32 v101, v101, v125
    v_add_f32 v102, v102, v126
    v_add_f32 v103, v103, v127
    v_lshlrev_b32 v120, 16, v28
    v_and_b32 v121, 0xffff0000, v28
    v_lshlrev_b32 v122, 16, v29
    v_and_b32 v123, 0xffff0000, v29
    v_lshlrev_b32 v124, 16, v30
    v_and_b32 v125, 0xffff0000, v30
    v_lshlrev_b32 v126, 16, v31
    v_and_b32 v127, 0xffff0000, v31
    v_add_f32 v96, v96, v120
    v_add_f32 v97, v97, v121
    v_add_f32 v98, v98, v122
    v_add_f32 v99, v99, v123
    v_add_f32 v100, v100, v124
    v_add_f32 v101, v101, v125
    v_add_f32 v102, v102, v126
    v_add_f32 v103, v103, v127
    v_lshlrev_b32 v120, 16, v32
    v_and_b32 v121, 0xffff0000, v32
    v_lshlrev_b32 v122, 16, v33
    v_and_b32 v123, 0xffff0000, v33
    v_lshlrev_b32 v124, 16, v34
    v_and_b32 v125, 0xffff0000, v34
    v_lshlrev_b32 v126, 16, v35
    v_and_b32 v127, 0xffff0000, v35
    v_add_f32 v96, v96, v120
    v_add_f32 v97, v97, v121
    v_add_f32 v98, v98, v122
    v_add_f32 v99, v99, v123
    v_add_f32 v100, v100, v124
    v_add_f32 v101, v101, v125
    v_add_f32 v102, v102, v126
    v_add_f32 v103, v103, v127
    v_lshlrev_b32 v120, 16, v36
    v_and_b32 v121, 0xffff0000, v36
    v_lshlrev_b32 v122, 16, v37
    v_and_b32 v123, 0xffff0000, v37
    v_lshlrev_b32 v124, 16, v38
    v_and_b32 v125, 0xffff0000, v38
    v_lshlrev_b32 v126, 16, v39
    v_and_b32 v127, 0xffff0000, v39
    v_add_f32 v96, v96, v120
    v_add_f32 v97, v97, v121
    v_add_f32 v98, v98, v122
    v_add_f32 v99, v99, v123
    v_add_f32 v100, v100, v124
    v_add_f32 v101, v101, v125
    v_add_f32 v102, v102, v126
    v_add_f32 v103, v103, v127
    v_lshlrev_b32 v120, 16, v40
    v_and_b32 v121, 0xffff0000, v40
    v_lshlrev_b32 v122, 16, v41
    v_and_b32 v123, 0xffff0000, v41
    v_lshlrev_b32 v124, 16, v42
    v_and_b32 v125, 0xffff0000, v42
    v_lshlrev_b32 v126, 16, v43
    v_and_b32 v127, 0xffff0000, v43
    v_add_f32 v96, v96, v120
    v_add_f32 v97, v97, v121
    v_add_f32 v98, v98, v122
    v_add_f32 v99, v99, v123
    v_add_f32 v100, v100, v124
    v_add_f32 v101, v101, v125
    v_add_f32 v102, v102, v126
    v_add_f32 v103, v103, v127
    v_lshlrev_b32 v120, 16, v44
    v_and_b32 v121, 0xffff0000, v44
    v_lshlrev_b32 v122, 16, v45
    v_and_b32 v123, 0xffff0000, v45
    v_lshlrev_b32 v124, 16, v46
    v_and_b32 v125, 0xffff0000, v46
    v_lshlrev_b32 v126, 16, v47
    v_and_b32 v127, 0xffff0000, v47
    v_add_f32 v96, v96, v120
    v_add_f32 v97, v97, v121
    v_add_f32 v98, v98, v122
    v_add_f32 v99, v99, v123
    v_add_f32 v100, v100, v124
    v_add_f32 v101, v101, v125
    v_add_f32 v102, v102, v126
    v_add_f32 v103, v103, v127
    v_cndmask_b32 v108, v88, v90, s[76:77]
    v_cndmask_b32 v109, v89, v91, s[76:77]
    v_cndmask_b32 v110, v90, v88, s[76:77]
    v_cndmask_b32 v111, v91, v89, s[76:77]
    v_cvt_pk_bf16_f32 v104, v96, v97
    v_lshlrev_b32 v96, 16, v104
    v_and_b32 v97, 0xffff0000, v104
    v_lshlrev_b32 v104, 16, v136
    v_and_b32 v105, 0xffff0000, v136
    v_mul_f32 v96, v96, v104
    v_mul_f32 v97, v97, v105
    v_cvt_pk_bf16_f32 v104, v96, v97
    v_lshlrev_b32 v96, 16, v104
    v_and_b32 v97, 0xffff0000, v104
    v_lshlrev_b32 v104, 16, v108
    v_and_b32 v105, 0xffff0000, v108
    v_add_f32 v96, v96, v104
    v_add_f32 v97, v97, v105
    v_cvt_pk_bf16_f32 v112, v96, v97
    v_cvt_pk_bf16_f32 v104, v98, v99
    v_lshlrev_b32 v98, 16, v104
    v_and_b32 v99, 0xffff0000, v104
    v_lshlrev_b32 v104, 16, v137
    v_and_b32 v105, 0xffff0000, v137
    v_mul_f32 v98, v98, v104
    v_mul_f32 v99, v99, v105
    v_cvt_pk_bf16_f32 v104, v98, v99
    v_lshlrev_b32 v98, 16, v104
    v_and_b32 v99, 0xffff0000, v104
    v_lshlrev_b32 v104, 16, v109
    v_and_b32 v105, 0xffff0000, v109
    v_add_f32 v98, v98, v104
    v_add_f32 v99, v99, v105
    v_cvt_pk_bf16_f32 v113, v98, v99
    v_cvt_pk_bf16_f32 v104, v100, v101
    v_lshlrev_b32 v100, 16, v104
    v_and_b32 v101, 0xffff0000, v104
    v_lshlrev_b32 v104, 16, v138
    v_and_b32 v105, 0xffff0000, v138
    v_mul_f32 v100, v100, v104
    v_mul_f32 v101, v101, v105
    v_cvt_pk_bf16_f32 v104, v100, v101
    v_lshlrev_b32 v100, 16, v104
    v_and_b32 v101, 0xffff0000, v104
    v_lshlrev_b32 v104, 16, v110
    v_and_b32 v105, 0xffff0000, v110
    v_add_f32 v100, v100, v104
    v_add_f32 v101, v101, v105
    v_cvt_pk_bf16_f32 v114, v100, v101
    v_cvt_pk_bf16_f32 v104, v102, v103
    v_lshlrev_b32 v102, 16, v104
    v_and_b32 v103, 0xffff0000, v104
    v_lshlrev_b32 v104, 16, v139
    v_and_b32 v105, 0xffff0000, v139
    v_mul_f32 v102, v102, v104
    v_mul_f32 v103, v103, v105
    v_cvt_pk_bf16_f32 v104, v102, v103
    v_lshlrev_b32 v102, 16, v104
    v_and_b32 v103, 0xffff0000, v104
    v_lshlrev_b32 v104, 16, v111
    v_and_b32 v105, 0xffff0000, v111
    v_add_f32 v102, v102, v104
    v_add_f32 v103, v103, v105
    v_cvt_pk_bf16_f32 v115, v102, v103
    v_cndmask_b32 v128, v112, v114, s[76:77]
    v_cndmask_b32 v129, v113, v115, s[76:77]
    v_cndmask_b32 v130, v114, v112, s[76:77]
    v_cndmask_b32 v131, v115, v113, s[76:77]
    buffer_store_dwordx4 v[128:131], v4, s[12:15], s74 offen offset:0
    s_branch w_fin_done
w_fin_done:
    s_load_dwordx16 s[32:47], s[24:25], 0
    s_add_u32 s24, s24, 64
    s_addc_u32 s25, s25, 0
    s_waitcnt lgkmcnt(0)
    s_sub_u32 s57, s32, 1
    s_cmp_ge_u32 s57, 5
    s_cbranch_scc1 w_cold
    v_and_b32 v20, 63, v0
    v_lshlrev_b32 v1, 4, v20
    v_add_u32 v19, 0x1000, v1
    v_lshrrev_b32 v4, 4, v20
    v_mov_b32 v17, 0
    v_mov_b32 v18, 1
    s_lshr_b32 s26, s3, 2
    s_and_b32 s27, s3, 3
    s_lshl_b32 s21, s3, 11
    s_lshl_b32 s22, s3, 10
    s_add_u32 s22, s22, 16384
    s_mov_b32 s11, 131072
    s_mov_b32 s15, 131072
    s_mov_b32 s28, 0
    v_and_b32 v21, 15, v20
    v_lshlrev_b32 v22, 2, v4
    v_xor_b32 v21, v21, v22
    s_lshr_b32 s30, s3, 1
    s_and_b32 s30, s30, 1
    v_xor_b32 v21, s30, v21
    v_lshlrev_b32 v3, 4, v21
    s_lshl_b32 s30, s26, 13
    v_add_u32 v5, s30, v1
    v_add_u32 v6, 0x10000, v5
    v_bfe_u32 v21, v20, 2, 2
    v_and_b32 v22, 3, v20
    v_and_b32 v23, 1, v4
    v_xor_b32 v24, s27, v21
    v_xor_b32 v25, v22, v23
    v_lshl_add_u32 v24, v24, 2, v25
    v_lshlrev_b32 v24, 4, v24
    v_lshl_add_u32 v25, v4, 3, v21
    v_lshl_add_u32 v24, v25, 8, v24
    v_and_b32 v22, 1, v22
    v_xor_b32 v25, 0, v23
    v_lshl_add_u32 v8, v25, 10, v24
    v_xor_b32 v25, 0, v22
    v_lshl_add_u32 v8, v25, 3, v8
    v_add_u32 v12, 0x10000, v8
    v_xor_b32 v25, 1, v23
    v_lshl_add_u32 v9, v25, 10, v24
    v_xor_b32 v25, 0, v22
    v_lshl_add_u32 v9, v25, 3, v9
    v_add_u32 v13, 0x10000, v9
    v_xor_b32 v25, 0, v23
    v_lshl_add_u32 v10, v25, 10, v24
    v_xor_b32 v25, 1, v22
    v_lshl_add_u32 v10, v25, 3, v10
    v_add_u32 v14, 0x10000, v10
    v_xor_b32 v25, 1, v23
    v_lshl_add_u32 v11, v25, 10, v24
    v_xor_b32 v25, 1, v22
    v_lshl_add_u32 v11, v25, 3, v11
    v_add_u32 v15, 0x10000, v11
    s_lshl_b32 s30, s3, 2
    s_add_u32 s30, s30, 131072
    v_mov_b32 v7, s30
    s_branch w_cold
chain_map:
    s_lshl_b32 s52, s12, 5
    s_add_u32 s52, s52, s13
    s_lshr_b32 s15, s52, 2
    s_lshr_b32 s14, s52, 4
    s_and_b32 s34, s13, 15
    s_and_b32 s53, s13, 3
    s_mov_b32 s16, 0
    s_mov_b32 s22, 131072
    s_mov_b32 s100, 131072
    s_getreg_b32 s40, hwreg(HW_REG_XCC_ID)
    s_and_b32 s40, s40, 15
    s_mul_i32 s19, s40, s40
    s_lshl_b32 s19, s19, 18
    s_lshl_b32 s40, s40, 8
    s_add_u32 s40, s40, s19
    s_add_u32 s40, s40, 1
    s_lshl_b32 s35, s14, 4
    s_add_u32 s35, s35, 218104320
    s_and_b32 s21, s3, 3
    s_mul_i32 s42, s21, 24576
    s_add_u32 s42, s42, 65536
    s_lshl_b32 s41, s14, 2
    s_add_u32 s41, s41, s21
    s_lshl_b32 s41, s41, 12
    s_cmp_ge_u32 s3, 4
    s_cbranch_scc1 ch_a_pro
    s_add_u32 s41, s41, 262144
    s_lshl_b32 s38, s15, 13
    s_add_u32 s38, s38, 214958080
    s_lshl_b32 s17, s13, 1
    s_and_b32 s18, s3, 1
    s_add_u32 s17, s17, s18
    s_lshl_b32 s17, s17, 1
    s_cmp_lt_u32 s3, 2
    s_cselect_b32 s56, 0xff, 0
    s_mov_b32 s57, s56
    s_lshr_b32 s18, s17, 1
    s_and_b32 s19, s17, 1
    s_lshl_b32 s20, s12, 14
    s_add_u32 s20, s20, 213909504
    s_lshl_b32 s36, s3, 12
    s_add_u32 s36, s36, s20
    s_lshl_b32 s37, s18, 8
    s_add_u32 s37, s37, s20
    s_lshl_b32 s20, s19, 5
    s_add_u32 s37, s37, s20
    s_lshr_b32 s39, s17, 3
    s_lshl_b32 s39, s39, 14
    s_and_b32 s20, s17, 7
    s_lshl_b32 s20, s20, 10
    s_add_u32 s39, s39, s20
    s_add_u32 s39, s39, 209715200
    s_lshl_b32 s30, s14, 22
    s_lshl_b32 s20, s34, 11
    s_add_u32 s30, s30, s20
    s_lshl_b32 s20, s3, 9
    s_add_u32 s30, s30, s20
    s_add_u32 s30, s30, 78643200
    s_lshl_b32 s55, s15, 13
    s_add_u32 s55, s55, 192937984
    s_mov_b32 s26, s38
    s_mov_b32 s54, s30
    s_mov_b32 s29, 2
    s_mov_b32 s58, 0
    s_mov_b32 s31, 786432
    v_and_b32 v20, 63, v0
    v_lshlrev_b32 v1, 4, v20
    v_mov_b32 v10, -1
    v_mov_b32 v11, -1
    v_lshrrev_b32 v21, 2, v20
    v_and_b32 v22, 3, v20
    v_lshlrev_b32 v21, 13, v21
    v_lshl_add_u32 v21, v22, 4, v21
    s_lshl_b32 s17, s3, 21
    s_lshl_b32 s18, s52, 6
    s_add_u32 s17, s17, s18
    s_lshl_b32 s19, s3, 15
    s_mov_b32 s10, 8388608
    s_mov_b32 s11, 131072
    v_lshrrev_b32 v24, 5, v20
    v_bfe_u32 v25, v20, 3, 1
    v_lshl_add_u32 v24, v24, 1, v25
    v_bfe_u32 v26, v20, 4, 1
    v_xor_b32 v26, v26, v25
    v_lshl_add_u32 v24, v24, 1, v26
    v_bfe_u32 v25, v20, 2, 1
    v_lshl_add_u32 v24, v24, 2, v25
    v_lshlrev_b32 v24, 6, v24
    v_lshl_add_u32 v24, v22, 3, v24
    v_add_u32 v24, s19, v24
    s_load_dwordx2 s[8:9], s[0:1], 16
    s_mov_b32 s20, s17
    s_waitcnt lgkmcnt(0)
    s_add_u32 m0, s19, 0
    s_nop 0
    buffer_load_dwordx4 v21, s[8:11], s20 offen lds
    s_add_u32 s20, s20, 131072
    s_add_u32 m0, s19, 1024
    s_nop 0
    buffer_load_dwordx4 v21, s[8:11], s20 offen lds
    s_add_u32 s20, s20, 131072
    s_add_u32 m0, s19, 2048
    s_nop 0
    buffer_load_dwordx4 v21, s[8:11], s20 offen lds
    s_add_u32 s20, s20, 131072
    s_add_u32 m0, s19, 3072
    s_nop 0
    buffer_load_dwordx4 v21, s[8:11], s20 offen lds
    s_add_u32 s20, s20, 131072
    s_add_u32 m0, s19, 4096
    s_nop 0
    buffer_load_dwordx4 v21, s[8:11], s20 offen lds
    s_add_u32 s20, s20, 131072
    s_add_u32 m0, s19, 5120
    s_nop 0
    buffer_load_dwordx4 v21, s[8:11], s20 offen lds
    s_add_u32 s20, s20, 131072
    s_add_u32 m0, s19, 6144
    s_nop 0
    buffer_load_dwordx4 v21, s[8:11], s20 offen lds
    s_add_u32 s20, s20, 131072
    s_add_u32 m0, s19, 7168
    s_nop 0
    buffer_load_dwordx4 v21, s[8:11], s20 offen lds
    s_add_u32 s20, s20, 131072
    s_add_u32 m0, s19, 8192
    s_nop 0
    buffer_load_dwordx4 v21, s[8:11], s20 offen lds
    s_add_u32 s20, s20, 131072
    s_add_u32 m0, s19, 9216
    s_nop 0
    buffer_load_dwordx4 v21, s[8:11], s20 offen lds
    s_add_u32 s20, s20, 131072
    s_add_u32 m0, s19, 10240
    s_nop 0
    buffer_load_dwordx4 v21, s[8:11], s20 offen lds
    s_add_u32 s20, s20, 131072
    s_add_u32 m0, s19, 11264
    s_nop 0
    buffer_load_dwordx4 v21, s[8:11], s20 offen lds
    s_add_u32 s20, s20, 131072
    s_add_u32 m0, s19, 12288
    s_nop 0
    buffer_load_dwordx4 v21, s[8:11], s20 offen lds
    s_add_u32 s20, s20, 131072
    s_add_u32 m0, s19, 13312
    s_nop 0
    buffer_load_dwordx4 v21, s[8:11], s20 offen lds
    s_add_u32 s20, s20, 131072
    s_add_u32 m0, s19, 14336
    s_nop 0
    buffer_load_dwordx4 v21, s[8:11], s20 offen lds
    s_add_u32 s20, s20, 131072
    s_add_u32 m0, s19, 15360
    s_nop 0
    buffer_load_dwordx4 v21, s[8:11], s20 offen lds
    s_add_u32 s20, s20, 131072
    s_load_dwordx2 s[8:9], s[0:1], 24
    s_mov_b32 s20, s17
    s_waitcnt lgkmcnt(0)
    s_add_u32 m0, s19, 16384
    s_nop 0
    buffer_load_dwordx4 v21, s[8:11], s20 offen lds
    s_add_u32 s20, s20, 131072
    s_add_u32 m0, s19, 17408
    s_nop 0
    buffer_load_dwordx4 v21, s[8:11], s20 offen lds
    s_add_u32 s20, s20, 131072
    s_add_u32 m0, s19, 18432
    s_nop 0
    buffer_load_dwordx4 v21, s[8:11], s20 offen lds
    s_add_u32 s20, s20, 131072
    s_add_u32 m0, s19, 19456
    s_nop 0
    buffer_load_dwordx4 v21, s[8:11], s20 offen lds
    s_add_u32 s20, s20, 131072
    s_add_u32 m0, s19, 20480
    s_nop 0
    buffer_load_dwordx4 v21, s[8:11], s20 offen lds
    s_add_u32 s20, s20, 131072
    s_add_u32 m0, s19, 21504
    s_nop 0
    buffer_load_dwordx4 v21, s[8:11], s20 offen lds
    s_add_u32 s20, s20, 131072
    s_add_u32 m0, s19, 22528
    s_nop 0
    buffer_load_dwordx4 v21, s[8:11], s20 offen lds
    s_add_u32 s20, s20, 131072
    s_add_u32 m0, s19, 23552
    s_nop 0
    buffer_load_dwordx4 v21, s[8:11], s20 offen lds
    s_add_u32 s20, s20, 131072
    s_add_u32 m0, s19, 24576
    s_nop 0
    buffer_load_dwordx4 v21, s[8:11], s20 offen lds
    s_add_u32 s20, s20, 131072
    s_add_u32 m0, s19, 25600
    s_nop 0
    buffer_load_dwordx4 v21, s[8:11], s20 offen lds
    s_add_u32 s20, s20, 131072
    s_add_u32 m0, s19, 26624
    s_nop 0
    buffer_load_dwordx4 v21, s[8:11], s20 offen lds
    s_add_u32 s20, s20, 131072
    s_add_u32 m0, s19, 27648
    s_nop 0
    buffer_load_dwordx4 v21, s[8:11], s20 offen lds
    s_add_u32 s20, s20, 131072
    s_add_u32 m0, s19, 28672
    s_nop 0
    buffer_load_dwordx4 v21, s[8:11], s20 offen lds
    s_add_u32 s20, s20, 131072
    s_add_u32 m0, s19, 29696
    s_nop 0
    buffer_load_dwordx4 v21, s[8:11], s20 offen lds
    s_add_u32 s20, s20, 131072
    s_add_u32 m0, s19, 30720
    s_nop 0
    buffer_load_dwordx4 v21, s[8:11], s20 offen lds
    s_add_u32 s20, s20, 131072
    s_add_u32 m0, s19, 31744
    s_nop 0
    buffer_load_dwordx4 v21, s[8:11], s20 offen lds
    s_add_u32 s20, s20, 131072
    s_load_dwordx2 s[8:9], s[0:1], 32
    s_mov_b32 s20, s17
    s_waitcnt lgkmcnt(0)
    buffer_load_dwordx4 v[96:99], v21, s[8:11], s20 offen
    s_add_u32 s20, s20, 131072
    buffer_load_dwordx4 v[100:103], v21, s[8:11], s20 offen
    s_add_u32 s20, s20, 131072
    buffer_load_dwordx4 v[104:107], v21, s[8:11], s20 offen
    s_add_u32 s20, s20, 131072
    buffer_load_dwordx4 v[108:111], v21, s[8:11], s20 offen
    s_add_u32 s20, s20, 131072
    buffer_load_dwordx4 v[144:147], v21, s[8:11], s20 offen
    s_add_u32 s20, s20, 131072
    buffer_load_dwordx4 v[148:151], v21, s[8:11], s20 offen
    s_add_u32 s20, s20, 131072
    buffer_load_dwordx4 v[152:155], v21, s[8:11], s20 offen
    s_add_u32 s20, s20, 131072
    buffer_load_dwordx4 v[156:159], v21, s[8:11], s20 offen
    s_add_u32 s20, s20, 131072
    buffer_load_dwordx4 v[192:195], v21, s[8:11], s20 offen
    s_add_u32 s20, s20, 131072
    buffer_load_dwordx4 v[196:199], v21, s[8:11], s20 offen
    s_add_u32 s20, s20, 131072
    buffer_load_dwordx4 v[200:203], v21, s[8:11], s20 offen
    s_add_u32 s20, s20, 131072
    buffer_load_dwordx4 v[204:207], v21, s[8:11], s20 offen
    s_add_u32 s20, s20, 131072
    buffer_load_dwordx4 v[240:243], v21, s[8:11], s20 offen
    s_add_u32 s20, s20, 131072
    buffer_load_dwordx4 v[244:247], v21, s[8:11], s20 offen
    s_add_u32 s20, s20, 131072
    buffer_load_dwordx4 v[248:251], v21, s[8:11], s20 offen
    s_add_u32 s20, s20, 131072
    buffer_load_dwordx4 v[252:255], v21, s[8:11], s20 offen
    s_add_u32 s20, s20, 131072
    s_load_dwordx2 s[8:9], s[0:1], 8
    s_mov_b32 s10, 16384
    v_bfe_u32 v57, v20, 2, 2
    v_and_b32 v58, 1, v20
    v_lshl_add_u32 v57, v57, 1, v58
    v_lshlrev_b32 v57, 11, v57
    v_lshrrev_b32 v58, 4, v20
    v_lshl_add_u32 v57, v58, 5, v57
    v_bfe_u32 v58, v20, 1, 1
    v_lshl_add_u32 v57, v58, 4, v57
    v_lshl_add_u32 v59, v58, 3, v57
    v_xor_b32 v60, 8, v59
    s_lshl_b32 s20, s3, 9
    s_waitcnt lgkmcnt(0)
    buffer_load_dwordx2 v[32:33], v59, s[8:11], s20 offen offset:0
    buffer_load_dwordx2 v[34:35], v60, s[8:11], s20 offen offset:0
    buffer_load_dwordx2 v[36:37], v59, s[8:11], s20 offen offset:128
    buffer_load_dwordx2 v[38:39], v60, s[8:11], s20 offen offset:128
    buffer_load_dwordx2 v[40:41], v59, s[8:11], s20 offen offset:256
    buffer_load_dwordx2 v[42:43], v60, s[8:11], s20 offen offset:256
    buffer_load_dwordx2 v[44:45], v59, s[8:11], s20 offen offset:384
    buffer_load_dwordx2 v[46:47], v60, s[8:11], s20 offen offset:384
    s_barrier
    v_add_u32 v56, s19, v1
    s_waitcnt vmcnt(40)
    ds_read_b64_tr_b16 v[64:65], v24 offset:0
    ds_read_b64_tr_b16 v[66:67], v24 offset:128
    ds_read_b64_tr_b16 v[68:69], v24 offset:2048
    ds_read_b64_tr_b16 v[70:71], v24 offset:2176
    ds_read_b64_tr_b16 v[72:73], v24 offset:32
    ds_read_b64_tr_b16 v[74:75], v24 offset:160
    ds_read_b64_tr_b16 v[76:77], v24 offset:2080
    ds_read_b64_tr_b16 v[78:79], v24 offset:2208
    s_waitcnt lgkmcnt(0)
    ds_read_b64_tr_b16 v[112:113], v24 offset:4096
    ds_read_b64_tr_b16 v[114:115], v24 offset:4224
    ds_read_b64_tr_b16 v[116:117], v24 offset:6144
    ds_read_b64_tr_b16 v[118:119], v24 offset:6272
    ds_read_b64_tr_b16 v[120:121], v24 offset:4128
    ds_read_b64_tr_b16 v[122:123], v24 offset:4256
    ds_read_b64_tr_b16 v[124:125], v24 offset:6176
    ds_read_b64_tr_b16 v[126:127], v24 offset:6304
    s_waitcnt lgkmcnt(0)
    ds_read_b64_tr_b16 v[160:161], v24 offset:8192
    ds_read_b64_tr_b16 v[162:163], v24 offset:8320
    ds_read_b64_tr_b16 v[164:165], v24 offset:10240
    ds_read_b64_tr_b16 v[166:167], v24 offset:10368
    ds_read_b64_tr_b16 v[168:169], v24 offset:8224
    ds_read_b64_tr_b16 v[170:171], v24 offset:8352
    ds_read_b64_tr_b16 v[172:173], v24 offset:10272
    ds_read_b64_tr_b16 v[174:175], v24 offset:10400
    s_waitcnt lgkmcnt(0)
    ds_read_b64_tr_b16 v[208:209], v24 offset:12288
    ds_read_b64_tr_b16 v[210:211], v24 offset:12416
    ds_read_b64_tr_b16 v[212:213], v24 offset:14336
    ds_read_b64_tr_b16 v[214:215], v24 offset:14464
    ds_read_b64_tr_b16 v[216:217], v24 offset:12320
    ds_read_b64_tr_b16 v[218:219], v24 offset:12448
    ds_read_b64_tr_b16 v[220:221], v24 offset:14368
    ds_read_b64_tr_b16 v[222:223], v24 offset:14496
    s_waitcnt lgkmcnt(0)
    s_waitcnt vmcnt(24)
    ds_read_b64_tr_b16 v[80:81], v24 offset:16384
    ds_read_b64_tr_b16 v[82:83], v24 offset:16512
    ds_read_b64_tr_b16 v[84:85], v24 offset:18432
    ds_read_b64_tr_b16 v[86:87], v24 offset:18560
    ds_read_b64_tr_b16 v[88:89], v24 offset:16416
    ds_read_b64_tr_b16 v[90:91], v24 offset:16544
    ds_read_b64_tr_b16 v[92:93], v24 offset:18464
    ds_read_b64_tr_b16 v[94:95], v24 offset:18592
    s_waitcnt lgkmcnt(0)
    ds_read_b64_tr_b16 v[128:129], v24 offset:20480
    ds_read_b64_tr_b16 v[130:131], v24 offset:20608
    ds_read_b64_tr_b16 v[132:133], v24 offset:22528
    ds_read_b64_tr_b16 v[134:135], v24 offset:22656
    ds_read_b64_tr_b16 v[136:137], v24 offset:20512
    ds_read_b64_tr_b16 v[138:139], v24 offset:20640
    ds_read_b64_tr_b16 v[140:141], v24 offset:22560
    ds_read_b64_tr_b16 v[142:143], v24 offset:22688
    s_waitcnt lgkmcnt(0)
    ds_read_b64_tr_b16 v[176:177], v24 offset:24576
    ds_read_b64_tr_b16 v[178:179], v24 offset:24704
    ds_read_b64_tr_b16 v[180:181], v24 offset:26624
    ds_read_b64_tr_b16 v[182:183], v24 offset:26752
    ds_read_b64_tr_b16 v[184:185], v24 offset:24608
    ds_read_b64_tr_b16 v[186:187], v24 offset:24736
    ds_read_b64_tr_b16 v[188:189], v24 offset:26656
    ds_read_b64_tr_b16 v[190:191], v24 offset:26784
    s_waitcnt lgkmcnt(0)
    ds_read_b64_tr_b16 v[224:225], v24 offset:28672
    ds_read_b64_tr_b16 v[226:227], v24 offset:28800
    ds_read_b64_tr_b16 v[228:229], v24 offset:30720
    ds_read_b64_tr_b16 v[230:231], v24 offset:30848
    ds_read_b64_tr_b16 v[232:233], v24 offset:28704
    ds_read_b64_tr_b16 v[234:235], v24 offset:28832
    ds_read_b64_tr_b16 v[236:237], v24 offset:30752
    ds_read_b64_tr_b16 v[238:239], v24 offset:30880
    s_waitcnt lgkmcnt(0)
    s_waitcnt vmcnt(8)
    ds_write_b128 v56, v[96:99] offset:0
    ds_write_b128 v56, v[100:103] offset:1024
    ds_write_b128 v56, v[104:107] offset:2048
    ds_write_b128 v56, v[108:111] offset:3072
    ds_write_b128 v56, v[144:147] offset:4096
    ds_write_b128 v56, v[148:151] offset:5120
    ds_write_b128 v56, v[152:155] offset:6144
    ds_write_b128 v56, v[156:159] offset:7168
    ds_write_b128 v56, v[192:195] offset:8192
    ds_write_b128 v56, v[196:199] offset:9216
    ds_write_b128 v56, v[200:203] offset:10240
    ds_write_b128 v56, v[204:207] offset:11264
    ds_write_b128 v56, v[240:243] offset:12288
    ds_write_b128 v56, v[244:247] offset:13312
    ds_write_b128 v56, v[248:251] offset:14336
    ds_write_b128 v56, v[252:255] offset:15360
    s_waitcnt lgkmcnt(0)
    ds_read_b64_tr_b16 v[96:97], v24 offset:0
    ds_read_b64_tr_b16 v[98:99], v24 offset:128
    ds_read_b64_tr_b16 v[100:101], v24 offset:2048
    ds_read_b64_tr_b16 v[102:103], v24 offset:2176
    ds_read_b64_tr_b16 v[104:105], v24 offset:32
    ds_read_b64_tr_b16 v[106:107], v24 offset:160
    ds_read_b64_tr_b16 v[108:109], v24 offset:2080
    ds_read_b64_tr_b16 v[110:111], v24 offset:2208
    s_waitcnt lgkmcnt(0)
    ds_read_b64_tr_b16 v[144:145], v24 offset:4096
    ds_read_b64_tr_b16 v[146:147], v24 offset:4224
    ds_read_b64_tr_b16 v[148:149], v24 offset:6144
    ds_read_b64_tr_b16 v[150:151], v24 offset:6272
    ds_read_b64_tr_b16 v[152:153], v24 offset:4128
    ds_read_b64_tr_b16 v[154:155], v24 offset:4256
    ds_read_b64_tr_b16 v[156:157], v24 offset:6176
    ds_read_b64_tr_b16 v[158:159], v24 offset:6304
    s_waitcnt lgkmcnt(0)
    ds_read_b64_tr_b16 v[192:193], v24 offset:8192
    ds_read_b64_tr_b16 v[194:195], v24 offset:8320
    ds_read_b64_tr_b16 v[196:197], v24 offset:10240
    ds_read_b64_tr_b16 v[198:199], v24 offset:10368
    ds_read_b64_tr_b16 v[200:201], v24 offset:8224
    ds_read_b64_tr_b16 v[202:203], v24 offset:8352
    ds_read_b64_tr_b16 v[204:205], v24 offset:10272
    ds_read_b64_tr_b16 v[206:207], v24 offset:10400
    s_waitcnt lgkmcnt(0)
    ds_read_b64_tr_b16 v[240:241], v24 offset:12288
    ds_read_b64_tr_b16 v[242:243], v24 offset:12416
    ds_read_b64_tr_b16 v[244:245], v24 offset:14336
    ds_read_b64_tr_b16 v[246:247], v24 offset:14464
    ds_read_b64_tr_b16 v[248:249], v24 offset:12320
    ds_read_b64_tr_b16 v[250:251], v24 offset:12448
    ds_read_b64_tr_b16 v[252:253], v24 offset:14368
    ds_read_b64_tr_b16 v[254:255], v24 offset:14496
    s_waitcnt lgkmcnt(0)
    v_mov_b32 v21, 0x44444444
    v_mov_b32 v22, 0xeeeeeeee
    v_and_b32 v23, 2, v20
    v_cmp_eq_u32 vcc, 0, v23
    s_nop 1
    v_cndmask_b32 v8, v22, v21, vcc
    v_bfe_u32 v21, v20, 2, 3
    v_lshrrev_b32 v22, 5, v20
    v_mul_u32_u24 v23, 160, v21
    v_mul_u32_u24 v24, 1280, v22
    v_add_u32 v23, v23, v24
    v_and_b32 v24, 3, v20
    v_lshl_add_u32 v27, v24, 4, v23
    v_lshrrev_b32 v23, 1, v21
    v_and_b32 v21, 1, v21
    v_lshl_add_u32 v21, v23, 2, v21
    v_xor_b32 v22, 1, v22
    v_lshl_add_u32 v21, v22, 1, v21
    v_bfe_u32 v22, v20, 1, 1
    v_lshl_add_u32 v21, v22, 4, v21
    v_xor_b32 v22, v20, v22
    v_and_b32 v22, 1, v22
    v_lshlrev_b32 v21, 4, v21
    v_lshl_add_u32 v25, v22, 3, v21
    v_lshrrev_b32 v21, 3, v20
    v_mul_u32_u24 v23, 160, v21
    v_and_b32 v24, 7, v20
    v_lshl_add_u32 v28, v24, 4, v23
    v_lshrrev_b32 v23, 1, v21
    v_and_b32 v21, 1, v21
    v_lshl_add_u32 v21, v23, 2, v21
    v_and_b32 v22, 1, v20
    v_lshl_add_u32 v21, v22, 1, v21
    v_bfe_u32 v22, v20, 2, 1
    v_lshl_add_u32 v21, v22, 4, v21
    v_bfe_u32 v22, v20, 1, 1
    v_lshlrev_b32 v21, 4, v21
    v_lshl_add_u32 v26, v22, 3, v21
    s_lshl_b32 s17, s53, 10
    s_lshl_b32 s18, s3, 9
    s_add_u32 s17, s17, s18
    s_lshl_b32 s18, s3, 6
    s_lshl_b32 s19, s53, 9
    s_add_u32 s19, s19, 4096
    s_cmp_ge_u32 s3, 2
    s_cselect_b32 s17, s19, s17
    s_cselect_b32 s18, 2560, s18
    s_cselect_b64 vcc, -1, 0
    v_cndmask_b32 v22, v25, v26, vcc
    v_cndmask_b32 v23, v27, v28, vcc
    v_add_u32 v2, s17, v22
    v_add_u32 v4, s18, v23
    v_lshrrev_b32 v21, 4, v20
    v_and_b32 v22, 15, v20
    v_mul_u32_u24 v23, 320, v21
    v_lshl_add_u32 v23, v22, 2, v23
    s_mul_i32 s17, s3, 3840
    v_add_u32 v3, s17, v23
    v_add_u32 v61, 1280, v3
    v_bfe_u32 v24, v20, 3, 1
    v_bfe_u32 v25, v20, 2, 1
    v_xor_b32 v25, v25, v24
    v_bfe_u32 v26, v20, 1, 1
    v_lshl_add_u32 v25, v26, 1, v25
    v_lshl_add_u32 v25, v24, 2, v25
    v_and_b32 v26, 1, v20
    v_lshl_add_u32 v25, v25, 1, v26
    v_sub_u32 v25, v25, v22
    v_lshl_add_u32 v25, v25, 2, v3
    v_add_u32 v62, 2560, v25
    v_lshlrev_b32 v23, 4, v22
    v_lshl_add_u32 v6, v21, 12, v23
    s_lshl_b32 s17, s3, 10
    s_add_u32 s17, s17, 32768
    v_add_u32 v6, s17, v6
    v_lshrrev_b32 v24, 1, v21
    v_lshl_add_u32 v23, v24, 15, v23
    v_and_b32 v24, 1, v21
    v_lshl_add_u32 v7, v24, 8, v23
    v_mov_b32 v58, 15872
    v_bfe_u32 v23, v20, 1, 2
    v_lshlrev_b32 v23, 6, v23
    v_and_b32 v25, 1, v20
    v_lshl_add_u32 v23, v25, 4, v23
    v_lshrrev_b32 v24, 5, v20
    v_lshl_add_u32 v5, v24, 5, v23
    v_and_b32 v23, 7, v20
    v_lshlrev_b32 v23, 7, v23
    v_bfe_u32 v24, v20, 3, 1
    v_lshl_add_u32 v23, v24, 17, v23
    v_lshrrev_b32 v24, 4, v20
    v_add_u32 v24, 1, v24
    v_cmp_le_u32 vcc, 3, v24
    s_nop 1
    v_cndmask_b32 v24, v24, 0, vcc
    v_lshl_add_u32 v23, v24, 24, v23
    s_lshl_b32 s17, s14, 14
    s_lshl_b32 s18, s34, 10
    s_add_u32 s17, s17, s18
    s_add_u32 s17, s17, 4194304
    v_add_u32 v0, s17, v23
    s_lshl_b32 s17, s3, 2
    s_add_u32 s17, s17, 15872
    v_mov_b32 v63, s17
    v_and_b32 v21, 15, v20
    v_and_b32 v22, 1, v21
    v_lshlrev_b32 v22, 4, v22
    v_mov_b32 v12, 0x3f80
    v_lshlrev_b32 v22, v22, v12
    v_lshrrev_b32 v21, 1, v21
    v_cmp_eq_u32 vcc, 0, v21
    s_nop 1
    v_cndmask_b32 v12, 0, v22, vcc
    v_cmp_eq_u32 vcc, 1, v21
    s_nop 1
    v_cndmask_b32 v13, 0, v22, vcc
    v_cmp_eq_u32 vcc, 2, v21
    s_nop 1
    v_cndmask_b32 v14, 0, v22, vcc
    v_cmp_eq_u32 vcc, 3, v21
    s_nop 1
    v_cndmask_b32 v15, 0, v22, vcc
    s_waitcnt vmcnt(0)
    v_mov_b32 v16, v32
    v_mov_b32 v17, v33
    v_mov_b32 v18, v34
    v_mov_b32 v19, v35
    v_mov_b32 v20, v36
    v_mov_b32 v21, v37
    v_mov_b32 v22, v38
    v_mov_b32 v23, v39
    v_mov_b32 v24, v40
    v_mov_b32 v25, v41
    v_mov_b32 v26, v42
    v_mov_b32 v27, v43
    v_mov_b32 v28, v44
    v_mov_b32 v29, v45
    v_mov_b32 v30, v46
    v_mov_b32 v31, v47
    v_mov_b32 v52, -1
    v_mov_b32 v53, -1
    v_mov_b32 v54, -1
    v_mov_b32 v55, -1
    s_add_u32 s17, s30, 851968
    buffer_store_dwordx4 v[52:55], v7, s[4:7], s17 offen sc1
    s_add_u32 s17, s30, 917504
    buffer_store_dwordx4 v[52:55], v7, s[4:7], s17 offen sc1
    s_add_u32 s17, s30, 983040
    buffer_store_dwordx4 v[52:55], v7, s[4:7], s17 offen sc1
    s_lshl_b32 s40, s40, 5
    s_barrier
    ds_write_b32 v63, v10
    ds_write_b32 v63, v10 offset:16
    ds_write_b32 v63, v10 offset:32
    ds_write_b32 v63, v10 offset:48
    v_mov_b32 v60, 12
    v_mov_b32 v56, 15968
    s_waitcnt lgkmcnt(0)
    s_barrier
    ds_read_b64 v[32:33], v56
    s_waitcnt lgkmcnt(0)
    v_cmp_ne_u32 vcc, s40, v32
    s_setprio 3
    v_readfirstlane_b32 s17, v33
    s_add_u32 s39, s39, s17
    s_cbranch_vccnz ch_p_slow
    v_mov_b32 v32, 0
    v_mov_b32 v33, 0
    v_mov_b32 v34, 0
    v_mov_b32 v35, 0
    v_mov_b32 v36, 0
    v_mov_b32 v37, 0
    v_mov_b32 v38, 0
    v_mov_b32 v39, 0
    v_mov_b32 v40, 0
    v_mov_b32 v41, 0
    v_mov_b32 v42, 0
    v_mov_b32 v43, 0
    v_mov_b32 v44, 0
    v_mov_b32 v45, 0
    v_mov_b32 v46, 0
    v_mov_b32 v47, 0
    v_mov_b32 v48, 0
    v_mov_b32 v49, 0
    v_mov_b32 v50, 0
    v_mov_b32 v51, 0
    v_mov_b32 v52, 0
    v_mov_b32 v53, 0
    v_mov_b32 v54, 0
    v_mov_b32 v55, 0
    v_mov_b32 v59, 0
    s_nop 1
    s_branch ploopL_7_nc
.p2align 6
    s_nop 0
    s_nop 0
    s_nop 0
    s_nop 0
    s_nop 0
    s_nop 0
    s_nop 0
    s_nop 0
    s_nop 0
    s_nop 0
    s_nop 0
ploopL_7:
    v_mov_b32 v32, 0
    v_mov_b32 v33, 0
    v_mov_b32 v34, 0
    v_mov_b32 v35, 0
    v_mov_b32 v36, 0
    v_mov_b32 v37, 0
    v_mov_b32 v38, 0
    v_mov_b32 v39, 0
    v_mov_b32 v40, 0
    v_mov_b32 v41, 0
    v_mov_b32 v42, 0
    v_mov_b32 v43, 0
    v_mov_b32 v44, 0
    v_mov_b32 v45, 0
    v_mov_b32 v46, 0
    v_mov_b32 v47, 0
    v_mov_b32 v48, 0
    v_mov_b32 v49, 0
    v_mov_b32 v50, 0
    v_mov_b32 v51, 0
    v_mov_b32 v52, 0
    v_mov_b32 v53, 0
    v_mov_b32 v54, 0
    v_mov_b32 v55, 0
    s_sleep 1
    buffer_load_dwordx4 v[16:19], v1, s[4:7], s23 offen offset:0 sc1
    buffer_load_dwordx4 v[20:23], v1, s[4:7], s23 offen offset:1024 sc1
    buffer_load_dwordx4 v[24:27], v1, s[4:7], s23 offen offset:2048 sc1
    buffer_load_dwordx4 v[28:31], v1, s[4:7], s23 offen offset:3072 sc1
    s_waitcnt vmcnt(3)
    v_cmp_eq_u32 vcc, -1, v16
    s_cbranch_vccnz ploopL_7_rm_0
ploopL_7_rm_0ok:
    v_smfmac_f32_16x16x64_bf16 v[32:35], v[16:19], v[64:71], v8
    v_smfmac_f32_16x16x64_bf16 v[36:39], v[16:19], v[72:79], v8
    s_waitcnt vmcnt(2)
    v_cmp_eq_u32 vcc, -1, v20
    v_smfmac_f32_16x16x64_bf16 v[40:43], v[16:19], v[80:87], v8
    v_smfmac_f32_16x16x64_bf16 v[44:47], v[16:19], v[88:95], v8
    v_smfmac_f32_16x16x64_bf16 v[48:51], v[16:19], v[96:103], v8
    v_smfmac_f32_16x16x64_bf16 v[52:55], v[16:19], v[104:111], v8
    s_cbranch_vccnz ploopL_7_rm_1
ploopL_7_rm_1ok:
    v_smfmac_f32_16x16x64_bf16 v[32:35], v[20:23], v[112:119], v8
    v_smfmac_f32_16x16x64_bf16 v[36:39], v[20:23], v[120:127], v8
    s_waitcnt vmcnt(1)
    v_cmp_eq_u32 vcc, -1, v24
    v_smfmac_f32_16x16x64_bf16 v[40:43], v[20:23], v[128:135], v8
    v_smfmac_f32_16x16x64_bf16 v[44:47], v[20:23], v[136:143], v8
    v_smfmac_f32_16x16x64_bf16 v[48:51], v[20:23], v[144:151], v8
    v_smfmac_f32_16x16x64_bf16 v[52:55], v[20:23], v[152:159], v8
    s_cbranch_vccnz ploopL_7_rm_2
ploopL_7_rm_2ok:
    v_smfmac_f32_16x16x64_bf16 v[32:35], v[24:27], v[160:167], v8
    v_smfmac_f32_16x16x64_bf16 v[36:39], v[24:27], v[168:175], v8
    s_waitcnt vmcnt(0)
    v_cmp_eq_u32 vcc, -1, v28
    v_smfmac_f32_16x16x64_bf16 v[40:43], v[24:27], v[176:183], v8
    v_smfmac_f32_16x16x64_bf16 v[44:47], v[24:27], v[184:191], v8
    v_smfmac_f32_16x16x64_bf16 v[48:51], v[24:27], v[192:199], v8
    v_smfmac_f32_16x16x64_bf16 v[52:55], v[24:27], v[200:207], v8
    s_cbranch_vccnz ploopL_7_rm_3
ploopL_7_rm_3ok:
    v_smfmac_f32_16x16x64_bf16 v[32:35], v[28:31], v[208:215], v8
    ds_write_b32 v63, v59 offset:32
    v_smfmac_f32_16x16x64_bf16 v[36:39], v[28:31], v[216:223], v8
    v_smfmac_f32_16x16x64_bf16 v[40:43], v[28:31], v[224:231], v8
    v_smfmac_f32_16x16x64_bf16 v[44:47], v[28:31], v[232:239], v8
    v_smfmac_f32_16x16x64_bf16 v[48:51], v[28:31], v[240:247], v8
    v_smfmac_f32_16x16x64_bf16 v[52:55], v[28:31], v[248:255], v8
    s_branch ploopL_7_mmd
ploopL_7_nc:
    v_smfmac_f32_16x16x64_bf16 v[32:35], v[16:19], v[64:71], v8
    v_smfmac_f32_16x16x64_bf16 v[36:39], v[16:19], v[72:79], v8
    v_smfmac_f32_16x16x64_bf16 v[40:43], v[16:19], v[80:87], v8
    v_smfmac_f32_16x16x64_bf16 v[44:47], v[16:19], v[88:95], v8
    v_smfmac_f32_16x16x64_bf16 v[48:51], v[16:19], v[96:103], v8
    v_smfmac_f32_16x16x64_bf16 v[52:55], v[16:19], v[104:111], v8
    v_smfmac_f32_16x16x64_bf16 v[32:35], v[20:23], v[112:119], v8
    v_smfmac_f32_16x16x64_bf16 v[36:39], v[20:23], v[120:127], v8
    v_smfmac_f32_16x16x64_bf16 v[40:43], v[20:23], v[128:135], v8
    v_smfmac_f32_16x16x64_bf16 v[44:47], v[20:23], v[136:143], v8
    v_smfmac_f32_16x16x64_bf16 v[48:51], v[20:23], v[144:151], v8
    v_smfmac_f32_16x16x64_bf16 v[52:55], v[20:23], v[152:159], v8
    v_smfmac_f32_16x16x64_bf16 v[32:35], v[24:27], v[160:167], v8
    v_smfmac_f32_16x16x64_bf16 v[36:39], v[24:27], v[168:175], v8
    v_smfmac_f32_16x16x64_bf16 v[40:43], v[24:27], v[176:183], v8
    v_smfmac_f32_16x16x64_bf16 v[44:47], v[24:27], v[184:191], v8
    v_smfmac_f32_16x16x64_bf16 v[48:51], v[24:27], v[192:199], v8
    v_smfmac_f32_16x16x64_bf16 v[52:55], v[24:27], v[200:207], v8
    v_smfmac_f32_16x16x64_bf16 v[32:35], v[28:31], v[208:215], v8
    ds_write_b32 v63, v59 offset:32
    v_smfmac_f32_16x16x64_bf16 v[36:39], v[28:31], v[216:223], v8
    v_smfmac_f32_16x16x64_bf16 v[40:43], v[28:31], v[224:231], v8
    v_smfmac_f32_16x16x64_bf16 v[44:47], v[28:31], v[232:239], v8
    v_smfmac_f32_16x16x64_bf16 v[48:51], v[28:31], v[240:247], v8
    v_smfmac_f32_16x16x64_bf16 v[52:55], v[28:31], v[248:255], v8
ploopL_7_mmd:
    s_cmp_eq_u32 s3, 3
    s_nop 1
    v_add_f32 v32, v32, v34
    v_add_f32 v33, v33, v35
    ds_write2_b32 v3, v32, v33 offset0:0 offset1:40
    v_add_f32 v36, v36, v38
    v_add_f32 v37, v37, v39
    ds_write2_b32 v3, v36, v37 offset0:16 offset1:56
    v_add_f32 v40, v40, v42
    v_add_f32 v41, v41, v43
    ds_write2_b32 v61, v40, v41 offset0:0 offset1:40
    v_add_f32 v44, v44, v46
    v_add_f32 v45, v45, v47
    ds_write2_b32 v61, v44, v45 offset0:16 offset1:56
    v_add_f32 v48, v48, v50
    v_add_f32 v49, v49, v51
    ds_write2_b32 v62, v48, v49 offset0:0 offset1:40
    v_add_f32 v52, v52, v54
    v_add_f32 v53, v53, v55
    ds_write2_b32 v62, v52, v53 offset0:16 offset1:56
    s_waitcnt lgkmcnt(0)
    s_barrier
    s_cbranch_scc1 ploopL_7_sk1
    ds_read_b128 v[32:35], v4 offset:0
    ds_read_b128 v[36:39], v4 offset:3840
    ds_read_b128 v[40:43], v4 offset:7680
    ds_read_b128 v[44:47], v4 offset:11520
    s_waitcnt lgkmcnt(2)
    v_add_f32 v32, v32, v36
    v_add_f32 v33, v33, v37
    v_add_f32 v34, v34, v38
    v_add_f32 v35, v35, v39
    s_waitcnt lgkmcnt(0)
    v_add_f32 v40, v40, v44
    v_add_f32 v41, v41, v45
    v_add_f32 v42, v42, v46
    v_add_f32 v43, v43, v47
    v_add_f32 v32, v32, v40
    v_add_f32 v33, v33, v41
    v_add_f32 v34, v34, v42
    v_add_f32 v35, v35, v43
    v_cvt_pk_bf16_f32 v56, v32, v33
    v_cvt_pk_bf16_f32 v57, v34, v35
    v_min_u32 v56, -2, v56
    buffer_store_dwordx2 v[56:57], v2, s[4:7], s26 offen
    s_add_u32 s27, s16, 2
    s_and_b32 s27, s27, 3
    s_lshl_b32 s27, s27, 18
    s_add_u32 s27, s27, s38
    buffer_store_dwordx2 v[10:11], v2, s[4:7], s27 offen
ploopL_7_sk1:
    s_setprio 0
    s_add_u32 s25, s16, 3
    s_and_b32 s25, s25, 3
    s_lshl_b32 s25, s25, 16
    s_add_u32 s25, s25, s37
    v_mov_b32 v44, -1
    v_mov_b32 v45, -1
    v_mov_b32 v46, -1
    v_mov_b32 v47, -1
    s_mov_b64 exec, s[56:57]
    buffer_store_dwordx4 v[44:47], v5, s[4:7], s25 offen
    s_mov_b64 exec, -1
    v_mov_b32_dpp v48, v12 row_ror:8 row_mask:0xf bank_mask:0xf
    v_mov_b32_dpp v49, v13 row_ror:8 row_mask:0xf bank_mask:0xf
    v_mov_b32_dpp v50, v14 row_ror:8 row_mask:0xf bank_mask:0xf
    v_mov_b32_dpp v51, v15 row_ror:8 row_mask:0xf bank_mask:0xf
    s_and_b32 s28, s16, 3
    s_lshl_b32 s28, s28, 18
    s_add_u32 s28, s28, s39
    s_add_u32 s24, s16, 1
    s_and_b32 s24, s24, 3
    s_lshl_b32 s24, s24, 16
    s_add_u32 s24, s24, s37
    s_add_u32 s23, s16, 1
    s_and_b32 s23, s23, 3
    s_lshl_b32 s23, s23, 16
    s_add_u32 s23, s23, s36
    s_add_u32 s26, s16, 1
    s_and_b32 s26, s26, 3
    s_lshl_b32 s26, s26, 18
    s_add_u32 s26, s26, s38
    v_mov_b32 v40, v2
    v_mov_b32 v42, v56
    v_mov_b32 v43, v57
    s_cmp_lg_u32 s3, 2
    s_cbranch_scc1 ploopL_7_nx
    v_and_b32 v40, 0x60, v1
    v_lshlrev_b32 v40, 2, v40
    v_lshrrev_b32 v41, 3, v1
    v_and_b32 v41, 0x70, v41
    v_or_b32 v40, v40, v41
    v_bfe_u32 v41, v1, 4, 1
    v_lshl_or_b32 v40, v41, 3, v40
    s_lshl_b32 s17, s53, 9
    s_add_u32 s17, s17, 4096
    v_add_u32 v40, s17, v40
    s_mov_b32 vcc_lo, 0x55555555
    s_mov_b32 vcc_hi, 0x55555555
    v_cndmask_b32_dpp v42, v57, v56, vcc quad_perm:[1,0,3,2] row_mask:0xf bank_mask:0xf
    s_not_b64 vcc, vcc
    v_cndmask_b32_dpp v43, v56, v57, vcc quad_perm:[1,0,3,2] row_mask:0xf bank_mask:0xf
ploopL_7_nx:
    s_bitcmp1_b32 s29, 1
    s_cbranch_scc1 gate_8_ok
    s_add_u32 s21, s16, 2
    s_min_u32 s21, s21, 63
    s_cmp_ge_u32 s21, 48
    s_cselect_b32 s19, 12, 8
    s_and_b32 s32, s21, 4
    s_lshr_b32 s21, s21, 3
    s_lshl_b32 s21, s21, 8
    s_add_u32 s32, s32, s21
    s_add_u32 s32, s32, s35
gate_8:
    buffer_load_dword v9, off, s[4:7], s32 sc1
    s_waitcnt vmcnt(0)
    v_readfirstlane_b32 s21, v9
    s_cmp_ge_u32 s21, s19
    s_cbranch_scc1 gate_8_set
    s_sleep 8
    s_sub_u32 s22, s22, 1
    s_cbranch_scc0 gate_8
    s_mov_b32 s22, 0
gate_8_set:
    s_bitset1_b32 s29, 1
gate_8_ok:
    v_readfirstlane_b32 s21, v60
    s_lshr_b32 s29, s29, 1
    s_cmp_ge_u32 s21, s58
    s_cselect_b32 s21, 2, 0
    s_or_b32 s29, s29, s21
    s_cmp_eq_u32 s3, 3
    s_cselect_b32 s20, s21, 0
    s_add_u32 s21, s16, 4
    s_min_u32 s21, s21, 63
    s_cmp_ge_u32 s21, 48
    s_cselect_b32 s58, 12, 8
    s_and_b32 s33, s21, 4
    s_lshr_b32 s21, s21, 3
    s_lshl_b32 s21, s21, 8
    s_add_u32 s33, s33, s21
    s_add_u32 s33, s33, s35
    s_setprio 3
ploopL_7_fs:
    ds_read_b128 v[32:35], v58 offset:0
    s_waitcnt lgkmcnt(0)
    v_min3_i32 v32, v32, v33, v34
    v_min_i32 v32, v32, v35
    s_nop 0
    v_readfirstlane_b32 s18, v32
    s_cmp_ge_i32 s18, s16
    s_cbranch_scc1 ploopL_7_fsok
    s_sleep 1
    s_branch ploopL_7_fs
ploopL_7_fsok:
    s_setprio 1
    s_cmp_eq_u32 s20, 0
    s_cbranch_scc1 ploopL_7_nt
    s_cmp_ge_u32 s16, 45
    s_cselect_b32 exec_hi, 0xffff, 0
    buffer_load_dword v60, v0, s[4:7], s31 offen sc1
    s_mov_b32 exec_hi, -1
ploopL_7_nt:
    s_cmp_eq_u32 s3, 3
    s_cbranch_scc1 ploopL_7_nx2
    buffer_store_dwordx2 v[42:43], v40, s[4:7], s55 offen sc1
ploopL_7_nx2:
    s_add_u32 s55, s55, 262144
    s_barrier
    buffer_load_dword v60, off, s[4:7], s33 sc1
    s_add_u32 s16, s16, 1
    v_mov_b32 v59, s16
    s_add_u32 s41, s41, 262144
    s_add_u32 s31, s31, 262144
    s_setprio 3
    s_sleep 13
ploopL_7_pagain:
    buffer_load_dwordx4 v[16:19], v1, s[4:7], s28 offen offset:0 sc1
    buffer_load_dwordx4 v[20:23], v1, s[4:7], s28 offen offset:1024 sc1
    s_waitcnt vmcnt(1)
    v_mfma_f32_16x16x32_bf16 v[32:35], v[12:15], v[16:19], 0
    s_waitcnt vmcnt(0)
    v_mfma_f32_16x16x32_bf16 v[32:35], v[48:51], v[20:23], v[32:35]
    v_max_u32 v9, v16, v20
    v_cmp_eq_u32 vcc, -1, v9
    s_cbranch_vccnz ploopL_7_rp
ploopL_7_pgo:
    s_cmp_lt_u32 s16, 48
    s_nop 3
    v_add_f32_dpp v36, v32, v32 row_ror:8 row_mask:0xf bank_mask:0xf
    v_add_f32_dpp v37, v33, v33 row_ror:8 row_mask:0xf bank_mask:0xf
    v_add_f32_dpp v38, v34, v34 row_ror:8 row_mask:0xf bank_mask:0xf
    v_add_f32_dpp v39, v35, v35 row_ror:8 row_mask:0xf bank_mask:0xf
    v_cvt_pk_bf16_f32 v52, v36, v37
    v_cvt_pk_bf16_f32 v53, v38, v39
    s_nop 0
    v_permlane16_swap_b32 v52, v54
    v_permlane16_swap_b32 v53, v55
    s_mov_b64 exec, s[56:57]
    v_min_u32 v52, -2, v52
    buffer_store_dwordx4 v[52:55], v5, s[4:7], s24 offen
    s_mov_b64 exec, -1
    ds_write_b32 v63, v59 offset:16
    s_cbranch_scc1 ploopL_7
    s_branch ploopH_6
ploopL_7_rm_0:
    s_sub_u32 s22, s22, 1
    s_cbranch_scc1 ploopL_7_rm_0_g
    buffer_load_dwordx4 v[16:19], v1, s[4:7], s23 offen offset:0 sc1
    buffer_load_dwordx4 v[20:23], v1, s[4:7], s23 offen offset:1024 sc1
    buffer_load_dwordx4 v[24:27], v1, s[4:7], s23 offen offset:2048 sc1
    buffer_load_dwordx4 v[28:31], v1, s[4:7], s23 offen offset:3072 sc1
    s_waitcnt vmcnt(3)
    v_cmp_eq_u32 vcc, -1, v16
    s_cbranch_vccnz ploopL_7_rm_0
    s_branch ploopL_7_rm_0ok
ploopL_7_rm_0_g:
    s_mov_b32 s22, 0
    s_waitcnt vmcnt(0)
    s_branch ploopL_7_rm_0ok
ploopL_7_rm_1:
    s_sub_u32 s22, s22, 1
    s_cbranch_scc1 ploopL_7_rm_1_g
    buffer_load_dwordx4 v[20:23], v1, s[4:7], s23 offen offset:1024 sc1
    buffer_load_dwordx4 v[24:27], v1, s[4:7], s23 offen offset:2048 sc1
    buffer_load_dwordx4 v[28:31], v1, s[4:7], s23 offen offset:3072 sc1
    s_waitcnt vmcnt(2)
    v_cmp_eq_u32 vcc, -1, v20
    s_cbranch_vccnz ploopL_7_rm_1
    s_branch ploopL_7_rm_1ok
ploopL_7_rm_1_g:
    s_mov_b32 s22, 0
    s_waitcnt vmcnt(0)
    s_branch ploopL_7_rm_1ok
ploopL_7_rm_2:
    s_sub_u32 s22, s22, 1
    s_cbranch_scc1 ploopL_7_rm_2_g
    buffer_load_dwordx4 v[24:27], v1, s[4:7], s23 offen offset:2048 sc1
    buffer_load_dwordx4 v[28:31], v1, s[4:7], s23 offen offset:3072 sc1
    s_waitcnt vmcnt(1)
    v_cmp_eq_u32 vcc, -1, v24
    s_cbranch_vccnz ploopL_7_rm_2
    s_branch ploopL_7_rm_2ok
ploopL_7_rm_2_g:
    s_mov_b32 s22, 0
    s_waitcnt vmcnt(0)
    s_branch ploopL_7_rm_2ok
ploopL_7_rm_3:
    s_sub_u32 s22, s22, 1
    s_cbranch_scc1 ploopL_7_rm_3_g
    buffer_load_dwordx4 v[28:31], v1, s[4:7], s23 offen offset:3072 sc1
    s_waitcnt vmcnt(0)
    v_cmp_eq_u32 vcc, -1, v28
    s_cbranch_vccnz ploopL_7_rm_3
    s_branch ploopL_7_rm_3ok
ploopL_7_rm_3_g:
    s_mov_b32 s22, 0
    s_waitcnt vmcnt(0)
    s_branch ploopL_7_rm_3ok
ploopL_7_rp:
    s_sub_u32 s22, s22, 1
    s_cbranch_scc0 ploopL_7_pagain
    s_mov_b32 s22, 0
    s_branch ploopL_7_pgo
.p2align 6
    s_nop 0
    s_nop 0
    s_nop 0
    s_nop 0
    s_nop 0
    s_nop 0
    s_nop 0
    s_nop 0
    s_nop 0
    s_nop 0
    s_nop 0
ploopH_6:
    v_mov_b32 v32, 0
    v_mov_b32 v33, 0
    v_mov_b32 v34, 0
    v_mov_b32 v35, 0
    v_mov_b32 v36, 0
    v_mov_b32 v37, 0
    v_mov_b32 v38, 0
    v_mov_b32 v39, 0
    v_mov_b32 v40, 0
    v_mov_b32 v41, 0
    v_mov_b32 v42, 0
    v_mov_b32 v43, 0
    v_mov_b32 v44, 0
    v_mov_b32 v45, 0
    v_mov_b32 v46, 0
    v_mov_b32 v47, 0
    v_mov_b32 v48, 0
    v_mov_b32 v49, 0
    v_mov_b32 v50, 0
    v_mov_b32 v51, 0
    v_mov_b32 v52, 0
    v_mov_b32 v53, 0
    v_mov_b32 v54, 0
    v_mov_b32 v55, 0
    s_sleep 1
    buffer_load_dwordx4 v[16:19], v1, s[4:7], s23 offen offset:0 sc1
    buffer_load_dwordx4 v[20:23], v1, s[4:7], s23 offen offset:1024 sc1
    buffer_load_dwordx4 v[24:27], v1, s[4:7], s23 offen offset:2048 sc1
    buffer_load_dwordx4 v[28:31], v1, s[4:7], s23 offen offset:3072 sc1
    s_waitcnt vmcnt(3)
    v_cmp_eq_u32 vcc, -1, v16
    s_cbranch_vccnz ploopH_6_rm_0
ploopH_6_rm_0ok:
    v_smfmac_f32_16x16x64_bf16 v[32:35], v[16:19], v[64:71], v8
    v_smfmac_f32_16x16x64_bf16 v[36:39], v[16:19], v[72:79], v8
    s_waitcnt vmcnt(2)
    v_cmp_eq_u32 vcc, -1, v20
    v_smfmac_f32_16x16x64_bf16 v[40:43], v[16:19], v[80:87], v8
    v_smfmac_f32_16x16x64_bf16 v[44:47], v[16:19], v[88:95], v8
    v_smfmac_f32_16x16x64_bf16 v[48:51], v[16:19], v[96:103], v8
    v_smfmac_f32_16x16x64_bf16 v[52:55], v[16:19], v[104:111], v8
    s_cbranch_vccnz ploopH_6_rm_1
ploopH_6_rm_1ok:
    v_smfmac_f32_16x16x64_bf16 v[32:35], v[20:23], v[112:119], v8
    v_smfmac_f32_16x16x64_bf16 v[36:39], v[20:23], v[120:127], v8
    s_waitcnt vmcnt(1)
    v_cmp_eq_u32 vcc, -1, v24
    v_smfmac_f32_16x16x64_bf16 v[40:43], v[20:23], v[128:135], v8
    v_smfmac_f32_16x16x64_bf16 v[44:47], v[20:23], v[136:143], v8
    v_smfmac_f32_16x16x64_bf16 v[48:51], v[20:23], v[144:151], v8
    v_smfmac_f32_16x16x64_bf16 v[52:55], v[20:23], v[152:159], v8
    s_cbranch_vccnz ploopH_6_rm_2
ploopH_6_rm_2ok:
    v_smfmac_f32_16x16x64_bf16 v[32:35], v[24:27], v[160:167], v8
    v_smfmac_f32_16x16x64_bf16 v[36:39], v[24:27], v[168:175], v8
    s_waitcnt vmcnt(0)
    v_cmp_eq_u32 vcc, -1, v28
    v_smfmac_f32_16x16x64_bf16 v[40:43], v[24:27], v[176:183], v8
    v_smfmac_f32_16x16x64_bf16 v[44:47], v[24:27], v[184:191], v8
    v_smfmac_f32_16x16x64_bf16 v[48:51], v[24:27], v[192:199], v8
    v_smfmac_f32_16x16x64_bf16 v[52:55], v[24:27], v[200:207], v8
    s_cbranch_vccnz ploopH_6_rm_3
ploopH_6_rm_3ok:
    v_smfmac_f32_16x16x64_bf16 v[32:35], v[28:31], v[208:215], v8
    ds_write_b32 v63, v59 offset:32
    v_smfmac_f32_16x16x64_bf16 v[36:39], v[28:31], v[216:223], v8
    v_smfmac_f32_16x16x64_bf16 v[40:43], v[28:31], v[224:231], v8
    v_smfmac_f32_16x16x64_bf16 v[44:47], v[28:31], v[232:239], v8
    v_smfmac_f32_16x16x64_bf16 v[48:51], v[28:31], v[240:247], v8
    v_smfmac_f32_16x16x64_bf16 v[52:55], v[28:31], v[248:255], v8
    s_cmp_eq_u32 s3, 3
    s_nop 1
    v_add_f32 v32, v32, v34
    v_add_f32 v33, v33, v35
    ds_write2_b32 v3, v32, v33 offset0:0 offset1:40
    v_add_f32 v36, v36, v38
    v_add_f32 v37, v37, v39
    ds_write2_b32 v3, v36, v37 offset0:16 offset1:56
    v_add_f32 v40, v40, v42
    v_add_f32 v41, v41, v43
    ds_write2_b32 v61, v40, v41 offset0:0 offset1:40
    v_add_f32 v44, v44, v46
    v_add_f32 v45, v45, v47
    ds_write2_b32 v61, v44, v45 offset0:16 offset1:56
    v_add_f32 v48, v48, v50
    v_add_f32 v49, v49, v51
    ds_write2_b32 v62, v48, v49 offset0:0 offset1:40
    v_add_f32 v52, v52, v54
    v_add_f32 v53, v53, v55
    ds_write2_b32 v62, v52, v53 offset0:16 offset1:56
    s_waitcnt lgkmcnt(0)
    s_barrier
    s_cbranch_scc1 ploopH_6_sk1
    ds_read_b128 v[32:35], v4 offset:0
    ds_read_b128 v[36:39], v4 offset:3840
    ds_read_b128 v[40:43], v4 offset:7680
    ds_read_b128 v[44:47], v4 offset:11520
    s_waitcnt lgkmcnt(2)
    v_add_f32 v32, v32, v36
    v_add_f32 v33, v33, v37
    v_add_f32 v34, v34, v38
    v_add_f32 v35, v35, v39
    s_waitcnt lgkmcnt(0)
    v_add_f32 v40, v40, v44
    v_add_f32 v41, v41, v45
    v_add_f32 v42, v42, v46
    v_add_f32 v43, v43, v47
    v_add_f32 v32, v32, v40
    v_add_f32 v33, v33, v41
    v_add_f32 v34, v34, v42
    v_add_f32 v35, v35, v43
    v_cvt_pk_bf16_f32 v56, v32, v33
    v_cvt_pk_bf16_f32 v57, v34, v35
    v_min_u32 v56, -2, v56
    buffer_store_dwordx2 v[56:57], v2, s[4:7], s26 offen
    s_add_u32 s27, s16, 2
    s_and_b32 s27, s27, 3
    s_lshl_b32 s27, s27, 18
    s_add_u32 s27, s27, s38
    buffer_store_dwordx2 v[10:11], v2, s[4:7], s27 offen
ploopH_6_sk1:
    s_setprio 0
    s_add_u32 s25, s16, 3
    s_and_b32 s25, s25, 3
    s_lshl_b32 s25, s25, 16
    s_add_u32 s25, s25, s37
    v_mov_b32 v44, -1
    v_mov_b32 v45, -1
    v_mov_b32 v46, -1
    v_mov_b32 v47, -1
    s_mov_b64 exec, s[56:57]
    buffer_store_dwordx4 v[44:47], v5, s[4:7], s25 offen
    s_mov_b64 exec, -1
    v_mov_b32_dpp v48, v12 row_ror:8 row_mask:0xf bank_mask:0xf
    v_mov_b32_dpp v49, v13 row_ror:8 row_mask:0xf bank_mask:0xf
    v_mov_b32_dpp v50, v14 row_ror:8 row_mask:0xf bank_mask:0xf
    v_mov_b32_dpp v51, v15 row_ror:8 row_mask:0xf bank_mask:0xf
    s_and_b32 s28, s16, 3
    s_lshl_b32 s28, s28, 18
    s_add_u32 s28, s28, s39
    s_add_u32 s24, s16, 1
    s_and_b32 s24, s24, 3
    s_lshl_b32 s24, s24, 16
    s_add_u32 s24, s24, s37
    s_add_u32 s23, s16, 1
    s_and_b32 s23, s23, 3
    s_lshl_b32 s23, s23, 16
    s_add_u32 s23, s23, s36
    s_add_u32 s26, s16, 1
    s_and_b32 s26, s26, 3
    s_lshl_b32 s26, s26, 18
    s_add_u32 s26, s26, s38
    s_cmp_eq_u32 s16, 63
    s_cbranch_scc1 ploopH_6_tail
    s_cmp_eq_u32 s30, s54
    s_cbranch_scc1 pnoseg_9
    ds_read_b128 v[16:19], v6 offset:0
    ds_read_b128 v[20:23], v6 offset:256
    ds_read_b128 v[24:27], v6 offset:512
    ds_read_b128 v[28:31], v6 offset:768
    v_xor_b32 v6, 0x4000, v6
    s_waitcnt lgkmcnt(2)
    v_mfma_f32_16x16x32_bf16 v[40:43], v[12:15], v[16:19], 0
    v_mfma_f32_16x16x32_bf16 v[40:43], v[48:51], v[20:23], v[40:43]
    s_waitcnt lgkmcnt(0)
    v_mfma_f32_16x16x32_bf16 v[44:47], v[12:15], v[24:27], 0
    v_mfma_f32_16x16x32_bf16 v[44:47], v[48:51], v[28:31], v[44:47]
    s_nop 7
    v_cvt_pk_bf16_f32 v40, v40, v41
    v_cvt_pk_bf16_f32 v41, v42, v43
    v_cvt_pk_bf16_f32 v42, v44, v45
    v_cvt_pk_bf16_f32 v43, v46, v47
    s_nop 1
    v_permlane16_swap_b32 v40, v42
    v_permlane16_swap_b32 v41, v43
    s_nop 1
    v_min_u32 v40, -2, v40
pnoseg_9:
    s_bitcmp1_b32 s29, 0
    s_cbranch_scc1 gate_10_ok
    s_add_u32 s21, s16, 1
    s_min_u32 s21, s21, 63
    s_cmp_ge_u32 s21, 48
    s_cselect_b32 s19, 12, 8
    s_and_b32 s32, s21, 4
    s_lshr_b32 s21, s21, 3
    s_lshl_b32 s21, s21, 8
    s_add_u32 s32, s32, s21
    s_add_u32 s32, s32, s35
gate_10:
    buffer_load_dword v9, off, s[4:7], s32 sc1
    s_waitcnt vmcnt(0)
    v_readfirstlane_b32 s21, v9
    s_cmp_ge_u32 s21, s19
    s_cbranch_scc1 gate_10_set
    s_sleep 8
    s_sub_u32 s22, s22, 1
    s_cbranch_scc0 gate_10
    s_mov_b32 s22, 0
gate_10_set:
    s_bitset1_b32 s29, 0
gate_10_ok:
    v_readfirstlane_b32 s21, v60
    s_lshr_b32 s29, s29, 1
    s_cmp_ge_u32 s21, s58
    s_cselect_b32 s21, 2, 0
    s_or_b32 s29, s29, s21
    s_cmp_eq_u32 s3, 3
    s_cselect_b32 s20, s21, 0
    s_add_u32 s21, s16, 4
    s_min_u32 s21, s21, 63
    s_cmp_ge_u32 s21, 48
    s_cselect_b32 s58, 12, 8
    s_and_b32 s33, s21, 4
    s_lshr_b32 s21, s21, 3
    s_lshl_b32 s21, s21, 8
    s_add_u32 s33, s33, s21
    s_add_u32 s33, s33, s35
    s_setprio 3
ploopH_6_fs:
    ds_read_b128 v[32:35], v58 offset:0
    s_waitcnt lgkmcnt(0)
    v_min3_i32 v32, v32, v33, v34
    v_min_i32 v32, v32, v35
    s_nop 0
    v_readfirstlane_b32 s18, v32
    s_cmp_ge_i32 s18, s16
    s_cbranch_scc1 ploopH_6_fsok
    s_sleep 1
    s_branch ploopH_6_fs
ploopH_6_fsok:
    s_setprio 1
    s_add_u32 m0, s42, 0
    s_add_u32 s17, s41, 20971520
    buffer_load_dwordx4 v1, s[4:7], s17 offen offset:0 sc1 lds
    buffer_load_dwordx4 v1, s[4:7], s17 offen offset:1024 sc1 lds
    buffer_load_dwordx4 v1, s[4:7], s17 offen offset:2048 sc1 lds
    buffer_load_dwordx4 v1, s[4:7], s17 offen offset:3072 sc1 lds
    s_add_u32 m0, s42, 4096
    s_add_u32 s17, s41, 21102592
    buffer_load_dwordx4 v1, s[4:7], s17 offen offset:0 sc1 lds
    buffer_load_dwordx4 v1, s[4:7], s17 offen offset:1024 sc1 lds
    buffer_load_dwordx4 v1, s[4:7], s17 offen offset:2048 sc1 lds
    buffer_load_dwordx4 v1, s[4:7], s17 offen offset:3072 sc1 lds
    s_cmp_eq_u32 s20, 0
    s_cbranch_scc1 ploopH_6_nt
    s_mov_b32 exec_hi, 0xffff
    buffer_load_dword v60, v0, s[4:7], s31 offen sc1
    s_mov_b32 exec_hi, -1
ploopH_6_nt:
    s_cmp_eq_u32 s30, s54
    s_cbranch_scc1 pnoseg_11
    buffer_store_dwordx4 v[40:43], v7, s[4:7], s30 offen sc1
    s_add_u32 s30, s30, 65536
pnoseg_11:
    s_barrier
    buffer_load_dword v60, off, s[4:7], s33 sc1
    s_sleep 6
    s_add_u32 m0, s42, 8192
    s_add_u32 s17, s41, 37748736
    buffer_load_dwordx4 v1, s[4:7], s17 offen offset:0 sc1 lds
    buffer_load_dwordx4 v1, s[4:7], s17 offen offset:1024 sc1 lds
    buffer_load_dwordx4 v1, s[4:7], s17 offen offset:2048 sc1 lds
    buffer_load_dwordx4 v1, s[4:7], s17 offen offset:3072 sc1 lds
    s_add_u32 m0, s42, 12288
    s_add_u32 s17, s41, 37879808
    buffer_load_dwordx4 v1, s[4:7], s17 offen offset:0 sc1 lds
    buffer_load_dwordx4 v1, s[4:7], s17 offen offset:1024 sc1 lds
    buffer_load_dwordx4 v1, s[4:7], s17 offen offset:2048 sc1 lds
    buffer_load_dwordx4 v1, s[4:7], s17 offen offset:3072 sc1 lds
    s_add_u32 s16, s16, 1
    v_mov_b32 v59, s16
    s_add_u32 s41, s41, 262144
    s_add_u32 s31, s31, 262144
    s_mov_b32 s54, 0
    s_setprio 3
    s_sleep 1
ploopH_6_pagain:
    buffer_load_dwordx4 v[16:19], v1, s[4:7], s28 offen offset:0 sc1
    buffer_load_dwordx4 v[20:23], v1, s[4:7], s28 offen offset:1024 sc1
    s_waitcnt vmcnt(1)
    v_mfma_f32_16x16x32_bf16 v[32:35], v[12:15], v[16:19], 0
    s_waitcnt vmcnt(0)
    v_mfma_f32_16x16x32_bf16 v[32:35], v[48:51], v[20:23], v[32:35]
    v_max_u32 v9, v16, v20
    v_cmp_eq_u32 vcc, -1, v9
    s_cbranch_vccnz ploopH_6_rp
ploopH_6_pgo:
    s_nop 4
    v_add_f32_dpp v36, v32, v32 row_ror:8 row_mask:0xf bank_mask:0xf
    v_add_f32_dpp v37, v33, v33 row_ror:8 row_mask:0xf bank_mask:0xf
    v_add_f32_dpp v38, v34, v34 row_ror:8 row_mask:0xf bank_mask:0xf
    v_add_f32_dpp v39, v35, v35 row_ror:8 row_mask:0xf bank_mask:0xf
    v_cvt_pk_bf16_f32 v52, v36, v37
    v_cvt_pk_bf16_f32 v53, v38, v39
    s_nop 0
    v_permlane16_swap_b32 v52, v54
    v_permlane16_swap_b32 v53, v55
    s_mov_b64 exec, s[56:57]
    v_min_u32 v52, -2, v52
    buffer_store_dwordx4 v[52:55], v5, s[4:7], s24 offen
    s_mov_b64 exec, -1
    ds_write_b32 v63, v59 offset:16
    s_branch ploopH_6
ploopH_6_rm_0:
    s_sub_u32 s22, s22, 1
    s_cbranch_scc1 ploopH_6_rm_0_g
    buffer_load_dwordx4 v[16:19], v1, s[4:7], s23 offen offset:0 sc1
    buffer_load_dwordx4 v[20:23], v1, s[4:7], s23 offen offset:1024 sc1
    buffer_load_dwordx4 v[24:27], v1, s[4:7], s23 offen offset:2048 sc1
    buffer_load_dwordx4 v[28:31], v1, s[4:7], s23 offen offset:3072 sc1
    s_waitcnt vmcnt(3)
    v_cmp_eq_u32 vcc, -1, v16
    s_cbranch_vccnz ploopH_6_rm_0
    s_branch ploopH_6_rm_0ok
ploopH_6_rm_0_g:
    s_mov_b32 s22, 0
    s_waitcnt vmcnt(0)
    s_branch ploopH_6_rm_0ok
ploopH_6_rm_1:
    s_sub_u32 s22, s22, 1
    s_cbranch_scc1 ploopH_6_rm_1_g
    buffer_load_dwordx4 v[20:23], v1, s[4:7], s23 offen offset:1024 sc1
    buffer_load_dwordx4 v[24:27], v1, s[4:7], s23 offen offset:2048 sc1
    buffer_load_dwordx4 v[28:31], v1, s[4:7], s23 offen offset:3072 sc1
    s_waitcnt vmcnt(2)
    v_cmp_eq_u32 vcc, -1, v20
    s_cbranch_vccnz ploopH_6_rm_1
    s_branch ploopH_6_rm_1ok
ploopH_6_rm_1_g:
    s_mov_b32 s22, 0
    s_waitcnt vmcnt(0)
    s_branch ploopH_6_rm_1ok
ploopH_6_rm_2:
    s_sub_u32 s22, s22, 1
    s_cbranch_scc1 ploopH_6_rm_2_g
    buffer_load_dwordx4 v[24:27], v1, s[4:7], s23 offen offset:2048 sc1
    buffer_load_dwordx4 v[28:31], v1, s[4:7], s23 offen offset:3072 sc1
    s_waitcnt vmcnt(1)
    v_cmp_eq_u32 vcc, -1, v24
    s_cbranch_vccnz ploopH_6_rm_2
    s_branch ploopH_6_rm_2ok
ploopH_6_rm_2_g:
    s_mov_b32 s22, 0
    s_waitcnt vmcnt(0)
    s_branch ploopH_6_rm_2ok
ploopH_6_rm_3:
    s_sub_u32 s22, s22, 1
    s_cbranch_scc1 ploopH_6_rm_3_g
    buffer_load_dwordx4 v[28:31], v1, s[4:7], s23 offen offset:3072 sc1
    s_waitcnt vmcnt(0)
    v_cmp_eq_u32 vcc, -1, v28
    s_cbranch_vccnz ploopH_6_rm_3
    s_branch ploopH_6_rm_3ok
ploopH_6_rm_3_g:
    s_mov_b32 s22, 0
    s_waitcnt vmcnt(0)
    s_branch ploopH_6_rm_3ok
ploopH_6_rp:
    s_sub_u32 s22, s22, 1
    s_cbranch_scc0 ploopH_6_pagain
    s_mov_b32 s22, 0
    s_branch ploopH_6_pgo
ploopH_6_tail:
    ds_read_b128 v[16:19], v6 offset:0
    ds_read_b128 v[20:23], v6 offset:256
    ds_read_b128 v[24:27], v6 offset:512
    ds_read_b128 v[28:31], v6 offset:768
    v_xor_b32 v6, 0x4000, v6
    s_waitcnt lgkmcnt(2)
    v_mfma_f32_16x16x32_bf16 v[40:43], v[12:15], v[16:19], 0
    v_mfma_f32_16x16x32_bf16 v[40:43], v[48:51], v[20:23], v[40:43]
    s_waitcnt lgkmcnt(0)
    v_mfma_f32_16x16x32_bf16 v[44:47], v[12:15], v[24:27], 0
    v_mfma_f32_16x16x32_bf16 v[44:47], v[48:51], v[28:31], v[44:47]
    s_nop 7
    v_cvt_pk_bf16_f32 v40, v40, v41
    v_cvt_pk_bf16_f32 v41, v42, v43
    v_cvt_pk_bf16_f32 v42, v44, v45
    v_cvt_pk_bf16_f32 v43, v46, v47
    s_nop 1
    v_permlane16_swap_b32 v40, v42
    v_permlane16_swap_b32 v41, v43
    s_nop 1
    v_min_u32 v40, -2, v40
    buffer_store_dwordx4 v[40:43], v7, s[4:7], s30 offen sc1
    s_add_u32 s30, s30, 65536
    s_barrier
    ds_read_b128 v[16:19], v6 offset:0
    ds_read_b128 v[20:23], v6 offset:256
    ds_read_b128 v[24:27], v6 offset:512
    ds_read_b128 v[28:31], v6 offset:768
    v_xor_b32 v6, 0x4000, v6
    s_waitcnt lgkmcnt(2)
    v_mfma_f32_16x16x32_bf16 v[40:43], v[12:15], v[16:19], 0
    v_mfma_f32_16x16x32_bf16 v[40:43], v[48:51], v[20:23], v[40:43]
    s_waitcnt lgkmcnt(0)
    v_mfma_f32_16x16x32_bf16 v[44:47], v[12:15], v[24:27], 0
    v_mfma_f32_16x16x32_bf16 v[44:47], v[48:51], v[28:31], v[44:47]
    s_nop 7
    v_cvt_pk_bf16_f32 v40, v40, v41
    v_cvt_pk_bf16_f32 v41, v42, v43
    v_cvt_pk_bf16_f32 v42, v44, v45
    v_cvt_pk_bf16_f32 v43, v46, v47
    s_nop 1
    v_permlane16_swap_b32 v40, v42
    v_permlane16_swap_b32 v41, v43
    s_nop 1
    v_min_u32 v40, -2, v40
    buffer_store_dwordx4 v[40:43], v7, s[4:7], s30 offen sc1
    s_add_u32 s30, s30, 65536
    s_branch k_end
ch_p_slow:
    v_mov_b32 v32, 0
    v_mov_b32 v33, 0
    v_mov_b32 v34, 0
    v_mov_b32 v35, 0
    v_mov_b32 v36, 0
    v_mov_b32 v37, 0
    v_mov_b32 v38, 0
    v_mov_b32 v39, 0
    v_mov_b32 v40, 0
    v_mov_b32 v41, 0
    v_mov_b32 v42, 0
    v_mov_b32 v43, 0
    v_mov_b32 v44, 0
    v_mov_b32 v45, 0
    v_mov_b32 v46, 0
    v_mov_b32 v47, 0
    v_mov_b32 v48, 0
    v_mov_b32 v49, 0
    v_mov_b32 v50, 0
    v_mov_b32 v51, 0
    v_mov_b32 v52, 0
    v_mov_b32 v53, 0
    v_mov_b32 v54, 0
    v_mov_b32 v55, 0
    v_mov_b32 v59, 0
    s_nop 1
    s_branch ploopL_13_nc
.p2align 6
    s_nop 0
    s_nop 0
    s_nop 0
    s_nop 0
    s_nop 0
    s_nop 0
    s_nop 0
    s_nop 0
    s_nop 0
    s_nop 0
    s_nop 0
ploopL_13:
    v_mov_b32 v32, 0
    v_mov_b32 v33, 0
    v_mov_b32 v34, 0
    v_mov_b32 v35, 0
    v_mov_b32 v36, 0
    v_mov_b32 v37, 0
    v_mov_b32 v38, 0
    v_mov_b32 v39, 0
    v_mov_b32 v40, 0
    v_mov_b32 v41, 0
    v_mov_b32 v42, 0
    v_mov_b32 v43, 0
    v_mov_b32 v44, 0
    v_mov_b32 v45, 0
    v_mov_b32 v46, 0
    v_mov_b32 v47, 0
    v_mov_b32 v48, 0
    v_mov_b32 v49, 0
    v_mov_b32 v50, 0
    v_mov_b32 v51, 0
    v_mov_b32 v52, 0
    v_mov_b32 v53, 0
    v_mov_b32 v54, 0
    v_mov_b32 v55, 0
    s_sleep 1
    buffer_load_dwordx4 v[16:19], v1, s[4:7], s23 offen offset:0 sc1
    buffer_load_dwordx4 v[20:23], v1, s[4:7], s23 offen offset:1024 sc1
    buffer_load_dwordx4 v[24:27], v1, s[4:7], s23 offen offset:2048 sc1
    buffer_load_dwordx4 v[28:31], v1, s[4:7], s23 offen offset:3072 sc1
    s_waitcnt vmcnt(3)
    v_cmp_eq_u32 vcc, -1, v16
    s_cbranch_vccnz ploopL_13_rm_0
ploopL_13_rm_0ok:
    v_smfmac_f32_16x16x64_bf16 v[32:35], v[16:19], v[64:71], v8
    v_smfmac_f32_16x16x64_bf16 v[36:39], v[16:19], v[72:79], v8
    s_waitcnt vmcnt(2)
    v_cmp_eq_u32 vcc, -1, v20
    v_smfmac_f32_16x16x64_bf16 v[40:43], v[16:19], v[80:87], v8
    v_smfmac_f32_16x16x64_bf16 v[44:47], v[16:19], v[88:95], v8
    v_smfmac_f32_16x16x64_bf16 v[48:51], v[16:19], v[96:103], v8
    v_smfmac_f32_16x16x64_bf16 v[52:55], v[16:19], v[104:111], v8
    s_cbranch_vccnz ploopL_13_rm_1
ploopL_13_rm_1ok:
    v_smfmac_f32_16x16x64_bf16 v[32:35], v[20:23], v[112:119], v8
    v_smfmac_f32_16x16x64_bf16 v[36:39], v[20:23], v[120:127], v8
    s_waitcnt vmcnt(1)
    v_cmp_eq_u32 vcc, -1, v24
    v_smfmac_f32_16x16x64_bf16 v[40:43], v[20:23], v[128:135], v8
    v_smfmac_f32_16x16x64_bf16 v[44:47], v[20:23], v[136:143], v8
    v_smfmac_f32_16x16x64_bf16 v[48:51], v[20:23], v[144:151], v8
    v_smfmac_f32_16x16x64_bf16 v[52:55], v[20:23], v[152:159], v8
    s_cbranch_vccnz ploopL_13_rm_2
ploopL_13_rm_2ok:
    v_smfmac_f32_16x16x64_bf16 v[32:35], v[24:27], v[160:167], v8
    v_smfmac_f32_16x16x64_bf16 v[36:39], v[24:27], v[168:175], v8
    s_waitcnt vmcnt(0)
    v_cmp_eq_u32 vcc, -1, v28
    v_smfmac_f32_16x16x64_bf16 v[40:43], v[24:27], v[176:183], v8
    v_smfmac_f32_16x16x64_bf16 v[44:47], v[24:27], v[184:191], v8
    v_smfmac_f32_16x16x64_bf16 v[48:51], v[24:27], v[192:199], v8
    v_smfmac_f32_16x16x64_bf16 v[52:55], v[24:27], v[200:207], v8
    s_cbranch_vccnz ploopL_13_rm_3
ploopL_13_rm_3ok:
    v_smfmac_f32_16x16x64_bf16 v[32:35], v[28:31], v[208:215], v8
    ds_write_b32 v63, v59 offset:32
    v_smfmac_f32_16x16x64_bf16 v[36:39], v[28:31], v[216:223], v8
    v_smfmac_f32_16x16x64_bf16 v[40:43], v[28:31], v[224:231], v8
    v_smfmac_f32_16x16x64_bf16 v[44:47], v[28:31], v[232:239], v8
    v_smfmac_f32_16x16x64_bf16 v[48:51], v[28:31], v[240:247], v8
    v_smfmac_f32_16x16x64_bf16 v[52:55], v[28:31], v[248:255], v8
    s_branch ploopL_13_mmd
ploopL_13_nc:
    v_smfmac_f32_16x16x64_bf16 v[32:35], v[16:19], v[64:71], v8
    v_smfmac_f32_16x16x64_bf16 v[36:39], v[16:19], v[72:79], v8
    v_smfmac_f32_16x16x64_bf16 v[40:43], v[16:19], v[80:87], v8
    v_smfmac_f32_16x16x64_bf16 v[44:47], v[16:19], v[88:95], v8
    v_smfmac_f32_16x16x64_bf16 v[48:51], v[16:19], v[96:103], v8
    v_smfmac_f32_16x16x64_bf16 v[52:55], v[16:19], v[104:111], v8
    v_smfmac_f32_16x16x64_bf16 v[32:35], v[20:23], v[112:119], v8
    v_smfmac_f32_16x16x64_bf16 v[36:39], v[20:23], v[120:127], v8
    v_smfmac_f32_16x16x64_bf16 v[40:43], v[20:23], v[128:135], v8
    v_smfmac_f32_16x16x64_bf16 v[44:47], v[20:23], v[136:143], v8
    v_smfmac_f32_16x16x64_bf16 v[48:51], v[20:23], v[144:151], v8
    v_smfmac_f32_16x16x64_bf16 v[52:55], v[20:23], v[152:159], v8
    v_smfmac_f32_16x16x64_bf16 v[32:35], v[24:27], v[160:167], v8
    v_smfmac_f32_16x16x64_bf16 v[36:39], v[24:27], v[168:175], v8
    v_smfmac_f32_16x16x64_bf16 v[40:43], v[24:27], v[176:183], v8
    v_smfmac_f32_16x16x64_bf16 v[44:47], v[24:27], v[184:191], v8
    v_smfmac_f32_16x16x64_bf16 v[48:51], v[24:27], v[192:199], v8
    v_smfmac_f32_16x16x64_bf16 v[52:55], v[24:27], v[200:207], v8
    v_smfmac_f32_16x16x64_bf16 v[32:35], v[28:31], v[208:215], v8
    ds_write_b32 v63, v59 offset:32
    v_smfmac_f32_16x16x64_bf16 v[36:39], v[28:31], v[216:223], v8
    v_smfmac_f32_16x16x64_bf16 v[40:43], v[28:31], v[224:231], v8
    v_smfmac_f32_16x16x64_bf16 v[44:47], v[28:31], v[232:239], v8
    v_smfmac_f32_16x16x64_bf16 v[48:51], v[28:31], v[240:247], v8
    v_smfmac_f32_16x16x64_bf16 v[52:55], v[28:31], v[248:255], v8
ploopL_13_mmd:
    s_cmp_eq_u32 s3, 3
    s_nop 1
    v_add_f32 v32, v32, v34
    v_add_f32 v33, v33, v35
    ds_write2_b32 v3, v32, v33 offset0:0 offset1:40
    v_add_f32 v36, v36, v38
    v_add_f32 v37, v37, v39
    ds_write2_b32 v3, v36, v37 offset0:16 offset1:56
    v_add_f32 v40, v40, v42
    v_add_f32 v41, v41, v43
    ds_write2_b32 v61, v40, v41 offset0:0 offset1:40
    v_add_f32 v44, v44, v46
    v_add_f32 v45, v45, v47
    ds_write2_b32 v61, v44, v45 offset0:16 offset1:56
    v_add_f32 v48, v48, v50
    v_add_f32 v49, v49, v51
    ds_write2_b32 v62, v48, v49 offset0:0 offset1:40
    v_add_f32 v52, v52, v54
    v_add_f32 v53, v53, v55
    ds_write2_b32 v62, v52, v53 offset0:16 offset1:56
    s_waitcnt lgkmcnt(0)
    s_barrier
    s_cbranch_scc1 ploopL_13_sk1
    ds_read_b128 v[32:35], v4 offset:0
    ds_read_b128 v[36:39], v4 offset:3840
    ds_read_b128 v[40:43], v4 offset:7680
    ds_read_b128 v[44:47], v4 offset:11520
    s_waitcnt lgkmcnt(2)
    v_add_f32 v32, v32, v36
    v_add_f32 v33, v33, v37
    v_add_f32 v34, v34, v38
    v_add_f32 v35, v35, v39
    s_waitcnt lgkmcnt(0)
    v_add_f32 v40, v40, v44
    v_add_f32 v41, v41, v45
    v_add_f32 v42, v42, v46
    v_add_f32 v43, v43, v47
    v_add_f32 v32, v32, v40
    v_add_f32 v33, v33, v41
    v_add_f32 v34, v34, v42
    v_add_f32 v35, v35, v43
    v_cvt_pk_bf16_f32 v56, v32, v33
    v_cvt_pk_bf16_f32 v57, v34, v35
    v_min_u32 v56, -2, v56
    buffer_store_dwordx2 v[56:57], v2, s[4:7], s26 offen sc1
    s_add_u32 s27, s16, 2
    s_and_b32 s27, s27, 3
    s_lshl_b32 s27, s27, 18
    s_add_u32 s27, s27, s38
    buffer_store_dwordx2 v[10:11], v2, s[4:7], s27 offen sc1
ploopL_13_sk1:
    s_setprio 0
    s_add_u32 s25, s16, 3
    s_and_b32 s25, s25, 3
    s_lshl_b32 s25, s25, 16
    s_add_u32 s25, s25, s37
    v_mov_b32 v44, -1
    v_mov_b32 v45, -1
    v_mov_b32 v46, -1
    v_mov_b32 v47, -1
    s_mov_b64 exec, s[56:57]
    buffer_store_dwordx4 v[44:47], v5, s[4:7], s25 offen sc1
    s_mov_b64 exec, -1
    v_mov_b32_dpp v48, v12 row_ror:8 row_mask:0xf bank_mask:0xf
    v_mov_b32_dpp v49, v13 row_ror:8 row_mask:0xf bank_mask:0xf
    v_mov_b32_dpp v50, v14 row_ror:8 row_mask:0xf bank_mask:0xf
    v_mov_b32_dpp v51, v15 row_ror:8 row_mask:0xf bank_mask:0xf
    s_and_b32 s28, s16, 3
    s_lshl_b32 s28, s28, 18
    s_add_u32 s28, s28, s39
    s_add_u32 s24, s16, 1
    s_and_b32 s24, s24, 3
    s_lshl_b32 s24, s24, 16
    s_add_u32 s24, s24, s37
    s_add_u32 s23, s16, 1
    s_and_b32 s23, s23, 3
    s_lshl_b32 s23, s23, 16
    s_add_u32 s23, s23, s36
    s_add_u32 s26, s16, 1
    s_and_b32 s26, s26, 3
    s_lshl_b32 s26, s26, 18
    s_add_u32 s26, s26, s38
    v_mov_b32 v40, v2
    v_mov_b32 v42, v56
    v_mov_b32 v43, v57
    s_cmp_lg_u32 s3, 2
    s_cbranch_scc1 ploopL_13_nx
    v_and_b32 v40, 0x60, v1
    v_lshlrev_b32 v40, 2, v40
    v_lshrrev_b32 v41, 3, v1
    v_and_b32 v41, 0x70, v41
    v_or_b32 v40, v40, v41
    v_bfe_u32 v41, v1, 4, 1
    v_lshl_or_b32 v40, v41, 3, v40
    s_lshl_b32 s17, s53, 9
    s_add_u32 s17, s17, 4096
    v_add_u32 v40, s17, v40
    s_mov_b32 vcc_lo, 0x55555555
    s_mov_b32 vcc_hi, 0x55555555
    v_cndmask_b32_dpp v42, v57, v56, vcc quad_perm:[1,0,3,2] row_mask:0xf bank_mask:0xf
    s_not_b64 vcc, vcc
    v_cndmask_b32_dpp v43, v56, v57, vcc quad_perm:[1,0,3,2] row_mask:0xf bank_mask:0xf
ploopL_13_nx:
    s_bitcmp1_b32 s29, 1
    s_cbranch_scc1 gate_14_ok
    s_add_u32 s21, s16, 2
    s_min_u32 s21, s21, 63
    s_cmp_ge_u32 s21, 48
    s_cselect_b32 s19, 12, 8
    s_and_b32 s32, s21, 4
    s_lshr_b32 s21, s21, 3
    s_lshl_b32 s21, s21, 8
    s_add_u32 s32, s32, s21
    s_add_u32 s32, s32, s35
gate_14:
    buffer_load_dword v9, off, s[4:7], s32 sc1
    s_waitcnt vmcnt(0)
    v_readfirstlane_b32 s21, v9
    s_cmp_ge_u32 s21, s19
    s_cbranch_scc1 gate_14_set
    s_sleep 8
    s_sub_u32 s22, s22, 1
    s_cbranch_scc0 gate_14
    s_mov_b32 s22, 0
gate_14_set:
    s_bitset1_b32 s29, 1
gate_14_ok:
    v_readfirstlane_b32 s21, v60
    s_lshr_b32 s29, s29, 1
    s_cmp_ge_u32 s21, s58
    s_cselect_b32 s21, 2, 0
    s_or_b32 s29, s29, s21
    s_cmp_eq_u32 s3, 3
    s_cselect_b32 s20, s21, 0
    s_add_u32 s21, s16, 4
    s_min_u32 s21, s21, 63
    s_cmp_ge_u32 s21, 48
    s_cselect_b32 s58, 12, 8
    s_and_b32 s33, s21, 4
    s_lshr_b32 s21, s21, 3
    s_lshl_b32 s21, s21, 8
    s_add_u32 s33, s33, s21
    s_add_u32 s33, s33, s35
    s_setprio 3
ploopL_13_fs:
    ds_read_b128 v[32:35], v58 offset:0
    s_waitcnt lgkmcnt(0)
    v_min3_i32 v32, v32, v33, v34
    v_min_i32 v32, v32, v35
    s_nop 0
    v_readfirstlane_b32 s18, v32
    s_cmp_ge_i32 s18, s16
    s_cbranch_scc1 ploopL_13_fsok
    s_sleep 1
    s_branch ploopL_13_fs
ploopL_13_fsok:
    s_setprio 1
    s_cmp_eq_u32 s20, 0
    s_cbranch_scc1 ploopL_13_nt
    s_cmp_ge_u32 s16, 45
    s_cselect_b32 exec_hi, 0xffff, 0
    buffer_load_dword v60, v0, s[4:7], s31 offen sc1
    s_mov_b32 exec_hi, -1
ploopL_13_nt:
    s_cmp_eq_u32 s3, 3
    s_cbranch_scc1 ploopL_13_nx2
    buffer_store_dwordx2 v[42:43], v40, s[4:7], s55 offen sc1
ploopL_13_nx2:
    s_add_u32 s55, s55, 262144
    s_barrier
    buffer_load_dword v60, off, s[4:7], s33 sc1
    s_add_u32 s16, s16, 1
    v_mov_b32 v59, s16
    s_add_u32 s41, s41, 262144
    s_add_u32 s31, s31, 262144
    s_setprio 3
    s_sleep 13
ploopL_13_pagain:
    buffer_load_dwordx4 v[16:19], v1, s[4:7], s28 offen offset:0 sc1
    buffer_load_dwordx4 v[20:23], v1, s[4:7], s28 offen offset:1024 sc1
    s_waitcnt vmcnt(1)
    v_mfma_f32_16x16x32_bf16 v[32:35], v[12:15], v[16:19], 0
    s_waitcnt vmcnt(0)
    v_mfma_f32_16x16x32_bf16 v[32:35], v[48:51], v[20:23], v[32:35]
    v_max_u32 v9, v16, v20
    v_cmp_eq_u32 vcc, -1, v9
    s_cbranch_vccnz ploopL_13_rp
ploopL_13_pgo:
    s_cmp_lt_u32 s16, 48
    s_nop 3
    v_add_f32_dpp v36, v32, v32 row_ror:8 row_mask:0xf bank_mask:0xf
    v_add_f32_dpp v37, v33, v33 row_ror:8 row_mask:0xf bank_mask:0xf
    v_add_f32_dpp v38, v34, v34 row_ror:8 row_mask:0xf bank_mask:0xf
    v_add_f32_dpp v39, v35, v35 row_ror:8 row_mask:0xf bank_mask:0xf
    v_cvt_pk_bf16_f32 v52, v36, v37
    v_cvt_pk_bf16_f32 v53, v38, v39
    s_nop 0
    v_permlane16_swap_b32 v52, v54
    v_permlane16_swap_b32 v53, v55
    s_mov_b64 exec, s[56:57]
    v_min_u32 v52, -2, v52
    buffer_store_dwordx4 v[52:55], v5, s[4:7], s24 offen sc1
    s_mov_b64 exec, -1
    ds_write_b32 v63, v59 offset:16
    s_cbranch_scc1 ploopL_13
    s_branch ploopH_12
ploopL_13_rm_0:
    s_sub_u32 s22, s22, 1
    s_cbranch_scc1 ploopL_13_rm_0_g
    buffer_load_dwordx4 v[16:19], v1, s[4:7], s23 offen offset:0 sc1
    buffer_load_dwordx4 v[20:23], v1, s[4:7], s23 offen offset:1024 sc1
    buffer_load_dwordx4 v[24:27], v1, s[4:7], s23 offen offset:2048 sc1
    buffer_load_dwordx4 v[28:31], v1, s[4:7], s23 offen offset:3072 sc1
    s_waitcnt vmcnt(3)
    v_cmp_eq_u32 vcc, -1, v16
    s_cbranch_vccnz ploopL_13_rm_0
    s_branch ploopL_13_rm_0ok
ploopL_13_rm_0_g:
    s_mov_b32 s22, 0
    s_waitcnt vmcnt(0)
    s_branch ploopL_13_rm_0ok
ploopL_13_rm_1:
    s_sub_u32 s22, s22, 1
    s_cbranch_scc1 ploopL_13_rm_1_g
    buffer_load_dwordx4 v[20:23], v1, s[4:7], s23 offen offset:1024 sc1
    buffer_load_dwordx4 v[24:27], v1, s[4:7], s23 offen offset:2048 sc1
    buffer_load_dwordx4 v[28:31], v1, s[4:7], s23 offen offset:3072 sc1
    s_waitcnt vmcnt(2)
    v_cmp_eq_u32 vcc, -1, v20
    s_cbranch_vccnz ploopL_13_rm_1
    s_branch ploopL_13_rm_1ok
ploopL_13_rm_1_g:
    s_mov_b32 s22, 0
    s_waitcnt vmcnt(0)
    s_branch ploopL_13_rm_1ok
ploopL_13_rm_2:
    s_sub_u32 s22, s22, 1
    s_cbranch_scc1 ploopL_13_rm_2_g
    buffer_load_dwordx4 v[24:27], v1, s[4:7], s23 offen offset:2048 sc1
    buffer_load_dwordx4 v[28:31], v1, s[4:7], s23 offen offset:3072 sc1
    s_waitcnt vmcnt(1)
    v_cmp_eq_u32 vcc, -1, v24
    s_cbranch_vccnz ploopL_13_rm_2
    s_branch ploopL_13_rm_2ok
ploopL_13_rm_2_g:
    s_mov_b32 s22, 0
    s_waitcnt vmcnt(0)
    s_branch ploopL_13_rm_2ok
ploopL_13_rm_3:
    s_sub_u32 s22, s22, 1
    s_cbranch_scc1 ploopL_13_rm_3_g
    buffer_load_dwordx4 v[28:31], v1, s[4:7], s23 offen offset:3072 sc1
    s_waitcnt vmcnt(0)
    v_cmp_eq_u32 vcc, -1, v28
    s_cbranch_vccnz ploopL_13_rm_3
    s_branch ploopL_13_rm_3ok
ploopL_13_rm_3_g:
    s_mov_b32 s22, 0
    s_waitcnt vmcnt(0)
    s_branch ploopL_13_rm_3ok
ploopL_13_rp:
    s_sub_u32 s22, s22, 1
    s_cbranch_scc0 ploopL_13_pagain
    s_mov_b32 s22, 0
    s_branch ploopL_13_pgo
.p2align 6
    s_nop 0
    s_nop 0
    s_nop 0
    s_nop 0
    s_nop 0
    s_nop 0
    s_nop 0
    s_nop 0
    s_nop 0
    s_nop 0
    s_nop 0
ploopH_12:
    v_mov_b32 v32, 0
    v_mov_b32 v33, 0
    v_mov_b32 v34, 0
    v_mov_b32 v35, 0
    v_mov_b32 v36, 0
    v_mov_b32 v37, 0
    v_mov_b32 v38, 0
    v_mov_b32 v39, 0
    v_mov_b32 v40, 0
    v_mov_b32 v41, 0
    v_mov_b32 v42, 0
    v_mov_b32 v43, 0
    v_mov_b32 v44, 0
    v_mov_b32 v45, 0
    v_mov_b32 v46, 0
    v_mov_b32 v47, 0
    v_mov_b32 v48, 0
    v_mov_b32 v49, 0
    v_mov_b32 v50, 0
    v_mov_b32 v51, 0
    v_mov_b32 v52, 0
    v_mov_b32 v53, 0
    v_mov_b32 v54, 0
    v_mov_b32 v55, 0
    s_sleep 1
    buffer_load_dwordx4 v[16:19], v1, s[4:7], s23 offen offset:0 sc1
    buffer_load_dwordx4 v[20:23], v1, s[4:7], s23 offen offset:1024 sc1
    buffer_load_dwordx4 v[24:27], v1, s[4:7], s23 offen offset:2048 sc1
    buffer_load_dwordx4 v[28:31], v1, s[4:7], s23 offen offset:3072 sc1
    s_waitcnt vmcnt(3)
    v_cmp_eq_u32 vcc, -1, v16
    s_cbranch_vccnz ploopH_12_rm_0
ploopH_12_rm_0ok:
    v_smfmac_f32_16x16x64_bf16 v[32:35], v[16:19], v[64:71], v8
    v_smfmac_f32_16x16x64_bf16 v[36:39], v[16:19], v[72:79], v8
    s_waitcnt vmcnt(2)
    v_cmp_eq_u32 vcc, -1, v20
    v_smfmac_f32_16x16x64_bf16 v[40:43], v[16:19], v[80:87], v8
    v_smfmac_f32_16x16x64_bf16 v[44:47], v[16:19], v[88:95], v8
    v_smfmac_f32_16x16x64_bf16 v[48:51], v[16:19], v[96:103], v8
    v_smfmac_f32_16x16x64_bf16 v[52:55], v[16:19], v[104:111], v8
    s_cbranch_vccnz ploopH_12_rm_1
ploopH_12_rm_1ok:
    v_smfmac_f32_16x16x64_bf16 v[32:35], v[20:23], v[112:119], v8
    v_smfmac_f32_16x16x64_bf16 v[36:39], v[20:23], v[120:127], v8
    s_waitcnt vmcnt(1)
    v_cmp_eq_u32 vcc, -1, v24
    v_smfmac_f32_16x16x64_bf16 v[40:43], v[20:23], v[128:135], v8
    v_smfmac_f32_16x16x64_bf16 v[44:47], v[20:23], v[136:143], v8
    v_smfmac_f32_16x16x64_bf16 v[48:51], v[20:23], v[144:151], v8
    v_smfmac_f32_16x16x64_bf16 v[52:55], v[20:23], v[152:159], v8
    s_cbranch_vccnz ploopH_12_rm_2
ploopH_12_rm_2ok:
    v_smfmac_f32_16x16x64_bf16 v[32:35], v[24:27], v[160:167], v8
    v_smfmac_f32_16x16x64_bf16 v[36:39], v[24:27], v[168:175], v8
    s_waitcnt vmcnt(0)
    v_cmp_eq_u32 vcc, -1, v28
    v_smfmac_f32_16x16x64_bf16 v[40:43], v[24:27], v[176:183], v8
    v_smfmac_f32_16x16x64_bf16 v[44:47], v[24:27], v[184:191], v8
    v_smfmac_f32_16x16x64_bf16 v[48:51], v[24:27], v[192:199], v8
    v_smfmac_f32_16x16x64_bf16 v[52:55], v[24:27], v[200:207], v8
    s_cbranch_vccnz ploopH_12_rm_3
ploopH_12_rm_3ok:
    v_smfmac_f32_16x16x64_bf16 v[32:35], v[28:31], v[208:215], v8
    ds_write_b32 v63, v59 offset:32
    v_smfmac_f32_16x16x64_bf16 v[36:39], v[28:31], v[216:223], v8
    v_smfmac_f32_16x16x64_bf16 v[40:43], v[28:31], v[224:231], v8
    v_smfmac_f32_16x16x64_bf16 v[44:47], v[28:31], v[232:239], v8
    v_smfmac_f32_16x16x64_bf16 v[48:51], v[28:31], v[240:247], v8
    v_smfmac_f32_16x16x64_bf16 v[52:55], v[28:31], v[248:255], v8
    s_cmp_eq_u32 s3, 3
    s_nop 1
    v_add_f32 v32, v32, v34
    v_add_f32 v33, v33, v35
    ds_write2_b32 v3, v32, v33 offset0:0 offset1:40
    v_add_f32 v36, v36, v38
    v_add_f32 v37, v37, v39
    ds_write2_b32 v3, v36, v37 offset0:16 offset1:56
    v_add_f32 v40, v40, v42
    v_add_f32 v41, v41, v43
    ds_write2_b32 v61, v40, v41 offset0:0 offset1:40
    v_add_f32 v44, v44, v46
    v_add_f32 v45, v45, v47
    ds_write2_b32 v61, v44, v45 offset0:16 offset1:56
    v_add_f32 v48, v48, v50
    v_add_f32 v49, v49, v51
    ds_write2_b32 v62, v48, v49 offset0:0 offset1:40
    v_add_f32 v52, v52, v54
    v_add_f32 v53, v53, v55
    ds_write2_b32 v62, v52, v53 offset0:16 offset1:56
    s_waitcnt lgkmcnt(0)
    s_barrier
    s_cbranch_scc1 ploopH_12_sk1
    ds_read_b128 v[32:35], v4 offset:0
    ds_read_b128 v[36:39], v4 offset:3840
    ds_read_b128 v[40:43], v4 offset:7680
    ds_read_b128 v[44:47], v4 offset:11520
    s_waitcnt lgkmcnt(2)
    v_add_f32 v32, v32, v36
    v_add_f32 v33, v33, v37
    v_add_f32 v34, v34, v38
    v_add_f32 v35, v35, v39
    s_waitcnt lgkmcnt(0)
    v_add_f32 v40, v40, v44
    v_add_f32 v41, v41, v45
    v_add_f32 v42, v42, v46
    v_add_f32 v43, v43, v47
    v_add_f32 v32, v32, v40
    v_add_f32 v33, v33, v41
    v_add_f32 v34, v34, v42
    v_add_f32 v35, v35, v43
    v_cvt_pk_bf16_f32 v56, v32, v33
    v_cvt_pk_bf16_f32 v57, v34, v35
    v_min_u32 v56, -2, v56
    buffer_store_dwordx2 v[56:57], v2, s[4:7], s26 offen sc1
    s_add_u32 s27, s16, 2
    s_and_b32 s27, s27, 3
    s_lshl_b32 s27, s27, 18
    s_add_u32 s27, s27, s38
    buffer_store_dwordx2 v[10:11], v2, s[4:7], s27 offen sc1
ploopH_12_sk1:
    s_setprio 0
    s_add_u32 s25, s16, 3
    s_and_b32 s25, s25, 3
    s_lshl_b32 s25, s25, 16
    s_add_u32 s25, s25, s37
    v_mov_b32 v44, -1
    v_mov_b32 v45, -1
    v_mov_b32 v46, -1
    v_mov_b32 v47, -1
    s_mov_b64 exec, s[56:57]
    buffer_store_dwordx4 v[44:47], v5, s[4:7], s25 offen sc1
    s_mov_b64 exec, -1
    v_mov_b32_dpp v48, v12 row_ror:8 row_mask:0xf bank_mask:0xf
    v_mov_b32_dpp v49, v13 row_ror:8 row_mask:0xf bank_mask:0xf
    v_mov_b32_dpp v50, v14 row_ror:8 row_mask:0xf bank_mask:0xf
    v_mov_b32_dpp v51, v15 row_ror:8 row_mask:0xf bank_mask:0xf
    s_and_b32 s28, s16, 3
    s_lshl_b32 s28, s28, 18
    s_add_u32 s28, s28, s39
    s_add_u32 s24, s16, 1
    s_and_b32 s24, s24, 3
    s_lshl_b32 s24, s24, 16
    s_add_u32 s24, s24, s37
    s_add_u32 s23, s16, 1
    s_and_b32 s23, s23, 3
    s_lshl_b32 s23, s23, 16
    s_add_u32 s23, s23, s36
    s_add_u32 s26, s16, 1
    s_and_b32 s26, s26, 3
    s_lshl_b32 s26, s26, 18
    s_add_u32 s26, s26, s38
    s_cmp_eq_u32 s16, 63
    s_cbranch_scc1 ploopH_12_tail
    s_cmp_eq_u32 s30, s54
    s_cbranch_scc1 pnoseg_15
    ds_read_b128 v[16:19], v6 offset:0
    ds_read_b128 v[20:23], v6 offset:256
    ds_read_b128 v[24:27], v6 offset:512
    ds_read_b128 v[28:31], v6 offset:768
    v_xor_b32 v6, 0x4000, v6
    s_waitcnt lgkmcnt(2)
    v_mfma_f32_16x16x32_bf16 v[40:43], v[12:15], v[16:19], 0
    v_mfma_f32_16x16x32_bf16 v[40:43], v[48:51], v[20:23], v[40:43]
    s_waitcnt lgkmcnt(0)
    v_mfma_f32_16x16x32_bf16 v[44:47], v[12:15], v[24:27], 0
    v_mfma_f32_16x16x32_bf16 v[44:47], v[48:51], v[28:31], v[44:47]
    s_nop 7
    v_cvt_pk_bf16_f32 v40, v40, v41
    v_cvt_pk_bf16_f32 v41, v42, v43
    v_cvt_pk_bf16_f32 v42, v44, v45
    v_cvt_pk_bf16_f32 v43, v46, v47
    s_nop 1
    v_permlane16_swap_b32 v40, v42
    v_permlane16_swap_b32 v41, v43
    s_nop 1
    v_min_u32 v40, -2, v40
pnoseg_15:
    s_bitcmp1_b32 s29, 0
    s_cbranch_scc1 gate_16_ok
    s_add_u32 s21, s16, 1
    s_min_u32 s21, s21, 63
    s_cmp_ge_u32 s21, 48
    s_cselect_b32 s19, 12, 8
    s_and_b32 s32, s21, 4
    s_lshr_b32 s21, s21, 3
    s_lshl_b32 s21, s21, 8
    s_add_u32 s32, s32, s21
    s_add_u32 s32, s32, s35
gate_16:
    buffer_load_dword v9, off, s[4:7], s32 sc1
    s_waitcnt vmcnt(0)
    v_readfirstlane_b32 s21, v9
    s_cmp_ge_u32 s21, s19
    s_cbranch_scc1 gate_16_set
    s_sleep 8
    s_sub_u32 s22, s22, 1
    s_cbranch_scc0 gate_16
    s_mov_b32 s22, 0
gate_16_set:
    s_bitset1_b32 s29, 0
gate_16_ok:
    v_readfirstlane_b32 s21, v60
    s_lshr_b32 s29, s29, 1
    s_cmp_ge_u32 s21, s58
    s_cselect_b32 s21, 2, 0
    s_or_b32 s29, s29, s21
    s_cmp_eq_u32 s3, 3
    s_cselect_b32 s20, s21, 0
    s_add_u32 s21, s16, 4
    s_min_u32 s21, s21, 63
    s_cmp_ge_u32 s21, 48
    s_cselect_b32 s58, 12, 8
    s_and_b32 s33, s21, 4
    s_lshr_b32 s21, s21, 3
    s_lshl_b32 s21, s21, 8
    s_add_u32 s33, s33, s21
    s_add_u32 s33, s33, s35
    s_setprio 3
ploopH_12_fs:
    ds_read_b128 v[32:35], v58 offset:0
    s_waitcnt lgkmcnt(0)
    v_min3_i32 v32, v32, v33, v34
    v_min_i32 v32, v32, v35
    s_nop 0
    v_readfirstlane_b32 s18, v32
    s_cmp_ge_i32 s18, s16
    s_cbranch_scc1 ploopH_12_fsok
    s_sleep 1
    s_branch ploopH_12_fs
ploopH_12_fsok:
    s_setprio 1
    s_add_u32 m0, s42, 0
    s_add_u32 s17, s41, 20971520
    buffer_load_dwordx4 v1, s[4:7], s17 offen offset:0 sc1 lds
    buffer_load_dwordx4 v1, s[4:7], s17 offen offset:1024 sc1 lds
    buffer_load_dwordx4 v1, s[4:7], s17 offen offset:2048 sc1 lds
    buffer_load_dwordx4 v1, s[4:7], s17 offen offset:3072 sc1 lds
    s_add_u32 m0, s42, 4096
    s_add_u32 s17, s41, 21102592
    buffer_load_dwordx4 v1, s[4:7], s17 offen offset:0 sc1 lds
    buffer_load_dwordx4 v1, s[4:7], s17 offen offset:1024 sc1 lds
    buffer_load_dwordx4 v1, s[4:7], s17 offen offset:2048 sc1 lds
    buffer_load_dwordx4 v1, s[4:7], s17 offen offset:3072 sc1 lds
    s_cmp_eq_u32 s20, 0
    s_cbranch_scc1 ploopH_12_nt
    s_mov_b32 exec_hi, 0xffff
    buffer_load_dword v60, v0, s[4:7], s31 offen sc1
    s_mov_b32 exec_hi, -1
ploopH_12_nt:
    s_cmp_eq_u32 s30, s54
    s_cbranch_scc1 pnoseg_17
    buffer_store_dwordx4 v[40:43], v7, s[4:7], s30 offen sc1
    s_add_u32 s30, s30, 65536
pnoseg_17:
    s_barrier
    buffer_load_dword v60, off, s[4:7], s33 sc1
    s_sleep 6
    s_add_u32 m0, s42, 8192
    s_add_u32 s17, s41, 37748736
    buffer_load_dwordx4 v1, s[4:7], s17 offen offset:0 sc1 lds
    buffer_load_dwordx4 v1, s[4:7], s17 offen offset:1024 sc1 lds
    buffer_load_dwordx4 v1, s[4:7], s17 offen offset:2048 sc1 lds
    buffer_load_dwordx4 v1, s[4:7], s17 offen offset:3072 sc1 lds
    s_add_u32 m0, s42, 12288
    s_add_u32 s17, s41, 37879808
    buffer_load_dwordx4 v1, s[4:7], s17 offen offset:0 sc1 lds
    buffer_load_dwordx4 v1, s[4:7], s17 offen offset:1024 sc1 lds
    buffer_load_dwordx4 v1, s[4:7], s17 offen offset:2048 sc1 lds
    buffer_load_dwordx4 v1, s[4:7], s17 offen offset:3072 sc1 lds
    s_add_u32 s16, s16, 1
    v_mov_b32 v59, s16
    s_add_u32 s41, s41, 262144
    s_add_u32 s31, s31, 262144
    s_mov_b32 s54, 0
    s_setprio 3
    s_sleep 1
ploopH_12_pagain:
    buffer_load_dwordx4 v[16:19], v1, s[4:7], s28 offen offset:0 sc1
    buffer_load_dwordx4 v[20:23], v1, s[4:7], s28 offen offset:1024 sc1
    s_waitcnt vmcnt(1)
    v_mfma_f32_16x16x32_bf16 v[32:35], v[12:15], v[16:19], 0
    s_waitcnt vmcnt(0)
    v_mfma_f32_16x16x32_bf16 v[32:35], v[48:51], v[20:23], v[32:35]
    v_max_u32 v9, v16, v20
    v_cmp_eq_u32 vcc, -1, v9
    s_cbranch_vccnz ploopH_12_rp
ploopH_12_pgo:
    s_nop 4
    v_add_f32_dpp v36, v32, v32 row_ror:8 row_mask:0xf bank_mask:0xf
    v_add_f32_dpp v37, v33, v33 row_ror:8 row_mask:0xf bank_mask:0xf
    v_add_f32_dpp v38, v34, v34 row_ror:8 row_mask:0xf bank_mask:0xf
    v_add_f32_dpp v39, v35, v35 row_ror:8 row_mask:0xf bank_mask:0xf
    v_cvt_pk_bf16_f32 v52, v36, v37
    v_cvt_pk_bf16_f32 v53, v38, v39
    s_nop 0
    v_permlane16_swap_b32 v52, v54
    v_permlane16_swap_b32 v53, v55
    s_mov_b64 exec, s[56:57]
    v_min_u32 v52, -2, v52
    buffer_store_dwordx4 v[52:55], v5, s[4:7], s24 offen sc1
    s_mov_b64 exec, -1
    ds_write_b32 v63, v59 offset:16
    s_branch ploopH_12
ploopH_12_rm_0:
    s_sub_u32 s22, s22, 1
    s_cbranch_scc1 ploopH_12_rm_0_g
    buffer_load_dwordx4 v[16:19], v1, s[4:7], s23 offen offset:0 sc1
    buffer_load_dwordx4 v[20:23], v1, s[4:7], s23 offen offset:1024 sc1
    buffer_load_dwordx4 v[24:27], v1, s[4:7], s23 offen offset:2048 sc1
    buffer_load_dwordx4 v[28:31], v1, s[4:7], s23 offen offset:3072 sc1
    s_waitcnt vmcnt(3)
    v_cmp_eq_u32 vcc, -1, v16
    s_cbranch_vccnz ploopH_12_rm_0
    s_branch ploopH_12_rm_0ok
ploopH_12_rm_0_g:
    s_mov_b32 s22, 0
    s_waitcnt vmcnt(0)
    s_branch ploopH_12_rm_0ok
ploopH_12_rm_1:
    s_sub_u32 s22, s22, 1
    s_cbranch_scc1 ploopH_12_rm_1_g
    buffer_load_dwordx4 v[20:23], v1, s[4:7], s23 offen offset:1024 sc1
    buffer_load_dwordx4 v[24:27], v1, s[4:7], s23 offen offset:2048 sc1
    buffer_load_dwordx4 v[28:31], v1, s[4:7], s23 offen offset:3072 sc1
    s_waitcnt vmcnt(2)
    v_cmp_eq_u32 vcc, -1, v20
    s_cbranch_vccnz ploopH_12_rm_1
    s_branch ploopH_12_rm_1ok
ploopH_12_rm_1_g:
    s_mov_b32 s22, 0
    s_waitcnt vmcnt(0)
    s_branch ploopH_12_rm_1ok
ploopH_12_rm_2:
    s_sub_u32 s22, s22, 1
    s_cbranch_scc1 ploopH_12_rm_2_g
    buffer_load_dwordx4 v[24:27], v1, s[4:7], s23 offen offset:2048 sc1
    buffer_load_dwordx4 v[28:31], v1, s[4:7], s23 offen offset:3072 sc1
    s_waitcnt vmcnt(1)
    v_cmp_eq_u32 vcc, -1, v24
    s_cbranch_vccnz ploopH_12_rm_2
    s_branch ploopH_12_rm_2ok
ploopH_12_rm_2_g:
    s_mov_b32 s22, 0
    s_waitcnt vmcnt(0)
    s_branch ploopH_12_rm_2ok
ploopH_12_rm_3:
    s_sub_u32 s22, s22, 1
    s_cbranch_scc1 ploopH_12_rm_3_g
    buffer_load_dwordx4 v[28:31], v1, s[4:7], s23 offen offset:3072 sc1
    s_waitcnt vmcnt(0)
    v_cmp_eq_u32 vcc, -1, v28
    s_cbranch_vccnz ploopH_12_rm_3
    s_branch ploopH_12_rm_3ok
ploopH_12_rm_3_g:
    s_mov_b32 s22, 0
    s_waitcnt vmcnt(0)
    s_branch ploopH_12_rm_3ok
ploopH_12_rp:
    s_sub_u32 s22, s22, 1
    s_cbranch_scc0 ploopH_12_pagain
    s_mov_b32 s22, 0
    s_branch ploopH_12_pgo
ploopH_12_tail:
    ds_read_b128 v[16:19], v6 offset:0
    ds_read_b128 v[20:23], v6 offset:256
    ds_read_b128 v[24:27], v6 offset:512
    ds_read_b128 v[28:31], v6 offset:768
    v_xor_b32 v6, 0x4000, v6
    s_waitcnt lgkmcnt(2)
    v_mfma_f32_16x16x32_bf16 v[40:43], v[12:15], v[16:19], 0
    v_mfma_f32_16x16x32_bf16 v[40:43], v[48:51], v[20:23], v[40:43]
    s_waitcnt lgkmcnt(0)
    v_mfma_f32_16x16x32_bf16 v[44:47], v[12:15], v[24:27], 0
    v_mfma_f32_16x16x32_bf16 v[44:47], v[48:51], v[28:31], v[44:47]
    s_nop 7
    v_cvt_pk_bf16_f32 v40, v40, v41
    v_cvt_pk_bf16_f32 v41, v42, v43
    v_cvt_pk_bf16_f32 v42, v44, v45
    v_cvt_pk_bf16_f32 v43, v46, v47
    s_nop 1
    v_permlane16_swap_b32 v40, v42
    v_permlane16_swap_b32 v41, v43
    s_nop 1
    v_min_u32 v40, -2, v40
    buffer_store_dwordx4 v[40:43], v7, s[4:7], s30 offen sc1
    s_add_u32 s30, s30, 65536
    s_barrier
    ds_read_b128 v[16:19], v6 offset:0
    ds_read_b128 v[20:23], v6 offset:256
    ds_read_b128 v[24:27], v6 offset:512
    ds_read_b128 v[28:31], v6 offset:768
    v_xor_b32 v6, 0x4000, v6
    s_waitcnt lgkmcnt(2)
    v_mfma_f32_16x16x32_bf16 v[40:43], v[12:15], v[16:19], 0
    v_mfma_f32_16x16x32_bf16 v[40:43], v[48:51], v[20:23], v[40:43]
    s_waitcnt lgkmcnt(0)
    v_mfma_f32_16x16x32_bf16 v[44:47], v[12:15], v[24:27], 0
    v_mfma_f32_16x16x32_bf16 v[44:47], v[48:51], v[28:31], v[44:47]
    s_nop 7
    v_cvt_pk_bf16_f32 v40, v40, v41
    v_cvt_pk_bf16_f32 v41, v42, v43
    v_cvt_pk_bf16_f32 v42, v44, v45
    v_cvt_pk_bf16_f32 v43, v46, v47
    s_nop 1
    v_permlane16_swap_b32 v40, v42
    v_permlane16_swap_b32 v41, v43
    s_nop 1
    v_min_u32 v40, -2, v40
    buffer_store_dwordx4 v[40:43], v7, s[4:7], s30 offen sc1
    s_add_u32 s30, s30, 65536
    s_branch k_end
ch_a_pro:
    s_sub_u32 s21, s3, 4
    s_lshl_b32 s15, s14, 2
    s_add_u32 s15, s15, s21
    s_lshl_b32 s38, s15, 13
    s_add_u32 s38, s38, 214958080
    s_min_u32 s20, s21, 2
    s_lshl_b32 s18, s20, 3
    s_add_u32 s18, s18, 16
    s_load_dwordx2 s[8:9], s[0:1], s18
    s_mov_b32 s10, 8388608
    s_mov_b32 s11, 131072
    v_and_b32 v20, 63, v0
    v_lshlrev_b32 v21, 13, v20
    s_lshl_b32 s17, s34, 19
    s_lshl_b32 s18, s14, 10
    s_add_u32 s17, s17, s18
    s_waitcnt lgkmcnt(0)
    buffer_load_dword v26, v21, s[8:11], s17 offen offset:384
    v_and_b32 v20, 63, v0
    v_lshrrev_b32 v21, 4, v20
    v_bfe_u32 v22, v20, 1, 1
    v_xor_b32 v22, 1, v22
    v_lshl_add_u32 v23, v22, 2, v21
    v_bfe_u32 v22, v20, 2, 2
    v_and_b32 v24, 1, v20
    v_lshl_add_u32 v22, v22, 1, v24
    v_lshl_add_u32 v23, v23, 3, v22
    v_and_b32 v22, 7, v20
    v_lshlrev_b32 v23, 4, v23
    s_lshl_b32 s17, s21, 10
    s_add_u32 s17, s17, 16384
    v_add_u32 v160, s17, v23
    v_and_b32 v24, 15, v20
    v_lshlrev_b32 v24, 4, v24
    v_lshl_add_u32 v23, v21, 10, v24
    s_lshl_b32 s17, s21, 8
    s_add_u32 s17, s17, 16384
    v_add_u32 v161, s17, v23
    v_lshl_add_u32 v23, v21, 9, v24
    s_lshl_b32 s17, s21, 12
    s_add_u32 s17, s17, 32768
    v_add_u32 v162, s17, v23
    v_bfe_u32 v23, v20, 3, 1
    v_lshlrev_b32 v23, 10, v23
    v_lshl_add_u32 v23, v22, 4, v23
    v_mov_b32 v1, v23
    s_lshl_b32 s39, s34, 14
    s_lshl_b32 s17, s21, 11
    s_add_u32 s39, s39, s17
    s_lshl_b32 s17, s14, 7
    s_add_u32 s39, s39, s17
    s_add_u32 s39, s39, 209715200
    v_mov_b32 v176, -1
    v_mov_b32 v177, -1
    v_mov_b32 v178, -1
    v_mov_b32 v179, -1
    v_lshlrev_b32 v24, 4, v0
    s_lshl_b32 s17, s52, 13
    s_add_u32 s19, s17, 209711104
    s_add_u32 s17, s17, 214953984
    s_lshl_b32 s18, s52, 12
    s_add_u32 s18, s18, 213905408
    buffer_store_dwordx4 v[176:179], v24, s[4:7], s19 offen sc1
    s_add_u32 s19, s19, 4096
    buffer_store_dwordx4 v[176:179], v24, s[4:7], s19 offen sc1
    buffer_store_dwordx4 v[176:179], v24, s[4:7], s17 offen sc1
    s_add_u32 s17, s17, 4096
    buffer_store_dwordx4 v[176:179], v24, s[4:7], s17 offen sc1
    buffer_store_dwordx4 v[176:179], v24, s[4:7], s18 offen sc1
    s_and_b32 s17, s13, 7
    s_sub_u32 s18, s21, 1
    s_cmp_lt_u32 s18, 2
    s_cselect_b32 s54, s17, 1
    s_lshr_b32 s19, s52, 3
    s_lshl_b32 s19, s19, 8
    s_lshl_b32 s18, s18, 7
    s_add_u32 s19, s19, s18
    s_add_u32 s55, s19, 210763776
    s_cmp_lg_u32 s54, 0
    s_cbranch_scc1 ch_nv0
    v_lshlrev_b32 v24, 13, v20
    s_mov_b64 exec, 0xffff
    buffer_store_dword v176, v24, s[4:7], s55 offen sc1
    s_mov_b64 exec, -1
ch_nv0:
    v_mov_b32 v2, s40
    s_lshl_b32 s17, s12, 2
    s_add_u32 s17, s17, 128
    s_waitcnt vmcnt(0)
    s_barrier
    s_cmp_lg_u32 s3, 4
    s_cbranch_scc1 ch_nox
    s_mov_b64 exec, 1
    buffer_atomic_add v2, off, s[64:67], s17 sc1
    s_mov_b64 exec, -1
ch_nox:
    v_and_b32 v20, 63, v0
    v_lshlrev_b32 v0, 4, v20
    s_lshl_b32 s17, s15, 18
    s_lshl_b32 s18, s34, 7
    s_add_u32 s17, s17, s18
    s_lshl_b32 s19, s21, 13
    s_add_u32 s19, s19, 131072
    s_load_dwordx2 s[8:9], s[0:1], 40
    s_mov_b32 s10, 8388608
    s_mov_b32 s11, 131072
    v_lshrrev_b32 v21, 3, v20
    v_and_b32 v22, 7, v20
    v_lshlrev_b32 v21, 11, v21
    v_lshl_add_u32 v21, v22, 4, v21
    v_lshrrev_b32 v28, 4, v20
    v_and_b32 v29, 1, v28
    v_xor_b32 v29, 0, v29
    v_lshlrev_b32 v29, 2, v29
    v_lshl_add_u32 v29, v28, 3, v29
    v_bfe_u32 v28, v20, 2, 2
    v_add_u32 v29, v29, v28
    v_lshlrev_b32 v29, 7, v29
    v_and_b32 v28, 3, v20
    v_lshl_add_u32 v29, v28, 4, v29
    v_and_b32 v28, 1, v28
    v_xor_b32 v28, 0, v28
    v_lshl_add_u32 v24, v28, 3, v29
    v_add_u32 v24, s19, v24
    v_lshrrev_b32 v28, 4, v20
    v_and_b32 v29, 1, v28
    v_xor_b32 v29, 1, v29
    v_lshlrev_b32 v29, 2, v29
    v_lshl_add_u32 v29, v28, 3, v29
    v_bfe_u32 v28, v20, 2, 2
    v_add_u32 v29, v29, v28
    v_lshlrev_b32 v29, 7, v29
    v_and_b32 v28, 3, v20
    v_lshl_add_u32 v29, v28, 4, v29
    v_and_b32 v28, 1, v28
    v_xor_b32 v28, 0, v28
    v_lshl_add_u32 v25, v28, 3, v29
    v_add_u32 v25, s19, v25
    v_lshrrev_b32 v28, 4, v20
    v_and_b32 v29, 1, v28
    v_xor_b32 v29, 0, v29
    v_lshlrev_b32 v29, 2, v29
    v_lshl_add_u32 v29, v28, 3, v29
    v_bfe_u32 v28, v20, 2, 2
    v_add_u32 v29, v29, v28
    v_lshlrev_b32 v29, 7, v29
    v_and_b32 v28, 3, v20
    v_lshl_add_u32 v29, v28, 4, v29
    v_and_b32 v28, 1, v28
    v_xor_b32 v28, 1, v28
    v_lshl_add_u32 v26, v28, 3, v29
    v_add_u32 v26, s19, v26
    v_lshrrev_b32 v28, 4, v20
    v_and_b32 v29, 1, v28
    v_xor_b32 v29, 1, v29
    v_lshlrev_b32 v29, 2, v29
    v_lshl_add_u32 v29, v28, 3, v29
    v_bfe_u32 v28, v20, 2, 2
    v_add_u32 v29, v29, v28
    v_lshlrev_b32 v29, 7, v29
    v_and_b32 v28, 3, v20
    v_lshl_add_u32 v29, v28, 4, v29
    v_and_b32 v28, 1, v28
    v_xor_b32 v28, 1, v28
    v_lshl_add_u32 v27, v28, 3, v29
    v_add_u32 v27, s19, v27
    s_waitcnt lgkmcnt(0)
    s_add_u32 m0, s19, 0
    s_nop 0
    buffer_load_dwordx4 v21, s[8:11], s17 offen lds
    s_add_u32 s17, s17, 16384
    s_add_u32 m0, s19, 1024
    s_nop 0
    buffer_load_dwordx4 v21, s[8:11], s17 offen lds
    s_add_u32 s17, s17, 16384
    s_add_u32 m0, s19, 2048
    s_nop 0
    buffer_load_dwordx4 v21, s[8:11], s17 offen lds
    s_add_u32 s17, s17, 16384
    s_add_u32 m0, s19, 3072
    s_nop 0
    buffer_load_dwordx4 v21, s[8:11], s17 offen lds
    s_add_u32 s17, s17, 16384
    s_add_u32 m0, s19, 4096
    s_nop 0
    buffer_load_dwordx4 v21, s[8:11], s17 offen lds
    s_add_u32 s17, s17, 16384
    s_add_u32 m0, s19, 5120
    s_nop 0
    buffer_load_dwordx4 v21, s[8:11], s17 offen lds
    s_add_u32 s17, s17, 16384
    s_add_u32 m0, s19, 6144
    s_nop 0
    buffer_load_dwordx4 v21, s[8:11], s17 offen lds
    s_add_u32 s17, s17, 16384
    s_add_u32 m0, s19, 7168
    s_nop 0
    buffer_load_dwordx4 v21, s[8:11], s17 offen lds
    s_add_u32 s17, s17, 16384
    buffer_load_dwordx4 v[96:99], v21, s[8:11], s17 offen
    s_add_u32 s17, s17, 16384
    buffer_load_dwordx4 v[100:103], v21, s[8:11], s17 offen
    s_add_u32 s17, s17, 16384
    buffer_load_dwordx4 v[104:107], v21, s[8:11], s17 offen
    s_add_u32 s17, s17, 16384
    buffer_load_dwordx4 v[108:111], v21, s[8:11], s17 offen
    s_add_u32 s17, s17, 16384
    buffer_load_dwordx4 v[112:115], v21, s[8:11], s17 offen
    s_add_u32 s17, s17, 16384
    buffer_load_dwordx4 v[116:119], v21, s[8:11], s17 offen
    s_add_u32 s17, s17, 16384
    buffer_load_dwordx4 v[120:123], v21, s[8:11], s17 offen
    s_add_u32 s17, s17, 16384
    buffer_load_dwordx4 v[124:127], v21, s[8:11], s17 offen
    s_add_u32 s17, s17, 16384
    s_cmp_lg_u32 s54, 0
    s_cbranch_scc1 ch_nv1
    s_mov_b32 s58, -1
    s_mov_b32 s59, -1
    s_memtime s[60:61]
    s_add_u32 s56, s55, 0
    s_waitcnt lgkmcnt(0)
    s_load_dword s57, s[4:5], s56 glc
    s_waitcnt lgkmcnt(0)
    s_memtime s[62:63]
    s_waitcnt lgkmcnt(0)
    s_sub_u32 s57, s62, s60
    s_min_u32 s58, s58, s57
    s_memtime s[60:61]
    s_add_u32 s56, s55, 8192
    s_waitcnt lgkmcnt(0)
    s_load_dword s57, s[4:5], s56 glc
    s_waitcnt lgkmcnt(0)
    s_memtime s[62:63]
    s_waitcnt lgkmcnt(0)
    s_sub_u32 s57, s62, s60
    s_min_u32 s59, s59, s57
    s_memtime s[60:61]
    s_add_u32 s56, s55, 16384
    s_waitcnt lgkmcnt(0)
    s_load_dword s57, s[4:5], s56 glc
    s_waitcnt lgkmcnt(0)
    s_memtime s[62:63]
    s_waitcnt lgkmcnt(0)
    s_sub_u32 s57, s62, s60
    s_min_u32 s58, s58, s57
    s_memtime s[60:61]
    s_add_u32 s56, s55, 24576
    s_waitcnt lgkmcnt(0)
    s_load_dword s57, s[4:5], s56 glc
    s_waitcnt lgkmcnt(0)
    s_memtime s[62:63]
    s_waitcnt lgkmcnt(0)
    s_sub_u32 s57, s62, s60
    s_min_u32 s59, s59, s57
    s_memtime s[60:61]
    s_add_u32 s56, s55, 32768
    s_waitcnt lgkmcnt(0)
    s_load_dword s57, s[4:5], s56 glc
    s_waitcnt lgkmcnt(0)
    s_memtime s[62:63]
    s_waitcnt lgkmcnt(0)
    s_sub_u32 s57, s62, s60
    s_min_u32 s58, s58, s57
    s_memtime s[60:61]
    s_add_u32 s56, s55, 40960
    s_waitcnt lgkmcnt(0)
    s_load_dword s57, s[4:5], s56 glc
    s_waitcnt lgkmcnt(0)
    s_memtime s[62:63]
    s_waitcnt lgkmcnt(0)
    s_sub_u32 s57, s62, s60
    s_min_u32 s59, s59, s57
    s_memtime s[60:61]
    s_add_u32 s56, s55, 49152
    s_waitcnt lgkmcnt(0)
    s_load_dword s57, s[4:5], s56 glc
    s_waitcnt lgkmcnt(0)
    s_memtime s[62:63]
    s_waitcnt lgkmcnt(0)
    s_sub_u32 s57, s62, s60
    s_min_u32 s58, s58, s57
    s_memtime s[60:61]
    s_add_u32 s56, s55, 57344
    s_waitcnt lgkmcnt(0)
    s_load_dword s57, s[4:5], s56 glc
    s_waitcnt lgkmcnt(0)
    s_memtime s[62:63]
    s_waitcnt lgkmcnt(0)
    s_sub_u32 s57, s62, s60
    s_min_u32 s59, s59, s57
    s_memtime s[60:61]
    s_add_u32 s56, s55, 65536
    s_waitcnt lgkmcnt(0)
    s_load_dword s57, s[4:5], s56 glc
    s_waitcnt lgkmcnt(0)
    s_memtime s[62:63]
    s_waitcnt lgkmcnt(0)
    s_sub_u32 s57, s62, s60
    s_min_u32 s58, s58, s57
    s_memtime s[60:61]
    s_add_u32 s56, s55, 73728
    s_waitcnt lgkmcnt(0)
    s_load_dword s57, s[4:5], s56 glc
    s_waitcnt lgkmcnt(0)
    s_memtime s[62:63]
    s_waitcnt lgkmcnt(0)
    s_sub_u32 s57, s62, s60
    s_min_u32 s59, s59, s57
    s_memtime s[60:61]
    s_add_u32 s56, s55, 81920
    s_waitcnt lgkmcnt(0)
    s_load_dword s57, s[4:5], s56 glc
    s_waitcnt lgkmcnt(0)
    s_memtime s[62:63]
    s_waitcnt lgkmcnt(0)
    s_sub_u32 s57, s62, s60
    s_min_u32 s58, s58, s57
    s_memtime s[60:61]
    s_add_u32 s56, s55, 90112
    s_waitcnt lgkmcnt(0)
    s_load_dword s57, s[4:5], s56 glc
    s_waitcnt lgkmcnt(0)
    s_memtime s[62:63]
    s_waitcnt lgkmcnt(0)
    s_sub_u32 s57, s62, s60
    s_min_u32 s59, s59, s57
    s_memtime s[60:61]
    s_add_u32 s56, s55, 98304
    s_waitcnt lgkmcnt(0)
    s_load_dword s57, s[4:5], s56 glc
    s_waitcnt lgkmcnt(0)
    s_memtime s[62:63]
    s_waitcnt lgkmcnt(0)
    s_sub_u32 s57, s62, s60
    s_min_u32 s58, s58, s57
    s_memtime s[60:61]
    s_add_u32 s56, s55, 106496
    s_waitcnt lgkmcnt(0)
    s_load_dword s57, s[4:5], s56 glc
    s_waitcnt lgkmcnt(0)
    s_memtime s[62:63]
    s_waitcnt lgkmcnt(0)
    s_sub_u32 s57, s62, s60
    s_min_u32 s59, s59, s57
    s_memtime s[60:61]
    s_add_u32 s56, s55, 114688
    s_waitcnt lgkmcnt(0)
    s_load_dword s57, s[4:5], s56 glc
    s_waitcnt lgkmcnt(0)
    s_memtime s[62:63]
    s_waitcnt lgkmcnt(0)
    s_sub_u32 s57, s62, s60
    s_min_u32 s58, s58, s57
    s_memtime s[60:61]
    s_add_u32 s56, s55, 122880
    s_waitcnt lgkmcnt(0)
    s_load_dword s57, s[4:5], s56 glc
    s_waitcnt lgkmcnt(0)
    s_memtime s[62:63]
    s_waitcnt lgkmcnt(0)
    s_sub_u32 s57, s62, s60
    s_min_u32 s59, s59, s57
    s_sub_i32 s57, s58, s59
    s_min_i32 s57, s57, 400
    s_max_i32 s57, s57, -400
    s_add_u32 s57, s57, 16777616
    s_getreg_b32 s56, hwreg(HW_REG_XCC_ID)
    s_and_b32 s56, s56, 0
    v_mov_b32 v2, s57
    s_mov_b64 exec, 1
    buffer_atomic_add v2, off, s[64:67], s56 offset:160 sc1
    s_mov_b64 exec, -1
    s_waitcnt vmcnt(0)
ch_nv1:
    s_lshl_b32 s19, s21, 13
    s_add_u32 s19, s19, 131072
    v_add_u32 v30, s19, v0
    s_waitcnt vmcnt(8)
    ds_read_b64_tr_b16 v[192:193], v24 offset:0
    ds_read_b64_tr_b16 v[194:195], v25 offset:0
    ds_read_b64_tr_b16 v[208:209], v26 offset:0
    ds_read_b64_tr_b16 v[210:211], v27 offset:0
    ds_read_b64_tr_b16 v[224:225], v24 offset:64
    ds_read_b64_tr_b16 v[226:227], v25 offset:64
    ds_read_b64_tr_b16 v[240:241], v26 offset:64
    ds_read_b64_tr_b16 v[242:243], v27 offset:64
    s_waitcnt lgkmcnt(0)
    ds_read_b64_tr_b16 v[196:197], v24 offset:4096
    ds_read_b64_tr_b16 v[198:199], v25 offset:4096
    ds_read_b64_tr_b16 v[212:213], v26 offset:4096
    ds_read_b64_tr_b16 v[214:215], v27 offset:4096
    ds_read_b64_tr_b16 v[228:229], v24 offset:4160
    ds_read_b64_tr_b16 v[230:231], v25 offset:4160
    ds_read_b64_tr_b16 v[244:245], v26 offset:4160
    ds_read_b64_tr_b16 v[246:247], v27 offset:4160
    s_waitcnt lgkmcnt(0)
    s_waitcnt vmcnt(0)
    ds_write_b128 v30, v[96:99] offset:0
    ds_write_b128 v30, v[100:103] offset:1024
    ds_write_b128 v30, v[104:107] offset:2048
    ds_write_b128 v30, v[108:111] offset:3072
    ds_write_b128 v30, v[112:115] offset:4096
    ds_write_b128 v30, v[116:119] offset:5120
    ds_write_b128 v30, v[120:123] offset:6144
    ds_write_b128 v30, v[124:127] offset:7168
    s_waitcnt lgkmcnt(0)
    ds_read_b64_tr_b16 v[200:201], v24 offset:0
    ds_read_b64_tr_b16 v[202:203], v25 offset:0
    ds_read_b64_tr_b16 v[216:217], v26 offset:0
    ds_read_b64_tr_b16 v[218:219], v27 offset:0
    ds_read_b64_tr_b16 v[232:233], v24 offset:64
    ds_read_b64_tr_b16 v[234:235], v25 offset:64
    ds_read_b64_tr_b16 v[248:249], v26 offset:64
    ds_read_b64_tr_b16 v[250:251], v27 offset:64
    s_waitcnt lgkmcnt(0)
    ds_read_b64_tr_b16 v[204:205], v24 offset:4096
    ds_read_b64_tr_b16 v[206:207], v25 offset:4096
    ds_read_b64_tr_b16 v[220:221], v26 offset:4096
    ds_read_b64_tr_b16 v[222:223], v27 offset:4096
    ds_read_b64_tr_b16 v[236:237], v24 offset:4160
    ds_read_b64_tr_b16 v[238:239], v25 offset:4160
    ds_read_b64_tr_b16 v[252:253], v26 offset:4160
    ds_read_b64_tr_b16 v[254:255], v27 offset:4160
    s_waitcnt lgkmcnt(0)
    v_lshrrev_b32 v21, 4, v20
    v_and_b32 v22, 2, v20
    v_cmp_eq_u32 s[56:57], 2, v22
    v_and_b32 v23, 15, v20
    v_lshlrev_b32 v21, 2, v21
    v_mov_b32 v8, 0x44444444
    v_mov_b32 v9, 0xeeeeeeee
    v_cndmask_b32 v166, v8, v9, s[56:57]
    v_mov_b32 v8, 0x3f803f80
    v_mov_b32 v9, 0
    v_mov_b32 v10, 0
    v_mov_b32 v11, 0
    v_mov_b32 v4, 0x3f803f80
    v_mov_b32 v5, 0x3f803f80
    v_mov_b32 v6, 0x3f803f80
    v_mov_b32 v7, 0x3f803f80
    s_mov_b32 s29, 0x3e0293ee
    s_lshl_b32 s27, s13, 2
    s_add_u32 s27, s27, s21
    s_lshl_b32 s28, s12, 7
    s_add_u32 s28, s28, 218112000
    v_add_u32 v163, s42, v0
    s_lshl_b32 s17, s21, 2
    s_add_u32 s17, s17, 15872
    v_mov_b32 v164, s17
    v_mov_b32 v167, 15872
    v_and_b32 v24, 15, v20
    v_and_b32 v25, 1, v24
    v_lshlrev_b32 v25, 4, v25
    v_mov_b32 v184, 0x3f80
    v_lshlrev_b32 v25, v25, v184
    v_lshrrev_b32 v24, 1, v24
    v_cmp_eq_u32 vcc, 0, v24
    s_nop 1
    v_cndmask_b32 v184, 0, v25, vcc
    v_cmp_eq_u32 vcc, 1, v24
    s_nop 1
    v_cndmask_b32 v185, 0, v25, vcc
    v_cmp_eq_u32 vcc, 2, v24
    s_nop 1
    v_cndmask_b32 v186, 0, v25, vcc
    v_cmp_eq_u32 vcc, 3, v24
    s_nop 1
    v_cndmask_b32 v187, 0, v25, vcc
    v_add_u32 v24, 0, v21
    v_cmp_gt_u32 s[44:45], v24, v23
    v_add_u32 v24, 1, v21
    v_cmp_gt_u32 s[46:47], v24, v23
    v_add_u32 v24, 2, v21
    v_cmp_gt_u32 s[48:49], v24, v23
    v_add_u32 v24, 3, v21
    v_cmp_gt_u32 s[50:51], v24, v23
    s_cmp_lg_u32 s3, 4
    s_cbranch_scc1 ch_xcc_skip
    v_lshrrev_b32 v56, 2, v0
    v_add_u32 v56, 128, v56
    v_writelane_b32 v56, 0, 10
    v_mov_b32 v59, 63
    v_mov_b32 v60, 32
    v_writelane_b32 v59, 0, 8
    v_writelane_b32 v60, 0, 8
    v_writelane_b32 v59, 0, 9
    v_writelane_b32 v60, 0, 9
    v_writelane_b32 v59, -1, 10
    s_movk_i32 s17, 128
    v_writelane_b32 v60, s17, 10
    s_mov_b64 exec, 0x70f
ch_xcc:
    buffer_load_dword v57, v56, s[64:67], 0 offen sc1
    s_waitcnt vmcnt(0)
    v_and_b32 v62, v59, v57
    v_cmp_ne_u32 vcc, v62, v60
    v_readlane_b32 s18, v57, 8
    v_readlane_b32 s19, v57, 9
    s_add_u32 s17, s18, s19
    s_lshr_b32 s17, s17, 24
    s_cmp_lg_u32 s17, 32
    s_cbranch_scc1 ch_xcc_w
    s_cbranch_vccz ch_xcc_ok
ch_xcc_w:
    s_sleep 16
    s_sub_u32 s22, s22, 1
    s_cbranch_scc0 ch_xcc
    s_mov_b32 s22, 0
ch_xcc_ok:
    s_getreg_b32 s17, hwreg(HW_REG_XCC_ID)
    s_bitcmp1_b32 s17, 2
    s_cselect_b32 s18, s18, s18
    v_readlane_b32 s17, v57, s12
    s_mov_b64 exec, -1
    s_lshr_b32 s19, s18, 24
    s_mul_i32 s19, s19, 400
    s_and_b32 s18, s18, 0xffffff
    s_cmp_gt_u32 s18, s19
    s_cselect_b32 s18, 8192, 0
    v_mov_b32 v58, 15968
    v_mov_b32 v60, s17
    v_mov_b32 v61, s18
    s_barrier
    ds_write_b64 v58, v[60:61]
    s_waitcnt lgkmcnt(0)
    s_branch ch_xcc_b3
ch_xcc_skip:
    s_barrier
ch_xcc_b3:
    s_barrier
    v_mov_b32 v58, 15968
    ds_read_b64 v[60:61], v58
    v_and_b32 v23, 7, v20
    v_lshlrev_b32 v23, 7, v23
    v_bfe_u32 v24, v20, 3, 1
    v_lshl_add_u32 v23, v24, 17, v23
    v_lshrrev_b32 v24, 4, v20
    v_lshl_add_u32 v23, v24, 24, v23
    s_lshl_b32 s19, s14, 14
    s_lshl_b32 s18, s34, 10
    s_add_u32 s19, s19, s18
    s_and_b32 s18, s21, 1
    s_lshl_b32 s18, s18, 18
    s_add_u32 s19, s19, s18
    s_add_u32 s19, s19, 4456448
    s_waitcnt lgkmcnt(0)
    v_readfirstlane_b32 s17, v61
    s_add_u32 s39, s39, s17
ch_g0:
    buffer_load_dword v57, off, s[4:7], s35 sc1
    s_waitcnt vmcnt(0)
    v_readfirstlane_b32 s17, v57
    s_cmp_ge_u32 s17, 8
    s_cbranch_scc1 ch_g0b
    s_sleep 12
    s_sub_u32 s22, s22, 1
    s_cbranch_scc0 ch_g0
    s_mov_b32 s22, 0
ch_g0b:
    s_add_u32 s23, s41, 37748736
    buffer_load_dwordx4 v[128:131], v0, s[4:7], s23 offen offset:0 sc1
    buffer_load_dwordx4 v[132:135], v0, s[4:7], s23 offen offset:1024 sc1
    buffer_load_dwordx4 v[136:139], v0, s[4:7], s23 offen offset:2048 sc1
    buffer_load_dwordx4 v[140:143], v0, s[4:7], s23 offen offset:3072 sc1
    s_add_u32 s24, s41, 37879808
    buffer_load_dwordx4 v[144:147], v0, s[4:7], s24 offen offset:0 sc1
    buffer_load_dwordx4 v[148:151], v0, s[4:7], s24 offen offset:1024 sc1
    buffer_load_dwordx4 v[152:155], v0, s[4:7], s24 offen offset:2048 sc1
    buffer_load_dwordx4 v[156:159], v0, s[4:7], s24 offen offset:3072 sc1
    s_add_u32 s23, s41, 20971520
    buffer_load_dwordx4 v[96:99], v0, s[4:7], s23 offen offset:0 sc1
    buffer_load_dwordx4 v[100:103], v0, s[4:7], s23 offen offset:1024 sc1
    buffer_load_dwordx4 v[104:107], v0, s[4:7], s23 offen offset:2048 sc1
    buffer_load_dwordx4 v[108:111], v0, s[4:7], s23 offen offset:3072 sc1
    s_add_u32 s24, s41, 21102592
    buffer_load_dwordx4 v[112:115], v0, s[4:7], s24 offen offset:0 sc1
    buffer_load_dwordx4 v[116:119], v0, s[4:7], s24 offen offset:1024 sc1
    buffer_load_dwordx4 v[120:123], v0, s[4:7], s24 offen offset:2048 sc1
    buffer_load_dwordx4 v[124:127], v0, s[4:7], s24 offen offset:3072 sc1
    s_mov_b32 exec_hi, 0xffff
    buffer_load_dword v175, v23, s[4:7], s19 offen sc1
    s_mov_b32 exec_hi, -1
    v_mov_b32 v165, 0
    s_waitcnt vmcnt(1)
    ds_write_b32 v164, v165 offset:16
.p2align 6
aloopL_19:
    s_and_b32 s23, s16, 3
    s_lshl_b32 s23, s23, 18
    s_add_u32 s23, s23, s38
    s_add_u32 s24, s23, 4096
    s_and_b32 s25, s16, 3
    s_lshl_b32 s25, s25, 18
    s_add_u32 s25, s25, s39
    s_add_u32 s26, s16, 2
    s_and_b32 s26, s26, 3
    s_lshl_b32 s26, s26, 18
    s_add_u32 s26, s26, s39
    v_mov_b32 v165, s16
    v_mfma_f32_16x16x32_bf16 v[48:51], v[128:131], v[192:195], 0
    v_mfma_f32_16x16x32_bf16 v[52:55], v[128:131], v[208:211], 0
    v_mfma_f32_16x16x32_bf16 v[56:59], v[128:131], v[224:227], 0
    v_mfma_f32_16x16x32_bf16 v[60:63], v[128:131], v[240:243], 0
    v_mfma_f32_16x16x32_bf16 v[64:67], v[144:147], v[192:195], 0
    v_mfma_f32_16x16x32_bf16 v[68:71], v[144:147], v[208:211], 0
    v_mfma_f32_16x16x32_bf16 v[72:75], v[144:147], v[224:227], 0
    v_mfma_f32_16x16x32_bf16 v[76:79], v[144:147], v[240:243], 0
    v_mfma_f32_16x16x32_bf16 v[48:51], v[132:135], v[196:199], v[48:51]
    v_mfma_f32_16x16x32_bf16 v[52:55], v[132:135], v[212:215], v[52:55]
    v_mfma_f32_16x16x32_bf16 v[56:59], v[132:135], v[228:231], v[56:59]
    v_mfma_f32_16x16x32_bf16 v[60:63], v[132:135], v[244:247], v[60:63]
    v_mfma_f32_16x16x32_bf16 v[64:67], v[148:151], v[196:199], v[64:67]
    v_mfma_f32_16x16x32_bf16 v[68:71], v[148:151], v[212:215], v[68:71]
    v_mfma_f32_16x16x32_bf16 v[72:75], v[148:151], v[228:231], v[72:75]
    v_mfma_f32_16x16x32_bf16 v[76:79], v[148:151], v[244:247], v[76:79]
    v_mfma_f32_16x16x32_bf16 v[48:51], v[136:139], v[200:203], v[48:51]
    v_mfma_f32_16x16x32_bf16 v[52:55], v[136:139], v[216:219], v[52:55]
    v_mfma_f32_16x16x32_bf16 v[56:59], v[136:139], v[232:235], v[56:59]
    v_mfma_f32_16x16x32_bf16 v[60:63], v[136:139], v[248:251], v[60:63]
    v_mfma_f32_16x16x32_bf16 v[64:67], v[152:155], v[200:203], v[64:67]
    v_mfma_f32_16x16x32_bf16 v[68:71], v[152:155], v[216:219], v[68:71]
    v_mfma_f32_16x16x32_bf16 v[72:75], v[152:155], v[232:235], v[72:75]
    v_mfma_f32_16x16x32_bf16 v[76:79], v[152:155], v[248:251], v[76:79]
    v_mfma_f32_16x16x32_bf16 v[48:51], v[140:143], v[204:207], v[48:51]
    v_mfma_f32_16x16x32_bf16 v[52:55], v[140:143], v[220:223], v[52:55]
    v_mfma_f32_16x16x32_bf16 v[56:59], v[140:143], v[236:239], v[56:59]
    v_mfma_f32_16x16x32_bf16 v[60:63], v[140:143], v[252:255], v[60:63]
    v_mfma_f32_16x16x32_bf16 v[64:67], v[156:159], v[204:207], v[64:67]
    v_mfma_f32_16x16x32_bf16 v[68:71], v[156:159], v[220:223], v[68:71]
    v_mfma_f32_16x16x32_bf16 v[72:75], v[156:159], v[236:239], v[72:75]
    v_mfma_f32_16x16x32_bf16 v[76:79], v[156:159], v[252:255], v[76:79]
    v_mov_b32 v24, 0
    v_mov_b32 v25, 0
    v_mov_b32 v26, 0
    v_mov_b32 v27, 0
    v_mov_b32 v28, 0
    v_mov_b32 v29, 0
    v_mov_b32 v30, 0
    v_mov_b32 v31, 0
    v_mov_b32 v32, 0
    v_mov_b32 v33, 0
    v_mov_b32 v34, 0
    v_mov_b32 v35, 0
    v_mov_b32 v36, 0
    v_mov_b32 v37, 0
    v_mov_b32 v38, 0
    v_mov_b32 v39, 0
    v_cvt_pk_bf16_f32 v80, v48, v49
    v_cvt_pk_bf16_f32 v81, v50, v51
    v_cvt_pk_bf16_f32 v82, v64, v65
    v_cvt_pk_bf16_f32 v83, v66, v67
    v_cvt_pk_bf16_f32 v84, v52, v53
    v_cvt_pk_bf16_f32 v85, v54, v55
    v_cvt_pk_bf16_f32 v86, v68, v69
    v_cvt_pk_bf16_f32 v87, v70, v71
    v_cvt_pk_bf16_f32 v88, v56, v57
    v_cvt_pk_bf16_f32 v89, v58, v59
    v_cvt_pk_bf16_f32 v90, v72, v73
    v_cvt_pk_bf16_f32 v91, v74, v75
    v_cvt_pk_bf16_f32 v92, v60, v61
    v_cvt_pk_bf16_f32 v93, v62, v63
    v_cvt_pk_bf16_f32 v94, v76, v77
    v_cvt_pk_bf16_f32 v95, v78, v79
    s_setprio 2
aloopL_19_wm:
    ds_read_b32 v188, v164 offset:32
    s_waitcnt lgkmcnt(0)
    v_readfirstlane_b32 s19, v188
    s_cmp_ge_i32 s19, s16
    s_cbranch_scc1 aloopL_19_wmok
    s_sleep 1
    s_branch aloopL_19_wm
aloopL_19_wmok:
    s_add_u32 s41, s41, 262144
    s_add_u32 s17, s41, 37748736
    buffer_load_dwordx4 v[128:131], v0, s[4:7], s17 offen offset:0 sc1
    buffer_load_dwordx4 v[132:135], v0, s[4:7], s17 offen offset:1024 sc1
    buffer_load_dwordx4 v[136:139], v0, s[4:7], s17 offen offset:2048 sc1
    buffer_load_dwordx4 v[140:143], v0, s[4:7], s17 offen offset:3072 sc1
    s_add_u32 s18, s41, 37879808
    buffer_load_dwordx4 v[144:147], v0, s[4:7], s18 offen offset:0 sc1
    buffer_load_dwordx4 v[148:151], v0, s[4:7], s18 offen offset:1024 sc1
    buffer_load_dwordx4 v[152:155], v0, s[4:7], s18 offen offset:2048 sc1
    buffer_load_dwordx4 v[156:159], v0, s[4:7], s18 offen offset:3072 sc1
    s_barrier
    s_sleep 9
    s_waitcnt lgkmcnt(0)
    buffer_load_dwordx4 v[48:51], v0, s[4:7], s23 offen offset:0 sc1
    buffer_load_dwordx4 v[52:55], v0, s[4:7], s23 offen offset:1024 sc1
    buffer_load_dwordx4 v[56:59], v0, s[4:7], s23 offen offset:2048 sc1
    buffer_load_dwordx4 v[60:63], v0, s[4:7], s23 offen offset:3072 sc1
    s_sleep 2
    buffer_load_dwordx4 v[64:67], v0, s[4:7], s24 offen offset:0 sc1
    buffer_load_dwordx4 v[68:71], v0, s[4:7], s24 offen offset:1024 sc1
    s_waitcnt vmcnt(5)
    v_mfma_f32_16x16x32_bf16 v[12:15], v[96:99], v[48:51], 0
    v_mfma_f32_16x16x32_bf16 v[16:19], v[112:115], v[48:51], 0
    v_max_u32 v3, v48, v50
    v_cmp_eq_u32 vcc, -1, v3
    v_mfma_f32_16x16x32_bf16 v[20:23], v[48:51], v[48:51], 0
    s_cbranch_vccnz aloopL_19_rq_0
    s_waitcnt vmcnt(4)
    v_mfma_f32_16x16x32_bf16 v[12:15], v[100:103], v[52:55], v[12:15]
    v_mfma_f32_16x16x32_bf16 v[16:19], v[116:119], v[52:55], v[16:19]
    v_max_u32 v3, v52, v54
    v_cmp_eq_u32 vcc, -1, v3
    v_mfma_f32_16x16x32_bf16 v[20:23], v[52:55], v[52:55], v[20:23]
    s_cbranch_vccnz aloopL_19_rq_1
    s_waitcnt vmcnt(3)
    v_mfma_f32_16x16x32_bf16 v[12:15], v[104:107], v[56:59], v[12:15]
    v_mfma_f32_16x16x32_bf16 v[16:19], v[120:123], v[56:59], v[16:19]
    v_max_u32 v3, v56, v58
    v_cmp_eq_u32 vcc, -1, v3
    v_mfma_f32_16x16x32_bf16 v[20:23], v[56:59], v[56:59], v[20:23]
    s_cbranch_vccnz aloopL_19_rq_2
    s_waitcnt vmcnt(2)
    v_mfma_f32_16x16x32_bf16 v[12:15], v[108:111], v[60:63], v[12:15]
    v_mfma_f32_16x16x32_bf16 v[16:19], v[124:127], v[60:63], v[16:19]
    v_max_u32 v3, v60, v62
    v_cmp_eq_u32 vcc, -1, v3
    v_mfma_f32_16x16x32_bf16 v[20:23], v[60:63], v[60:63], v[20:23]
    s_cbranch_vccnz aloopL_19_rq_3
aloopL_19_sdone:
    s_nop 1
    ds_write_b32 v164, v165
    s_nop 0
    v_max3_f32 v2, v12, v13, v14
    v_max3_f32 v3, v15, v16, v17
    v_max3_f32 v2, v2, v18, v19
    v_max3_f32 v3, v3, v20, v21
    v_max_f32 v2, v2, v3
    v_mov_b32 v3, v2
    s_nop 1
    v_permlane16_swap_b32 v3, v2
    v_max_f32 v2, v2, v3
    v_mov_b32 v3, v2
    s_waitcnt vmcnt(0)
    v_max3_u32 v188, v64, v66, v68
    v_permlane32_swap_b32 v3, v2
    v_max_f32 v2, v2, v3
    v_max_u32 v188, v188, v70
    v_mul_f32 v2, s29, v2
    v_cmp_eq_u32 vcc, -1, v188
    v_fma_f32 v12, v12, s29, -v2
    v_fma_f32 v13, v13, s29, -v2
    s_cbranch_vccnz aloopL_19_rq_v
aloopL_19_vok:
    v_smfmac_f32_16x16x64_bf16 v[24:27], v[64:67], v[192:199], v166
    v_fma_f32 v14, v14, s29, -v2
    v_exp_f32 v12, v12
    v_smfmac_f32_16x16x64_bf16 v[32:35], v[64:67], v[224:231], v166
    v_fma_f32 v15, v15, s29, -v2
    v_exp_f32 v13, v13
    v_smfmac_f32_16x16x64_bf16 v[28:31], v[64:67], v[208:215], v166
    v_fma_f32 v16, v16, s29, -v2
    v_exp_f32 v14, v14
    v_smfmac_f32_16x16x64_bf16 v[36:39], v[64:67], v[240:247], v166
    v_fma_f32 v17, v17, s29, -v2
    v_exp_f32 v15, v15
    v_smfmac_f32_16x16x64_bf16 v[24:27], v[68:71], v[200:207], v166
    v_fma_f32 v18, v18, s29, -v2
    v_exp_f32 v16, v16
    v_smfmac_f32_16x16x64_bf16 v[32:35], v[68:71], v[232:239], v166
    v_fma_f32 v19, v19, s29, -v2
    v_exp_f32 v17, v17
    v_smfmac_f32_16x16x64_bf16 v[28:31], v[68:71], v[216:223], v166
    v_fma_f32 v20, v20, s29, -v2
    v_exp_f32 v18, v18
    v_smfmac_f32_16x16x64_bf16 v[36:39], v[68:71], v[248:255], v166
    v_fma_f32 v21, v21, s29, -v2
    v_exp_f32 v19, v19
    v_exp_f32 v20, v20
    v_exp_f32 v21, v21
    v_cvt_pk_bf16_f32 v12, v12, v13
    v_cvt_pk_bf16_f32 v13, v14, v15
    v_cvt_pk_bf16_f32 v14, v16, v17
    v_cvt_pk_bf16_f32 v15, v18, v19
    v_cvt_pk_bf16_f32 v20, v20, v21
    v_mov_b32 v22, 0
    v_mfma_f32_16x16x32_bf16 v[16:19], v[4:7], v[12:15], 0
    v_mov_b32 v21, v20
    v_mov_b32 v23, 0
    v_cvt_pk_bf16_f32 v40, v24, v25
    v_cvt_pk_bf16_f32 v41, v26, v27
    v_mfma_f32_16x16x32_bf16 v[16:19], v[8:11], v[20:23], v[16:19]
    v_mfma_f32_16x16x32_bf16 v[24:27], v[80:83], v[12:15], 0
    v_cvt_pk_bf16_f32 v44, v32, v33
    v_cvt_pk_bf16_f32 v45, v34, v35
    v_mfma_f32_16x16x32_bf16 v[32:35], v[88:91], v[12:15], 0
    v_cvt_pk_bf16_f32 v42, v28, v29
    v_cvt_pk_bf16_f32 v43, v30, v31
    v_mfma_f32_16x16x32_bf16 v[28:31], v[84:87], v[12:15], 0
    v_cvt_pk_bf16_f32 v46, v36, v37
    v_cvt_pk_bf16_f32 v47, v38, v39
    v_mfma_f32_16x16x32_bf16 v[36:39], v[92:95], v[12:15], 0
    s_mov_b64 vcc, s[56:57]
    v_rcp_f32 v3, v16
    v_mfma_f32_16x16x32_bf16 v[24:27], v[40:43], v[20:23], v[24:27]
    v_mfma_f32_16x16x32_bf16 v[32:35], v[44:47], v[20:23], v[32:35]
    v_mfma_f32_16x16x32_bf16 v[28:31], v[42:45], v[20:23], v[28:31]
    v_mfma_f32_16x16x32_bf16 v[36:39], v[46:49], v[20:23], v[36:39]
    v_mov_b32_dpp v3, v3 quad_perm:[2,3,2,3] row_mask:0xf bank_mask:0xf
    s_nop 4
    v_cndmask_b32_dpp v24, v32, v24, vcc quad_perm:[2,3,2,3] row_mask:0xf bank_mask:0xf
    v_cndmask_b32_dpp v25, v33, v25, vcc quad_perm:[2,3,2,3] row_mask:0xf bank_mask:0xf
    v_cndmask_b32_dpp v26, v34, v26, vcc quad_perm:[2,3,2,3] row_mask:0xf bank_mask:0xf
    v_cndmask_b32_dpp v27, v35, v27, vcc quad_perm:[2,3,2,3] row_mask:0xf bank_mask:0xf
    v_cndmask_b32_dpp v28, v36, v28, vcc quad_perm:[2,3,2,3] row_mask:0xf bank_mask:0xf
    v_cndmask_b32_dpp v29, v37, v29, vcc quad_perm:[2,3,2,3] row_mask:0xf bank_mask:0xf
    v_cndmask_b32_dpp v30, v38, v30, vcc quad_perm:[2,3,2,3] row_mask:0xf bank_mask:0xf
    v_cndmask_b32_dpp v31, v39, v31, vcc quad_perm:[2,3,2,3] row_mask:0xf bank_mask:0xf
    v_mul_f32 v24, v24, v3
    v_mul_f32 v25, v25, v3
    v_mul_f32 v26, v26, v3
    v_mul_f32 v27, v27, v3
    v_mul_f32 v28, v28, v3
    v_mul_f32 v29, v29, v3
    v_mul_f32 v30, v30, v3
    v_mul_f32 v31, v31, v3
    v_cvt_pk_bf16_f32 v168, v24, v25
    v_cvt_pk_bf16_f32 v169, v26, v27
    v_cvt_pk_bf16_f32 v170, v28, v29
    v_cvt_pk_bf16_f32 v171, v30, v31
    ds_write_b128 v160, v[168:171]
    s_waitcnt lgkmcnt(0)
    s_barrier
    ds_read_b128 v[172:175], v161
    s_waitcnt lgkmcnt(0)
    v_mfma_f32_16x16x32_bf16 v[24:27], v[184:187], v[172:175], 0
    s_nop 7
    v_cvt_pk_bf16_f32 v168, v24, v25
    v_cvt_pk_bf16_f32 v169, v26, v27
    s_nop 0
    v_permlane16_swap_b32 v168, v170
    v_permlane16_swap_b32 v169, v171
    s_mov_b64 exec, 0xffff
    v_min_u32 v168, -2, v168
    buffer_store_dwordx4 v[168:171], v1, s[4:7], s25 offen sc1
    s_setprio 0
    buffer_store_dwordx4 v[176:179], v1, s[4:7], s26 offen sc1
    s_mov_b64 exec, -1
    s_cmp_lg_u32 s27, 0
    s_cbranch_scc1 pg_20
    s_sub_u32 s21, s16, 1
    s_cbranch_scc1 pg_20
    s_and_b32 s17, s16, 3
    s_cmp_ge_u32 s16, 58
    s_cselect_b32 s17, 0, s17
    s_cmp_lg_u32 s17, 0
    s_cbranch_scc1 pg_20
    v_mov_b32 v3, s21
    s_mov_b64 exec, 1
    buffer_store_dword v3, off, s[4:7], s28 sc1
    s_mov_b64 exec, -1
pg_20:
    s_add_u32 s17, s41, 20971520
    buffer_load_dwordx4 v[96:99], v0, s[4:7], s17 offen offset:0 sc1
    buffer_load_dwordx4 v[100:103], v0, s[4:7], s17 offen offset:1024 sc1
    buffer_load_dwordx4 v[104:107], v0, s[4:7], s17 offen offset:2048 sc1
    buffer_load_dwordx4 v[108:111], v0, s[4:7], s17 offen offset:3072 sc1
    s_add_u32 s18, s41, 21102592
    buffer_load_dwordx4 v[112:115], v0, s[4:7], s18 offen offset:0 sc1
    buffer_load_dwordx4 v[116:119], v0, s[4:7], s18 offen offset:1024 sc1
    buffer_load_dwordx4 v[120:123], v0, s[4:7], s18 offen offset:2048 sc1
    buffer_load_dwordx4 v[124:127], v0, s[4:7], s18 offen offset:3072 sc1
    s_add_u32 s16, s16, 1
    s_cmp_lt_u32 s16, 48
    s_cbranch_scc1 aloopL_19
    s_waitcnt vmcnt(0)
    ds_write_b128 v163, v[128:131] offset:8192
    ds_write_b128 v163, v[96:99] offset:0
    ds_write_b128 v163, v[132:135] offset:9216
    ds_write_b128 v163, v[100:103] offset:1024
    ds_write_b128 v163, v[136:139] offset:10240
    ds_write_b128 v163, v[104:107] offset:2048
    ds_write_b128 v163, v[140:143] offset:11264
    ds_write_b128 v163, v[108:111] offset:3072
    ds_write_b128 v163, v[144:147] offset:12288
    ds_write_b128 v163, v[112:115] offset:4096
    ds_write_b128 v163, v[148:151] offset:13312
    ds_write_b128 v163, v[116:119] offset:5120
    ds_write_b128 v163, v[152:155] offset:14336
    ds_write_b128 v163, v[120:123] offset:6144
    ds_write_b128 v163, v[156:159] offset:15360
    ds_write_b128 v163, v[124:127] offset:7168
    s_waitcnt lgkmcnt(0)
    s_branch aloopH_18
aloopL_19_rq_0:
    s_sub_u32 s22, s22, 1
    s_cbranch_scc1 aloopL_19_rq_0_g
    buffer_load_dwordx4 v[48:51], v0, s[4:7], s23 offen offset:0 sc1
    buffer_load_dwordx4 v[52:55], v0, s[4:7], s23 offen offset:1024 sc1
    buffer_load_dwordx4 v[56:59], v0, s[4:7], s23 offen offset:2048 sc1
    buffer_load_dwordx4 v[60:63], v0, s[4:7], s23 offen offset:3072 sc1
    buffer_load_dwordx4 v[64:67], v0, s[4:7], s24 offen offset:0 sc1
    buffer_load_dwordx4 v[68:71], v0, s[4:7], s24 offen offset:1024 sc1
    s_waitcnt vmcnt(5)
    v_max_u32 v3, v48, v50
    v_cmp_eq_u32 vcc, -1, v3
    s_cbranch_vccnz aloopL_19_rq_0
    s_branch aloopL_19_again
aloopL_19_rq_0_g:
    s_mov_b32 s22, 0
    s_waitcnt vmcnt(0)
    s_branch aloopL_19_nochk
aloopL_19_rq_1:
    s_sub_u32 s22, s22, 1
    s_cbranch_scc1 aloopL_19_rq_1_g
    buffer_load_dwordx4 v[52:55], v0, s[4:7], s23 offen offset:1024 sc1
    buffer_load_dwordx4 v[56:59], v0, s[4:7], s23 offen offset:2048 sc1
    buffer_load_dwordx4 v[60:63], v0, s[4:7], s23 offen offset:3072 sc1
    buffer_load_dwordx4 v[64:67], v0, s[4:7], s24 offen offset:0 sc1
    buffer_load_dwordx4 v[68:71], v0, s[4:7], s24 offen offset:1024 sc1
    s_waitcnt vmcnt(4)
    v_max_u32 v3, v52, v54
    v_cmp_eq_u32 vcc, -1, v3
    s_cbranch_vccnz aloopL_19_rq_1
    s_branch aloopL_19_again
aloopL_19_rq_1_g:
    s_mov_b32 s22, 0
    s_waitcnt vmcnt(0)
    s_branch aloopL_19_nochk
aloopL_19_rq_2:
    s_sub_u32 s22, s22, 1
    s_cbranch_scc1 aloopL_19_rq_2_g
    buffer_load_dwordx4 v[56:59], v0, s[4:7], s23 offen offset:2048 sc1
    buffer_load_dwordx4 v[60:63], v0, s[4:7], s23 offen offset:3072 sc1
    buffer_load_dwordx4 v[64:67], v0, s[4:7], s24 offen offset:0 sc1
    buffer_load_dwordx4 v[68:71], v0, s[4:7], s24 offen offset:1024 sc1
    s_waitcnt vmcnt(3)
    v_max_u32 v3, v56, v58
    v_cmp_eq_u32 vcc, -1, v3
    s_cbranch_vccnz aloopL_19_rq_2
    s_branch aloopL_19_again
aloopL_19_rq_2_g:
    s_mov_b32 s22, 0
    s_waitcnt vmcnt(0)
    s_branch aloopL_19_nochk
aloopL_19_rq_3:
    s_sub_u32 s22, s22, 1
    s_cbranch_scc1 aloopL_19_rq_3_g
    buffer_load_dwordx4 v[60:63], v0, s[4:7], s23 offen offset:3072 sc1
    buffer_load_dwordx4 v[64:67], v0, s[4:7], s24 offen offset:0 sc1
    buffer_load_dwordx4 v[68:71], v0, s[4:7], s24 offen offset:1024 sc1
    s_waitcnt vmcnt(2)
    v_max_u32 v3, v60, v62
    v_cmp_eq_u32 vcc, -1, v3
    s_cbranch_vccnz aloopL_19_rq_3
    s_branch aloopL_19_again
aloopL_19_rq_3_g:
    s_mov_b32 s22, 0
    s_waitcnt vmcnt(0)
    s_branch aloopL_19_nochk
aloopL_19_again:
    s_waitcnt vmcnt(5)
    v_mfma_f32_16x16x32_bf16 v[12:15], v[96:99], v[48:51], 0
    v_mfma_f32_16x16x32_bf16 v[16:19], v[112:115], v[48:51], 0
    v_max_u32 v3, v48, v50
    v_cmp_eq_u32 vcc, -1, v3
    v_mfma_f32_16x16x32_bf16 v[20:23], v[48:51], v[48:51], 0
    s_cbranch_vccnz aloopL_19_rq_0
    s_waitcnt vmcnt(4)
    v_mfma_f32_16x16x32_bf16 v[12:15], v[100:103], v[52:55], v[12:15]
    v_mfma_f32_16x16x32_bf16 v[16:19], v[116:119], v[52:55], v[16:19]
    v_max_u32 v3, v52, v54
    v_cmp_eq_u32 vcc, -1, v3
    v_mfma_f32_16x16x32_bf16 v[20:23], v[52:55], v[52:55], v[20:23]
    s_cbranch_vccnz aloopL_19_rq_1
    s_waitcnt vmcnt(3)
    v_mfma_f32_16x16x32_bf16 v[12:15], v[104:107], v[56:59], v[12:15]
    v_mfma_f32_16x16x32_bf16 v[16:19], v[120:123], v[56:59], v[16:19]
    v_max_u32 v3, v56, v58
    v_cmp_eq_u32 vcc, -1, v3
    v_mfma_f32_16x16x32_bf16 v[20:23], v[56:59], v[56:59], v[20:23]
    s_cbranch_vccnz aloopL_19_rq_2
    s_waitcnt vmcnt(2)
    v_mfma_f32_16x16x32_bf16 v[12:15], v[108:111], v[60:63], v[12:15]
    v_mfma_f32_16x16x32_bf16 v[16:19], v[124:127], v[60:63], v[16:19]
    v_max_u32 v3, v60, v62
    v_cmp_eq_u32 vcc, -1, v3
    v_mfma_f32_16x16x32_bf16 v[20:23], v[60:63], v[60:63], v[20:23]
    s_cbranch_vccnz aloopL_19_rq_3
    s_branch aloopL_19_sdone
aloopL_19_rq_v:
    s_sub_u32 s22, s22, 1
    s_cbranch_scc1 aloopL_19_rq_vg
    buffer_load_dwordx4 v[64:67], v0, s[4:7], s24 offen offset:0 sc1
    buffer_load_dwordx4 v[68:71], v0, s[4:7], s24 offen offset:1024 sc1
    s_waitcnt vmcnt(0)
    v_max3_u32 v188, v64, v66, v68
    v_max_u32 v188, v188, v70
    v_cmp_eq_u32 vcc, -1, v188
    s_cbranch_vccnz aloopL_19_rq_v
    s_branch aloopL_19_vok
aloopL_19_rq_vg:
    s_mov_b32 s22, 0
    s_branch aloopL_19_vok
aloopL_19_nochk:
    v_mfma_f32_16x16x32_bf16 v[12:15], v[96:99], v[48:51], 0
    v_mfma_f32_16x16x32_bf16 v[16:19], v[112:115], v[48:51], 0
    v_mfma_f32_16x16x32_bf16 v[20:23], v[48:51], v[48:51], 0
    v_mfma_f32_16x16x32_bf16 v[12:15], v[100:103], v[52:55], v[12:15]
    v_mfma_f32_16x16x32_bf16 v[16:19], v[116:119], v[52:55], v[16:19]
    v_mfma_f32_16x16x32_bf16 v[20:23], v[52:55], v[52:55], v[20:23]
    v_mfma_f32_16x16x32_bf16 v[12:15], v[104:107], v[56:59], v[12:15]
    v_mfma_f32_16x16x32_bf16 v[16:19], v[120:123], v[56:59], v[16:19]
    v_mfma_f32_16x16x32_bf16 v[20:23], v[56:59], v[56:59], v[20:23]
    v_mfma_f32_16x16x32_bf16 v[12:15], v[108:111], v[60:63], v[12:15]
    v_mfma_f32_16x16x32_bf16 v[16:19], v[124:127], v[60:63], v[16:19]
    v_mfma_f32_16x16x32_bf16 v[20:23], v[60:63], v[60:63], v[20:23]
    s_nop 1
    s_branch aloopL_19_sdone
.p2align 6
aloopH_18:
    s_and_b32 s23, s16, 3
    s_lshl_b32 s23, s23, 18
    s_add_u32 s23, s23, s38
    s_add_u32 s24, s23, 4096
    s_and_b32 s25, s16, 3
    s_lshl_b32 s25, s25, 18
    s_add_u32 s25, s25, s39
    s_add_u32 s26, s16, 2
    s_and_b32 s26, s26, 3
    s_lshl_b32 s26, s26, 18
    s_add_u32 s26, s26, s39
    v_mov_b32 v165, s16
aloopH_18_wkv:
    ds_read_b32 v188, v164 offset:16
    s_waitcnt lgkmcnt(0)
    v_readfirstlane_b32 s19, v188
    s_cmp_ge_i32 s19, s16
    s_cbranch_scc1 aloopH_18_wkvok
    s_sleep 1
    s_branch aloopH_18_wkv
aloopH_18_wkvok:
    ds_read_b128 v[128:131], v163 offset:8192
    ds_read_b128 v[144:147], v163 offset:12288
    ds_read_b128 v[132:135], v163 offset:9216
    ds_read_b128 v[148:151], v163 offset:13312
    ds_read_b128 v[136:139], v163 offset:10240
    ds_read_b128 v[152:155], v163 offset:14336
    ds_read_b128 v[140:143], v163 offset:11264
    ds_read_b128 v[156:159], v163 offset:15360
    ds_read_b128 v[96:99], v163 offset:0
    ds_read_b128 v[100:103], v163 offset:1024
    ds_read_b128 v[104:107], v163 offset:2048
    ds_read_b128 v[108:111], v163 offset:3072
    ds_read_b128 v[112:115], v163 offset:4096
    ds_read_b128 v[116:119], v163 offset:5120
    ds_read_b128 v[120:123], v163 offset:6144
    ds_read_b128 v[124:127], v163 offset:7168
    s_waitcnt lgkmcnt(14)
    v_mfma_f32_16x16x32_bf16 v[48:51], v[128:131], v[192:195], 0
    v_mfma_f32_16x16x32_bf16 v[52:55], v[128:131], v[208:211], 0
    v_mfma_f32_16x16x32_bf16 v[56:59], v[128:131], v[224:227], 0
    v_mfma_f32_16x16x32_bf16 v[60:63], v[128:131], v[240:243], 0
    v_mfma_f32_16x16x32_bf16 v[64:67], v[144:147], v[192:195], 0
    v_mfma_f32_16x16x32_bf16 v[68:71], v[144:147], v[208:211], 0
    v_mfma_f32_16x16x32_bf16 v[72:75], v[144:147], v[224:227], 0
    v_mfma_f32_16x16x32_bf16 v[76:79], v[144:147], v[240:243], 0
    s_setprio 2
aloopH_18_wm:
    ds_read_b32 v188, v164 offset:32
    s_waitcnt lgkmcnt(0)
    v_readfirstlane_b32 s19, v188
    s_cmp_ge_i32 s19, s16
    s_cbranch_scc1 aloopH_18_wmok
    s_sleep 1
    s_branch aloopH_18_wm
aloopH_18_wmok:
    s_add_u32 m0, s42, 16384
    s_add_u32 s17, s41, 4194304
    buffer_load_dwordx4 v0, s[4:7], s17 offen offset:0 sc1 lds
    buffer_load_dwordx4 v0, s[4:7], s17 offen offset:1024 sc1 lds
    buffer_load_dwordx4 v0, s[4:7], s17 offen offset:2048 sc1 lds
    buffer_load_dwordx4 v0, s[4:7], s17 offen offset:3072 sc1 lds
    s_add_u32 m0, s42, 20480
    s_add_u32 s17, s41, 4325376
    buffer_load_dwordx4 v0, s[4:7], s17 offen offset:0 sc1 lds
    buffer_load_dwordx4 v0, s[4:7], s17 offen offset:1024 sc1 lds
    buffer_load_dwordx4 v0, s[4:7], s17 offen offset:2048 sc1 lds
    buffer_load_dwordx4 v0, s[4:7], s17 offen offset:3072 sc1 lds
    s_add_u32 s41, s41, 262144
    s_barrier
    s_waitcnt lgkmcnt(12)
    v_mfma_f32_16x16x32_bf16 v[48:51], v[132:135], v[196:199], v[48:51]
    v_mfma_f32_16x16x32_bf16 v[52:55], v[132:135], v[212:215], v[52:55]
    v_mfma_f32_16x16x32_bf16 v[56:59], v[132:135], v[228:231], v[56:59]
    v_mfma_f32_16x16x32_bf16 v[60:63], v[132:135], v[244:247], v[60:63]
    v_mfma_f32_16x16x32_bf16 v[64:67], v[148:151], v[196:199], v[64:67]
    v_mfma_f32_16x16x32_bf16 v[68:71], v[148:151], v[212:215], v[68:71]
    v_mfma_f32_16x16x32_bf16 v[72:75], v[148:151], v[228:231], v[72:75]
    v_mfma_f32_16x16x32_bf16 v[76:79], v[148:151], v[244:247], v[76:79]
    s_waitcnt lgkmcnt(10)
    v_mfma_f32_16x16x32_bf16 v[48:51], v[136:139], v[200:203], v[48:51]
    v_mfma_f32_16x16x32_bf16 v[52:55], v[136:139], v[216:219], v[52:55]
    v_mfma_f32_16x16x32_bf16 v[56:59], v[136:139], v[232:235], v[56:59]
    v_mfma_f32_16x16x32_bf16 v[60:63], v[136:139], v[248:251], v[60:63]
    v_mfma_f32_16x16x32_bf16 v[64:67], v[152:155], v[200:203], v[64:67]
    v_mfma_f32_16x16x32_bf16 v[68:71], v[152:155], v[216:219], v[68:71]
    v_mfma_f32_16x16x32_bf16 v[72:75], v[152:155], v[232:235], v[72:75]
    v_mfma_f32_16x16x32_bf16 v[76:79], v[152:155], v[248:251], v[76:79]
    s_waitcnt lgkmcnt(8)
    v_mfma_f32_16x16x32_bf16 v[48:51], v[140:143], v[204:207], v[48:51]
    v_mfma_f32_16x16x32_bf16 v[52:55], v[140:143], v[220:223], v[52:55]
    v_mfma_f32_16x16x32_bf16 v[56:59], v[140:143], v[236:239], v[56:59]
    v_mfma_f32_16x16x32_bf16 v[60:63], v[140:143], v[252:255], v[60:63]
    v_mfma_f32_16x16x32_bf16 v[64:67], v[156:159], v[204:207], v[64:67]
    v_mfma_f32_16x16x32_bf16 v[68:71], v[156:159], v[220:223], v[68:71]
    v_mfma_f32_16x16x32_bf16 v[72:75], v[156:159], v[236:239], v[72:75]
    v_mfma_f32_16x16x32_bf16 v[76:79], v[156:159], v[252:255], v[76:79]
    s_nop 2
    v_cvt_pk_bf16_f32 v80, v48, v49
    v_cvt_pk_bf16_f32 v81, v50, v51
    v_cvt_pk_bf16_f32 v82, v64, v65
    v_cvt_pk_bf16_f32 v83, v66, v67
    v_cvt_pk_bf16_f32 v84, v52, v53
    v_cvt_pk_bf16_f32 v85, v54, v55
    v_cvt_pk_bf16_f32 v86, v68, v69
    v_cvt_pk_bf16_f32 v87, v70, v71
    v_cvt_pk_bf16_f32 v88, v56, v57
    v_cvt_pk_bf16_f32 v89, v58, v59
    v_cvt_pk_bf16_f32 v90, v72, v73
    v_cvt_pk_bf16_f32 v91, v74, v75
    v_cvt_pk_bf16_f32 v92, v60, v61
    v_cvt_pk_bf16_f32 v93, v62, v63
    v_cvt_pk_bf16_f32 v94, v76, v77
    v_cvt_pk_bf16_f32 v95, v78, v79
    v_mov_b32 v24, 0
    v_mov_b32 v25, 0
    v_mov_b32 v26, 0
    v_mov_b32 v27, 0
    v_mov_b32 v28, 0
    v_mov_b32 v29, 0
    v_mov_b32 v30, 0
    v_mov_b32 v31, 0
    v_mov_b32 v32, 0
    v_mov_b32 v33, 0
    v_mov_b32 v34, 0
    v_mov_b32 v35, 0
    v_mov_b32 v36, 0
    v_mov_b32 v37, 0
    v_mov_b32 v38, 0
    v_mov_b32 v39, 0
    s_waitcnt lgkmcnt(0)
    buffer_load_dwordx4 v[48:51], v0, s[4:7], s23 offen offset:0 sc1
    buffer_load_dwordx4 v[52:55], v0, s[4:7], s23 offen offset:1024 sc1
    buffer_load_dwordx4 v[56:59], v0, s[4:7], s23 offen offset:2048 sc1
    buffer_load_dwordx4 v[60:63], v0, s[4:7], s23 offen offset:3072 sc1
    s_sleep 2
    buffer_load_dwordx4 v[64:67], v0, s[4:7], s24 offen offset:0 sc1
    buffer_load_dwordx4 v[68:71], v0, s[4:7], s24 offen offset:1024 sc1
    s_waitcnt vmcnt(5)
    v_mfma_f32_16x16x32_bf16 v[12:15], v[96:99], v[48:51], 0
    v_mfma_f32_16x16x32_bf16 v[16:19], v[112:115], v[48:51], 0
    v_max_u32 v3, v48, v50
    v_cmp_eq_u32 vcc, -1, v3
    v_mfma_f32_16x16x32_bf16 v[20:23], v[48:51], v[48:51], 0
    s_cbranch_vccnz aloopH_18_rq_0
    s_waitcnt vmcnt(4)
    v_mfma_f32_16x16x32_bf16 v[12:15], v[100:103], v[52:55], v[12:15]
    v_mfma_f32_16x16x32_bf16 v[16:19], v[116:119], v[52:55], v[16:19]
    v_max_u32 v3, v52, v54
    v_cmp_eq_u32 vcc, -1, v3
    v_mfma_f32_16x16x32_bf16 v[20:23], v[52:55], v[52:55], v[20:23]
    s_cbranch_vccnz aloopH_18_rq_1
    s_waitcnt vmcnt(3)
    v_mfma_f32_16x16x32_bf16 v[12:15], v[104:107], v[56:59], v[12:15]
    v_mfma_f32_16x16x32_bf16 v[16:19], v[120:123], v[56:59], v[16:19]
    v_max_u32 v3, v56, v58
    v_cmp_eq_u32 vcc, -1, v3
    v_mfma_f32_16x16x32_bf16 v[20:23], v[56:59], v[56:59], v[20:23]
    s_cbranch_vccnz aloopH_18_rq_2
    s_waitcnt vmcnt(2)
    v_mfma_f32_16x16x32_bf16 v[12:15], v[108:111], v[60:63], v[12:15]
    v_mfma_f32_16x16x32_bf16 v[16:19], v[124:127], v[60:63], v[16:19]
    v_max_u32 v3, v60, v62
    v_cmp_eq_u32 vcc, -1, v3
    v_mfma_f32_16x16x32_bf16 v[20:23], v[60:63], v[60:63], v[20:23]
    s_cbranch_vccnz aloopH_18_rq_3
aloopH_18_sdone:
    s_cmp_eq_u32 s16, 63
    s_cbranch_scc1 aloopH_18_lsk
    ds_write_b32 v164, v165
    s_nop 0
    v_max3_f32 v2, v12, v13, v14
    v_max3_f32 v3, v15, v16, v17
    v_max3_f32 v2, v2, v18, v19
    v_max3_f32 v3, v3, v20, v21
    v_max_f32 v2, v2, v3
    v_mov_b32 v3, v2
    s_nop 1
    v_permlane16_swap_b32 v3, v2
    v_max_f32 v2, v2, v3
    v_mov_b32 v3, v2
    s_waitcnt vmcnt(0)
    v_max3_u32 v188, v64, v66, v68
    v_permlane32_swap_b32 v3, v2
    v_max_f32 v2, v2, v3
    v_max_u32 v188, v188, v70
    v_mul_f32 v2, s29, v2
    v_cmp_eq_u32 vcc, -1, v188
    v_fma_f32 v12, v12, s29, -v2
    v_fma_f32 v13, v13, s29, -v2
    s_cbranch_vccnz aloopH_18_rq_v
aloopH_18_vok:
    v_smfmac_f32_16x16x64_bf16 v[24:27], v[64:67], v[192:199], v166
    v_fma_f32 v14, v14, s29, -v2
    v_exp_f32 v12, v12
    v_smfmac_f32_16x16x64_bf16 v[32:35], v[64:67], v[224:231], v166
    v_fma_f32 v15, v15, s29, -v2
    v_exp_f32 v13, v13
    v_smfmac_f32_16x16x64_bf16 v[28:31], v[64:67], v[208:215], v166
    v_fma_f32 v16, v16, s29, -v2
    v_exp_f32 v14, v14
    v_smfmac_f32_16x16x64_bf16 v[36:39], v[64:67], v[240:247], v166
    v_fma_f32 v17, v17, s29, -v2
    v_exp_f32 v15, v15
    v_smfmac_f32_16x16x64_bf16 v[24:27], v[68:71], v[200:207], v166
    v_fma_f32 v18, v18, s29, -v2
    v_exp_f32 v16, v16
    v_smfmac_f32_16x16x64_bf16 v[32:35], v[68:71], v[232:239], v166
    v_fma_f32 v19, v19, s29, -v2
    v_exp_f32 v17, v17
    v_smfmac_f32_16x16x64_bf16 v[28:31], v[68:71], v[216:223], v166
    v_fma_f32 v20, v20, s29, -v2
    v_exp_f32 v18, v18
    v_smfmac_f32_16x16x64_bf16 v[36:39], v[68:71], v[248:255], v166
    v_fma_f32 v21, v21, s29, -v2
    v_exp_f32 v19, v19
    v_exp_f32 v20, v20
    v_exp_f32 v21, v21
    v_cvt_pk_bf16_f32 v12, v12, v13
    v_cvt_pk_bf16_f32 v13, v14, v15
    v_cvt_pk_bf16_f32 v14, v16, v17
    v_cvt_pk_bf16_f32 v15, v18, v19
    v_cvt_pk_bf16_f32 v20, v20, v21
    v_mov_b32 v22, 0
    v_mfma_f32_16x16x32_bf16 v[16:19], v[4:7], v[12:15], 0
    v_mov_b32 v21, v20
    v_mov_b32 v23, 0
    v_cvt_pk_bf16_f32 v40, v24, v25
    v_cvt_pk_bf16_f32 v41, v26, v27
    v_mfma_f32_16x16x32_bf16 v[16:19], v[8:11], v[20:23], v[16:19]
    v_mfma_f32_16x16x32_bf16 v[24:27], v[80:83], v[12:15], 0
    v_cvt_pk_bf16_f32 v44, v32, v33
    v_cvt_pk_bf16_f32 v45, v34, v35
    v_mfma_f32_16x16x32_bf16 v[32:35], v[88:91], v[12:15], 0
    v_cvt_pk_bf16_f32 v42, v28, v29
    v_cvt_pk_bf16_f32 v43, v30, v31
    v_mfma_f32_16x16x32_bf16 v[28:31], v[84:87], v[12:15], 0
    v_cvt_pk_bf16_f32 v46, v36, v37
    v_cvt_pk_bf16_f32 v47, v38, v39
    v_mfma_f32_16x16x32_bf16 v[36:39], v[92:95], v[12:15], 0
    s_mov_b64 vcc, s[56:57]
    v_rcp_f32 v3, v16
    v_mfma_f32_16x16x32_bf16 v[24:27], v[40:43], v[20:23], v[24:27]
    v_mfma_f32_16x16x32_bf16 v[32:35], v[44:47], v[20:23], v[32:35]
    v_mfma_f32_16x16x32_bf16 v[28:31], v[42:45], v[20:23], v[28:31]
    v_mfma_f32_16x16x32_bf16 v[36:39], v[46:49], v[20:23], v[36:39]
    v_mov_b32_dpp v3, v3 quad_perm:[2,3,2,3] row_mask:0xf bank_mask:0xf
    s_nop 4
    v_cndmask_b32_dpp v24, v32, v24, vcc quad_perm:[2,3,2,3] row_mask:0xf bank_mask:0xf
    v_cndmask_b32_dpp v25, v33, v25, vcc quad_perm:[2,3,2,3] row_mask:0xf bank_mask:0xf
    v_cndmask_b32_dpp v26, v34, v26, vcc quad_perm:[2,3,2,3] row_mask:0xf bank_mask:0xf
    v_cndmask_b32_dpp v27, v35, v27, vcc quad_perm:[2,3,2,3] row_mask:0xf bank_mask:0xf
    v_cndmask_b32_dpp v28, v36, v28, vcc quad_perm:[2,3,2,3] row_mask:0xf bank_mask:0xf
    v_cndmask_b32_dpp v29, v37, v29, vcc quad_perm:[2,3,2,3] row_mask:0xf bank_mask:0xf
    v_cndmask_b32_dpp v30, v38, v30, vcc quad_perm:[2,3,2,3] row_mask:0xf bank_mask:0xf
    v_cndmask_b32_dpp v31, v39, v31, vcc quad_perm:[2,3,2,3] row_mask:0xf bank_mask:0xf
    v_mul_f32 v24, v24, v3
    v_mul_f32 v25, v25, v3
    v_mul_f32 v26, v26, v3
    v_mul_f32 v27, v27, v3
    v_mul_f32 v28, v28, v3
    v_mul_f32 v29, v29, v3
    v_mul_f32 v30, v30, v3
    v_mul_f32 v31, v31, v3
    v_cvt_pk_bf16_f32 v168, v24, v25
    v_cvt_pk_bf16_f32 v169, v26, v27
    v_cvt_pk_bf16_f32 v170, v28, v29
    v_cvt_pk_bf16_f32 v171, v30, v31
    ds_write_b128 v160, v[168:171]
    s_waitcnt lgkmcnt(0)
    s_barrier
    ds_read_b128 v[172:175], v161
    s_waitcnt lgkmcnt(0)
    v_mfma_f32_16x16x32_bf16 v[24:27], v[184:187], v[172:175], 0
    s_nop 7
    v_cvt_pk_bf16_f32 v168, v24, v25
    v_cvt_pk_bf16_f32 v169, v26, v27
    s_nop 0
    v_permlane16_swap_b32 v168, v170
    v_permlane16_swap_b32 v169, v171
    s_mov_b64 exec, 0xffff
    v_min_u32 v168, -2, v168
    buffer_store_dwordx4 v[168:171], v1, s[4:7], s25 offen sc1
    s_setprio 0
    buffer_store_dwordx4 v[176:179], v1, s[4:7], s26 offen sc1
    s_mov_b64 exec, -1
    s_cmp_lg_u32 s27, 0
    s_cbranch_scc1 pg_21
    s_sub_u32 s21, s16, 1
    s_cbranch_scc1 pg_21
    s_and_b32 s17, s16, 3
    s_cmp_ge_u32 s16, 58
    s_cselect_b32 s17, 0, s17
    s_cmp_lg_u32 s17, 0
    s_cbranch_scc1 pg_21
    v_mov_b32 v3, s21
    s_mov_b64 exec, 1
    buffer_store_dword v3, off, s[4:7], s28 sc1
    s_mov_b64 exec, -1
pg_21:
aloopH_18_lskb:
    v_mov_b32 v64, 0xff61b1e6
    ds_read_b128 v[128:131], v163 offset:16384
    ds_read_b128 v[132:135], v163 offset:17408
    ds_read_b128 v[136:139], v163 offset:18432
    ds_read_b128 v[140:143], v163 offset:19456
    ds_read_b128 v[144:147], v163 offset:20480
    ds_read_b128 v[148:151], v163 offset:21504
    ds_read_b128 v[152:155], v163 offset:22528
    ds_read_b128 v[156:159], v163 offset:23552
    s_waitcnt lgkmcnt(4)
    v_mfma_f32_16x16x32_bf16 v[12:15], v[96:99], v[128:131], 0
    v_mfma_f32_16x16x32_bf16 v[20:23], v[48:51], v[128:131], 0
    v_mfma_f32_16x16x32_bf16 v[12:15], v[100:103], v[132:135], v[12:15]
    v_mfma_f32_16x16x32_bf16 v[20:23], v[52:55], v[132:135], v[20:23]
    v_mfma_f32_16x16x32_bf16 v[12:15], v[104:107], v[136:139], v[12:15]
    v_mfma_f32_16x16x32_bf16 v[20:23], v[56:59], v[136:139], v[20:23]
    v_mfma_f32_16x16x32_bf16 v[12:15], v[108:111], v[140:143], v[12:15]
    v_mfma_f32_16x16x32_bf16 v[20:23], v[60:63], v[140:143], v[20:23]
    s_waitcnt lgkmcnt(0)
    v_mfma_f32_16x16x32_bf16 v[68:71], v[96:99], v[144:147], 0
    v_mfma_f32_16x16x32_bf16 v[72:75], v[112:115], v[144:147], 0
    v_mfma_f32_16x16x32_bf16 v[76:79], v[48:51], v[144:147], 0
    v_mfma_f32_16x16x32_bf16 v[68:71], v[100:103], v[148:151], v[68:71]
    v_mfma_f32_16x16x32_bf16 v[72:75], v[116:119], v[148:151], v[72:75]
    v_mfma_f32_16x16x32_bf16 v[76:79], v[52:55], v[148:151], v[76:79]
    v_mfma_f32_16x16x32_bf16 v[68:71], v[104:107], v[152:155], v[68:71]
    v_mfma_f32_16x16x32_bf16 v[72:75], v[120:123], v[152:155], v[72:75]
    v_mfma_f32_16x16x32_bf16 v[76:79], v[56:59], v[152:155], v[76:79]
    v_mfma_f32_16x16x32_bf16 v[68:71], v[108:111], v[156:159], v[68:71]
    v_mfma_f32_16x16x32_bf16 v[72:75], v[124:127], v[156:159], v[72:75]
    v_mfma_f32_16x16x32_bf16 v[76:79], v[60:63], v[156:159], v[76:79]
    v_cndmask_b32 v12, v12, v64, s[44:45]
    v_cndmask_b32 v13, v13, v64, s[46:47]
    v_cndmask_b32 v14, v14, v64, s[48:49]
    v_cndmask_b32 v15, v15, v64, s[50:51]
    v_max3_f32 v2, v12, v13, v14
    v_max3_f32 v3, v15, v20, v21
    v_max_f32 v2, v2, v3
    v_mov_b32 v3, v2
    s_nop 1
    v_permlane16_swap_b32 v3, v2
    v_max_f32 v2, v2, v3
    v_mov_b32 v3, v2
    s_nop 1
    v_permlane32_swap_b32 v3, v2
    v_max_f32 v2, v2, v3
    v_mul_f32 v2, s29, v2
    v_fma_f32 v12, v12, s29, -v2
    v_fma_f32 v13, v13, s29, -v2
    v_fma_f32 v14, v14, s29, -v2
    v_exp_f32 v12, v12
    v_fma_f32 v15, v15, s29, -v2
    v_exp_f32 v13, v13
    v_fma_f32 v20, v20, s29, -v2
    v_exp_f32 v14, v14
    v_fma_f32 v21, v21, s29, -v2
    v_exp_f32 v15, v15
    v_exp_f32 v20, v20
    v_exp_f32 v21, v21
    v_cvt_pk_bf16_f32 v12, v12, v13
    v_cvt_pk_bf16_f32 v13, v14, v15
    v_mov_b32 v14, 0
    v_mov_b32 v15, 0
    v_cvt_pk_bf16_f32 v20, v20, v21
    v_mov_b32 v22, 0
    v_mov_b32 v21, v20
    v_mov_b32 v23, 0
    s_nop 1
    v_cndmask_b32 v72, v72, v64, s[44:45]
    v_mfma_f32_16x16x32_bf16 v[16:19], v[4:7], v[12:15], 0
    v_cndmask_b32 v73, v73, v64, s[46:47]
    v_cndmask_b32 v74, v74, v64, s[48:49]
    v_mfma_f32_16x16x32_bf16 v[16:19], v[8:11], v[20:23], v[16:19]
    v_cndmask_b32 v75, v75, v64, s[50:51]
    v_max3_f32 v2, v68, v69, v70
    v_mfma_f32_16x16x32_bf16 v[24:27], v[80:83], v[12:15], 0
    v_max3_f32 v3, v71, v72, v73
    v_max3_f32 v2, v2, v74, v75
    v_mfma_f32_16x16x32_bf16 v[24:27], v[40:43], v[20:23], v[24:27]
    v_max3_f32 v3, v3, v76, v77
    v_max_f32 v2, v2, v3
    v_mfma_f32_16x16x32_bf16 v[28:31], v[84:87], v[12:15], 0
    v_mov_b32 v3, v2
    s_nop 1
    v_mfma_f32_16x16x32_bf16 v[28:31], v[42:45], v[20:23], v[28:31]
    v_permlane16_swap_b32 v3, v2
    v_max_f32 v2, v2, v3
    v_mfma_f32_16x16x32_bf16 v[32:35], v[88:91], v[12:15], 0
    v_mov_b32 v3, v2
    s_nop 1
    v_mfma_f32_16x16x32_bf16 v[32:35], v[44:47], v[20:23], v[32:35]
    v_permlane32_swap_b32 v3, v2
    v_max_f32 v2, v2, v3
    v_mfma_f32_16x16x32_bf16 v[36:39], v[92:95], v[12:15], 0
    v_mul_f32 v2, s29, v2
    v_fma_f32 v68, v68, s29, -v2
    v_mfma_f32_16x16x32_bf16 v[36:39], v[46:49], v[20:23], v[36:39]
    v_fma_f32 v69, v69, s29, -v2
    v_fma_f32 v70, v70, s29, -v2
    v_exp_f32 v68, v68
    v_fma_f32 v71, v71, s29, -v2
    v_exp_f32 v69, v69
    v_fma_f32 v72, v72, s29, -v2
    v_exp_f32 v70, v70
    v_fma_f32 v73, v73, s29, -v2
    v_exp_f32 v71, v71
    v_fma_f32 v74, v74, s29, -v2
    v_exp_f32 v72, v72
    v_fma_f32 v75, v75, s29, -v2
    v_exp_f32 v73, v73
    v_fma_f32 v76, v76, s29, -v2
    v_exp_f32 v74, v74
    v_fma_f32 v77, v77, s29, -v2
    v_exp_f32 v75, v75
    v_exp_f32 v76, v76
    v_exp_f32 v77, v77
    v_cvt_pk_bf16_f32 v68, v68, v69
    v_cvt_pk_bf16_f32 v69, v70, v71
    v_cvt_pk_bf16_f32 v70, v72, v73
    v_cvt_pk_bf16_f32 v71, v74, v75
    v_cvt_pk_bf16_f32 v76, v76, v77
    v_mov_b32 v78, 0
    v_mov_b32 v77, v76
    v_mov_b32 v79, 0
    v_rcp_f32 v66, v16
    s_nop 0
    v_mul_f32 v24, v24, v66
    v_mul_f32 v25, v25, v66
    v_mul_f32 v26, v26, v66
    v_mul_f32 v27, v27, v66
    v_cvt_pk_bf16_f32 v168, v24, v25
    v_cvt_pk_bf16_f32 v169, v26, v27
    v_mul_f32 v28, v28, v66
    v_mul_f32 v29, v29, v66
    v_mul_f32 v30, v30, v66
    v_mul_f32 v31, v31, v66
    v_cvt_pk_bf16_f32 v170, v28, v29
    v_cvt_pk_bf16_f32 v171, v30, v31
    v_mul_f32 v32, v32, v66
    v_mul_f32 v33, v33, v66
    v_mul_f32 v34, v34, v66
    v_mul_f32 v35, v35, v66
    v_cvt_pk_bf16_f32 v172, v32, v33
    v_cvt_pk_bf16_f32 v173, v34, v35
    v_mul_f32 v36, v36, v66
    v_mul_f32 v37, v37, v66
    v_mul_f32 v38, v38, v66
    v_mul_f32 v39, v39, v66
    v_cvt_pk_bf16_f32 v174, v36, v37
    v_cvt_pk_bf16_f32 v175, v38, v39
    ds_write_b128 v162, v[168:171] offset:0
    ds_write_b128 v162, v[172:175] offset:2048
    v_mfma_f32_16x16x32_bf16 v[72:75], v[4:7], v[68:71], 0
    v_mfma_f32_16x16x32_bf16 v[72:75], v[8:11], v[76:79], v[72:75]
    v_mfma_f32_16x16x32_bf16 v[24:27], v[80:83], v[68:71], 0
    v_mfma_f32_16x16x32_bf16 v[24:27], v[40:43], v[76:79], v[24:27]
    v_mfma_f32_16x16x32_bf16 v[28:31], v[84:87], v[68:71], 0
    v_mfma_f32_16x16x32_bf16 v[28:31], v[42:45], v[76:79], v[28:31]
    v_mfma_f32_16x16x32_bf16 v[32:35], v[88:91], v[68:71], 0
    v_mfma_f32_16x16x32_bf16 v[32:35], v[44:47], v[76:79], v[32:35]
    v_mfma_f32_16x16x32_bf16 v[36:39], v[92:95], v[68:71], 0
    v_mfma_f32_16x16x32_bf16 v[36:39], v[46:49], v[76:79], v[36:39]
    v_rcp_f32 v3, v72
    s_nop 0
    v_mul_f32 v24, v24, v3
    v_mul_f32 v25, v25, v3
    v_mul_f32 v26, v26, v3
    v_mul_f32 v27, v27, v3
    v_cvt_pk_bf16_f32 v168, v24, v25
    v_cvt_pk_bf16_f32 v169, v26, v27
    v_mul_f32 v28, v28, v3
    v_mul_f32 v29, v29, v3
    v_mul_f32 v30, v30, v3
    v_mul_f32 v31, v31, v3
    v_cvt_pk_bf16_f32 v170, v28, v29
    v_cvt_pk_bf16_f32 v171, v30, v31
    v_mul_f32 v32, v32, v3
    v_mul_f32 v33, v33, v3
    v_mul_f32 v34, v34, v3
    v_mul_f32 v35, v35, v3
    v_cvt_pk_bf16_f32 v172, v32, v33
    v_cvt_pk_bf16_f32 v173, v34, v35
    v_mul_f32 v36, v36, v3
    v_mul_f32 v37, v37, v3
    v_mul_f32 v38, v38, v3
    v_mul_f32 v39, v39, v3
    v_cvt_pk_bf16_f32 v174, v36, v37
    v_cvt_pk_bf16_f32 v175, v38, v39
    ds_write_b128 v162, v[168:171] offset:256
    ds_write_b128 v162, v[172:175] offset:2304
    v_xor_b32 v162, 0x4000, v162
    s_add_u32 s16, s16, 1
    s_cmp_le_u32 s16, 63
    s_cbranch_scc1 aloopH_18
    s_waitcnt lgkmcnt(0)
    s_barrier
    s_waitcnt vmcnt(0)
    s_branch k_end
aloopH_18_rq_0:
    s_sub_u32 s22, s22, 1
    s_cbranch_scc1 aloopH_18_rq_0_g
    buffer_load_dwordx4 v[48:51], v0, s[4:7], s23 offen offset:0 sc1
    buffer_load_dwordx4 v[52:55], v0, s[4:7], s23 offen offset:1024 sc1
    buffer_load_dwordx4 v[56:59], v0, s[4:7], s23 offen offset:2048 sc1
    buffer_load_dwordx4 v[60:63], v0, s[4:7], s23 offen offset:3072 sc1
    buffer_load_dwordx4 v[64:67], v0, s[4:7], s24 offen offset:0 sc1
    buffer_load_dwordx4 v[68:71], v0, s[4:7], s24 offen offset:1024 sc1
    s_waitcnt vmcnt(5)
    v_max_u32 v3, v48, v50
    v_cmp_eq_u32 vcc, -1, v3
    s_cbranch_vccnz aloopH_18_rq_0
    s_branch aloopH_18_again
aloopH_18_rq_0_g:
    s_mov_b32 s22, 0
    s_waitcnt vmcnt(0)
    s_branch aloopH_18_nochk
aloopH_18_rq_1:
    s_sub_u32 s22, s22, 1
    s_cbranch_scc1 aloopH_18_rq_1_g
    buffer_load_dwordx4 v[52:55], v0, s[4:7], s23 offen offset:1024 sc1
    buffer_load_dwordx4 v[56:59], v0, s[4:7], s23 offen offset:2048 sc1
    buffer_load_dwordx4 v[60:63], v0, s[4:7], s23 offen offset:3072 sc1
    buffer_load_dwordx4 v[64:67], v0, s[4:7], s24 offen offset:0 sc1
    buffer_load_dwordx4 v[68:71], v0, s[4:7], s24 offen offset:1024 sc1
    s_waitcnt vmcnt(4)
    v_max_u32 v3, v52, v54
    v_cmp_eq_u32 vcc, -1, v3
    s_cbranch_vccnz aloopH_18_rq_1
    s_branch aloopH_18_again
aloopH_18_rq_1_g:
    s_mov_b32 s22, 0
    s_waitcnt vmcnt(0)
    s_branch aloopH_18_nochk
aloopH_18_rq_2:
    s_sub_u32 s22, s22, 1
    s_cbranch_scc1 aloopH_18_rq_2_g
    buffer_load_dwordx4 v[56:59], v0, s[4:7], s23 offen offset:2048 sc1
    buffer_load_dwordx4 v[60:63], v0, s[4:7], s23 offen offset:3072 sc1
    buffer_load_dwordx4 v[64:67], v0, s[4:7], s24 offen offset:0 sc1
    buffer_load_dwordx4 v[68:71], v0, s[4:7], s24 offen offset:1024 sc1
    s_waitcnt vmcnt(3)
    v_max_u32 v3, v56, v58
    v_cmp_eq_u32 vcc, -1, v3
    s_cbranch_vccnz aloopH_18_rq_2
    s_branch aloopH_18_again
aloopH_18_rq_2_g:
    s_mov_b32 s22, 0
    s_waitcnt vmcnt(0)
    s_branch aloopH_18_nochk
aloopH_18_rq_3:
    s_sub_u32 s22, s22, 1
    s_cbranch_scc1 aloopH_18_rq_3_g
    buffer_load_dwordx4 v[60:63], v0, s[4:7], s23 offen offset:3072 sc1
    buffer_load_dwordx4 v[64:67], v0, s[4:7], s24 offen offset:0 sc1
    buffer_load_dwordx4 v[68:71], v0, s[4:7], s24 offen offset:1024 sc1
    s_waitcnt vmcnt(2)
    v_max_u32 v3, v60, v62
    v_cmp_eq_u32 vcc, -1, v3
    s_cbranch_vccnz aloopH_18_rq_3
    s_branch aloopH_18_again
aloopH_18_rq_3_g:
    s_mov_b32 s22, 0
    s_waitcnt vmcnt(0)
    s_branch aloopH_18_nochk
aloopH_18_again:
    s_waitcnt vmcnt(5)
    v_mfma_f32_16x16x32_bf16 v[12:15], v[96:99], v[48:51], 0
    v_mfma_f32_16x16x32_bf16 v[16:19], v[112:115], v[48:51], 0
    v_max_u32 v3, v48, v50
    v_cmp_eq_u32 vcc, -1, v3
    v_mfma_f32_16x16x32_bf16 v[20:23], v[48:51], v[48:51], 0
    s_cbranch_vccnz aloopH_18_rq_0
    s_waitcnt vmcnt(4)
    v_mfma_f32_16x16x32_bf16 v[12:15], v[100:103], v[52:55], v[12:15]
    v_mfma_f32_16x16x32_bf16 v[16:19], v[116:119], v[52:55], v[16:19]
    v_max_u32 v3, v52, v54
    v_cmp_eq_u32 vcc, -1, v3
    v_mfma_f32_16x16x32_bf16 v[20:23], v[52:55], v[52:55], v[20:23]
    s_cbranch_vccnz aloopH_18_rq_1
    s_waitcnt vmcnt(3)
    v_mfma_f32_16x16x32_bf16 v[12:15], v[104:107], v[56:59], v[12:15]
    v_mfma_f32_16x16x32_bf16 v[16:19], v[120:123], v[56:59], v[16:19]
    v_max_u32 v3, v56, v58
    v_cmp_eq_u32 vcc, -1, v3
    v_mfma_f32_16x16x32_bf16 v[20:23], v[56:59], v[56:59], v[20:23]
    s_cbranch_vccnz aloopH_18_rq_2
    s_waitcnt vmcnt(2)
    v_mfma_f32_16x16x32_bf16 v[12:15], v[108:111], v[60:63], v[12:15]
    v_mfma_f32_16x16x32_bf16 v[16:19], v[124:127], v[60:63], v[16:19]
    v_max_u32 v3, v60, v62
    v_cmp_eq_u32 vcc, -1, v3
    v_mfma_f32_16x16x32_bf16 v[20:23], v[60:63], v[60:63], v[20:23]
    s_cbranch_vccnz aloopH_18_rq_3
    s_branch aloopH_18_sdone
aloopH_18_rq_v:
    s_sub_u32 s22, s22, 1
    s_cbranch_scc1 aloopH_18_rq_vg
    buffer_load_dwordx4 v[64:67], v0, s[4:7], s24 offen offset:0 sc1
    buffer_load_dwordx4 v[68:71], v0, s[4:7], s24 offen offset:1024 sc1
    s_waitcnt vmcnt(0)
    v_max3_u32 v188, v64, v66, v68
    v_max_u32 v188, v188, v70
    v_cmp_eq_u32 vcc, -1, v188
    s_cbranch_vccnz aloopH_18_rq_v
    s_branch aloopH_18_vok
aloopH_18_rq_vg:
    s_mov_b32 s22, 0
    s_branch aloopH_18_vok
aloopH_18_nochk:
    v_mfma_f32_16x16x32_bf16 v[12:15], v[96:99], v[48:51], 0
    v_mfma_f32_16x16x32_bf16 v[16:19], v[112:115], v[48:51], 0
    v_mfma_f32_16x16x32_bf16 v[20:23], v[48:51], v[48:51], 0
    v_mfma_f32_16x16x32_bf16 v[12:15], v[100:103], v[52:55], v[12:15]
    v_mfma_f32_16x16x32_bf16 v[16:19], v[116:119], v[52:55], v[16:19]
    v_mfma_f32_16x16x32_bf16 v[20:23], v[52:55], v[52:55], v[20:23]
    v_mfma_f32_16x16x32_bf16 v[12:15], v[104:107], v[56:59], v[12:15]
    v_mfma_f32_16x16x32_bf16 v[16:19], v[120:123], v[56:59], v[16:19]
    v_mfma_f32_16x16x32_bf16 v[20:23], v[56:59], v[56:59], v[20:23]
    v_mfma_f32_16x16x32_bf16 v[12:15], v[108:111], v[60:63], v[12:15]
    v_mfma_f32_16x16x32_bf16 v[16:19], v[124:127], v[60:63], v[16:19]
    v_mfma_f32_16x16x32_bf16 v[20:23], v[60:63], v[60:63], v[20:23]
    s_nop 1
    s_branch aloopH_18_sdone
aloopH_18_rq_v2:
    s_sub_u32 s22, s22, 1
    s_cbranch_scc1 aloopH_18_rq_v2g
    buffer_load_dwordx4 v[64:67], v0, s[4:7], s24 offen offset:0 sc1
    buffer_load_dwordx4 v[68:71], v0, s[4:7], s24 offen offset:1024 sc1
    s_waitcnt vmcnt(0)
    v_max3_u32 v188, v64, v66, v68
    v_max_u32 v188, v188, v70
    v_cmp_eq_u32 vcc, -1, v188
    s_cbranch_vccnz aloopH_18_rq_v2
    s_branch aloopH_18_lsk3
aloopH_18_rq_v2g:
    s_mov_b32 s22, 0
    s_branch aloopH_18_lsk3
aloopH_18_lsk:
    s_cmp_lg_u32 s27, 0
    s_cbranch_scc1 aloopH_18_lsk2
    v_mov_b32 v3, 62
    s_mov_b64 exec, 1
    buffer_store_dword v3, off, s[4:7], s28 sc1
    s_mov_b64 exec, -1
aloopH_18_lsk2:
    s_waitcnt vmcnt(0)
    v_max3_u32 v188, v64, v66, v68
    v_max_u32 v188, v188, v70
    v_cmp_eq_u32 vcc, -1, v188
    s_cbranch_vccnz aloopH_18_rq_v2
aloopH_18_lsk3:
    v_smfmac_f32_16x16x64_bf16 v[24:27], v[64:67], v[192:199], v166
    v_smfmac_f32_16x16x64_bf16 v[32:35], v[64:67], v[224:231], v166
    v_smfmac_f32_16x16x64_bf16 v[28:31], v[64:67], v[208:215], v166
    v_smfmac_f32_16x16x64_bf16 v[36:39], v[64:67], v[240:247], v166
    v_smfmac_f32_16x16x64_bf16 v[24:27], v[68:71], v[200:207], v166
    v_smfmac_f32_16x16x64_bf16 v[32:35], v[68:71], v[232:239], v166
    v_smfmac_f32_16x16x64_bf16 v[28:31], v[68:71], v[216:223], v166
    v_smfmac_f32_16x16x64_bf16 v[36:39], v[68:71], v[248:255], v166
    s_nop 7
    s_nop 1
    v_cvt_pk_bf16_f32 v40, v24, v25
    v_cvt_pk_bf16_f32 v41, v26, v27
    v_cvt_pk_bf16_f32 v42, v28, v29
    v_cvt_pk_bf16_f32 v43, v30, v31
    v_cvt_pk_bf16_f32 v44, v32, v33
    v_cvt_pk_bf16_f32 v45, v34, v35
    v_cvt_pk_bf16_f32 v46, v36, v37
    v_cvt_pk_bf16_f32 v47, v38, v39
    s_waitcnt lgkmcnt(0)
    s_branch aloopH_18_lskb
k_end:
k_exit:
    s_endpgm
.section .rodata,"a"
.p2align 6
jobtab:
    .long 4, 24, 24, 8192, 0, 262144, 8388608, 0, 32768, 4, 20971520, 131072, 0, 0, 218104321, 0
    .long 4, 24, 24, 8192, 0, 262144, 8388608, 262144, 32768, 4, 22020096, 131072, 0, 0, 218104324, 0
    .long 1, 32, 32, 8192, 0, 256, 8388608, 2097152, 32768, 8, 46137344, 131072, 0, 0, 218105354, 0
    .long 1, 16, 16, 8192, 1024, 1280, 8388608, 0, 32768, 8, 4210688, 131072, 0, 0, 218107930, 0
    .long 2, 64, 72, 7168, 512, 512, 7340032, 1048576, 32768, 8, 58204160, 114688, 0, 0, 218103937, 0
    .long 1, 32, 32, 8192, 1536, 1792, 8388608, 3670016, 32768, 8, 52453376, 131072, 0, 0, 218106138, 0
    .long 5, 218108416, 0, 0, 0, 0, 0, 20, 0, 0, 0, 0, 218112000, 23, 218107009, 0
    .long 5, 218108944, 0, 0, 4, 0, 0, 36, 0, 0, 0, 0, 218112000, 39, 218107137, 0
    .long 1, 40, 40, 2048, 0, 256, 8388608, 182452224, 131072, 8, 77070336, 32768, 218107072, 4, 218106564, 0
    .long 6, 0, 0, 0, 0, 0, 0, 7, 0, 0, 0, 0, 0, 0, 0, 0
    .long 6, 0, 0, 0, 0, 0, 0, 24, 0, 0, 0, 0, 0, 0, 0, 0
    .long 6, 0, 0, 0, 0, 0, 0, 56, 0, 0, 0, 0, 0, 0, 0, 0
    .long 0, 0, 0, 0, 0, 0, 0, 0, 0, 0, 0, 0, 0, 0, 0, 0
    .long 0, 0, 0, 0, 0, 0, 0, 0, 0, 0, 0, 0, 0, 0, 0, 0
    .long 0, 0, 0, 0, 0, 0, 0, 0, 0, 0, 0, 0, 0, 0, 0, 0
    .long 4, 24, 24, 8192, 2048, 264192, 8388608, 0, 32768, 4, 21004288, 131072, 0, 0, 218104353, 0
    .long 4, 24, 24, 8192, 2048, 264192, 8388608, 262144, 32768, 4, 22052864, 131072, 0, 0, 218104356, 0
    .long 1, 32, 32, 8192, 2048, 2304, 8388608, 2097152, 32768, 8, 46170112, 131072, 0, 0, 218105386, 0
    .long 1, 16, 16, 8192, 3072, 3328, 8388608, 0, 32768, 8, 4243456, 131072, 0, 0, 218107962, 0
    .long 2, 64, 72, 7168, 2304, 2304, 7340032, 1048576, 32768, 8, 58232832, 114688, 0, 0, 218103940, 0
    .long 1, 32, 32, 8192, 3584, 3840, 8388608, 3670016, 32768, 8, 52486144, 131072, 0, 0, 218106170, 0
    .long 5, 218108448, 0, 0, 8, 0, 0, 20, 0, 0, 0, 0, 218112128, 23, 218107012, 0
    .long 5, 218108976, 0, 0, 12, 0, 0, 36, 0, 0, 0, 0, 218112128, 39, 218107140, 0
    .long 1, 40, 40, 2048, 2097152, 2097408, 8388608, 182484992, 131072, 8, 81264640, 32768, 218107076, 4, 218106564, 0
    .long 6, 0, 0, 0, 1, 0, 0, 7, 0, 0, 0, 0, 0, 0, 0, 0
    .long 6, 0, 0, 0, 1, 0, 0, 24, 0, 0, 0, 0, 0, 0, 0, 0
    .long 6, 0, 0, 0, 1, 0, 0, 56, 0, 0, 0, 0, 0, 0, 0, 0
    .long 0, 0, 0, 0, 0, 0, 0, 0, 0, 0, 0, 0, 0, 0, 0, 0
    .long 0, 0, 0, 0, 0, 0, 0, 0, 0, 0, 0, 0, 0, 0, 0, 0
    .long 0, 0, 0, 0, 0, 0, 0, 0, 0, 0, 0, 0, 0, 0, 0, 0
    .long 4, 24, 24, 8192, 4096, 266240, 8388608, 0, 32768, 4, 21037056, 131072, 0, 0, 218104385, 0
    .long 4, 24, 24, 8192, 4096, 266240, 8388608, 262144, 32768, 4, 22085632, 131072, 0, 0, 218104388, 0
    .long 1, 32, 32, 8192, 4096, 4352, 8388608, 2097152, 32768, 8, 46202880, 131072, 0, 0, 218105418, 0
    .long 1, 16, 16, 8192, 5120, 5376, 8388608, 0, 32768, 8, 4276224, 131072, 0, 0, 218107994, 0
    .long 2, 64, 72, 7168, 4096, 4096, 7340032, 1048576, 32768, 8, 58261504, 114688, 0, 0, 218103953, 0
    .long 1, 32, 32, 8192, 5632, 5888, 8388608, 3670016, 32768, 8, 52518912, 131072, 0, 0, 218106202, 0
    .long 5, 218108480, 0, 0, 16, 0, 0, 20, 0, 0, 0, 0, 218112256, 23, 218107025, 0
    .long 5, 218109008, 0, 0, 20, 0, 0, 36, 0, 0, 0, 0, 218112256, 39, 218107153, 0
    .long 1, 40, 40, 2048, 4194304, 4194560, 8388608, 182517760, 131072, 8, 85458944, 32768, 218107088, 4, 218106564, 0
    .long 6, 0, 0, 0, 2, 0, 0, 7, 0, 0, 0, 0, 0, 0, 0, 0
    .long 6, 0, 0, 0, 2, 0, 0, 24, 0, 0, 0, 0, 0, 0, 0, 0
    .long 6, 0, 0, 0, 2, 0, 0, 56, 0, 0, 0, 0, 0, 0, 0, 0
    .long 0, 0, 0, 0, 0, 0, 0, 0, 0, 0, 0, 0, 0, 0, 0, 0
    .long 0, 0, 0, 0, 0, 0, 0, 0, 0, 0, 0, 0, 0, 0, 0, 0
    .long 0, 0, 0, 0, 0, 0, 0, 0, 0, 0, 0, 0, 0, 0, 0, 0
    .long 4, 24, 24, 8192, 6144, 268288, 8388608, 0, 32768, 4, 21069824, 131072, 0, 0, 218104417, 0
    .long 4, 24, 24, 8192, 6144, 268288, 8388608, 262144, 32768, 4, 22118400, 131072, 0, 0, 218104420, 0
    .long 1, 32, 32, 8192, 6144, 6400, 8388608, 2097152, 32768, 8, 46235648, 131072, 0, 0, 218105450, 0
    .long 1, 16, 16, 8192, 7168, 7424, 8388608, 0, 32768, 8, 4308992, 131072, 0, 0, 218108026, 0
    .long 2, 64, 72, 7168, 5888, 5888, 7340032, 1048576, 32768, 8, 58290176, 114688, 0, 0, 218103956, 0
    .long 1, 32, 32, 8192, 7680, 7936, 8388608, 3670016, 32768, 8, 52551680, 131072, 0, 0, 218106234, 0
    .long 5, 218108512, 0, 0, 24, 0, 0, 20, 0, 0, 0, 0, 218112384, 23, 218107028, 0
    .long 5, 218109040, 0, 0, 28, 0, 0, 36, 0, 0, 0, 0, 218112384, 39, 218107156, 0
    .long 1, 40, 40, 2048, 6291456, 6291712, 8388608, 182550528, 131072, 8, 89653248, 32768, 218107092, 4, 218106564, 0
    .long 6, 0, 0, 0, 3, 0, 0, 7, 0, 0, 0, 0, 0, 0, 0, 0
    .long 6, 0, 0, 0, 3, 0, 0, 24, 0, 0, 0, 0, 0, 0, 0, 0
    .long 6, 0, 0, 0, 3, 0, 0, 56, 0, 0, 0, 0, 0, 0, 0, 0
    .long 0, 0, 0, 0, 0, 0, 0, 0, 0, 0, 0, 0, 0, 0, 0, 0
    .long 0, 0, 0, 0, 0, 0, 0, 0, 0, 0, 0, 0, 0, 0, 0, 0
    .long 0, 0, 0, 0, 0, 0, 0, 0, 0, 0, 0, 0, 0, 0, 0, 0
    .long 4, 24, 24, 8192, 256, 262400, 8388608, 0, 32768, 4, 20975616, 131072, 0, 0, 218104321, 0
    .long 4, 24, 24, 8192, 256, 262400, 8388608, 262144, 32768, 4, 22024192, 131072, 0, 0, 218104324, 0
    .long 1, 24, 24, 8192, 1024, 1280, 8388608, 2097152, 32768, 8, 29376512, 131072, 0, 0, 218105370, 0
    .long 1, 16, 16, 8192, 512, 768, 8388608, 1048576, 32768, 8, 8396800, 131072, 0, 0, 218108426, 0
    .long 1, 16, 16, 8192, 1536, 1792, 8388608, 1048576, 32768, 8, 8413184, 131072, 0, 0, 218108442, 0
    .long 5, 218107904, 0, 0, 0, 0, 0, 0, 0, 0, 0, 0, 218112000, 3, 218106881, 0
    .long 5, 218108688, 0, 0, 4, 0, 0, 28, 0, 0, 0, 0, 218112000, 31, 218107073, 0
    .long 2, 64, 72, 7168, 1536, 1536, 7340032, 3670016, 32768, 8, 67395584, 114688, 0, 0, 218104257, 0
    .long 1, 40, 40, 2048, 1024, 1280, 8388608, 180355072, 131072, 8, 76562432, 32768, 218107008, 4, 218106500, 0
    .long 6, 0, 0, 0, 0, 0, 0, 4, 0, 0, 0, 0, 0, 0, 0, 0
    .long 6, 0, 0, 0, 0, 0, 0, 14, 0, 0, 0, 0, 0, 0, 0, 0
    .long 6, 0, 0, 0, 0, 0, 0, 51, 0, 0, 0, 0, 0, 0, 0, 0
    .long 7, 0, 0, 0, 1, 0, 0, 62, 0, 0, 0, 0, 0, 0, 0, 0
    .long 0, 0, 0, 0, 0, 0, 0, 0, 0, 0, 0, 0, 0, 0, 0, 0
    .long 0, 0, 0, 0, 0, 0, 0, 0, 0, 0, 0, 0, 0, 0, 0, 0
    .long 4, 24, 24, 8192, 2304, 264448, 8388608, 0, 32768, 4, 21008384, 131072, 0, 0, 218104353, 0
    .long 4, 24, 24, 8192, 2304, 264448, 8388608, 262144, 32768, 4, 22056960, 131072, 0, 0, 218104356, 0
    .long 1, 24, 24, 8192, 3072, 3328, 8388608, 2097152, 32768, 8, 29409280, 131072, 0, 0, 218105402, 0
    .long 1, 16, 16, 8192, 2560, 2816, 8388608, 1048576, 32768, 8, 8429568, 131072, 0, 0, 218108458, 0
    .long 1, 16, 16, 8192, 3584, 3840, 8388608, 1048576, 32768, 8, 8445952, 131072, 0, 0, 218108474, 0
    .long 5, 218107936, 0, 0, 8, 0, 0, 0, 0, 0, 0, 0, 218112128, 3, 218106884, 0
    .long 5, 218108720, 0, 0, 12, 0, 0, 28, 0, 0, 0, 0, 218112128, 31, 218107076, 0
    .long 2, 64, 72, 7168, 3328, 3328, 7340032, 3670016, 32768, 8, 67424256, 114688, 0, 0, 218104260, 0
    .long 1, 40, 40, 2048, 2098176, 2098432, 8388608, 180387840, 131072, 8, 80756736, 32768, 218107012, 4, 218106500, 0
    .long 6, 0, 0, 0, 1, 0, 0, 4, 0, 0, 0, 0, 0, 0, 0, 0
    .long 6, 0, 0, 0, 1, 0, 0, 14, 0, 0, 0, 0, 0, 0, 0, 0
    .long 6, 0, 0, 0, 1, 0, 0, 51, 0, 0, 0, 0, 0, 0, 0, 0
    .long 7, 0, 0, 0, 5, 0, 0, 62, 0, 0, 0, 0, 0, 0, 0, 0
    .long 0, 0, 0, 0, 0, 0, 0, 0, 0, 0, 0, 0, 0, 0, 0, 0
    .long 0, 0, 0, 0, 0, 0, 0, 0, 0, 0, 0, 0, 0, 0, 0, 0
    .long 4, 24, 24, 8192, 4352, 266496, 8388608, 0, 32768, 4, 21041152, 131072, 0, 0, 218104385, 0
    .long 4, 24, 24, 8192, 4352, 266496, 8388608, 262144, 32768, 4, 22089728, 131072, 0, 0, 218104388, 0
    .long 1, 24, 24, 8192, 5120, 5376, 8388608, 2097152, 32768, 8, 29442048, 131072, 0, 0, 218105434, 0
    .long 1, 16, 16, 8192, 4608, 4864, 8388608, 1048576, 32768, 8, 8462336, 131072, 0, 0, 218108490, 0
    .long 1, 16, 16, 8192, 5632, 5888, 8388608, 1048576, 32768, 8, 8478720, 131072, 0, 0, 218108506, 0
    .long 5, 218107968, 0, 0, 16, 0, 0, 0, 0, 0, 0, 0, 218112256, 3, 218106897, 0
    .long 5, 218108752, 0, 0, 20, 0, 0, 28, 0, 0, 0, 0, 218112256, 31, 218107089, 0
    .long 2, 64, 72, 7168, 5120, 5120, 7340032, 3670016, 32768, 8, 67452928, 114688, 0, 0, 218104273, 0
    .long 1, 40, 40, 2048, 4195328, 4195584, 8388608, 180420608, 131072, 8, 84951040, 32768, 218107024, 4, 218106500, 0
    .long 6, 0, 0, 0, 2, 0, 0, 4, 0, 0, 0, 0, 0, 0, 0, 0
    .long 6, 0, 0, 0, 2, 0, 0, 14, 0, 0, 0, 0, 0, 0, 0, 0
    .long 6, 0, 0, 0, 2, 0, 0, 51, 0, 0, 0, 0, 0, 0, 0, 0
    .long 7, 0, 0, 0, 9, 0, 0, 62, 0, 0, 0, 0, 0, 0, 0, 0
    .long 0, 0, 0, 0, 0, 0, 0, 0, 0, 0, 0, 0, 0, 0, 0, 0
    .long 0, 0, 0, 0, 0, 0, 0, 0, 0, 0, 0, 0, 0, 0, 0, 0
    .long 4, 24, 24, 8192, 6400, 268544, 8388608, 0, 32768, 4, 21073920, 131072, 0, 0, 218104417, 0
    .long 4, 24, 24, 8192, 6400, 268544, 8388608, 262144, 32768, 4, 22122496, 131072, 0, 0, 218104420, 0
    .long 1, 24, 24, 8192, 7168, 7424, 8388608, 2097152, 32768, 8, 29474816, 131072, 0, 0, 218105466, 0
    .long 1, 16, 16, 8192, 6656, 6912, 8388608, 1048576, 32768, 8, 8495104, 131072, 0, 0, 218108522, 0
    .long 1, 16, 16, 8192, 7680, 7936, 8388608, 1048576, 32768, 8, 8511488, 131072, 0, 0, 218108538, 0
    .long 5, 218108000, 0, 0, 24, 0, 0, 0, 0, 0, 0, 0, 218112384, 3, 218106900, 0
    .long 5, 218108784, 0, 0, 28, 0, 0, 28, 0, 0, 0, 0, 218112384, 31, 218107092, 0
    .long 2, 64, 72, 7168, 6912, 6912, 7340032, 3670016, 32768, 8, 67481600, 114688, 0, 0, 218104276, 0
    .long 1, 40, 40, 2048, 6292480, 6292736, 8388608, 180453376, 131072, 8, 89145344, 32768, 218107028, 4, 218106500, 0
    .long 6, 0, 0, 0, 3, 0, 0, 4, 0, 0, 0, 0, 0, 0, 0, 0
    .long 6, 0, 0, 0, 3, 0, 0, 14, 0, 0, 0, 0, 0, 0, 0, 0
    .long 6, 0, 0, 0, 3, 0, 0, 51, 0, 0, 0, 0, 0, 0, 0, 0
    .long 7, 0, 0, 0, 13, 0, 0, 62, 0, 0, 0, 0, 0, 0, 0, 0
    .long 0, 0, 0, 0, 0, 0, 0, 0, 0, 0, 0, 0, 0, 0, 0, 0
    .long 0, 0, 0, 0, 0, 0, 0, 0, 0, 0, 0, 0, 0, 0, 0, 0
    .long 4, 24, 24, 8192, 512, 262656, 8388608, 0, 32768, 4, 20979712, 131072, 0, 0, 218104321, 0
    .long 4, 24, 24, 8192, 512, 262656, 8388608, 262144, 32768, 4, 22028288, 131072, 0, 0, 218104324, 0
    .long 1, 24, 24, 8192, 0, 256, 8388608, 2097152, 32768, 8, 29360128, 131072, 0, 0, 218105354, 0
    .long 2, 64, 72, 7168, 512, 512, 7340032, 524288, 32768, 8, 56369152, 114688, 0, 0, 218103873, 0
    .long 1, 32, 32, 8192, 0, 256, 8388608, 3145728, 32768, 8, 50331648, 131072, 0, 0, 218105866, 0
    .long 2, 64, 72, 7168, 768, 768, 7340032, 1048576, 32768, 8, 58208256, 114688, 0, 0, 218103937, 0
    .long 5, 218108432, 0, 0, 4, 0, 0, 16, 0, 0, 0, 0, 218112000, 19, 218107009, 0
    .long 1, 80, 80, 2048, 1024, 1280, 7340032, 54525952, 114688, 7, 117456896, 32768, 218103808, 7, 218106369, 0
    .long 1, 40, 40, 2048, 1024, 1280, 8388608, 186646528, 131072, 8, 78135296, 32768, 218107200, 4, 218106692, 0
    .long 0, 0, 0, 0, 0, 0, 0, 0, 0, 0, 0, 0, 0, 0, 0, 0
    .long 0, 0, 0, 0, 0, 0, 0, 0, 0, 0, 0, 0, 0, 0, 0, 0
    .long 0, 0, 0, 0, 0, 0, 0, 0, 0, 0, 0, 0, 0, 0, 0, 0
    .long 0, 0, 0, 0, 0, 0, 0, 0, 0, 0, 0, 0, 0, 0, 0, 0
    .long 0, 0, 0, 0, 0, 0, 0, 0, 0, 0, 0, 0, 0, 0, 0, 0
    .long 0, 0, 0, 0, 0, 0, 0, 0, 0, 0, 0, 0, 0, 0, 0, 0
    .long 4, 24, 24, 8192, 2560, 264704, 8388608, 0, 32768, 4, 21012480, 131072, 0, 0, 218104353, 0
    .long 4, 24, 24, 8192, 2560, 264704, 8388608, 262144, 32768, 4, 22061056, 131072, 0, 0, 218104356, 0
    .long 1, 24, 24, 8192, 2048, 2304, 8388608, 2097152, 32768, 8, 29392896, 131072, 0, 0, 218105386, 0
    .long 2, 64, 72, 7168, 2304, 2304, 7340032, 524288, 32768, 8, 56397824, 114688, 0, 0, 218103876, 0
    .long 1, 32, 32, 8192, 2048, 2304, 8388608, 3145728, 32768, 8, 50364416, 131072, 0, 0, 218105898, 0
    .long 2, 64, 72, 7168, 2560, 2560, 7340032, 1048576, 32768, 8, 58236928, 114688, 0, 0, 218103940, 0
    .long 5, 218108464, 0, 0, 12, 0, 0, 16, 0, 0, 0, 0, 218112128, 19, 218107012, 0
    .long 1, 80, 80, 2048, 1836032, 1836288, 7340032, 54554624, 114688, 7, 121651200, 32768, 218103812, 7, 218106369, 0
    .long 1, 40, 40, 2048, 2098176, 2098432, 8388608, 186679296, 131072, 8, 82329600, 32768, 218107204, 4, 218106692, 0
    .long 0, 0, 0, 0, 0, 0, 0, 0, 0, 0, 0, 0, 0, 0, 0, 0
    .long 0, 0, 0, 0, 0, 0, 0, 0, 0, 0, 0, 0, 0, 0, 0, 0
    .long 0, 0, 0, 0, 0, 0, 0, 0, 0, 0, 0, 0, 0, 0, 0, 0
    .long 0, 0, 0, 0, 0, 0, 0, 0, 0, 0, 0, 0, 0, 0, 0, 0
    .long 0, 0, 0, 0, 0, 0, 0, 0, 0, 0, 0, 0, 0, 0, 0, 0
    .long 0, 0, 0, 0, 0, 0, 0, 0, 0, 0, 0, 0, 0, 0, 0, 0
    .long 4, 24, 24, 8192, 4608, 266752, 8388608, 0, 32768, 4, 21045248, 131072, 0, 0, 218104385, 0
    .long 4, 24, 24, 8192, 4608, 266752, 8388608, 262144, 32768, 4, 22093824, 131072, 0, 0, 218104388, 0
    .long 1, 24, 24, 8192, 4096, 4352, 8388608, 2097152, 32768, 8, 29425664, 131072, 0, 0, 218105418, 0
    .long 2, 64, 72, 7168, 4096, 4096, 7340032, 524288, 32768, 8, 56426496, 114688, 0, 0, 218103889, 0
    .long 1, 32, 32, 8192, 4096, 4352, 8388608, 3145728, 32768, 8, 50397184, 131072, 0, 0, 218105930, 0
    .long 2, 64, 72, 7168, 4352, 4352, 7340032, 1048576, 32768, 8, 58265600, 114688, 0, 0, 218103953, 0
    .long 5, 218108496, 0, 0, 20, 0, 0, 16, 0, 0, 0, 0, 218112256, 19, 218107025, 0
    .long 1, 80, 80, 2048, 3671040, 3671296, 7340032, 54583296, 114688, 7, 125845504, 32768, 218103824, 7, 218106369, 0
    .long 1, 40, 40, 2048, 4195328, 4195584, 8388608, 186712064, 131072, 8, 86523904, 32768, 218107216, 4, 218106692, 0
    .long 0, 0, 0, 0, 0, 0, 0, 0, 0, 0, 0, 0, 0, 0, 0, 0
    .long 0, 0, 0, 0, 0, 0, 0, 0, 0, 0, 0, 0, 0, 0, 0, 0
    .long 0, 0, 0, 0, 0, 0, 0, 0, 0, 0, 0, 0, 0, 0, 0, 0
    .long 0, 0, 0, 0, 0, 0, 0, 0, 0, 0, 0, 0, 0, 0, 0, 0
    .long 0, 0, 0, 0, 0, 0, 0, 0, 0, 0, 0, 0, 0, 0, 0, 0
    .long 0, 0, 0, 0, 0, 0, 0, 0, 0, 0, 0, 0, 0, 0, 0, 0
    .long 4, 24, 24, 8192, 6656, 268800, 8388608, 0, 32768, 4, 21078016, 131072, 0, 0, 218104417, 0
    .long 4, 24, 24, 8192, 6656, 268800, 8388608, 262144, 32768, 4, 22126592, 131072, 0, 0, 218104420, 0
    .long 1, 24, 24, 8192, 6144, 6400, 8388608, 2097152, 32768, 8, 29458432, 131072, 0, 0, 218105450, 0
    .long 2, 64, 72, 7168, 5888, 5888, 7340032, 524288, 32768, 8, 56455168, 114688, 0, 0, 218103892, 0
    .long 1, 32, 32, 8192, 6144, 6400, 8388608, 3145728, 32768, 8, 50429952, 131072, 0, 0, 218105962, 0
    .long 2, 64, 72, 7168, 6144, 6144, 7340032, 1048576, 32768, 8, 58294272, 114688, 0, 0, 218103956, 0
    .long 5, 218108528, 0, 0, 28, 0, 0, 16, 0, 0, 0, 0, 218112384, 19, 218107028, 0
    .long 1, 80, 80, 2048, 5506048, 5506304, 7340032, 54611968, 114688, 7, 130039808, 32768, 218103828, 7, 218106369, 0
    .long 1, 40, 40, 2048, 6292480, 6292736, 8388608, 186744832, 131072, 8, 90718208, 32768, 218107220, 4, 218106692, 0
    .long 0, 0, 0, 0, 0, 0, 0, 0, 0, 0, 0, 0, 0, 0, 0, 0
    .long 0, 0, 0, 0, 0, 0, 0, 0, 0, 0, 0, 0, 0, 0, 0, 0
    .long 0, 0, 0, 0, 0, 0, 0, 0, 0, 0, 0, 0, 0, 0, 0, 0
    .long 0, 0, 0, 0, 0, 0, 0, 0, 0, 0, 0, 0, 0, 0, 0, 0
    .long 0, 0, 0, 0, 0, 0, 0, 0, 0, 0, 0, 0, 0, 0, 0, 0
    .long 0, 0, 0, 0, 0, 0, 0, 0, 0, 0, 0, 0, 0, 0, 0, 0
    .long 4, 24, 24, 8192, 768, 262912, 8388608, 0, 32768, 4, 20983808, 131072, 0, 0, 218104321, 0
    .long 4, 24, 24, 8192, 768, 262912, 8388608, 262144, 32768, 4, 22032384, 131072, 0, 0, 218104324, 0
    .long 1, 24, 24, 8192, 0, 256, 8388608, 1572864, 32768, 8, 27262976, 131072, 0, 0, 218105098, 0
    .long 2, 64, 72, 7168, 0, 0, 7340032, 3670016, 32768, 8, 67371008, 114688, 0, 0, 218104257, 0
    .long 2, 64, 72, 7168, 0, 0, 7340032, 1048576, 32768, 8, 58195968, 114688, 0, 0, 218103937, 0
    .long 5, 218108160, 0, 0, 0, 0, 0, 12, 0, 0, 0, 0, 218112000, 15, 218106945, 0
    .long 1, 32, 32, 8192, 1024, 1280, 8388608, 3670016, 32768, 8, 52445184, 131072, 0, 0, 218106138, 0
    .long 1, 40, 40, 2048, 1536, 1792, 8388608, 178257920, 131072, 8, 76046336, 32768, 218106944, 4, 218106436, 0
    .long 1, 40, 40, 2048, 0, 256, 8388608, 186646528, 131072, 8, 78118912, 32768, 218107200, 4, 218106692, 0
    .long 6, 0, 0, 0, 0, 0, 0, 44, 0, 0, 0, 0, 0, 0, 0, 0
    .long 0, 0, 0, 0, 0, 0, 0, 0, 0, 0, 0, 0, 0, 0, 0, 0
    .long 0, 0, 0, 0, 0, 0, 0, 0, 0, 0, 0, 0, 0, 0, 0, 0
    .long 0, 0, 0, 0, 0, 0, 0, 0, 0, 0, 0, 0, 0, 0, 0, 0
    .long 0, 0, 0, 0, 0, 0, 0, 0, 0, 0, 0, 0, 0, 0, 0, 0
    .long 0, 0, 0, 0, 0, 0, 0, 0, 0, 0, 0, 0, 0, 0, 0, 0
    .long 4, 24, 24, 8192, 2816, 264960, 8388608, 0, 32768, 4, 21016576, 131072, 0, 0, 218104353, 0
    .long 4, 24, 24, 8192, 2816, 264960, 8388608, 262144, 32768, 4, 22065152, 131072, 0, 0, 218104356, 0
    .long 1, 24, 24, 8192, 2048, 2304, 8388608, 1572864, 32768, 8, 27295744, 131072, 0, 0, 218105130, 0
    .long 2, 64, 72, 7168, 1792, 1792, 7340032, 3670016, 32768, 8, 67399680, 114688, 0, 0, 218104260, 0
    .long 2, 64, 72, 7168, 1792, 1792, 7340032, 1048576, 32768, 8, 58224640, 114688, 0, 0, 218103940, 0
    .long 5, 218108192, 0, 0, 8, 0, 0, 12, 0, 0, 0, 0, 218112128, 15, 218106948, 0
    .long 1, 32, 32, 8192, 3072, 3328, 8388608, 3670016, 32768, 8, 52477952, 131072, 0, 0, 218106170, 0
    .long 1, 40, 40, 2048, 2098688, 2098944, 8388608, 178290688, 131072, 8, 80240640, 32768, 218106948, 4, 218106436, 0
    .long 1, 40, 40, 2048, 2097152, 2097408, 8388608, 186679296, 131072, 8, 82313216, 32768, 218107204, 4, 218106692, 0
    .long 6, 0, 0, 0, 1, 0, 0, 44, 0, 0, 0, 0, 0, 0, 0, 0
    .long 0, 0, 0, 0, 0, 0, 0, 0, 0, 0, 0, 0, 0, 0, 0, 0
    .long 0, 0, 0, 0, 0, 0, 0, 0, 0, 0, 0, 0, 0, 0, 0, 0
    .long 0, 0, 0, 0, 0, 0, 0, 0, 0, 0, 0, 0, 0, 0, 0, 0
    .long 0, 0, 0, 0, 0, 0, 0, 0, 0, 0, 0, 0, 0, 0, 0, 0
    .long 0, 0, 0, 0, 0, 0, 0, 0, 0, 0, 0, 0, 0, 0, 0, 0
    .long 4, 24, 24, 8192, 4864, 267008, 8388608, 0, 32768, 4, 21049344, 131072, 0, 0, 218104385, 0
    .long 4, 24, 24, 8192, 4864, 267008, 8388608, 262144, 32768, 4, 22097920, 131072, 0, 0, 218104388, 0
    .long 1, 24, 24, 8192, 4096, 4352, 8388608, 1572864, 32768, 8, 27328512, 131072, 0, 0, 218105162, 0
    .long 2, 64, 72, 7168, 3584, 3584, 7340032, 3670016, 32768, 8, 67428352, 114688, 0, 0, 218104273, 0
    .long 2, 64, 72, 7168, 3584, 3584, 7340032, 1048576, 32768, 8, 58253312, 114688, 0, 0, 218103953, 0
    .long 5, 218108224, 0, 0, 16, 0, 0, 12, 0, 0, 0, 0, 218112256, 15, 218106961, 0
    .long 1, 32, 32, 8192, 5120, 5376, 8388608, 3670016, 32768, 8, 52510720, 131072, 0, 0, 218106202, 0
    .long 1, 40, 40, 2048, 4195840, 4196096, 8388608, 178323456, 131072, 8, 84434944, 32768, 218106960, 4, 218106436, 0
    .long 1, 40, 40, 2048, 4194304, 4194560, 8388608, 186712064, 131072, 8, 86507520, 32768, 218107216, 4, 218106692, 0
    .long 6, 0, 0, 0, 2, 0, 0, 44, 0, 0, 0, 0, 0, 0, 0, 0
    .long 0, 0, 0, 0, 0, 0, 0, 0, 0, 0, 0, 0, 0, 0, 0, 0
    .long 0, 0, 0, 0, 0, 0, 0, 0, 0, 0, 0, 0, 0, 0, 0, 0
    .long 0, 0, 0, 0, 0, 0, 0, 0, 0, 0, 0, 0, 0, 0, 0, 0
    .long 0, 0, 0, 0, 0, 0, 0, 0, 0, 0, 0, 0, 0, 0, 0, 0
    .long 0, 0, 0, 0, 0, 0, 0, 0, 0, 0, 0, 0, 0, 0, 0, 0
    .long 4, 24, 24, 8192, 6912, 269056, 8388608, 0, 32768, 4, 21082112, 131072, 0, 0, 218104417, 0
    .long 4, 24, 24, 8192, 6912, 269056, 8388608, 262144, 32768, 4, 22130688, 131072, 0, 0, 218104420, 0
    .long 1, 24, 24, 8192, 6144, 6400, 8388608, 1572864, 32768, 8, 27361280, 131072, 0, 0, 218105194, 0
    .long 2, 64, 72, 7168, 5376, 5376, 7340032, 3670016, 32768, 8, 67457024, 114688, 0, 0, 218104276, 0
    .long 2, 64, 72, 7168, 5376, 5376, 7340032, 1048576, 32768, 8, 58281984, 114688, 0, 0, 218103956, 0
    .long 5, 218108256, 0, 0, 24, 0, 0, 12, 0, 0, 0, 0, 218112384, 15, 218106964, 0
    .long 1, 32, 32, 8192, 7168, 7424, 8388608, 3670016, 32768, 8, 52543488, 131072, 0, 0, 218106234, 0
    .long 1, 40, 40, 2048, 6292992, 6293248, 8388608, 178356224, 131072, 8, 88629248, 32768, 218106964, 4, 218106436, 0
    .long 1, 40, 40, 2048, 6291456, 6291712, 8388608, 186744832, 131072, 8, 90701824, 32768, 218107220, 4, 218106692, 0
    .long 6, 0, 0, 0, 3, 0, 0, 44, 0, 0, 0, 0, 0, 0, 0, 0
    .long 0, 0, 0, 0, 0, 0, 0, 0, 0, 0, 0, 0, 0, 0, 0, 0
    .long 0, 0, 0, 0, 0, 0, 0, 0, 0, 0, 0, 0, 0, 0, 0, 0
    .long 0, 0, 0, 0, 0, 0, 0, 0, 0, 0, 0, 0, 0, 0, 0, 0
    .long 0, 0, 0, 0, 0, 0, 0, 0, 0, 0, 0, 0, 0, 0, 0, 0
    .long 0, 0, 0, 0, 0, 0, 0, 0, 0, 0, 0, 0, 0, 0, 0, 0
    .long 4, 24, 24, 8192, 1024, 263168, 8388608, 0, 32768, 4, 20987904, 131072, 0, 0, 218104337, 0
    .long 4, 24, 24, 8192, 1024, 263168, 8388608, 262144, 32768, 4, 22036480, 131072, 0, 0, 218104340, 0
    .long 1, 24, 24, 8192, 0, 256, 8388608, 3145728, 32768, 8, 33554432, 131072, 0, 0, 218105866, 0
    .long 2, 64, 72, 7168, 512, 512, 7340032, 1572864, 32768, 8, 60039168, 114688, 0, 0, 218104001, 0
    .long 2, 64, 72, 7168, 1536, 1536, 7340032, 1048576, 32768, 8, 58220544, 114688, 0, 0, 218103937, 0
    .long 2, 64, 72, 7168, 1024, 1024, 7340032, 2621440, 32768, 8, 63717376, 114688, 0, 0, 218104129, 0
    .long 5, 218108688, 0, 0, 4, 0, 0, 24, 0, 0, 0, 0, 218112000, 27, 218107073, 0
    .long 5, 218109184, 0, 0, 0, 0, 0, 40, 0, 0, 0, 0, 218112000, 43, 218107201, 0
    .long 1, 40, 40, 2048, 1024, 1280, 8388608, 184549376, 131072, 8, 77611008, 32768, 218107136, 4, 218106628, 0
    .long 6, 0, 0, 0, 0, 0, 0, 31, 0, 0, 0, 0, 0, 0, 0, 0
    .long 6, 0, 0, 0, 0, 0, 0, 52, 0, 0, 0, 0, 0, 0, 0, 0
    .long 0, 0, 0, 0, 0, 0, 0, 0, 0, 0, 0, 0, 0, 0, 0, 0
    .long 0, 0, 0, 0, 0, 0, 0, 0, 0, 0, 0, 0, 0, 0, 0, 0
    .long 0, 0, 0, 0, 0, 0, 0, 0, 0, 0, 0, 0, 0, 0, 0, 0
    .long 0, 0, 0, 0, 0, 0, 0, 0, 0, 0, 0, 0, 0, 0, 0, 0
    .long 4, 24, 24, 8192, 3072, 265216, 8388608, 0, 32768, 4, 21020672, 131072, 0, 0, 218104369, 0
    .long 4, 24, 24, 8192, 3072, 265216, 8388608, 262144, 32768, 4, 22069248, 131072, 0, 0, 218104372, 0
    .long 1, 24, 24, 8192, 2048, 2304, 8388608, 3145728, 32768, 8, 33587200, 131072, 0, 0, 218105898, 0
    .long 2, 64, 72, 7168, 2304, 2304, 7340032, 1572864, 32768, 8, 60067840, 114688, 0, 0, 218104004, 0
    .long 2, 64, 72, 7168, 3328, 3328, 7340032, 1048576, 32768, 8, 58249216, 114688, 0, 0, 218103940, 0
    .long 2, 64, 72, 7168, 2816, 2816, 7340032, 2621440, 32768, 8, 63746048, 114688, 0, 0, 218104132, 0
    .long 5, 218108720, 0, 0, 12, 0, 0, 24, 0, 0, 0, 0, 218112128, 27, 218107076, 0
    .long 5, 218109216, 0, 0, 8, 0, 0, 40, 0, 0, 0, 0, 218112128, 43, 218107204, 0
    .long 1, 40, 40, 2048, 2098176, 2098432, 8388608, 184582144, 131072, 8, 81805312, 32768, 218107140, 4, 218106628, 0
    .long 6, 0, 0, 0, 1, 0, 0, 31, 0, 0, 0, 0, 0, 0, 0, 0
    .long 6, 0, 0, 0, 1, 0, 0, 52, 0, 0, 0, 0, 0, 0, 0, 0
    .long 0, 0, 0, 0, 0, 0, 0, 0, 0, 0, 0, 0, 0, 0, 0, 0
    .long 0, 0, 0, 0, 0, 0, 0, 0, 0, 0, 0, 0, 0, 0, 0, 0
    .long 0, 0, 0, 0, 0, 0, 0, 0, 0, 0, 0, 0, 0, 0, 0, 0
    .long 0, 0, 0, 0, 0, 0, 0, 0, 0, 0, 0, 0, 0, 0, 0, 0
    .long 4, 24, 24, 8192, 5120, 267264, 8388608, 0, 32768, 4, 21053440, 131072, 0, 0, 218104401, 0
    .long 4, 24, 24, 8192, 5120, 267264, 8388608, 262144, 32768, 4, 22102016, 131072, 0, 0, 218104404, 0
    .long 1, 24, 24, 8192, 4096, 4352, 8388608, 3145728, 32768, 8, 33619968, 131072, 0, 0, 218105930, 0
    .long 2, 64, 72, 7168, 4096, 4096, 7340032, 1572864, 32768, 8, 60096512, 114688, 0, 0, 218104017, 0
    .long 2, 64, 72, 7168, 5120, 5120, 7340032, 1048576, 32768, 8, 58277888, 114688, 0, 0, 218103953, 0
    .long 2, 64, 72, 7168, 4608, 4608, 7340032, 2621440, 32768, 8, 63774720, 114688, 0, 0, 218104145, 0
    .long 5, 218108752, 0, 0, 20, 0, 0, 24, 0, 0, 0, 0, 218112256, 27, 218107089, 0
    .long 5, 218109248, 0, 0, 16, 0, 0, 40, 0, 0, 0, 0, 218112256, 43, 218107217, 0
    .long 1, 40, 40, 2048, 4195328, 4195584, 8388608, 184614912, 131072, 8, 85999616, 32768, 218107152, 4, 218106628, 0
    .long 6, 0, 0, 0, 2, 0, 0, 31, 0, 0, 0, 0, 0, 0, 0, 0
    .long 6, 0, 0, 0, 2, 0, 0, 52, 0, 0, 0, 0, 0, 0, 0, 0
    .long 0, 0, 0, 0, 0, 0, 0, 0, 0, 0, 0, 0, 0, 0, 0, 0
    .long 0, 0, 0, 0, 0, 0, 0, 0, 0, 0, 0, 0, 0, 0, 0, 0
    .long 0, 0, 0, 0, 0, 0, 0, 0, 0, 0, 0, 0, 0, 0, 0, 0
    .long 0, 0, 0, 0, 0, 0, 0, 0, 0, 0, 0, 0, 0, 0, 0, 0
    .long 4, 24, 24, 8192, 7168, 269312, 8388608, 0, 32768, 4, 21086208, 131072, 0, 0, 218104433, 0
    .long 4, 24, 24, 8192, 7168, 269312, 8388608, 262144, 32768, 4, 22134784, 131072, 0, 0, 218104436, 0
    .long 1, 24, 24, 8192, 6144, 6400, 8388608, 3145728, 32768, 8, 33652736, 131072, 0, 0, 218105962, 0
    .long 2, 64, 72, 7168, 5888, 5888, 7340032, 1572864, 32768, 8, 60125184, 114688, 0, 0, 218104020, 0
    .long 2, 64, 72, 7168, 6912, 6912, 7340032, 1048576, 32768, 8, 58306560, 114688, 0, 0, 218103956, 0
    .long 2, 64, 72, 7168, 6400, 6400, 7340032, 2621440, 32768, 8, 63803392, 114688, 0, 0, 218104148, 0
    .long 5, 218108784, 0, 0, 28, 0, 0, 24, 0, 0, 0, 0, 218112384, 27, 218107092, 0
    .long 5, 218109280, 0, 0, 24, 0, 0, 40, 0, 0, 0, 0, 218112384, 43, 218107220, 0
    .long 1, 40, 40, 2048, 6292480, 6292736, 8388608, 184647680, 131072, 8, 90193920, 32768, 218107156, 4, 218106628, 0
    .long 6, 0, 0, 0, 3, 0, 0, 31, 0, 0, 0, 0, 0, 0, 0, 0
    .long 6, 0, 0, 0, 3, 0, 0, 52, 0, 0, 0, 0, 0, 0, 0, 0
    .long 0, 0, 0, 0, 0, 0, 0, 0, 0, 0, 0, 0, 0, 0, 0, 0
    .long 0, 0, 0, 0, 0, 0, 0, 0, 0, 0, 0, 0, 0, 0, 0, 0
    .long 0, 0, 0, 0, 0, 0, 0, 0, 0, 0, 0, 0, 0, 0, 0, 0
    .long 0, 0, 0, 0, 0, 0, 0, 0, 0, 0, 0, 0, 0, 0, 0, 0
    .long 4, 24, 24, 8192, 1280, 263424, 8388608, 0, 32768, 4, 20992000, 131072, 0, 0, 218104337, 0
    .long 4, 24, 24, 8192, 1280, 263424, 8388608, 262144, 32768, 4, 22040576, 131072, 0, 0, 218104340, 0
    .long 1, 16, 16, 8192, 1024, 1280, 8388608, 3145728, 32768, 8, 16793600, 131072, 0, 0, 218105882, 0
    .long 1, 16, 16, 8192, 0, 256, 8388608, 524288, 32768, 8, 6291456, 131072, 0, 0, 218108170, 0
    .long 2, 64, 72, 7168, 512, 512, 7340032, 0, 32768, 8, 54534144, 114688, 0, 0, 218103809, 0
    .long 1, 16, 16, 8192, 512, 768, 8388608, 3670016, 32768, 8, 18882560, 131072, 0, 0, 218106122, 0
    .long 5, 218108944, 0, 0, 4, 0, 0, 32, 0, 0, 0, 0, 218112000, 35, 218107137, 0
    .long 1, 80, 80, 2048, 0, 256, 7340032, 60030976, 114688, 7, 119013376, 32768, 218104000, 7, 218106561, 0
    .long 1, 80, 80, 2048, 0, 256, 7340032, 67371008, 114688, 7, 121110528, 32768, 218104256, 7, 218106817, 0
    .long 6, 0, 0, 0, 0, 0, 0, 55, 0, 0, 0, 0, 0, 0, 0, 0
    .long 7, 0, 0, 0, 3, 0, 0, 63, 0, 0, 0, 0, 0, 0, 0, 0
    .long 0, 0, 0, 0, 0, 0, 0, 0, 0, 0, 0, 0, 0, 0, 0, 0
    .long 0, 0, 0, 0, 0, 0, 0, 0, 0, 0, 0, 0, 0, 0, 0, 0
    .long 0, 0, 0, 0, 0, 0, 0, 0, 0, 0, 0, 0, 0, 0, 0, 0
    .long 0, 0, 0, 0, 0, 0, 0, 0, 0, 0, 0, 0, 0, 0, 0, 0
    .long 4, 24, 24, 8192, 3328, 265472, 8388608, 0, 32768, 4, 21024768, 131072, 0, 0, 218104369, 0
    .long 4, 24, 24, 8192, 3328, 265472, 8388608, 262144, 32768, 4, 22073344, 131072, 0, 0, 218104372, 0
    .long 1, 16, 16, 8192, 3072, 3328, 8388608, 3145728, 32768, 8, 16826368, 131072, 0, 0, 218105914, 0
    .long 1, 16, 16, 8192, 2048, 2304, 8388608, 524288, 32768, 8, 6324224, 131072, 0, 0, 218108202, 0
    .long 2, 64, 72, 7168, 2304, 2304, 7340032, 0, 32768, 8, 54562816, 114688, 0, 0, 218103812, 0
    .long 1, 16, 16, 8192, 2560, 2816, 8388608, 3670016, 32768, 8, 18915328, 131072, 0, 0, 218106154, 0
    .long 5, 218108976, 0, 0, 12, 0, 0, 32, 0, 0, 0, 0, 218112128, 35, 218107140, 0
    .long 1, 80, 80, 2048, 1835008, 1835264, 7340032, 60059648, 114688, 7, 123207680, 32768, 218104004, 7, 218106561, 0
    .long 1, 80, 80, 2048, 1835008, 1835264, 7340032, 67399680, 114688, 7, 125304832, 32768, 218104260, 7, 218106817, 0
    .long 6, 0, 0, 0, 1, 0, 0, 55, 0, 0, 0, 0, 0, 0, 0, 0
    .long 7, 0, 0, 0, 7, 0, 0, 63, 0, 0, 0, 0, 0, 0, 0, 0
    .long 0, 0, 0, 0, 0, 0, 0, 0, 0, 0, 0, 0, 0, 0, 0, 0
    .long 0, 0, 0, 0, 0, 0, 0, 0, 0, 0, 0, 0, 0, 0, 0, 0
    .long 0, 0, 0, 0, 0, 0, 0, 0, 0, 0, 0, 0, 0, 0, 0, 0
    .long 0, 0, 0, 0, 0, 0, 0, 0, 0, 0, 0, 0, 0, 0, 0, 0
    .long 4, 24, 24, 8192, 5376, 267520, 8388608, 0, 32768, 4, 21057536, 131072, 0, 0, 218104401, 0
    .long 4, 24, 24, 8192, 5376, 267520, 8388608, 262144, 32768, 4, 22106112, 131072, 0, 0, 218104404, 0
    .long 1, 16, 16, 8192, 5120, 5376, 8388608, 3145728, 32768, 8, 16859136, 131072, 0, 0, 218105946, 0
    .long 1, 16, 16, 8192, 4096, 4352, 8388608, 524288, 32768, 8, 6356992, 131072, 0, 0, 218108234, 0
    .long 2, 64, 72, 7168, 4096, 4096, 7340032, 0, 32768, 8, 54591488, 114688, 0, 0, 218103825, 0
    .long 1, 16, 16, 8192, 4608, 4864, 8388608, 3670016, 32768, 8, 18948096, 131072, 0, 0, 218106186, 0
    .long 5, 218109008, 0, 0, 20, 0, 0, 32, 0, 0, 0, 0, 218112256, 35, 218107153, 0
    .long 1, 80, 80, 2048, 3670016, 3670272, 7340032, 60088320, 114688, 7, 127401984, 32768, 218104016, 7, 218106561, 0
    .long 1, 80, 80, 2048, 3670016, 3670272, 7340032, 67428352, 114688, 7, 129499136, 32768, 218104272, 7, 218106817, 0
    .long 6, 0, 0, 0, 2, 0, 0, 55, 0, 0, 0, 0, 0, 0, 0, 0
    .long 7, 0, 0, 0, 11, 0, 0, 63, 0, 0, 0, 0, 0, 0, 0, 0
    .long 0, 0, 0, 0, 0, 0, 0, 0, 0, 0, 0, 0, 0, 0, 0, 0
    .long 0, 0, 0, 0, 0, 0, 0, 0, 0, 0, 0, 0, 0, 0, 0, 0
    .long 0, 0, 0, 0, 0, 0, 0, 0, 0, 0, 0, 0, 0, 0, 0, 0
    .long 0, 0, 0, 0, 0, 0, 0, 0, 0, 0, 0, 0, 0, 0, 0, 0
    .long 4, 24, 24, 8192, 7424, 269568, 8388608, 0, 32768, 4, 21090304, 131072, 0, 0, 218104433, 0
    .long 4, 24, 24, 8192, 7424, 269568, 8388608, 262144, 32768, 4, 22138880, 131072, 0, 0, 218104436, 0
    .long 1, 16, 16, 8192, 7168, 7424, 8388608, 3145728, 32768, 8, 16891904, 131072, 0, 0, 218105978, 0
    .long 1, 16, 16, 8192, 6144, 6400, 8388608, 524288, 32768, 8, 6389760, 131072, 0, 0, 218108266, 0
    .long 2, 64, 72, 7168, 5888, 5888, 7340032, 0, 32768, 8, 54620160, 114688, 0, 0, 218103828, 0
    .long 1, 16, 16, 8192, 6656, 6912, 8388608, 3670016, 32768, 8, 18980864, 131072, 0, 0, 218106218, 0
    .long 5, 218109040, 0, 0, 28, 0, 0, 32, 0, 0, 0, 0, 218112384, 35, 218107156, 0
    .long 1, 80, 80, 2048, 5505024, 5505280, 7340032, 60116992, 114688, 7, 131596288, 32768, 218104020, 7, 218106561, 0
    .long 1, 80, 80, 2048, 5505024, 5505280, 7340032, 67457024, 114688, 7, 133693440, 32768, 218104276, 7, 218106817, 0
    .long 6, 0, 0, 0, 3, 0, 0, 55, 0, 0, 0, 0, 0, 0, 0, 0
    .long 7, 0, 0, 0, 15, 0, 0, 63, 0, 0, 0, 0, 0, 0, 0, 0
    .long 0, 0, 0, 0, 0, 0, 0, 0, 0, 0, 0, 0, 0, 0, 0, 0
    .long 0, 0, 0, 0, 0, 0, 0, 0, 0, 0, 0, 0, 0, 0, 0, 0
    .long 0, 0, 0, 0, 0, 0, 0, 0, 0, 0, 0, 0, 0, 0, 0, 0
    .long 0, 0, 0, 0, 0, 0, 0, 0, 0, 0, 0, 0, 0, 0, 0, 0
    .long 4, 24, 24, 8192, 1536, 263680, 8388608, 0, 32768, 4, 20996096, 131072, 0, 0, 218104337, 0
    .long 4, 24, 24, 8192, 1536, 263680, 8388608, 262144, 32768, 4, 22044672, 131072, 0, 0, 218104340, 0
    .long 1, 32, 32, 8192, 0, 256, 8388608, 2621440, 32768, 8, 48234496, 131072, 0, 0, 218105610, 0
    .long 1, 16, 16, 8192, 1024, 1280, 8388608, 2621440, 32768, 8, 14696448, 131072, 0, 0, 218109210, 0
    .long 2, 64, 72, 7168, 1280, 1280, 7340032, 2097152, 32768, 8, 61886464, 114688, 0, 0, 218104065, 0
    .long 5, 218108160, 0, 0, 0, 0, 0, 8, 0, 0, 0, 0, 218112000, 11, 218106945, 0
    .long 1, 16, 16, 8192, 1024, 1280, 8388608, 3670016, 32768, 8, 18890752, 131072, 0, 0, 218106138, 0
    .long 1, 40, 40, 2048, 0, 256, 8388608, 176160768, 131072, 8, 75497472, 32768, 218106880, 4, 218106372, 0
    .long 1, 80, 80, 2048, 512, 768, 7340032, 63700992, 114688, 7, 120070144, 32768, 218104128, 7, 218106689, 0
    .long 6, 0, 0, 0, 0, 0, 0, 41, 0, 0, 0, 0, 0, 0, 0, 0
    .long 0, 0, 0, 0, 0, 0, 0, 0, 0, 0, 0, 0, 0, 0, 0, 0
    .long 0, 0, 0, 0, 0, 0, 0, 0, 0, 0, 0, 0, 0, 0, 0, 0
    .long 0, 0, 0, 0, 0, 0, 0, 0, 0, 0, 0, 0, 0, 0, 0, 0
    .long 0, 0, 0, 0, 0, 0, 0, 0, 0, 0, 0, 0, 0, 0, 0, 0
    .long 0, 0, 0, 0, 0, 0, 0, 0, 0, 0, 0, 0, 0, 0, 0, 0
    .long 4, 24, 24, 8192, 3584, 265728, 8388608, 0, 32768, 4, 21028864, 131072, 0, 0, 218104369, 0
    .long 4, 24, 24, 8192, 3584, 265728, 8388608, 262144, 32768, 4, 22077440, 131072, 0, 0, 218104372, 0
    .long 1, 32, 32, 8192, 2048, 2304, 8388608, 2621440, 32768, 8, 48267264, 131072, 0, 0, 218105642, 0
    .long 1, 16, 16, 8192, 3072, 3328, 8388608, 2621440, 32768, 8, 14729216, 131072, 0, 0, 218109242, 0
    .long 2, 64, 72, 7168, 3072, 3072, 7340032, 2097152, 32768, 8, 61915136, 114688, 0, 0, 218104068, 0
    .long 5, 218108192, 0, 0, 8, 0, 0, 8, 0, 0, 0, 0, 218112128, 11, 218106948, 0
    .long 1, 16, 16, 8192, 3072, 3328, 8388608, 3670016, 32768, 8, 18923520, 131072, 0, 0, 218106170, 0
    .long 1, 40, 40, 2048, 2097152, 2097408, 8388608, 176193536, 131072, 8, 79691776, 32768, 218106884, 4, 218106372, 0
    .long 1, 80, 80, 2048, 1835520, 1835776, 7340032, 63729664, 114688, 7, 124264448, 32768, 218104132, 7, 218106689, 0
    .long 6, 0, 0, 0, 1, 0, 0, 41, 0, 0, 0, 0, 0, 0, 0, 0
    .long 0, 0, 0, 0, 0, 0, 0, 0, 0, 0, 0, 0, 0, 0, 0, 0
    .long 0, 0, 0, 0, 0, 0, 0, 0, 0, 0, 0, 0, 0, 0, 0, 0
    .long 0, 0, 0, 0, 0, 0, 0, 0, 0, 0, 0, 0, 0, 0, 0, 0
    .long 0, 0, 0, 0, 0, 0, 0, 0, 0, 0, 0, 0, 0, 0, 0, 0
    .long 0, 0, 0, 0, 0, 0, 0, 0, 0, 0, 0, 0, 0, 0, 0, 0
    .long 4, 24, 24, 8192, 5632, 267776, 8388608, 0, 32768, 4, 21061632, 131072, 0, 0, 218104401, 0
    .long 4, 24, 24, 8192, 5632, 267776, 8388608, 262144, 32768, 4, 22110208, 131072, 0, 0, 218104404, 0
    .long 1, 32, 32, 8192, 4096, 4352, 8388608, 2621440, 32768, 8, 48300032, 131072, 0, 0, 218105674, 0
    .long 1, 16, 16, 8192, 5120, 5376, 8388608, 2621440, 32768, 8, 14761984, 131072, 0, 0, 218109274, 0
    .long 2, 64, 72, 7168, 4864, 4864, 7340032, 2097152, 32768, 8, 61943808, 114688, 0, 0, 218104081, 0
    .long 5, 218108224, 0, 0, 16, 0, 0, 8, 0, 0, 0, 0, 218112256, 11, 218106961, 0
    .long 1, 16, 16, 8192, 5120, 5376, 8388608, 3670016, 32768, 8, 18956288, 131072, 0, 0, 218106202, 0
    .long 1, 40, 40, 2048, 4194304, 4194560, 8388608, 176226304, 131072, 8, 83886080, 32768, 218106896, 4, 218106372, 0
    .long 1, 80, 80, 2048, 3670528, 3670784, 7340032, 63758336, 114688, 7, 128458752, 32768, 218104144, 7, 218106689, 0
    .long 6, 0, 0, 0, 2, 0, 0, 41, 0, 0, 0, 0, 0, 0, 0, 0
    .long 0, 0, 0, 0, 0, 0, 0, 0, 0, 0, 0, 0, 0, 0, 0, 0
    .long 0, 0, 0, 0, 0, 0, 0, 0, 0, 0, 0, 0, 0, 0, 0, 0
    .long 0, 0, 0, 0, 0, 0, 0, 0, 0, 0, 0, 0, 0, 0, 0, 0
    .long 0, 0, 0, 0, 0, 0, 0, 0, 0, 0, 0, 0, 0, 0, 0, 0
    .long 0, 0, 0, 0, 0, 0, 0, 0, 0, 0, 0, 0, 0, 0, 0, 0
    .long 4, 24, 24, 8192, 7680, 269824, 8388608, 0, 32768, 4, 21094400, 131072, 0, 0, 218104433, 0
    .long 4, 24, 24, 8192, 7680, 269824, 8388608, 262144, 32768, 4, 22142976, 131072, 0, 0, 218104436, 0
    .long 1, 32, 32, 8192, 6144, 6400, 8388608, 2621440, 32768, 8, 48332800, 131072, 0, 0, 218105706, 0
    .long 1, 16, 16, 8192, 7168, 7424, 8388608, 2621440, 32768, 8, 14794752, 131072, 0, 0, 218109306, 0
    .long 2, 64, 72, 7168, 6656, 6656, 7340032, 2097152, 32768, 8, 61972480, 114688, 0, 0, 218104084, 0
    .long 5, 218108256, 0, 0, 24, 0, 0, 8, 0, 0, 0, 0, 218112384, 11, 218106964, 0
    .long 1, 16, 16, 8192, 7168, 7424, 8388608, 3670016, 32768, 8, 18989056, 131072, 0, 0, 218106234, 0
    .long 1, 40, 40, 2048, 6291456, 6291712, 8388608, 176259072, 131072, 8, 88080384, 32768, 218106900, 4, 218106372, 0
    .long 1, 80, 80, 2048, 5505536, 5505792, 7340032, 63787008, 114688, 7, 132653056, 32768, 218104148, 7, 218106689, 0
    .long 6, 0, 0, 0, 3, 0, 0, 41, 0, 0, 0, 0, 0, 0, 0, 0
    .long 0, 0, 0, 0, 0, 0, 0, 0, 0, 0, 0, 0, 0, 0, 0, 0
    .long 0, 0, 0, 0, 0, 0, 0, 0, 0, 0, 0, 0, 0, 0, 0, 0
    .long 0, 0, 0, 0, 0, 0, 0, 0, 0, 0, 0, 0, 0, 0, 0, 0
    .long 0, 0, 0, 0, 0, 0, 0, 0, 0, 0, 0, 0, 0, 0, 0, 0
    .long 0, 0, 0, 0, 0, 0, 0, 0, 0, 0, 0, 0, 0, 0, 0, 0
    .long 4, 24, 24, 8192, 1792, 263936, 8388608, 0, 32768, 4, 21000192, 131072, 0, 0, 218104337, 0
    .long 4, 24, 24, 8192, 1792, 263936, 8388608, 262144, 32768, 4, 22048768, 131072, 0, 0, 218104340, 0
    .long 1, 16, 16, 8192, 1536, 1792, 8388608, 3145728, 32768, 8, 16801792, 131072, 0, 0, 218105882, 0
    .long 2, 64, 72, 7168, 512, 512, 7340032, 3670016, 32768, 8, 67379200, 114688, 0, 0, 218104257, 0
    .long 2, 64, 72, 7168, 1536, 1536, 7340032, 0, 32768, 8, 54550528, 114688, 0, 0, 218103809, 0
    .long 5, 218107904, 0, 0, 0, 0, 0, 4, 0, 0, 0, 0, 218112000, 7, 218106881, 0
    .long 1, 40, 40, 2048, 1024, 1280, 8388608, 176160768, 131072, 8, 75513856, 32768, 218106880, 4, 218106372, 0
    .long 1, 40, 40, 2048, 1024, 1280, 8388608, 178257920, 131072, 8, 76038144, 32768, 218106944, 4, 218106436, 0
    .long 1, 80, 80, 2048, 1536, 1792, 7340032, 63700992, 114688, 7, 120086528, 32768, 218104128, 7, 218106689, 0
    .long 6, 0, 0, 0, 0, 0, 0, 47, 0, 0, 0, 0, 0, 0, 0, 0
    .long 0, 0, 0, 0, 0, 0, 0, 0, 0, 0, 0, 0, 0, 0, 0, 0
    .long 0, 0, 0, 0, 0, 0, 0, 0, 0, 0, 0, 0, 0, 0, 0, 0
    .long 0, 0, 0, 0, 0, 0, 0, 0, 0, 0, 0, 0, 0, 0, 0, 0
    .long 0, 0, 0, 0, 0, 0, 0, 0, 0, 0, 0, 0, 0, 0, 0, 0
    .long 0, 0, 0, 0, 0, 0, 0, 0, 0, 0, 0, 0, 0, 0, 0, 0
    .long 4, 24, 24, 8192, 3840, 265984, 8388608, 0, 32768, 4, 21032960, 131072, 0, 0, 218104369, 0
    .long 4, 24, 24, 8192, 3840, 265984, 8388608, 262144, 32768, 4, 22081536, 131072, 0, 0, 218104372, 0
    .long 1, 16, 16, 8192, 3584, 3840, 8388608, 3145728, 32768, 8, 16834560, 131072, 0, 0, 218105914, 0
    .long 2, 64, 72, 7168, 2304, 2304, 7340032, 3670016, 32768, 8, 67407872, 114688, 0, 0, 218104260, 0
    .long 2, 64, 72, 7168, 3328, 3328, 7340032, 0, 32768, 8, 54579200, 114688, 0, 0, 218103812, 0
    .long 5, 218107936, 0, 0, 8, 0, 0, 4, 0, 0, 0, 0, 218112128, 7, 218106884, 0
    .long 1, 40, 40, 2048, 2098176, 2098432, 8388608, 176193536, 131072, 8, 79708160, 32768, 218106884, 4, 218106372, 0
    .long 1, 40, 40, 2048, 2098176, 2098432, 8388608, 178290688, 131072, 8, 80232448, 32768, 218106948, 4, 218106436, 0
    .long 1, 80, 80, 2048, 1836544, 1836800, 7340032, 63729664, 114688, 7, 124280832, 32768, 218104132, 7, 218106689, 0
    .long 6, 0, 0, 0, 1, 0, 0, 47, 0, 0, 0, 0, 0, 0, 0, 0
    .long 0, 0, 0, 0, 0, 0, 0, 0, 0, 0, 0, 0, 0, 0, 0, 0
    .long 0, 0, 0, 0, 0, 0, 0, 0, 0, 0, 0, 0, 0, 0, 0, 0
    .long 0, 0, 0, 0, 0, 0, 0, 0, 0, 0, 0, 0, 0, 0, 0, 0
    .long 0, 0, 0, 0, 0, 0, 0, 0, 0, 0, 0, 0, 0, 0, 0, 0
    .long 0, 0, 0, 0, 0, 0, 0, 0, 0, 0, 0, 0, 0, 0, 0, 0
    .long 4, 24, 24, 8192, 5888, 268032, 8388608, 0, 32768, 4, 21065728, 131072, 0, 0, 218104401, 0
    .long 4, 24, 24, 8192, 5888, 268032, 8388608, 262144, 32768, 4, 22114304, 131072, 0, 0, 218104404, 0
    .long 1, 16, 16, 8192, 5632, 5888, 8388608, 3145728, 32768, 8, 16867328, 131072, 0, 0, 218105946, 0
    .long 2, 64, 72, 7168, 4096, 4096, 7340032, 3670016, 32768, 8, 67436544, 114688, 0, 0, 218104273, 0
    .long 2, 64, 72, 7168, 5120, 5120, 7340032, 0, 32768, 8, 54607872, 114688, 0, 0, 218103825, 0
    .long 5, 218107968, 0, 0, 16, 0, 0, 4, 0, 0, 0, 0, 218112256, 7, 218106897, 0
    .long 1, 40, 40, 2048, 4195328, 4195584, 8388608, 176226304, 131072, 8, 83902464, 32768, 218106896, 4, 218106372, 0
    .long 1, 40, 40, 2048, 4195328, 4195584, 8388608, 178323456, 131072, 8, 84426752, 32768, 218106960, 4, 218106436, 0
    .long 1, 80, 80, 2048, 3671552, 3671808, 7340032, 63758336, 114688, 7, 128475136, 32768, 218104144, 7, 218106689, 0
    .long 6, 0, 0, 0, 2, 0, 0, 47, 0, 0, 0, 0, 0, 0, 0, 0
    .long 0, 0, 0, 0, 0, 0, 0, 0, 0, 0, 0, 0, 0, 0, 0, 0
    .long 0, 0, 0, 0, 0, 0, 0, 0, 0, 0, 0, 0, 0, 0, 0, 0
    .long 0, 0, 0, 0, 0, 0, 0, 0, 0, 0, 0, 0, 0, 0, 0, 0
    .long 0, 0, 0, 0, 0, 0, 0, 0, 0, 0, 0, 0, 0, 0, 0, 0
    .long 0, 0, 0, 0, 0, 0, 0, 0, 0, 0, 0, 0, 0, 0, 0, 0
    .long 4, 24, 24, 8192, 7936, 270080, 8388608, 0, 32768, 4, 21098496, 131072, 0, 0, 218104433, 0
    .long 4, 24, 24, 8192, 7936, 270080, 8388608, 262144, 32768, 4, 22147072, 131072, 0, 0, 218104436, 0
    .long 1, 16, 16, 8192, 7680, 7936, 8388608, 3145728, 32768, 8, 16900096, 131072, 0, 0, 218105978, 0
    .long 2, 64, 72, 7168, 5888, 5888, 7340032, 3670016, 32768, 8, 67465216, 114688, 0, 0, 218104276, 0
    .long 2, 64, 72, 7168, 6912, 6912, 7340032, 0, 32768, 8, 54636544, 114688, 0, 0, 218103828, 0
    .long 5, 218108000, 0, 0, 24, 0, 0, 4, 0, 0, 0, 0, 218112384, 7, 218106900, 0
    .long 1, 40, 40, 2048, 6292480, 6292736, 8388608, 176259072, 131072, 8, 88096768, 32768, 218106900, 4, 218106372, 0
    .long 1, 40, 40, 2048, 6292480, 6292736, 8388608, 178356224, 131072, 8, 88621056, 32768, 218106964, 4, 218106436, 0
    .long 1, 80, 80, 2048, 5506560, 5506816, 7340032, 63787008, 114688, 7, 132669440, 32768, 218104148, 7, 218106689, 0
    .long 6, 0, 0, 0, 3, 0, 0, 47, 0, 0, 0, 0, 0, 0, 0, 0
    .long 0, 0, 0, 0, 0, 0, 0, 0, 0, 0, 0, 0, 0, 0, 0, 0
    .long 0, 0, 0, 0, 0, 0, 0, 0, 0, 0, 0, 0, 0, 0, 0, 0
    .long 0, 0, 0, 0, 0, 0, 0, 0, 0, 0, 0, 0, 0, 0, 0, 0
    .long 0, 0, 0, 0, 0, 0, 0, 0, 0, 0, 0, 0, 0, 0, 0, 0
    .long 0, 0, 0, 0, 0, 0, 0, 0, 0, 0, 0, 0, 0, 0, 0, 0
    .long 4, 32, 32, 8192, 0, 262144, 8388608, 0, 32768, 4, 37748736, 131072, 0, 0, 218104321, 0
    .long 4, 32, 32, 8192, 0, 262144, 8388608, 262144, 32768, 4, 38797312, 131072, 0, 0, 218104324, 0
    .long 1, 16, 16, 8192, 1024, 1280, 8388608, 524288, 32768, 8, 6307840, 131072, 0, 0, 218108186, 0
    .long 1, 16, 16, 8192, 512, 768, 8388608, 524288, 32768, 8, 6299648, 131072, 0, 0, 218108170, 0
    .long 2, 64, 72, 7168, 1280, 1280, 7340032, 1048576, 32768, 8, 58216448, 114688, 0, 0, 218103937, 0
    .long 2, 64, 72, 7168, 1024, 1024, 7340032, 0, 32768, 8, 54542336, 114688, 0, 0, 218103809, 0
    .long 2, 64, 72, 7168, 256, 256, 7340032, 3670016, 32768, 8, 67375104, 114688, 0, 0, 218104257, 0
    .long 1, 80, 80, 2048, 1024, 1280, 7340032, 56360960, 114688, 7, 117981184, 32768, 218103872, 7, 218106433, 0
    .long 6, 0, 0, 0, 0, 0, 0, 1, 0, 0, 0, 0, 0, 0, 0, 0
    .long 6, 0, 0, 0, 0, 0, 0, 20, 0, 0, 0, 0, 0, 0, 0, 0
    .long 6, 0, 0, 0, 0, 0, 0, 50, 0, 0, 0, 0, 0, 0, 0, 0
    .long 7, 0, 0, 0, 1, 0, 0, 63, 0, 0, 0, 0, 0, 0, 0, 0
    .long 0, 0, 0, 0, 0, 0, 0, 0, 0, 0, 0, 0, 0, 0, 0, 0
    .long 0, 0, 0, 0, 0, 0, 0, 0, 0, 0, 0, 0, 0, 0, 0, 0
    .long 0, 0, 0, 0, 0, 0, 0, 0, 0, 0, 0, 0, 0, 0, 0, 0
    .long 4, 32, 32, 8192, 2048, 264192, 8388608, 0, 32768, 4, 37781504, 131072, 0, 0, 218104353, 0
    .long 4, 32, 32, 8192, 2048, 264192, 8388608, 262144, 32768, 4, 38830080, 131072, 0, 0, 218104356, 0
    .long 1, 16, 16, 8192, 3072, 3328, 8388608, 524288, 32768, 8, 6340608, 131072, 0, 0, 218108218, 0
    .long 1, 16, 16, 8192, 2560, 2816, 8388608, 524288, 32768, 8, 6332416, 131072, 0, 0, 218108202, 0
    .long 2, 64, 72, 7168, 3072, 3072, 7340032, 1048576, 32768, 8, 58245120, 114688, 0, 0, 218103940, 0
    .long 2, 64, 72, 7168, 2816, 2816, 7340032, 0, 32768, 8, 54571008, 114688, 0, 0, 218103812, 0
    .long 2, 64, 72, 7168, 2048, 2048, 7340032, 3670016, 32768, 8, 67403776, 114688, 0, 0, 218104260, 0
    .long 1, 80, 80, 2048, 1836032, 1836288, 7340032, 56389632, 114688, 7, 122175488, 32768, 218103876, 7, 218106433, 0
    .long 6, 0, 0, 0, 1, 0, 0, 1, 0, 0, 0, 0, 0, 0, 0, 0
    .long 6, 0, 0, 0, 1, 0, 0, 20, 0, 0, 0, 0, 0, 0, 0, 0
    .long 6, 0, 0, 0, 1, 0, 0, 50, 0, 0, 0, 0, 0, 0, 0, 0
    .long 7, 0, 0, 0, 5, 0, 0, 63, 0, 0, 0, 0, 0, 0, 0, 0
    .long 0, 0, 0, 0, 0, 0, 0, 0, 0, 0, 0, 0, 0, 0, 0, 0
    .long 0, 0, 0, 0, 0, 0, 0, 0, 0, 0, 0, 0, 0, 0, 0, 0
    .long 0, 0, 0, 0, 0, 0, 0, 0, 0, 0, 0, 0, 0, 0, 0, 0
    .long 4, 32, 32, 8192, 4096, 266240, 8388608, 0, 32768, 4, 37814272, 131072, 0, 0, 218104385, 0
    .long 4, 32, 32, 8192, 4096, 266240, 8388608, 262144, 32768, 4, 38862848, 131072, 0, 0, 218104388, 0
    .long 1, 16, 16, 8192, 5120, 5376, 8388608, 524288, 32768, 8, 6373376, 131072, 0, 0, 218108250, 0
    .long 1, 16, 16, 8192, 4608, 4864, 8388608, 524288, 32768, 8, 6365184, 131072, 0, 0, 218108234, 0
    .long 2, 64, 72, 7168, 4864, 4864, 7340032, 1048576, 32768, 8, 58273792, 114688, 0, 0, 218103953, 0
    .long 2, 64, 72, 7168, 4608, 4608, 7340032, 0, 32768, 8, 54599680, 114688, 0, 0, 218103825, 0
    .long 2, 64, 72, 7168, 3840, 3840, 7340032, 3670016, 32768, 8, 67432448, 114688, 0, 0, 218104273, 0
    .long 1, 80, 80, 2048, 3671040, 3671296, 7340032, 56418304, 114688, 7, 126369792, 32768, 218103888, 7, 218106433, 0
    .long 6, 0, 0, 0, 2, 0, 0, 1, 0, 0, 0, 0, 0, 0, 0, 0
    .long 6, 0, 0, 0, 2, 0, 0, 20, 0, 0, 0, 0, 0, 0, 0, 0
    .long 6, 0, 0, 0, 2, 0, 0, 50, 0, 0, 0, 0, 0, 0, 0, 0
    .long 7, 0, 0, 0, 9, 0, 0, 63, 0, 0, 0, 0, 0, 0, 0, 0
    .long 0, 0, 0, 0, 0, 0, 0, 0, 0, 0, 0, 0, 0, 0, 0, 0
    .long 0, 0, 0, 0, 0, 0, 0, 0, 0, 0, 0, 0, 0, 0, 0, 0
    .long 0, 0, 0, 0, 0, 0, 0, 0, 0, 0, 0, 0, 0, 0, 0, 0
    .long 4, 32, 32, 8192, 6144, 268288, 8388608, 0, 32768, 4, 37847040, 131072, 0, 0, 218104417, 0
    .long 4, 32, 32, 8192, 6144, 268288, 8388608, 262144, 32768, 4, 38895616, 131072, 0, 0, 218104420, 0
    .long 1, 16, 16, 8192, 7168, 7424, 8388608, 524288, 32768, 8, 6406144, 131072, 0, 0, 218108282, 0
    .long 1, 16, 16, 8192, 6656, 6912, 8388608, 524288, 32768, 8, 6397952, 131072, 0, 0, 218108266, 0
    .long 2, 64, 72, 7168, 6656, 6656, 7340032, 1048576, 32768, 8, 58302464, 114688, 0, 0, 218103956, 0
    .long 2, 64, 72, 7168, 6400, 6400, 7340032, 0, 32768, 8, 54628352, 114688, 0, 0, 218103828, 0
    .long 2, 64, 72, 7168, 5632, 5632, 7340032, 3670016, 32768, 8, 67461120, 114688, 0, 0, 218104276, 0
    .long 1, 80, 80, 2048, 5506048, 5506304, 7340032, 56446976, 114688, 7, 130564096, 32768, 218103892, 7, 218106433, 0
    .long 6, 0, 0, 0, 3, 0, 0, 1, 0, 0, 0, 0, 0, 0, 0, 0
    .long 6, 0, 0, 0, 3, 0, 0, 20, 0, 0, 0, 0, 0, 0, 0, 0
    .long 6, 0, 0, 0, 3, 0, 0, 50, 0, 0, 0, 0, 0, 0, 0, 0
    .long 7, 0, 0, 0, 13, 0, 0, 63, 0, 0, 0, 0, 0, 0, 0, 0
    .long 0, 0, 0, 0, 0, 0, 0, 0, 0, 0, 0, 0, 0, 0, 0, 0
    .long 0, 0, 0, 0, 0, 0, 0, 0, 0, 0, 0, 0, 0, 0, 0, 0
    .long 0, 0, 0, 0, 0, 0, 0, 0, 0, 0, 0, 0, 0, 0, 0, 0
    .long 4, 32, 32, 8192, 256, 262400, 8388608, 0, 32768, 4, 37752832, 131072, 0, 0, 218104321, 0
    .long 4, 32, 32, 8192, 256, 262400, 8388608, 262144, 32768, 4, 38801408, 131072, 0, 0, 218104324, 0
    .long 1, 24, 24, 8192, 0, 256, 8388608, 2621440, 32768, 8, 31457280, 131072, 0, 0, 218105610, 0
    .long 1, 16, 16, 8192, 1536, 1792, 8388608, 3670016, 32768, 8, 18898944, 131072, 0, 0, 218106138, 0
    .long 2, 64, 72, 7168, 256, 256, 7340032, 0, 32768, 8, 54530048, 114688, 0, 0, 218103809, 0
    .long 2, 64, 72, 7168, 1024, 1024, 7340032, 1048576, 32768, 8, 58212352, 114688, 0, 0, 218103937, 0
    .long 2, 64, 72, 7168, 256, 256, 7340032, 2621440, 32768, 8, 63705088, 114688, 0, 0, 218104129, 0
    .long 1, 40, 40, 2048, 512, 768, 8388608, 180355072, 131072, 8, 76554240, 32768, 218107008, 4, 218106500, 0
    .long 6, 0, 0, 0, 0, 0, 0, 13, 0, 0, 0, 0, 0, 0, 0, 0
    .long 6, 0, 0, 0, 0, 0, 0, 49, 0, 0, 0, 0, 0, 0, 0, 0
    .long 6, 0, 0, 0, 0, 0, 0, 57, 0, 0, 0, 0, 0, 0, 0, 0
    .long 0, 0, 0, 0, 0, 0, 0, 0, 0, 0, 0, 0, 0, 0, 0, 0
    .long 0, 0, 0, 0, 0, 0, 0, 0, 0, 0, 0, 0, 0, 0, 0, 0
    .long 0, 0, 0, 0, 0, 0, 0, 0, 0, 0, 0, 0, 0, 0, 0, 0
    .long 0, 0, 0, 0, 0, 0, 0, 0, 0, 0, 0, 0, 0, 0, 0, 0
    .long 4, 32, 32, 8192, 2304, 264448, 8388608, 0, 32768, 4, 37785600, 131072, 0, 0, 218104353, 0
    .long 4, 32, 32, 8192, 2304, 264448, 8388608, 262144, 32768, 4, 38834176, 131072, 0, 0, 218104356, 0
    .long 1, 24, 24, 8192, 2048, 2304, 8388608, 2621440, 32768, 8, 31490048, 131072, 0, 0, 218105642, 0
    .long 1, 16, 16, 8192, 3584, 3840, 8388608, 3670016, 32768, 8, 18931712, 131072, 0, 0, 218106170, 0
    .long 2, 64, 72, 7168, 2048, 2048, 7340032, 0, 32768, 8, 54558720, 114688, 0, 0, 218103812, 0
    .long 2, 64, 72, 7168, 2816, 2816, 7340032, 1048576, 32768, 8, 58241024, 114688, 0, 0, 218103940, 0
    .long 2, 64, 72, 7168, 2048, 2048, 7340032, 2621440, 32768, 8, 63733760, 114688, 0, 0, 218104132, 0
    .long 1, 40, 40, 2048, 2097664, 2097920, 8388608, 180387840, 131072, 8, 80748544, 32768, 218107012, 4, 218106500, 0
    .long 6, 0, 0, 0, 1, 0, 0, 13, 0, 0, 0, 0, 0, 0, 0, 0
    .long 6, 0, 0, 0, 1, 0, 0, 49, 0, 0, 0, 0, 0, 0, 0, 0
    .long 6, 0, 0, 0, 1, 0, 0, 57, 0, 0, 0, 0, 0, 0, 0, 0
    .long 0, 0, 0, 0, 0, 0, 0, 0, 0, 0, 0, 0, 0, 0, 0, 0
    .long 0, 0, 0, 0, 0, 0, 0, 0, 0, 0, 0, 0, 0, 0, 0, 0
    .long 0, 0, 0, 0, 0, 0, 0, 0, 0, 0, 0, 0, 0, 0, 0, 0
    .long 0, 0, 0, 0, 0, 0, 0, 0, 0, 0, 0, 0, 0, 0, 0, 0
    .long 4, 32, 32, 8192, 4352, 266496, 8388608, 0, 32768, 4, 37818368, 131072, 0, 0, 218104385, 0
    .long 4, 32, 32, 8192, 4352, 266496, 8388608, 262144, 32768, 4, 38866944, 131072, 0, 0, 218104388, 0
    .long 1, 24, 24, 8192, 4096, 4352, 8388608, 2621440, 32768, 8, 31522816, 131072, 0, 0, 218105674, 0
    .long 1, 16, 16, 8192, 5632, 5888, 8388608, 3670016, 32768, 8, 18964480, 131072, 0, 0, 218106202, 0
    .long 2, 64, 72, 7168, 3840, 3840, 7340032, 0, 32768, 8, 54587392, 114688, 0, 0, 218103825, 0
    .long 2, 64, 72, 7168, 4608, 4608, 7340032, 1048576, 32768, 8, 58269696, 114688, 0, 0, 218103953, 0
    .long 2, 64, 72, 7168, 3840, 3840, 7340032, 2621440, 32768, 8, 63762432, 114688, 0, 0, 218104145, 0
    .long 1, 40, 40, 2048, 4194816, 4195072, 8388608, 180420608, 131072, 8, 84942848, 32768, 218107024, 4, 218106500, 0
    .long 6, 0, 0, 0, 2, 0, 0, 13, 0, 0, 0, 0, 0, 0, 0, 0
    .long 6, 0, 0, 0, 2, 0, 0, 49, 0, 0, 0, 0, 0, 0, 0, 0
    .long 6, 0, 0, 0, 2, 0, 0, 57, 0, 0, 0, 0, 0, 0, 0, 0
    .long 0, 0, 0, 0, 0, 0, 0, 0, 0, 0, 0, 0, 0, 0, 0, 0
    .long 0, 0, 0, 0, 0, 0, 0, 0, 0, 0, 0, 0, 0, 0, 0, 0
    .long 0, 0, 0, 0, 0, 0, 0, 0, 0, 0, 0, 0, 0, 0, 0, 0
    .long 0, 0, 0, 0, 0, 0, 0, 0, 0, 0, 0, 0, 0, 0, 0, 0
    .long 4, 32, 32, 8192, 6400, 268544, 8388608, 0, 32768, 4, 37851136, 131072, 0, 0, 218104417, 0
    .long 4, 32, 32, 8192, 6400, 268544, 8388608, 262144, 32768, 4, 38899712, 131072, 0, 0, 218104420, 0
    .long 1, 24, 24, 8192, 6144, 6400, 8388608, 2621440, 32768, 8, 31555584, 131072, 0, 0, 218105706, 0
    .long 1, 16, 16, 8192, 7680, 7936, 8388608, 3670016, 32768, 8, 18997248, 131072, 0, 0, 218106234, 0
    .long 2, 64, 72, 7168, 5632, 5632, 7340032, 0, 32768, 8, 54616064, 114688, 0, 0, 218103828, 0
    .long 2, 64, 72, 7168, 6400, 6400, 7340032, 1048576, 32768, 8, 58298368, 114688, 0, 0, 218103956, 0
    .long 2, 64, 72, 7168, 5632, 5632, 7340032, 2621440, 32768, 8, 63791104, 114688, 0, 0, 218104148, 0
    .long 1, 40, 40, 2048, 6291968, 6292224, 8388608, 180453376, 131072, 8, 89137152, 32768, 218107028, 4, 218106500, 0
    .long 6, 0, 0, 0, 3, 0, 0, 13, 0, 0, 0, 0, 0, 0, 0, 0
    .long 6, 0, 0, 0, 3, 0, 0, 49, 0, 0, 0, 0, 0, 0, 0, 0
    .long 6, 0, 0, 0, 3, 0, 0, 57, 0, 0, 0, 0, 0, 0, 0, 0
    .long 0, 0, 0, 0, 0, 0, 0, 0, 0, 0, 0, 0, 0, 0, 0, 0
    .long 0, 0, 0, 0, 0, 0, 0, 0, 0, 0, 0, 0, 0, 0, 0, 0
    .long 0, 0, 0, 0, 0, 0, 0, 0, 0, 0, 0, 0, 0, 0, 0, 0
    .long 0, 0, 0, 0, 0, 0, 0, 0, 0, 0, 0, 0, 0, 0, 0, 0
    .long 4, 32, 32, 8192, 512, 262656, 8388608, 0, 32768, 4, 37756928, 131072, 0, 0, 218104321, 0
    .long 4, 32, 32, 8192, 512, 262656, 8388608, 262144, 32768, 4, 38805504, 131072, 0, 0, 218104324, 0
    .long 1, 24, 24, 8192, 512, 768, 8388608, 2097152, 32768, 8, 29368320, 131072, 0, 0, 218105354, 0
    .long 1, 32, 32, 8192, 1536, 1792, 8388608, 2621440, 32768, 8, 48259072, 131072, 0, 0, 218105626, 0
    .long 2, 64, 72, 7168, 256, 256, 7340032, 2097152, 32768, 8, 61870080, 114688, 0, 0, 218104065, 0
    .long 5, 218107920, 0, 0, 4, 0, 0, 4, 0, 0, 0, 0, 218112000, 7, 218106881, 0
    .long 5, 218108176, 0, 0, 4, 0, 0, 8, 0, 0, 0, 0, 218112000, 11, 218106945, 0
    .long 5, 218108672, 0, 0, 0, 0, 0, 24, 0, 0, 0, 0, 218112000, 27, 218107073, 0
    .long 1, 80, 80, 2048, 0, 256, 7340032, 54525952, 114688, 7, 117440512, 32768, 218103808, 7, 218106369, 0
    .long 1, 80, 80, 2048, 1024, 1280, 7340032, 63700992, 114688, 7, 120078336, 32768, 218104128, 7, 218106689, 0
    .long 0, 0, 0, 0, 0, 0, 0, 0, 0, 0, 0, 0, 0, 0, 0, 0
    .long 0, 0, 0, 0, 0, 0, 0, 0, 0, 0, 0, 0, 0, 0, 0, 0
    .long 0, 0, 0, 0, 0, 0, 0, 0, 0, 0, 0, 0, 0, 0, 0, 0
    .long 0, 0, 0, 0, 0, 0, 0, 0, 0, 0, 0, 0, 0, 0, 0, 0
    .long 0, 0, 0, 0, 0, 0, 0, 0, 0, 0, 0, 0, 0, 0, 0, 0
    .long 4, 32, 32, 8192, 2560, 264704, 8388608, 0, 32768, 4, 37789696, 131072, 0, 0, 218104353, 0
    .long 4, 32, 32, 8192, 2560, 264704, 8388608, 262144, 32768, 4, 38838272, 131072, 0, 0, 218104356, 0
    .long 1, 24, 24, 8192, 2560, 2816, 8388608, 2097152, 32768, 8, 29401088, 131072, 0, 0, 218105386, 0
    .long 1, 32, 32, 8192, 3584, 3840, 8388608, 2621440, 32768, 8, 48291840, 131072, 0, 0, 218105658, 0
    .long 2, 64, 72, 7168, 2048, 2048, 7340032, 2097152, 32768, 8, 61898752, 114688, 0, 0, 218104068, 0
    .long 5, 218107952, 0, 0, 12, 0, 0, 4, 0, 0, 0, 0, 218112128, 7, 218106884, 0
    .long 5, 218108208, 0, 0, 12, 0, 0, 8, 0, 0, 0, 0, 218112128, 11, 218106948, 0
    .long 5, 218108704, 0, 0, 8, 0, 0, 24, 0, 0, 0, 0, 218112128, 27, 218107076, 0
    .long 1, 80, 80, 2048, 1835008, 1835264, 7340032, 54554624, 114688, 7, 121634816, 32768, 218103812, 7, 218106369, 0
    .long 1, 80, 80, 2048, 1836032, 1836288, 7340032, 63729664, 114688, 7, 124272640, 32768, 218104132, 7, 218106689, 0
    .long 0, 0, 0, 0, 0, 0, 0, 0, 0, 0, 0, 0, 0, 0, 0, 0
    .long 0, 0, 0, 0, 0, 0, 0, 0, 0, 0, 0, 0, 0, 0, 0, 0
    .long 0, 0, 0, 0, 0, 0, 0, 0, 0, 0, 0, 0, 0, 0, 0, 0
    .long 0, 0, 0, 0, 0, 0, 0, 0, 0, 0, 0, 0, 0, 0, 0, 0
    .long 0, 0, 0, 0, 0, 0, 0, 0, 0, 0, 0, 0, 0, 0, 0, 0
    .long 4, 32, 32, 8192, 4608, 266752, 8388608, 0, 32768, 4, 37822464, 131072, 0, 0, 218104385, 0
    .long 4, 32, 32, 8192, 4608, 266752, 8388608, 262144, 32768, 4, 38871040, 131072, 0, 0, 218104388, 0
    .long 1, 24, 24, 8192, 4608, 4864, 8388608, 2097152, 32768, 8, 29433856, 131072, 0, 0, 218105418, 0
    .long 1, 32, 32, 8192, 5632, 5888, 8388608, 2621440, 32768, 8, 48324608, 131072, 0, 0, 218105690, 0
    .long 2, 64, 72, 7168, 3840, 3840, 7340032, 2097152, 32768, 8, 61927424, 114688, 0, 0, 218104081, 0
    .long 5, 218107984, 0, 0, 20, 0, 0, 4, 0, 0, 0, 0, 218112256, 7, 218106897, 0
    .long 5, 218108240, 0, 0, 20, 0, 0, 8, 0, 0, 0, 0, 218112256, 11, 218106961, 0
    .long 5, 218108736, 0, 0, 16, 0, 0, 24, 0, 0, 0, 0, 218112256, 27, 218107089, 0
    .long 1, 80, 80, 2048, 3670016, 3670272, 7340032, 54583296, 114688, 7, 125829120, 32768, 218103824, 7, 218106369, 0
    .long 1, 80, 80, 2048, 3671040, 3671296, 7340032, 63758336, 114688, 7, 128466944, 32768, 218104144, 7, 218106689, 0
    .long 0, 0, 0, 0, 0, 0, 0, 0, 0, 0, 0, 0, 0, 0, 0, 0
    .long 0, 0, 0, 0, 0, 0, 0, 0, 0, 0, 0, 0, 0, 0, 0, 0
    .long 0, 0, 0, 0, 0, 0, 0, 0, 0, 0, 0, 0, 0, 0, 0, 0
    .long 0, 0, 0, 0, 0, 0, 0, 0, 0, 0, 0, 0, 0, 0, 0, 0
    .long 0, 0, 0, 0, 0, 0, 0, 0, 0, 0, 0, 0, 0, 0, 0, 0
    .long 4, 32, 32, 8192, 6656, 268800, 8388608, 0, 32768, 4, 37855232, 131072, 0, 0, 218104417, 0
    .long 4, 32, 32, 8192, 6656, 268800, 8388608, 262144, 32768, 4, 38903808, 131072, 0, 0, 218104420, 0
    .long 1, 24, 24, 8192, 6656, 6912, 8388608, 2097152, 32768, 8, 29466624, 131072, 0, 0, 218105450, 0
    .long 1, 32, 32, 8192, 7680, 7936, 8388608, 2621440, 32768, 8, 48357376, 131072, 0, 0, 218105722, 0
    .long 2, 64, 72, 7168, 5632, 5632, 7340032, 2097152, 32768, 8, 61956096, 114688, 0, 0, 218104084, 0
    .long 5, 218108016, 0, 0, 28, 0, 0, 4, 0, 0, 0, 0, 218112384, 7, 218106900, 0
    .long 5, 218108272, 0, 0, 28, 0, 0, 8, 0, 0, 0, 0, 218112384, 11, 218106964, 0
    .long 5, 218108768, 0, 0, 24, 0, 0, 24, 0, 0, 0, 0, 218112384, 27, 218107092, 0
    .long 1, 80, 80, 2048, 5505024, 5505280, 7340032, 54611968, 114688, 7, 130023424, 32768, 218103828, 7, 218106369, 0
    .long 1, 80, 80, 2048, 5506048, 5506304, 7340032, 63787008, 114688, 7, 132661248, 32768, 218104148, 7, 218106689, 0
    .long 0, 0, 0, 0, 0, 0, 0, 0, 0, 0, 0, 0, 0, 0, 0, 0
    .long 0, 0, 0, 0, 0, 0, 0, 0, 0, 0, 0, 0, 0, 0, 0, 0
    .long 0, 0, 0, 0, 0, 0, 0, 0, 0, 0, 0, 0, 0, 0, 0, 0
    .long 0, 0, 0, 0, 0, 0, 0, 0, 0, 0, 0, 0, 0, 0, 0, 0
    .long 0, 0, 0, 0, 0, 0, 0, 0, 0, 0, 0, 0, 0, 0, 0, 0
    .long 4, 32, 32, 8192, 768, 262912, 8388608, 0, 32768, 4, 37761024, 131072, 0, 0, 218104321, 0
    .long 4, 32, 32, 8192, 768, 262912, 8388608, 262144, 32768, 4, 38809600, 131072, 0, 0, 218104324, 0
    .long 1, 16, 16, 8192, 1536, 1792, 8388608, 1572864, 32768, 8, 10510336, 131072, 0, 0, 218108698, 0
    .long 1, 16, 16, 8192, 512, 768, 8388608, 0, 32768, 8, 4202496, 131072, 0, 0, 218107914, 0
    .long 2, 64, 72, 7168, 256, 256, 7340032, 3145728, 32768, 8, 65540096, 114688, 0, 0, 218104193, 0
    .long 1, 24, 24, 8192, 512, 768, 8388608, 3670016, 32768, 8, 35659776, 131072, 0, 0, 218106122, 0
    .long 5, 218108432, 0, 0, 4, 0, 0, 20, 0, 0, 0, 0, 218112000, 23, 218107009, 0
    .long 1, 40, 40, 2048, 512, 768, 8388608, 178257920, 131072, 8, 76029952, 32768, 218106944, 4, 218106436, 0
    .long 1, 80, 80, 2048, 0, 256, 7340032, 63700992, 114688, 7, 120061952, 32768, 218104128, 7, 218106689, 0
    .long 6, 0, 0, 0, 0, 0, 0, 46, 0, 0, 0, 0, 0, 0, 0, 0
    .long 0, 0, 0, 0, 0, 0, 0, 0, 0, 0, 0, 0, 0, 0, 0, 0
    .long 0, 0, 0, 0, 0, 0, 0, 0, 0, 0, 0, 0, 0, 0, 0, 0
    .long 0, 0, 0, 0, 0, 0, 0, 0, 0, 0, 0, 0, 0, 0, 0, 0
    .long 0, 0, 0, 0, 0, 0, 0, 0, 0, 0, 0, 0, 0, 0, 0, 0
    .long 0, 0, 0, 0, 0, 0, 0, 0, 0, 0, 0, 0, 0, 0, 0, 0
    .long 4, 32, 32, 8192, 2816, 264960, 8388608, 0, 32768, 4, 37793792, 131072, 0, 0, 218104353, 0
    .long 4, 32, 32, 8192, 2816, 264960, 8388608, 262144, 32768, 4, 38842368, 131072, 0, 0, 218104356, 0
    .long 1, 16, 16, 8192, 3584, 3840, 8388608, 1572864, 32768, 8, 10543104, 131072, 0, 0, 218108730, 0
    .long 1, 16, 16, 8192, 2560, 2816, 8388608, 0, 32768, 8, 4235264, 131072, 0, 0, 218107946, 0
    .long 2, 64, 72, 7168, 2048, 2048, 7340032, 3145728, 32768, 8, 65568768, 114688, 0, 0, 218104196, 0
    .long 1, 24, 24, 8192, 2560, 2816, 8388608, 3670016, 32768, 8, 35692544, 131072, 0, 0, 218106154, 0
    .long 5, 218108464, 0, 0, 12, 0, 0, 20, 0, 0, 0, 0, 218112128, 23, 218107012, 0
    .long 1, 40, 40, 2048, 2097664, 2097920, 8388608, 178290688, 131072, 8, 80224256, 32768, 218106948, 4, 218106436, 0
    .long 1, 80, 80, 2048, 1835008, 1835264, 7340032, 63729664, 114688, 7, 124256256, 32768, 218104132, 7, 218106689, 0
    .long 6, 0, 0, 0, 1, 0, 0, 46, 0, 0, 0, 0, 0, 0, 0, 0
    .long 0, 0, 0, 0, 0, 0, 0, 0, 0, 0, 0, 0, 0, 0, 0, 0
    .long 0, 0, 0, 0, 0, 0, 0, 0, 0, 0, 0, 0, 0, 0, 0, 0
    .long 0, 0, 0, 0, 0, 0, 0, 0, 0, 0, 0, 0, 0, 0, 0, 0
    .long 0, 0, 0, 0, 0, 0, 0, 0, 0, 0, 0, 0, 0, 0, 0, 0
    .long 0, 0, 0, 0, 0, 0, 0, 0, 0, 0, 0, 0, 0, 0, 0, 0
    .long 4, 32, 32, 8192, 4864, 267008, 8388608, 0, 32768, 4, 37826560, 131072, 0, 0, 218104385, 0
    .long 4, 32, 32, 8192, 4864, 267008, 8388608, 262144, 32768, 4, 38875136, 131072, 0, 0, 218104388, 0
    .long 1, 16, 16, 8192, 5632, 5888, 8388608, 1572864, 32768, 8, 10575872, 131072, 0, 0, 218108762, 0
    .long 1, 16, 16, 8192, 4608, 4864, 8388608, 0, 32768, 8, 4268032, 131072, 0, 0, 218107978, 0
    .long 2, 64, 72, 7168, 3840, 3840, 7340032, 3145728, 32768, 8, 65597440, 114688, 0, 0, 218104209, 0
    .long 1, 24, 24, 8192, 4608, 4864, 8388608, 3670016, 32768, 8, 35725312, 131072, 0, 0, 218106186, 0
    .long 5, 218108496, 0, 0, 20, 0, 0, 20, 0, 0, 0, 0, 218112256, 23, 218107025, 0
    .long 1, 40, 40, 2048, 4194816, 4195072, 8388608, 178323456, 131072, 8, 84418560, 32768, 218106960, 4, 218106436, 0
    .long 1, 80, 80, 2048, 3670016, 3670272, 7340032, 63758336, 114688, 7, 128450560, 32768, 218104144, 7, 218106689, 0
    .long 6, 0, 0, 0, 2, 0, 0, 46, 0, 0, 0, 0, 0, 0, 0, 0
    .long 0, 0, 0, 0, 0, 0, 0, 0, 0, 0, 0, 0, 0, 0, 0, 0
    .long 0, 0, 0, 0, 0, 0, 0, 0, 0, 0, 0, 0, 0, 0, 0, 0
    .long 0, 0, 0, 0, 0, 0, 0, 0, 0, 0, 0, 0, 0, 0, 0, 0
    .long 0, 0, 0, 0, 0, 0, 0, 0, 0, 0, 0, 0, 0, 0, 0, 0
    .long 0, 0, 0, 0, 0, 0, 0, 0, 0, 0, 0, 0, 0, 0, 0, 0
    .long 4, 32, 32, 8192, 6912, 269056, 8388608, 0, 32768, 4, 37859328, 131072, 0, 0, 218104417, 0
    .long 4, 32, 32, 8192, 6912, 269056, 8388608, 262144, 32768, 4, 38907904, 131072, 0, 0, 218104420, 0
    .long 1, 16, 16, 8192, 7680, 7936, 8388608, 1572864, 32768, 8, 10608640, 131072, 0, 0, 218108794, 0
    .long 1, 16, 16, 8192, 6656, 6912, 8388608, 0, 32768, 8, 4300800, 131072, 0, 0, 218108010, 0
    .long 2, 64, 72, 7168, 5632, 5632, 7340032, 3145728, 32768, 8, 65626112, 114688, 0, 0, 218104212, 0
    .long 1, 24, 24, 8192, 6656, 6912, 8388608, 3670016, 32768, 8, 35758080, 131072, 0, 0, 218106218, 0
    .long 5, 218108528, 0, 0, 28, 0, 0, 20, 0, 0, 0, 0, 218112384, 23, 218107028, 0
    .long 1, 40, 40, 2048, 6291968, 6292224, 8388608, 178356224, 131072, 8, 88612864, 32768, 218106964, 4, 218106436, 0
    .long 1, 80, 80, 2048, 5505024, 5505280, 7340032, 63787008, 114688, 7, 132644864, 32768, 218104148, 7, 218106689, 0
    .long 6, 0, 0, 0, 3, 0, 0, 46, 0, 0, 0, 0, 0, 0, 0, 0
    .long 0, 0, 0, 0, 0, 0, 0, 0, 0, 0, 0, 0, 0, 0, 0, 0
    .long 0, 0, 0, 0, 0, 0, 0, 0, 0, 0, 0, 0, 0, 0, 0, 0
    .long 0, 0, 0, 0, 0, 0, 0, 0, 0, 0, 0, 0, 0, 0, 0, 0
    .long 0, 0, 0, 0, 0, 0, 0, 0, 0, 0, 0, 0, 0, 0, 0, 0
    .long 0, 0, 0, 0, 0, 0, 0, 0, 0, 0, 0, 0, 0, 0, 0, 0
    .long 4, 32, 32, 8192, 1024, 263168, 8388608, 0, 32768, 4, 37765120, 131072, 0, 0, 218104337, 0
    .long 4, 32, 32, 8192, 1024, 263168, 8388608, 262144, 32768, 4, 38813696, 131072, 0, 0, 218104340, 0
    .long 1, 16, 16, 8192, 1536, 1792, 8388608, 524288, 32768, 8, 6316032, 131072, 0, 0, 218108186, 0
    .long 2, 64, 72, 7168, 0, 0, 7340032, 0, 32768, 8, 54525952, 114688, 0, 0, 218103809, 0
    .long 2, 64, 72, 7168, 256, 256, 7340032, 1048576, 32768, 8, 58200064, 114688, 0, 0, 218103937, 0
    .long 2, 64, 72, 7168, 1536, 1536, 7340032, 2621440, 32768, 8, 63725568, 114688, 0, 0, 218104129, 0
    .long 1, 40, 40, 2048, 512, 768, 8388608, 176160768, 131072, 8, 75505664, 32768, 218106880, 4, 218106372, 0
    .long 1, 40, 40, 2048, 1536, 1792, 8388608, 182452224, 131072, 8, 77094912, 32768, 218107072, 4, 218106564, 0
    .long 6, 0, 0, 0, 0, 0, 0, 0, 0, 0, 0, 0, 0, 0, 0, 0
    .long 6, 0, 0, 0, 0, 0, 0, 18, 0, 0, 0, 0, 0, 0, 0, 0
    .long 6, 0, 0, 0, 0, 0, 0, 54, 0, 0, 0, 0, 0, 0, 0, 0
    .long 0, 0, 0, 0, 0, 0, 0, 0, 0, 0, 0, 0, 0, 0, 0, 0
    .long 0, 0, 0, 0, 0, 0, 0, 0, 0, 0, 0, 0, 0, 0, 0, 0
    .long 0, 0, 0, 0, 0, 0, 0, 0, 0, 0, 0, 0, 0, 0, 0, 0
    .long 0, 0, 0, 0, 0, 0, 0, 0, 0, 0, 0, 0, 0, 0, 0, 0
    .long 4, 32, 32, 8192, 3072, 265216, 8388608, 0, 32768, 4, 37797888, 131072, 0, 0, 218104369, 0
    .long 4, 32, 32, 8192, 3072, 265216, 8388608, 262144, 32768, 4, 38846464, 131072, 0, 0, 218104372, 0
    .long 1, 16, 16, 8192, 3584, 3840, 8388608, 524288, 32768, 8, 6348800, 131072, 0, 0, 218108218, 0
    .long 2, 64, 72, 7168, 1792, 1792, 7340032, 0, 32768, 8, 54554624, 114688, 0, 0, 218103812, 0
    .long 2, 64, 72, 7168, 2048, 2048, 7340032, 1048576, 32768, 8, 58228736, 114688, 0, 0, 218103940, 0
    .long 2, 64, 72, 7168, 3328, 3328, 7340032, 2621440, 32768, 8, 63754240, 114688, 0, 0, 218104132, 0
    .long 1, 40, 40, 2048, 2097664, 2097920, 8388608, 176193536, 131072, 8, 79699968, 32768, 218106884, 4, 218106372, 0
    .long 1, 40, 40, 2048, 2098688, 2098944, 8388608, 182484992, 131072, 8, 81289216, 32768, 218107076, 4, 218106564, 0
    .long 6, 0, 0, 0, 1, 0, 0, 0, 0, 0, 0, 0, 0, 0, 0, 0
    .long 6, 0, 0, 0, 1, 0, 0, 18, 0, 0, 0, 0, 0, 0, 0, 0
    .long 6, 0, 0, 0, 1, 0, 0, 54, 0, 0, 0, 0, 0, 0, 0, 0
    .long 0, 0, 0, 0, 0, 0, 0, 0, 0, 0, 0, 0, 0, 0, 0, 0
    .long 0, 0, 0, 0, 0, 0, 0, 0, 0, 0, 0, 0, 0, 0, 0, 0
    .long 0, 0, 0, 0, 0, 0, 0, 0, 0, 0, 0, 0, 0, 0, 0, 0
    .long 0, 0, 0, 0, 0, 0, 0, 0, 0, 0, 0, 0, 0, 0, 0, 0
    .long 4, 32, 32, 8192, 5120, 267264, 8388608, 0, 32768, 4, 37830656, 131072, 0, 0, 218104401, 0
    .long 4, 32, 32, 8192, 5120, 267264, 8388608, 262144, 32768, 4, 38879232, 131072, 0, 0, 218104404, 0
    .long 1, 16, 16, 8192, 5632, 5888, 8388608, 524288, 32768, 8, 6381568, 131072, 0, 0, 218108250, 0
    .long 2, 64, 72, 7168, 3584, 3584, 7340032, 0, 32768, 8, 54583296, 114688, 0, 0, 218103825, 0
    .long 2, 64, 72, 7168, 3840, 3840, 7340032, 1048576, 32768, 8, 58257408, 114688, 0, 0, 218103953, 0
    .long 2, 64, 72, 7168, 5120, 5120, 7340032, 2621440, 32768, 8, 63782912, 114688, 0, 0, 218104145, 0
    .long 1, 40, 40, 2048, 4194816, 4195072, 8388608, 176226304, 131072, 8, 83894272, 32768, 218106896, 4, 218106372, 0
    .long 1, 40, 40, 2048, 4195840, 4196096, 8388608, 182517760, 131072, 8, 85483520, 32768, 218107088, 4, 218106564, 0
    .long 6, 0, 0, 0, 2, 0, 0, 0, 0, 0, 0, 0, 0, 0, 0, 0
    .long 6, 0, 0, 0, 2, 0, 0, 18, 0, 0, 0, 0, 0, 0, 0, 0
    .long 6, 0, 0, 0, 2, 0, 0, 54, 0, 0, 0, 0, 0, 0, 0, 0
    .long 0, 0, 0, 0, 0, 0, 0, 0, 0, 0, 0, 0, 0, 0, 0, 0
    .long 0, 0, 0, 0, 0, 0, 0, 0, 0, 0, 0, 0, 0, 0, 0, 0
    .long 0, 0, 0, 0, 0, 0, 0, 0, 0, 0, 0, 0, 0, 0, 0, 0
    .long 0, 0, 0, 0, 0, 0, 0, 0, 0, 0, 0, 0, 0, 0, 0, 0
    .long 4, 32, 32, 8192, 7168, 269312, 8388608, 0, 32768, 4, 37863424, 131072, 0, 0, 218104433, 0
    .long 4, 32, 32, 8192, 7168, 269312, 8388608, 262144, 32768, 4, 38912000, 131072, 0, 0, 218104436, 0
    .long 1, 16, 16, 8192, 7680, 7936, 8388608, 524288, 32768, 8, 6414336, 131072, 0, 0, 218108282, 0
    .long 2, 64, 72, 7168, 5376, 5376, 7340032, 0, 32768, 8, 54611968, 114688, 0, 0, 218103828, 0
    .long 2, 64, 72, 7168, 5632, 5632, 7340032, 1048576, 32768, 8, 58286080, 114688, 0, 0, 218103956, 0
    .long 2, 64, 72, 7168, 6912, 6912, 7340032, 2621440, 32768, 8, 63811584, 114688, 0, 0, 218104148, 0
    .long 1, 40, 40, 2048, 6291968, 6292224, 8388608, 176259072, 131072, 8, 88088576, 32768, 218106900, 4, 218106372, 0
    .long 1, 40, 40, 2048, 6292992, 6293248, 8388608, 182550528, 131072, 8, 89677824, 32768, 218107092, 4, 218106564, 0
    .long 6, 0, 0, 0, 3, 0, 0, 0, 0, 0, 0, 0, 0, 0, 0, 0
    .long 6, 0, 0, 0, 3, 0, 0, 18, 0, 0, 0, 0, 0, 0, 0, 0
    .long 6, 0, 0, 0, 3, 0, 0, 54, 0, 0, 0, 0, 0, 0, 0, 0
    .long 0, 0, 0, 0, 0, 0, 0, 0, 0, 0, 0, 0, 0, 0, 0, 0
    .long 0, 0, 0, 0, 0, 0, 0, 0, 0, 0, 0, 0, 0, 0, 0, 0
    .long 0, 0, 0, 0, 0, 0, 0, 0, 0, 0, 0, 0, 0, 0, 0, 0
    .long 0, 0, 0, 0, 0, 0, 0, 0, 0, 0, 0, 0, 0, 0, 0, 0
    .long 4, 32, 32, 8192, 1280, 263424, 8388608, 0, 32768, 4, 37769216, 131072, 0, 0, 218104337, 0
    .long 4, 32, 32, 8192, 1280, 263424, 8388608, 262144, 32768, 4, 38817792, 131072, 0, 0, 218104340, 0
    .long 1, 24, 24, 8192, 512, 768, 8388608, 2621440, 32768, 8, 31465472, 131072, 0, 0, 218105610, 0
    .long 1, 16, 16, 8192, 0, 256, 8388608, 0, 32768, 8, 4194304, 131072, 0, 0, 218107914, 0
    .long 2, 64, 72, 7168, 1280, 1280, 7340032, 0, 32768, 8, 54546432, 114688, 0, 0, 218103809, 0
    .long 2, 64, 72, 7168, 768, 768, 7340032, 0, 32768, 8, 54538240, 114688, 0, 0, 218103809, 0
    .long 1, 80, 80, 2048, 1024, 1280, 7340032, 60030976, 114688, 7, 119029760, 32768, 218104000, 7, 218106561, 0
    .long 5, 218109184, 0, 0, 0, 0, 0, 44, 0, 0, 0, 0, 218112000, 47, 218107201, 0
    .long 1, 40, 40, 2048, 1536, 1792, 8388608, 186646528, 131072, 8, 78143488, 32768, 218107200, 4, 218106692, 0
    .long 6, 0, 0, 0, 0, 0, 0, 43, 0, 0, 0, 0, 0, 0, 0, 0
    .long 0, 0, 0, 0, 0, 0, 0, 0, 0, 0, 0, 0, 0, 0, 0, 0
    .long 0, 0, 0, 0, 0, 0, 0, 0, 0, 0, 0, 0, 0, 0, 0, 0
    .long 0, 0, 0, 0, 0, 0, 0, 0, 0, 0, 0, 0, 0, 0, 0, 0
    .long 0, 0, 0, 0, 0, 0, 0, 0, 0, 0, 0, 0, 0, 0, 0, 0
    .long 0, 0, 0, 0, 0, 0, 0, 0, 0, 0, 0, 0, 0, 0, 0, 0
    .long 4, 32, 32, 8192, 3328, 265472, 8388608, 0, 32768, 4, 37801984, 131072, 0, 0, 218104369, 0
    .long 4, 32, 32, 8192, 3328, 265472, 8388608, 262144, 32768, 4, 38850560, 131072, 0, 0, 218104372, 0
    .long 1, 24, 24, 8192, 2560, 2816, 8388608, 2621440, 32768, 8, 31498240, 131072, 0, 0, 218105642, 0
    .long 1, 16, 16, 8192, 2048, 2304, 8388608, 0, 32768, 8, 4227072, 131072, 0, 0, 218107946, 0
    .long 2, 64, 72, 7168, 3072, 3072, 7340032, 0, 32768, 8, 54575104, 114688, 0, 0, 218103812, 0
    .long 2, 64, 72, 7168, 2560, 2560, 7340032, 0, 32768, 8, 54566912, 114688, 0, 0, 218103812, 0
    .long 1, 80, 80, 2048, 1836032, 1836288, 7340032, 60059648, 114688, 7, 123224064, 32768, 218104004, 7, 218106561, 0
    .long 5, 218109216, 0, 0, 8, 0, 0, 44, 0, 0, 0, 0, 218112128, 47, 218107204, 0
    .long 1, 40, 40, 2048, 2098688, 2098944, 8388608, 186679296, 131072, 8, 82337792, 32768, 218107204, 4, 218106692, 0
    .long 6, 0, 0, 0, 1, 0, 0, 43, 0, 0, 0, 0, 0, 0, 0, 0
    .long 0, 0, 0, 0, 0, 0, 0, 0, 0, 0, 0, 0, 0, 0, 0, 0
    .long 0, 0, 0, 0, 0, 0, 0, 0, 0, 0, 0, 0, 0, 0, 0, 0
    .long 0, 0, 0, 0, 0, 0, 0, 0, 0, 0, 0, 0, 0, 0, 0, 0
    .long 0, 0, 0, 0, 0, 0, 0, 0, 0, 0, 0, 0, 0, 0, 0, 0
    .long 0, 0, 0, 0, 0, 0, 0, 0, 0, 0, 0, 0, 0, 0, 0, 0
    .long 4, 32, 32, 8192, 5376, 267520, 8388608, 0, 32768, 4, 37834752, 131072, 0, 0, 218104401, 0
    .long 4, 32, 32, 8192, 5376, 267520, 8388608, 262144, 32768, 4, 38883328, 131072, 0, 0, 218104404, 0
    .long 1, 24, 24, 8192, 4608, 4864, 8388608, 2621440, 32768, 8, 31531008, 131072, 0, 0, 218105674, 0
    .long 1, 16, 16, 8192, 4096, 4352, 8388608, 0, 32768, 8, 4259840, 131072, 0, 0, 218107978, 0
    .long 2, 64, 72, 7168, 4864, 4864, 7340032, 0, 32768, 8, 54603776, 114688, 0, 0, 218103825, 0
    .long 2, 64, 72, 7168, 4352, 4352, 7340032, 0, 32768, 8, 54595584, 114688, 0, 0, 218103825, 0
    .long 1, 80, 80, 2048, 3671040, 3671296, 7340032, 60088320, 114688, 7, 127418368, 32768, 218104016, 7, 218106561, 0
    .long 5, 218109248, 0, 0, 16, 0, 0, 44, 0, 0, 0, 0, 218112256, 47, 218107217, 0
    .long 1, 40, 40, 2048, 4195840, 4196096, 8388608, 186712064, 131072, 8, 86532096, 32768, 218107216, 4, 218106692, 0
    .long 6, 0, 0, 0, 2, 0, 0, 43, 0, 0, 0, 0, 0, 0, 0, 0
    .long 0, 0, 0, 0, 0, 0, 0, 0, 0, 0, 0, 0, 0, 0, 0, 0
    .long 0, 0, 0, 0, 0, 0, 0, 0, 0, 0, 0, 0, 0, 0, 0, 0
    .long 0, 0, 0, 0, 0, 0, 0, 0, 0, 0, 0, 0, 0, 0, 0, 0
    .long 0, 0, 0, 0, 0, 0, 0, 0, 0, 0, 0, 0, 0, 0, 0, 0
    .long 0, 0, 0, 0, 0, 0, 0, 0, 0, 0, 0, 0, 0, 0, 0, 0
    .long 4, 32, 32, 8192, 7424, 269568, 8388608, 0, 32768, 4, 37867520, 131072, 0, 0, 218104433, 0
    .long 4, 32, 32, 8192, 7424, 269568, 8388608, 262144, 32768, 4, 38916096, 131072, 0, 0, 218104436, 0
    .long 1, 24, 24, 8192, 6656, 6912, 8388608, 2621440, 32768, 8, 31563776, 131072, 0, 0, 218105706, 0
    .long 1, 16, 16, 8192, 6144, 6400, 8388608, 0, 32768, 8, 4292608, 131072, 0, 0, 218108010, 0
    .long 2, 64, 72, 7168, 6656, 6656, 7340032, 0, 32768, 8, 54632448, 114688, 0, 0, 218103828, 0
    .long 2, 64, 72, 7168, 6144, 6144, 7340032, 0, 32768, 8, 54624256, 114688, 0, 0, 218103828, 0
    .long 1, 80, 80, 2048, 5506048, 5506304, 7340032, 60116992, 114688, 7, 131612672, 32768, 218104020, 7, 218106561, 0
    .long 5, 218109280, 0, 0, 24, 0, 0, 44, 0, 0, 0, 0, 218112384, 47, 218107220, 0
    .long 1, 40, 40, 2048, 6292992, 6293248, 8388608, 186744832, 131072, 8, 90726400, 32768, 218107220, 4, 218106692, 0
    .long 6, 0, 0, 0, 3, 0, 0, 43, 0, 0, 0, 0, 0, 0, 0, 0
    .long 0, 0, 0, 0, 0, 0, 0, 0, 0, 0, 0, 0, 0, 0, 0, 0
    .long 0, 0, 0, 0, 0, 0, 0, 0, 0, 0, 0, 0, 0, 0, 0, 0
    .long 0, 0, 0, 0, 0, 0, 0, 0, 0, 0, 0, 0, 0, 0, 0, 0
    .long 0, 0, 0, 0, 0, 0, 0, 0, 0, 0, 0, 0, 0, 0, 0, 0
    .long 0, 0, 0, 0, 0, 0, 0, 0, 0, 0, 0, 0, 0, 0, 0, 0
    .long 4, 32, 32, 8192, 1536, 263680, 8388608, 0, 32768, 4, 37773312, 131072, 0, 0, 218104337, 0
    .long 4, 32, 32, 8192, 1536, 263680, 8388608, 262144, 32768, 4, 38821888, 131072, 0, 0, 218104340, 0
    .long 1, 24, 24, 8192, 1024, 1280, 8388608, 1572864, 32768, 8, 27279360, 131072, 0, 0, 218105114, 0
    .long 2, 64, 72, 7168, 0, 0, 7340032, 2621440, 32768, 8, 63700992, 114688, 0, 0, 218104129, 0
    .long 1, 16, 16, 8192, 1536, 1792, 8388608, 2097152, 32768, 8, 12607488, 131072, 0, 0, 218108954, 0
    .long 1, 16, 16, 8192, 512, 768, 8388608, 2621440, 32768, 8, 14688256, 131072, 0, 0, 218109194, 0
    .long 5, 218108928, 0, 0, 0, 0, 0, 32, 0, 0, 0, 0, 218112000, 35, 218107137, 0
    .long 1, 40, 40, 2048, 0, 256, 8388608, 178257920, 131072, 8, 76021760, 32768, 218106944, 4, 218106436, 0
    .long 1, 80, 80, 2048, 512, 768, 7340032, 67371008, 114688, 7, 121118720, 32768, 218104256, 7, 218106817, 0
    .long 7, 0, 0, 0, 2, 0, 0, 61, 0, 0, 0, 0, 0, 0, 0, 0
    .long 0, 0, 0, 0, 0, 0, 0, 0, 0, 0, 0, 0, 0, 0, 0, 0
    .long 0, 0, 0, 0, 0, 0, 0, 0, 0, 0, 0, 0, 0, 0, 0, 0
    .long 0, 0, 0, 0, 0, 0, 0, 0, 0, 0, 0, 0, 0, 0, 0, 0
    .long 0, 0, 0, 0, 0, 0, 0, 0, 0, 0, 0, 0, 0, 0, 0, 0
    .long 0, 0, 0, 0, 0, 0, 0, 0, 0, 0, 0, 0, 0, 0, 0, 0
    .long 4, 32, 32, 8192, 3584, 265728, 8388608, 0, 32768, 4, 37806080, 131072, 0, 0, 218104369, 0
    .long 4, 32, 32, 8192, 3584, 265728, 8388608, 262144, 32768, 4, 38854656, 131072, 0, 0, 218104372, 0
    .long 1, 24, 24, 8192, 3072, 3328, 8388608, 1572864, 32768, 8, 27312128, 131072, 0, 0, 218105146, 0
    .long 2, 64, 72, 7168, 1792, 1792, 7340032, 2621440, 32768, 8, 63729664, 114688, 0, 0, 218104132, 0
    .long 1, 16, 16, 8192, 3584, 3840, 8388608, 2097152, 32768, 8, 12640256, 131072, 0, 0, 218108986, 0
    .long 1, 16, 16, 8192, 2560, 2816, 8388608, 2621440, 32768, 8, 14721024, 131072, 0, 0, 218109226, 0
    .long 5, 218108960, 0, 0, 8, 0, 0, 32, 0, 0, 0, 0, 218112128, 35, 218107140, 0
    .long 1, 40, 40, 2048, 2097152, 2097408, 8388608, 178290688, 131072, 8, 80216064, 32768, 218106948, 4, 218106436, 0
    .long 1, 80, 80, 2048, 1835520, 1835776, 7340032, 67399680, 114688, 7, 125313024, 32768, 218104260, 7, 218106817, 0
    .long 7, 0, 0, 0, 6, 0, 0, 61, 0, 0, 0, 0, 0, 0, 0, 0
    .long 0, 0, 0, 0, 0, 0, 0, 0, 0, 0, 0, 0, 0, 0, 0, 0
    .long 0, 0, 0, 0, 0, 0, 0, 0, 0, 0, 0, 0, 0, 0, 0, 0
    .long 0, 0, 0, 0, 0, 0, 0, 0, 0, 0, 0, 0, 0, 0, 0, 0
    .long 0, 0, 0, 0, 0, 0, 0, 0, 0, 0, 0, 0, 0, 0, 0, 0
    .long 0, 0, 0, 0, 0, 0, 0, 0, 0, 0, 0, 0, 0, 0, 0, 0
    .long 4, 32, 32, 8192, 5632, 267776, 8388608, 0, 32768, 4, 37838848, 131072, 0, 0, 218104401, 0
    .long 4, 32, 32, 8192, 5632, 267776, 8388608, 262144, 32768, 4, 38887424, 131072, 0, 0, 218104404, 0
    .long 1, 24, 24, 8192, 5120, 5376, 8388608, 1572864, 32768, 8, 27344896, 131072, 0, 0, 218105178, 0
    .long 2, 64, 72, 7168, 3584, 3584, 7340032, 2621440, 32768, 8, 63758336, 114688, 0, 0, 218104145, 0
    .long 1, 16, 16, 8192, 5632, 5888, 8388608, 2097152, 32768, 8, 12673024, 131072, 0, 0, 218109018, 0
    .long 1, 16, 16, 8192, 4608, 4864, 8388608, 2621440, 32768, 8, 14753792, 131072, 0, 0, 218109258, 0
    .long 5, 218108992, 0, 0, 16, 0, 0, 32, 0, 0, 0, 0, 218112256, 35, 218107153, 0
    .long 1, 40, 40, 2048, 4194304, 4194560, 8388608, 178323456, 131072, 8, 84410368, 32768, 218106960, 4, 218106436, 0
    .long 1, 80, 80, 2048, 3670528, 3670784, 7340032, 67428352, 114688, 7, 129507328, 32768, 218104272, 7, 218106817, 0
    .long 7, 0, 0, 0, 10, 0, 0, 61, 0, 0, 0, 0, 0, 0, 0, 0
    .long 0, 0, 0, 0, 0, 0, 0, 0, 0, 0, 0, 0, 0, 0, 0, 0
    .long 0, 0, 0, 0, 0, 0, 0, 0, 0, 0, 0, 0, 0, 0, 0, 0
    .long 0, 0, 0, 0, 0, 0, 0, 0, 0, 0, 0, 0, 0, 0, 0, 0
    .long 0, 0, 0, 0, 0, 0, 0, 0, 0, 0, 0, 0, 0, 0, 0, 0
    .long 0, 0, 0, 0, 0, 0, 0, 0, 0, 0, 0, 0, 0, 0, 0, 0
    .long 4, 32, 32, 8192, 7680, 269824, 8388608, 0, 32768, 4, 37871616, 131072, 0, 0, 218104433, 0
    .long 4, 32, 32, 8192, 7680, 269824, 8388608, 262144, 32768, 4, 38920192, 131072, 0, 0, 218104436, 0
    .long 1, 24, 24, 8192, 7168, 7424, 8388608, 1572864, 32768, 8, 27377664, 131072, 0, 0, 218105210, 0
    .long 2, 64, 72, 7168, 5376, 5376, 7340032, 2621440, 32768, 8, 63787008, 114688, 0, 0, 218104148, 0
    .long 1, 16, 16, 8192, 7680, 7936, 8388608, 2097152, 32768, 8, 12705792, 131072, 0, 0, 218109050, 0
    .long 1, 16, 16, 8192, 6656, 6912, 8388608, 2621440, 32768, 8, 14786560, 131072, 0, 0, 218109290, 0
    .long 5, 218109024, 0, 0, 24, 0, 0, 32, 0, 0, 0, 0, 218112384, 35, 218107156, 0
    .long 1, 40, 40, 2048, 6291456, 6291712, 8388608, 178356224, 131072, 8, 88604672, 32768, 218106964, 4, 218106436, 0
    .long 1, 80, 80, 2048, 5505536, 5505792, 7340032, 67457024, 114688, 7, 133701632, 32768, 218104276, 7, 218106817, 0
    .long 7, 0, 0, 0, 14, 0, 0, 61, 0, 0, 0, 0, 0, 0, 0, 0
    .long 0, 0, 0, 0, 0, 0, 0, 0, 0, 0, 0, 0, 0, 0, 0, 0
    .long 0, 0, 0, 0, 0, 0, 0, 0, 0, 0, 0, 0, 0, 0, 0, 0
    .long 0, 0, 0, 0, 0, 0, 0, 0, 0, 0, 0, 0, 0, 0, 0, 0
    .long 0, 0, 0, 0, 0, 0, 0, 0, 0, 0, 0, 0, 0, 0, 0, 0
    .long 0, 0, 0, 0, 0, 0, 0, 0, 0, 0, 0, 0, 0, 0, 0, 0
    .long 4, 32, 32, 8192, 1792, 263936, 8388608, 0, 32768, 4, 37777408, 131072, 0, 0, 218104337, 0
    .long 4, 32, 32, 8192, 1792, 263936, 8388608, 262144, 32768, 4, 38825984, 131072, 0, 0, 218104340, 0
    .long 1, 32, 32, 8192, 0, 256, 8388608, 1572864, 32768, 8, 44040192, 131072, 0, 0, 218105098, 0
    .long 1, 16, 16, 8192, 1536, 1792, 8388608, 0, 32768, 8, 4218880, 131072, 0, 0, 218107930, 0
    .long 2, 64, 72, 7168, 0, 0, 7340032, 1572864, 32768, 8, 60030976, 114688, 0, 0, 218104001, 0
    .long 1, 32, 32, 8192, 0, 256, 8388608, 3670016, 32768, 8, 52428800, 131072, 0, 0, 218106122, 0
    .long 1, 80, 80, 2048, 512, 768, 7340032, 60030976, 114688, 7, 119021568, 32768, 218104000, 7, 218106561, 0
    .long 5, 218109200, 0, 0, 4, 0, 0, 40, 0, 0, 0, 0, 218112000, 43, 218107201, 0
    .long 1, 80, 80, 2048, 1024, 1280, 7340032, 67371008, 114688, 7, 121126912, 32768, 218104256, 7, 218106817, 0
    .long 6, 0, 0, 0, 0, 0, 0, 33, 0, 0, 0, 0, 0, 0, 0, 0
    .long 0, 0, 0, 0, 0, 0, 0, 0, 0, 0, 0, 0, 0, 0, 0, 0
    .long 0, 0, 0, 0, 0, 0, 0, 0, 0, 0, 0, 0, 0, 0, 0, 0
    .long 0, 0, 0, 0, 0, 0, 0, 0, 0, 0, 0, 0, 0, 0, 0, 0
    .long 0, 0, 0, 0, 0, 0, 0, 0, 0, 0, 0, 0, 0, 0, 0, 0
    .long 0, 0, 0, 0, 0, 0, 0, 0, 0, 0, 0, 0, 0, 0, 0, 0
    .long 4, 32, 32, 8192, 3840, 265984, 8388608, 0, 32768, 4, 37810176, 131072, 0, 0, 218104369, 0
    .long 4, 32, 32, 8192, 3840, 265984, 8388608, 262144, 32768, 4, 38858752, 131072, 0, 0, 218104372, 0
    .long 1, 32, 32, 8192, 2048, 2304, 8388608, 1572864, 32768, 8, 44072960, 131072, 0, 0, 218105130, 0
    .long 1, 16, 16, 8192, 3584, 3840, 8388608, 0, 32768, 8, 4251648, 131072, 0, 0, 218107962, 0
    .long 2, 64, 72, 7168, 1792, 1792, 7340032, 1572864, 32768, 8, 60059648, 114688, 0, 0, 218104004, 0
    .long 1, 32, 32, 8192, 2048, 2304, 8388608, 3670016, 32768, 8, 52461568, 131072, 0, 0, 218106154, 0
    .long 1, 80, 80, 2048, 1835520, 1835776, 7340032, 60059648, 114688, 7, 123215872, 32768, 218104004, 7, 218106561, 0
    .long 5, 218109232, 0, 0, 12, 0, 0, 40, 0, 0, 0, 0, 218112128, 43, 218107204, 0
    .long 1, 80, 80, 2048, 1836032, 1836288, 7340032, 67399680, 114688, 7, 125321216, 32768, 218104260, 7, 218106817, 0
    .long 6, 0, 0, 0, 1, 0, 0, 33, 0, 0, 0, 0, 0, 0, 0, 0
    .long 0, 0, 0, 0, 0, 0, 0, 0, 0, 0, 0, 0, 0, 0, 0, 0
    .long 0, 0, 0, 0, 0, 0, 0, 0, 0, 0, 0, 0, 0, 0, 0, 0
    .long 0, 0, 0, 0, 0, 0, 0, 0, 0, 0, 0, 0, 0, 0, 0, 0
    .long 0, 0, 0, 0, 0, 0, 0, 0, 0, 0, 0, 0, 0, 0, 0, 0
    .long 0, 0, 0, 0, 0, 0, 0, 0, 0, 0, 0, 0, 0, 0, 0, 0
    .long 4, 32, 32, 8192, 5888, 268032, 8388608, 0, 32768, 4, 37842944, 131072, 0, 0, 218104401, 0
    .long 4, 32, 32, 8192, 5888, 268032, 8388608, 262144, 32768, 4, 38891520, 131072, 0, 0, 218104404, 0
    .long 1, 32, 32, 8192, 4096, 4352, 8388608, 1572864, 32768, 8, 44105728, 131072, 0, 0, 218105162, 0
    .long 1, 16, 16, 8192, 5632, 5888, 8388608, 0, 32768, 8, 4284416, 131072, 0, 0, 218107994, 0
    .long 2, 64, 72, 7168, 3584, 3584, 7340032, 1572864, 32768, 8, 60088320, 114688, 0, 0, 218104017, 0
    .long 1, 32, 32, 8192, 4096, 4352, 8388608, 3670016, 32768, 8, 52494336, 131072, 0, 0, 218106186, 0
    .long 1, 80, 80, 2048, 3670528, 3670784, 7340032, 60088320, 114688, 7, 127410176, 32768, 218104016, 7, 218106561, 0
    .long 5, 218109264, 0, 0, 20, 0, 0, 40, 0, 0, 0, 0, 218112256, 43, 218107217, 0
    .long 1, 80, 80, 2048, 3671040, 3671296, 7340032, 67428352, 114688, 7, 129515520, 32768, 218104272, 7, 218106817, 0
    .long 6, 0, 0, 0, 2, 0, 0, 33, 0, 0, 0, 0, 0, 0, 0, 0
    .long 0, 0, 0, 0, 0, 0, 0, 0, 0, 0, 0, 0, 0, 0, 0, 0
    .long 0, 0, 0, 0, 0, 0, 0, 0, 0, 0, 0, 0, 0, 0, 0, 0
    .long 0, 0, 0, 0, 0, 0, 0, 0, 0, 0, 0, 0, 0, 0, 0, 0
    .long 0, 0, 0, 0, 0, 0, 0, 0, 0, 0, 0, 0, 0, 0, 0, 0
    .long 0, 0, 0, 0, 0, 0, 0, 0, 0, 0, 0, 0, 0, 0, 0, 0
    .long 4, 32, 32, 8192, 7936, 270080, 8388608, 0, 32768, 4, 37875712, 131072, 0, 0, 218104433, 0
    .long 4, 32, 32, 8192, 7936, 270080, 8388608, 262144, 32768, 4, 38924288, 131072, 0, 0, 218104436, 0
    .long 1, 32, 32, 8192, 6144, 6400, 8388608, 1572864, 32768, 8, 44138496, 131072, 0, 0, 218105194, 0
    .long 1, 16, 16, 8192, 7680, 7936, 8388608, 0, 32768, 8, 4317184, 131072, 0, 0, 218108026, 0
    .long 2, 64, 72, 7168, 5376, 5376, 7340032, 1572864, 32768, 8, 60116992, 114688, 0, 0, 218104020, 0
    .long 1, 32, 32, 8192, 6144, 6400, 8388608, 3670016, 32768, 8, 52527104, 131072, 0, 0, 218106218, 0
    .long 1, 80, 80, 2048, 5505536, 5505792, 7340032, 60116992, 114688, 7, 131604480, 32768, 218104020, 7, 218106561, 0
    .long 5, 218109296, 0, 0, 28, 0, 0, 40, 0, 0, 0, 0, 218112384, 43, 218107220, 0
    .long 1, 80, 80, 2048, 5506048, 5506304, 7340032, 67457024, 114688, 7, 133709824, 32768, 218104276, 7, 218106817, 0
    .long 6, 0, 0, 0, 3, 0, 0, 33, 0, 0, 0, 0, 0, 0, 0, 0
    .long 0, 0, 0, 0, 0, 0, 0, 0, 0, 0, 0, 0, 0, 0, 0, 0
    .long 0, 0, 0, 0, 0, 0, 0, 0, 0, 0, 0, 0, 0, 0, 0, 0
    .long 0, 0, 0, 0, 0, 0, 0, 0, 0, 0, 0, 0, 0, 0, 0, 0
    .long 0, 0, 0, 0, 0, 0, 0, 0, 0, 0, 0, 0, 0, 0, 0, 0
    .long 0, 0, 0, 0, 0, 0, 0, 0, 0, 0, 0, 0, 0, 0, 0, 0
    .long 1, 24, 24, 8192, 0, 256, 8388608, 524288, 32768, 8, 23068672, 131072, 0, 0, 218104586, 0
    .long 1, 32, 32, 8192, 512, 768, 8388608, 2097152, 32768, 8, 46145536, 131072, 0, 0, 218105354, 0
    .long 2, 64, 72, 7168, 0, 0, 7340032, 3145728, 32768, 8, 65536000, 114688, 0, 0, 218104193, 0
    .long 1, 24, 24, 8192, 1536, 1792, 8388608, 3670016, 32768, 8, 35676160, 131072, 0, 0, 218106138, 0
    .long 1, 24, 24, 8192, 0, 256, 8388608, 3670016, 32768, 8, 35651584, 131072, 0, 0, 218106122, 0
    .long 2, 64, 72, 7168, 1280, 1280, 7340032, 3670016, 32768, 8, 67391488, 114688, 0, 0, 218104257, 0
    .long 1, 80, 80, 2048, 0, 256, 7340032, 61865984, 114688, 7, 119537664, 32768, 218104064, 7, 218106625, 0
    .long 6, 0, 0, 0, 0, 0, 0, 8, 0, 0, 0, 0, 0, 0, 0, 0
    .long 6, 0, 0, 0, 0, 0, 0, 36, 0, 0, 0, 0, 0, 0, 0, 0
    .long 7, 0, 0, 0, 2, 0, 0, 62, 0, 0, 0, 0, 0, 0, 0, 0
    .long 0, 0, 0, 0, 0, 0, 0, 0, 0, 0, 0, 0, 0, 0, 0, 0
    .long 0, 0, 0, 0, 0, 0, 0, 0, 0, 0, 0, 0, 0, 0, 0, 0
    .long 0, 0, 0, 0, 0, 0, 0, 0, 0, 0, 0, 0, 0, 0, 0, 0
    .long 0, 0, 0, 0, 0, 0, 0, 0, 0, 0, 0, 0, 0, 0, 0, 0
    .long 0, 0, 0, 0, 0, 0, 0, 0, 0, 0, 0, 0, 0, 0, 0, 0
    .long 1, 24, 24, 8192, 2048, 2304, 8388608, 524288, 32768, 8, 23101440, 131072, 0, 0, 218104618, 0
    .long 1, 32, 32, 8192, 2560, 2816, 8388608, 2097152, 32768, 8, 46178304, 131072, 0, 0, 218105386, 0
    .long 2, 64, 72, 7168, 1792, 1792, 7340032, 3145728, 32768, 8, 65564672, 114688, 0, 0, 218104196, 0
    .long 1, 24, 24, 8192, 3584, 3840, 8388608, 3670016, 32768, 8, 35708928, 131072, 0, 0, 218106170, 0
    .long 1, 24, 24, 8192, 2048, 2304, 8388608, 3670016, 32768, 8, 35684352, 131072, 0, 0, 218106154, 0
    .long 2, 64, 72, 7168, 3072, 3072, 7340032, 3670016, 32768, 8, 67420160, 114688, 0, 0, 218104260, 0
    .long 1, 80, 80, 2048, 1835008, 1835264, 7340032, 61894656, 114688, 7, 123731968, 32768, 218104068, 7, 218106625, 0
    .long 6, 0, 0, 0, 1, 0, 0, 8, 0, 0, 0, 0, 0, 0, 0, 0
    .long 6, 0, 0, 0, 1, 0, 0, 36, 0, 0, 0, 0, 0, 0, 0, 0
    .long 7, 0, 0, 0, 6, 0, 0, 62, 0, 0, 0, 0, 0, 0, 0, 0
    .long 0, 0, 0, 0, 0, 0, 0, 0, 0, 0, 0, 0, 0, 0, 0, 0
    .long 0, 0, 0, 0, 0, 0, 0, 0, 0, 0, 0, 0, 0, 0, 0, 0
    .long 0, 0, 0, 0, 0, 0, 0, 0, 0, 0, 0, 0, 0, 0, 0, 0
    .long 0, 0, 0, 0, 0, 0, 0, 0, 0, 0, 0, 0, 0, 0, 0, 0
    .long 0, 0, 0, 0, 0, 0, 0, 0, 0, 0, 0, 0, 0, 0, 0, 0
    .long 1, 24, 24, 8192, 4096, 4352, 8388608, 524288, 32768, 8, 23134208, 131072, 0, 0, 218104650, 0
    .long 1, 32, 32, 8192, 4608, 4864, 8388608, 2097152, 32768, 8, 46211072, 131072, 0, 0, 218105418, 0
    .long 2, 64, 72, 7168, 3584, 3584, 7340032, 3145728, 32768, 8, 65593344, 114688, 0, 0, 218104209, 0
    .long 1, 24, 24, 8192, 5632, 5888, 8388608, 3670016, 32768, 8, 35741696, 131072, 0, 0, 218106202, 0
    .long 1, 24, 24, 8192, 4096, 4352, 8388608, 3670016, 32768, 8, 35717120, 131072, 0, 0, 218106186, 0
    .long 2, 64, 72, 7168, 4864, 4864, 7340032, 3670016, 32768, 8, 67448832, 114688, 0, 0, 218104273, 0
    .long 1, 80, 80, 2048, 3670016, 3670272, 7340032, 61923328, 114688, 7, 127926272, 32768, 218104080, 7, 218106625, 0
    .long 6, 0, 0, 0, 2, 0, 0, 8, 0, 0, 0, 0, 0, 0, 0, 0
    .long 6, 0, 0, 0, 2, 0, 0, 36, 0, 0, 0, 0, 0, 0, 0, 0
    .long 7, 0, 0, 0, 10, 0, 0, 62, 0, 0, 0, 0, 0, 0, 0, 0
    .long 0, 0, 0, 0, 0, 0, 0, 0, 0, 0, 0, 0, 0, 0, 0, 0
    .long 0, 0, 0, 0, 0, 0, 0, 0, 0, 0, 0, 0, 0, 0, 0, 0
    .long 0, 0, 0, 0, 0, 0, 0, 0, 0, 0, 0, 0, 0, 0, 0, 0
    .long 0, 0, 0, 0, 0, 0, 0, 0, 0, 0, 0, 0, 0, 0, 0, 0
    .long 0, 0, 0, 0, 0, 0, 0, 0, 0, 0, 0, 0, 0, 0, 0, 0
    .long 1, 24, 24, 8192, 6144, 6400, 8388608, 524288, 32768, 8, 23166976, 131072, 0, 0, 218104682, 0
    .long 1, 32, 32, 8192, 6656, 6912, 8388608, 2097152, 32768, 8, 46243840, 131072, 0, 0, 218105450, 0
    .long 2, 64, 72, 7168, 5376, 5376, 7340032, 3145728, 32768, 8, 65622016, 114688, 0, 0, 218104212, 0
    .long 1, 24, 24, 8192, 7680, 7936, 8388608, 3670016, 32768, 8, 35774464, 131072, 0, 0, 218106234, 0
    .long 1, 24, 24, 8192, 6144, 6400, 8388608, 3670016, 32768, 8, 35749888, 131072, 0, 0, 218106218, 0
    .long 2, 64, 72, 7168, 6656, 6656, 7340032, 3670016, 32768, 8, 67477504, 114688, 0, 0, 218104276, 0
    .long 1, 80, 80, 2048, 5505024, 5505280, 7340032, 61952000, 114688, 7, 132120576, 32768, 218104084, 7, 218106625, 0
    .long 6, 0, 0, 0, 3, 0, 0, 8, 0, 0, 0, 0, 0, 0, 0, 0
    .long 6, 0, 0, 0, 3, 0, 0, 36, 0, 0, 0, 0, 0, 0, 0, 0
    .long 7, 0, 0, 0, 14, 0, 0, 62, 0, 0, 0, 0, 0, 0, 0, 0
    .long 0, 0, 0, 0, 0, 0, 0, 0, 0, 0, 0, 0, 0, 0, 0, 0
    .long 0, 0, 0, 0, 0, 0, 0, 0, 0, 0, 0, 0, 0, 0, 0, 0
    .long 0, 0, 0, 0, 0, 0, 0, 0, 0, 0, 0, 0, 0, 0, 0, 0
    .long 0, 0, 0, 0, 0, 0, 0, 0, 0, 0, 0, 0, 0, 0, 0, 0
    .long 0, 0, 0, 0, 0, 0, 0, 0, 0, 0, 0, 0, 0, 0, 0, 0
    .long 1, 24, 24, 8192, 512, 768, 8388608, 524288, 32768, 8, 23076864, 131072, 0, 0, 218104586, 0
    .long 2, 64, 72, 7168, 1024, 1024, 7340032, 1572864, 32768, 8, 60047360, 114688, 0, 0, 218104001, 0
    .long 5, 218108176, 0, 0, 4, 0, 0, 12, 0, 0, 0, 0, 218112000, 15, 218106945, 0
    .long 1, 24, 24, 8192, 1024, 1280, 8388608, 3670016, 32768, 8, 35667968, 131072, 0, 0, 218106138, 0
    .long 2, 64, 72, 7168, 768, 768, 7340032, 3145728, 32768, 8, 65548288, 114688, 0, 0, 218104193, 0
    .long 1, 40, 40, 2048, 1536, 1792, 8388608, 176160768, 131072, 8, 75522048, 32768, 218106880, 4, 218106372, 0
    .long 1, 80, 80, 2048, 1024, 1280, 7340032, 58195968, 114688, 7, 118505472, 32768, 218103936, 7, 218106497, 0
    .long 6, 0, 0, 0, 0, 0, 0, 11, 0, 0, 0, 0, 0, 0, 0, 0
    .long 6, 0, 0, 0, 0, 0, 0, 2, 0, 0, 0, 0, 0, 0, 0, 0
    .long 6, 0, 0, 0, 0, 0, 0, 38, 0, 0, 0, 0, 0, 0, 0, 0
    .long 7, 0, 0, 0, 1, 0, 0, 61, 0, 0, 0, 0, 0, 0, 0, 0
    .long 0, 0, 0, 0, 0, 0, 0, 0, 0, 0, 0, 0, 0, 0, 0, 0
    .long 0, 0, 0, 0, 0, 0, 0, 0, 0, 0, 0, 0, 0, 0, 0, 0
    .long 0, 0, 0, 0, 0, 0, 0, 0, 0, 0, 0, 0, 0, 0, 0, 0
    .long 0, 0, 0, 0, 0, 0, 0, 0, 0, 0, 0, 0, 0, 0, 0, 0
    .long 1, 24, 24, 8192, 2560, 2816, 8388608, 524288, 32768, 8, 23109632, 131072, 0, 0, 218104618, 0
    .long 2, 64, 72, 7168, 2816, 2816, 7340032, 1572864, 32768, 8, 60076032, 114688, 0, 0, 218104004, 0
    .long 5, 218108208, 0, 0, 12, 0, 0, 12, 0, 0, 0, 0, 218112128, 15, 218106948, 0
    .long 1, 24, 24, 8192, 3072, 3328, 8388608, 3670016, 32768, 8, 35700736, 131072, 0, 0, 218106170, 0
    .long 2, 64, 72, 7168, 2560, 2560, 7340032, 3145728, 32768, 8, 65576960, 114688, 0, 0, 218104196, 0
    .long 1, 40, 40, 2048, 2098688, 2098944, 8388608, 176193536, 131072, 8, 79716352, 32768, 218106884, 4, 218106372, 0
    .long 1, 80, 80, 2048, 1836032, 1836288, 7340032, 58224640, 114688, 7, 122699776, 32768, 218103940, 7, 218106497, 0
    .long 6, 0, 0, 0, 1, 0, 0, 11, 0, 0, 0, 0, 0, 0, 0, 0
    .long 6, 0, 0, 0, 1, 0, 0, 2, 0, 0, 0, 0, 0, 0, 0, 0
    .long 6, 0, 0, 0, 1, 0, 0, 38, 0, 0, 0, 0, 0, 0, 0, 0
    .long 7, 0, 0, 0, 5, 0, 0, 61, 0, 0, 0, 0, 0, 0, 0, 0
    .long 0, 0, 0, 0, 0, 0, 0, 0, 0, 0, 0, 0, 0, 0, 0, 0
    .long 0, 0, 0, 0, 0, 0, 0, 0, 0, 0, 0, 0, 0, 0, 0, 0
    .long 0, 0, 0, 0, 0, 0, 0, 0, 0, 0, 0, 0, 0, 0, 0, 0
    .long 0, 0, 0, 0, 0, 0, 0, 0, 0, 0, 0, 0, 0, 0, 0, 0
    .long 1, 24, 24, 8192, 4608, 4864, 8388608, 524288, 32768, 8, 23142400, 131072, 0, 0, 218104650, 0
    .long 2, 64, 72, 7168, 4608, 4608, 7340032, 1572864, 32768, 8, 60104704, 114688, 0, 0, 218104017, 0
    .long 5, 218108240, 0, 0, 20, 0, 0, 12, 0, 0, 0, 0, 218112256, 15, 218106961, 0
    .long 1, 24, 24, 8192, 5120, 5376, 8388608, 3670016, 32768, 8, 35733504, 131072, 0, 0, 218106202, 0
    .long 2, 64, 72, 7168, 4352, 4352, 7340032, 3145728, 32768, 8, 65605632, 114688, 0, 0, 218104209, 0
    .long 1, 40, 40, 2048, 4195840, 4196096, 8388608, 176226304, 131072, 8, 83910656, 32768, 218106896, 4, 218106372, 0
    .long 1, 80, 80, 2048, 3671040, 3671296, 7340032, 58253312, 114688, 7, 126894080, 32768, 218103952, 7, 218106497, 0
    .long 6, 0, 0, 0, 2, 0, 0, 11, 0, 0, 0, 0, 0, 0, 0, 0
    .long 6, 0, 0, 0, 2, 0, 0, 2, 0, 0, 0, 0, 0, 0, 0, 0
    .long 6, 0, 0, 0, 2, 0, 0, 38, 0, 0, 0, 0, 0, 0, 0, 0
    .long 7, 0, 0, 0, 9, 0, 0, 61, 0, 0, 0, 0, 0, 0, 0, 0
    .long 0, 0, 0, 0, 0, 0, 0, 0, 0, 0, 0, 0, 0, 0, 0, 0
    .long 0, 0, 0, 0, 0, 0, 0, 0, 0, 0, 0, 0, 0, 0, 0, 0
    .long 0, 0, 0, 0, 0, 0, 0, 0, 0, 0, 0, 0, 0, 0, 0, 0
    .long 0, 0, 0, 0, 0, 0, 0, 0, 0, 0, 0, 0, 0, 0, 0, 0
    .long 1, 24, 24, 8192, 6656, 6912, 8388608, 524288, 32768, 8, 23175168, 131072, 0, 0, 218104682, 0
    .long 2, 64, 72, 7168, 6400, 6400, 7340032, 1572864, 32768, 8, 60133376, 114688, 0, 0, 218104020, 0
    .long 5, 218108272, 0, 0, 28, 0, 0, 12, 0, 0, 0, 0, 218112384, 15, 218106964, 0
    .long 1, 24, 24, 8192, 7168, 7424, 8388608, 3670016, 32768, 8, 35766272, 131072, 0, 0, 218106234, 0
    .long 2, 64, 72, 7168, 6144, 6144, 7340032, 3145728, 32768, 8, 65634304, 114688, 0, 0, 218104212, 0
    .long 1, 40, 40, 2048, 6292992, 6293248, 8388608, 176259072, 131072, 8, 88104960, 32768, 218106900, 4, 218106372, 0
    .long 1, 80, 80, 2048, 5506048, 5506304, 7340032, 58281984, 114688, 7, 131088384, 32768, 218103956, 7, 218106497, 0
    .long 6, 0, 0, 0, 3, 0, 0, 11, 0, 0, 0, 0, 0, 0, 0, 0
    .long 6, 0, 0, 0, 3, 0, 0, 2, 0, 0, 0, 0, 0, 0, 0, 0
    .long 6, 0, 0, 0, 3, 0, 0, 38, 0, 0, 0, 0, 0, 0, 0, 0
    .long 7, 0, 0, 0, 13, 0, 0, 61, 0, 0, 0, 0, 0, 0, 0, 0
    .long 0, 0, 0, 0, 0, 0, 0, 0, 0, 0, 0, 0, 0, 0, 0, 0
    .long 0, 0, 0, 0, 0, 0, 0, 0, 0, 0, 0, 0, 0, 0, 0, 0
    .long 0, 0, 0, 0, 0, 0, 0, 0, 0, 0, 0, 0, 0, 0, 0, 0
    .long 0, 0, 0, 0, 0, 0, 0, 0, 0, 0, 0, 0, 0, 0, 0, 0
    .long 1, 24, 24, 8192, 1024, 1280, 8388608, 524288, 32768, 8, 23085056, 131072, 0, 0, 218104602, 0
    .long 1, 24, 24, 8192, 1536, 1792, 8388608, 2097152, 32768, 8, 29384704, 131072, 0, 0, 218105370, 0
    .long 2, 64, 72, 7168, 1280, 1280, 7340032, 3145728, 32768, 8, 65556480, 114688, 0, 0, 218104193, 0
    .long 1, 16, 16, 8192, 1024, 1280, 8388608, 1572864, 32768, 8, 10502144, 131072, 0, 0, 218108698, 0
    .long 2, 64, 72, 7168, 768, 768, 7340032, 2097152, 32768, 8, 61878272, 114688, 0, 0, 218104065, 0
    .long 1, 80, 80, 2048, 512, 768, 7340032, 54525952, 114688, 7, 117448704, 32768, 218103808, 7, 218106369, 0
    .long 1, 80, 80, 2048, 1024, 1280, 7340032, 61865984, 114688, 7, 119554048, 32768, 218104064, 7, 218106625, 0
    .long 6, 0, 0, 0, 0, 0, 0, 5, 0, 0, 0, 0, 0, 0, 0, 0
    .long 6, 0, 0, 0, 0, 0, 0, 30, 0, 0, 0, 0, 0, 0, 0, 0
    .long 0, 0, 0, 0, 0, 0, 0, 0, 0, 0, 0, 0, 0, 0, 0, 0
    .long 0, 0, 0, 0, 0, 0, 0, 0, 0, 0, 0, 0, 0, 0, 0, 0
    .long 0, 0, 0, 0, 0, 0, 0, 0, 0, 0, 0, 0, 0, 0, 0, 0
    .long 0, 0, 0, 0, 0, 0, 0, 0, 0, 0, 0, 0, 0, 0, 0, 0
    .long 0, 0, 0, 0, 0, 0, 0, 0, 0, 0, 0, 0, 0, 0, 0, 0
    .long 0, 0, 0, 0, 0, 0, 0, 0, 0, 0, 0, 0, 0, 0, 0, 0
    .long 1, 24, 24, 8192, 3072, 3328, 8388608, 524288, 32768, 8, 23117824, 131072, 0, 0, 218104634, 0
    .long 1, 24, 24, 8192, 3584, 3840, 8388608, 2097152, 32768, 8, 29417472, 131072, 0, 0, 218105402, 0
    .long 2, 64, 72, 7168, 3072, 3072, 7340032, 3145728, 32768, 8, 65585152, 114688, 0, 0, 218104196, 0
    .long 1, 16, 16, 8192, 3072, 3328, 8388608, 1572864, 32768, 8, 10534912, 131072, 0, 0, 218108730, 0
    .long 2, 64, 72, 7168, 2560, 2560, 7340032, 2097152, 32768, 8, 61906944, 114688, 0, 0, 218104068, 0
    .long 1, 80, 80, 2048, 1835520, 1835776, 7340032, 54554624, 114688, 7, 121643008, 32768, 218103812, 7, 218106369, 0
    .long 1, 80, 80, 2048, 1836032, 1836288, 7340032, 61894656, 114688, 7, 123748352, 32768, 218104068, 7, 218106625, 0
    .long 6, 0, 0, 0, 1, 0, 0, 5, 0, 0, 0, 0, 0, 0, 0, 0
    .long 6, 0, 0, 0, 1, 0, 0, 30, 0, 0, 0, 0, 0, 0, 0, 0
    .long 0, 0, 0, 0, 0, 0, 0, 0, 0, 0, 0, 0, 0, 0, 0, 0
    .long 0, 0, 0, 0, 0, 0, 0, 0, 0, 0, 0, 0, 0, 0, 0, 0
    .long 0, 0, 0, 0, 0, 0, 0, 0, 0, 0, 0, 0, 0, 0, 0, 0
    .long 0, 0, 0, 0, 0, 0, 0, 0, 0, 0, 0, 0, 0, 0, 0, 0
    .long 0, 0, 0, 0, 0, 0, 0, 0, 0, 0, 0, 0, 0, 0, 0, 0
    .long 0, 0, 0, 0, 0, 0, 0, 0, 0, 0, 0, 0, 0, 0, 0, 0
    .long 1, 24, 24, 8192, 5120, 5376, 8388608, 524288, 32768, 8, 23150592, 131072, 0, 0, 218104666, 0
    .long 1, 24, 24, 8192, 5632, 5888, 8388608, 2097152, 32768, 8, 29450240, 131072, 0, 0, 218105434, 0
    .long 2, 64, 72, 7168, 4864, 4864, 7340032, 3145728, 32768, 8, 65613824, 114688, 0, 0, 218104209, 0
    .long 1, 16, 16, 8192, 5120, 5376, 8388608, 1572864, 32768, 8, 10567680, 131072, 0, 0, 218108762, 0
    .long 2, 64, 72, 7168, 4352, 4352, 7340032, 2097152, 32768, 8, 61935616, 114688, 0, 0, 218104081, 0
    .long 1, 80, 80, 2048, 3670528, 3670784, 7340032, 54583296, 114688, 7, 125837312, 32768, 218103824, 7, 218106369, 0
    .long 1, 80, 80, 2048, 3671040, 3671296, 7340032, 61923328, 114688, 7, 127942656, 32768, 218104080, 7, 218106625, 0
    .long 6, 0, 0, 0, 2, 0, 0, 5, 0, 0, 0, 0, 0, 0, 0, 0
    .long 6, 0, 0, 0, 2, 0, 0, 30, 0, 0, 0, 0, 0, 0, 0, 0
    .long 0, 0, 0, 0, 0, 0, 0, 0, 0, 0, 0, 0, 0, 0, 0, 0
    .long 0, 0, 0, 0, 0, 0, 0, 0, 0, 0, 0, 0, 0, 0, 0, 0
    .long 0, 0, 0, 0, 0, 0, 0, 0, 0, 0, 0, 0, 0, 0, 0, 0
    .long 0, 0, 0, 0, 0, 0, 0, 0, 0, 0, 0, 0, 0, 0, 0, 0
    .long 0, 0, 0, 0, 0, 0, 0, 0, 0, 0, 0, 0, 0, 0, 0, 0
    .long 0, 0, 0, 0, 0, 0, 0, 0, 0, 0, 0, 0, 0, 0, 0, 0
    .long 1, 24, 24, 8192, 7168, 7424, 8388608, 524288, 32768, 8, 23183360, 131072, 0, 0, 218104698, 0
    .long 1, 24, 24, 8192, 7680, 7936, 8388608, 2097152, 32768, 8, 29483008, 131072, 0, 0, 218105466, 0
    .long 2, 64, 72, 7168, 6656, 6656, 7340032, 3145728, 32768, 8, 65642496, 114688, 0, 0, 218104212, 0
    .long 1, 16, 16, 8192, 7168, 7424, 8388608, 1572864, 32768, 8, 10600448, 131072, 0, 0, 218108794, 0
    .long 2, 64, 72, 7168, 6144, 6144, 7340032, 2097152, 32768, 8, 61964288, 114688, 0, 0, 218104084, 0
    .long 1, 80, 80, 2048, 5505536, 5505792, 7340032, 54611968, 114688, 7, 130031616, 32768, 218103828, 7, 218106369, 0
    .long 1, 80, 80, 2048, 5506048, 5506304, 7340032, 61952000, 114688, 7, 132136960, 32768, 218104084, 7, 218106625, 0
    .long 6, 0, 0, 0, 3, 0, 0, 5, 0, 0, 0, 0, 0, 0, 0, 0
    .long 6, 0, 0, 0, 3, 0, 0, 30, 0, 0, 0, 0, 0, 0, 0, 0
    .long 0, 0, 0, 0, 0, 0, 0, 0, 0, 0, 0, 0, 0, 0, 0, 0
    .long 0, 0, 0, 0, 0, 0, 0, 0, 0, 0, 0, 0, 0, 0, 0, 0
    .long 0, 0, 0, 0, 0, 0, 0, 0, 0, 0, 0, 0, 0, 0, 0, 0
    .long 0, 0, 0, 0, 0, 0, 0, 0, 0, 0, 0, 0, 0, 0, 0, 0
    .long 0, 0, 0, 0, 0, 0, 0, 0, 0, 0, 0, 0, 0, 0, 0, 0
    .long 0, 0, 0, 0, 0, 0, 0, 0, 0, 0, 0, 0, 0, 0, 0, 0
    .long 1, 24, 24, 8192, 1536, 1792, 8388608, 524288, 32768, 8, 23093248, 131072, 0, 0, 218104602, 0
    .long 1, 24, 24, 8192, 1536, 1792, 8388608, 1572864, 32768, 8, 27287552, 131072, 0, 0, 218105114, 0
    .long 1, 16, 16, 8192, 512, 768, 8388608, 1572864, 32768, 8, 10493952, 131072, 0, 0, 218108682, 0
    .long 1, 16, 16, 8192, 1024, 1280, 8388608, 1048576, 32768, 8, 8404992, 131072, 0, 0, 218108442, 0
    .long 2, 64, 72, 7168, 1024, 1024, 7340032, 3670016, 32768, 8, 67387392, 114688, 0, 0, 218104257, 0
    .long 2, 64, 72, 7168, 768, 768, 7340032, 2621440, 32768, 8, 63713280, 114688, 0, 0, 218104129, 0
    .long 1, 80, 80, 2048, 0, 256, 7340032, 65536000, 114688, 7, 120586240, 32768, 218104192, 7, 218106753, 0
    .long 6, 0, 0, 0, 0, 0, 0, 29, 0, 0, 0, 0, 0, 0, 0, 0
    .long 6, 0, 0, 0, 0, 0, 0, 35, 0, 0, 0, 0, 0, 0, 0, 0
    .long 0, 0, 0, 0, 0, 0, 0, 0, 0, 0, 0, 0, 0, 0, 0, 0
    .long 0, 0, 0, 0, 0, 0, 0, 0, 0, 0, 0, 0, 0, 0, 0, 0
    .long 0, 0, 0, 0, 0, 0, 0, 0, 0, 0, 0, 0, 0, 0, 0, 0
    .long 0, 0, 0, 0, 0, 0, 0, 0, 0, 0, 0, 0, 0, 0, 0, 0
    .long 0, 0, 0, 0, 0, 0, 0, 0, 0, 0, 0, 0, 0, 0, 0, 0
    .long 0, 0, 0, 0, 0, 0, 0, 0, 0, 0, 0, 0, 0, 0, 0, 0
    .long 1, 24, 24, 8192, 3584, 3840, 8388608, 524288, 32768, 8, 23126016, 131072, 0, 0, 218104634, 0
    .long 1, 24, 24, 8192, 3584, 3840, 8388608, 1572864, 32768, 8, 27320320, 131072, 0, 0, 218105146, 0
    .long 1, 16, 16, 8192, 2560, 2816, 8388608, 1572864, 32768, 8, 10526720, 131072, 0, 0, 218108714, 0
    .long 1, 16, 16, 8192, 3072, 3328, 8388608, 1048576, 32768, 8, 8437760, 131072, 0, 0, 218108474, 0
    .long 2, 64, 72, 7168, 2816, 2816, 7340032, 3670016, 32768, 8, 67416064, 114688, 0, 0, 218104260, 0
    .long 2, 64, 72, 7168, 2560, 2560, 7340032, 2621440, 32768, 8, 63741952, 114688, 0, 0, 218104132, 0
    .long 1, 80, 80, 2048, 1835008, 1835264, 7340032, 65564672, 114688, 7, 124780544, 32768, 218104196, 7, 218106753, 0
    .long 6, 0, 0, 0, 1, 0, 0, 29, 0, 0, 0, 0, 0, 0, 0, 0
    .long 6, 0, 0, 0, 1, 0, 0, 35, 0, 0, 0, 0, 0, 0, 0, 0
    .long 0, 0, 0, 0, 0, 0, 0, 0, 0, 0, 0, 0, 0, 0, 0, 0
    .long 0, 0, 0, 0, 0, 0, 0, 0, 0, 0, 0, 0, 0, 0, 0, 0
    .long 0, 0, 0, 0, 0, 0, 0, 0, 0, 0, 0, 0, 0, 0, 0, 0
    .long 0, 0, 0, 0, 0, 0, 0, 0, 0, 0, 0, 0, 0, 0, 0, 0
    .long 0, 0, 0, 0, 0, 0, 0, 0, 0, 0, 0, 0, 0, 0, 0, 0
    .long 0, 0, 0, 0, 0, 0, 0, 0, 0, 0, 0, 0, 0, 0, 0, 0
    .long 1, 24, 24, 8192, 5632, 5888, 8388608, 524288, 32768, 8, 23158784, 131072, 0, 0, 218104666, 0
    .long 1, 24, 24, 8192, 5632, 5888, 8388608, 1572864, 32768, 8, 27353088, 131072, 0, 0, 218105178, 0
    .long 1, 16, 16, 8192, 4608, 4864, 8388608, 1572864, 32768, 8, 10559488, 131072, 0, 0, 218108746, 0
    .long 1, 16, 16, 8192, 5120, 5376, 8388608, 1048576, 32768, 8, 8470528, 131072, 0, 0, 218108506, 0
    .long 2, 64, 72, 7168, 4608, 4608, 7340032, 3670016, 32768, 8, 67444736, 114688, 0, 0, 218104273, 0
    .long 2, 64, 72, 7168, 4352, 4352, 7340032, 2621440, 32768, 8, 63770624, 114688, 0, 0, 218104145, 0
    .long 1, 80, 80, 2048, 3670016, 3670272, 7340032, 65593344, 114688, 7, 128974848, 32768, 218104208, 7, 218106753, 0
    .long 6, 0, 0, 0, 2, 0, 0, 29, 0, 0, 0, 0, 0, 0, 0, 0
    .long 6, 0, 0, 0, 2, 0, 0, 35, 0, 0, 0, 0, 0, 0, 0, 0
    .long 0, 0, 0, 0, 0, 0, 0, 0, 0, 0, 0, 0, 0, 0, 0, 0
    .long 0, 0, 0, 0, 0, 0, 0, 0, 0, 0, 0, 0, 0, 0, 0, 0
    .long 0, 0, 0, 0, 0, 0, 0, 0, 0, 0, 0, 0, 0, 0, 0, 0
    .long 0, 0, 0, 0, 0, 0, 0, 0, 0, 0, 0, 0, 0, 0, 0, 0
    .long 0, 0, 0, 0, 0, 0, 0, 0, 0, 0, 0, 0, 0, 0, 0, 0
    .long 0, 0, 0, 0, 0, 0, 0, 0, 0, 0, 0, 0, 0, 0, 0, 0
    .long 1, 24, 24, 8192, 7680, 7936, 8388608, 524288, 32768, 8, 23191552, 131072, 0, 0, 218104698, 0
    .long 1, 24, 24, 8192, 7680, 7936, 8388608, 1572864, 32768, 8, 27385856, 131072, 0, 0, 218105210, 0
    .long 1, 16, 16, 8192, 6656, 6912, 8388608, 1572864, 32768, 8, 10592256, 131072, 0, 0, 218108778, 0
    .long 1, 16, 16, 8192, 7168, 7424, 8388608, 1048576, 32768, 8, 8503296, 131072, 0, 0, 218108538, 0
    .long 2, 64, 72, 7168, 6400, 6400, 7340032, 3670016, 32768, 8, 67473408, 114688, 0, 0, 218104276, 0
    .long 2, 64, 72, 7168, 6144, 6144, 7340032, 2621440, 32768, 8, 63799296, 114688, 0, 0, 218104148, 0
    .long 1, 80, 80, 2048, 5505024, 5505280, 7340032, 65622016, 114688, 7, 133169152, 32768, 218104212, 7, 218106753, 0
    .long 6, 0, 0, 0, 3, 0, 0, 29, 0, 0, 0, 0, 0, 0, 0, 0
    .long 6, 0, 0, 0, 3, 0, 0, 35, 0, 0, 0, 0, 0, 0, 0, 0
    .long 0, 0, 0, 0, 0, 0, 0, 0, 0, 0, 0, 0, 0, 0, 0, 0
    .long 0, 0, 0, 0, 0, 0, 0, 0, 0, 0, 0, 0, 0, 0, 0, 0
    .long 0, 0, 0, 0, 0, 0, 0, 0, 0, 0, 0, 0, 0, 0, 0, 0
    .long 0, 0, 0, 0, 0, 0, 0, 0, 0, 0, 0, 0, 0, 0, 0, 0
    .long 0, 0, 0, 0, 0, 0, 0, 0, 0, 0, 0, 0, 0, 0, 0, 0
    .long 0, 0, 0, 0, 0, 0, 0, 0, 0, 0, 0, 0, 0, 0, 0, 0
    .long 1, 32, 32, 8192, 0, 256, 8388608, 524288, 32768, 8, 39845888, 131072, 0, 0, 218104586, 0
    .long 1, 24, 24, 8192, 512, 768, 8388608, 3145728, 32768, 8, 33562624, 131072, 0, 0, 218105866, 0
    .long 2, 64, 72, 7168, 0, 0, 7340032, 2097152, 32768, 8, 61865984, 114688, 0, 0, 218104065, 0
    .long 2, 64, 72, 7168, 768, 768, 7340032, 524288, 32768, 8, 56373248, 114688, 0, 0, 218103873, 0
    .long 2, 64, 72, 7168, 1536, 1536, 7340032, 2097152, 32768, 8, 61890560, 114688, 0, 0, 218104065, 0
    .long 1, 80, 80, 2048, 0, 256, 7340032, 58195968, 114688, 7, 118489088, 32768, 218103936, 7, 218106497, 0
    .long 1, 80, 80, 2048, 512, 768, 7340032, 61865984, 114688, 7, 119545856, 32768, 218104064, 7, 218106625, 0
    .long 6, 0, 0, 0, 0, 0, 0, 22, 0, 0, 0, 0, 0, 0, 0, 0
    .long 6, 0, 0, 0, 0, 0, 0, 25, 0, 0, 0, 0, 0, 0, 0, 0
    .long 6, 0, 0, 0, 0, 0, 0, 42, 0, 0, 0, 0, 0, 0, 0, 0
    .long 0, 0, 0, 0, 0, 0, 0, 0, 0, 0, 0, 0, 0, 0, 0, 0
    .long 0, 0, 0, 0, 0, 0, 0, 0, 0, 0, 0, 0, 0, 0, 0, 0
    .long 0, 0, 0, 0, 0, 0, 0, 0, 0, 0, 0, 0, 0, 0, 0, 0
    .long 0, 0, 0, 0, 0, 0, 0, 0, 0, 0, 0, 0, 0, 0, 0, 0
    .long 0, 0, 0, 0, 0, 0, 0, 0, 0, 0, 0, 0, 0, 0, 0, 0
    .long 1, 32, 32, 8192, 2048, 2304, 8388608, 524288, 32768, 8, 39878656, 131072, 0, 0, 218104618, 0
    .long 1, 24, 24, 8192, 2560, 2816, 8388608, 3145728, 32768, 8, 33595392, 131072, 0, 0, 218105898, 0
    .long 2, 64, 72, 7168, 1792, 1792, 7340032, 2097152, 32768, 8, 61894656, 114688, 0, 0, 218104068, 0
    .long 2, 64, 72, 7168, 2560, 2560, 7340032, 524288, 32768, 8, 56401920, 114688, 0, 0, 218103876, 0
    .long 2, 64, 72, 7168, 3328, 3328, 7340032, 2097152, 32768, 8, 61919232, 114688, 0, 0, 218104068, 0
    .long 1, 80, 80, 2048, 1835008, 1835264, 7340032, 58224640, 114688, 7, 122683392, 32768, 218103940, 7, 218106497, 0
    .long 1, 80, 80, 2048, 1835520, 1835776, 7340032, 61894656, 114688, 7, 123740160, 32768, 218104068, 7, 218106625, 0
    .long 6, 0, 0, 0, 1, 0, 0, 22, 0, 0, 0, 0, 0, 0, 0, 0
    .long 6, 0, 0, 0, 1, 0, 0, 25, 0, 0, 0, 0, 0, 0, 0, 0
    .long 6, 0, 0, 0, 1, 0, 0, 42, 0, 0, 0, 0, 0, 0, 0, 0
    .long 0, 0, 0, 0, 0, 0, 0, 0, 0, 0, 0, 0, 0, 0, 0, 0
    .long 0, 0, 0, 0, 0, 0, 0, 0, 0, 0, 0, 0, 0, 0, 0, 0
    .long 0, 0, 0, 0, 0, 0, 0, 0, 0, 0, 0, 0, 0, 0, 0, 0
    .long 0, 0, 0, 0, 0, 0, 0, 0, 0, 0, 0, 0, 0, 0, 0, 0
    .long 0, 0, 0, 0, 0, 0, 0, 0, 0, 0, 0, 0, 0, 0, 0, 0
    .long 1, 32, 32, 8192, 4096, 4352, 8388608, 524288, 32768, 8, 39911424, 131072, 0, 0, 218104650, 0
    .long 1, 24, 24, 8192, 4608, 4864, 8388608, 3145728, 32768, 8, 33628160, 131072, 0, 0, 218105930, 0
    .long 2, 64, 72, 7168, 3584, 3584, 7340032, 2097152, 32768, 8, 61923328, 114688, 0, 0, 218104081, 0
    .long 2, 64, 72, 7168, 4352, 4352, 7340032, 524288, 32768, 8, 56430592, 114688, 0, 0, 218103889, 0
    .long 2, 64, 72, 7168, 5120, 5120, 7340032, 2097152, 32768, 8, 61947904, 114688, 0, 0, 218104081, 0
    .long 1, 80, 80, 2048, 3670016, 3670272, 7340032, 58253312, 114688, 7, 126877696, 32768, 218103952, 7, 218106497, 0
    .long 1, 80, 80, 2048, 3670528, 3670784, 7340032, 61923328, 114688, 7, 127934464, 32768, 218104080, 7, 218106625, 0
    .long 6, 0, 0, 0, 2, 0, 0, 22, 0, 0, 0, 0, 0, 0, 0, 0
    .long 6, 0, 0, 0, 2, 0, 0, 25, 0, 0, 0, 0, 0, 0, 0, 0
    .long 6, 0, 0, 0, 2, 0, 0, 42, 0, 0, 0, 0, 0, 0, 0, 0
    .long 0, 0, 0, 0, 0, 0, 0, 0, 0, 0, 0, 0, 0, 0, 0, 0
    .long 0, 0, 0, 0, 0, 0, 0, 0, 0, 0, 0, 0, 0, 0, 0, 0
    .long 0, 0, 0, 0, 0, 0, 0, 0, 0, 0, 0, 0, 0, 0, 0, 0
    .long 0, 0, 0, 0, 0, 0, 0, 0, 0, 0, 0, 0, 0, 0, 0, 0
    .long 0, 0, 0, 0, 0, 0, 0, 0, 0, 0, 0, 0, 0, 0, 0, 0
    .long 1, 32, 32, 8192, 6144, 6400, 8388608, 524288, 32768, 8, 39944192, 131072, 0, 0, 218104682, 0
    .long 1, 24, 24, 8192, 6656, 6912, 8388608, 3145728, 32768, 8, 33660928, 131072, 0, 0, 218105962, 0
    .long 2, 64, 72, 7168, 5376, 5376, 7340032, 2097152, 32768, 8, 61952000, 114688, 0, 0, 218104084, 0
    .long 2, 64, 72, 7168, 6144, 6144, 7340032, 524288, 32768, 8, 56459264, 114688, 0, 0, 218103892, 0
    .long 2, 64, 72, 7168, 6912, 6912, 7340032, 2097152, 32768, 8, 61976576, 114688, 0, 0, 218104084, 0
    .long 1, 80, 80, 2048, 5505024, 5505280, 7340032, 58281984, 114688, 7, 131072000, 32768, 218103956, 7, 218106497, 0
    .long 1, 80, 80, 2048, 5505536, 5505792, 7340032, 61952000, 114688, 7, 132128768, 32768, 218104084, 7, 218106625, 0
    .long 6, 0, 0, 0, 3, 0, 0, 22, 0, 0, 0, 0, 0, 0, 0, 0
    .long 6, 0, 0, 0, 3, 0, 0, 25, 0, 0, 0, 0, 0, 0, 0, 0
    .long 6, 0, 0, 0, 3, 0, 0, 42, 0, 0, 0, 0, 0, 0, 0, 0
    .long 0, 0, 0, 0, 0, 0, 0, 0, 0, 0, 0, 0, 0, 0, 0, 0
    .long 0, 0, 0, 0, 0, 0, 0, 0, 0, 0, 0, 0, 0, 0, 0, 0
    .long 0, 0, 0, 0, 0, 0, 0, 0, 0, 0, 0, 0, 0, 0, 0, 0
    .long 0, 0, 0, 0, 0, 0, 0, 0, 0, 0, 0, 0, 0, 0, 0, 0
    .long 0, 0, 0, 0, 0, 0, 0, 0, 0, 0, 0, 0, 0, 0, 0, 0
    .long 1, 32, 32, 8192, 512, 768, 8388608, 524288, 32768, 8, 39854080, 131072, 0, 0, 218104586, 0
    .long 1, 32, 32, 8192, 512, 768, 8388608, 3670016, 32768, 8, 52436992, 131072, 0, 0, 218106122, 0
    .long 1, 16, 16, 8192, 0, 256, 8388608, 1572864, 32768, 8, 10485760, 131072, 0, 0, 218108682, 0
    .long 1, 24, 24, 8192, 1536, 1792, 8388608, 3145728, 32768, 8, 33579008, 131072, 0, 0, 218105882, 0
    .long 2, 64, 72, 7168, 512, 512, 7340032, 3145728, 32768, 8, 65544192, 114688, 0, 0, 218104193, 0
    .long 1, 80, 80, 2048, 512, 768, 7340032, 65536000, 114688, 7, 120594432, 32768, 218104192, 7, 218106753, 0
    .long 1, 40, 40, 2048, 1024, 1280, 8388608, 182452224, 131072, 8, 77086720, 32768, 218107072, 4, 218106564, 0
    .long 6, 0, 0, 0, 0, 0, 0, 10, 0, 0, 0, 0, 0, 0, 0, 0
    .long 6, 0, 0, 0, 0, 0, 0, 37, 0, 0, 0, 0, 0, 0, 0, 0
    .long 7, 0, 0, 0, 0, 0, 0, 62, 0, 0, 0, 0, 0, 0, 0, 0
    .long 0, 0, 0, 0, 0, 0, 0, 0, 0, 0, 0, 0, 0, 0, 0, 0
    .long 0, 0, 0, 0, 0, 0, 0, 0, 0, 0, 0, 0, 0, 0, 0, 0
    .long 0, 0, 0, 0, 0, 0, 0, 0, 0, 0, 0, 0, 0, 0, 0, 0
    .long 0, 0, 0, 0, 0, 0, 0, 0, 0, 0, 0, 0, 0, 0, 0, 0
    .long 0, 0, 0, 0, 0, 0, 0, 0, 0, 0, 0, 0, 0, 0, 0, 0
    .long 1, 32, 32, 8192, 2560, 2816, 8388608, 524288, 32768, 8, 39886848, 131072, 0, 0, 218104618, 0
    .long 1, 32, 32, 8192, 2560, 2816, 8388608, 3670016, 32768, 8, 52469760, 131072, 0, 0, 218106154, 0
    .long 1, 16, 16, 8192, 2048, 2304, 8388608, 1572864, 32768, 8, 10518528, 131072, 0, 0, 218108714, 0
    .long 1, 24, 24, 8192, 3584, 3840, 8388608, 3145728, 32768, 8, 33611776, 131072, 0, 0, 218105914, 0
    .long 2, 64, 72, 7168, 2304, 2304, 7340032, 3145728, 32768, 8, 65572864, 114688, 0, 0, 218104196, 0
    .long 1, 80, 80, 2048, 1835520, 1835776, 7340032, 65564672, 114688, 7, 124788736, 32768, 218104196, 7, 218106753, 0
    .long 1, 40, 40, 2048, 2098176, 2098432, 8388608, 182484992, 131072, 8, 81281024, 32768, 218107076, 4, 218106564, 0
    .long 6, 0, 0, 0, 1, 0, 0, 10, 0, 0, 0, 0, 0, 0, 0, 0
    .long 6, 0, 0, 0, 1, 0, 0, 37, 0, 0, 0, 0, 0, 0, 0, 0
    .long 7, 0, 0, 0, 4, 0, 0, 62, 0, 0, 0, 0, 0, 0, 0, 0
    .long 0, 0, 0, 0, 0, 0, 0, 0, 0, 0, 0, 0, 0, 0, 0, 0
    .long 0, 0, 0, 0, 0, 0, 0, 0, 0, 0, 0, 0, 0, 0, 0, 0
    .long 0, 0, 0, 0, 0, 0, 0, 0, 0, 0, 0, 0, 0, 0, 0, 0
    .long 0, 0, 0, 0, 0, 0, 0, 0, 0, 0, 0, 0, 0, 0, 0, 0
    .long 0, 0, 0, 0, 0, 0, 0, 0, 0, 0, 0, 0, 0, 0, 0, 0
    .long 1, 32, 32, 8192, 4608, 4864, 8388608, 524288, 32768, 8, 39919616, 131072, 0, 0, 218104650, 0
    .long 1, 32, 32, 8192, 4608, 4864, 8388608, 3670016, 32768, 8, 52502528, 131072, 0, 0, 218106186, 0
    .long 1, 16, 16, 8192, 4096, 4352, 8388608, 1572864, 32768, 8, 10551296, 131072, 0, 0, 218108746, 0
    .long 1, 24, 24, 8192, 5632, 5888, 8388608, 3145728, 32768, 8, 33644544, 131072, 0, 0, 218105946, 0
    .long 2, 64, 72, 7168, 4096, 4096, 7340032, 3145728, 32768, 8, 65601536, 114688, 0, 0, 218104209, 0
    .long 1, 80, 80, 2048, 3670528, 3670784, 7340032, 65593344, 114688, 7, 128983040, 32768, 218104208, 7, 218106753, 0
    .long 1, 40, 40, 2048, 4195328, 4195584, 8388608, 182517760, 131072, 8, 85475328, 32768, 218107088, 4, 218106564, 0
    .long 6, 0, 0, 0, 2, 0, 0, 10, 0, 0, 0, 0, 0, 0, 0, 0
    .long 6, 0, 0, 0, 2, 0, 0, 37, 0, 0, 0, 0, 0, 0, 0, 0
    .long 7, 0, 0, 0, 8, 0, 0, 62, 0, 0, 0, 0, 0, 0, 0, 0
    .long 0, 0, 0, 0, 0, 0, 0, 0, 0, 0, 0, 0, 0, 0, 0, 0
    .long 0, 0, 0, 0, 0, 0, 0, 0, 0, 0, 0, 0, 0, 0, 0, 0
    .long 0, 0, 0, 0, 0, 0, 0, 0, 0, 0, 0, 0, 0, 0, 0, 0
    .long 0, 0, 0, 0, 0, 0, 0, 0, 0, 0, 0, 0, 0, 0, 0, 0
    .long 0, 0, 0, 0, 0, 0, 0, 0, 0, 0, 0, 0, 0, 0, 0, 0
    .long 1, 32, 32, 8192, 6656, 6912, 8388608, 524288, 32768, 8, 39952384, 131072, 0, 0, 218104682, 0
    .long 1, 32, 32, 8192, 6656, 6912, 8388608, 3670016, 32768, 8, 52535296, 131072, 0, 0, 218106218, 0
    .long 1, 16, 16, 8192, 6144, 6400, 8388608, 1572864, 32768, 8, 10584064, 131072, 0, 0, 218108778, 0
    .long 1, 24, 24, 8192, 7680, 7936, 8388608, 3145728, 32768, 8, 33677312, 131072, 0, 0, 218105978, 0
    .long 2, 64, 72, 7168, 5888, 5888, 7340032, 3145728, 32768, 8, 65630208, 114688, 0, 0, 218104212, 0
    .long 1, 80, 80, 2048, 5505536, 5505792, 7340032, 65622016, 114688, 7, 133177344, 32768, 218104212, 7, 218106753, 0
    .long 1, 40, 40, 2048, 6292480, 6292736, 8388608, 182550528, 131072, 8, 89669632, 32768, 218107092, 4, 218106564, 0
    .long 6, 0, 0, 0, 3, 0, 0, 10, 0, 0, 0, 0, 0, 0, 0, 0
    .long 6, 0, 0, 0, 3, 0, 0, 37, 0, 0, 0, 0, 0, 0, 0, 0
    .long 7, 0, 0, 0, 12, 0, 0, 62, 0, 0, 0, 0, 0, 0, 0, 0
    .long 0, 0, 0, 0, 0, 0, 0, 0, 0, 0, 0, 0, 0, 0, 0, 0
    .long 0, 0, 0, 0, 0, 0, 0, 0, 0, 0, 0, 0, 0, 0, 0, 0
    .long 0, 0, 0, 0, 0, 0, 0, 0, 0, 0, 0, 0, 0, 0, 0, 0
    .long 0, 0, 0, 0, 0, 0, 0, 0, 0, 0, 0, 0, 0, 0, 0, 0
    .long 0, 0, 0, 0, 0, 0, 0, 0, 0, 0, 0, 0, 0, 0, 0, 0
    .long 1, 32, 32, 8192, 1024, 1280, 8388608, 524288, 32768, 8, 39862272, 131072, 0, 0, 218104602, 0
    .long 1, 32, 32, 8192, 512, 768, 8388608, 2621440, 32768, 8, 48242688, 131072, 0, 0, 218105610, 0
    .long 2, 64, 72, 7168, 1536, 1536, 7340032, 524288, 32768, 8, 56385536, 114688, 0, 0, 218103873, 0
    .long 1, 16, 16, 8192, 0, 256, 8388608, 1048576, 32768, 8, 8388608, 131072, 0, 0, 218108426, 0
    .long 1, 80, 80, 2048, 1536, 1792, 7340032, 60030976, 114688, 7, 119037952, 32768, 218104000, 7, 218106561, 0
    .long 5, 218108928, 0, 0, 0, 0, 0, 36, 0, 0, 0, 0, 218112000, 39, 218107137, 0
    .long 1, 40, 40, 2048, 0, 256, 8388608, 180355072, 131072, 8, 76546048, 32768, 218107008, 4, 218106500, 0
    .long 6, 0, 0, 0, 0, 0, 0, 12, 0, 0, 0, 0, 0, 0, 0, 0
    .long 6, 0, 0, 0, 0, 0, 0, 19, 0, 0, 0, 0, 0, 0, 0, 0
    .long 6, 0, 0, 0, 0, 0, 0, 39, 0, 0, 0, 0, 0, 0, 0, 0
    .long 7, 0, 0, 0, 3, 0, 0, 62, 0, 0, 0, 0, 0, 0, 0, 0
    .long 0, 0, 0, 0, 0, 0, 0, 0, 0, 0, 0, 0, 0, 0, 0, 0
    .long 0, 0, 0, 0, 0, 0, 0, 0, 0, 0, 0, 0, 0, 0, 0, 0
    .long 0, 0, 0, 0, 0, 0, 0, 0, 0, 0, 0, 0, 0, 0, 0, 0
    .long 0, 0, 0, 0, 0, 0, 0, 0, 0, 0, 0, 0, 0, 0, 0, 0
    .long 1, 32, 32, 8192, 3072, 3328, 8388608, 524288, 32768, 8, 39895040, 131072, 0, 0, 218104634, 0
    .long 1, 32, 32, 8192, 2560, 2816, 8388608, 2621440, 32768, 8, 48275456, 131072, 0, 0, 218105642, 0
    .long 2, 64, 72, 7168, 3328, 3328, 7340032, 524288, 32768, 8, 56414208, 114688, 0, 0, 218103876, 0
    .long 1, 16, 16, 8192, 2048, 2304, 8388608, 1048576, 32768, 8, 8421376, 131072, 0, 0, 218108458, 0
    .long 1, 80, 80, 2048, 1836544, 1836800, 7340032, 60059648, 114688, 7, 123232256, 32768, 218104004, 7, 218106561, 0
    .long 5, 218108960, 0, 0, 8, 0, 0, 36, 0, 0, 0, 0, 218112128, 39, 218107140, 0
    .long 1, 40, 40, 2048, 2097152, 2097408, 8388608, 180387840, 131072, 8, 80740352, 32768, 218107012, 4, 218106500, 0
    .long 6, 0, 0, 0, 1, 0, 0, 12, 0, 0, 0, 0, 0, 0, 0, 0
    .long 6, 0, 0, 0, 1, 0, 0, 19, 0, 0, 0, 0, 0, 0, 0, 0
    .long 6, 0, 0, 0, 1, 0, 0, 39, 0, 0, 0, 0, 0, 0, 0, 0
    .long 7, 0, 0, 0, 7, 0, 0, 62, 0, 0, 0, 0, 0, 0, 0, 0
    .long 0, 0, 0, 0, 0, 0, 0, 0, 0, 0, 0, 0, 0, 0, 0, 0
    .long 0, 0, 0, 0, 0, 0, 0, 0, 0, 0, 0, 0, 0, 0, 0, 0
    .long 0, 0, 0, 0, 0, 0, 0, 0, 0, 0, 0, 0, 0, 0, 0, 0
    .long 0, 0, 0, 0, 0, 0, 0, 0, 0, 0, 0, 0, 0, 0, 0, 0
    .long 1, 32, 32, 8192, 5120, 5376, 8388608, 524288, 32768, 8, 39927808, 131072, 0, 0, 218104666, 0
    .long 1, 32, 32, 8192, 4608, 4864, 8388608, 2621440, 32768, 8, 48308224, 131072, 0, 0, 218105674, 0
    .long 2, 64, 72, 7168, 5120, 5120, 7340032, 524288, 32768, 8, 56442880, 114688, 0, 0, 218103889, 0
    .long 1, 16, 16, 8192, 4096, 4352, 8388608, 1048576, 32768, 8, 8454144, 131072, 0, 0, 218108490, 0
    .long 1, 80, 80, 2048, 3671552, 3671808, 7340032, 60088320, 114688, 7, 127426560, 32768, 218104016, 7, 218106561, 0
    .long 5, 218108992, 0, 0, 16, 0, 0, 36, 0, 0, 0, 0, 218112256, 39, 218107153, 0
    .long 1, 40, 40, 2048, 4194304, 4194560, 8388608, 180420608, 131072, 8, 84934656, 32768, 218107024, 4, 218106500, 0
    .long 6, 0, 0, 0, 2, 0, 0, 12, 0, 0, 0, 0, 0, 0, 0, 0
    .long 6, 0, 0, 0, 2, 0, 0, 19, 0, 0, 0, 0, 0, 0, 0, 0
    .long 6, 0, 0, 0, 2, 0, 0, 39, 0, 0, 0, 0, 0, 0, 0, 0
    .long 7, 0, 0, 0, 11, 0, 0, 62, 0, 0, 0, 0, 0, 0, 0, 0
    .long 0, 0, 0, 0, 0, 0, 0, 0, 0, 0, 0, 0, 0, 0, 0, 0
    .long 0, 0, 0, 0, 0, 0, 0, 0, 0, 0, 0, 0, 0, 0, 0, 0
    .long 0, 0, 0, 0, 0, 0, 0, 0, 0, 0, 0, 0, 0, 0, 0, 0
    .long 0, 0, 0, 0, 0, 0, 0, 0, 0, 0, 0, 0, 0, 0, 0, 0
    .long 1, 32, 32, 8192, 7168, 7424, 8388608, 524288, 32768, 8, 39960576, 131072, 0, 0, 218104698, 0
    .long 1, 32, 32, 8192, 6656, 6912, 8388608, 2621440, 32768, 8, 48340992, 131072, 0, 0, 218105706, 0
    .long 2, 64, 72, 7168, 6912, 6912, 7340032, 524288, 32768, 8, 56471552, 114688, 0, 0, 218103892, 0
    .long 1, 16, 16, 8192, 6144, 6400, 8388608, 1048576, 32768, 8, 8486912, 131072, 0, 0, 218108522, 0
    .long 1, 80, 80, 2048, 5506560, 5506816, 7340032, 60116992, 114688, 7, 131620864, 32768, 218104020, 7, 218106561, 0
    .long 5, 218109024, 0, 0, 24, 0, 0, 36, 0, 0, 0, 0, 218112384, 39, 218107156, 0
    .long 1, 40, 40, 2048, 6291456, 6291712, 8388608, 180453376, 131072, 8, 89128960, 32768, 218107028, 4, 218106500, 0
    .long 6, 0, 0, 0, 3, 0, 0, 12, 0, 0, 0, 0, 0, 0, 0, 0
    .long 6, 0, 0, 0, 3, 0, 0, 19, 0, 0, 0, 0, 0, 0, 0, 0
    .long 6, 0, 0, 0, 3, 0, 0, 39, 0, 0, 0, 0, 0, 0, 0, 0
    .long 7, 0, 0, 0, 15, 0, 0, 62, 0, 0, 0, 0, 0, 0, 0, 0
    .long 0, 0, 0, 0, 0, 0, 0, 0, 0, 0, 0, 0, 0, 0, 0, 0
    .long 0, 0, 0, 0, 0, 0, 0, 0, 0, 0, 0, 0, 0, 0, 0, 0
    .long 0, 0, 0, 0, 0, 0, 0, 0, 0, 0, 0, 0, 0, 0, 0, 0
    .long 0, 0, 0, 0, 0, 0, 0, 0, 0, 0, 0, 0, 0, 0, 0, 0
    .long 1, 32, 32, 8192, 1536, 1792, 8388608, 524288, 32768, 8, 39870464, 131072, 0, 0, 218104602, 0
    .long 1, 32, 32, 8192, 512, 768, 8388608, 3145728, 32768, 8, 50339840, 131072, 0, 0, 218105866, 0
    .long 1, 16, 16, 8192, 512, 768, 8388608, 2097152, 32768, 8, 12591104, 131072, 0, 0, 218108938, 0
    .long 2, 64, 72, 7168, 256, 256, 7340032, 1572864, 32768, 8, 60035072, 114688, 0, 0, 218104001, 0
    .long 2, 64, 72, 7168, 512, 512, 7340032, 2097152, 32768, 8, 61874176, 114688, 0, 0, 218104065, 0
    .long 2, 64, 72, 7168, 1280, 1280, 7340032, 2621440, 32768, 8, 63721472, 114688, 0, 0, 218104129, 0
    .long 1, 80, 80, 2048, 1536, 1792, 7340032, 67371008, 114688, 7, 121135104, 32768, 218104256, 7, 218106817, 0
    .long 6, 0, 0, 0, 0, 0, 0, 27, 0, 0, 0, 0, 0, 0, 0, 0
    .long 6, 0, 0, 0, 0, 0, 0, 45, 0, 0, 0, 0, 0, 0, 0, 0
    .long 0, 0, 0, 0, 0, 0, 0, 0, 0, 0, 0, 0, 0, 0, 0, 0
    .long 0, 0, 0, 0, 0, 0, 0, 0, 0, 0, 0, 0, 0, 0, 0, 0
    .long 0, 0, 0, 0, 0, 0, 0, 0, 0, 0, 0, 0, 0, 0, 0, 0
    .long 0, 0, 0, 0, 0, 0, 0, 0, 0, 0, 0, 0, 0, 0, 0, 0
    .long 0, 0, 0, 0, 0, 0, 0, 0, 0, 0, 0, 0, 0, 0, 0, 0
    .long 0, 0, 0, 0, 0, 0, 0, 0, 0, 0, 0, 0, 0, 0, 0, 0
    .long 1, 32, 32, 8192, 3584, 3840, 8388608, 524288, 32768, 8, 39903232, 131072, 0, 0, 218104634, 0
    .long 1, 32, 32, 8192, 2560, 2816, 8388608, 3145728, 32768, 8, 50372608, 131072, 0, 0, 218105898, 0
    .long 1, 16, 16, 8192, 2560, 2816, 8388608, 2097152, 32768, 8, 12623872, 131072, 0, 0, 218108970, 0
    .long 2, 64, 72, 7168, 2048, 2048, 7340032, 1572864, 32768, 8, 60063744, 114688, 0, 0, 218104004, 0
    .long 2, 64, 72, 7168, 2304, 2304, 7340032, 2097152, 32768, 8, 61902848, 114688, 0, 0, 218104068, 0
    .long 2, 64, 72, 7168, 3072, 3072, 7340032, 2621440, 32768, 8, 63750144, 114688, 0, 0, 218104132, 0
    .long 1, 80, 80, 2048, 1836544, 1836800, 7340032, 67399680, 114688, 7, 125329408, 32768, 218104260, 7, 218106817, 0
    .long 6, 0, 0, 0, 1, 0, 0, 27, 0, 0, 0, 0, 0, 0, 0, 0
    .long 6, 0, 0, 0, 1, 0, 0, 45, 0, 0, 0, 0, 0, 0, 0, 0
    .long 0, 0, 0, 0, 0, 0, 0, 0, 0, 0, 0, 0, 0, 0, 0, 0
    .long 0, 0, 0, 0, 0, 0, 0, 0, 0, 0, 0, 0, 0, 0, 0, 0
    .long 0, 0, 0, 0, 0, 0, 0, 0, 0, 0, 0, 0, 0, 0, 0, 0
    .long 0, 0, 0, 0, 0, 0, 0, 0, 0, 0, 0, 0, 0, 0, 0, 0
    .long 0, 0, 0, 0, 0, 0, 0, 0, 0, 0, 0, 0, 0, 0, 0, 0
    .long 0, 0, 0, 0, 0, 0, 0, 0, 0, 0, 0, 0, 0, 0, 0, 0
    .long 1, 32, 32, 8192, 5632, 5888, 8388608, 524288, 32768, 8, 39936000, 131072, 0, 0, 218104666, 0
    .long 1, 32, 32, 8192, 4608, 4864, 8388608, 3145728, 32768, 8, 50405376, 131072, 0, 0, 218105930, 0
    .long 1, 16, 16, 8192, 4608, 4864, 8388608, 2097152, 32768, 8, 12656640, 131072, 0, 0, 218109002, 0
    .long 2, 64, 72, 7168, 3840, 3840, 7340032, 1572864, 32768, 8, 60092416, 114688, 0, 0, 218104017, 0
    .long 2, 64, 72, 7168, 4096, 4096, 7340032, 2097152, 32768, 8, 61931520, 114688, 0, 0, 218104081, 0
    .long 2, 64, 72, 7168, 4864, 4864, 7340032, 2621440, 32768, 8, 63778816, 114688, 0, 0, 218104145, 0
    .long 1, 80, 80, 2048, 3671552, 3671808, 7340032, 67428352, 114688, 7, 129523712, 32768, 218104272, 7, 218106817, 0
    .long 6, 0, 0, 0, 2, 0, 0, 27, 0, 0, 0, 0, 0, 0, 0, 0
    .long 6, 0, 0, 0, 2, 0, 0, 45, 0, 0, 0, 0, 0, 0, 0, 0
    .long 0, 0, 0, 0, 0, 0, 0, 0, 0, 0, 0, 0, 0, 0, 0, 0
    .long 0, 0, 0, 0, 0, 0, 0, 0, 0, 0, 0, 0, 0, 0, 0, 0
    .long 0, 0, 0, 0, 0, 0, 0, 0, 0, 0, 0, 0, 0, 0, 0, 0
    .long 0, 0, 0, 0, 0, 0, 0, 0, 0, 0, 0, 0, 0, 0, 0, 0
    .long 0, 0, 0, 0, 0, 0, 0, 0, 0, 0, 0, 0, 0, 0, 0, 0
    .long 0, 0, 0, 0, 0, 0, 0, 0, 0, 0, 0, 0, 0, 0, 0, 0
    .long 1, 32, 32, 8192, 7680, 7936, 8388608, 524288, 32768, 8, 39968768, 131072, 0, 0, 218104698, 0
    .long 1, 32, 32, 8192, 6656, 6912, 8388608, 3145728, 32768, 8, 50438144, 131072, 0, 0, 218105962, 0
    .long 1, 16, 16, 8192, 6656, 6912, 8388608, 2097152, 32768, 8, 12689408, 131072, 0, 0, 218109034, 0
    .long 2, 64, 72, 7168, 5632, 5632, 7340032, 1572864, 32768, 8, 60121088, 114688, 0, 0, 218104020, 0
    .long 2, 64, 72, 7168, 5888, 5888, 7340032, 2097152, 32768, 8, 61960192, 114688, 0, 0, 218104084, 0
    .long 2, 64, 72, 7168, 6656, 6656, 7340032, 2621440, 32768, 8, 63807488, 114688, 0, 0, 218104148, 0
    .long 1, 80, 80, 2048, 5506560, 5506816, 7340032, 67457024, 114688, 7, 133718016, 32768, 218104276, 7, 218106817, 0
    .long 6, 0, 0, 0, 3, 0, 0, 27, 0, 0, 0, 0, 0, 0, 0, 0
    .long 6, 0, 0, 0, 3, 0, 0, 45, 0, 0, 0, 0, 0, 0, 0, 0
    .long 0, 0, 0, 0, 0, 0, 0, 0, 0, 0, 0, 0, 0, 0, 0, 0
    .long 0, 0, 0, 0, 0, 0, 0, 0, 0, 0, 0, 0, 0, 0, 0, 0
    .long 0, 0, 0, 0, 0, 0, 0, 0, 0, 0, 0, 0, 0, 0, 0, 0
    .long 0, 0, 0, 0, 0, 0, 0, 0, 0, 0, 0, 0, 0, 0, 0, 0
    .long 0, 0, 0, 0, 0, 0, 0, 0, 0, 0, 0, 0, 0, 0, 0, 0
    .long 0, 0, 0, 0, 0, 0, 0, 0, 0, 0, 0, 0, 0, 0, 0, 0
    .long 1, 24, 24, 8192, 0, 256, 8388608, 1048576, 32768, 8, 25165824, 131072, 0, 0, 218104842, 0
    .long 1, 32, 32, 8192, 1024, 1280, 8388608, 1572864, 32768, 8, 44056576, 131072, 0, 0, 218105114, 0
    .long 1, 16, 16, 8192, 0, 256, 8388608, 2097152, 32768, 8, 12582912, 131072, 0, 0, 218108938, 0
    .long 2, 64, 72, 7168, 768, 768, 7340032, 1572864, 32768, 8, 60043264, 114688, 0, 0, 218104001, 0
    .long 1, 16, 16, 8192, 0, 256, 8388608, 3670016, 32768, 8, 18874368, 131072, 0, 0, 218106122, 0
    .long 1, 80, 80, 2048, 1536, 1792, 7340032, 65536000, 114688, 7, 120610816, 32768, 218104192, 7, 218106753, 0
    .long 1, 40, 40, 2048, 0, 256, 8388608, 184549376, 131072, 8, 77594624, 32768, 218107136, 4, 218106628, 0
    .long 6, 0, 0, 0, 0, 0, 0, 9, 0, 0, 0, 0, 0, 0, 0, 0
    .long 6, 0, 0, 0, 0, 0, 0, 15, 0, 0, 0, 0, 0, 0, 0, 0
    .long 7, 0, 0, 0, 3, 0, 0, 61, 0, 0, 0, 0, 0, 0, 0, 0
    .long 0, 0, 0, 0, 0, 0, 0, 0, 0, 0, 0, 0, 0, 0, 0, 0
    .long 0, 0, 0, 0, 0, 0, 0, 0, 0, 0, 0, 0, 0, 0, 0, 0
    .long 0, 0, 0, 0, 0, 0, 0, 0, 0, 0, 0, 0, 0, 0, 0, 0
    .long 0, 0, 0, 0, 0, 0, 0, 0, 0, 0, 0, 0, 0, 0, 0, 0
    .long 0, 0, 0, 0, 0, 0, 0, 0, 0, 0, 0, 0, 0, 0, 0, 0
    .long 1, 24, 24, 8192, 2048, 2304, 8388608, 1048576, 32768, 8, 25198592, 131072, 0, 0, 218104874, 0
    .long 1, 32, 32, 8192, 3072, 3328, 8388608, 1572864, 32768, 8, 44089344, 131072, 0, 0, 218105146, 0
    .long 1, 16, 16, 8192, 2048, 2304, 8388608, 2097152, 32768, 8, 12615680, 131072, 0, 0, 218108970, 0
    .long 2, 64, 72, 7168, 2560, 2560, 7340032, 1572864, 32768, 8, 60071936, 114688, 0, 0, 218104004, 0
    .long 1, 16, 16, 8192, 2048, 2304, 8388608, 3670016, 32768, 8, 18907136, 131072, 0, 0, 218106154, 0
    .long 1, 80, 80, 2048, 1836544, 1836800, 7340032, 65564672, 114688, 7, 124805120, 32768, 218104196, 7, 218106753, 0
    .long 1, 40, 40, 2048, 2097152, 2097408, 8388608, 184582144, 131072, 8, 81788928, 32768, 218107140, 4, 218106628, 0
    .long 6, 0, 0, 0, 1, 0, 0, 9, 0, 0, 0, 0, 0, 0, 0, 0
    .long 6, 0, 0, 0, 1, 0, 0, 15, 0, 0, 0, 0, 0, 0, 0, 0
    .long 7, 0, 0, 0, 7, 0, 0, 61, 0, 0, 0, 0, 0, 0, 0, 0
    .long 0, 0, 0, 0, 0, 0, 0, 0, 0, 0, 0, 0, 0, 0, 0, 0
    .long 0, 0, 0, 0, 0, 0, 0, 0, 0, 0, 0, 0, 0, 0, 0, 0
    .long 0, 0, 0, 0, 0, 0, 0, 0, 0, 0, 0, 0, 0, 0, 0, 0
    .long 0, 0, 0, 0, 0, 0, 0, 0, 0, 0, 0, 0, 0, 0, 0, 0
    .long 0, 0, 0, 0, 0, 0, 0, 0, 0, 0, 0, 0, 0, 0, 0, 0
    .long 1, 24, 24, 8192, 4096, 4352, 8388608, 1048576, 32768, 8, 25231360, 131072, 0, 0, 218104906, 0
    .long 1, 32, 32, 8192, 5120, 5376, 8388608, 1572864, 32768, 8, 44122112, 131072, 0, 0, 218105178, 0
    .long 1, 16, 16, 8192, 4096, 4352, 8388608, 2097152, 32768, 8, 12648448, 131072, 0, 0, 218109002, 0
    .long 2, 64, 72, 7168, 4352, 4352, 7340032, 1572864, 32768, 8, 60100608, 114688, 0, 0, 218104017, 0
    .long 1, 16, 16, 8192, 4096, 4352, 8388608, 3670016, 32768, 8, 18939904, 131072, 0, 0, 218106186, 0
    .long 1, 80, 80, 2048, 3671552, 3671808, 7340032, 65593344, 114688, 7, 128999424, 32768, 218104208, 7, 218106753, 0
    .long 1, 40, 40, 2048, 4194304, 4194560, 8388608, 184614912, 131072, 8, 85983232, 32768, 218107152, 4, 218106628, 0
    .long 6, 0, 0, 0, 2, 0, 0, 9, 0, 0, 0, 0, 0, 0, 0, 0
    .long 6, 0, 0, 0, 2, 0, 0, 15, 0, 0, 0, 0, 0, 0, 0, 0
    .long 7, 0, 0, 0, 11, 0, 0, 61, 0, 0, 0, 0, 0, 0, 0, 0
    .long 0, 0, 0, 0, 0, 0, 0, 0, 0, 0, 0, 0, 0, 0, 0, 0
    .long 0, 0, 0, 0, 0, 0, 0, 0, 0, 0, 0, 0, 0, 0, 0, 0
    .long 0, 0, 0, 0, 0, 0, 0, 0, 0, 0, 0, 0, 0, 0, 0, 0
    .long 0, 0, 0, 0, 0, 0, 0, 0, 0, 0, 0, 0, 0, 0, 0, 0
    .long 0, 0, 0, 0, 0, 0, 0, 0, 0, 0, 0, 0, 0, 0, 0, 0
    .long 1, 24, 24, 8192, 6144, 6400, 8388608, 1048576, 32768, 8, 25264128, 131072, 0, 0, 218104938, 0
    .long 1, 32, 32, 8192, 7168, 7424, 8388608, 1572864, 32768, 8, 44154880, 131072, 0, 0, 218105210, 0
    .long 1, 16, 16, 8192, 6144, 6400, 8388608, 2097152, 32768, 8, 12681216, 131072, 0, 0, 218109034, 0
    .long 2, 64, 72, 7168, 6144, 6144, 7340032, 1572864, 32768, 8, 60129280, 114688, 0, 0, 218104020, 0
    .long 1, 16, 16, 8192, 6144, 6400, 8388608, 3670016, 32768, 8, 18972672, 131072, 0, 0, 218106218, 0
    .long 1, 80, 80, 2048, 5506560, 5506816, 7340032, 65622016, 114688, 7, 133193728, 32768, 218104212, 7, 218106753, 0
    .long 1, 40, 40, 2048, 6291456, 6291712, 8388608, 184647680, 131072, 8, 90177536, 32768, 218107156, 4, 218106628, 0
    .long 6, 0, 0, 0, 3, 0, 0, 9, 0, 0, 0, 0, 0, 0, 0, 0
    .long 6, 0, 0, 0, 3, 0, 0, 15, 0, 0, 0, 0, 0, 0, 0, 0
    .long 7, 0, 0, 0, 15, 0, 0, 61, 0, 0, 0, 0, 0, 0, 0, 0
    .long 0, 0, 0, 0, 0, 0, 0, 0, 0, 0, 0, 0, 0, 0, 0, 0
    .long 0, 0, 0, 0, 0, 0, 0, 0, 0, 0, 0, 0, 0, 0, 0, 0
    .long 0, 0, 0, 0, 0, 0, 0, 0, 0, 0, 0, 0, 0, 0, 0, 0
    .long 0, 0, 0, 0, 0, 0, 0, 0, 0, 0, 0, 0, 0, 0, 0, 0
    .long 0, 0, 0, 0, 0, 0, 0, 0, 0, 0, 0, 0, 0, 0, 0, 0
    .long 1, 24, 24, 8192, 512, 768, 8388608, 1048576, 32768, 8, 25174016, 131072, 0, 0, 218104842, 0
    .long 1, 32, 32, 8192, 1536, 1792, 8388608, 2097152, 32768, 8, 46161920, 131072, 0, 0, 218105370, 0
    .long 2, 64, 72, 7168, 1280, 1280, 7340032, 524288, 32768, 8, 56381440, 114688, 0, 0, 218103873, 0
    .long 2, 64, 72, 7168, 256, 256, 7340032, 524288, 32768, 8, 56365056, 114688, 0, 0, 218103873, 0
    .long 2, 64, 72, 7168, 512, 512, 7340032, 2621440, 32768, 8, 63709184, 114688, 0, 0, 218104129, 0
    .long 1, 80, 80, 2048, 512, 768, 7340032, 56360960, 114688, 7, 117972992, 32768, 218103872, 7, 218106433, 0
    .long 1, 40, 40, 2048, 1536, 1792, 8388608, 184549376, 131072, 8, 77619200, 32768, 218107136, 4, 218106628, 0
    .long 6, 0, 0, 0, 0, 0, 0, 21, 0, 0, 0, 0, 0, 0, 0, 0
    .long 6, 0, 0, 0, 0, 0, 0, 53, 0, 0, 0, 0, 0, 0, 0, 0
    .long 7, 0, 0, 0, 2, 0, 0, 63, 0, 0, 0, 0, 0, 0, 0, 0
    .long 0, 0, 0, 0, 0, 0, 0, 0, 0, 0, 0, 0, 0, 0, 0, 0
    .long 0, 0, 0, 0, 0, 0, 0, 0, 0, 0, 0, 0, 0, 0, 0, 0
    .long 0, 0, 0, 0, 0, 0, 0, 0, 0, 0, 0, 0, 0, 0, 0, 0
    .long 0, 0, 0, 0, 0, 0, 0, 0, 0, 0, 0, 0, 0, 0, 0, 0
    .long 0, 0, 0, 0, 0, 0, 0, 0, 0, 0, 0, 0, 0, 0, 0, 0
    .long 1, 24, 24, 8192, 2560, 2816, 8388608, 1048576, 32768, 8, 25206784, 131072, 0, 0, 218104874, 0
    .long 1, 32, 32, 8192, 3584, 3840, 8388608, 2097152, 32768, 8, 46194688, 131072, 0, 0, 218105402, 0
    .long 2, 64, 72, 7168, 3072, 3072, 7340032, 524288, 32768, 8, 56410112, 114688, 0, 0, 218103876, 0
    .long 2, 64, 72, 7168, 2048, 2048, 7340032, 524288, 32768, 8, 56393728, 114688, 0, 0, 218103876, 0
    .long 2, 64, 72, 7168, 2304, 2304, 7340032, 2621440, 32768, 8, 63737856, 114688, 0, 0, 218104132, 0
    .long 1, 80, 80, 2048, 1835520, 1835776, 7340032, 56389632, 114688, 7, 122167296, 32768, 218103876, 7, 218106433, 0
    .long 1, 40, 40, 2048, 2098688, 2098944, 8388608, 184582144, 131072, 8, 81813504, 32768, 218107140, 4, 218106628, 0
    .long 6, 0, 0, 0, 1, 0, 0, 21, 0, 0, 0, 0, 0, 0, 0, 0
    .long 6, 0, 0, 0, 1, 0, 0, 53, 0, 0, 0, 0, 0, 0, 0, 0
    .long 7, 0, 0, 0, 6, 0, 0, 63, 0, 0, 0, 0, 0, 0, 0, 0
    .long 0, 0, 0, 0, 0, 0, 0, 0, 0, 0, 0, 0, 0, 0, 0, 0
    .long 0, 0, 0, 0, 0, 0, 0, 0, 0, 0, 0, 0, 0, 0, 0, 0
    .long 0, 0, 0, 0, 0, 0, 0, 0, 0, 0, 0, 0, 0, 0, 0, 0
    .long 0, 0, 0, 0, 0, 0, 0, 0, 0, 0, 0, 0, 0, 0, 0, 0
    .long 0, 0, 0, 0, 0, 0, 0, 0, 0, 0, 0, 0, 0, 0, 0, 0
    .long 1, 24, 24, 8192, 4608, 4864, 8388608, 1048576, 32768, 8, 25239552, 131072, 0, 0, 218104906, 0
    .long 1, 32, 32, 8192, 5632, 5888, 8388608, 2097152, 32768, 8, 46227456, 131072, 0, 0, 218105434, 0
    .long 2, 64, 72, 7168, 4864, 4864, 7340032, 524288, 32768, 8, 56438784, 114688, 0, 0, 218103889, 0
    .long 2, 64, 72, 7168, 3840, 3840, 7340032, 524288, 32768, 8, 56422400, 114688, 0, 0, 218103889, 0
    .long 2, 64, 72, 7168, 4096, 4096, 7340032, 2621440, 32768, 8, 63766528, 114688, 0, 0, 218104145, 0
    .long 1, 80, 80, 2048, 3670528, 3670784, 7340032, 56418304, 114688, 7, 126361600, 32768, 218103888, 7, 218106433, 0
    .long 1, 40, 40, 2048, 4195840, 4196096, 8388608, 184614912, 131072, 8, 86007808, 32768, 218107152, 4, 218106628, 0
    .long 6, 0, 0, 0, 2, 0, 0, 21, 0, 0, 0, 0, 0, 0, 0, 0
    .long 6, 0, 0, 0, 2, 0, 0, 53, 0, 0, 0, 0, 0, 0, 0, 0
    .long 7, 0, 0, 0, 10, 0, 0, 63, 0, 0, 0, 0, 0, 0, 0, 0
    .long 0, 0, 0, 0, 0, 0, 0, 0, 0, 0, 0, 0, 0, 0, 0, 0
    .long 0, 0, 0, 0, 0, 0, 0, 0, 0, 0, 0, 0, 0, 0, 0, 0
    .long 0, 0, 0, 0, 0, 0, 0, 0, 0, 0, 0, 0, 0, 0, 0, 0
    .long 0, 0, 0, 0, 0, 0, 0, 0, 0, 0, 0, 0, 0, 0, 0, 0
    .long 0, 0, 0, 0, 0, 0, 0, 0, 0, 0, 0, 0, 0, 0, 0, 0
    .long 1, 24, 24, 8192, 6656, 6912, 8388608, 1048576, 32768, 8, 25272320, 131072, 0, 0, 218104938, 0
    .long 1, 32, 32, 8192, 7680, 7936, 8388608, 2097152, 32768, 8, 46260224, 131072, 0, 0, 218105466, 0
    .long 2, 64, 72, 7168, 6656, 6656, 7340032, 524288, 32768, 8, 56467456, 114688, 0, 0, 218103892, 0
    .long 2, 64, 72, 7168, 5632, 5632, 7340032, 524288, 32768, 8, 56451072, 114688, 0, 0, 218103892, 0
    .long 2, 64, 72, 7168, 5888, 5888, 7340032, 2621440, 32768, 8, 63795200, 114688, 0, 0, 218104148, 0
    .long 1, 80, 80, 2048, 5505536, 5505792, 7340032, 56446976, 114688, 7, 130555904, 32768, 218103892, 7, 218106433, 0
    .long 1, 40, 40, 2048, 6292992, 6293248, 8388608, 184647680, 131072, 8, 90202112, 32768, 218107156, 4, 218106628, 0
    .long 6, 0, 0, 0, 3, 0, 0, 21, 0, 0, 0, 0, 0, 0, 0, 0
    .long 6, 0, 0, 0, 3, 0, 0, 53, 0, 0, 0, 0, 0, 0, 0, 0
    .long 7, 0, 0, 0, 14, 0, 0, 63, 0, 0, 0, 0, 0, 0, 0, 0
    .long 0, 0, 0, 0, 0, 0, 0, 0, 0, 0, 0, 0, 0, 0, 0, 0
    .long 0, 0, 0, 0, 0, 0, 0, 0, 0, 0, 0, 0, 0, 0, 0, 0
    .long 0, 0, 0, 0, 0, 0, 0, 0, 0, 0, 0, 0, 0, 0, 0, 0
    .long 0, 0, 0, 0, 0, 0, 0, 0, 0, 0, 0, 0, 0, 0, 0, 0
    .long 0, 0, 0, 0, 0, 0, 0, 0, 0, 0, 0, 0, 0, 0, 0, 0
    .long 1, 24, 24, 8192, 1024, 1280, 8388608, 1048576, 32768, 8, 25182208, 131072, 0, 0, 218104858, 0
    .long 1, 32, 32, 8192, 1024, 1280, 8388608, 2621440, 32768, 8, 48250880, 131072, 0, 0, 218105626, 0
    .long 1, 32, 32, 8192, 1024, 1280, 8388608, 3145728, 32768, 8, 50348032, 131072, 0, 0, 218105882, 0
    .long 1, 24, 24, 8192, 1024, 1280, 8388608, 3145728, 32768, 8, 33570816, 131072, 0, 0, 218105882, 0
    .long 2, 64, 72, 7168, 1536, 1536, 7340032, 3145728, 32768, 8, 65560576, 114688, 0, 0, 218104193, 0
    .long 1, 80, 80, 2048, 1536, 1792, 7340032, 56360960, 114688, 7, 117989376, 32768, 218103872, 7, 218106433, 0
    .long 1, 40, 40, 2048, 1536, 1792, 8388608, 180355072, 131072, 8, 76570624, 32768, 218107008, 4, 218106500, 0
    .long 6, 0, 0, 0, 0, 0, 0, 23, 0, 0, 0, 0, 0, 0, 0, 0
    .long 6, 0, 0, 0, 0, 0, 0, 28, 0, 0, 0, 0, 0, 0, 0, 0
    .long 6, 0, 0, 0, 0, 0, 0, 59, 0, 0, 0, 0, 0, 0, 0, 0
    .long 0, 0, 0, 0, 0, 0, 0, 0, 0, 0, 0, 0, 0, 0, 0, 0
    .long 0, 0, 0, 0, 0, 0, 0, 0, 0, 0, 0, 0, 0, 0, 0, 0
    .long 0, 0, 0, 0, 0, 0, 0, 0, 0, 0, 0, 0, 0, 0, 0, 0
    .long 0, 0, 0, 0, 0, 0, 0, 0, 0, 0, 0, 0, 0, 0, 0, 0
    .long 0, 0, 0, 0, 0, 0, 0, 0, 0, 0, 0, 0, 0, 0, 0, 0
    .long 1, 24, 24, 8192, 3072, 3328, 8388608, 1048576, 32768, 8, 25214976, 131072, 0, 0, 218104890, 0
    .long 1, 32, 32, 8192, 3072, 3328, 8388608, 2621440, 32768, 8, 48283648, 131072, 0, 0, 218105658, 0
    .long 1, 32, 32, 8192, 3072, 3328, 8388608, 3145728, 32768, 8, 50380800, 131072, 0, 0, 218105914, 0
    .long 1, 24, 24, 8192, 3072, 3328, 8388608, 3145728, 32768, 8, 33603584, 131072, 0, 0, 218105914, 0
    .long 2, 64, 72, 7168, 3328, 3328, 7340032, 3145728, 32768, 8, 65589248, 114688, 0, 0, 218104196, 0
    .long 1, 80, 80, 2048, 1836544, 1836800, 7340032, 56389632, 114688, 7, 122183680, 32768, 218103876, 7, 218106433, 0
    .long 1, 40, 40, 2048, 2098688, 2098944, 8388608, 180387840, 131072, 8, 80764928, 32768, 218107012, 4, 218106500, 0
    .long 6, 0, 0, 0, 1, 0, 0, 23, 0, 0, 0, 0, 0, 0, 0, 0
    .long 6, 0, 0, 0, 1, 0, 0, 28, 0, 0, 0, 0, 0, 0, 0, 0
    .long 6, 0, 0, 0, 1, 0, 0, 59, 0, 0, 0, 0, 0, 0, 0, 0
    .long 0, 0, 0, 0, 0, 0, 0, 0, 0, 0, 0, 0, 0, 0, 0, 0
    .long 0, 0, 0, 0, 0, 0, 0, 0, 0, 0, 0, 0, 0, 0, 0, 0
    .long 0, 0, 0, 0, 0, 0, 0, 0, 0, 0, 0, 0, 0, 0, 0, 0
    .long 0, 0, 0, 0, 0, 0, 0, 0, 0, 0, 0, 0, 0, 0, 0, 0
    .long 0, 0, 0, 0, 0, 0, 0, 0, 0, 0, 0, 0, 0, 0, 0, 0
    .long 1, 24, 24, 8192, 5120, 5376, 8388608, 1048576, 32768, 8, 25247744, 131072, 0, 0, 218104922, 0
    .long 1, 32, 32, 8192, 5120, 5376, 8388608, 2621440, 32768, 8, 48316416, 131072, 0, 0, 218105690, 0
    .long 1, 32, 32, 8192, 5120, 5376, 8388608, 3145728, 32768, 8, 50413568, 131072, 0, 0, 218105946, 0
    .long 1, 24, 24, 8192, 5120, 5376, 8388608, 3145728, 32768, 8, 33636352, 131072, 0, 0, 218105946, 0
    .long 2, 64, 72, 7168, 5120, 5120, 7340032, 3145728, 32768, 8, 65617920, 114688, 0, 0, 218104209, 0
    .long 1, 80, 80, 2048, 3671552, 3671808, 7340032, 56418304, 114688, 7, 126377984, 32768, 218103888, 7, 218106433, 0
    .long 1, 40, 40, 2048, 4195840, 4196096, 8388608, 180420608, 131072, 8, 84959232, 32768, 218107024, 4, 218106500, 0
    .long 6, 0, 0, 0, 2, 0, 0, 23, 0, 0, 0, 0, 0, 0, 0, 0
    .long 6, 0, 0, 0, 2, 0, 0, 28, 0, 0, 0, 0, 0, 0, 0, 0
    .long 6, 0, 0, 0, 2, 0, 0, 59, 0, 0, 0, 0, 0, 0, 0, 0
    .long 0, 0, 0, 0, 0, 0, 0, 0, 0, 0, 0, 0, 0, 0, 0, 0
    .long 0, 0, 0, 0, 0, 0, 0, 0, 0, 0, 0, 0, 0, 0, 0, 0
    .long 0, 0, 0, 0, 0, 0, 0, 0, 0, 0, 0, 0, 0, 0, 0, 0
    .long 0, 0, 0, 0, 0, 0, 0, 0, 0, 0, 0, 0, 0, 0, 0, 0
    .long 0, 0, 0, 0, 0, 0, 0, 0, 0, 0, 0, 0, 0, 0, 0, 0
    .long 1, 24, 24, 8192, 7168, 7424, 8388608, 1048576, 32768, 8, 25280512, 131072, 0, 0, 218104954, 0
    .long 1, 32, 32, 8192, 7168, 7424, 8388608, 2621440, 32768, 8, 48349184, 131072, 0, 0, 218105722, 0
    .long 1, 32, 32, 8192, 7168, 7424, 8388608, 3145728, 32768, 8, 50446336, 131072, 0, 0, 218105978, 0
    .long 1, 24, 24, 8192, 7168, 7424, 8388608, 3145728, 32768, 8, 33669120, 131072, 0, 0, 218105978, 0
    .long 2, 64, 72, 7168, 6912, 6912, 7340032, 3145728, 32768, 8, 65646592, 114688, 0, 0, 218104212, 0
    .long 1, 80, 80, 2048, 5506560, 5506816, 7340032, 56446976, 114688, 7, 130572288, 32768, 218103892, 7, 218106433, 0
    .long 1, 40, 40, 2048, 6292992, 6293248, 8388608, 180453376, 131072, 8, 89153536, 32768, 218107028, 4, 218106500, 0
    .long 6, 0, 0, 0, 3, 0, 0, 23, 0, 0, 0, 0, 0, 0, 0, 0
    .long 6, 0, 0, 0, 3, 0, 0, 28, 0, 0, 0, 0, 0, 0, 0, 0
    .long 6, 0, 0, 0, 3, 0, 0, 59, 0, 0, 0, 0, 0, 0, 0, 0
    .long 0, 0, 0, 0, 0, 0, 0, 0, 0, 0, 0, 0, 0, 0, 0, 0
    .long 0, 0, 0, 0, 0, 0, 0, 0, 0, 0, 0, 0, 0, 0, 0, 0
    .long 0, 0, 0, 0, 0, 0, 0, 0, 0, 0, 0, 0, 0, 0, 0, 0
    .long 0, 0, 0, 0, 0, 0, 0, 0, 0, 0, 0, 0, 0, 0, 0, 0
    .long 0, 0, 0, 0, 0, 0, 0, 0, 0, 0, 0, 0, 0, 0, 0, 0
    .long 1, 24, 24, 8192, 1536, 1792, 8388608, 1048576, 32768, 8, 25190400, 131072, 0, 0, 218104858, 0
    .long 1, 24, 24, 8192, 512, 768, 8388608, 1572864, 32768, 8, 27271168, 131072, 0, 0, 218105098, 0
    .long 1, 32, 32, 8192, 1024, 1280, 8388608, 2097152, 32768, 8, 46153728, 131072, 0, 0, 218105370, 0
    .long 2, 64, 72, 7168, 1024, 1024, 7340032, 524288, 32768, 8, 56377344, 114688, 0, 0, 218103873, 0
    .long 1, 16, 16, 8192, 1536, 1792, 8388608, 2621440, 32768, 8, 14704640, 131072, 0, 0, 218109210, 0
    .long 1, 80, 80, 2048, 0, 256, 7340032, 56360960, 114688, 7, 117964800, 32768, 218103872, 7, 218106433, 0
    .long 1, 40, 40, 2048, 512, 768, 8388608, 182452224, 131072, 8, 77078528, 32768, 218107072, 4, 218106564, 0
    .long 6, 0, 0, 0, 0, 0, 0, 17, 0, 0, 0, 0, 0, 0, 0, 0
    .long 6, 0, 0, 0, 0, 0, 0, 32, 0, 0, 0, 0, 0, 0, 0, 0
    .long 7, 0, 0, 0, 0, 0, 0, 61, 0, 0, 0, 0, 0, 0, 0, 0
    .long 0, 0, 0, 0, 0, 0, 0, 0, 0, 0, 0, 0, 0, 0, 0, 0
    .long 0, 0, 0, 0, 0, 0, 0, 0, 0, 0, 0, 0, 0, 0, 0, 0
    .long 0, 0, 0, 0, 0, 0, 0, 0, 0, 0, 0, 0, 0, 0, 0, 0
    .long 0, 0, 0, 0, 0, 0, 0, 0, 0, 0, 0, 0, 0, 0, 0, 0
    .long 0, 0, 0, 0, 0, 0, 0, 0, 0, 0, 0, 0, 0, 0, 0, 0
    .long 1, 24, 24, 8192, 3584, 3840, 8388608, 1048576, 32768, 8, 25223168, 131072, 0, 0, 218104890, 0
    .long 1, 24, 24, 8192, 2560, 2816, 8388608, 1572864, 32768, 8, 27303936, 131072, 0, 0, 218105130, 0
    .long 1, 32, 32, 8192, 3072, 3328, 8388608, 2097152, 32768, 8, 46186496, 131072, 0, 0, 218105402, 0
    .long 2, 64, 72, 7168, 2816, 2816, 7340032, 524288, 32768, 8, 56406016, 114688, 0, 0, 218103876, 0
    .long 1, 16, 16, 8192, 3584, 3840, 8388608, 2621440, 32768, 8, 14737408, 131072, 0, 0, 218109242, 0
    .long 1, 80, 80, 2048, 1835008, 1835264, 7340032, 56389632, 114688, 7, 122159104, 32768, 218103876, 7, 218106433, 0
    .long 1, 40, 40, 2048, 2097664, 2097920, 8388608, 182484992, 131072, 8, 81272832, 32768, 218107076, 4, 218106564, 0
    .long 6, 0, 0, 0, 1, 0, 0, 17, 0, 0, 0, 0, 0, 0, 0, 0
    .long 6, 0, 0, 0, 1, 0, 0, 32, 0, 0, 0, 0, 0, 0, 0, 0
    .long 7, 0, 0, 0, 4, 0, 0, 61, 0, 0, 0, 0, 0, 0, 0, 0
    .long 0, 0, 0, 0, 0, 0, 0, 0, 0, 0, 0, 0, 0, 0, 0, 0
    .long 0, 0, 0, 0, 0, 0, 0, 0, 0, 0, 0, 0, 0, 0, 0, 0
    .long 0, 0, 0, 0, 0, 0, 0, 0, 0, 0, 0, 0, 0, 0, 0, 0
    .long 0, 0, 0, 0, 0, 0, 0, 0, 0, 0, 0, 0, 0, 0, 0, 0
    .long 0, 0, 0, 0, 0, 0, 0, 0, 0, 0, 0, 0, 0, 0, 0, 0
    .long 1, 24, 24, 8192, 5632, 5888, 8388608, 1048576, 32768, 8, 25255936, 131072, 0, 0, 218104922, 0
    .long 1, 24, 24, 8192, 4608, 4864, 8388608, 1572864, 32768, 8, 27336704, 131072, 0, 0, 218105162, 0
    .long 1, 32, 32, 8192, 5120, 5376, 8388608, 2097152, 32768, 8, 46219264, 131072, 0, 0, 218105434, 0
    .long 2, 64, 72, 7168, 4608, 4608, 7340032, 524288, 32768, 8, 56434688, 114688, 0, 0, 218103889, 0
    .long 1, 16, 16, 8192, 5632, 5888, 8388608, 2621440, 32768, 8, 14770176, 131072, 0, 0, 218109274, 0
    .long 1, 80, 80, 2048, 3670016, 3670272, 7340032, 56418304, 114688, 7, 126353408, 32768, 218103888, 7, 218106433, 0
    .long 1, 40, 40, 2048, 4194816, 4195072, 8388608, 182517760, 131072, 8, 85467136, 32768, 218107088, 4, 218106564, 0
    .long 6, 0, 0, 0, 2, 0, 0, 17, 0, 0, 0, 0, 0, 0, 0, 0
    .long 6, 0, 0, 0, 2, 0, 0, 32, 0, 0, 0, 0, 0, 0, 0, 0
    .long 7, 0, 0, 0, 8, 0, 0, 61, 0, 0, 0, 0, 0, 0, 0, 0
    .long 0, 0, 0, 0, 0, 0, 0, 0, 0, 0, 0, 0, 0, 0, 0, 0
    .long 0, 0, 0, 0, 0, 0, 0, 0, 0, 0, 0, 0, 0, 0, 0, 0
    .long 0, 0, 0, 0, 0, 0, 0, 0, 0, 0, 0, 0, 0, 0, 0, 0
    .long 0, 0, 0, 0, 0, 0, 0, 0, 0, 0, 0, 0, 0, 0, 0, 0
    .long 0, 0, 0, 0, 0, 0, 0, 0, 0, 0, 0, 0, 0, 0, 0, 0
    .long 1, 24, 24, 8192, 7680, 7936, 8388608, 1048576, 32768, 8, 25288704, 131072, 0, 0, 218104954, 0
    .long 1, 24, 24, 8192, 6656, 6912, 8388608, 1572864, 32768, 8, 27369472, 131072, 0, 0, 218105194, 0
    .long 1, 32, 32, 8192, 7168, 7424, 8388608, 2097152, 32768, 8, 46252032, 131072, 0, 0, 218105466, 0
    .long 2, 64, 72, 7168, 6400, 6400, 7340032, 524288, 32768, 8, 56463360, 114688, 0, 0, 218103892, 0
    .long 1, 16, 16, 8192, 7680, 7936, 8388608, 2621440, 32768, 8, 14802944, 131072, 0, 0, 218109306, 0
    .long 1, 80, 80, 2048, 5505024, 5505280, 7340032, 56446976, 114688, 7, 130547712, 32768, 218103892, 7, 218106433, 0
    .long 1, 40, 40, 2048, 6291968, 6292224, 8388608, 182550528, 131072, 8, 89661440, 32768, 218107092, 4, 218106564, 0
    .long 6, 0, 0, 0, 3, 0, 0, 17, 0, 0, 0, 0, 0, 0, 0, 0
    .long 6, 0, 0, 0, 3, 0, 0, 32, 0, 0, 0, 0, 0, 0, 0, 0
    .long 7, 0, 0, 0, 12, 0, 0, 61, 0, 0, 0, 0, 0, 0, 0, 0
    .long 0, 0, 0, 0, 0, 0, 0, 0, 0, 0, 0, 0, 0, 0, 0, 0
    .long 0, 0, 0, 0, 0, 0, 0, 0, 0, 0, 0, 0, 0, 0, 0, 0
    .long 0, 0, 0, 0, 0, 0, 0, 0, 0, 0, 0, 0, 0, 0, 0, 0
    .long 0, 0, 0, 0, 0, 0, 0, 0, 0, 0, 0, 0, 0, 0, 0, 0
    .long 0, 0, 0, 0, 0, 0, 0, 0, 0, 0, 0, 0, 0, 0, 0, 0
    .long 1, 32, 32, 8192, 0, 256, 8388608, 1048576, 32768, 8, 41943040, 131072, 0, 0, 218104842, 0
    .long 1, 32, 32, 8192, 1536, 1792, 8388608, 1572864, 32768, 8, 44064768, 131072, 0, 0, 218105114, 0
    .long 2, 64, 72, 7168, 1536, 1536, 7340032, 1572864, 32768, 8, 60055552, 114688, 0, 0, 218104001, 0
    .long 2, 64, 72, 7168, 1024, 1024, 7340032, 3145728, 32768, 8, 65552384, 114688, 0, 0, 218104193, 0
    .long 1, 16, 16, 8192, 0, 256, 8388608, 2621440, 32768, 8, 14680064, 131072, 0, 0, 218109194, 0
    .long 1, 80, 80, 2048, 1536, 1792, 7340032, 58195968, 114688, 7, 118513664, 32768, 218103936, 7, 218106497, 0
    .long 1, 40, 40, 2048, 512, 768, 8388608, 184549376, 131072, 8, 77602816, 32768, 218107136, 4, 218106628, 0
    .long 6, 0, 0, 0, 0, 0, 0, 6, 0, 0, 0, 0, 0, 0, 0, 0
    .long 6, 0, 0, 0, 0, 0, 0, 34, 0, 0, 0, 0, 0, 0, 0, 0
    .long 6, 0, 0, 0, 0, 0, 0, 40, 0, 0, 0, 0, 0, 0, 0, 0
    .long 0, 0, 0, 0, 0, 0, 0, 0, 0, 0, 0, 0, 0, 0, 0, 0
    .long 0, 0, 0, 0, 0, 0, 0, 0, 0, 0, 0, 0, 0, 0, 0, 0
    .long 0, 0, 0, 0, 0, 0, 0, 0, 0, 0, 0, 0, 0, 0, 0, 0
    .long 0, 0, 0, 0, 0, 0, 0, 0, 0, 0, 0, 0, 0, 0, 0, 0
    .long 0, 0, 0, 0, 0, 0, 0, 0, 0, 0, 0, 0, 0, 0, 0, 0
    .long 1, 32, 32, 8192, 2048, 2304, 8388608, 1048576, 32768, 8, 41975808, 131072, 0, 0, 218104874, 0
    .long 1, 32, 32, 8192, 3584, 3840, 8388608, 1572864, 32768, 8, 44097536, 131072, 0, 0, 218105146, 0
    .long 2, 64, 72, 7168, 3328, 3328, 7340032, 1572864, 32768, 8, 60084224, 114688, 0, 0, 218104004, 0
    .long 2, 64, 72, 7168, 2816, 2816, 7340032, 3145728, 32768, 8, 65581056, 114688, 0, 0, 218104196, 0
    .long 1, 16, 16, 8192, 2048, 2304, 8388608, 2621440, 32768, 8, 14712832, 131072, 0, 0, 218109226, 0
    .long 1, 80, 80, 2048, 1836544, 1836800, 7340032, 58224640, 114688, 7, 122707968, 32768, 218103940, 7, 218106497, 0
    .long 1, 40, 40, 2048, 2097664, 2097920, 8388608, 184582144, 131072, 8, 81797120, 32768, 218107140, 4, 218106628, 0
    .long 6, 0, 0, 0, 1, 0, 0, 6, 0, 0, 0, 0, 0, 0, 0, 0
    .long 6, 0, 0, 0, 1, 0, 0, 34, 0, 0, 0, 0, 0, 0, 0, 0
    .long 6, 0, 0, 0, 1, 0, 0, 40, 0, 0, 0, 0, 0, 0, 0, 0
    .long 0, 0, 0, 0, 0, 0, 0, 0, 0, 0, 0, 0, 0, 0, 0, 0
    .long 0, 0, 0, 0, 0, 0, 0, 0, 0, 0, 0, 0, 0, 0, 0, 0
    .long 0, 0, 0, 0, 0, 0, 0, 0, 0, 0, 0, 0, 0, 0, 0, 0
    .long 0, 0, 0, 0, 0, 0, 0, 0, 0, 0, 0, 0, 0, 0, 0, 0
    .long 0, 0, 0, 0, 0, 0, 0, 0, 0, 0, 0, 0, 0, 0, 0, 0
    .long 1, 32, 32, 8192, 4096, 4352, 8388608, 1048576, 32768, 8, 42008576, 131072, 0, 0, 218104906, 0
    .long 1, 32, 32, 8192, 5632, 5888, 8388608, 1572864, 32768, 8, 44130304, 131072, 0, 0, 218105178, 0
    .long 2, 64, 72, 7168, 5120, 5120, 7340032, 1572864, 32768, 8, 60112896, 114688, 0, 0, 218104017, 0
    .long 2, 64, 72, 7168, 4608, 4608, 7340032, 3145728, 32768, 8, 65609728, 114688, 0, 0, 218104209, 0
    .long 1, 16, 16, 8192, 4096, 4352, 8388608, 2621440, 32768, 8, 14745600, 131072, 0, 0, 218109258, 0
    .long 1, 80, 80, 2048, 3671552, 3671808, 7340032, 58253312, 114688, 7, 126902272, 32768, 218103952, 7, 218106497, 0
    .long 1, 40, 40, 2048, 4194816, 4195072, 8388608, 184614912, 131072, 8, 85991424, 32768, 218107152, 4, 218106628, 0
    .long 6, 0, 0, 0, 2, 0, 0, 6, 0, 0, 0, 0, 0, 0, 0, 0
    .long 6, 0, 0, 0, 2, 0, 0, 34, 0, 0, 0, 0, 0, 0, 0, 0
    .long 6, 0, 0, 0, 2, 0, 0, 40, 0, 0, 0, 0, 0, 0, 0, 0
    .long 0, 0, 0, 0, 0, 0, 0, 0, 0, 0, 0, 0, 0, 0, 0, 0
    .long 0, 0, 0, 0, 0, 0, 0, 0, 0, 0, 0, 0, 0, 0, 0, 0
    .long 0, 0, 0, 0, 0, 0, 0, 0, 0, 0, 0, 0, 0, 0, 0, 0
    .long 0, 0, 0, 0, 0, 0, 0, 0, 0, 0, 0, 0, 0, 0, 0, 0
    .long 0, 0, 0, 0, 0, 0, 0, 0, 0, 0, 0, 0, 0, 0, 0, 0
    .long 1, 32, 32, 8192, 6144, 6400, 8388608, 1048576, 32768, 8, 42041344, 131072, 0, 0, 218104938, 0
    .long 1, 32, 32, 8192, 7680, 7936, 8388608, 1572864, 32768, 8, 44163072, 131072, 0, 0, 218105210, 0
    .long 2, 64, 72, 7168, 6912, 6912, 7340032, 1572864, 32768, 8, 60141568, 114688, 0, 0, 218104020, 0
    .long 2, 64, 72, 7168, 6400, 6400, 7340032, 3145728, 32768, 8, 65638400, 114688, 0, 0, 218104212, 0
    .long 1, 16, 16, 8192, 6144, 6400, 8388608, 2621440, 32768, 8, 14778368, 131072, 0, 0, 218109290, 0
    .long 1, 80, 80, 2048, 5506560, 5506816, 7340032, 58281984, 114688, 7, 131096576, 32768, 218103956, 7, 218106497, 0
    .long 1, 40, 40, 2048, 6291968, 6292224, 8388608, 184647680, 131072, 8, 90185728, 32768, 218107156, 4, 218106628, 0
    .long 6, 0, 0, 0, 3, 0, 0, 6, 0, 0, 0, 0, 0, 0, 0, 0
    .long 6, 0, 0, 0, 3, 0, 0, 34, 0, 0, 0, 0, 0, 0, 0, 0
    .long 6, 0, 0, 0, 3, 0, 0, 40, 0, 0, 0, 0, 0, 0, 0, 0
    .long 0, 0, 0, 0, 0, 0, 0, 0, 0, 0, 0, 0, 0, 0, 0, 0
    .long 0, 0, 0, 0, 0, 0, 0, 0, 0, 0, 0, 0, 0, 0, 0, 0
    .long 0, 0, 0, 0, 0, 0, 0, 0, 0, 0, 0, 0, 0, 0, 0, 0
    .long 0, 0, 0, 0, 0, 0, 0, 0, 0, 0, 0, 0, 0, 0, 0, 0
    .long 0, 0, 0, 0, 0, 0, 0, 0, 0, 0, 0, 0, 0, 0, 0, 0
    .long 1, 32, 32, 8192, 512, 768, 8388608, 1048576, 32768, 8, 41951232, 131072, 0, 0, 218104842, 0
    .long 1, 24, 24, 8192, 1536, 1792, 8388608, 2621440, 32768, 8, 31481856, 131072, 0, 0, 218105626, 0
    .long 2, 64, 72, 7168, 0, 0, 7340032, 524288, 32768, 8, 56360960, 114688, 0, 0, 218103873, 0
    .long 1, 24, 24, 8192, 1024, 1280, 8388608, 2621440, 32768, 8, 31473664, 131072, 0, 0, 218105626, 0
    .long 2, 64, 72, 7168, 1024, 1024, 7340032, 2097152, 32768, 8, 61882368, 114688, 0, 0, 218104065, 0
    .long 1, 80, 80, 2048, 1536, 1792, 7340032, 54525952, 114688, 7, 117465088, 32768, 218103808, 7, 218106369, 0
    .long 1, 80, 80, 2048, 1024, 1280, 7340032, 65536000, 114688, 7, 120602624, 32768, 218104192, 7, 218106753, 0
    .long 6, 0, 0, 0, 0, 0, 0, 3, 0, 0, 0, 0, 0, 0, 0, 0
    .long 6, 0, 0, 0, 0, 0, 0, 48, 0, 0, 0, 0, 0, 0, 0, 0
    .long 6, 0, 0, 0, 0, 0, 0, 58, 0, 0, 0, 0, 0, 0, 0, 0
    .long 0, 0, 0, 0, 0, 0, 0, 0, 0, 0, 0, 0, 0, 0, 0, 0
    .long 0, 0, 0, 0, 0, 0, 0, 0, 0, 0, 0, 0, 0, 0, 0, 0
    .long 0, 0, 0, 0, 0, 0, 0, 0, 0, 0, 0, 0, 0, 0, 0, 0
    .long 0, 0, 0, 0, 0, 0, 0, 0, 0, 0, 0, 0, 0, 0, 0, 0
    .long 0, 0, 0, 0, 0, 0, 0, 0, 0, 0, 0, 0, 0, 0, 0, 0
    .long 1, 32, 32, 8192, 2560, 2816, 8388608, 1048576, 32768, 8, 41984000, 131072, 0, 0, 218104874, 0
    .long 1, 24, 24, 8192, 3584, 3840, 8388608, 2621440, 32768, 8, 31514624, 131072, 0, 0, 218105658, 0
    .long 2, 64, 72, 7168, 1792, 1792, 7340032, 524288, 32768, 8, 56389632, 114688, 0, 0, 218103876, 0
    .long 1, 24, 24, 8192, 3072, 3328, 8388608, 2621440, 32768, 8, 31506432, 131072, 0, 0, 218105658, 0
    .long 2, 64, 72, 7168, 2816, 2816, 7340032, 2097152, 32768, 8, 61911040, 114688, 0, 0, 218104068, 0
    .long 1, 80, 80, 2048, 1836544, 1836800, 7340032, 54554624, 114688, 7, 121659392, 32768, 218103812, 7, 218106369, 0
    .long 1, 80, 80, 2048, 1836032, 1836288, 7340032, 65564672, 114688, 7, 124796928, 32768, 218104196, 7, 218106753, 0
    .long 6, 0, 0, 0, 1, 0, 0, 3, 0, 0, 0, 0, 0, 0, 0, 0
    .long 6, 0, 0, 0, 1, 0, 0, 48, 0, 0, 0, 0, 0, 0, 0, 0
    .long 6, 0, 0, 0, 1, 0, 0, 58, 0, 0, 0, 0, 0, 0, 0, 0
    .long 0, 0, 0, 0, 0, 0, 0, 0, 0, 0, 0, 0, 0, 0, 0, 0
    .long 0, 0, 0, 0, 0, 0, 0, 0, 0, 0, 0, 0, 0, 0, 0, 0
    .long 0, 0, 0, 0, 0, 0, 0, 0, 0, 0, 0, 0, 0, 0, 0, 0
    .long 0, 0, 0, 0, 0, 0, 0, 0, 0, 0, 0, 0, 0, 0, 0, 0
    .long 0, 0, 0, 0, 0, 0, 0, 0, 0, 0, 0, 0, 0, 0, 0, 0
    .long 1, 32, 32, 8192, 4608, 4864, 8388608, 1048576, 32768, 8, 42016768, 131072, 0, 0, 218104906, 0
    .long 1, 24, 24, 8192, 5632, 5888, 8388608, 2621440, 32768, 8, 31547392, 131072, 0, 0, 218105690, 0
    .long 2, 64, 72, 7168, 3584, 3584, 7340032, 524288, 32768, 8, 56418304, 114688, 0, 0, 218103889, 0
    .long 1, 24, 24, 8192, 5120, 5376, 8388608, 2621440, 32768, 8, 31539200, 131072, 0, 0, 218105690, 0
    .long 2, 64, 72, 7168, 4608, 4608, 7340032, 2097152, 32768, 8, 61939712, 114688, 0, 0, 218104081, 0
    .long 1, 80, 80, 2048, 3671552, 3671808, 7340032, 54583296, 114688, 7, 125853696, 32768, 218103824, 7, 218106369, 0
    .long 1, 80, 80, 2048, 3671040, 3671296, 7340032, 65593344, 114688, 7, 128991232, 32768, 218104208, 7, 218106753, 0
    .long 6, 0, 0, 0, 2, 0, 0, 3, 0, 0, 0, 0, 0, 0, 0, 0
    .long 6, 0, 0, 0, 2, 0, 0, 48, 0, 0, 0, 0, 0, 0, 0, 0
    .long 6, 0, 0, 0, 2, 0, 0, 58, 0, 0, 0, 0, 0, 0, 0, 0
    .long 0, 0, 0, 0, 0, 0, 0, 0, 0, 0, 0, 0, 0, 0, 0, 0
    .long 0, 0, 0, 0, 0, 0, 0, 0, 0, 0, 0, 0, 0, 0, 0, 0
    .long 0, 0, 0, 0, 0, 0, 0, 0, 0, 0, 0, 0, 0, 0, 0, 0
    .long 0, 0, 0, 0, 0, 0, 0, 0, 0, 0, 0, 0, 0, 0, 0, 0
    .long 0, 0, 0, 0, 0, 0, 0, 0, 0, 0, 0, 0, 0, 0, 0, 0
    .long 1, 32, 32, 8192, 6656, 6912, 8388608, 1048576, 32768, 8, 42049536, 131072, 0, 0, 218104938, 0
    .long 1, 24, 24, 8192, 7680, 7936, 8388608, 2621440, 32768, 8, 31580160, 131072, 0, 0, 218105722, 0
    .long 2, 64, 72, 7168, 5376, 5376, 7340032, 524288, 32768, 8, 56446976, 114688, 0, 0, 218103892, 0
    .long 1, 24, 24, 8192, 7168, 7424, 8388608, 2621440, 32768, 8, 31571968, 131072, 0, 0, 218105722, 0
    .long 2, 64, 72, 7168, 6400, 6400, 7340032, 2097152, 32768, 8, 61968384, 114688, 0, 0, 218104084, 0
    .long 1, 80, 80, 2048, 5506560, 5506816, 7340032, 54611968, 114688, 7, 130048000, 32768, 218103828, 7, 218106369, 0
    .long 1, 80, 80, 2048, 5506048, 5506304, 7340032, 65622016, 114688, 7, 133185536, 32768, 218104212, 7, 218106753, 0
    .long 6, 0, 0, 0, 3, 0, 0, 3, 0, 0, 0, 0, 0, 0, 0, 0
    .long 6, 0, 0, 0, 3, 0, 0, 48, 0, 0, 0, 0, 0, 0, 0, 0
    .long 6, 0, 0, 0, 3, 0, 0, 58, 0, 0, 0, 0, 0, 0, 0, 0
    .long 0, 0, 0, 0, 0, 0, 0, 0, 0, 0, 0, 0, 0, 0, 0, 0
    .long 0, 0, 0, 0, 0, 0, 0, 0, 0, 0, 0, 0, 0, 0, 0, 0
    .long 0, 0, 0, 0, 0, 0, 0, 0, 0, 0, 0, 0, 0, 0, 0, 0
    .long 0, 0, 0, 0, 0, 0, 0, 0, 0, 0, 0, 0, 0, 0, 0, 0
    .long 0, 0, 0, 0, 0, 0, 0, 0, 0, 0, 0, 0, 0, 0, 0, 0
    .long 1, 32, 32, 8192, 1024, 1280, 8388608, 1048576, 32768, 8, 41959424, 131072, 0, 0, 218104858, 0
    .long 1, 32, 32, 8192, 1536, 1792, 8388608, 3145728, 32768, 8, 50356224, 131072, 0, 0, 218105882, 0
    .long 1, 16, 16, 8192, 512, 768, 8388608, 3145728, 32768, 8, 16785408, 131072, 0, 0, 218105866, 0
    .long 5, 218107920, 0, 0, 4, 0, 0, 0, 0, 0, 0, 0, 218112000, 3, 218106881, 0
    .long 1, 16, 16, 8192, 1024, 1280, 8388608, 2097152, 32768, 8, 12599296, 131072, 0, 0, 218108954, 0
    .long 5, 218108672, 0, 0, 0, 0, 0, 28, 0, 0, 0, 0, 218112000, 31, 218107073, 0
    .long 1, 80, 80, 2048, 512, 768, 7340032, 58195968, 114688, 7, 118497280, 32768, 218103936, 7, 218106497, 0
    .long 1, 80, 80, 2048, 1536, 1792, 7340032, 61865984, 114688, 7, 119562240, 32768, 218104064, 7, 218106625, 0
    .long 6, 0, 0, 0, 0, 0, 0, 16, 0, 0, 0, 0, 0, 0, 0, 0
    .long 6, 0, 0, 0, 0, 0, 0, 26, 0, 0, 0, 0, 0, 0, 0, 0
    .long 7, 0, 0, 0, 0, 0, 0, 63, 0, 0, 0, 0, 0, 0, 0, 0
    .long 0, 0, 0, 0, 0, 0, 0, 0, 0, 0, 0, 0, 0, 0, 0, 0
    .long 0, 0, 0, 0, 0, 0, 0, 0, 0, 0, 0, 0, 0, 0, 0, 0
    .long 0, 0, 0, 0, 0, 0, 0, 0, 0, 0, 0, 0, 0, 0, 0, 0
    .long 0, 0, 0, 0, 0, 0, 0, 0, 0, 0, 0, 0, 0, 0, 0, 0
    .long 1, 32, 32, 8192, 3072, 3328, 8388608, 1048576, 32768, 8, 41992192, 131072, 0, 0, 218104890, 0
    .long 1, 32, 32, 8192, 3584, 3840, 8388608, 3145728, 32768, 8, 50388992, 131072, 0, 0, 218105914, 0
    .long 1, 16, 16, 8192, 2560, 2816, 8388608, 3145728, 32768, 8, 16818176, 131072, 0, 0, 218105898, 0
    .long 5, 218107952, 0, 0, 12, 0, 0, 0, 0, 0, 0, 0, 218112128, 3, 218106884, 0
    .long 1, 16, 16, 8192, 3072, 3328, 8388608, 2097152, 32768, 8, 12632064, 131072, 0, 0, 218108986, 0
    .long 5, 218108704, 0, 0, 8, 0, 0, 28, 0, 0, 0, 0, 218112128, 31, 218107076, 0
    .long 1, 80, 80, 2048, 1835520, 1835776, 7340032, 58224640, 114688, 7, 122691584, 32768, 218103940, 7, 218106497, 0
    .long 1, 80, 80, 2048, 1836544, 1836800, 7340032, 61894656, 114688, 7, 123756544, 32768, 218104068, 7, 218106625, 0
    .long 6, 0, 0, 0, 1, 0, 0, 16, 0, 0, 0, 0, 0, 0, 0, 0
    .long 6, 0, 0, 0, 1, 0, 0, 26, 0, 0, 0, 0, 0, 0, 0, 0
    .long 7, 0, 0, 0, 4, 0, 0, 63, 0, 0, 0, 0, 0, 0, 0, 0
    .long 0, 0, 0, 0, 0, 0, 0, 0, 0, 0, 0, 0, 0, 0, 0, 0
    .long 0, 0, 0, 0, 0, 0, 0, 0, 0, 0, 0, 0, 0, 0, 0, 0
    .long 0, 0, 0, 0, 0, 0, 0, 0, 0, 0, 0, 0, 0, 0, 0, 0
    .long 0, 0, 0, 0, 0, 0, 0, 0, 0, 0, 0, 0, 0, 0, 0, 0
    .long 1, 32, 32, 8192, 5120, 5376, 8388608, 1048576, 32768, 8, 42024960, 131072, 0, 0, 218104922, 0
    .long 1, 32, 32, 8192, 5632, 5888, 8388608, 3145728, 32768, 8, 50421760, 131072, 0, 0, 218105946, 0
    .long 1, 16, 16, 8192, 4608, 4864, 8388608, 3145728, 32768, 8, 16850944, 131072, 0, 0, 218105930, 0
    .long 5, 218107984, 0, 0, 20, 0, 0, 0, 0, 0, 0, 0, 218112256, 3, 218106897, 0
    .long 1, 16, 16, 8192, 5120, 5376, 8388608, 2097152, 32768, 8, 12664832, 131072, 0, 0, 218109018, 0
    .long 5, 218108736, 0, 0, 16, 0, 0, 28, 0, 0, 0, 0, 218112256, 31, 218107089, 0
    .long 1, 80, 80, 2048, 3670528, 3670784, 7340032, 58253312, 114688, 7, 126885888, 32768, 218103952, 7, 218106497, 0
    .long 1, 80, 80, 2048, 3671552, 3671808, 7340032, 61923328, 114688, 7, 127950848, 32768, 218104080, 7, 218106625, 0
    .long 6, 0, 0, 0, 2, 0, 0, 16, 0, 0, 0, 0, 0, 0, 0, 0
    .long 6, 0, 0, 0, 2, 0, 0, 26, 0, 0, 0, 0, 0, 0, 0, 0
    .long 7, 0, 0, 0, 8, 0, 0, 63, 0, 0, 0, 0, 0, 0, 0, 0
    .long 0, 0, 0, 0, 0, 0, 0, 0, 0, 0, 0, 0, 0, 0, 0, 0
    .long 0, 0, 0, 0, 0, 0, 0, 0, 0, 0, 0, 0, 0, 0, 0, 0
    .long 0, 0, 0, 0, 0, 0, 0, 0, 0, 0, 0, 0, 0, 0, 0, 0
    .long 0, 0, 0, 0, 0, 0, 0, 0, 0, 0, 0, 0, 0, 0, 0, 0
    .long 1, 32, 32, 8192, 7168, 7424, 8388608, 1048576, 32768, 8, 42057728, 131072, 0, 0, 218104954, 0
    .long 1, 32, 32, 8192, 7680, 7936, 8388608, 3145728, 32768, 8, 50454528, 131072, 0, 0, 218105978, 0
    .long 1, 16, 16, 8192, 6656, 6912, 8388608, 3145728, 32768, 8, 16883712, 131072, 0, 0, 218105962, 0
    .long 5, 218108016, 0, 0, 28, 0, 0, 0, 0, 0, 0, 0, 218112384, 3, 218106900, 0
    .long 1, 16, 16, 8192, 7168, 7424, 8388608, 2097152, 32768, 8, 12697600, 131072, 0, 0, 218109050, 0
    .long 5, 218108768, 0, 0, 24, 0, 0, 28, 0, 0, 0, 0, 218112384, 31, 218107092, 0
    .long 1, 80, 80, 2048, 5505536, 5505792, 7340032, 58281984, 114688, 7, 131080192, 32768, 218103956, 7, 218106497, 0
    .long 1, 80, 80, 2048, 5506560, 5506816, 7340032, 61952000, 114688, 7, 132145152, 32768, 218104084, 7, 218106625, 0
    .long 6, 0, 0, 0, 3, 0, 0, 16, 0, 0, 0, 0, 0, 0, 0, 0
    .long 6, 0, 0, 0, 3, 0, 0, 26, 0, 0, 0, 0, 0, 0, 0, 0
    .long 7, 0, 0, 0, 12, 0, 0, 63, 0, 0, 0, 0, 0, 0, 0, 0
    .long 0, 0, 0, 0, 0, 0, 0, 0, 0, 0, 0, 0, 0, 0, 0, 0
    .long 0, 0, 0, 0, 0, 0, 0, 0, 0, 0, 0, 0, 0, 0, 0, 0
    .long 0, 0, 0, 0, 0, 0, 0, 0, 0, 0, 0, 0, 0, 0, 0, 0
    .long 0, 0, 0, 0, 0, 0, 0, 0, 0, 0, 0, 0, 0, 0, 0, 0
    .long 1, 32, 32, 8192, 1536, 1792, 8388608, 1048576, 32768, 8, 41967616, 131072, 0, 0, 218104858, 0
    .long 1, 32, 32, 8192, 512, 768, 8388608, 1572864, 32768, 8, 44048384, 131072, 0, 0, 218105098, 0
    .long 2, 64, 72, 7168, 1280, 1280, 7340032, 1572864, 32768, 8, 60051456, 114688, 0, 0, 218104001, 0
    .long 1, 16, 16, 8192, 0, 256, 8388608, 3145728, 32768, 8, 16777216, 131072, 0, 0, 218105866, 0
    .long 2, 64, 72, 7168, 768, 768, 7340032, 3670016, 32768, 8, 67383296, 114688, 0, 0, 218104257, 0
    .long 5, 218108416, 0, 0, 0, 0, 0, 16, 0, 0, 0, 0, 218112000, 19, 218107009, 0
    .long 5, 218109200, 0, 0, 4, 0, 0, 44, 0, 0, 0, 0, 218112000, 47, 218107201, 0
    .long 1, 40, 40, 2048, 512, 768, 8388608, 186646528, 131072, 8, 78127104, 32768, 218107200, 4, 218106692, 0
    .long 6, 0, 0, 0, 0, 0, 0, 60, 0, 0, 0, 0, 0, 0, 0, 0
    .long 0, 0, 0, 0, 0, 0, 0, 0, 0, 0, 0, 0, 0, 0, 0, 0
    .long 0, 0, 0, 0, 0, 0, 0, 0, 0, 0, 0, 0, 0, 0, 0, 0
    .long 0, 0, 0, 0, 0, 0, 0, 0, 0, 0, 0, 0, 0, 0, 0, 0
    .long 0, 0, 0, 0, 0, 0, 0, 0, 0, 0, 0, 0, 0, 0, 0, 0
    .long 0, 0, 0, 0, 0, 0, 0, 0, 0, 0, 0, 0, 0, 0, 0, 0
    .long 0, 0, 0, 0, 0, 0, 0, 0, 0, 0, 0, 0, 0, 0, 0, 0
    .long 1, 32, 32, 8192, 3584, 3840, 8388608, 1048576, 32768, 8, 42000384, 131072, 0, 0, 218104890, 0
    .long 1, 32, 32, 8192, 2560, 2816, 8388608, 1572864, 32768, 8, 44081152, 131072, 0, 0, 218105130, 0
    .long 2, 64, 72, 7168, 3072, 3072, 7340032, 1572864, 32768, 8, 60080128, 114688, 0, 0, 218104004, 0
    .long 1, 16, 16, 8192, 2048, 2304, 8388608, 3145728, 32768, 8, 16809984, 131072, 0, 0, 218105898, 0
    .long 2, 64, 72, 7168, 2560, 2560, 7340032, 3670016, 32768, 8, 67411968, 114688, 0, 0, 218104260, 0
    .long 5, 218108448, 0, 0, 8, 0, 0, 16, 0, 0, 0, 0, 218112128, 19, 218107012, 0
    .long 5, 218109232, 0, 0, 12, 0, 0, 44, 0, 0, 0, 0, 218112128, 47, 218107204, 0
    .long 1, 40, 40, 2048, 2097664, 2097920, 8388608, 186679296, 131072, 8, 82321408, 32768, 218107204, 4, 218106692, 0
    .long 6, 0, 0, 0, 1, 0, 0, 60, 0, 0, 0, 0, 0, 0, 0, 0
    .long 0, 0, 0, 0, 0, 0, 0, 0, 0, 0, 0, 0, 0, 0, 0, 0
    .long 0, 0, 0, 0, 0, 0, 0, 0, 0, 0, 0, 0, 0, 0, 0, 0
    .long 0, 0, 0, 0, 0, 0, 0, 0, 0, 0, 0, 0, 0, 0, 0, 0
    .long 0, 0, 0, 0, 0, 0, 0, 0, 0, 0, 0, 0, 0, 0, 0, 0
    .long 0, 0, 0, 0, 0, 0, 0, 0, 0, 0, 0, 0, 0, 0, 0, 0
    .long 0, 0, 0, 0, 0, 0, 0, 0, 0, 0, 0, 0, 0, 0, 0, 0
    .long 1, 32, 32, 8192, 5632, 5888, 8388608, 1048576, 32768, 8, 42033152, 131072, 0, 0, 218104922, 0
    .long 1, 32, 32, 8192, 4608, 4864, 8388608, 1572864, 32768, 8, 44113920, 131072, 0, 0, 218105162, 0
    .long 2, 64, 72, 7168, 4864, 4864, 7340032, 1572864, 32768, 8, 60108800, 114688, 0, 0, 218104017, 0
    .long 1, 16, 16, 8192, 4096, 4352, 8388608, 3145728, 32768, 8, 16842752, 131072, 0, 0, 218105930, 0
    .long 2, 64, 72, 7168, 4352, 4352, 7340032, 3670016, 32768, 8, 67440640, 114688, 0, 0, 218104273, 0
    .long 5, 218108480, 0, 0, 16, 0, 0, 16, 0, 0, 0, 0, 218112256, 19, 218107025, 0
    .long 5, 218109264, 0, 0, 20, 0, 0, 44, 0, 0, 0, 0, 218112256, 47, 218107217, 0
    .long 1, 40, 40, 2048, 4194816, 4195072, 8388608, 186712064, 131072, 8, 86515712, 32768, 218107216, 4, 218106692, 0
    .long 6, 0, 0, 0, 2, 0, 0, 60, 0, 0, 0, 0, 0, 0, 0, 0
    .long 0, 0, 0, 0, 0, 0, 0, 0, 0, 0, 0, 0, 0, 0, 0, 0
    .long 0, 0, 0, 0, 0, 0, 0, 0, 0, 0, 0, 0, 0, 0, 0, 0
    .long 0, 0, 0, 0, 0, 0, 0, 0, 0, 0, 0, 0, 0, 0, 0, 0
    .long 0, 0, 0, 0, 0, 0, 0, 0, 0, 0, 0, 0, 0, 0, 0, 0
    .long 0, 0, 0, 0, 0, 0, 0, 0, 0, 0, 0, 0, 0, 0, 0, 0
    .long 0, 0, 0, 0, 0, 0, 0, 0, 0, 0, 0, 0, 0, 0, 0, 0
    .long 1, 32, 32, 8192, 7680, 7936, 8388608, 1048576, 32768, 8, 42065920, 131072, 0, 0, 218104954, 0
    .long 1, 32, 32, 8192, 6656, 6912, 8388608, 1572864, 32768, 8, 44146688, 131072, 0, 0, 218105194, 0
    .long 2, 64, 72, 7168, 6656, 6656, 7340032, 1572864, 32768, 8, 60137472, 114688, 0, 0, 218104020, 0
    .long 1, 16, 16, 8192, 6144, 6400, 8388608, 3145728, 32768, 8, 16875520, 131072, 0, 0, 218105962, 0
    .long 2, 64, 72, 7168, 6144, 6144, 7340032, 3670016, 32768, 8, 67469312, 114688, 0, 0, 218104276, 0
    .long 5, 218108512, 0, 0, 24, 0, 0, 16, 0, 0, 0, 0, 218112384, 19, 218107028, 0
    .long 5, 218109296, 0, 0, 28, 0, 0, 44, 0, 0, 0, 0, 218112384, 47, 218107220, 0
    .long 1, 40, 40, 2048, 6291968, 6292224, 8388608, 186744832, 131072, 8, 90710016, 32768, 218107220, 4, 218106692, 0
    .long 6, 0, 0, 0, 3, 0, 0, 60, 0, 0, 0, 0, 0, 0, 0, 0
    .long 0, 0, 0, 0, 0, 0, 0, 0, 0, 0, 0, 0, 0, 0, 0, 0
    .long 0, 0, 0, 0, 0, 0, 0, 0, 0, 0, 0, 0, 0, 0, 0, 0
    .long 0, 0, 0, 0, 0, 0, 0, 0, 0, 0, 0, 0, 0, 0, 0, 0
    .long 0, 0, 0, 0, 0, 0, 0, 0, 0, 0, 0, 0, 0, 0, 0, 0
    .long 0, 0, 0, 0, 0, 0, 0, 0, 0, 0, 0, 0, 0, 0, 0, 0
    .long 0, 0, 0, 0, 0, 0, 0, 0, 0, 0, 0, 0, 0, 0, 0, 0
.p2align 6
.amdhsa_kernel recurrent_scan__memory_aug_recurrent_mem_tr__glu_gated_glu__prompt_kernel
  .amdhsa_next_free_vgpr 256
  .amdhsa_next_free_sgpr 102
  .amdhsa_accum_offset 256
  .amdhsa_group_segment_fixed_size 0
  .amdhsa_kernarg_size 112
  .amdhsa_user_sgpr_count 2
  .amdhsa_user_sgpr_kernarg_segment_ptr 1
  .amdhsa_system_sgpr_workgroup_id_x 1
  .amdhsa_float_denorm_mode_32 3
.end_amdhsa_kernel
```

```asm
; @launch grid=(256,1,1) block=(512,1,1) lds=163840
.amdgcn_target "amdgcn-amd-amdhsa--gfx950"
.text
.globl recurrent_scan__memory_aug_recurrent_mem_tr__glu_gated_glu__prompt_kernel
.p2align 8
.type recurrent_scan__memory_aug_recurrent_mem_tr__glu_gated_glu__prompt_kernel,@function
recurrent_scan__memory_aug_recurrent_mem_tr__glu_gated_glu__prompt_kernel:
    s_cmp_ge_u32 s2, 256
    s_cbranch_scc1 k_exit
    s_mov_b32 s99, s2
    s_load_dwordx2 s[4:5], s[0:1], 104
    s_load_dwordx2 s[64:65], s[0:1], 96
    v_lshrrev_b32 v2, 6, v0
    s_mov_b32 s6, 268435456
    s_mov_b32 s7, 131072
    s_mov_b32 s66, 256
    s_mov_b32 s67, 131072
    v_readfirstlane_b32 s3, v2
    s_lshr_b32 s13, s2, 3
    s_and_b32 s12, s2, 3
    s_waitcnt lgkmcnt(0)
    s_bitcmp0_b32 s2, 2
    s_cbranch_scc1 chain_map
    s_lshl_b32 s63, s13, 2
    s_add_u32 s63, s63, s12
    s_cmp_ge_u32 s3, 4
    s_cbranch_scc1 ln_touch
    s_load_dwordx2 s[8:9], s[0:1], 0
    v_and_b32 v1, 63, v0
    s_mov_b32 s10, 4194304
    s_mov_b32 s11, 131072
    v_and_b32 v3, 15, v1
    v_lshrrev_b32 v4, 4, v1
    v_lshlrev_b32 v5, 11, v3
    v_lshl_add_u32 v5, v4, 4, v5
    s_lshl_b32 s12, s63, 15
    s_lshl_b32 s13, s3, 9
    s_add_u32 s12, s12, s13
    s_waitcnt lgkmcnt(0)
    buffer_load_dwordx4 v[16:19], v5, s[8:11], s12 offen offset:0
    buffer_load_dwordx4 v[20:23], v5, s[8:11], s12 offen offset:64
    buffer_load_dwordx4 v[24:27], v5, s[8:11], s12 offen offset:128
    buffer_load_dwordx4 v[28:31], v5, s[8:11], s12 offen offset:192
    buffer_load_dwordx4 v[32:35], v5, s[8:11], s12 offen offset:256
    buffer_load_dwordx4 v[36:39], v5, s[8:11], s12 offen offset:320
    buffer_load_dwordx4 v[40:43], v5, s[8:11], s12 offen offset:384
    buffer_load_dwordx4 v[44:47], v5, s[8:11], s12 offen offset:448
    v_mov_b32 v14, 0
    s_lshl_b32 s13, s63, 7
    s_add_u32 s13, s13, 218103808
    v_lshlrev_b32 v13, 2, v0
    v_cmp_gt_u32 vcc, 32, v0
    s_and_saveexec_b64 s[22:23], vcc
    s_cbranch_execz ln_nz
    buffer_store_dword v14, v13, s[4:7], s13 offen sc1
ln_nz:
    s_mov_b64 exec, -1
    v_lshlrev_b32 v6, 4, v3
    s_lshl_b32 s14, s3, 2
    v_add_u32 v7, s14, v6
    v_lshlrev_b32 v8, 4, v1
    s_lshl_b32 s15, s63, 15
    s_lshl_b32 s16, s3, 13
    s_add_u32 s15, s15, s16
    s_add_u32 s16, s15, 4096
    v_and_b32 v9, 1, v4
    v_cmp_eq_u32 s[20:21], 1, v9
    s_waitcnt vmcnt(1)
    v_lshlrev_b32 v48, 16, v16
    v_and_b32 v49, 0xffff0000, v16
    v_lshlrev_b32 v50, 16, v17
    v_and_b32 v51, 0xffff0000, v17
    v_lshlrev_b32 v52, 16, v18
    v_and_b32 v53, 0xffff0000, v18
    v_lshlrev_b32 v54, 16, v19
    v_and_b32 v55, 0xffff0000, v19
    v_lshlrev_b32 v56, 16, v20
    v_and_b32 v57, 0xffff0000, v20
    v_lshlrev_b32 v58, 16, v21
    v_and_b32 v59, 0xffff0000, v21
    v_lshlrev_b32 v60, 16, v22
    v_and_b32 v61, 0xffff0000, v22
    v_lshlrev_b32 v62, 16, v23
    v_and_b32 v63, 0xffff0000, v23
    v_lshlrev_b32 v64, 16, v24
    v_and_b32 v65, 0xffff0000, v24
    v_lshlrev_b32 v66, 16, v25
    v_and_b32 v67, 0xffff0000, v25
    v_lshlrev_b32 v68, 16, v26
    v_and_b32 v69, 0xffff0000, v26
    v_lshlrev_b32 v70, 16, v27
    v_and_b32 v71, 0xffff0000, v27
    v_lshlrev_b32 v72, 16, v28
    v_and_b32 v73, 0xffff0000, v28
    v_lshlrev_b32 v74, 16, v29
    v_and_b32 v75, 0xffff0000, v29
    v_lshlrev_b32 v76, 16, v30
    v_and_b32 v77, 0xffff0000, v30
    v_lshlrev_b32 v78, 16, v31
    v_and_b32 v79, 0xffff0000, v31
    v_lshlrev_b32 v80, 16, v32
    v_and_b32 v81, 0xffff0000, v32
    v_lshlrev_b32 v82, 16, v33
    v_and_b32 v83, 0xffff0000, v33
    v_lshlrev_b32 v84, 16, v34
    v_and_b32 v85, 0xffff0000, v34
    v_lshlrev_b32 v86, 16, v35
    v_and_b32 v87, 0xffff0000, v35
    v_lshlrev_b32 v88, 16, v36
    v_and_b32 v89, 0xffff0000, v36
    v_lshlrev_b32 v90, 16, v37
    v_and_b32 v91, 0xffff0000, v37
    v_lshlrev_b32 v92, 16, v38
    v_and_b32 v93, 0xffff0000, v38
    v_lshlrev_b32 v94, 16, v39
    v_and_b32 v95, 0xffff0000, v39
    v_lshlrev_b32 v96, 16, v40
    v_and_b32 v97, 0xffff0000, v40
    v_lshlrev_b32 v98, 16, v41
    v_and_b32 v99, 0xffff0000, v41
    v_lshlrev_b32 v100, 16, v42
    v_and_b32 v101, 0xffff0000, v42
    v_lshlrev_b32 v102, 16, v43
    v_and_b32 v103, 0xffff0000, v43
    v_lshlrev_b32 v104, 16, v44
    v_and_b32 v105, 0xffff0000, v44
    v_lshlrev_b32 v106, 16, v45
    v_and_b32 v107, 0xffff0000, v45
    v_lshlrev_b32 v108, 16, v46
    v_and_b32 v109, 0xffff0000, v46
    v_lshlrev_b32 v110, 16, v47
    v_and_b32 v111, 0xffff0000, v47
    v_add_f32 v112, v48, v80
    v_add_f32 v113, v49, v81
    v_add_f32 v114, v50, v82
    v_add_f32 v115, v51, v83
    v_add_f32 v116, v52, v84
    v_add_f32 v117, v53, v85
    v_add_f32 v118, v54, v86
    v_add_f32 v119, v55, v87
    v_add_f32 v120, v56, v88
    v_add_f32 v121, v57, v89
    v_add_f32 v122, v58, v90
    v_add_f32 v123, v59, v91
    v_add_f32 v124, v60, v92
    v_add_f32 v125, v61, v93
    v_add_f32 v126, v62, v94
    v_add_f32 v127, v63, v95
    v_add_f32 v128, v64, v96
    v_add_f32 v129, v65, v97
    v_add_f32 v130, v66, v98
    v_add_f32 v131, v67, v99
    v_add_f32 v132, v68, v100
    v_add_f32 v133, v69, v101
    v_add_f32 v134, v70, v102
    v_add_f32 v135, v71, v103
    v_add_f32 v136, v72, v104
    v_add_f32 v137, v73, v105
    v_add_f32 v138, v74, v106
    v_add_f32 v139, v75, v107
    v_add_f32 v140, v76, v108
    v_add_f32 v141, v77, v109
    v_add_f32 v142, v78, v110
    v_add_f32 v143, v79, v111
    v_add_f32 v112, v112, v128
    v_add_f32 v113, v113, v129
    v_add_f32 v114, v114, v130
    v_add_f32 v115, v115, v131
    v_add_f32 v116, v116, v132
    v_add_f32 v117, v117, v133
    v_add_f32 v118, v118, v134
    v_add_f32 v119, v119, v135
    v_add_f32 v120, v120, v136
    v_add_f32 v121, v121, v137
    v_add_f32 v122, v122, v138
    v_add_f32 v123, v123, v139
    v_add_f32 v124, v124, v140
    v_add_f32 v125, v125, v141
    v_add_f32 v126, v126, v142
    v_add_f32 v127, v127, v143
    v_add_f32 v112, v112, v120
    v_add_f32 v113, v113, v121
    v_add_f32 v114, v114, v122
    v_add_f32 v115, v115, v123
    v_add_f32 v116, v116, v124
    v_add_f32 v117, v117, v125
    v_add_f32 v118, v118, v126
    v_add_f32 v119, v119, v127
    v_add_f32 v112, v112, v116
    v_add_f32 v113, v113, v117
    v_add_f32 v114, v114, v118
    v_add_f32 v115, v115, v119
    v_add_f32 v112, v112, v114
    v_add_f32 v113, v113, v115
    v_add_f32 v112, v112, v113
    v_mov_b32 v113, v112
    s_nop 1
    v_permlane16_swap_b32 v113, v112
    v_add_f32 v112, v112, v113
    v_mov_b32 v113, v112
    s_nop 1
    v_permlane32_swap_b32 v113, v112
    v_add_f32 v112, v112, v113
    ds_write_b32 v7, v112
    s_waitcnt lgkmcnt(0)
    s_barrier
    ds_read_b128 v[112:115], v6
    s_waitcnt lgkmcnt(0)
    v_add_f32 v112, v112, v114
    v_add_f32 v113, v113, v115
    v_add_f32 v112, v112, v113
    v_mul_f32 v10, 0x3a800000, v112
    v_sub_f32 v176, v48, v10
    v_sub_f32 v177, v49, v10
    v_sub_f32 v178, v50, v10
    v_sub_f32 v179, v51, v10
    v_sub_f32 v180, v52, v10
    v_sub_f32 v181, v53, v10
    v_sub_f32 v182, v54, v10
    v_sub_f32 v183, v55, v10
    v_sub_f32 v184, v56, v10
    v_sub_f32 v185, v57, v10
    v_sub_f32 v186, v58, v10
    v_sub_f32 v187, v59, v10
    v_sub_f32 v188, v60, v10
    v_sub_f32 v189, v61, v10
    v_sub_f32 v190, v62, v10
    v_sub_f32 v191, v63, v10
    v_sub_f32 v192, v64, v10
    v_sub_f32 v193, v65, v10
    v_sub_f32 v194, v66, v10
    v_sub_f32 v195, v67, v10
    v_sub_f32 v196, v68, v10
    v_sub_f32 v197, v69, v10
    v_sub_f32 v198, v70, v10
    v_sub_f32 v199, v71, v10
    v_sub_f32 v200, v72, v10
    v_sub_f32 v201, v73, v10
    v_sub_f32 v202, v74, v10
    v_sub_f32 v203, v75, v10
    v_sub_f32 v204, v76, v10
    v_sub_f32 v205, v77, v10
    v_sub_f32 v206, v78, v10
    v_sub_f32 v207, v79, v10
    v_sub_f32 v208, v80, v10
    v_sub_f32 v209, v81, v10
    v_sub_f32 v210, v82, v10
    v_sub_f32 v211, v83, v10
    v_sub_f32 v212, v84, v10
    v_sub_f32 v213, v85, v10
    v_sub_f32 v214, v86, v10
    v_sub_f32 v215, v87, v10
    v_sub_f32 v216, v88, v10
    v_sub_f32 v217, v89, v10
    v_sub_f32 v218, v90, v10
    v_sub_f32 v219, v91, v10
    v_sub_f32 v220, v92, v10
    v_sub_f32 v221, v93, v10
    v_sub_f32 v222, v94, v10
    v_sub_f32 v223, v95, v10
    v_sub_f32 v224, v96, v10
    v_sub_f32 v225, v97, v10
    v_sub_f32 v226, v98, v10
    v_sub_f32 v227, v99, v10
    v_sub_f32 v228, v100, v10
    v_sub_f32 v229, v101, v10
    v_sub_f32 v230, v102, v10
    v_sub_f32 v231, v103, v10
    v_sub_f32 v232, v104, v10
    v_sub_f32 v233, v105, v10
    v_sub_f32 v234, v106, v10
    v_sub_f32 v235, v107, v10
    v_sub_f32 v236, v108, v10
    v_sub_f32 v237, v109, v10
    v_sub_f32 v238, v110, v10
    v_sub_f32 v239, v111, v10
    v_mul_f32 v112, v176, v176
    v_fmac_f32 v112, v208, v208
    v_mul_f32 v113, v177, v177
    v_fmac_f32 v113, v209, v209
    v_mul_f32 v114, v178, v178
    v_fmac_f32 v114, v210, v210
    v_mul_f32 v115, v179, v179
    v_fmac_f32 v115, v211, v211
    v_mul_f32 v116, v180, v180
    v_fmac_f32 v116, v212, v212
    v_mul_f32 v117, v181, v181
    v_fmac_f32 v117, v213, v213
    v_mul_f32 v118, v182, v182
    v_fmac_f32 v118, v214, v214
    v_mul_f32 v119, v183, v183
    v_fmac_f32 v119, v215, v215
    v_mul_f32 v120, v184, v184
    v_fmac_f32 v120, v216, v216
    v_mul_f32 v121, v185, v185
    v_fmac_f32 v121, v217, v217
    v_mul_f32 v122, v186, v186
    v_fmac_f32 v122, v218, v218
    v_mul_f32 v123, v187, v187
    v_fmac_f32 v123, v219, v219
    v_mul_f32 v124, v188, v188
    v_fmac_f32 v124, v220, v220
    v_mul_f32 v125, v189, v189
    v_fmac_f32 v125, v221, v221
    v_mul_f32 v126, v190, v190
    v_fmac_f32 v126, v222, v222
    v_mul_f32 v127, v191, v191
    v_fmac_f32 v127, v223, v223
    v_mul_f32 v128, v192, v192
    v_fmac_f32 v128, v224, v224
    v_mul_f32 v129, v193, v193
    v_fmac_f32 v129, v225, v225
    v_mul_f32 v130, v194, v194
    v_fmac_f32 v130, v226, v226
    v_mul_f32 v131, v195, v195
    v_fmac_f32 v131, v227, v227
    v_mul_f32 v132, v196, v196
    v_fmac_f32 v132, v228, v228
    v_mul_f32 v133, v197, v197
    v_fmac_f32 v133, v229, v229
    v_mul_f32 v134, v198, v198
    v_fmac_f32 v134, v230, v230
    v_mul_f32 v135, v199, v199
    v_fmac_f32 v135, v231, v231
    v_mul_f32 v136, v200, v200
    v_fmac_f32 v136, v232, v232
    v_mul_f32 v137, v201, v201
    v_fmac_f32 v137, v233, v233
    v_mul_f32 v138, v202, v202
    v_fmac_f32 v138, v234, v234
    v_mul_f32 v139, v203, v203
    v_fmac_f32 v139, v235, v235
    v_mul_f32 v140, v204, v204
    v_fmac_f32 v140, v236, v236
    v_mul_f32 v141, v205, v205
    v_fmac_f32 v141, v237, v237
    v_mul_f32 v142, v206, v206
    v_fmac_f32 v142, v238, v238
    v_mul_f32 v143, v207, v207
    v_fmac_f32 v143, v239, v239
    v_add_f32 v112, v112, v128
    v_add_f32 v113, v113, v129
    v_add_f32 v114, v114, v130
    v_add_f32 v115, v115, v131
    v_add_f32 v116, v116, v132
    v_add_f32 v117, v117, v133
    v_add_f32 v118, v118, v134
    v_add_f32 v119, v119, v135
    v_add_f32 v120, v120, v136
    v_add_f32 v121, v121, v137
    v_add_f32 v122, v122, v138
    v_add_f32 v123, v123, v139
    v_add_f32 v124, v124, v140
    v_add_f32 v125, v125, v141
    v_add_f32 v126, v126, v142
    v_add_f32 v127, v127, v143
    v_add_f32 v112, v112, v120
    v_add_f32 v113, v113, v121
    v_add_f32 v114, v114, v122
    v_add_f32 v115, v115, v123
    v_add_f32 v116, v116, v124
    v_add_f32 v117, v117, v125
    v_add_f32 v118, v118, v126
    v_add_f32 v119, v119, v127
    v_add_f32 v112, v112, v116
    v_add_f32 v113, v113, v117
    v_add_f32 v114, v114, v118
    v_add_f32 v115, v115, v119
    v_add_f32 v112, v112, v114
    v_add_f32 v113, v113, v115
    v_add_f32 v112, v112, v113
    v_mov_b32 v113, v112
    s_nop 1
    v_permlane16_swap_b32 v113, v112
    v_add_f32 v112, v112, v113
    v_mov_b32 v113, v112
    s_nop 1
    v_permlane32_swap_b32 v113, v112
    v_add_f32 v112, v112, v113
    ds_write_b32 v7, v112 offset:512
    s_waitcnt lgkmcnt(0)
    s_barrier
    ds_read_b128 v[112:115], v6 offset:512
    s_waitcnt lgkmcnt(0)
    v_add_f32 v112, v112, v114
    v_add_f32 v113, v113, v115
    v_add_f32 v112, v112, v113
    v_mul_f32 v11, 0x3a800000, v112
    v_cvt_pk_bf16_f32 v10, v10, v10
    v_lshlrev_b32 v10, 16, v10
    v_cvt_pk_bf16_f32 v11, v11, v11
    v_lshlrev_b32 v11, 16, v11
    v_add_f32 v11, 0x3727c5ac, v11
    v_cvt_pk_bf16_f32 v11, v11, v11
    v_lshlrev_b32 v11, 16, v11
    v_sqrt_f32 v11, v11
    s_nop 0
    v_cvt_pk_bf16_f32 v11, v11, v11
    v_lshlrev_b32 v11, 16, v11
    v_rcp_f32 v11, v11
    s_nop 0
    v_sub_f32 v48, v48, v10
    v_sub_f32 v49, v49, v10
    v_cvt_pk_bf16_f32 v16, v48, v49
    v_lshlrev_b32 v48, 16, v16
    v_and_b32 v49, 0xffff0000, v16
    v_mul_f32 v48, v48, v11
    v_mul_f32 v49, v49, v11
    v_cvt_pk_bf16_f32 v16, v48, v49
    v_sub_f32 v50, v50, v10
    v_sub_f32 v51, v51, v10
    v_cvt_pk_bf16_f32 v17, v50, v51
    v_lshlrev_b32 v50, 16, v17
    v_and_b32 v51, 0xffff0000, v17
    v_mul_f32 v50, v50, v11
    v_mul_f32 v51, v51, v11
    v_cvt_pk_bf16_f32 v17, v50, v51
    v_sub_f32 v52, v52, v10
    v_sub_f32 v53, v53, v10
    v_cvt_pk_bf16_f32 v18, v52, v53
    v_lshlrev_b32 v52, 16, v18
    v_and_b32 v53, 0xffff0000, v18
    v_mul_f32 v52, v52, v11
    v_mul_f32 v53, v53, v11
    v_cvt_pk_bf16_f32 v18, v52, v53
    v_sub_f32 v54, v54, v10
    v_sub_f32 v55, v55, v10
    v_cvt_pk_bf16_f32 v19, v54, v55
    v_lshlrev_b32 v54, 16, v19
    v_and_b32 v55, 0xffff0000, v19
    v_mul_f32 v54, v54, v11
    v_mul_f32 v55, v55, v11
    v_cvt_pk_bf16_f32 v19, v54, v55
    v_cndmask_b32 v112, v16, v18, s[20:21]
    v_cndmask_b32 v113, v17, v19, s[20:21]
    v_cndmask_b32 v114, v18, v16, s[20:21]
    v_cndmask_b32 v115, v19, v17, s[20:21]
    buffer_store_dwordx4 v[112:115], v8, s[4:7], s15 offen offset:0 sc1
    v_sub_f32 v56, v56, v10
    v_sub_f32 v57, v57, v10
    v_cvt_pk_bf16_f32 v20, v56, v57
    v_lshlrev_b32 v56, 16, v20
    v_and_b32 v57, 0xffff0000, v20
    v_mul_f32 v56, v56, v11
    v_mul_f32 v57, v57, v11
    v_cvt_pk_bf16_f32 v20, v56, v57
    v_sub_f32 v58, v58, v10
    v_sub_f32 v59, v59, v10
    v_cvt_pk_bf16_f32 v21, v58, v59
    v_lshlrev_b32 v58, 16, v21
    v_and_b32 v59, 0xffff0000, v21
    v_mul_f32 v58, v58, v11
    v_mul_f32 v59, v59, v11
    v_cvt_pk_bf16_f32 v21, v58, v59
    v_sub_f32 v60, v60, v10
    v_sub_f32 v61, v61, v10
    v_cvt_pk_bf16_f32 v22, v60, v61
    v_lshlrev_b32 v60, 16, v22
    v_and_b32 v61, 0xffff0000, v22
    v_mul_f32 v60, v60, v11
    v_mul_f32 v61, v61, v11
    v_cvt_pk_bf16_f32 v22, v60, v61
    v_sub_f32 v62, v62, v10
    v_sub_f32 v63, v63, v10
    v_cvt_pk_bf16_f32 v23, v62, v63
    v_lshlrev_b32 v62, 16, v23
    v_and_b32 v63, 0xffff0000, v23
    v_mul_f32 v62, v62, v11
    v_mul_f32 v63, v63, v11
    v_cvt_pk_bf16_f32 v23, v62, v63
    v_cndmask_b32 v116, v20, v22, s[20:21]
    v_cndmask_b32 v117, v21, v23, s[20:21]
    v_cndmask_b32 v118, v22, v20, s[20:21]
    v_cndmask_b32 v119, v23, v21, s[20:21]
    buffer_store_dwordx4 v[116:119], v8, s[4:7], s15 offen offset:1024 sc1
    v_sub_f32 v64, v64, v10
    v_sub_f32 v65, v65, v10
    v_cvt_pk_bf16_f32 v24, v64, v65
    v_lshlrev_b32 v64, 16, v24
    v_and_b32 v65, 0xffff0000, v24
    v_mul_f32 v64, v64, v11
    v_mul_f32 v65, v65, v11
    v_cvt_pk_bf16_f32 v24, v64, v65
    v_sub_f32 v66, v66, v10
    v_sub_f32 v67, v67, v10
    v_cvt_pk_bf16_f32 v25, v66, v67
    v_lshlrev_b32 v66, 16, v25
    v_and_b32 v67, 0xffff0000, v25
    v_mul_f32 v66, v66, v11
    v_mul_f32 v67, v67, v11
    v_cvt_pk_bf16_f32 v25, v66, v67
    v_sub_f32 v68, v68, v10
    v_sub_f32 v69, v69, v10
    v_cvt_pk_bf16_f32 v26, v68, v69
    v_lshlrev_b32 v68, 16, v26
    v_and_b32 v69, 0xffff0000, v26
    v_mul_f32 v68, v68, v11
    v_mul_f32 v69, v69, v11
    v_cvt_pk_bf16_f32 v26, v68, v69
    v_sub_f32 v70, v70, v10
    v_sub_f32 v71, v71, v10
    v_cvt_pk_bf16_f32 v27, v70, v71
    v_lshlrev_b32 v70, 16, v27
    v_and_b32 v71, 0xffff0000, v27
    v_mul_f32 v70, v70, v11
    v_mul_f32 v71, v71, v11
    v_cvt_pk_bf16_f32 v27, v70, v71
    v_cndmask_b32 v120, v24, v26, s[20:21]
    v_cndmask_b32 v121, v25, v27, s[20:21]
    v_cndmask_b32 v122, v26, v24, s[20:21]
    v_cndmask_b32 v123, v27, v25, s[20:21]
    buffer_store_dwordx4 v[120:123], v8, s[4:7], s15 offen offset:2048 sc1
    v_sub_f32 v72, v72, v10
    v_sub_f32 v73, v73, v10
    v_cvt_pk_bf16_f32 v28, v72, v73
    v_lshlrev_b32 v72, 16, v28
    v_and_b32 v73, 0xffff0000, v28
    v_mul_f32 v72, v72, v11
    v_mul_f32 v73, v73, v11
    v_cvt_pk_bf16_f32 v28, v72, v73
    v_sub_f32 v74, v74, v10
    v_sub_f32 v75, v75, v10
    v_cvt_pk_bf16_f32 v29, v74, v75
    v_lshlrev_b32 v74, 16, v29
    v_and_b32 v75, 0xffff0000, v29
    v_mul_f32 v74, v74, v11
    v_mul_f32 v75, v75, v11
    v_cvt_pk_bf16_f32 v29, v74, v75
    v_sub_f32 v76, v76, v10
    v_sub_f32 v77, v77, v10
    v_cvt_pk_bf16_f32 v30, v76, v77
    v_lshlrev_b32 v76, 16, v30
    v_and_b32 v77, 0xffff0000, v30
    v_mul_f32 v76, v76, v11
    v_mul_f32 v77, v77, v11
    v_cvt_pk_bf16_f32 v30, v76, v77
    v_sub_f32 v78, v78, v10
    v_sub_f32 v79, v79, v10
    v_cvt_pk_bf16_f32 v31, v78, v79
    v_lshlrev_b32 v78, 16, v31
    v_and_b32 v79, 0xffff0000, v31
    v_mul_f32 v78, v78, v11
    v_mul_f32 v79, v79, v11
    v_cvt_pk_bf16_f32 v31, v78, v79
    v_cndmask_b32 v124, v28, v30, s[20:21]
    v_cndmask_b32 v125, v29, v31, s[20:21]
    v_cndmask_b32 v126, v30, v28, s[20:21]
    v_cndmask_b32 v127, v31, v29, s[20:21]
    buffer_store_dwordx4 v[124:127], v8, s[4:7], s15 offen offset:3072 sc1
    v_sub_f32 v80, v80, v10
    v_sub_f32 v81, v81, v10
    v_cvt_pk_bf16_f32 v32, v80, v81
    v_lshlrev_b32 v80, 16, v32
    v_and_b32 v81, 0xffff0000, v32
    v_mul_f32 v80, v80, v11
    v_mul_f32 v81, v81, v11
    v_cvt_pk_bf16_f32 v32, v80, v81
    v_sub_f32 v82, v82, v10
    v_sub_f32 v83, v83, v10
    v_cvt_pk_bf16_f32 v33, v82, v83
    v_lshlrev_b32 v82, 16, v33
    v_and_b32 v83, 0xffff0000, v33
    v_mul_f32 v82, v82, v11
    v_mul_f32 v83, v83, v11
    v_cvt_pk_bf16_f32 v33, v82, v83
    v_sub_f32 v84, v84, v10
    v_sub_f32 v85, v85, v10
    v_cvt_pk_bf16_f32 v34, v84, v85
    v_lshlrev_b32 v84, 16, v34
    v_and_b32 v85, 0xffff0000, v34
    v_mul_f32 v84, v84, v11
    v_mul_f32 v85, v85, v11
    v_cvt_pk_bf16_f32 v34, v84, v85
    v_sub_f32 v86, v86, v10
    v_sub_f32 v87, v87, v10
    v_cvt_pk_bf16_f32 v35, v86, v87
    v_lshlrev_b32 v86, 16, v35
    v_and_b32 v87, 0xffff0000, v35
    v_mul_f32 v86, v86, v11
    v_mul_f32 v87, v87, v11
    v_cvt_pk_bf16_f32 v35, v86, v87
    v_cndmask_b32 v128, v32, v34, s[20:21]
    v_cndmask_b32 v129, v33, v35, s[20:21]
    v_cndmask_b32 v130, v34, v32, s[20:21]
    v_cndmask_b32 v131, v35, v33, s[20:21]
    buffer_store_dwordx4 v[128:131], v8, s[4:7], s16 offen offset:0 sc1
    v_sub_f32 v88, v88, v10
    v_sub_f32 v89, v89, v10
    v_cvt_pk_bf16_f32 v36, v88, v89
    v_lshlrev_b32 v88, 16, v36
    v_and_b32 v89, 0xffff0000, v36
    v_mul_f32 v88, v88, v11
    v_mul_f32 v89, v89, v11
    v_cvt_pk_bf16_f32 v36, v88, v89
    v_sub_f32 v90, v90, v10
    v_sub_f32 v91, v91, v10
    v_cvt_pk_bf16_f32 v37, v90, v91
    v_lshlrev_b32 v90, 16, v37
    v_and_b32 v91, 0xffff0000, v37
    v_mul_f32 v90, v90, v11
    v_mul_f32 v91, v91, v11
    v_cvt_pk_bf16_f32 v37, v90, v91
    v_sub_f32 v92, v92, v10
    v_sub_f32 v93, v93, v10
    v_cvt_pk_bf16_f32 v38, v92, v93
    v_lshlrev_b32 v92, 16, v38
    v_and_b32 v93, 0xffff0000, v38
    v_mul_f32 v92, v92, v11
    v_mul_f32 v93, v93, v11
    v_cvt_pk_bf16_f32 v38, v92, v93
    v_sub_f32 v94, v94, v10
    v_sub_f32 v95, v95, v10
    v_cvt_pk_bf16_f32 v39, v94, v95
    v_lshlrev_b32 v94, 16, v39
    v_and_b32 v95, 0xffff0000, v39
    v_mul_f32 v94, v94, v11
    v_mul_f32 v95, v95, v11
    v_cvt_pk_bf16_f32 v39, v94, v95
    v_cndmask_b32 v132, v36, v38, s[20:21]
    v_cndmask_b32 v133, v37, v39, s[20:21]
    v_cndmask_b32 v134, v38, v36, s[20:21]
    v_cndmask_b32 v135, v39, v37, s[20:21]
    buffer_store_dwordx4 v[132:135], v8, s[4:7], s16 offen offset:1024 sc1
    v_sub_f32 v96, v96, v10
    v_sub_f32 v97, v97, v10
    v_cvt_pk_bf16_f32 v40, v96, v97
    v_lshlrev_b32 v96, 16, v40
    v_and_b32 v97, 0xffff0000, v40
    v_mul_f32 v96, v96, v11
    v_mul_f32 v97, v97, v11
    v_cvt_pk_bf16_f32 v40, v96, v97
    v_sub_f32 v98, v98, v10
    v_sub_f32 v99, v99, v10
    v_cvt_pk_bf16_f32 v41, v98, v99
    v_lshlrev_b32 v98, 16, v41
    v_and_b32 v99, 0xffff0000, v41
    v_mul_f32 v98, v98, v11
    v_mul_f32 v99, v99, v11
    v_cvt_pk_bf16_f32 v41, v98, v99
    v_sub_f32 v100, v100, v10
    v_sub_f32 v101, v101, v10
    v_cvt_pk_bf16_f32 v42, v100, v101
    v_lshlrev_b32 v100, 16, v42
    v_and_b32 v101, 0xffff0000, v42
    v_mul_f32 v100, v100, v11
    v_mul_f32 v101, v101, v11
    v_cvt_pk_bf16_f32 v42, v100, v101
    v_sub_f32 v102, v102, v10
    v_sub_f32 v103, v103, v10
    v_cvt_pk_bf16_f32 v43, v102, v103
    v_lshlrev_b32 v102, 16, v43
    v_and_b32 v103, 0xffff0000, v43
    v_mul_f32 v102, v102, v11
    v_mul_f32 v103, v103, v11
    v_cvt_pk_bf16_f32 v43, v102, v103
    v_cndmask_b32 v136, v40, v42, s[20:21]
    v_cndmask_b32 v137, v41, v43, s[20:21]
    v_cndmask_b32 v138, v42, v40, s[20:21]
    v_cndmask_b32 v139, v43, v41, s[20:21]
    buffer_store_dwordx4 v[136:139], v8, s[4:7], s16 offen offset:2048 sc1
    v_sub_f32 v104, v104, v10
    v_sub_f32 v105, v105, v10
    v_cvt_pk_bf16_f32 v44, v104, v105
    v_lshlrev_b32 v104, 16, v44
    v_and_b32 v105, 0xffff0000, v44
    v_mul_f32 v104, v104, v11
    v_mul_f32 v105, v105, v11
    v_cvt_pk_bf16_f32 v44, v104, v105
    v_sub_f32 v106, v106, v10
    v_sub_f32 v107, v107, v10
    v_cvt_pk_bf16_f32 v45, v106, v107
    v_lshlrev_b32 v106, 16, v45
    v_and_b32 v107, 0xffff0000, v45
    v_mul_f32 v106, v106, v11
    v_mul_f32 v107, v107, v11
    v_cvt_pk_bf16_f32 v45, v106, v107
    v_sub_f32 v108, v108, v10
    v_sub_f32 v109, v109, v10
    v_cvt_pk_bf16_f32 v46, v108, v109
    v_lshlrev_b32 v108, 16, v46
    v_and_b32 v109, 0xffff0000, v46
    v_mul_f32 v108, v108, v11
    v_mul_f32 v109, v109, v11
    v_cvt_pk_bf16_f32 v46, v108, v109
    v_sub_f32 v110, v110, v10
    v_sub_f32 v111, v111, v10
    v_cvt_pk_bf16_f32 v47, v110, v111
    v_lshlrev_b32 v110, 16, v47
    v_and_b32 v111, 0xffff0000, v47
    v_mul_f32 v110, v110, v11
    v_mul_f32 v111, v111, v11
    v_cvt_pk_bf16_f32 v47, v110, v111
    v_cndmask_b32 v140, v44, v46, s[20:21]
    v_cndmask_b32 v141, v45, v47, s[20:21]
    v_cndmask_b32 v142, v46, v44, s[20:21]
    v_cndmask_b32 v143, v47, v45, s[20:21]
    buffer_store_dwordx4 v[140:143], v8, s[4:7], s16 offen offset:3072 sc1
    s_waitcnt vmcnt(0)
    s_barrier
    s_cmp_lg_u32 s3, 0
    s_cbranch_scc1 ln_sig
    v_mov_b32 v2, 1
    s_mov_b64 exec, 1
    s_cmp_ge_u32 s63, 8
    s_cbranch_scc1 ln_sb
    buffer_atomic_add v2, off, s[64:67], 0 offset:192 sc1
ln_sb:
    buffer_atomic_add v2, off, s[64:67], 0 offset:0 sc1
    s_mov_b64 exec, -1
    s_branch ln_sig
ln_touch:
    s_getpc_b64 s[24:25]
    s_add_u32 s24, s24, jobtab@rel32@lo+4
    s_addc_u32 s25, s25, jobtab@rel32@hi+12
    s_and_b32 s30, s63, 3
    s_mul_i32 s30, s30, 338
    s_lshr_b32 s31, s63, 2
    s_add_u32 s30, s30, s31
    s_lshl_b32 s30, s30, 6
    s_add_u32 s24, s24, s30
    s_addc_u32 s25, s25, 0
    s_load_dwordx16 s[32:47], s[24:25], 0
    s_mov_b32 s11, 131072
    v_and_b32 v20, 63, v0
    s_waitcnt lgkmcnt(0)
    s_load_dwordx2 s[8:9], s[0:1], s33
    s_mov_b32 s10, s38
    s_lshl_b32 s30, s35, 4
    v_mul_lo_u32 v21, s30, v20
    v_and_b32 v22, 15, v20
    v_mul_lo_u32 v22, s43, v22
    s_waitcnt lgkmcnt(0)
    s_cmp_eq_u32 s3, 4
    s_cbranch_scc0 tlb_1_1
    buffer_load_dword v23, v21, s[8:11], s36 offen
    s_branch tlb_1
tlb_1_1:
    s_cmp_eq_u32 s3, 5
    s_cbranch_scc0 tlb_1
    buffer_load_dword v23, v22, s[4:7], s42 offen
    buffer_load_dword v23, off, s[4:7], s46
tlb_1:
    s_barrier
    s_barrier
    s_barrier
ln_sig:
    s_mov_b32 s29, s63
    v_and_b32 v20, 63, v0
    v_lshlrev_b32 v1, 4, v20
    v_add_u32 v19, 0x1000, v1
    v_lshrrev_b32 v4, 4, v20
    v_mov_b32 v17, 0
    v_mov_b32 v18, 1
    s_lshr_b32 s26, s3, 2
    s_and_b32 s27, s3, 3
    s_lshl_b32 s21, s3, 11
    s_lshl_b32 s22, s3, 10
    s_add_u32 s22, s22, 16384
    s_mov_b32 s11, 131072
    s_mov_b32 s15, 131072
    s_mov_b32 s28, 0
    v_and_b32 v21, 15, v20
    v_lshlrev_b32 v22, 2, v4
    v_xor_b32 v21, v21, v22
    s_lshr_b32 s30, s3, 1
    s_and_b32 s30, s30, 1
    v_xor_b32 v21, s30, v21
    v_lshlrev_b32 v3, 4, v21
    s_lshl_b32 s30, s26, 13
    v_add_u32 v5, s30, v1
    v_add_u32 v6, 0x10000, v5
    v_bfe_u32 v21, v20, 2, 2
    v_and_b32 v22, 3, v20
    v_and_b32 v23, 1, v4
    v_xor_b32 v24, s27, v21
    v_xor_b32 v25, v22, v23
    v_lshl_add_u32 v24, v24, 2, v25
    v_lshlrev_b32 v24, 4, v24
    v_lshl_add_u32 v25, v4, 3, v21
    v_lshl_add_u32 v24, v25, 8, v24
    v_and_b32 v22, 1, v22
    v_xor_b32 v25, 0, v23
    v_lshl_add_u32 v8, v25, 10, v24
    v_xor_b32 v25, 0, v22
    v_lshl_add_u32 v8, v25, 3, v8
    v_add_u32 v12, 0x10000, v8
    v_xor_b32 v25, 1, v23
    v_lshl_add_u32 v9, v25, 10, v24
    v_xor_b32 v25, 0, v22
    v_lshl_add_u32 v9, v25, 3, v9
    v_add_u32 v13, 0x10000, v9
    v_xor_b32 v25, 0, v23
    v_lshl_add_u32 v10, v25, 10, v24
    v_xor_b32 v25, 1, v22
    v_lshl_add_u32 v10, v25, 3, v10
    v_add_u32 v14, 0x10000, v10
    v_xor_b32 v25, 1, v23
    v_lshl_add_u32 v11, v25, 10, v24
    v_xor_b32 v25, 1, v22
    v_lshl_add_u32 v11, v25, 3, v11
    v_add_u32 v15, 0x10000, v11
    s_lshl_b32 s30, s3, 2
    s_add_u32 s30, s30, 131072
    v_mov_b32 v7, s30
    s_cmp_ge_u32 s3, 4
    s_cbranch_scc0 w_np
    s_setprio 1
w_np:
    s_getpc_b64 s[24:25]
    s_add_u32 s24, s24, jobtab@rel32@lo+4
    s_addc_u32 s25, s25, jobtab@rel32@hi+12
    s_and_b32 s31, s29, 3
    s_mul_i32 s30, s31, 21632
    s_add_u32 s24, s24, s30
    s_addc_u32 s25, s25, 0
    s_lshl_b32 s71, s31, 2
    s_add_u32 s71, s71, 64
    s_lshr_b32 s59, s29, 2
    s_lshl_b32 s30, s59, 6
    s_load_dwordx16 s[32:47], s[24:25], s30
    s_waitcnt lgkmcnt(0)
    s_cmp_lg_u32 s32, 4
    s_cbranch_scc1 w_nopre
    s_load_dwordx2 s[8:9], s[0:1], s33
    s_load_dwordx2 s[12:13], s[0:1], s34
    s_mov_b32 s10, s38
    s_mov_b32 s14, s38
    s_cmp_eq_u32 s32, 4
    s_cselect_b32 s31, 0, 1
    s_lshl_b32 s30, s3, s31
    s_mul_i32 s30, s30, s40
    s_add_u32 s16, s39, s30
    s_cmp_eq_u32 s32, 4
    s_cselect_b32 s30, 1024, s40
    s_cselect_b32 s31, 6, 5
    s_lshl_b32 s62, 32, s31
    s_add_u32 s17, s16, s30
    s_lshl_b32 s30, s3, 2
    s_mul_i32 s30, s30, s35
    s_add_u32 s18, s36, s30
    s_add_u32 s19, s37, s30
    s_lshl_b32 s20, s35, s31
    v_mul_u32_u24 v2, s35, v4
    v_add_u32 v2, v2, v3
    s_waitcnt lgkmcnt(0)
    s_add_u32 m0, s22, 0
    s_nop 0
    buffer_load_dwordx4 v2, s[8:11], s18 offen lds
    s_add_u32 s18, s18, s20
    s_add_u32 m0, s22, 8192
    s_nop 0
    buffer_load_dwordx4 v2, s[12:15], s19 offen lds
    s_add_u32 s19, s19, s20
    s_add_u32 m0, s22, 32768
    s_nop 0
    buffer_load_dwordx4 v2, s[8:11], s18 offen lds
    s_add_u32 s18, s18, s20
    s_add_u32 m0, s22, 40960
    s_nop 0
    buffer_load_dwordx4 v2, s[12:15], s19 offen lds
    s_add_u32 s19, s19, s20
    s_add_u32 m0, s22, 65536
    s_nop 0
    buffer_load_dwordx4 v2, s[8:11], s18 offen lds
    s_add_u32 s18, s18, s20
    s_add_u32 m0, s22, 73728
    s_nop 0
    buffer_load_dwordx4 v2, s[12:15], s19 offen lds
    s_add_u32 s19, s19, s20
    s_add_u32 m0, s22, 98304
    s_nop 0
    buffer_load_dwordx4 v2, s[8:11], s18 offen lds
    s_add_u32 s18, s18, s20
    s_add_u32 m0, s22, 106496
    s_nop 0
    buffer_load_dwordx4 v2, s[12:15], s19 offen lds
    s_add_u32 s19, s19, s20
    s_cmp_eq_u32 s32, 4
    s_cselect_b32 s70, 1, 0
    s_cmp_eq_u32 s39, 0
    s_cselect_b32 s70, s70, 0
    s_cmp_lg_u32 s3, 0
    s_cbranch_scc1 lnwp_ok
    s_cmp_eq_u32 s70, 0
    s_cbranch_scc1 lnwp_full
    s_mov_b32 s69, 65536
lnwap:
    buffer_load_dword v20, off, s[64:67], 0 offset:192 sc1
    s_waitcnt vmcnt(0)
    v_readfirstlane_b32 s68, v20
    s_cmp_ge_u32 s68, 8
    s_cbranch_scc1 lnwap_ok
    s_sleep 8
    s_sub_u32 s69, s69, 1
    s_cbranch_scc0 lnwap
lnwap_ok:
    s_branch lnwp_ok
lnwp_full:
    s_mov_b32 s69, 65536
lnwp:
    buffer_load_dword v20, off, s[64:67], 0 offset:0 sc1
    s_waitcnt vmcnt(0)
    v_readfirstlane_b32 s68, v20
    s_cmp_ge_u32 s68, 128
    s_cbranch_scc1 lnwp_ok
    s_sleep 8
    s_sub_u32 s69, s69, 1
    s_cbranch_scc0 lnwp
lnwp_ok:
    s_barrier
    s_add_u32 m0, s21, 0
    s_nop 0
    buffer_load_dwordx4 v1, s[4:7], s16 offen sc1 lds
    s_add_u32 s16, s16, s62
    s_add_u32 m0, s21, 1024
    s_nop 0
    buffer_load_dwordx4 v1, s[4:7], s17 offen sc1 lds
    s_add_u32 s17, s17, s62
    s_add_u32 m0, s21, 32768
    s_nop 0
    buffer_load_dwordx4 v1, s[4:7], s16 offen sc1 lds
    s_add_u32 s16, s16, s62
    s_add_u32 m0, s21, 33792
    s_nop 0
    buffer_load_dwordx4 v1, s[4:7], s17 offen sc1 lds
    s_add_u32 s17, s17, s62
    s_add_u32 m0, s21, 65536
    s_nop 0
    buffer_load_dwordx4 v1, s[4:7], s16 offen sc1 lds
    s_add_u32 s16, s16, s62
    s_add_u32 m0, s21, 66560
    s_nop 0
    buffer_load_dwordx4 v1, s[4:7], s17 offen sc1 lds
    s_add_u32 s17, s17, s62
    s_add_u32 m0, s21, 98304
    s_nop 0
    buffer_load_dwordx4 v1, s[4:7], s16 offen sc1 lds
    s_add_u32 s16, s16, s62
    s_add_u32 m0, s21, 99328
    s_nop 0
    buffer_load_dwordx4 v1, s[4:7], s17 offen sc1 lds
    s_add_u32 s17, s17, s62
    s_branch w_adopt
w_nopre:
    s_cmp_eq_u32 s32, 4
    s_cselect_b32 s70, 1, 0
    s_cmp_eq_u32 s39, 0
    s_cselect_b32 s70, s70, 0
    s_cmp_lg_u32 s3, 0
    s_cbranch_scc1 lnw_ok
    s_cmp_eq_u32 s70, 0
    s_cbranch_scc1 lnw_full
    s_mov_b32 s69, 65536
lnwa:
    buffer_load_dword v20, off, s[64:67], 0 offset:192 sc1
    s_waitcnt vmcnt(0)
    v_readfirstlane_b32 s68, v20
    s_cmp_ge_u32 s68, 8
    s_cbranch_scc1 lnwa_ok
    s_sleep 8
    s_sub_u32 s69, s69, 1
    s_cbranch_scc0 lnwa
lnwa_ok:
    s_branch lnw_ok
lnw_full:
    s_mov_b32 s69, 65536
lnw:
    buffer_load_dword v20, off, s[64:67], 0 offset:0 sc1
    s_waitcnt vmcnt(0)
    v_readfirstlane_b32 s68, v20
    s_cmp_ge_u32 s68, 128
    s_cbranch_scc1 lnw_ok
    s_sleep 8
    s_sub_u32 s69, s69, 1
    s_cbranch_scc0 lnw
lnw_ok:
    s_barrier
w_cold:
    s_cmp_eq_u32 s32, 0
    s_cbranch_scc1 k_end
    s_cmp_ge_u32 s32, 6
    s_cbranch_scc1 w_fin
    s_cmp_lg_u32 s3, 0
    s_cbranch_scc1 w_depok
    s_cmp_eq_u32 s45, 0
    s_cbranch_scc1 w_depok
    s_mov_b32 s31, 0x40000
w_waitdep:
    buffer_load_dword v16, v17, s[4:7], s44 offen sc1
    s_waitcnt vmcnt(0)
    v_readfirstlane_b32 s30, v16
    s_cmp_ge_u32 s30, s45
    s_cbranch_scc1 w_depok
    s_sleep 16
    s_sub_u32 s31, s31, 1
    s_cbranch_scc0 w_waitdep
w_depok:
    s_cmp_eq_u32 s32, 5
    s_cbranch_scc1 w_att
    s_load_dwordx2 s[8:9], s[0:1], s33
    s_load_dwordx2 s[12:13], s[0:1], s34
    s_mov_b32 s10, s38
    s_mov_b32 s14, s38
    s_cmp_eq_u32 s32, 4
    s_cselect_b32 s31, 0, 1
    s_lshl_b32 s30, s3, s31
    s_mul_i32 s30, s30, s40
    s_add_u32 s16, s39, s30
    s_cmp_eq_u32 s32, 4
    s_cselect_b32 s30, 1024, s40
    s_cselect_b32 s31, 6, 5
    s_lshl_b32 s62, 32, s31
    s_add_u32 s17, s16, s30
    s_lshl_b32 s30, s3, 2
    s_mul_i32 s30, s30, s35
    s_add_u32 s18, s36, s30
    s_add_u32 s19, s37, s30
    s_lshl_b32 s20, s35, s31
    v_mul_u32_u24 v2, s35, v4
    v_add_u32 v2, v2, v3
    s_waitcnt lgkmcnt(0)
    s_barrier
    s_add_u32 m0, s21, 0
    s_nop 0
    buffer_load_dwordx4 v1, s[4:7], s16 offen sc1 lds
    s_add_u32 s16, s16, s62
    s_add_u32 m0, s21, 1024
    s_nop 0
    buffer_load_dwordx4 v1, s[4:7], s17 offen sc1 lds
    s_add_u32 s17, s17, s62
    s_add_u32 m0, s22, 0
    s_nop 0
    buffer_load_dwordx4 v2, s[8:11], s18 offen lds
    s_add_u32 s18, s18, s20
    s_add_u32 m0, s22, 8192
    s_nop 0
    buffer_load_dwordx4 v2, s[12:15], s19 offen lds
    s_add_u32 s19, s19, s20
    s_add_u32 m0, s21, 32768
    s_nop 0
    buffer_load_dwordx4 v1, s[4:7], s16 offen sc1 lds
    s_add_u32 s16, s16, s62
    s_add_u32 m0, s21, 33792
    s_nop 0
    buffer_load_dwordx4 v1, s[4:7], s17 offen sc1 lds
    s_add_u32 s17, s17, s62
    s_add_u32 m0, s22, 32768
    s_nop 0
    buffer_load_dwordx4 v2, s[8:11], s18 offen lds
    s_add_u32 s18, s18, s20
    s_add_u32 m0, s22, 40960
    s_nop 0
    buffer_load_dwordx4 v2, s[12:15], s19 offen lds
    s_add_u32 s19, s19, s20
    s_add_u32 m0, s21, 65536
    s_nop 0
    buffer_load_dwordx4 v1, s[4:7], s16 offen sc1 lds
    s_add_u32 s16, s16, s62
    s_add_u32 m0, s21, 66560
    s_nop 0
    buffer_load_dwordx4 v1, s[4:7], s17 offen sc1 lds
    s_add_u32 s17, s17, s62
    s_add_u32 m0, s22, 65536
    s_nop 0
    buffer_load_dwordx4 v2, s[8:11], s18 offen lds
    s_add_u32 s18, s18, s20
    s_add_u32 m0, s22, 73728
    s_nop 0
    buffer_load_dwordx4 v2, s[12:15], s19 offen lds
    s_add_u32 s19, s19, s20
    s_add_u32 m0, s21, 98304
    s_nop 0
    buffer_load_dwordx4 v1, s[4:7], s16 offen sc1 lds
    s_add_u32 s16, s16, s62
    s_add_u32 m0, s21, 99328
    s_nop 0
    buffer_load_dwordx4 v1, s[4:7], s17 offen sc1 lds
    s_add_u32 s17, s17, s62
    s_add_u32 m0, s22, 98304
    s_nop 0
    buffer_load_dwordx4 v2, s[8:11], s18 offen lds
    s_add_u32 s18, s18, s20
    s_add_u32 m0, s22, 106496
    s_nop 0
    buffer_load_dwordx4 v2, s[12:15], s19 offen lds
    s_add_u32 s19, s19, s20
w_adopt:
    s_mov_b32 s48, s32
    s_cmp_eq_u32 s32, 4
    s_cselect_b32 s30, 2, 3
    s_lshl_b32 s30, s26, s30
    s_mul_i32 s30, s30, s43
    s_add_u32 s49, s42, s30
    s_mov_b32 s50, s43
    s_mov_b32 s51, s46
    s_mov_b32 s23, s41
    s_waitcnt vmcnt(0)
    s_barrier
    ds_read_b64_tr_b16 v[64:65], v8 offset:16384
    ds_read_b64_tr_b16 v[66:67], v9 offset:16384
    ds_read_b64_tr_b16 v[68:69], v10 offset:16384
    ds_read_b64_tr_b16 v[70:71], v11 offset:16384
    ds_read_b64_tr_b16 v[72:73], v8 offset:24576
    ds_read_b64_tr_b16 v[74:75], v9 offset:24576
    ds_read_b64_tr_b16 v[76:77], v10 offset:24576
    ds_read_b64_tr_b16 v[78:79], v11 offset:24576
    ds_read_b128 v[32:35], v5 offset:0
    ds_read_b128 v[36:39], v5 offset:1024
    ds_read_b128 v[40:43], v5 offset:2048
    ds_read_b128 v[44:47], v5 offset:3072
    ds_read_b128 v[48:51], v5 offset:4096
    ds_read_b128 v[52:55], v5 offset:5120
    ds_read_b128 v[56:59], v5 offset:6144
    ds_read_b128 v[60:63], v5 offset:7168
    s_waitcnt lgkmcnt(0)
    s_cmp_eq_u32 s48, 4
    s_cbranch_scc1 w_firstH
    s_branch w_first16
w_first4:
    s_waitcnt vmcnt(12)
    s_barrier
    v_mfma_f32_16x16x32_bf16 v[128:131], v[64:67], v[32:35], 0
    s_add_u32 m0, s21, 0
    s_nop 0
    buffer_load_dwordx4 v1, s[4:7], s16 offen sc1 lds
    s_add_u32 s16, s16, s62
    v_mfma_f32_16x16x32_bf16 v[132:135], v[68:71], v[32:35], 0
    ds_read_b64_tr_b16 v[112:113], v8 offset:49152
    v_mfma_f32_16x16x32_bf16 v[136:139], v[72:75], v[32:35], 0
    ds_read_b64_tr_b16 v[114:115], v9 offset:49152
    v_mfma_f32_16x16x32_bf16 v[140:143], v[76:79], v[32:35], 0
    ds_read_b64_tr_b16 v[116:117], v10 offset:49152
    v_mfma_f32_16x16x32_bf16 v[144:147], v[64:67], v[36:39], 0
    s_add_u32 m0, s21, 1024
    s_nop 0
    buffer_load_dwordx4 v1, s[4:7], s17 offen sc1 lds
    s_add_u32 s17, s17, s62
    v_mfma_f32_16x16x32_bf16 v[148:151], v[68:71], v[36:39], 0
    ds_read_b64_tr_b16 v[118:119], v11 offset:49152
    v_mfma_f32_16x16x32_bf16 v[152:155], v[72:75], v[36:39], 0
    ds_read_b64_tr_b16 v[120:121], v8 offset:57344
    v_mfma_f32_16x16x32_bf16 v[156:159], v[76:79], v[36:39], 0
    ds_read_b64_tr_b16 v[122:123], v9 offset:57344
    v_mfma_f32_16x16x32_bf16 v[160:163], v[64:67], v[40:43], 0
    s_add_u32 m0, s22, 0
    s_nop 0
    buffer_load_dwordx4 v2, s[8:11], s18 offen lds
    s_add_u32 s18, s18, s20
    v_mfma_f32_16x16x32_bf16 v[164:167], v[68:71], v[40:43], 0
    ds_read_b64_tr_b16 v[124:125], v10 offset:57344
    v_mfma_f32_16x16x32_bf16 v[168:171], v[72:75], v[40:43], 0
    ds_read_b64_tr_b16 v[126:127], v11 offset:57344
    v_mfma_f32_16x16x32_bf16 v[172:175], v[76:79], v[40:43], 0
    ds_read_b128 v[80:83], v5 offset:32768
    v_mfma_f32_16x16x32_bf16 v[176:179], v[64:67], v[44:47], 0
    s_add_u32 m0, s22, 8192
    s_nop 0
    buffer_load_dwordx4 v2, s[12:15], s19 offen lds
    s_add_u32 s19, s19, s20
    v_mfma_f32_16x16x32_bf16 v[180:183], v[68:71], v[44:47], 0
    ds_read_b128 v[84:87], v5 offset:33792
    v_mfma_f32_16x16x32_bf16 v[184:187], v[72:75], v[44:47], 0
    ds_read_b128 v[88:91], v5 offset:34816
    v_mfma_f32_16x16x32_bf16 v[188:191], v[76:79], v[44:47], 0
    ds_read_b128 v[92:95], v5 offset:35840
    v_mfma_f32_16x16x32_bf16 v[192:195], v[64:67], v[48:51], 0
    ds_read_b128 v[96:99], v5 offset:36864
    v_mfma_f32_16x16x32_bf16 v[196:199], v[68:71], v[48:51], 0
    ds_read_b128 v[100:103], v5 offset:37888
    v_mfma_f32_16x16x32_bf16 v[200:203], v[72:75], v[48:51], 0
    ds_read_b128 v[104:107], v5 offset:38912
    v_mfma_f32_16x16x32_bf16 v[204:207], v[76:79], v[48:51], 0
    ds_read_b128 v[108:111], v5 offset:39936
    v_mfma_f32_16x16x32_bf16 v[208:211], v[64:67], v[52:55], 0
    v_mfma_f32_16x16x32_bf16 v[212:215], v[68:71], v[52:55], 0
    v_mfma_f32_16x16x32_bf16 v[216:219], v[72:75], v[52:55], 0
    v_mfma_f32_16x16x32_bf16 v[220:223], v[76:79], v[52:55], 0
    v_mfma_f32_16x16x32_bf16 v[224:227], v[64:67], v[56:59], 0
    v_mfma_f32_16x16x32_bf16 v[228:231], v[68:71], v[56:59], 0
    v_mfma_f32_16x16x32_bf16 v[232:235], v[72:75], v[56:59], 0
    v_mfma_f32_16x16x32_bf16 v[236:239], v[76:79], v[56:59], 0
    v_mfma_f32_16x16x32_bf16 v[240:243], v[64:67], v[60:63], 0
    v_mfma_f32_16x16x32_bf16 v[244:247], v[68:71], v[60:63], 0
    v_mfma_f32_16x16x32_bf16 v[248:251], v[72:75], v[60:63], 0
    v_mfma_f32_16x16x32_bf16 v[252:255], v[76:79], v[60:63], 0
    s_waitcnt lgkmcnt(0)
    s_waitcnt vmcnt(12)
    s_barrier
    v_mfma_f32_16x16x32_bf16 v[128:131], v[112:115], v[80:83], v[128:131]
    s_add_u32 m0, s21, 32768
    s_nop 0
    buffer_load_dwordx4 v1, s[4:7], s16 offen sc1 lds
    s_add_u32 s16, s16, s62
    v_mfma_f32_16x16x32_bf16 v[132:135], v[116:119], v[80:83], v[132:135]
    ds_read_b64_tr_b16 v[64:65], v12 offset:16384
    v_mfma_f32_16x16x32_bf16 v[136:139], v[120:123], v[80:83], v[136:139]
    ds_read_b64_tr_b16 v[66:67], v13 offset:16384
    v_mfma_f32_16x16x32_bf16 v[140:143], v[124:127], v[80:83], v[140:143]
    ds_read_b64_tr_b16 v[68:69], v14 offset:16384
    v_mfma_f32_16x16x32_bf16 v[144:147], v[112:115], v[84:87], v[144:147]
    s_add_u32 m0, s21, 33792
    s_nop 0
    buffer_load_dwordx4 v1, s[4:7], s17 offen sc1 lds
    s_add_u32 s17, s17, s62
    v_mfma_f32_16x16x32_bf16 v[148:151], v[116:119], v[84:87], v[148:151]
    ds_read_b64_tr_b16 v[70:71], v15 offset:16384
    v_mfma_f32_16x16x32_bf16 v[152:155], v[120:123], v[84:87], v[152:155]
    ds_read_b64_tr_b16 v[72:73], v12 offset:24576
    v_mfma_f32_16x16x32_bf16 v[156:159], v[124:127], v[84:87], v[156:159]
    ds_read_b64_tr_b16 v[74:75], v13 offset:24576
    v_mfma_f32_16x16x32_bf16 v[160:163], v[112:115], v[88:91], v[160:163]
    s_add_u32 m0, s22, 32768
    s_nop 0
    buffer_load_dwordx4 v2, s[8:11], s18 offen lds
    s_add_u32 s18, s18, s20
    v_mfma_f32_16x16x32_bf16 v[164:167], v[116:119], v[88:91], v[164:167]
    ds_read_b64_tr_b16 v[76:77], v14 offset:24576
    v_mfma_f32_16x16x32_bf16 v[168:171], v[120:123], v[88:91], v[168:171]
    ds_read_b64_tr_b16 v[78:79], v15 offset:24576
    v_mfma_f32_16x16x32_bf16 v[172:175], v[124:127], v[88:91], v[172:175]
    ds_read_b128 v[32:35], v6 offset:0
    v_mfma_f32_16x16x32_bf16 v[176:179], v[112:115], v[92:95], v[176:179]
    s_add_u32 m0, s22, 40960
    s_nop 0
    buffer_load_dwordx4 v2, s[12:15], s19 offen lds
    s_add_u32 s19, s19, s20
    v_mfma_f32_16x16x32_bf16 v[180:183], v[116:119], v[92:95], v[180:183]
    ds_read_b128 v[36:39], v6 offset:1024
    v_mfma_f32_16x16x32_bf16 v[184:187], v[120:123], v[92:95], v[184:187]
    ds_read_b128 v[40:43], v6 offset:2048
    v_mfma_f32_16x16x32_bf16 v[188:191], v[124:127], v[92:95], v[188:191]
    ds_read_b128 v[44:47], v6 offset:3072
    v_mfma_f32_16x16x32_bf16 v[192:195], v[112:115], v[96:99], v[192:195]
    ds_read_b128 v[48:51], v6 offset:4096
    v_mfma_f32_16x16x32_bf16 v[196:199], v[116:119], v[96:99], v[196:199]
    ds_read_b128 v[52:55], v6 offset:5120
    v_mfma_f32_16x16x32_bf16 v[200:203], v[120:123], v[96:99], v[200:203]
    ds_read_b128 v[56:59], v6 offset:6144
    v_mfma_f32_16x16x32_bf16 v[204:207], v[124:127], v[96:99], v[204:207]
    ds_read_b128 v[60:63], v6 offset:7168
    v_mfma_f32_16x16x32_bf16 v[208:211], v[112:115], v[100:103], v[208:211]
    v_mfma_f32_16x16x32_bf16 v[212:215], v[116:119], v[100:103], v[212:215]
    v_mfma_f32_16x16x32_bf16 v[216:219], v[120:123], v[100:103], v[216:219]
    v_mfma_f32_16x16x32_bf16 v[220:223], v[124:127], v[100:103], v[220:223]
    v_mfma_f32_16x16x32_bf16 v[224:227], v[112:115], v[104:107], v[224:227]
    v_mfma_f32_16x16x32_bf16 v[228:231], v[116:119], v[104:107], v[228:231]
    v_mfma_f32_16x16x32_bf16 v[232:235], v[120:123], v[104:107], v[232:235]
    v_mfma_f32_16x16x32_bf16 v[236:239], v[124:127], v[104:107], v[236:239]
    v_mfma_f32_16x16x32_bf16 v[240:243], v[112:115], v[108:111], v[240:243]
    v_mfma_f32_16x16x32_bf16 v[244:247], v[116:119], v[108:111], v[244:247]
    v_mfma_f32_16x16x32_bf16 v[248:251], v[120:123], v[108:111], v[248:251]
    v_mfma_f32_16x16x32_bf16 v[252:255], v[124:127], v[108:111], v[252:255]
    s_waitcnt lgkmcnt(0)
    s_waitcnt vmcnt(12)
    s_barrier
    v_mfma_f32_16x16x32_bf16 v[128:131], v[64:67], v[32:35], v[128:131]
    s_add_u32 m0, s21, 65536
    s_nop 0
    buffer_load_dwordx4 v1, s[4:7], s16 offen sc1 lds
    s_add_u32 s16, s16, s62
    v_mfma_f32_16x16x32_bf16 v[132:135], v[68:71], v[32:35], v[132:135]
    ds_read_b64_tr_b16 v[112:113], v12 offset:49152
    v_mfma_f32_16x16x32_bf16 v[136:139], v[72:75], v[32:35], v[136:139]
    ds_read_b64_tr_b16 v[114:115], v13 offset:49152
    v_mfma_f32_16x16x32_bf16 v[140:143], v[76:79], v[32:35], v[140:143]
    ds_read_b64_tr_b16 v[116:117], v14 offset:49152
    v_mfma_f32_16x16x32_bf16 v[144:147], v[64:67], v[36:39], v[144:147]
    s_add_u32 m0, s21, 66560
    s_nop 0
    buffer_load_dwordx4 v1, s[4:7], s17 offen sc1 lds
    s_add_u32 s17, s17, s62
    v_mfma_f32_16x16x32_bf16 v[148:151], v[68:71], v[36:39], v[148:151]
    ds_read_b64_tr_b16 v[118:119], v15 offset:49152
    v_mfma_f32_16x16x32_bf16 v[152:155], v[72:75], v[36:39], v[152:155]
    ds_read_b64_tr_b16 v[120:121], v12 offset:57344
    v_mfma_f32_16x16x32_bf16 v[156:159], v[76:79], v[36:39], v[156:159]
    ds_read_b64_tr_b16 v[122:123], v13 offset:57344
    v_mfma_f32_16x16x32_bf16 v[160:163], v[64:67], v[40:43], v[160:163]
    s_add_u32 m0, s22, 65536
    s_nop 0
    buffer_load_dwordx4 v2, s[8:11], s18 offen lds
    s_add_u32 s18, s18, s20
    v_mfma_f32_16x16x32_bf16 v[164:167], v[68:71], v[40:43], v[164:167]
    ds_read_b64_tr_b16 v[124:125], v14 offset:57344
    v_mfma_f32_16x16x32_bf16 v[168:171], v[72:75], v[40:43], v[168:171]
    ds_read_b64_tr_b16 v[126:127], v15 offset:57344
    v_mfma_f32_16x16x32_bf16 v[172:175], v[76:79], v[40:43], v[172:175]
    ds_read_b128 v[80:83], v6 offset:32768
    v_mfma_f32_16x16x32_bf16 v[176:179], v[64:67], v[44:47], v[176:179]
    s_add_u32 m0, s22, 73728
    s_nop 0
    buffer_load_dwordx4 v2, s[12:15], s19 offen lds
    s_add_u32 s19, s19, s20
    v_mfma_f32_16x16x32_bf16 v[180:183], v[68:71], v[44:47], v[180:183]
    ds_read_b128 v[84:87], v6 offset:33792
    v_mfma_f32_16x16x32_bf16 v[184:187], v[72:75], v[44:47], v[184:187]
    ds_read_b128 v[88:91], v6 offset:34816
    v_mfma_f32_16x16x32_bf16 v[188:191], v[76:79], v[44:47], v[188:191]
    ds_read_b128 v[92:95], v6 offset:35840
    v_mfma_f32_16x16x32_bf16 v[192:195], v[64:67], v[48:51], v[192:195]
    ds_read_b128 v[96:99], v6 offset:36864
    v_mfma_f32_16x16x32_bf16 v[196:199], v[68:71], v[48:51], v[196:199]
    ds_read_b128 v[100:103], v6 offset:37888
    v_mfma_f32_16x16x32_bf16 v[200:203], v[72:75], v[48:51], v[200:203]
    ds_read_b128 v[104:107], v6 offset:38912
    v_mfma_f32_16x16x32_bf16 v[204:207], v[76:79], v[48:51], v[204:207]
    ds_read_b128 v[108:111], v6 offset:39936
    v_mfma_f32_16x16x32_bf16 v[208:211], v[64:67], v[52:55], v[208:211]
    v_mfma_f32_16x16x32_bf16 v[212:215], v[68:71], v[52:55], v[212:215]
    v_mfma_f32_16x16x32_bf16 v[216:219], v[72:75], v[52:55], v[216:219]
    v_mfma_f32_16x16x32_bf16 v[220:223], v[76:79], v[52:55], v[220:223]
    v_mfma_f32_16x16x32_bf16 v[224:227], v[64:67], v[56:59], v[224:227]
    v_mfma_f32_16x16x32_bf16 v[228:231], v[68:71], v[56:59], v[228:231]
    v_mfma_f32_16x16x32_bf16 v[232:235], v[72:75], v[56:59], v[232:235]
    v_mfma_f32_16x16x32_bf16 v[236:239], v[76:79], v[56:59], v[236:239]
    v_mfma_f32_16x16x32_bf16 v[240:243], v[64:67], v[60:63], v[240:243]
    v_mfma_f32_16x16x32_bf16 v[244:247], v[68:71], v[60:63], v[244:247]
    v_mfma_f32_16x16x32_bf16 v[248:251], v[72:75], v[60:63], v[248:251]
    v_mfma_f32_16x16x32_bf16 v[252:255], v[76:79], v[60:63], v[252:255]
    s_waitcnt lgkmcnt(0)
    s_waitcnt vmcnt(8)
    s_barrier
    s_cmp_eq_u32 s28, 0
    s_cbranch_scc1 sig_2
    s_cmp_lg_u32 s3, 0
    s_cbranch_scc1 sig_2
    s_and_b32 s57, s28, 3
    v_mov_b32 v24, s57
    s_bfe_u32 s57, s28, 0x20002
    v_mov_b32 v25, s57
    s_andn2_b32 s28, s28, 15
    s_mov_b64 exec, 1
    buffer_atomic_add_x2 v[24:25], v17, s[4:7], s28 offen sc1
    s_mov_b64 exec, -1
sig_2:
    s_mov_b32 s28, 0
    v_mfma_f32_16x16x32_bf16 v[128:131], v[112:115], v[80:83], v[128:131]
    s_add_u32 m0, s21, 98304
    s_nop 0
    buffer_load_dwordx4 v1, s[4:7], s16 offen sc1 lds
    s_add_u32 s16, s16, s62
    v_mfma_f32_16x16x32_bf16 v[132:135], v[116:119], v[80:83], v[132:135]
    ds_read_b64_tr_b16 v[64:65], v8 offset:16384
    v_mfma_f32_16x16x32_bf16 v[136:139], v[120:123], v[80:83], v[136:139]
    ds_read_b64_tr_b16 v[66:67], v9 offset:16384
    v_mfma_f32_16x16x32_bf16 v[140:143], v[124:127], v[80:83], v[140:143]
    ds_read_b64_tr_b16 v[68:69], v10 offset:16384
    v_mfma_f32_16x16x32_bf16 v[144:147], v[112:115], v[84:87], v[144:147]
    s_add_u32 m0, s21, 99328
    s_nop 0
    buffer_load_dwordx4 v1, s[4:7], s17 offen sc1 lds
    s_add_u32 s17, s17, s62
    v_mfma_f32_16x16x32_bf16 v[148:151], v[116:119], v[84:87], v[148:151]
    ds_read_b64_tr_b16 v[70:71], v11 offset:16384
    v_mfma_f32_16x16x32_bf16 v[152:155], v[120:123], v[84:87], v[152:155]
    ds_read_b64_tr_b16 v[72:73], v8 offset:24576
    v_mfma_f32_16x16x32_bf16 v[156:159], v[124:127], v[84:87], v[156:159]
    ds_read_b64_tr_b16 v[74:75], v9 offset:24576
    v_mfma_f32_16x16x32_bf16 v[160:163], v[112:115], v[88:91], v[160:163]
    s_add_u32 m0, s22, 98304
    s_nop 0
    buffer_load_dwordx4 v2, s[8:11], s18 offen lds
    s_add_u32 s18, s18, s20
    v_mfma_f32_16x16x32_bf16 v[164:167], v[116:119], v[88:91], v[164:167]
    ds_read_b64_tr_b16 v[76:77], v10 offset:24576
    v_mfma_f32_16x16x32_bf16 v[168:171], v[120:123], v[88:91], v[168:171]
    ds_read_b64_tr_b16 v[78:79], v11 offset:24576
    v_mfma_f32_16x16x32_bf16 v[172:175], v[124:127], v[88:91], v[172:175]
    ds_read_b128 v[32:35], v5 offset:0
    v_mfma_f32_16x16x32_bf16 v[176:179], v[112:115], v[92:95], v[176:179]
    s_add_u32 m0, s22, 106496
    s_nop 0
    buffer_load_dwordx4 v2, s[12:15], s19 offen lds
    s_add_u32 s19, s19, s20
    v_mfma_f32_16x16x32_bf16 v[180:183], v[116:119], v[92:95], v[180:183]
    ds_read_b128 v[36:39], v5 offset:1024
    v_mfma_f32_16x16x32_bf16 v[184:187], v[120:123], v[92:95], v[184:187]
    ds_read_b128 v[40:43], v5 offset:2048
    v_mfma_f32_16x16x32_bf16 v[188:191], v[124:127], v[92:95], v[188:191]
    ds_read_b128 v[44:47], v5 offset:3072
    v_mfma_f32_16x16x32_bf16 v[192:195], v[112:115], v[96:99], v[192:195]
    ds_read_b128 v[48:51], v5 offset:4096
    v_mfma_f32_16x16x32_bf16 v[196:199], v[116:119], v[96:99], v[196:199]
    ds_read_b128 v[52:55], v5 offset:5120
    v_mfma_f32_16x16x32_bf16 v[200:203], v[120:123], v[96:99], v[200:203]
    ds_read_b128 v[56:59], v5 offset:6144
    v_mfma_f32_16x16x32_bf16 v[204:207], v[124:127], v[96:99], v[204:207]
    ds_read_b128 v[60:63], v5 offset:7168
    v_mfma_f32_16x16x32_bf16 v[208:211], v[112:115], v[100:103], v[208:211]
    v_mfma_f32_16x16x32_bf16 v[212:215], v[116:119], v[100:103], v[212:215]
    v_mfma_f32_16x16x32_bf16 v[216:219], v[120:123], v[100:103], v[216:219]
    v_mfma_f32_16x16x32_bf16 v[220:223], v[124:127], v[100:103], v[220:223]
    v_mfma_f32_16x16x32_bf16 v[224:227], v[112:115], v[104:107], v[224:227]
    v_mfma_f32_16x16x32_bf16 v[228:231], v[116:119], v[104:107], v[228:231]
    v_mfma_f32_16x16x32_bf16 v[232:235], v[120:123], v[104:107], v[232:235]
    v_mfma_f32_16x16x32_bf16 v[236:239], v[124:127], v[104:107], v[236:239]
    v_mfma_f32_16x16x32_bf16 v[240:243], v[112:115], v[108:111], v[240:243]
    v_mfma_f32_16x16x32_bf16 v[244:247], v[116:119], v[108:111], v[244:247]
    v_mfma_f32_16x16x32_bf16 v[248:251], v[120:123], v[108:111], v[248:251]
    v_mfma_f32_16x16x32_bf16 v[252:255], v[124:127], v[108:111], v[252:255]
    s_waitcnt lgkmcnt(0)
    s_branch w_loop_chk
w_first8:
    s_waitcnt vmcnt(16)
    s_barrier
    v_mfma_f32_16x16x32_bf16 v[128:131], v[64:67], v[32:35], 0
    s_add_u32 m0, s21, 0
    s_nop 0
    buffer_load_dwordx4 v1, s[4:7], s16 offen sc1 lds
    s_add_u32 s16, s16, s62
    v_mfma_f32_16x16x32_bf16 v[132:135], v[68:71], v[32:35], 0
    ds_read_b64_tr_b16 v[112:113], v8 offset:49152
    v_mfma_f32_16x16x32_bf16 v[136:139], v[72:75], v[32:35], 0
    ds_read_b64_tr_b16 v[114:115], v9 offset:49152
    v_mfma_f32_16x16x32_bf16 v[140:143], v[76:79], v[32:35], 0
    ds_read_b64_tr_b16 v[116:117], v10 offset:49152
    v_mfma_f32_16x16x32_bf16 v[144:147], v[64:67], v[36:39], 0
    s_add_u32 m0, s21, 1024
    s_nop 0
    buffer_load_dwordx4 v1, s[4:7], s17 offen sc1 lds
    s_add_u32 s17, s17, s62
    v_mfma_f32_16x16x32_bf16 v[148:151], v[68:71], v[36:39], 0
    ds_read_b64_tr_b16 v[118:119], v11 offset:49152
    v_mfma_f32_16x16x32_bf16 v[152:155], v[72:75], v[36:39], 0
    ds_read_b64_tr_b16 v[120:121], v8 offset:57344
    v_mfma_f32_16x16x32_bf16 v[156:159], v[76:79], v[36:39], 0
    ds_read_b64_tr_b16 v[122:123], v9 offset:57344
    v_mfma_f32_16x16x32_bf16 v[160:163], v[64:67], v[40:43], 0
    s_add_u32 m0, s22, 0
    s_nop 0
    buffer_load_dwordx4 v2, s[8:11], s18 offen lds
    s_add_u32 s18, s18, s20
    v_mfma_f32_16x16x32_bf16 v[164:167], v[68:71], v[40:43], 0
    ds_read_b64_tr_b16 v[124:125], v10 offset:57344
    v_mfma_f32_16x16x32_bf16 v[168:171], v[72:75], v[40:43], 0
    ds_read_b64_tr_b16 v[126:127], v11 offset:57344
    v_mfma_f32_16x16x32_bf16 v[172:175], v[76:79], v[40:43], 0
    ds_read_b128 v[80:83], v5 offset:32768
    v_mfma_f32_16x16x32_bf16 v[176:179], v[64:67], v[44:47], 0
    s_add_u32 m0, s22, 8192
    s_nop 0
    buffer_load_dwordx4 v2, s[12:15], s19 offen lds
    s_add_u32 s19, s19, s20
    v_mfma_f32_16x16x32_bf16 v[180:183], v[68:71], v[44:47], 0
    ds_read_b128 v[84:87], v5 offset:33792
    v_mfma_f32_16x16x32_bf16 v[184:187], v[72:75], v[44:47], 0
    ds_read_b128 v[88:91], v5 offset:34816
    v_mfma_f32_16x16x32_bf16 v[188:191], v[76:79], v[44:47], 0
    ds_read_b128 v[92:95], v5 offset:35840
    v_mfma_f32_16x16x32_bf16 v[192:195], v[64:67], v[48:51], 0
    ds_read_b128 v[96:99], v5 offset:36864
    v_mfma_f32_16x16x32_bf16 v[196:199], v[68:71], v[48:51], 0
    ds_read_b128 v[100:103], v5 offset:37888
    v_mfma_f32_16x16x32_bf16 v[200:203], v[72:75], v[48:51], 0
    ds_read_b128 v[104:107], v5 offset:38912
    v_mfma_f32_16x16x32_bf16 v[204:207], v[76:79], v[48:51], 0
    ds_read_b128 v[108:111], v5 offset:39936
    v_mfma_f32_16x16x32_bf16 v[208:211], v[64:67], v[52:55], 0
    v_mfma_f32_16x16x32_bf16 v[212:215], v[68:71], v[52:55], 0
    v_mfma_f32_16x16x32_bf16 v[216:219], v[72:75], v[52:55], 0
    v_mfma_f32_16x16x32_bf16 v[220:223], v[76:79], v[52:55], 0
    v_mfma_f32_16x16x32_bf16 v[224:227], v[64:67], v[56:59], 0
    v_mfma_f32_16x16x32_bf16 v[228:231], v[68:71], v[56:59], 0
    v_mfma_f32_16x16x32_bf16 v[232:235], v[72:75], v[56:59], 0
    v_mfma_f32_16x16x32_bf16 v[236:239], v[76:79], v[56:59], 0
    v_mfma_f32_16x16x32_bf16 v[240:243], v[64:67], v[60:63], 0
    v_mfma_f32_16x16x32_bf16 v[244:247], v[68:71], v[60:63], 0
    v_mfma_f32_16x16x32_bf16 v[248:251], v[72:75], v[60:63], 0
    v_mfma_f32_16x16x32_bf16 v[252:255], v[76:79], v[60:63], 0
    s_waitcnt lgkmcnt(0)
    s_waitcnt vmcnt(16)
    s_barrier
    v_mfma_f32_16x16x32_bf16 v[128:131], v[112:115], v[80:83], v[128:131]
    s_add_u32 m0, s21, 32768
    s_nop 0
    buffer_load_dwordx4 v1, s[4:7], s16 offen sc1 lds
    s_add_u32 s16, s16, s62
    v_mfma_f32_16x16x32_bf16 v[132:135], v[116:119], v[80:83], v[132:135]
    ds_read_b64_tr_b16 v[64:65], v12 offset:16384
    v_mfma_f32_16x16x32_bf16 v[136:139], v[120:123], v[80:83], v[136:139]
    ds_read_b64_tr_b16 v[66:67], v13 offset:16384
    v_mfma_f32_16x16x32_bf16 v[140:143], v[124:127], v[80:83], v[140:143]
    ds_read_b64_tr_b16 v[68:69], v14 offset:16384
    v_mfma_f32_16x16x32_bf16 v[144:147], v[112:115], v[84:87], v[144:147]
    s_add_u32 m0, s21, 33792
    s_nop 0
    buffer_load_dwordx4 v1, s[4:7], s17 offen sc1 lds
    s_add_u32 s17, s17, s62
    v_mfma_f32_16x16x32_bf16 v[148:151], v[116:119], v[84:87], v[148:151]
    ds_read_b64_tr_b16 v[70:71], v15 offset:16384
    v_mfma_f32_16x16x32_bf16 v[152:155], v[120:123], v[84:87], v[152:155]
    ds_read_b64_tr_b16 v[72:73], v12 offset:24576
    v_mfma_f32_16x16x32_bf16 v[156:159], v[124:127], v[84:87], v[156:159]
    ds_read_b64_tr_b16 v[74:75], v13 offset:24576
    v_mfma_f32_16x16x32_bf16 v[160:163], v[112:115], v[88:91], v[160:163]
    s_add_u32 m0, s22, 32768
    s_nop 0
    buffer_load_dwordx4 v2, s[8:11], s18 offen lds
    s_add_u32 s18, s18, s20
    v_mfma_f32_16x16x32_bf16 v[164:167], v[116:119], v[88:91], v[164:167]
    ds_read_b64_tr_b16 v[76:77], v14 offset:24576
    v_mfma_f32_16x16x32_bf16 v[168:171], v[120:123], v[88:91], v[168:171]
    ds_read_b64_tr_b16 v[78:79], v15 offset:24576
    v_mfma_f32_16x16x32_bf16 v[172:175], v[124:127], v[88:91], v[172:175]
    ds_read_b128 v[32:35], v6 offset:0
    v_mfma_f32_16x16x32_bf16 v[176:179], v[112:115], v[92:95], v[176:179]
    s_add_u32 m0, s22, 40960
    s_nop 0
    buffer_load_dwordx4 v2, s[12:15], s19 offen lds
    s_add_u32 s19, s19, s20
    v_mfma_f32_16x16x32_bf16 v[180:183], v[116:119], v[92:95], v[180:183]
    ds_read_b128 v[36:39], v6 offset:1024
    v_mfma_f32_16x16x32_bf16 v[184:187], v[120:123], v[92:95], v[184:187]
    ds_read_b128 v[40:43], v6 offset:2048
    v_mfma_f32_16x16x32_bf16 v[188:191], v[124:127], v[92:95], v[188:191]
    ds_read_b128 v[44:47], v6 offset:3072
    v_mfma_f32_16x16x32_bf16 v[192:195], v[112:115], v[96:99], v[192:195]
    ds_read_b128 v[48:51], v6 offset:4096
    v_mfma_f32_16x16x32_bf16 v[196:199], v[116:119], v[96:99], v[196:199]
    ds_read_b128 v[52:55], v6 offset:5120
    v_mfma_f32_16x16x32_bf16 v[200:203], v[120:123], v[96:99], v[200:203]
    ds_read_b128 v[56:59], v6 offset:6144
    v_mfma_f32_16x16x32_bf16 v[204:207], v[124:127], v[96:99], v[204:207]
    ds_read_b128 v[60:63], v6 offset:7168
    v_mfma_f32_16x16x32_bf16 v[208:211], v[112:115], v[100:103], v[208:211]
    v_mfma_f32_16x16x32_bf16 v[212:215], v[116:119], v[100:103], v[212:215]
    v_mfma_f32_16x16x32_bf16 v[216:219], v[120:123], v[100:103], v[216:219]
    v_mfma_f32_16x16x32_bf16 v[220:223], v[124:127], v[100:103], v[220:223]
    v_mfma_f32_16x16x32_bf16 v[224:227], v[112:115], v[104:107], v[224:227]
    v_mfma_f32_16x16x32_bf16 v[228:231], v[116:119], v[104:107], v[228:231]
    v_mfma_f32_16x16x32_bf16 v[232:235], v[120:123], v[104:107], v[232:235]
    v_mfma_f32_16x16x32_bf16 v[236:239], v[124:127], v[104:107], v[236:239]
    v_mfma_f32_16x16x32_bf16 v[240:243], v[112:115], v[108:111], v[240:243]
    v_mfma_f32_16x16x32_bf16 v[244:247], v[116:119], v[108:111], v[244:247]
    v_mfma_f32_16x16x32_bf16 v[248:251], v[120:123], v[108:111], v[248:251]
    v_mfma_f32_16x16x32_bf16 v[252:255], v[124:127], v[108:111], v[252:255]
    s_waitcnt lgkmcnt(0)
    s_waitcnt vmcnt(16)
    s_barrier
    v_mfma_f32_16x16x32_bf16 v[128:131], v[64:67], v[32:35], v[128:131]
    s_add_u32 m0, s21, 65536
    s_nop 0
    buffer_load_dwordx4 v1, s[4:7], s16 offen sc1 lds
    s_add_u32 s16, s16, s62
    v_mfma_f32_16x16x32_bf16 v[132:135], v[68:71], v[32:35], v[132:135]
    ds_read_b64_tr_b16 v[112:113], v12 offset:49152
    v_mfma_f32_16x16x32_bf16 v[136:139], v[72:75], v[32:35], v[136:139]
    ds_read_b64_tr_b16 v[114:115], v13 offset:49152
    v_mfma_f32_16x16x32_bf16 v[140:143], v[76:79], v[32:35], v[140:143]
    ds_read_b64_tr_b16 v[116:117], v14 offset:49152
    v_mfma_f32_16x16x32_bf16 v[144:147], v[64:67], v[36:39], v[144:147]
    s_add_u32 m0, s21, 66560
    s_nop 0
    buffer_load_dwordx4 v1, s[4:7], s17 offen sc1 lds
    s_add_u32 s17, s17, s62
    v_mfma_f32_16x16x32_bf16 v[148:151], v[68:71], v[36:39], v[148:151]
    ds_read_b64_tr_b16 v[118:119], v15 offset:49152
    v_mfma_f32_16x16x32_bf16 v[152:155], v[72:75], v[36:39], v[152:155]
    ds_read_b64_tr_b16 v[120:121], v12 offset:57344
    v_mfma_f32_16x16x32_bf16 v[156:159], v[76:79], v[36:39], v[156:159]
    ds_read_b64_tr_b16 v[122:123], v13 offset:57344
    v_mfma_f32_16x16x32_bf16 v[160:163], v[64:67], v[40:43], v[160:163]
    s_add_u32 m0, s22, 65536
    s_nop 0
    buffer_load_dwordx4 v2, s[8:11], s18 offen lds
    s_add_u32 s18, s18, s20
    v_mfma_f32_16x16x32_bf16 v[164:167], v[68:71], v[40:43], v[164:167]
    ds_read_b64_tr_b16 v[124:125], v14 offset:57344
    v_mfma_f32_16x16x32_bf16 v[168:171], v[72:75], v[40:43], v[168:171]
    ds_read_b64_tr_b16 v[126:127], v15 offset:57344
    v_mfma_f32_16x16x32_bf16 v[172:175], v[76:79], v[40:43], v[172:175]
    ds_read_b128 v[80:83], v6 offset:32768
    v_mfma_f32_16x16x32_bf16 v[176:179], v[64:67], v[44:47], v[176:179]
    s_add_u32 m0, s22, 73728
    s_nop 0
    buffer_load_dwordx4 v2, s[12:15], s19 offen lds
    s_add_u32 s19, s19, s20
    v_mfma_f32_16x16x32_bf16 v[180:183], v[68:71], v[44:47], v[180:183]
    ds_read_b128 v[84:87], v6 offset:33792
    v_mfma_f32_16x16x32_bf16 v[184:187], v[72:75], v[44:47], v[184:187]
    ds_read_b128 v[88:91], v6 offset:34816
    v_mfma_f32_16x16x32_bf16 v[188:191], v[76:79], v[44:47], v[188:191]
    ds_read_b128 v[92:95], v6 offset:35840
    v_mfma_f32_16x16x32_bf16 v[192:195], v[64:67], v[48:51], v[192:195]
    ds_read_b128 v[96:99], v6 offset:36864
    v_mfma_f32_16x16x32_bf16 v[196:199], v[68:71], v[48:51], v[196:199]
    ds_read_b128 v[100:103], v6 offset:37888
    v_mfma_f32_16x16x32_bf16 v[200:203], v[72:75], v[48:51], v[200:203]
    ds_read_b128 v[104:107], v6 offset:38912
    v_mfma_f32_16x16x32_bf16 v[204:207], v[76:79], v[48:51], v[204:207]
    ds_read_b128 v[108:111], v6 offset:39936
    v_mfma_f32_16x16x32_bf16 v[208:211], v[64:67], v[52:55], v[208:211]
    v_mfma_f32_16x16x32_bf16 v[212:215], v[68:71], v[52:55], v[212:215]
    v_mfma_f32_16x16x32_bf16 v[216:219], v[72:75], v[52:55], v[216:219]
    v_mfma_f32_16x16x32_bf16 v[220:223], v[76:79], v[52:55], v[220:223]
    v_mfma_f32_16x16x32_bf16 v[224:227], v[64:67], v[56:59], v[224:227]
    v_mfma_f32_16x16x32_bf16 v[228:231], v[68:71], v[56:59], v[228:231]
    v_mfma_f32_16x16x32_bf16 v[232:235], v[72:75], v[56:59], v[232:235]
    v_mfma_f32_16x16x32_bf16 v[236:239], v[76:79], v[56:59], v[236:239]
    v_mfma_f32_16x16x32_bf16 v[240:243], v[64:67], v[60:63], v[240:243]
    v_mfma_f32_16x16x32_bf16 v[244:247], v[68:71], v[60:63], v[244:247]
    v_mfma_f32_16x16x32_bf16 v[248:251], v[72:75], v[60:63], v[248:251]
    v_mfma_f32_16x16x32_bf16 v[252:255], v[76:79], v[60:63], v[252:255]
    s_waitcnt lgkmcnt(0)
    s_waitcnt vmcnt(8)
    s_barrier
    s_cmp_eq_u32 s28, 0
    s_cbranch_scc1 sig_3
    s_cmp_lg_u32 s3, 0
    s_cbranch_scc1 sig_3
    s_and_b32 s57, s28, 3
    v_mov_b32 v24, s57
    s_bfe_u32 s57, s28, 0x20002
    v_mov_b32 v25, s57
    s_andn2_b32 s28, s28, 15
    s_mov_b64 exec, 1
    buffer_atomic_add_x2 v[24:25], v17, s[4:7], s28 offen sc1
    s_mov_b64 exec, -1
sig_3:
    s_mov_b32 s28, 0
    v_mfma_f32_16x16x32_bf16 v[128:131], v[112:115], v[80:83], v[128:131]
    s_add_u32 m0, s21, 98304
    s_nop 0
    buffer_load_dwordx4 v1, s[4:7], s16 offen sc1 lds
    s_add_u32 s16, s16, s62
    v_mfma_f32_16x16x32_bf16 v[132:135], v[116:119], v[80:83], v[132:135]
    ds_read_b64_tr_b16 v[64:65], v8 offset:16384
    v_mfma_f32_16x16x32_bf16 v[136:139], v[120:123], v[80:83], v[136:139]
    ds_read_b64_tr_b16 v[66:67], v9 offset:16384
    v_mfma_f32_16x16x32_bf16 v[140:143], v[124:127], v[80:83], v[140:143]
    ds_read_b64_tr_b16 v[68:69], v10 offset:16384
    v_mfma_f32_16x16x32_bf16 v[144:147], v[112:115], v[84:87], v[144:147]
    s_add_u32 m0, s21, 99328
    s_nop 0
    buffer_load_dwordx4 v1, s[4:7], s17 offen sc1 lds
    s_add_u32 s17, s17, s62
    v_mfma_f32_16x16x32_bf16 v[148:151], v[116:119], v[84:87], v[148:151]
    ds_read_b64_tr_b16 v[70:71], v11 offset:16384
    v_mfma_f32_16x16x32_bf16 v[152:155], v[120:123], v[84:87], v[152:155]
    ds_read_b64_tr_b16 v[72:73], v8 offset:24576
    v_mfma_f32_16x16x32_bf16 v[156:159], v[124:127], v[84:87], v[156:159]
    ds_read_b64_tr_b16 v[74:75], v9 offset:24576
    v_mfma_f32_16x16x32_bf16 v[160:163], v[112:115], v[88:91], v[160:163]
    s_add_u32 m0, s22, 98304
    s_nop 0
    buffer_load_dwordx4 v2, s[8:11], s18 offen lds
    s_add_u32 s18, s18, s20
    v_mfma_f32_16x16x32_bf16 v[164:167], v[116:119], v[88:91], v[164:167]
    ds_read_b64_tr_b16 v[76:77], v10 offset:24576
    v_mfma_f32_16x16x32_bf16 v[168:171], v[120:123], v[88:91], v[168:171]
    ds_read_b64_tr_b16 v[78:79], v11 offset:24576
    v_mfma_f32_16x16x32_bf16 v[172:175], v[124:127], v[88:91], v[172:175]
    ds_read_b128 v[32:35], v5 offset:0
    v_mfma_f32_16x16x32_bf16 v[176:179], v[112:115], v[92:95], v[176:179]
    s_add_u32 m0, s22, 106496
    s_nop 0
    buffer_load_dwordx4 v2, s[12:15], s19 offen lds
    s_add_u32 s19, s19, s20
    v_mfma_f32_16x16x32_bf16 v[180:183], v[116:119], v[92:95], v[180:183]
    ds_read_b128 v[36:39], v5 offset:1024
    v_mfma_f32_16x16x32_bf16 v[184:187], v[120:123], v[92:95], v[184:187]
    ds_read_b128 v[40:43], v5 offset:2048
    v_mfma_f32_16x16x32_bf16 v[188:191], v[124:127], v[92:95], v[188:191]
    ds_read_b128 v[44:47], v5 offset:3072
    v_mfma_f32_16x16x32_bf16 v[192:195], v[112:115], v[96:99], v[192:195]
    ds_read_b128 v[48:51], v5 offset:4096
    v_mfma_f32_16x16x32_bf16 v[196:199], v[116:119], v[96:99], v[196:199]
    ds_read_b128 v[52:55], v5 offset:5120
    v_mfma_f32_16x16x32_bf16 v[200:203], v[120:123], v[96:99], v[200:203]
    ds_read_b128 v[56:59], v5 offset:6144
    v_mfma_f32_16x16x32_bf16 v[204:207], v[124:127], v[96:99], v[204:207]
    ds_read_b128 v[60:63], v5 offset:7168
    v_mfma_f32_16x16x32_bf16 v[208:211], v[112:115], v[100:103], v[208:211]
    v_mfma_f32_16x16x32_bf16 v[212:215], v[116:119], v[100:103], v[212:215]
    v_mfma_f32_16x16x32_bf16 v[216:219], v[120:123], v[100:103], v[216:219]
    v_mfma_f32_16x16x32_bf16 v[220:223], v[124:127], v[100:103], v[220:223]
    v_mfma_f32_16x16x32_bf16 v[224:227], v[112:115], v[104:107], v[224:227]
    v_mfma_f32_16x16x32_bf16 v[228:231], v[116:119], v[104:107], v[228:231]
    v_mfma_f32_16x16x32_bf16 v[232:235], v[120:123], v[104:107], v[232:235]
    v_mfma_f32_16x16x32_bf16 v[236:239], v[124:127], v[104:107], v[236:239]
    v_mfma_f32_16x16x32_bf16 v[240:243], v[112:115], v[108:111], v[240:243]
    v_mfma_f32_16x16x32_bf16 v[244:247], v[116:119], v[108:111], v[244:247]
    v_mfma_f32_16x16x32_bf16 v[248:251], v[120:123], v[108:111], v[248:251]
    v_mfma_f32_16x16x32_bf16 v[252:255], v[124:127], v[108:111], v[252:255]
    s_waitcnt lgkmcnt(0)
    s_branch w_loop_chk
w_first16:
    s_waitcnt vmcnt(24)
    s_barrier
    v_mfma_f32_16x16x32_bf16 v[128:131], v[64:67], v[32:35], 0
    s_add_u32 m0, s21, 0
    s_nop 0
    buffer_load_dwordx4 v1, s[4:7], s16 offen sc1 lds
    s_add_u32 s16, s16, s62
    v_mfma_f32_16x16x32_bf16 v[132:135], v[68:71], v[32:35], 0
    ds_read_b64_tr_b16 v[112:113], v8 offset:49152
    v_mfma_f32_16x16x32_bf16 v[136:139], v[72:75], v[32:35], 0
    ds_read_b64_tr_b16 v[114:115], v9 offset:49152
    v_mfma_f32_16x16x32_bf16 v[140:143], v[76:79], v[32:35], 0
    ds_read_b64_tr_b16 v[116:117], v10 offset:49152
    v_mfma_f32_16x16x32_bf16 v[144:147], v[64:67], v[36:39], 0
    s_add_u32 m0, s21, 1024
    s_nop 0
    buffer_load_dwordx4 v1, s[4:7], s17 offen sc1 lds
    s_add_u32 s17, s17, s62
    v_mfma_f32_16x16x32_bf16 v[148:151], v[68:71], v[36:39], 0
    ds_read_b64_tr_b16 v[118:119], v11 offset:49152
    v_mfma_f32_16x16x32_bf16 v[152:155], v[72:75], v[36:39], 0
    ds_read_b64_tr_b16 v[120:121], v8 offset:57344
    v_mfma_f32_16x16x32_bf16 v[156:159], v[76:79], v[36:39], 0
    ds_read_b64_tr_b16 v[122:123], v9 offset:57344
    v_mfma_f32_16x16x32_bf16 v[160:163], v[64:67], v[40:43], 0
    s_add_u32 m0, s22, 0
    s_nop 0
    buffer_load_dwordx4 v2, s[8:11], s18 offen lds
    s_add_u32 s18, s18, s20
    v_mfma_f32_16x16x32_bf16 v[164:167], v[68:71], v[40:43], 0
    ds_read_b64_tr_b16 v[124:125], v10 offset:57344
    v_mfma_f32_16x16x32_bf16 v[168:171], v[72:75], v[40:43], 0
    ds_read_b64_tr_b16 v[126:127], v11 offset:57344
    v_mfma_f32_16x16x32_bf16 v[172:175], v[76:79], v[40:43], 0
    ds_read_b128 v[80:83], v5 offset:32768
    v_mfma_f32_16x16x32_bf16 v[176:179], v[64:67], v[44:47], 0
    s_add_u32 m0, s22, 8192
    s_nop 0
    buffer_load_dwordx4 v2, s[12:15], s19 offen lds
    s_add_u32 s19, s19, s20
    v_mfma_f32_16x16x32_bf16 v[180:183], v[68:71], v[44:47], 0
    ds_read_b128 v[84:87], v5 offset:33792
    v_mfma_f32_16x16x32_bf16 v[184:187], v[72:75], v[44:47], 0
    ds_read_b128 v[88:91], v5 offset:34816
    v_mfma_f32_16x16x32_bf16 v[188:191], v[76:79], v[44:47], 0
    ds_read_b128 v[92:95], v5 offset:35840
    v_mfma_f32_16x16x32_bf16 v[192:195], v[64:67], v[48:51], 0
    ds_read_b128 v[96:99], v5 offset:36864
    v_mfma_f32_16x16x32_bf16 v[196:199], v[68:71], v[48:51], 0
    ds_read_b128 v[100:103], v5 offset:37888
    v_mfma_f32_16x16x32_bf16 v[200:203], v[72:75], v[48:51], 0
    ds_read_b128 v[104:107], v5 offset:38912
    v_mfma_f32_16x16x32_bf16 v[204:207], v[76:79], v[48:51], 0
    ds_read_b128 v[108:111], v5 offset:39936
    v_mfma_f32_16x16x32_bf16 v[208:211], v[64:67], v[52:55], 0
    v_mfma_f32_16x16x32_bf16 v[212:215], v[68:71], v[52:55], 0
    v_mfma_f32_16x16x32_bf16 v[216:219], v[72:75], v[52:55], 0
    v_mfma_f32_16x16x32_bf16 v[220:223], v[76:79], v[52:55], 0
    v_mfma_f32_16x16x32_bf16 v[224:227], v[64:67], v[56:59], 0
    v_mfma_f32_16x16x32_bf16 v[228:231], v[68:71], v[56:59], 0
    v_mfma_f32_16x16x32_bf16 v[232:235], v[72:75], v[56:59], 0
    v_mfma_f32_16x16x32_bf16 v[236:239], v[76:79], v[56:59], 0
    v_mfma_f32_16x16x32_bf16 v[240:243], v[64:67], v[60:63], 0
    v_mfma_f32_16x16x32_bf16 v[244:247], v[68:71], v[60:63], 0
    v_mfma_f32_16x16x32_bf16 v[248:251], v[72:75], v[60:63], 0
    v_mfma_f32_16x16x32_bf16 v[252:255], v[76:79], v[60:63], 0
    s_waitcnt lgkmcnt(0)
    s_waitcnt vmcnt(24)
    s_barrier
    v_mfma_f32_16x16x32_bf16 v[128:131], v[112:115], v[80:83], v[128:131]
    s_add_u32 m0, s21, 32768
    s_nop 0
    buffer_load_dwordx4 v1, s[4:7], s16 offen sc1 lds
    s_add_u32 s16, s16, s62
    v_mfma_f32_16x16x32_bf16 v[132:135], v[116:119], v[80:83], v[132:135]
    ds_read_b64_tr_b16 v[64:65], v12 offset:16384
    v_mfma_f32_16x16x32_bf16 v[136:139], v[120:123], v[80:83], v[136:139]
    ds_read_b64_tr_b16 v[66:67], v13 offset:16384
    v_mfma_f32_16x16x32_bf16 v[140:143], v[124:127], v[80:83], v[140:143]
    ds_read_b64_tr_b16 v[68:69], v14 offset:16384
    v_mfma_f32_16x16x32_bf16 v[144:147], v[112:115], v[84:87], v[144:147]
    s_add_u32 m0, s21, 33792
    s_nop 0
    buffer_load_dwordx4 v1, s[4:7], s17 offen sc1 lds
    s_add_u32 s17, s17, s62
    v_mfma_f32_16x16x32_bf16 v[148:151], v[116:119], v[84:87], v[148:151]
    ds_read_b64_tr_b16 v[70:71], v15 offset:16384
    v_mfma_f32_16x16x32_bf16 v[152:155], v[120:123], v[84:87], v[152:155]
    ds_read_b64_tr_b16 v[72:73], v12 offset:24576
    v_mfma_f32_16x16x32_bf16 v[156:159], v[124:127], v[84:87], v[156:159]
    ds_read_b64_tr_b16 v[74:75], v13 offset:24576
    v_mfma_f32_16x16x32_bf16 v[160:163], v[112:115], v[88:91], v[160:163]
    s_add_u32 m0, s22, 32768
    s_nop 0
    buffer_load_dwordx4 v2, s[8:11], s18 offen lds
    s_add_u32 s18, s18, s20
    v_mfma_f32_16x16x32_bf16 v[164:167], v[116:119], v[88:91], v[164:167]
    ds_read_b64_tr_b16 v[76:77], v14 offset:24576
    v_mfma_f32_16x16x32_bf16 v[168:171], v[120:123], v[88:91], v[168:171]
    ds_read_b64_tr_b16 v[78:79], v15 offset:24576
    v_mfma_f32_16x16x32_bf16 v[172:175], v[124:127], v[88:91], v[172:175]
    ds_read_b128 v[32:35], v6 offset:0
    v_mfma_f32_16x16x32_bf16 v[176:179], v[112:115], v[92:95], v[176:179]
    s_add_u32 m0, s22, 40960
    s_nop 0
    buffer_load_dwordx4 v2, s[12:15], s19 offen lds
    s_add_u32 s19, s19, s20
    v_mfma_f32_16x16x32_bf16 v[180:183], v[116:119], v[92:95], v[180:183]
    ds_read_b128 v[36:39], v6 offset:1024
    v_mfma_f32_16x16x32_bf16 v[184:187], v[120:123], v[92:95], v[184:187]
    ds_read_b128 v[40:43], v6 offset:2048
    v_mfma_f32_16x16x32_bf16 v[188:191], v[124:127], v[92:95], v[188:191]
    ds_read_b128 v[44:47], v6 offset:3072
    v_mfma_f32_16x16x32_bf16 v[192:195], v[112:115], v[96:99], v[192:195]
    ds_read_b128 v[48:51], v6 offset:4096
    v_mfma_f32_16x16x32_bf16 v[196:199], v[116:119], v[96:99], v[196:199]
    ds_read_b128 v[52:55], v6 offset:5120
    v_mfma_f32_16x16x32_bf16 v[200:203], v[120:123], v[96:99], v[200:203]
    ds_read_b128 v[56:59], v6 offset:6144
    v_mfma_f32_16x16x32_bf16 v[204:207], v[124:127], v[96:99], v[204:207]
    ds_read_b128 v[60:63], v6 offset:7168
    v_mfma_f32_16x16x32_bf16 v[208:211], v[112:115], v[100:103], v[208:211]
    v_mfma_f32_16x16x32_bf16 v[212:215], v[116:119], v[100:103], v[212:215]
    v_mfma_f32_16x16x32_bf16 v[216:219], v[120:123], v[100:103], v[216:219]
    v_mfma_f32_16x16x32_bf16 v[220:223], v[124:127], v[100:103], v[220:223]
    v_mfma_f32_16x16x32_bf16 v[224:227], v[112:115], v[104:107], v[224:227]
    v_mfma_f32_16x16x32_bf16 v[228:231], v[116:119], v[104:107], v[228:231]
    v_mfma_f32_16x16x32_bf16 v[232:235], v[120:123], v[104:107], v[232:235]
    v_mfma_f32_16x16x32_bf16 v[236:239], v[124:127], v[104:107], v[236:239]
    v_mfma_f32_16x16x32_bf16 v[240:243], v[112:115], v[108:111], v[240:243]
    v_mfma_f32_16x16x32_bf16 v[244:247], v[116:119], v[108:111], v[244:247]
    v_mfma_f32_16x16x32_bf16 v[248:251], v[120:123], v[108:111], v[248:251]
    v_mfma_f32_16x16x32_bf16 v[252:255], v[124:127], v[108:111], v[252:255]
    s_waitcnt lgkmcnt(0)
    s_waitcnt vmcnt(24)
    s_barrier
    v_mfma_f32_16x16x32_bf16 v[128:131], v[64:67], v[32:35], v[128:131]
    s_add_u32 m0, s21, 65536
    s_nop 0
    buffer_load_dwordx4 v1, s[4:7], s16 offen sc1 lds
    s_add_u32 s16, s16, s62
    v_mfma_f32_16x16x32_bf16 v[132:135], v[68:71], v[32:35], v[132:135]
    ds_read_b64_tr_b16 v[112:113], v12 offset:49152
    v_mfma_f32_16x16x32_bf16 v[136:139], v[72:75], v[32:35], v[136:139]
    ds_read_b64_tr_b16 v[114:115], v13 offset:49152
    v_mfma_f32_16x16x32_bf16 v[140:143], v[76:79], v[32:35], v[140:143]
    ds_read_b64_tr_b16 v[116:117], v14 offset:49152
    v_mfma_f32_16x16x32_bf16 v[144:147], v[64:67], v[36:39], v[144:147]
    s_add_u32 m0, s21, 66560
    s_nop 0
    buffer_load_dwordx4 v1, s[4:7], s17 offen sc1 lds
    s_add_u32 s17, s17, s62
    v_mfma_f32_16x16x32_bf16 v[148:151], v[68:71], v[36:39], v[148:151]
    ds_read_b64_tr_b16 v[118:119], v15 offset:49152
    v_mfma_f32_16x16x32_bf16 v[152:155], v[72:75], v[36:39], v[152:155]
    ds_read_b64_tr_b16 v[120:121], v12 offset:57344
    v_mfma_f32_16x16x32_bf16 v[156:159], v[76:79], v[36:39], v[156:159]
    ds_read_b64_tr_b16 v[122:123], v13 offset:57344
    v_mfma_f32_16x16x32_bf16 v[160:163], v[64:67], v[40:43], v[160:163]
    s_add_u32 m0, s22, 65536
    s_nop 0
    buffer_load_dwordx4 v2, s[8:11], s18 offen lds
    s_add_u32 s18, s18, s20
    v_mfma_f32_16x16x32_bf16 v[164:167], v[68:71], v[40:43], v[164:167]
    ds_read_b64_tr_b16 v[124:125], v14 offset:57344
    v_mfma_f32_16x16x32_bf16 v[168:171], v[72:75], v[40:43], v[168:171]
    ds_read_b64_tr_b16 v[126:127], v15 offset:57344
    v_mfma_f32_16x16x32_bf16 v[172:175], v[76:79], v[40:43], v[172:175]
    ds_read_b128 v[80:83], v6 offset:32768
    v_mfma_f32_16x16x32_bf16 v[176:179], v[64:67], v[44:47], v[176:179]
    s_add_u32 m0, s22, 73728
    s_nop 0
    buffer_load_dwordx4 v2, s[12:15], s19 offen lds
    s_add_u32 s19, s19, s20
    v_mfma_f32_16x16x32_bf16 v[180:183], v[68:71], v[44:47], v[180:183]
    ds_read_b128 v[84:87], v6 offset:33792
    v_mfma_f32_16x16x32_bf16 v[184:187], v[72:75], v[44:47], v[184:187]
    ds_read_b128 v[88:91], v6 offset:34816
    v_mfma_f32_16x16x32_bf16 v[188:191], v[76:79], v[44:47], v[188:191]
    ds_read_b128 v[92:95], v6 offset:35840
    v_mfma_f32_16x16x32_bf16 v[192:195], v[64:67], v[48:51], v[192:195]
    ds_read_b128 v[96:99], v6 offset:36864
    v_mfma_f32_16x16x32_bf16 v[196:199], v[68:71], v[48:51], v[196:199]
    ds_read_b128 v[100:103], v6 offset:37888
    v_mfma_f32_16x16x32_bf16 v[200:203], v[72:75], v[48:51], v[200:203]
    ds_read_b128 v[104:107], v6 offset:38912
    v_mfma_f32_16x16x32_bf16 v[204:207], v[76:79], v[48:51], v[204:207]
    ds_read_b128 v[108:111], v6 offset:39936
    v_mfma_f32_16x16x32_bf16 v[208:211], v[64:67], v[52:55], v[208:211]
    v_mfma_f32_16x16x32_bf16 v[212:215], v[68:71], v[52:55], v[212:215]
    v_mfma_f32_16x16x32_bf16 v[216:219], v[72:75], v[52:55], v[216:219]
    v_mfma_f32_16x16x32_bf16 v[220:223], v[76:79], v[52:55], v[220:223]
    v_mfma_f32_16x16x32_bf16 v[224:227], v[64:67], v[56:59], v[224:227]
    v_mfma_f32_16x16x32_bf16 v[228:231], v[68:71], v[56:59], v[228:231]
    v_mfma_f32_16x16x32_bf16 v[232:235], v[72:75], v[56:59], v[232:235]
    v_mfma_f32_16x16x32_bf16 v[236:239], v[76:79], v[56:59], v[236:239]
    v_mfma_f32_16x16x32_bf16 v[240:243], v[64:67], v[60:63], v[240:243]
    v_mfma_f32_16x16x32_bf16 v[244:247], v[68:71], v[60:63], v[244:247]
    v_mfma_f32_16x16x32_bf16 v[248:251], v[72:75], v[60:63], v[248:251]
    v_mfma_f32_16x16x32_bf16 v[252:255], v[76:79], v[60:63], v[252:255]
    s_waitcnt lgkmcnt(0)
    s_waitcnt vmcnt(8)
    s_barrier
    s_cmp_eq_u32 s28, 0
    s_cbranch_scc1 sig_4
    s_cmp_lg_u32 s3, 0
    s_cbranch_scc1 sig_4
    s_and_b32 s57, s28, 3
    v_mov_b32 v24, s57
    s_bfe_u32 s57, s28, 0x20002
    v_mov_b32 v25, s57
    s_andn2_b32 s28, s28, 15
    s_mov_b64 exec, 1
    buffer_atomic_add_x2 v[24:25], v17, s[4:7], s28 offen sc1
    s_mov_b64 exec, -1
sig_4:
    s_mov_b32 s28, 0
    v_mfma_f32_16x16x32_bf16 v[128:131], v[112:115], v[80:83], v[128:131]
    s_add_u32 m0, s21, 98304
    s_nop 0
    buffer_load_dwordx4 v1, s[4:7], s16 offen sc1 lds
    s_add_u32 s16, s16, s62
    v_mfma_f32_16x16x32_bf16 v[132:135], v[116:119], v[80:83], v[132:135]
    ds_read_b64_tr_b16 v[64:65], v8 offset:16384
    v_mfma_f32_16x16x32_bf16 v[136:139], v[120:123], v[80:83], v[136:139]
    ds_read_b64_tr_b16 v[66:67], v9 offset:16384
    v_mfma_f32_16x16x32_bf16 v[140:143], v[124:127], v[80:83], v[140:143]
    ds_read_b64_tr_b16 v[68:69], v10 offset:16384
    v_mfma_f32_16x16x32_bf16 v[144:147], v[112:115], v[84:87], v[144:147]
    s_add_u32 m0, s21, 99328
    s_nop 0
    buffer_load_dwordx4 v1, s[4:7], s17 offen sc1 lds
    s_add_u32 s17, s17, s62
    v_mfma_f32_16x16x32_bf16 v[148:151], v[116:119], v[84:87], v[148:151]
    ds_read_b64_tr_b16 v[70:71], v11 offset:16384
    v_mfma_f32_16x16x32_bf16 v[152:155], v[120:123], v[84:87], v[152:155]
    ds_read_b64_tr_b16 v[72:73], v8 offset:24576
    v_mfma_f32_16x16x32_bf16 v[156:159], v[124:127], v[84:87], v[156:159]
    ds_read_b64_tr_b16 v[74:75], v9 offset:24576
    v_mfma_f32_16x16x32_bf16 v[160:163], v[112:115], v[88:91], v[160:163]
    s_add_u32 m0, s22, 98304
    s_nop 0
    buffer_load_dwordx4 v2, s[8:11], s18 offen lds
    s_add_u32 s18, s18, s20
    v_mfma_f32_16x16x32_bf16 v[164:167], v[116:119], v[88:91], v[164:167]
    ds_read_b64_tr_b16 v[76:77], v10 offset:24576
    v_mfma_f32_16x16x32_bf16 v[168:171], v[120:123], v[88:91], v[168:171]
    ds_read_b64_tr_b16 v[78:79], v11 offset:24576
    v_mfma_f32_16x16x32_bf16 v[172:175], v[124:127], v[88:91], v[172:175]
    ds_read_b128 v[32:35], v5 offset:0
    v_mfma_f32_16x16x32_bf16 v[176:179], v[112:115], v[92:95], v[176:179]
    s_add_u32 m0, s22, 106496
    s_nop 0
    buffer_load_dwordx4 v2, s[12:15], s19 offen lds
    s_add_u32 s19, s19, s20
    v_mfma_f32_16x16x32_bf16 v[180:183], v[116:119], v[92:95], v[180:183]
    ds_read_b128 v[36:39], v5 offset:1024
    v_mfma_f32_16x16x32_bf16 v[184:187], v[120:123], v[92:95], v[184:187]
    ds_read_b128 v[40:43], v5 offset:2048
    v_mfma_f32_16x16x32_bf16 v[188:191], v[124:127], v[92:95], v[188:191]
    ds_read_b128 v[44:47], v5 offset:3072
    v_mfma_f32_16x16x32_bf16 v[192:195], v[112:115], v[96:99], v[192:195]
    ds_read_b128 v[48:51], v5 offset:4096
    v_mfma_f32_16x16x32_bf16 v[196:199], v[116:119], v[96:99], v[196:199]
    ds_read_b128 v[52:55], v5 offset:5120
    v_mfma_f32_16x16x32_bf16 v[200:203], v[120:123], v[96:99], v[200:203]
    ds_read_b128 v[56:59], v5 offset:6144
    v_mfma_f32_16x16x32_bf16 v[204:207], v[124:127], v[96:99], v[204:207]
    ds_read_b128 v[60:63], v5 offset:7168
    v_mfma_f32_16x16x32_bf16 v[208:211], v[112:115], v[100:103], v[208:211]
    v_mfma_f32_16x16x32_bf16 v[212:215], v[116:119], v[100:103], v[212:215]
    v_mfma_f32_16x16x32_bf16 v[216:219], v[120:123], v[100:103], v[216:219]
    v_mfma_f32_16x16x32_bf16 v[220:223], v[124:127], v[100:103], v[220:223]
    v_mfma_f32_16x16x32_bf16 v[224:227], v[112:115], v[104:107], v[224:227]
    v_mfma_f32_16x16x32_bf16 v[228:231], v[116:119], v[104:107], v[228:231]
    v_mfma_f32_16x16x32_bf16 v[232:235], v[120:123], v[104:107], v[232:235]
    v_mfma_f32_16x16x32_bf16 v[236:239], v[124:127], v[104:107], v[236:239]
    v_mfma_f32_16x16x32_bf16 v[240:243], v[112:115], v[108:111], v[240:243]
    v_mfma_f32_16x16x32_bf16 v[244:247], v[116:119], v[108:111], v[244:247]
    v_mfma_f32_16x16x32_bf16 v[248:251], v[120:123], v[108:111], v[248:251]
    v_mfma_f32_16x16x32_bf16 v[252:255], v[124:127], v[108:111], v[252:255]
    s_waitcnt lgkmcnt(0)
w_loop_chk:
    s_sub_u32 s23, s23, 1
w_loop:
    s_cmp_gt_u32 s23, 3
    s_cbranch_scc1 w_body
    s_cmp_lg_u32 s23, 3
    s_cbranch_scc1 w_l2
    s_cmp_lg_u32 s3, 0
    s_cbranch_scc1 clm_5
    v_mov_b32 v26, 1
    s_mov_b64 exec, 1
    buffer_atomic_add v26, off, s[64:67], s71 sc0 sc1
    s_mov_b64 exec, -1
clm_5:
    s_branch w_body
w_l2:
    s_cmp_lg_u32 s23, 2
    s_cbranch_scc1 w_l1
    s_cmp_lg_u32 s3, 0
    s_cbranch_scc1 pub_6
    v_mov_b32 v20, 131136
    s_mov_b64 exec, 1
    ds_write_b32 v20, v26
    s_mov_b64 exec, -1
    s_waitcnt lgkmcnt(0)
pub_6:
    s_branch w_body
w_l1:
    s_waitcnt vmcnt(8)
    v_readfirstlane_b32 s30, v16
    s_cmp_ge_u32 s30, s45
    s_cselect_b32 s30, 0, 1
    s_or_b32 s30, s30, s70
    s_cmp_eq_u32 s32, 4
    s_cselect_b32 s30, 1, s30
    s_sub_u32 s57, s32, 1
    s_cmp_ge_u32 s57, 4
    s_cselect_b32 s30, 1, s30
    v_mov_b32 v20, s30
    ds_write_b32 v7, v20
    s_cbranch_scc1 w_body
    s_load_dwordx2 s[8:9], s[0:1], s33
    s_load_dwordx2 s[12:13], s[0:1], s34
    s_mov_b32 s10, s38
    s_mov_b32 s14, s38
    s_cmp_eq_u32 s32, 4
    s_cselect_b32 s31, 0, 1
    s_lshl_b32 s30, s3, s31
    s_mul_i32 s30, s30, s40
    s_add_u32 s16, s39, s30
    s_cmp_eq_u32 s32, 4
    s_cselect_b32 s30, 1024, s40
    s_cselect_b32 s31, 6, 5
    s_lshl_b32 s62, 32, s31
    s_add_u32 s17, s16, s30
    s_lshl_b32 s30, s3, 2
    s_mul_i32 s30, s30, s35
    s_add_u32 s18, s36, s30
    s_add_u32 s19, s37, s30
    s_lshl_b32 s20, s35, s31
    v_mul_u32_u24 v2, s35, v4
    v_add_u32 v2, v2, v3
    s_waitcnt lgkmcnt(0)
w_body:
    s_waitcnt vmcnt(8)
    s_barrier
    s_cmp_lg_u32 s23, 2
    s_cbranch_scc1 w_nf
    v_mov_b32 v20, 131136
    ds_read_b32 v20, v20
    s_waitcnt lgkmcnt(0)
    v_readfirstlane_b32 s59, v20
    s_add_u32 s59, s59, 32
    s_min_u32 s59, s59, 337
    s_lshl_b32 s57, s59, 6
    s_load_dwordx16 s[32:47], s[24:25], s57
w_nf:
    v_mfma_f32_16x16x32_bf16 v[128:131], v[64:67], v[32:35], v[128:131]
    s_add_u32 m0, s21, 0
    s_nop 0
    buffer_load_dwordx4 v1, s[4:7], s16 offen sc1 lds
    s_add_u32 s16, s16, s62
    v_mfma_f32_16x16x32_bf16 v[132:135], v[68:71], v[32:35], v[132:135]
    ds_read_b64_tr_b16 v[112:113], v8 offset:49152
    v_mfma_f32_16x16x32_bf16 v[136:139], v[72:75], v[32:35], v[136:139]
    ds_read_b64_tr_b16 v[114:115], v9 offset:49152
    v_mfma_f32_16x16x32_bf16 v[140:143], v[76:79], v[32:35], v[140:143]
    ds_read_b64_tr_b16 v[116:117], v10 offset:49152
    v_mfma_f32_16x16x32_bf16 v[144:147], v[64:67], v[36:39], v[144:147]
    s_add_u32 m0, s21, 1024
    s_nop 0
    buffer_load_dwordx4 v1, s[4:7], s17 offen sc1 lds
    s_add_u32 s17, s17, s62
    v_mfma_f32_16x16x32_bf16 v[148:151], v[68:71], v[36:39], v[148:151]
    ds_read_b64_tr_b16 v[118:119], v11 offset:49152
    v_mfma_f32_16x16x32_bf16 v[152:155], v[72:75], v[36:39], v[152:155]
    ds_read_b64_tr_b16 v[120:121], v8 offset:57344
    v_mfma_f32_16x16x32_bf16 v[156:159], v[76:79], v[36:39], v[156:159]
    ds_read_b64_tr_b16 v[122:123], v9 offset:57344
    v_mfma_f32_16x16x32_bf16 v[160:163], v[64:67], v[40:43], v[160:163]
    s_add_u32 m0, s22, 0
    s_nop 0
    buffer_load_dwordx4 v2, s[8:11], s18 offen lds
    s_add_u32 s18, s18, s20
    v_mfma_f32_16x16x32_bf16 v[164:167], v[68:71], v[40:43], v[164:167]
    ds_read_b64_tr_b16 v[124:125], v10 offset:57344
    v_mfma_f32_16x16x32_bf16 v[168:171], v[72:75], v[40:43], v[168:171]
    ds_read_b64_tr_b16 v[126:127], v11 offset:57344
    v_mfma_f32_16x16x32_bf16 v[172:175], v[76:79], v[40:43], v[172:175]
    ds_read_b128 v[80:83], v5 offset:32768
    v_mfma_f32_16x16x32_bf16 v[176:179], v[64:67], v[44:47], v[176:179]
    s_add_u32 m0, s22, 8192
    s_nop 0
    buffer_load_dwordx4 v2, s[12:15], s19 offen lds
    s_add_u32 s19, s19, s20
    v_mfma_f32_16x16x32_bf16 v[180:183], v[68:71], v[44:47], v[180:183]
    ds_read_b128 v[84:87], v5 offset:33792
    v_mfma_f32_16x16x32_bf16 v[184:187], v[72:75], v[44:47], v[184:187]
    ds_read_b128 v[88:91], v5 offset:34816
    v_mfma_f32_16x16x32_bf16 v[188:191], v[76:79], v[44:47], v[188:191]
    ds_read_b128 v[92:95], v5 offset:35840
    v_mfma_f32_16x16x32_bf16 v[192:195], v[64:67], v[48:51], v[192:195]
    ds_read_b128 v[96:99], v5 offset:36864
    v_mfma_f32_16x16x32_bf16 v[196:199], v[68:71], v[48:51], v[196:199]
    ds_read_b128 v[100:103], v5 offset:37888
    v_mfma_f32_16x16x32_bf16 v[200:203], v[72:75], v[48:51], v[200:203]
    ds_read_b128 v[104:107], v5 offset:38912
    v_mfma_f32_16x16x32_bf16 v[204:207], v[76:79], v[48:51], v[204:207]
    ds_read_b128 v[108:111], v5 offset:39936
    v_mfma_f32_16x16x32_bf16 v[208:211], v[64:67], v[52:55], v[208:211]
    v_mfma_f32_16x16x32_bf16 v[212:215], v[68:71], v[52:55], v[212:215]
    v_mfma_f32_16x16x32_bf16 v[216:219], v[72:75], v[52:55], v[216:219]
    v_mfma_f32_16x16x32_bf16 v[220:223], v[76:79], v[52:55], v[220:223]
    v_mfma_f32_16x16x32_bf16 v[224:227], v[64:67], v[56:59], v[224:227]
    v_mfma_f32_16x16x32_bf16 v[228:231], v[68:71], v[56:59], v[228:231]
    v_mfma_f32_16x16x32_bf16 v[232:235], v[72:75], v[56:59], v[232:235]
    v_mfma_f32_16x16x32_bf16 v[236:239], v[76:79], v[56:59], v[236:239]
    v_mfma_f32_16x16x32_bf16 v[240:243], v[64:67], v[60:63], v[240:243]
    v_mfma_f32_16x16x32_bf16 v[244:247], v[68:71], v[60:63], v[244:247]
    v_mfma_f32_16x16x32_bf16 v[248:251], v[72:75], v[60:63], v[248:251]
    v_mfma_f32_16x16x32_bf16 v[252:255], v[76:79], v[60:63], v[252:255]
    s_waitcnt lgkmcnt(0)
    s_waitcnt vmcnt(8)
    s_barrier
    buffer_load_dword v16, v17, s[4:7], s44 offen sc1
    v_mfma_f32_16x16x32_bf16 v[128:131], v[112:115], v[80:83], v[128:131]
    s_add_u32 m0, s21, 32768
    s_nop 0
    buffer_load_dwordx4 v1, s[4:7], s16 offen sc1 lds
    s_add_u32 s16, s16, s62
    v_mfma_f32_16x16x32_bf16 v[132:135], v[116:119], v[80:83], v[132:135]
    ds_read_b64_tr_b16 v[64:65], v12 offset:16384
    v_mfma_f32_16x16x32_bf16 v[136:139], v[120:123], v[80:83], v[136:139]
    ds_read_b64_tr_b16 v[66:67], v13 offset:16384
    v_mfma_f32_16x16x32_bf16 v[140:143], v[124:127], v[80:83], v[140:143]
    ds_read_b64_tr_b16 v[68:69], v14 offset:16384
    v_mfma_f32_16x16x32_bf16 v[144:147], v[112:115], v[84:87], v[144:147]
    s_add_u32 m0, s21, 33792
    s_nop 0
    buffer_load_dwordx4 v1, s[4:7], s17 offen sc1 lds
    s_add_u32 s17, s17, s62
    v_mfma_f32_16x16x32_bf16 v[148:151], v[116:119], v[84:87], v[148:151]
    ds_read_b64_tr_b16 v[70:71], v15 offset:16384
    v_mfma_f32_16x16x32_bf16 v[152:155], v[120:123], v[84:87], v[152:155]
    ds_read_b64_tr_b16 v[72:73], v12 offset:24576
    v_mfma_f32_16x16x32_bf16 v[156:159], v[124:127], v[84:87], v[156:159]
    ds_read_b64_tr_b16 v[74:75], v13 offset:24576
    v_mfma_f32_16x16x32_bf16 v[160:163], v[112:115], v[88:91], v[160:163]
    s_add_u32 m0, s22, 32768
    s_nop 0
    buffer_load_dwordx4 v2, s[8:11], s18 offen lds
    s_add_u32 s18, s18, s20
    v_mfma_f32_16x16x32_bf16 v[164:167], v[116:119], v[88:91], v[164:167]
    ds_read_b64_tr_b16 v[76:77], v14 offset:24576
    v_mfma_f32_16x16x32_bf16 v[168:171], v[120:123], v[88:91], v[168:171]
    ds_read_b64_tr_b16 v[78:79], v15 offset:24576
    v_mfma_f32_16x16x32_bf16 v[172:175], v[124:127], v[88:91], v[172:175]
    ds_read_b128 v[32:35], v6 offset:0
    v_mfma_f32_16x16x32_bf16 v[176:179], v[112:115], v[92:95], v[176:179]
    s_add_u32 m0, s22, 40960
    s_nop 0
    buffer_load_dwordx4 v2, s[12:15], s19 offen lds
    s_add_u32 s19, s19, s20
    v_mfma_f32_16x16x32_bf16 v[180:183], v[116:119], v[92:95], v[180:183]
    ds_read_b128 v[36:39], v6 offset:1024
    v_mfma_f32_16x16x32_bf16 v[184:187], v[120:123], v[92:95], v[184:187]
    ds_read_b128 v[40:43], v6 offset:2048
    v_mfma_f32_16x16x32_bf16 v[188:191], v[124:127], v[92:95], v[188:191]
    ds_read_b128 v[44:47], v6 offset:3072
    v_mfma_f32_16x16x32_bf16 v[192:195], v[112:115], v[96:99], v[192:195]
    ds_read_b128 v[48:51], v6 offset:4096
    v_mfma_f32_16x16x32_bf16 v[196:199], v[116:119], v[96:99], v[196:199]
    ds_read_b128 v[52:55], v6 offset:5120
    v_mfma_f32_16x16x32_bf16 v[200:203], v[120:123], v[96:99], v[200:203]
    ds_read_b128 v[56:59], v6 offset:6144
    v_mfma_f32_16x16x32_bf16 v[204:207], v[124:127], v[96:99], v[204:207]
    ds_read_b128 v[60:63], v6 offset:7168
    v_mfma_f32_16x16x32_bf16 v[208:211], v[112:115], v[100:103], v[208:211]
    v_mfma_f32_16x16x32_bf16 v[212:215], v[116:119], v[100:103], v[212:215]
    v_mfma_f32_16x16x32_bf16 v[216:219], v[120:123], v[100:103], v[216:219]
    v_mfma_f32_16x16x32_bf16 v[220:223], v[124:127], v[100:103], v[220:223]
    v_mfma_f32_16x16x32_bf16 v[224:227], v[112:115], v[104:107], v[224:227]
    v_mfma_f32_16x16x32_bf16 v[228:231], v[116:119], v[104:107], v[228:231]
    v_mfma_f32_16x16x32_bf16 v[232:235], v[120:123], v[104:107], v[232:235]
    v_mfma_f32_16x16x32_bf16 v[236:239], v[124:127], v[104:107], v[236:239]
    v_mfma_f32_16x16x32_bf16 v[240:243], v[112:115], v[108:111], v[240:243]
    v_mfma_f32_16x16x32_bf16 v[244:247], v[116:119], v[108:111], v[244:247]
    v_mfma_f32_16x16x32_bf16 v[248:251], v[120:123], v[108:111], v[248:251]
    v_mfma_f32_16x16x32_bf16 v[252:255], v[124:127], v[108:111], v[252:255]
    s_waitcnt lgkmcnt(0)
    s_waitcnt vmcnt(8)
    s_barrier
    v_mfma_f32_16x16x32_bf16 v[128:131], v[64:67], v[32:35], v[128:131]
    s_add_u32 m0, s21, 65536
    s_nop 0
    buffer_load_dwordx4 v1, s[4:7], s16 offen sc1 lds
    s_add_u32 s16, s16, s62
    v_mfma_f32_16x16x32_bf16 v[132:135], v[68:71], v[32:35], v[132:135]
    ds_read_b64_tr_b16 v[112:113], v12 offset:49152
    v_mfma_f32_16x16x32_bf16 v[136:139], v[72:75], v[32:35], v[136:139]
    ds_read_b64_tr_b16 v[114:115], v13 offset:49152
    v_mfma_f32_16x16x32_bf16 v[140:143], v[76:79], v[32:35], v[140:143]
    ds_read_b64_tr_b16 v[116:117], v14 offset:49152
    v_mfma_f32_16x16x32_bf16 v[144:147], v[64:67], v[36:39], v[144:147]
    s_add_u32 m0, s21, 66560
    s_nop 0
    buffer_load_dwordx4 v1, s[4:7], s17 offen sc1 lds
    s_add_u32 s17, s17, s62
    v_mfma_f32_16x16x32_bf16 v[148:151], v[68:71], v[36:39], v[148:151]
    ds_read_b64_tr_b16 v[118:119], v15 offset:49152
    v_mfma_f32_16x16x32_bf16 v[152:155], v[72:75], v[36:39], v[152:155]
    ds_read_b64_tr_b16 v[120:121], v12 offset:57344
    v_mfma_f32_16x16x32_bf16 v[156:159], v[76:79], v[36:39], v[156:159]
    ds_read_b64_tr_b16 v[122:123], v13 offset:57344
    v_mfma_f32_16x16x32_bf16 v[160:163], v[64:67], v[40:43], v[160:163]
    s_add_u32 m0, s22, 65536
    s_nop 0
    buffer_load_dwordx4 v2, s[8:11], s18 offen lds
    s_add_u32 s18, s18, s20
    v_mfma_f32_16x16x32_bf16 v[164:167], v[68:71], v[40:43], v[164:167]
    ds_read_b64_tr_b16 v[124:125], v14 offset:57344
    v_mfma_f32_16x16x32_bf16 v[168:171], v[72:75], v[40:43], v[168:171]
    ds_read_b64_tr_b16 v[126:127], v15 offset:57344
    v_mfma_f32_16x16x32_bf16 v[172:175], v[76:79], v[40:43], v[172:175]
    ds_read_b128 v[80:83], v6 offset:32768
    v_mfma_f32_16x16x32_bf16 v[176:179], v[64:67], v[44:47], v[176:179]
    s_add_u32 m0, s22, 73728
    s_nop 0
    buffer_load_dwordx4 v2, s[12:15], s19 offen lds
    s_add_u32 s19, s19, s20
    v_mfma_f32_16x16x32_bf16 v[180:183], v[68:71], v[44:47], v[180:183]
    ds_read_b128 v[84:87], v6 offset:33792
    v_mfma_f32_16x16x32_bf16 v[184:187], v[72:75], v[44:47], v[184:187]
    ds_read_b128 v[88:91], v6 offset:34816
    v_mfma_f32_16x16x32_bf16 v[188:191], v[76:79], v[44:47], v[188:191]
    ds_read_b128 v[92:95], v6 offset:35840
    v_mfma_f32_16x16x32_bf16 v[192:195], v[64:67], v[48:51], v[192:195]
    ds_read_b128 v[96:99], v6 offset:36864
    v_mfma_f32_16x16x32_bf16 v[196:199], v[68:71], v[48:51], v[196:199]
    ds_read_b128 v[100:103], v6 offset:37888
    v_mfma_f32_16x16x32_bf16 v[200:203], v[72:75], v[48:51], v[200:203]
    ds_read_b128 v[104:107], v6 offset:38912
    v_mfma_f32_16x16x32_bf16 v[204:207], v[76:79], v[48:51], v[204:207]
    ds_read_b128 v[108:111], v6 offset:39936
    v_mfma_f32_16x16x32_bf16 v[208:211], v[64:67], v[52:55], v[208:211]
    v_mfma_f32_16x16x32_bf16 v[212:215], v[68:71], v[52:55], v[212:215]
    v_mfma_f32_16x16x32_bf16 v[216:219], v[72:75], v[52:55], v[216:219]
    v_mfma_f32_16x16x32_bf16 v[220:223], v[76:79], v[52:55], v[220:223]
    v_mfma_f32_16x16x32_bf16 v[224:227], v[64:67], v[56:59], v[224:227]
    v_mfma_f32_16x16x32_bf16 v[228:231], v[68:71], v[56:59], v[228:231]
    v_mfma_f32_16x16x32_bf16 v[232:235], v[72:75], v[56:59], v[232:235]
    v_mfma_f32_16x16x32_bf16 v[236:239], v[76:79], v[56:59], v[236:239]
    v_mfma_f32_16x16x32_bf16 v[240:243], v[64:67], v[60:63], v[240:243]
    v_mfma_f32_16x16x32_bf16 v[244:247], v[68:71], v[60:63], v[244:247]
    v_mfma_f32_16x16x32_bf16 v[248:251], v[72:75], v[60:63], v[248:251]
    v_mfma_f32_16x16x32_bf16 v[252:255], v[76:79], v[60:63], v[252:255]
    s_waitcnt lgkmcnt(0)
    s_waitcnt vmcnt(8)
    s_barrier
    v_mfma_f32_16x16x32_bf16 v[128:131], v[112:115], v[80:83], v[128:131]
    s_add_u32 m0, s21, 98304
    s_nop 0
    buffer_load_dwordx4 v1, s[4:7], s16 offen sc1 lds
    s_add_u32 s16, s16, s62
    v_mfma_f32_16x16x32_bf16 v[132:135], v[116:119], v[80:83], v[132:135]
    ds_read_b64_tr_b16 v[64:65], v8 offset:16384
    v_mfma_f32_16x16x32_bf16 v[136:139], v[120:123], v[80:83], v[136:139]
    ds_read_b64_tr_b16 v[66:67], v9 offset:16384
    v_mfma_f32_16x16x32_bf16 v[140:143], v[124:127], v[80:83], v[140:143]
    ds_read_b64_tr_b16 v[68:69], v10 offset:16384
    v_mfma_f32_16x16x32_bf16 v[144:147], v[112:115], v[84:87], v[144:147]
    s_add_u32 m0, s21, 99328
    s_nop 0
    buffer_load_dwordx4 v1, s[4:7], s17 offen sc1 lds
    s_add_u32 s17, s17, s62
    v_mfma_f32_16x16x32_bf16 v[148:151], v[116:119], v[84:87], v[148:151]
    ds_read_b64_tr_b16 v[70:71], v11 offset:16384
    v_mfma_f32_16x16x32_bf16 v[152:155], v[120:123], v[84:87], v[152:155]
    ds_read_b64_tr_b16 v[72:73], v8 offset:24576
    v_mfma_f32_16x16x32_bf16 v[156:159], v[124:127], v[84:87], v[156:159]
    ds_read_b64_tr_b16 v[74:75], v9 offset:24576
    v_mfma_f32_16x16x32_bf16 v[160:163], v[112:115], v[88:91], v[160:163]
    s_add_u32 m0, s22, 98304
    s_nop 0
    buffer_load_dwordx4 v2, s[8:11], s18 offen lds
    s_add_u32 s18, s18, s20
    v_mfma_f32_16x16x32_bf16 v[164:167], v[116:119], v[88:91], v[164:167]
    ds_read_b64_tr_b16 v[76:77], v10 offset:24576
    v_mfma_f32_16x16x32_bf16 v[168:171], v[120:123], v[88:91], v[168:171]
    ds_read_b64_tr_b16 v[78:79], v11 offset:24576
    v_mfma_f32_16x16x32_bf16 v[172:175], v[124:127], v[88:91], v[172:175]
    ds_read_b128 v[32:35], v5 offset:0
    v_mfma_f32_16x16x32_bf16 v[176:179], v[112:115], v[92:95], v[176:179]
    s_add_u32 m0, s22, 106496
    s_nop 0
    buffer_load_dwordx4 v2, s[12:15], s19 offen lds
    s_add_u32 s19, s19, s20
    v_mfma_f32_16x16x32_bf16 v[180:183], v[116:119], v[92:95], v[180:183]
    ds_read_b128 v[36:39], v5 offset:1024
    v_mfma_f32_16x16x32_bf16 v[184:187], v[120:123], v[92:95], v[184:187]
    ds_read_b128 v[40:43], v5 offset:2048
    v_mfma_f32_16x16x32_bf16 v[188:191], v[124:127], v[92:95], v[188:191]
    ds_read_b128 v[44:47], v5 offset:3072
    v_mfma_f32_16x16x32_bf16 v[192:195], v[112:115], v[96:99], v[192:195]
    ds_read_b128 v[48:51], v5 offset:4096
    v_mfma_f32_16x16x32_bf16 v[196:199], v[116:119], v[96:99], v[196:199]
    ds_read_b128 v[52:55], v5 offset:5120
    v_mfma_f32_16x16x32_bf16 v[200:203], v[120:123], v[96:99], v[200:203]
    ds_read_b128 v[56:59], v5 offset:6144
    v_mfma_f32_16x16x32_bf16 v[204:207], v[124:127], v[96:99], v[204:207]
    ds_read_b128 v[60:63], v5 offset:7168
    v_mfma_f32_16x16x32_bf16 v[208:211], v[112:115], v[100:103], v[208:211]
    v_mfma_f32_16x16x32_bf16 v[212:215], v[116:119], v[100:103], v[212:215]
    v_mfma_f32_16x16x32_bf16 v[216:219], v[120:123], v[100:103], v[216:219]
    v_mfma_f32_16x16x32_bf16 v[220:223], v[124:127], v[100:103], v[220:223]
    v_mfma_f32_16x16x32_bf16 v[224:227], v[112:115], v[104:107], v[224:227]
    v_mfma_f32_16x16x32_bf16 v[228:231], v[116:119], v[104:107], v[228:231]
    v_mfma_f32_16x16x32_bf16 v[232:235], v[120:123], v[104:107], v[232:235]
    v_mfma_f32_16x16x32_bf16 v[236:239], v[124:127], v[104:107], v[236:239]
    v_mfma_f32_16x16x32_bf16 v[240:243], v[112:115], v[108:111], v[240:243]
    v_mfma_f32_16x16x32_bf16 v[244:247], v[116:119], v[108:111], v[244:247]
    v_mfma_f32_16x16x32_bf16 v[248:251], v[120:123], v[108:111], v[248:251]
    v_mfma_f32_16x16x32_bf16 v[252:255], v[124:127], v[108:111], v[252:255]
    s_waitcnt lgkmcnt(0)
    s_sub_u32 s23, s23, 1
    s_cmp_lg_u32 s23, 0
    s_cbranch_scc1 w_loop
    v_mov_b32 v20, 131072
    ds_read_b128 v[24:27], v20
    ds_read_b128 v[28:31], v20 offset:16
    s_cmp_eq_u32 s48, 2
    s_cbranch_scc1 w_epi_glu
    s_lshl_b32 s30, s27, 10
    s_add_u32 s30, s30, s49
    s_nop 7
    v_cvt_pk_bf16_f32 v80, v128, v129
    v_cvt_pk_bf16_f32 v81, v130, v131
    v_cvt_pk_bf16_f32 v82, v132, v133
    v_cvt_pk_bf16_f32 v83, v134, v135
    buffer_store_dwordx4 v[80:83], v1, s[4:7], s30 offen sc1
    v_cvt_pk_bf16_f32 v84, v136, v137
    v_cvt_pk_bf16_f32 v85, v138, v139
    v_cvt_pk_bf16_f32 v86, v140, v141
    v_cvt_pk_bf16_f32 v87, v142, v143
    buffer_store_dwordx4 v[84:87], v19, s[4:7], s30 offen sc1
    s_add_u32 s30, s30, s50
    v_cvt_pk_bf16_f32 v88, v144, v145
    v_cvt_pk_bf16_f32 v89, v146, v147
    v_cvt_pk_bf16_f32 v90, v148, v149
    v_cvt_pk_bf16_f32 v91, v150, v151
    buffer_store_dwordx4 v[88:91], v1, s[4:7], s30 offen sc1
    v_cvt_pk_bf16_f32 v92, v152, v153
    v_cvt_pk_bf16_f32 v93, v154, v155
    v_cvt_pk_bf16_f32 v94, v156, v157
    v_cvt_pk_bf16_f32 v95, v158, v159
    buffer_store_dwordx4 v[92:95], v19, s[4:7], s30 offen sc1
    s_add_u32 s30, s30, s50
    v_cvt_pk_bf16_f32 v80, v160, v161
    v_cvt_pk_bf16_f32 v81, v162, v163
    v_cvt_pk_bf16_f32 v82, v164, v165
    v_cvt_pk_bf16_f32 v83, v166, v167
    buffer_store_dwordx4 v[80:83], v1, s[4:7], s30 offen sc1
    v_cvt_pk_bf16_f32 v84, v168, v169
    v_cvt_pk_bf16_f32 v85, v170, v171
    v_cvt_pk_bf16_f32 v86, v172, v173
    v_cvt_pk_bf16_f32 v87, v174, v175
    buffer_store_dwordx4 v[84:87], v19, s[4:7], s30 offen sc1
    s_add_u32 s30, s30, s50
    v_cvt_pk_bf16_f32 v88, v176, v177
    v_cvt_pk_bf16_f32 v89, v178, v179
    v_cvt_pk_bf16_f32 v90, v180, v181
    v_cvt_pk_bf16_f32 v91, v182, v183
    buffer_store_dwordx4 v[88:91], v1, s[4:7], s30 offen sc1
    v_cvt_pk_bf16_f32 v92, v184, v185
    v_cvt_pk_bf16_f32 v93, v186, v187
    v_cvt_pk_bf16_f32 v94, v188, v189
    v_cvt_pk_bf16_f32 v95, v190, v191
    buffer_store_dwordx4 v[92:95], v19, s[4:7], s30 offen sc1
    s_add_u32 s30, s30, s50
    v_cvt_pk_bf16_f32 v80, v192, v193
    v_cvt_pk_bf16_f32 v81, v194, v195
    v_cvt_pk_bf16_f32 v82, v196, v197
    v_cvt_pk_bf16_f32 v83, v198, v199
    buffer_store_dwordx4 v[80:83], v1, s[4:7], s30 offen sc1
    v_cvt_pk_bf16_f32 v84, v200, v201
    v_cvt_pk_bf16_f32 v85, v202, v203
    v_cvt_pk_bf16_f32 v86, v204, v205
    v_cvt_pk_bf16_f32 v87, v206, v207
    buffer_store_dwordx4 v[84:87], v19, s[4:7], s30 offen sc1
    s_add_u32 s30, s30, s50
    v_cvt_pk_bf16_f32 v88, v208, v209
    v_cvt_pk_bf16_f32 v89, v210, v211
    v_cvt_pk_bf16_f32 v90, v212, v213
    v_cvt_pk_bf16_f32 v91, v214, v215
    buffer_store_dwordx4 v[88:91], v1, s[4:7], s30 offen sc1
    v_cvt_pk_bf16_f32 v92, v216, v217
    v_cvt_pk_bf16_f32 v93, v218, v219
    v_cvt_pk_bf16_f32 v94, v220, v221
    v_cvt_pk_bf16_f32 v95, v222, v223
    buffer_store_dwordx4 v[92:95], v19, s[4:7], s30 offen sc1
    s_add_u32 s30, s30, s50
    v_cvt_pk_bf16_f32 v80, v224, v225
    v_cvt_pk_bf16_f32 v81, v226, v227
    v_cvt_pk_bf16_f32 v82, v228, v229
    v_cvt_pk_bf16_f32 v83, v230, v231
    buffer_store_dwordx4 v[80:83], v1, s[4:7], s30 offen sc1
    v_cvt_pk_bf16_f32 v84, v232, v233
    v_cvt_pk_bf16_f32 v85, v234, v235
    v_cvt_pk_bf16_f32 v86, v236, v237
    v_cvt_pk_bf16_f32 v87, v238, v239
    buffer_store_dwordx4 v[84:87], v19, s[4:7], s30 offen sc1
    s_add_u32 s30, s30, s50
    v_cvt_pk_bf16_f32 v88, v240, v241
    v_cvt_pk_bf16_f32 v89, v242, v243
    v_cvt_pk_bf16_f32 v90, v244, v245
    v_cvt_pk_bf16_f32 v91, v246, v247
    buffer_store_dwordx4 v[88:91], v1, s[4:7], s30 offen sc1
    v_cvt_pk_bf16_f32 v92, v248, v249
    v_cvt_pk_bf16_f32 v93, v250, v251
    v_cvt_pk_bf16_f32 v94, v252, v253
    v_cvt_pk_bf16_f32 v95, v254, v255
    buffer_store_dwordx4 v[92:95], v19, s[4:7], s30 offen sc1
    s_waitcnt lgkmcnt(0)
    v_or3_b32 v24, v24, v25, v26
    v_or3_b32 v28, v28, v29, v30
    v_or3_b32 v24, v24, v27, v31
    v_or_b32 v24, v24, v28
    s_mov_b32 s28, s51
    v_readfirstlane_b32 s30, v24
    s_cmp_lg_u32 s30, 0
    s_cbranch_scc1 w_drain
    s_mov_b32 s48, s32
    s_cmp_eq_u32 s32, 4
    s_cselect_b32 s30, 2, 3
    s_lshl_b32 s30, s26, s30
    s_mul_i32 s30, s30, s43
    s_add_u32 s49, s42, s30
    s_mov_b32 s50, s43
    s_mov_b32 s51, s46
    s_mov_b32 s23, s41
    s_branch w_first16
w_epi_glu:
    s_lshl_b32 s30, s27, 10
    s_add_u32 s30, s30, s49
    s_mov_b32 s54, 0xbfb8aa3b
    s_nop 7
    v_cvt_pk_bf16_f32 v80, v128, v129
    v_cvt_pk_bf16_f32 v81, v130, v131
    v_cvt_pk_bf16_f32 v82, v132, v133
    v_cvt_pk_bf16_f32 v83, v134, v135
    v_lshlrev_b32 v96, 16, v80
    v_and_b32 v97, 0xffff0000, v80
    v_lshlrev_b32 v98, 16, v81
    v_and_b32 v99, 0xffff0000, v81
    v_lshlrev_b32 v100, 16, v82
    v_and_b32 v101, 0xffff0000, v82
    v_lshlrev_b32 v102, 16, v83
    v_and_b32 v103, 0xffff0000, v83
    v_mul_f32 v96, s54, v96
    v_mul_f32 v97, s54, v97
    v_mul_f32 v98, s54, v98
    v_mul_f32 v99, s54, v99
    v_mul_f32 v100, s54, v100
    v_mul_f32 v101, s54, v101
    v_mul_f32 v102, s54, v102
    v_mul_f32 v103, s54, v103
    v_exp_f32 v96, v96
    v_exp_f32 v97, v97
    v_exp_f32 v98, v98
    v_exp_f32 v99, v99
    v_exp_f32 v100, v100
    v_exp_f32 v101, v101
    v_exp_f32 v102, v102
    v_exp_f32 v103, v103
    v_add_f32 v96, 1.0, v96
    v_add_f32 v97, 1.0, v97
    v_add_f32 v98, 1.0, v98
    v_add_f32 v99, 1.0, v99
    v_add_f32 v100, 1.0, v100
    v_add_f32 v101, 1.0, v101
    v_add_f32 v102, 1.0, v102
    v_add_f32 v103, 1.0, v103
    v_rcp_f32 v96, v96
    v_rcp_f32 v97, v97
    v_rcp_f32 v98, v98
    v_rcp_f32 v99, v99
    v_rcp_f32 v100, v100
    v_rcp_f32 v101, v101
    v_rcp_f32 v102, v102
    v_rcp_f32 v103, v103
    v_mul_f32 v96, v96, v136
    v_mul_f32 v97, v97, v137
    v_mul_f32 v98, v98, v138
    v_mul_f32 v99, v99, v139
    v_mul_f32 v100, v100, v140
    v_mul_f32 v101, v101, v141
    v_mul_f32 v102, v102, v142
    v_mul_f32 v103, v103, v143
    v_cvt_pk_bf16_f32 v80, v96, v97
    v_cvt_pk_bf16_f32 v81, v98, v99
    v_cvt_pk_bf16_f32 v82, v100, v101
    v_cvt_pk_bf16_f32 v83, v102, v103
    buffer_store_dwordx4 v[80:83], v1, s[4:7], s30 offen sc1
    s_add_u32 s30, s30, s50
    v_cvt_pk_bf16_f32 v84, v144, v145
    v_cvt_pk_bf16_f32 v85, v146, v147
    v_cvt_pk_bf16_f32 v86, v148, v149
    v_cvt_pk_bf16_f32 v87, v150, v151
    v_lshlrev_b32 v104, 16, v84
    v_and_b32 v105, 0xffff0000, v84
    v_lshlrev_b32 v106, 16, v85
    v_and_b32 v107, 0xffff0000, v85
    v_lshlrev_b32 v108, 16, v86
    v_and_b32 v109, 0xffff0000, v86
    v_lshlrev_b32 v110, 16, v87
    v_and_b32 v111, 0xffff0000, v87
    v_mul_f32 v104, s54, v104
    v_mul_f32 v105, s54, v105
    v_mul_f32 v106, s54, v106
    v_mul_f32 v107, s54, v107
    v_mul_f32 v108, s54, v108
    v_mul_f32 v109, s54, v109
    v_mul_f32 v110, s54, v110
    v_mul_f32 v111, s54, v111
    v_exp_f32 v104, v104
    v_exp_f32 v105, v105
    v_exp_f32 v106, v106
    v_exp_f32 v107, v107
    v_exp_f32 v108, v108
    v_exp_f32 v109, v109
    v_exp_f32 v110, v110
    v_exp_f32 v111, v111
    v_add_f32 v104, 1.0, v104
    v_add_f32 v105, 1.0, v105
    v_add_f32 v106, 1.0, v106
    v_add_f32 v107, 1.0, v107
    v_add_f32 v108, 1.0, v108
    v_add_f32 v109, 1.0, v109
    v_add_f32 v110, 1.0, v110
    v_add_f32 v111, 1.0, v111
    v_rcp_f32 v104, v104
    v_rcp_f32 v105, v105
    v_rcp_f32 v106, v106
    v_rcp_f32 v107, v107
    v_rcp_f32 v108, v108
    v_rcp_f32 v109, v109
    v_rcp_f32 v110, v110
    v_rcp_f32 v111, v111
    v_mul_f32 v104, v104, v152
    v_mul_f32 v105, v105, v153
    v_mul_f32 v106, v106, v154
    v_mul_f32 v107, v107, v155
    v_mul_f32 v108, v108, v156
    v_mul_f32 v109, v109, v157
    v_mul_f32 v110, v110, v158
    v_mul_f32 v111, v111, v159
    v_cvt_pk_bf16_f32 v84, v104, v105
    v_cvt_pk_bf16_f32 v85, v106, v107
    v_cvt_pk_bf16_f32 v86, v108, v109
    v_cvt_pk_bf16_f32 v87, v110, v111
    buffer_store_dwordx4 v[84:87], v1, s[4:7], s30 offen sc1
    s_add_u32 s30, s30, s50
    v_cvt_pk_bf16_f32 v88, v160, v161
    v_cvt_pk_bf16_f32 v89, v162, v163
    v_cvt_pk_bf16_f32 v90, v164, v165
    v_cvt_pk_bf16_f32 v91, v166, v167
    v_lshlrev_b32 v96, 16, v88
    v_and_b32 v97, 0xffff0000, v88
    v_lshlrev_b32 v98, 16, v89
    v_and_b32 v99, 0xffff0000, v89
    v_lshlrev_b32 v100, 16, v90
    v_and_b32 v101, 0xffff0000, v90
    v_lshlrev_b32 v102, 16, v91
    v_and_b32 v103, 0xffff0000, v91
    v_mul_f32 v96, s54, v96
    v_mul_f32 v97, s54, v97
    v_mul_f32 v98, s54, v98
    v_mul_f32 v99, s54, v99
    v_mul_f32 v100, s54, v100
    v_mul_f32 v101, s54, v101
    v_mul_f32 v102, s54, v102
    v_mul_f32 v103, s54, v103
    v_exp_f32 v96, v96
    v_exp_f32 v97, v97
    v_exp_f32 v98, v98
    v_exp_f32 v99, v99
    v_exp_f32 v100, v100
    v_exp_f32 v101, v101
    v_exp_f32 v102, v102
    v_exp_f32 v103, v103
    v_add_f32 v96, 1.0, v96
    v_add_f32 v97, 1.0, v97
    v_add_f32 v98, 1.0, v98
    v_add_f32 v99, 1.0, v99
    v_add_f32 v100, 1.0, v100
    v_add_f32 v101, 1.0, v101
    v_add_f32 v102, 1.0, v102
    v_add_f32 v103, 1.0, v103
    v_rcp_f32 v96, v96
    v_rcp_f32 v97, v97
    v_rcp_f32 v98, v98
    v_rcp_f32 v99, v99
    v_rcp_f32 v100, v100
    v_rcp_f32 v101, v101
    v_rcp_f32 v102, v102
    v_rcp_f32 v103, v103
    v_mul_f32 v96, v96, v168
    v_mul_f32 v97, v97, v169
    v_mul_f32 v98, v98, v170
    v_mul_f32 v99, v99, v171
    v_mul_f32 v100, v100, v172
    v_mul_f32 v101, v101, v173
    v_mul_f32 v102, v102, v174
    v_mul_f32 v103, v103, v175
    v_cvt_pk_bf16_f32 v88, v96, v97
    v_cvt_pk_bf16_f32 v89, v98, v99
    v_cvt_pk_bf16_f32 v90, v100, v101
    v_cvt_pk_bf16_f32 v91, v102, v103
    buffer_store_dwordx4 v[88:91], v1, s[4:7], s30 offen sc1
    s_add_u32 s30, s30, s50
    v_cvt_pk_bf16_f32 v92, v176, v177
    v_cvt_pk_bf16_f32 v93, v178, v179
    v_cvt_pk_bf16_f32 v94, v180, v181
    v_cvt_pk_bf16_f32 v95, v182, v183
    v_lshlrev_b32 v104, 16, v92
    v_and_b32 v105, 0xffff0000, v92
    v_lshlrev_b32 v106, 16, v93
    v_and_b32 v107, 0xffff0000, v93
    v_lshlrev_b32 v108, 16, v94
    v_and_b32 v109, 0xffff0000, v94
    v_lshlrev_b32 v110, 16, v95
    v_and_b32 v111, 0xffff0000, v95
    v_mul_f32 v104, s54, v104
    v_mul_f32 v105, s54, v105
    v_mul_f32 v106, s54, v106
    v_mul_f32 v107, s54, v107
    v_mul_f32 v108, s54, v108
    v_mul_f32 v109, s54, v109
    v_mul_f32 v110, s54, v110
    v_mul_f32 v111, s54, v111
    v_exp_f32 v104, v104
    v_exp_f32 v105, v105
    v_exp_f32 v106, v106
    v_exp_f32 v107, v107
    v_exp_f32 v108, v108
    v_exp_f32 v109, v109
    v_exp_f32 v110, v110
    v_exp_f32 v111, v111
    v_add_f32 v104, 1.0, v104
    v_add_f32 v105, 1.0, v105
    v_add_f32 v106, 1.0, v106
    v_add_f32 v107, 1.0, v107
    v_add_f32 v108, 1.0, v108
    v_add_f32 v109, 1.0, v109
    v_add_f32 v110, 1.0, v110
    v_add_f32 v111, 1.0, v111
    v_rcp_f32 v104, v104
    v_rcp_f32 v105, v105
    v_rcp_f32 v106, v106
    v_rcp_f32 v107, v107
    v_rcp_f32 v108, v108
    v_rcp_f32 v109, v109
    v_rcp_f32 v110, v110
    v_rcp_f32 v111, v111
    v_mul_f32 v104, v104, v184
    v_mul_f32 v105, v105, v185
    v_mul_f32 v106, v106, v186
    v_mul_f32 v107, v107, v187
    v_mul_f32 v108, v108, v188
    v_mul_f32 v109, v109, v189
    v_mul_f32 v110, v110, v190
    v_mul_f32 v111, v111, v191
    v_cvt_pk_bf16_f32 v92, v104, v105
    v_cvt_pk_bf16_f32 v93, v106, v107
    v_cvt_pk_bf16_f32 v94, v108, v109
    v_cvt_pk_bf16_f32 v95, v110, v111
    buffer_store_dwordx4 v[92:95], v1, s[4:7], s30 offen sc1
    s_add_u32 s30, s30, s50
    v_cvt_pk_bf16_f32 v80, v192, v193
    v_cvt_pk_bf16_f32 v81, v194, v195
    v_cvt_pk_bf16_f32 v82, v196, v197
    v_cvt_pk_bf16_f32 v83, v198, v199
    v_lshlrev_b32 v96, 16, v80
    v_and_b32 v97, 0xffff0000, v80
    v_lshlrev_b32 v98, 16, v81
    v_and_b32 v99, 0xffff0000, v81
    v_lshlrev_b32 v100, 16, v82
    v_and_b32 v101, 0xffff0000, v82
    v_lshlrev_b32 v102, 16, v83
    v_and_b32 v103, 0xffff0000, v83
    v_mul_f32 v96, s54, v96
    v_mul_f32 v97, s54, v97
    v_mul_f32 v98, s54, v98
    v_mul_f32 v99, s54, v99
    v_mul_f32 v100, s54, v100
    v_mul_f32 v101, s54, v101
    v_mul_f32 v102, s54, v102
    v_mul_f32 v103, s54, v103
    v_exp_f32 v96, v96
    v_exp_f32 v97, v97
    v_exp_f32 v98, v98
    v_exp_f32 v99, v99
    v_exp_f32 v100, v100
    v_exp_f32 v101, v101
    v_exp_f32 v102, v102
    v_exp_f32 v103, v103
    v_add_f32 v96, 1.0, v96
    v_add_f32 v97, 1.0, v97
    v_add_f32 v98, 1.0, v98
    v_add_f32 v99, 1.0, v99
    v_add_f32 v100, 1.0, v100
    v_add_f32 v101, 1.0, v101
    v_add_f32 v102, 1.0, v102
    v_add_f32 v103, 1.0, v103
    v_rcp_f32 v96, v96
    v_rcp_f32 v97, v97
    v_rcp_f32 v98, v98
    v_rcp_f32 v99, v99
    v_rcp_f32 v100, v100
    v_rcp_f32 v101, v101
    v_rcp_f32 v102, v102
    v_rcp_f32 v103, v103
    v_mul_f32 v96, v96, v200
    v_mul_f32 v97, v97, v201
    v_mul_f32 v98, v98, v202
    v_mul_f32 v99, v99, v203
    v_mul_f32 v100, v100, v204
    v_mul_f32 v101, v101, v205
    v_mul_f32 v102, v102, v206
    v_mul_f32 v103, v103, v207
    v_cvt_pk_bf16_f32 v80, v96, v97
    v_cvt_pk_bf16_f32 v81, v98, v99
    v_cvt_pk_bf16_f32 v82, v100, v101
    v_cvt_pk_bf16_f32 v83, v102, v103
    buffer_store_dwordx4 v[80:83], v1, s[4:7], s30 offen sc1
    s_add_u32 s30, s30, s50
    v_cvt_pk_bf16_f32 v84, v208, v209
    v_cvt_pk_bf16_f32 v85, v210, v211
    v_cvt_pk_bf16_f32 v86, v212, v213
    v_cvt_pk_bf16_f32 v87, v214, v215
    v_lshlrev_b32 v104, 16, v84
    v_and_b32 v105, 0xffff0000, v84
    v_lshlrev_b32 v106, 16, v85
    v_and_b32 v107, 0xffff0000, v85
    v_lshlrev_b32 v108, 16, v86
    v_and_b32 v109, 0xffff0000, v86
    v_lshlrev_b32 v110, 16, v87
    v_and_b32 v111, 0xffff0000, v87
    v_mul_f32 v104, s54, v104
    v_mul_f32 v105, s54, v105
    v_mul_f32 v106, s54, v106
    v_mul_f32 v107, s54, v107
    v_mul_f32 v108, s54, v108
    v_mul_f32 v109, s54, v109
    v_mul_f32 v110, s54, v110
    v_mul_f32 v111, s54, v111
    v_exp_f32 v104, v104
    v_exp_f32 v105, v105
    v_exp_f32 v106, v106
    v_exp_f32 v107, v107
    v_exp_f32 v108, v108
    v_exp_f32 v109, v109
    v_exp_f32 v110, v110
    v_exp_f32 v111, v111
    v_add_f32 v104, 1.0, v104
    v_add_f32 v105, 1.0, v105
    v_add_f32 v106, 1.0, v106
    v_add_f32 v107, 1.0, v107
    v_add_f32 v108, 1.0, v108
    v_add_f32 v109, 1.0, v109
    v_add_f32 v110, 1.0, v110
    v_add_f32 v111, 1.0, v111
    v_rcp_f32 v104, v104
    v_rcp_f32 v105, v105
    v_rcp_f32 v106, v106
    v_rcp_f32 v107, v107
    v_rcp_f32 v108, v108
    v_rcp_f32 v109, v109
    v_rcp_f32 v110, v110
    v_rcp_f32 v111, v111
    v_mul_f32 v104, v104, v216
    v_mul_f32 v105, v105, v217
    v_mul_f32 v106, v106, v218
    v_mul_f32 v107, v107, v219
    v_mul_f32 v108, v108, v220
    v_mul_f32 v109, v109, v221
    v_mul_f32 v110, v110, v222
    v_mul_f32 v111, v111, v223
    v_cvt_pk_bf16_f32 v84, v104, v105
    v_cvt_pk_bf16_f32 v85, v106, v107
    v_cvt_pk_bf16_f32 v86, v108, v109
    v_cvt_pk_bf16_f32 v87, v110, v111
    buffer_store_dwordx4 v[84:87], v1, s[4:7], s30 offen sc1
    s_add_u32 s30, s30, s50
    v_cvt_pk_bf16_f32 v88, v224, v225
    v_cvt_pk_bf16_f32 v89, v226, v227
    v_cvt_pk_bf16_f32 v90, v228, v229
    v_cvt_pk_bf16_f32 v91, v230, v231
    v_lshlrev_b32 v96, 16, v88
    v_and_b32 v97, 0xffff0000, v88
    v_lshlrev_b32 v98, 16, v89
    v_and_b32 v99, 0xffff0000, v89
    v_lshlrev_b32 v100, 16, v90
    v_and_b32 v101, 0xffff0000, v90
    v_lshlrev_b32 v102, 16, v91
    v_and_b32 v103, 0xffff0000, v91
    v_mul_f32 v96, s54, v96
    v_mul_f32 v97, s54, v97
    v_mul_f32 v98, s54, v98
    v_mul_f32 v99, s54, v99
    v_mul_f32 v100, s54, v100
    v_mul_f32 v101, s54, v101
    v_mul_f32 v102, s54, v102
    v_mul_f32 v103, s54, v103
    v_exp_f32 v96, v96
    v_exp_f32 v97, v97
    v_exp_f32 v98, v98
    v_exp_f32 v99, v99
    v_exp_f32 v100, v100
    v_exp_f32 v101, v101
    v_exp_f32 v102, v102
    v_exp_f32 v103, v103
    v_add_f32 v96, 1.0, v96
    v_add_f32 v97, 1.0, v97
    v_add_f32 v98, 1.0, v98
    v_add_f32 v99, 1.0, v99
    v_add_f32 v100, 1.0, v100
    v_add_f32 v101, 1.0, v101
    v_add_f32 v102, 1.0, v102
    v_add_f32 v103, 1.0, v103
    v_rcp_f32 v96, v96
    v_rcp_f32 v97, v97
    v_rcp_f32 v98, v98
    v_rcp_f32 v99, v99
    v_rcp_f32 v100, v100
    v_rcp_f32 v101, v101
    v_rcp_f32 v102, v102
    v_rcp_f32 v103, v103
    v_mul_f32 v96, v96, v232
    v_mul_f32 v97, v97, v233
    v_mul_f32 v98, v98, v234
    v_mul_f32 v99, v99, v235
    v_mul_f32 v100, v100, v236
    v_mul_f32 v101, v101, v237
    v_mul_f32 v102, v102, v238
    v_mul_f32 v103, v103, v239
    v_cvt_pk_bf16_f32 v88, v96, v97
    v_cvt_pk_bf16_f32 v89, v98, v99
    v_cvt_pk_bf16_f32 v90, v100, v101
    v_cvt_pk_bf16_f32 v91, v102, v103
    buffer_store_dwordx4 v[88:91], v1, s[4:7], s30 offen sc1
    s_add_u32 s30, s30, s50
    v_cvt_pk_bf16_f32 v92, v240, v241
    v_cvt_pk_bf16_f32 v93, v242, v243
    v_cvt_pk_bf16_f32 v94, v244, v245
    v_cvt_pk_bf16_f32 v95, v246, v247
    v_lshlrev_b32 v104, 16, v92
    v_and_b32 v105, 0xffff0000, v92
    v_lshlrev_b32 v106, 16, v93
    v_and_b32 v107, 0xffff0000, v93
    v_lshlrev_b32 v108, 16, v94
    v_and_b32 v109, 0xffff0000, v94
    v_lshlrev_b32 v110, 16, v95
    v_and_b32 v111, 0xffff0000, v95
    v_mul_f32 v104, s54, v104
    v_mul_f32 v105, s54, v105
    v_mul_f32 v106, s54, v106
    v_mul_f32 v107, s54, v107
    v_mul_f32 v108, s54, v108
    v_mul_f32 v109, s54, v109
    v_mul_f32 v110, s54, v110
    v_mul_f32 v111, s54, v111
    v_exp_f32 v104, v104
    v_exp_f32 v105, v105
    v_exp_f32 v106, v106
    v_exp_f32 v107, v107
    v_exp_f32 v108, v108
    v_exp_f32 v109, v109
    v_exp_f32 v110, v110
    v_exp_f32 v111, v111
    v_add_f32 v104, 1.0, v104
    v_add_f32 v105, 1.0, v105
    v_add_f32 v106, 1.0, v106
    v_add_f32 v107, 1.0, v107
    v_add_f32 v108, 1.0, v108
    v_add_f32 v109, 1.0, v109
    v_add_f32 v110, 1.0, v110
    v_add_f32 v111, 1.0, v111
    v_rcp_f32 v104, v104
    v_rcp_f32 v105, v105
    v_rcp_f32 v106, v106
    v_rcp_f32 v107, v107
    v_rcp_f32 v108, v108
    v_rcp_f32 v109, v109
    v_rcp_f32 v110, v110
    v_rcp_f32 v111, v111
    v_mul_f32 v104, v104, v248
    v_mul_f32 v105, v105, v249
    v_mul_f32 v106, v106, v250
    v_mul_f32 v107, v107, v251
    v_mul_f32 v108, v108, v252
    v_mul_f32 v109, v109, v253
    v_mul_f32 v110, v110, v254
    v_mul_f32 v111, v111, v255
    v_cvt_pk_bf16_f32 v92, v104, v105
    v_cvt_pk_bf16_f32 v93, v106, v107
    v_cvt_pk_bf16_f32 v94, v108, v109
    v_cvt_pk_bf16_f32 v95, v110, v111
    buffer_store_dwordx4 v[92:95], v1, s[4:7], s30 offen sc1
    s_waitcnt lgkmcnt(0)
    v_or3_b32 v24, v24, v25, v26
    v_or3_b32 v28, v28, v29, v30
    v_or3_b32 v24, v24, v27, v31
    v_or_b32 v24, v24, v28
    s_mov_b32 s28, s51
    v_readfirstlane_b32 s30, v24
    s_cmp_lg_u32 s30, 0
    s_cbranch_scc1 w_drain
    s_mov_b32 s48, s32
    s_cmp_eq_u32 s32, 4
    s_cselect_b32 s30, 2, 3
    s_lshl_b32 s30, s26, s30
    s_mul_i32 s30, s30, s43
    s_add_u32 s49, s42, s30
    s_mov_b32 s50, s43
    s_mov_b32 s51, s46
    s_mov_b32 s23, s41
    s_branch w_first8
w_firstH:
    s_waitcnt vmcnt(8)
    s_barrier
    s_add_u32 m0, s21, 0
    s_nop 0
    buffer_load_dwordx4 v1, s[4:7], s16 offen sc1 lds
    s_add_u32 s16, s16, s62
    s_add_u32 m0, s21, 1024
    s_nop 0
    buffer_load_dwordx4 v1, s[4:7], s17 offen sc1 lds
    s_add_u32 s17, s17, s62
    s_add_u32 m0, s22, 0
    s_nop 0
    buffer_load_dwordx4 v2, s[8:11], s18 offen lds
    s_add_u32 s18, s18, s20
    s_add_u32 m0, s22, 8192
    s_nop 0
    buffer_load_dwordx4 v2, s[12:15], s19 offen lds
    s_add_u32 s19, s19, s20
    v_mfma_f32_16x16x32_bf16 v[128:131], v[64:67], v[32:35], 0
    ds_read_b64_tr_b16 v[112:113], v8 offset:49152
    v_mfma_f32_16x16x32_bf16 v[132:135], v[68:71], v[32:35], 0
    ds_read_b64_tr_b16 v[114:115], v9 offset:49152
    v_mfma_f32_16x16x32_bf16 v[144:147], v[64:67], v[40:43], 0
    ds_read_b64_tr_b16 v[116:117], v10 offset:49152
    v_mfma_f32_16x16x32_bf16 v[148:151], v[68:71], v[40:43], 0
    ds_read_b64_tr_b16 v[118:119], v11 offset:49152
    v_mfma_f32_16x16x32_bf16 v[160:163], v[64:67], v[48:51], 0
    ds_read_b64_tr_b16 v[120:121], v8 offset:57344
    v_mfma_f32_16x16x32_bf16 v[164:167], v[68:71], v[48:51], 0
    ds_read_b64_tr_b16 v[122:123], v9 offset:57344
    v_mfma_f32_16x16x32_bf16 v[176:179], v[64:67], v[56:59], 0
    ds_read_b64_tr_b16 v[124:125], v10 offset:57344
    v_mfma_f32_16x16x32_bf16 v[180:183], v[68:71], v[56:59], 0
    ds_read_b64_tr_b16 v[126:127], v11 offset:57344
    v_mfma_f32_16x16x32_bf16 v[128:131], v[72:75], v[36:39], v[128:131]
    ds_read_b128 v[80:83], v5 offset:32768
    v_mfma_f32_16x16x32_bf16 v[132:135], v[76:79], v[36:39], v[132:135]
    ds_read_b128 v[84:87], v5 offset:33792
    v_mfma_f32_16x16x32_bf16 v[144:147], v[72:75], v[44:47], v[144:147]
    ds_read_b128 v[88:91], v5 offset:34816
    v_mfma_f32_16x16x32_bf16 v[148:151], v[76:79], v[44:47], v[148:151]
    ds_read_b128 v[92:95], v5 offset:35840
    v_mfma_f32_16x16x32_bf16 v[160:163], v[72:75], v[52:55], v[160:163]
    ds_read_b128 v[96:99], v5 offset:36864
    v_mfma_f32_16x16x32_bf16 v[164:167], v[76:79], v[52:55], v[164:167]
    ds_read_b128 v[100:103], v5 offset:37888
    v_mfma_f32_16x16x32_bf16 v[176:179], v[72:75], v[60:63], v[176:179]
    ds_read_b128 v[104:107], v5 offset:38912
    v_mfma_f32_16x16x32_bf16 v[180:183], v[76:79], v[60:63], v[180:183]
    ds_read_b128 v[108:111], v5 offset:39936
    s_waitcnt lgkmcnt(0)
    s_waitcnt vmcnt(8)
    s_barrier
    s_add_u32 m0, s21, 32768
    s_nop 0
    buffer_load_dwordx4 v1, s[4:7], s16 offen sc1 lds
    s_add_u32 s16, s16, s62
    s_add_u32 m0, s21, 33792
    s_nop 0
    buffer_load_dwordx4 v1, s[4:7], s17 offen sc1 lds
    s_add_u32 s17, s17, s62
    s_add_u32 m0, s22, 32768
    s_nop 0
    buffer_load_dwordx4 v2, s[8:11], s18 offen lds
    s_add_u32 s18, s18, s20
    s_add_u32 m0, s22, 40960
    s_nop 0
    buffer_load_dwordx4 v2, s[12:15], s19 offen lds
    s_add_u32 s19, s19, s20
    v_mfma_f32_16x16x32_bf16 v[128:131], v[112:115], v[80:83], v[128:131]
    ds_read_b64_tr_b16 v[64:65], v12 offset:16384
    v_mfma_f32_16x16x32_bf16 v[132:135], v[116:119], v[80:83], v[132:135]
    ds_read_b64_tr_b16 v[66:67], v13 offset:16384
    v_mfma_f32_16x16x32_bf16 v[144:147], v[112:115], v[88:91], v[144:147]
    ds_read_b64_tr_b16 v[68:69], v14 offset:16384
    v_mfma_f32_16x16x32_bf16 v[148:151], v[116:119], v[88:91], v[148:151]
    ds_read_b64_tr_b16 v[70:71], v15 offset:16384
    v_mfma_f32_16x16x32_bf16 v[160:163], v[112:115], v[96:99], v[160:163]
    ds_read_b64_tr_b16 v[72:73], v12 offset:24576
    v_mfma_f32_16x16x32_bf16 v[164:167], v[116:119], v[96:99], v[164:167]
    ds_read_b64_tr_b16 v[74:75], v13 offset:24576
    v_mfma_f32_16x16x32_bf16 v[176:179], v[112:115], v[104:107], v[176:179]
    ds_read_b64_tr_b16 v[76:77], v14 offset:24576
    v_mfma_f32_16x16x32_bf16 v[180:183], v[116:119], v[104:107], v[180:183]
    ds_read_b64_tr_b16 v[78:79], v15 offset:24576
    v_mfma_f32_16x16x32_bf16 v[128:131], v[120:123], v[84:87], v[128:131]
    ds_read_b128 v[32:35], v6 offset:0
    v_mfma_f32_16x16x32_bf16 v[132:135], v[124:127], v[84:87], v[132:135]
    ds_read_b128 v[36:39], v6 offset:1024
    v_mfma_f32_16x16x32_bf16 v[144:147], v[120:123], v[92:95], v[144:147]
    ds_read_b128 v[40:43], v6 offset:2048
    v_mfma_f32_16x16x32_bf16 v[148:151], v[124:127], v[92:95], v[148:151]
    ds_read_b128 v[44:47], v6 offset:3072
    v_mfma_f32_16x16x32_bf16 v[160:163], v[120:123], v[100:103], v[160:163]
    ds_read_b128 v[48:51], v6 offset:4096
    v_mfma_f32_16x16x32_bf16 v[164:167], v[124:127], v[100:103], v[164:167]
    ds_read_b128 v[52:55], v6 offset:5120
    v_mfma_f32_16x16x32_bf16 v[176:179], v[120:123], v[108:111], v[176:179]
    ds_read_b128 v[56:59], v6 offset:6144
    v_mfma_f32_16x16x32_bf16 v[180:183], v[124:127], v[108:111], v[180:183]
    ds_read_b128 v[60:63], v6 offset:7168
    s_waitcnt lgkmcnt(0)
    s_waitcnt vmcnt(8)
    s_barrier
    s_add_u32 m0, s21, 65536
    s_nop 0
    buffer_load_dwordx4 v1, s[4:7], s16 offen sc1 lds
    s_add_u32 s16, s16, s62
    s_add_u32 m0, s21, 66560
    s_nop 0
    buffer_load_dwordx4 v1, s[4:7], s17 offen sc1 lds
    s_add_u32 s17, s17, s62
    s_add_u32 m0, s22, 65536
    s_nop 0
    buffer_load_dwordx4 v2, s[8:11], s18 offen lds
    s_add_u32 s18, s18, s20
    s_add_u32 m0, s22, 73728
    s_nop 0
    buffer_load_dwordx4 v2, s[12:15], s19 offen lds
    s_add_u32 s19, s19, s20
    v_mfma_f32_16x16x32_bf16 v[128:131], v[64:67], v[32:35], v[128:131]
    ds_read_b64_tr_b16 v[112:113], v12 offset:49152
    v_mfma_f32_16x16x32_bf16 v[132:135], v[68:71], v[32:35], v[132:135]
    ds_read_b64_tr_b16 v[114:115], v13 offset:49152
    v_mfma_f32_16x16x32_bf16 v[144:147], v[64:67], v[40:43], v[144:147]
    ds_read_b64_tr_b16 v[116:117], v14 offset:49152
    v_mfma_f32_16x16x32_bf16 v[148:151], v[68:71], v[40:43], v[148:151]
    ds_read_b64_tr_b16 v[118:119], v15 offset:49152
    v_mfma_f32_16x16x32_bf16 v[160:163], v[64:67], v[48:51], v[160:163]
    ds_read_b64_tr_b16 v[120:121], v12 offset:57344
    v_mfma_f32_16x16x32_bf16 v[164:167], v[68:71], v[48:51], v[164:167]
    ds_read_b64_tr_b16 v[122:123], v13 offset:57344
    v_mfma_f32_16x16x32_bf16 v[176:179], v[64:67], v[56:59], v[176:179]
    ds_read_b64_tr_b16 v[124:125], v14 offset:57344
    v_mfma_f32_16x16x32_bf16 v[180:183], v[68:71], v[56:59], v[180:183]
    ds_read_b64_tr_b16 v[126:127], v15 offset:57344
    v_mfma_f32_16x16x32_bf16 v[128:131], v[72:75], v[36:39], v[128:131]
    ds_read_b128 v[80:83], v6 offset:32768
    v_mfma_f32_16x16x32_bf16 v[132:135], v[76:79], v[36:39], v[132:135]
    ds_read_b128 v[84:87], v6 offset:33792
    v_mfma_f32_16x16x32_bf16 v[144:147], v[72:75], v[44:47], v[144:147]
    ds_read_b128 v[88:91], v6 offset:34816
    v_mfma_f32_16x16x32_bf16 v[148:151], v[76:79], v[44:47], v[148:151]
    ds_read_b128 v[92:95], v6 offset:35840
    v_mfma_f32_16x16x32_bf16 v[160:163], v[72:75], v[52:55], v[160:163]
    ds_read_b128 v[96:99], v6 offset:36864
    v_mfma_f32_16x16x32_bf16 v[164:167], v[76:79], v[52:55], v[164:167]
    ds_read_b128 v[100:103], v6 offset:37888
    v_mfma_f32_16x16x32_bf16 v[176:179], v[72:75], v[60:63], v[176:179]
    ds_read_b128 v[104:107], v6 offset:38912
    v_mfma_f32_16x16x32_bf16 v[180:183], v[76:79], v[60:63], v[180:183]
    ds_read_b128 v[108:111], v6 offset:39936
    s_waitcnt lgkmcnt(0)
    s_waitcnt vmcnt(8)
    s_barrier
    s_add_u32 m0, s21, 98304
    s_nop 0
    buffer_load_dwordx4 v1, s[4:7], s16 offen sc1 lds
    s_add_u32 s16, s16, s62
    s_add_u32 m0, s21, 99328
    s_nop 0
    buffer_load_dwordx4 v1, s[4:7], s17 offen sc1 lds
    s_add_u32 s17, s17, s62
    s_add_u32 m0, s22, 98304
    s_nop 0
    buffer_load_dwordx4 v2, s[8:11], s18 offen lds
    s_add_u32 s18, s18, s20
    s_add_u32 m0, s22, 106496
    s_nop 0
    buffer_load_dwordx4 v2, s[12:15], s19 offen lds
    s_add_u32 s19, s19, s20
    v_mfma_f32_16x16x32_bf16 v[128:131], v[112:115], v[80:83], v[128:131]
    ds_read_b64_tr_b16 v[64:65], v8 offset:16384
    v_mfma_f32_16x16x32_bf16 v[132:135], v[116:119], v[80:83], v[132:135]
    ds_read_b64_tr_b16 v[66:67], v9 offset:16384
    v_mfma_f32_16x16x32_bf16 v[144:147], v[112:115], v[88:91], v[144:147]
    ds_read_b64_tr_b16 v[68:69], v10 offset:16384
    v_mfma_f32_16x16x32_bf16 v[148:151], v[116:119], v[88:91], v[148:151]
    ds_read_b64_tr_b16 v[70:71], v11 offset:16384
    v_mfma_f32_16x16x32_bf16 v[160:163], v[112:115], v[96:99], v[160:163]
    ds_read_b64_tr_b16 v[72:73], v8 offset:24576
    v_mfma_f32_16x16x32_bf16 v[164:167], v[116:119], v[96:99], v[164:167]
    ds_read_b64_tr_b16 v[74:75], v9 offset:24576
    v_mfma_f32_16x16x32_bf16 v[176:179], v[112:115], v[104:107], v[176:179]
    ds_read_b64_tr_b16 v[76:77], v10 offset:24576
    v_mfma_f32_16x16x32_bf16 v[180:183], v[116:119], v[104:107], v[180:183]
    ds_read_b64_tr_b16 v[78:79], v11 offset:24576
    v_mfma_f32_16x16x32_bf16 v[128:131], v[120:123], v[84:87], v[128:131]
    ds_read_b128 v[32:35], v5 offset:0
    v_mfma_f32_16x16x32_bf16 v[132:135], v[124:127], v[84:87], v[132:135]
    ds_read_b128 v[36:39], v5 offset:1024
    v_mfma_f32_16x16x32_bf16 v[144:147], v[120:123], v[92:95], v[144:147]
    ds_read_b128 v[40:43], v5 offset:2048
    v_mfma_f32_16x16x32_bf16 v[148:151], v[124:127], v[92:95], v[148:151]
    ds_read_b128 v[44:47], v5 offset:3072
    v_mfma_f32_16x16x32_bf16 v[160:163], v[120:123], v[100:103], v[160:163]
    ds_read_b128 v[48:51], v5 offset:4096
    v_mfma_f32_16x16x32_bf16 v[164:167], v[124:127], v[100:103], v[164:167]
    ds_read_b128 v[52:55], v5 offset:5120
    v_mfma_f32_16x16x32_bf16 v[176:179], v[120:123], v[108:111], v[176:179]
    ds_read_b128 v[56:59], v5 offset:6144
    v_mfma_f32_16x16x32_bf16 v[180:183], v[124:127], v[108:111], v[180:183]
    ds_read_b128 v[60:63], v5 offset:7168
    s_waitcnt lgkmcnt(0)
w_loop_chkH:
    s_sub_u32 s23, s23, 1
w_loopH:
    s_cmp_gt_u32 s23, 3
    s_cbranch_scc1 w_bodyH
    s_cmp_lg_u32 s23, 3
    s_cbranch_scc1 w_l2H
    s_cmp_lg_u32 s3, 0
    s_cbranch_scc1 clm_7
    v_mov_b32 v26, 1
    s_mov_b64 exec, 1
    buffer_atomic_add v26, off, s[64:67], s71 sc0 sc1
    s_mov_b64 exec, -1
clm_7:
    s_branch w_bodyH
w_l2H:
    s_cmp_lg_u32 s23, 2
    s_cbranch_scc1 w_l1H
    s_cmp_lg_u32 s3, 0
    s_cbranch_scc1 pub_8
    v_mov_b32 v20, 131136
    s_mov_b64 exec, 1
    ds_write_b32 v20, v26
    s_mov_b64 exec, -1
    s_waitcnt lgkmcnt(0)
pub_8:
    s_branch w_bodyH
w_l1H:
    s_waitcnt vmcnt(8)
    buffer_load_dword v22, off, s[64:67], 0 sc1
    v_readfirstlane_b32 s30, v16
    s_cmp_ge_u32 s30, s45
    s_cselect_b32 s30, 0, 1
    s_or_b32 s30, s30, s70
    s_cmp_eq_u32 s32, 4
    s_cselect_b32 s30, 1, s30
    s_sub_u32 s57, s32, 1
    s_cmp_ge_u32 s57, 4
    s_cselect_b32 s30, 1, s30
    v_mov_b32 v20, s30
    ds_write_b32 v7, v20
    s_cbranch_scc1 w_bodyH
    s_load_dwordx2 s[8:9], s[0:1], s33
    s_load_dwordx2 s[12:13], s[0:1], s34
    s_mov_b32 s10, s38
    s_mov_b32 s14, s38
    s_cmp_eq_u32 s32, 4
    s_cselect_b32 s31, 0, 1
    s_lshl_b32 s30, s3, s31
    s_mul_i32 s30, s30, s40
    s_add_u32 s16, s39, s30
    s_cmp_eq_u32 s32, 4
    s_cselect_b32 s30, 1024, s40
    s_cselect_b32 s31, 6, 5
    s_lshl_b32 s62, 32, s31
    s_add_u32 s17, s16, s30
    s_lshl_b32 s30, s3, 2
    s_mul_i32 s30, s30, s35
    s_add_u32 s18, s36, s30
    s_add_u32 s19, s37, s30
    s_lshl_b32 s20, s35, s31
    v_mul_u32_u24 v2, s35, v4
    v_add_u32 v2, v2, v3
    s_waitcnt lgkmcnt(0)
w_bodyH:
    s_waitcnt vmcnt(8)
    s_barrier
    s_cmp_lg_u32 s23, 2
    s_cbranch_scc1 w_nfH
    v_mov_b32 v20, 131136
    ds_read_b32 v20, v20
    s_waitcnt lgkmcnt(0)
    v_readfirstlane_b32 s59, v20
    s_add_u32 s59, s59, 32
    s_min_u32 s59, s59, 337
    s_lshl_b32 s57, s59, 6
    s_load_dwordx16 s[32:47], s[24:25], s57
w_nfH:
    s_add_u32 m0, s21, 0
    s_nop 0
    buffer_load_dwordx4 v1, s[4:7], s16 offen sc1 lds
    s_add_u32 s16, s16, s62
    s_add_u32 m0, s21, 1024
    s_nop 0
    buffer_load_dwordx4 v1, s[4:7], s17 offen sc1 lds
    s_add_u32 s17, s17, s62
    s_add_u32 m0, s22, 0
    s_nop 0
    buffer_load_dwordx4 v2, s[8:11], s18 offen lds
    s_add_u32 s18, s18, s20
    s_add_u32 m0, s22, 8192
    s_nop 0
    buffer_load_dwordx4 v2, s[12:15], s19 offen lds
    s_add_u32 s19, s19, s20
    v_mfma_f32_16x16x32_bf16 v[128:131], v[64:67], v[32:35], v[128:131]
    ds_read_b64_tr_b16 v[112:113], v8 offset:49152
    v_mfma_f32_16x16x32_bf16 v[132:135], v[68:71], v[32:35], v[132:135]
    ds_read_b64_tr_b16 v[114:115], v9 offset:49152
    v_mfma_f32_16x16x32_bf16 v[144:147], v[64:67], v[40:43], v[144:147]
    ds_read_b64_tr_b16 v[116:117], v10 offset:49152
    v_mfma_f32_16x16x32_bf16 v[148:151], v[68:71], v[40:43], v[148:151]
    ds_read_b64_tr_b16 v[118:119], v11 offset:49152
    v_mfma_f32_16x16x32_bf16 v[160:163], v[64:67], v[48:51], v[160:163]
    ds_read_b64_tr_b16 v[120:121], v8 offset:57344
    v_mfma_f32_16x16x32_bf16 v[164:167], v[68:71], v[48:51], v[164:167]
    ds_read_b64_tr_b16 v[122:123], v9 offset:57344
    v_mfma_f32_16x16x32_bf16 v[176:179], v[64:67], v[56:59], v[176:179]
    ds_read_b64_tr_b16 v[124:125], v10 offset:57344
    v_mfma_f32_16x16x32_bf16 v[180:183], v[68:71], v[56:59], v[180:183]
    ds_read_b64_tr_b16 v[126:127], v11 offset:57344
    v_mfma_f32_16x16x32_bf16 v[128:131], v[72:75], v[36:39], v[128:131]
    ds_read_b128 v[80:83], v5 offset:32768
    v_mfma_f32_16x16x32_bf16 v[132:135], v[76:79], v[36:39], v[132:135]
    ds_read_b128 v[84:87], v5 offset:33792
    v_mfma_f32_16x16x32_bf16 v[144:147], v[72:75], v[44:47], v[144:147]
    ds_read_b128 v[88:91], v5 offset:34816
    v_mfma_f32_16x16x32_bf16 v[148:151], v[76:79], v[44:47], v[148:151]
    ds_read_b128 v[92:95], v5 offset:35840
    v_mfma_f32_16x16x32_bf16 v[160:163], v[72:75], v[52:55], v[160:163]
    ds_read_b128 v[96:99], v5 offset:36864
    v_mfma_f32_16x16x32_bf16 v[164:167], v[76:79], v[52:55], v[164:167]
    ds_read_b128 v[100:103], v5 offset:37888
    v_mfma_f32_16x16x32_bf16 v[176:179], v[72:75], v[60:63], v[176:179]
    ds_read_b128 v[104:107], v5 offset:38912
    v_mfma_f32_16x16x32_bf16 v[180:183], v[76:79], v[60:63], v[180:183]
    ds_read_b128 v[108:111], v5 offset:39936
    s_waitcnt lgkmcnt(0)
    s_waitcnt vmcnt(8)
    s_barrier
    buffer_load_dword v16, v17, s[4:7], s44 offen sc1
    s_add_u32 m0, s21, 32768
    s_nop 0
    buffer_load_dwordx4 v1, s[4:7], s16 offen sc1 lds
    s_add_u32 s16, s16, s62
    s_add_u32 m0, s21, 33792
    s_nop 0
    buffer_load_dwordx4 v1, s[4:7], s17 offen sc1 lds
    s_add_u32 s17, s17, s62
    s_add_u32 m0, s22, 32768
    s_nop 0
    buffer_load_dwordx4 v2, s[8:11], s18 offen lds
    s_add_u32 s18, s18, s20
    s_add_u32 m0, s22, 40960
    s_nop 0
    buffer_load_dwordx4 v2, s[12:15], s19 offen lds
    s_add_u32 s19, s19, s20
    v_mfma_f32_16x16x32_bf16 v[128:131], v[112:115], v[80:83], v[128:131]
    ds_read_b64_tr_b16 v[64:65], v12 offset:16384
    v_mfma_f32_16x16x32_bf16 v[132:135], v[116:119], v[80:83], v[132:135]
    ds_read_b64_tr_b16 v[66:67], v13 offset:16384
    v_mfma_f32_16x16x32_bf16 v[144:147], v[112:115], v[88:91], v[144:147]
    ds_read_b64_tr_b16 v[68:69], v14 offset:16384
    v_mfma_f32_16x16x32_bf16 v[148:151], v[116:119], v[88:91], v[148:151]
    ds_read_b64_tr_b16 v[70:71], v15 offset:16384
    v_mfma_f32_16x16x32_bf16 v[160:163], v[112:115], v[96:99], v[160:163]
    ds_read_b64_tr_b16 v[72:73], v12 offset:24576
    v_mfma_f32_16x16x32_bf16 v[164:167], v[116:119], v[96:99], v[164:167]
    ds_read_b64_tr_b16 v[74:75], v13 offset:24576
    v_mfma_f32_16x16x32_bf16 v[176:179], v[112:115], v[104:107], v[176:179]
    ds_read_b64_tr_b16 v[76:77], v14 offset:24576
    v_mfma_f32_16x16x32_bf16 v[180:183], v[116:119], v[104:107], v[180:183]
    ds_read_b64_tr_b16 v[78:79], v15 offset:24576
    v_mfma_f32_16x16x32_bf16 v[128:131], v[120:123], v[84:87], v[128:131]
    ds_read_b128 v[32:35], v6 offset:0
    v_mfma_f32_16x16x32_bf16 v[132:135], v[124:127], v[84:87], v[132:135]
    ds_read_b128 v[36:39], v6 offset:1024
    v_mfma_f32_16x16x32_bf16 v[144:147], v[120:123], v[92:95], v[144:147]
    ds_read_b128 v[40:43], v6 offset:2048
    v_mfma_f32_16x16x32_bf16 v[148:151], v[124:127], v[92:95], v[148:151]
    ds_read_b128 v[44:47], v6 offset:3072
    v_mfma_f32_16x16x32_bf16 v[160:163], v[120:123], v[100:103], v[160:163]
    ds_read_b128 v[48:51], v6 offset:4096
    v_mfma_f32_16x16x32_bf16 v[164:167], v[124:127], v[100:103], v[164:167]
    ds_read_b128 v[52:55], v6 offset:5120
    v_mfma_f32_16x16x32_bf16 v[176:179], v[120:123], v[108:111], v[176:179]
    ds_read_b128 v[56:59], v6 offset:6144
    v_mfma_f32_16x16x32_bf16 v[180:183], v[124:127], v[108:111], v[180:183]
    ds_read_b128 v[60:63], v6 offset:7168
    s_waitcnt lgkmcnt(0)
    s_waitcnt vmcnt(8)
    s_barrier
    s_add_u32 m0, s21, 65536
    s_nop 0
    buffer_load_dwordx4 v1, s[4:7], s16 offen sc1 lds
    s_add_u32 s16, s16, s62
    s_add_u32 m0, s21, 66560
    s_nop 0
    buffer_load_dwordx4 v1, s[4:7], s17 offen sc1 lds
    s_add_u32 s17, s17, s62
    s_add_u32 m0, s22, 65536
    s_nop 0
    buffer_load_dwordx4 v2, s[8:11], s18 offen lds
    s_add_u32 s18, s18, s20
    s_add_u32 m0, s22, 73728
    s_nop 0
    buffer_load_dwordx4 v2, s[12:15], s19 offen lds
    s_add_u32 s19, s19, s20
    v_mfma_f32_16x16x32_bf16 v[128:131], v[64:67], v[32:35], v[128:131]
    ds_read_b64_tr_b16 v[112:113], v12 offset:49152
    v_mfma_f32_16x16x32_bf16 v[132:135], v[68:71], v[32:35], v[132:135]
    ds_read_b64_tr_b16 v[114:115], v13 offset:49152
    v_mfma_f32_16x16x32_bf16 v[144:147], v[64:67], v[40:43], v[144:147]
    ds_read_b64_tr_b16 v[116:117], v14 offset:49152
    v_mfma_f32_16x16x32_bf16 v[148:151], v[68:71], v[40:43], v[148:151]
    ds_read_b64_tr_b16 v[118:119], v15 offset:49152
    v_mfma_f32_16x16x32_bf16 v[160:163], v[64:67], v[48:51], v[160:163]
    ds_read_b64_tr_b16 v[120:121], v12 offset:57344
    v_mfma_f32_16x16x32_bf16 v[164:167], v[68:71], v[48:51], v[164:167]
    ds_read_b64_tr_b16 v[122:123], v13 offset:57344
    v_mfma_f32_16x16x32_bf16 v[176:179], v[64:67], v[56:59], v[176:179]
    ds_read_b64_tr_b16 v[124:125], v14 offset:57344
    v_mfma_f32_16x16x32_bf16 v[180:183], v[68:71], v[56:59], v[180:183]
    ds_read_b64_tr_b16 v[126:127], v15 offset:57344
    v_mfma_f32_16x16x32_bf16 v[128:131], v[72:75], v[36:39], v[128:131]
    ds_read_b128 v[80:83], v6 offset:32768
    v_mfma_f32_16x16x32_bf16 v[132:135], v[76:79], v[36:39], v[132:135]
    ds_read_b128 v[84:87], v6 offset:33792
    v_mfma_f32_16x16x32_bf16 v[144:147], v[72:75], v[44:47], v[144:147]
    ds_read_b128 v[88:91], v6 offset:34816
    v_mfma_f32_16x16x32_bf16 v[148:151], v[76:79], v[44:47], v[148:151]
    ds_read_b128 v[92:95], v6 offset:35840
    v_mfma_f32_16x16x32_bf16 v[160:163], v[72:75], v[52:55], v[160:163]
    ds_read_b128 v[96:99], v6 offset:36864
    v_mfma_f32_16x16x32_bf16 v[164:167], v[76:79], v[52:55], v[164:167]
    ds_read_b128 v[100:103], v6 offset:37888
    v_mfma_f32_16x16x32_bf16 v[176:179], v[72:75], v[60:63], v[176:179]
    ds_read_b128 v[104:107], v6 offset:38912
    v_mfma_f32_16x16x32_bf16 v[180:183], v[76:79], v[60:63], v[180:183]
    ds_read_b128 v[108:111], v6 offset:39936
    s_waitcnt lgkmcnt(0)
    s_waitcnt vmcnt(8)
    s_barrier
    s_add_u32 m0, s21, 98304
    s_nop 0
    buffer_load_dwordx4 v1, s[4:7], s16 offen sc1 lds
    s_add_u32 s16, s16, s62
    s_add_u32 m0, s21, 99328
    s_nop 0
    buffer_load_dwordx4 v1, s[4:7], s17 offen sc1 lds
    s_add_u32 s17, s17, s62
    s_add_u32 m0, s22, 98304
    s_nop 0
    buffer_load_dwordx4 v2, s[8:11], s18 offen lds
    s_add_u32 s18, s18, s20
    s_add_u32 m0, s22, 106496
    s_nop 0
    buffer_load_dwordx4 v2, s[12:15], s19 offen lds
    s_add_u32 s19, s19, s20
    v_mfma_f32_16x16x32_bf16 v[128:131], v[112:115], v[80:83], v[128:131]
    ds_read_b64_tr_b16 v[64:65], v8 offset:16384
    v_mfma_f32_16x16x32_bf16 v[132:135], v[116:119], v[80:83], v[132:135]
    ds_read_b64_tr_b16 v[66:67], v9 offset:16384
    v_mfma_f32_16x16x32_bf16 v[144:147], v[112:115], v[88:91], v[144:147]
    ds_read_b64_tr_b16 v[68:69], v10 offset:16384
    v_mfma_f32_16x16x32_bf16 v[148:151], v[116:119], v[88:91], v[148:151]
    ds_read_b64_tr_b16 v[70:71], v11 offset:16384
    v_mfma_f32_16x16x32_bf16 v[160:163], v[112:115], v[96:99], v[160:163]
    ds_read_b64_tr_b16 v[72:73], v8 offset:24576
    v_mfma_f32_16x16x32_bf16 v[164:167], v[116:119], v[96:99], v[164:167]
    ds_read_b64_tr_b16 v[74:75], v9 offset:24576
    v_mfma_f32_16x16x32_bf16 v[176:179], v[112:115], v[104:107], v[176:179]
    ds_read_b64_tr_b16 v[76:77], v10 offset:24576
    v_mfma_f32_16x16x32_bf16 v[180:183], v[116:119], v[104:107], v[180:183]
    ds_read_b64_tr_b16 v[78:79], v11 offset:24576
    v_mfma_f32_16x16x32_bf16 v[128:131], v[120:123], v[84:87], v[128:131]
    ds_read_b128 v[32:35], v5 offset:0
    v_mfma_f32_16x16x32_bf16 v[132:135], v[124:127], v[84:87], v[132:135]
    ds_read_b128 v[36:39], v5 offset:1024
    v_mfma_f32_16x16x32_bf16 v[144:147], v[120:123], v[92:95], v[144:147]
    ds_read_b128 v[40:43], v5 offset:2048
    v_mfma_f32_16x16x32_bf16 v[148:151], v[124:127], v[92:95], v[148:151]
    ds_read_b128 v[44:47], v5 offset:3072
    v_mfma_f32_16x16x32_bf16 v[160:163], v[120:123], v[100:103], v[160:163]
    ds_read_b128 v[48:51], v5 offset:4096
    v_mfma_f32_16x16x32_bf16 v[164:167], v[124:127], v[100:103], v[164:167]
    ds_read_b128 v[52:55], v5 offset:5120
    v_mfma_f32_16x16x32_bf16 v[176:179], v[120:123], v[108:111], v[176:179]
    ds_read_b128 v[56:59], v5 offset:6144
    v_mfma_f32_16x16x32_bf16 v[180:183], v[124:127], v[108:111], v[180:183]
    ds_read_b128 v[60:63], v5 offset:7168
    s_waitcnt lgkmcnt(0)
    s_sub_u32 s23, s23, 1
    s_cmp_lg_u32 s23, 0
    s_cbranch_scc1 w_loopH
    v_mov_b32 v20, 131072
    ds_read_b128 v[24:27], v20
    ds_read_b128 v[28:31], v20 offset:16
    s_lshl_b32 s30, s27, 10
    s_add_u32 s30, s30, s49
    s_nop 7
    v_cvt_pk_bf16_f32 v80, v128, v129
    v_cvt_pk_bf16_f32 v81, v130, v131
    v_cvt_pk_bf16_f32 v82, v132, v133
    v_cvt_pk_bf16_f32 v83, v134, v135
    buffer_store_dwordx4 v[80:83], v1, s[4:7], s30 offen sc1
    s_add_u32 s30, s30, s50
    v_cvt_pk_bf16_f32 v84, v144, v145
    v_cvt_pk_bf16_f32 v85, v146, v147
    v_cvt_pk_bf16_f32 v86, v148, v149
    v_cvt_pk_bf16_f32 v87, v150, v151
    buffer_store_dwordx4 v[84:87], v1, s[4:7], s30 offen sc1
    s_add_u32 s30, s30, s50
    v_cvt_pk_bf16_f32 v88, v160, v161
    v_cvt_pk_bf16_f32 v89, v162, v163
    v_cvt_pk_bf16_f32 v90, v164, v165
    v_cvt_pk_bf16_f32 v91, v166, v167
    buffer_store_dwordx4 v[88:91], v1, s[4:7], s30 offen sc1
    s_add_u32 s30, s30, s50
    v_cvt_pk_bf16_f32 v92, v176, v177
    v_cvt_pk_bf16_f32 v93, v178, v179
    v_cvt_pk_bf16_f32 v94, v180, v181
    v_cvt_pk_bf16_f32 v95, v182, v183
    buffer_store_dwordx4 v[92:95], v1, s[4:7], s30 offen sc1
    s_add_u32 s30, s30, s50
    s_waitcnt lgkmcnt(0)
    v_or3_b32 v24, v24, v25, v26
    v_or3_b32 v28, v28, v29, v30
    v_or3_b32 v24, v24, v27, v31
    v_or_b32 v24, v24, v28
    s_mov_b32 s28, s51
    v_readfirstlane_b32 s30, v24
    s_cmp_lg_u32 s30, 0
    s_cbranch_scc1 w_drain
    s_mov_b32 s48, s32
    s_cmp_eq_u32 s32, 4
    s_cselect_b32 s30, 2, 3
    s_lshl_b32 s30, s26, s30
    s_mul_i32 s30, s30, s43
    s_add_u32 s49, s42, s30
    s_mov_b32 s50, s43
    s_mov_b32 s51, s46
    s_mov_b32 s23, s41
    s_branch w_first4
w_drain:
    s_waitcnt vmcnt(0)
    s_barrier
    s_cmp_eq_u32 s70, 0
    s_cbranch_scc1 drw_ok
    s_mov_b32 s70, 0
    s_cmp_lg_u32 s3, 0
    s_cbranch_scc1 drw_ok
    v_readfirstlane_b32 s68, v22
    s_cmp_ge_u32 s68, 128
    s_cbranch_scc1 drw_ok
    s_mov_b32 s69, 65536
drw:
    buffer_load_dword v20, off, s[64:67], 0 offset:0 sc1
    s_waitcnt vmcnt(0)
    v_readfirstlane_b32 s68, v20
    s_cmp_ge_u32 s68, 128
    s_cbranch_scc1 drw_ok
    s_sleep 8
    s_sub_u32 s69, s69, 1
    s_cbranch_scc0 drw
drw_ok:
    s_cmp_eq_u32 s28, 0
    s_cbranch_scc1 sig_9
    s_cmp_lg_u32 s3, 0
    s_cbranch_scc1 sig_9
    s_and_b32 s57, s28, 3
    v_mov_b32 v24, s57
    s_bfe_u32 s57, s28, 0x20002
    v_mov_b32 v25, s57
    s_andn2_b32 s28, s28, 15
    s_mov_b64 exec, 1
    buffer_atomic_add_x2 v[24:25], v17, s[4:7], s28 offen sc1
    s_mov_b64 exec, -1
sig_9:
    s_mov_b32 s28, 0
    s_branch w_cold
w_att:
    s_cmp_lg_u32 s3, 0
    s_cbranch_scc1 w_att_go
    s_mov_b32 s31, 0x40000
w_att_w:
    buffer_load_dwordx2 v[20:21], off, s[4:7], s33 sc1
    s_waitcnt vmcnt(0)
    v_add_u32 v20, v20, v21
    s_nop 0
    v_readfirstlane_b32 s30, v20
    s_cmp_ge_u32 s30, 8
    s_cbranch_scc1 w_att_go
    s_sleep 16
    s_sub_u32 s31, s31, 1
    s_cbranch_scc0 w_att_w
w_att_go:
    s_cmp_lg_u32 s3, 0
    s_cbranch_scc1 clm_10
    v_mov_b32 v250, 1
    s_mov_b64 exec, 1
    buffer_atomic_add v250, off, s[64:67], s71 sc0 sc1
    s_mov_b64 exec, -1
clm_10:
    s_barrier
    v_lshrrev_b32 v20, 4, v1
    v_lshrrev_b32 v21, 4, v20
    v_and_b32 v22, 15, v20
    v_lshlrev_b32 v23, 2, v21
    v_add_u32 v24, 0, v23
    v_cmp_gt_u32 s[72:73], v24, v22
    v_add_u32 v24, 1, v23
    v_cmp_gt_u32 s[74:75], v24, v22
    v_add_u32 v24, 2, v23
    v_cmp_gt_u32 s[76:77], v24, v22
    v_add_u32 v24, 3, v23
    v_cmp_gt_u32 s[78:79], v24, v22
    s_mul_i32 s83, s3, 10240
    v_and_b32 v22, 3, v20
    v_bfe_u32 v24, v20, 2, 2
    v_add_u32 v23, v23, v24
    v_lshl_add_u32 v23, v22, 4, v23
    v_lshlrev_b32 v23, 4, v23
    v_add_u32 v25, s83, v23
    v_and_b32 v24, 1, v24
    v_lshl_add_u32 v24, v21, 1, v24
    v_lshl_add_u32 v24, v22, 3, v24
    v_lshlrev_b32 v24, 4, v24
    v_add_u32 v26, s83, v24
    v_mov_b32 v22, 0xff61b1e6
    v_mov_b32 v136, 0
    v_mov_b32 v137, 0
    v_mov_b32 v220, 0
    v_mov_b32 v221, 0
    s_mov_b32 s80, 0x3e0293ee
    s_lshr_b32 s85, s3, 2
    s_add_u32 s85, s85, s39
    s_lshl_b32 s81, s85, 18
    s_and_b32 s85, s3, 3
    s_add_u32 s85, s85, s36
    s_lshl_b32 s82, s85, 13
    s_add_u32 s82, s82, s81
    s_add_u32 s82, s82, 192937984
    s_lshl_b32 s85, s85, 12
    s_add_u32 s81, s81, s85
    v_mov_b32 v28, 0x3f803f80
    v_mov_b32 v29, 0x3f803f80
    v_mov_b32 v30, 0x3f803f80
    v_mov_b32 v31, 0x3f803f80
    s_add_u32 s86, s82, 0
    buffer_load_dwordx4 v[120:123], v1, s[4:7], s86 offen offset:0 sc1
    buffer_load_dwordx4 v[124:127], v1, s[4:7], s86 offen offset:1024 sc1
    buffer_load_dwordx4 v[128:131], v1, s[4:7], s86 offen offset:2048 sc1
    buffer_load_dwordx4 v[132:135], v1, s[4:7], s86 offen offset:3072 sc1
    s_add_u32 s85, s81, 4194304
    buffer_load_dwordx4 v[56:59], v1, s[4:7], s85 offen offset:0 sc1
    buffer_load_dwordx4 v[60:63], v1, s[4:7], s85 offen offset:1024 sc1
    buffer_load_dwordx4 v[64:67], v1, s[4:7], s85 offen offset:2048 sc1
    buffer_load_dwordx4 v[68:71], v1, s[4:7], s85 offen offset:3072 sc1
    s_add_u32 s85, s81, 4325376
    buffer_load_dwordx4 v[72:75], v1, s[4:7], s85 offen offset:0 sc1
    buffer_load_dwordx4 v[76:79], v1, s[4:7], s85 offen offset:1024 sc1
    buffer_load_dwordx4 v[80:83], v1, s[4:7], s85 offen offset:2048 sc1
    buffer_load_dwordx4 v[84:87], v1, s[4:7], s85 offen offset:3072 sc1
    s_add_u32 s85, s81, 20971520
    buffer_load_dwordx4 v[88:91], v1, s[4:7], s85 offen offset:0 sc1
    buffer_load_dwordx4 v[92:95], v1, s[4:7], s85 offen offset:1024 sc1
    buffer_load_dwordx4 v[96:99], v1, s[4:7], s85 offen offset:2048 sc1
    buffer_load_dwordx4 v[100:103], v1, s[4:7], s85 offen offset:3072 sc1
    s_add_u32 s85, s81, 21102592
    buffer_load_dwordx4 v[104:107], v1, s[4:7], s85 offen offset:0 sc1
    buffer_load_dwordx4 v[108:111], v1, s[4:7], s85 offen offset:1024 sc1
    buffer_load_dwordx4 v[112:115], v1, s[4:7], s85 offen offset:2048 sc1
    buffer_load_dwordx4 v[116:119], v1, s[4:7], s85 offen offset:3072 sc1
    s_add_u32 m0, s83, 0
    s_add_u32 s85, s81, 37748736
    buffer_load_dwordx4 v1, s[4:7], s85 offen offset:0 sc1 lds
    buffer_load_dwordx4 v1, s[4:7], s85 offen offset:1024 sc1 lds
    buffer_load_dwordx4 v1, s[4:7], s85 offen offset:2048 sc1 lds
    buffer_load_dwordx4 v1, s[4:7], s85 offen offset:3072 sc1 lds
    s_add_u32 m0, s83, 4096
    s_add_u32 s85, s81, 37879808
    buffer_load_dwordx4 v1, s[4:7], s85 offen offset:0 sc1 lds
    buffer_load_dwordx4 v1, s[4:7], s85 offen offset:1024 sc1 lds
    buffer_load_dwordx4 v1, s[4:7], s85 offen offset:2048 sc1 lds
    buffer_load_dwordx4 v1, s[4:7], s85 offen offset:3072 sc1 lds
    s_add_u32 m0, s83, 8192
    s_add_u32 s85, s82, 4096
    buffer_load_dwordx4 v1, s[4:7], s85 offen offset:0 sc1 lds
    buffer_load_dwordx4 v1, s[4:7], s85 offen offset:1024 sc1 lds
    s_add_u32 s86, s82, 524288
    buffer_load_dwordx4 v[204:207], v1, s[4:7], s86 offen offset:0 sc1
    buffer_load_dwordx4 v[208:211], v1, s[4:7], s86 offen offset:1024 sc1
    buffer_load_dwordx4 v[212:215], v1, s[4:7], s86 offen offset:2048 sc1
    buffer_load_dwordx4 v[216:219], v1, s[4:7], s86 offen offset:3072 sc1
    s_add_u32 s85, s81, 4718592
    buffer_load_dwordx4 v[140:143], v1, s[4:7], s85 offen offset:0 sc1
    buffer_load_dwordx4 v[144:147], v1, s[4:7], s85 offen offset:1024 sc1
    buffer_load_dwordx4 v[148:151], v1, s[4:7], s85 offen offset:2048 sc1
    buffer_load_dwordx4 v[152:155], v1, s[4:7], s85 offen offset:3072 sc1
    s_add_u32 s85, s81, 4849664
    buffer_load_dwordx4 v[156:159], v1, s[4:7], s85 offen offset:0 sc1
    buffer_load_dwordx4 v[160:163], v1, s[4:7], s85 offen offset:1024 sc1
    buffer_load_dwordx4 v[164:167], v1, s[4:7], s85 offen offset:2048 sc1
    buffer_load_dwordx4 v[168:171], v1, s[4:7], s85 offen offset:3072 sc1
    s_add_u32 s85, s81, 21495808
    buffer_load_dwordx4 v[172:175], v1, s[4:7], s85 offen offset:0 sc1
    buffer_load_dwordx4 v[176:179], v1, s[4:7], s85 offen offset:1024 sc1
    buffer_load_dwordx4 v[180:183], v1, s[4:7], s85 offen offset:2048 sc1
    buffer_load_dwordx4 v[184:187], v1, s[4:7], s85 offen offset:3072 sc1
    s_add_u32 s85, s81, 21626880
    buffer_load_dwordx4 v[188:191], v1, s[4:7], s85 offen offset:0 sc1
    buffer_load_dwordx4 v[192:195], v1, s[4:7], s85 offen offset:1024 sc1
    buffer_load_dwordx4 v[196:199], v1, s[4:7], s85 offen offset:2048 sc1
    buffer_load_dwordx4 v[200:203], v1, s[4:7], s85 offen offset:3072 sc1
    s_add_u32 m0, s83, 81920
    s_add_u32 s85, s81, 38273024
    buffer_load_dwordx4 v1, s[4:7], s85 offen offset:0 sc1 lds
    buffer_load_dwordx4 v1, s[4:7], s85 offen offset:1024 sc1 lds
    buffer_load_dwordx4 v1, s[4:7], s85 offen offset:2048 sc1 lds
    buffer_load_dwordx4 v1, s[4:7], s85 offen offset:3072 sc1 lds
    s_add_u32 m0, s83, 86016
    s_add_u32 s85, s81, 38404096
    buffer_load_dwordx4 v1, s[4:7], s85 offen offset:0 sc1 lds
    buffer_load_dwordx4 v1, s[4:7], s85 offen offset:1024 sc1 lds
    buffer_load_dwordx4 v1, s[4:7], s85 offen offset:2048 sc1 lds
    buffer_load_dwordx4 v1, s[4:7], s85 offen offset:3072 sc1 lds
    s_add_u32 m0, s83, 90112
    s_add_u32 s85, s82, 528384
    buffer_load_dwordx4 v1, s[4:7], s85 offen offset:0 sc1 lds
    buffer_load_dwordx4 v1, s[4:7], s85 offen offset:1024 sc1 lds
    s_waitcnt vmcnt(40)
    v_mfma_f32_16x16x32_bf16 v[32:35], v[88:91], v[56:59], 0
    v_mfma_f32_16x16x32_bf16 v[40:43], v[120:123], v[56:59], 0
    v_mfma_f32_16x16x32_bf16 v[32:35], v[92:95], v[60:63], v[32:35]
    v_mfma_f32_16x16x32_bf16 v[40:43], v[124:127], v[60:63], v[40:43]
    v_mfma_f32_16x16x32_bf16 v[32:35], v[96:99], v[64:67], v[32:35]
    v_mfma_f32_16x16x32_bf16 v[40:43], v[128:131], v[64:67], v[40:43]
    v_mfma_f32_16x16x32_bf16 v[32:35], v[100:103], v[68:71], v[32:35]
    v_mfma_f32_16x16x32_bf16 v[40:43], v[132:135], v[68:71], v[40:43]
    v_mfma_f32_16x16x32_bf16 v[44:47], v[88:91], v[72:75], 0
    v_mfma_f32_16x16x32_bf16 v[48:51], v[104:107], v[72:75], 0
    v_mfma_f32_16x16x32_bf16 v[52:55], v[120:123], v[72:75], 0
    v_mfma_f32_16x16x32_bf16 v[44:47], v[92:95], v[76:79], v[44:47]
    v_mfma_f32_16x16x32_bf16 v[48:51], v[108:111], v[76:79], v[48:51]
    v_mfma_f32_16x16x32_bf16 v[52:55], v[124:127], v[76:79], v[52:55]
    v_mfma_f32_16x16x32_bf16 v[44:47], v[96:99], v[80:83], v[44:47]
    v_mfma_f32_16x16x32_bf16 v[48:51], v[112:115], v[80:83], v[48:51]
    v_mfma_f32_16x16x32_bf16 v[52:55], v[128:131], v[80:83], v[52:55]
    v_mfma_f32_16x16x32_bf16 v[44:47], v[100:103], v[84:87], v[44:47]
    v_mfma_f32_16x16x32_bf16 v[48:51], v[116:119], v[84:87], v[48:51]
    v_mfma_f32_16x16x32_bf16 v[52:55], v[132:135], v[84:87], v[52:55]
    v_cndmask_b32 v32, v32, v22, s[72:73]
    v_cndmask_b32 v33, v33, v22, s[74:75]
    v_cndmask_b32 v34, v34, v22, s[76:77]
    v_cndmask_b32 v35, v35, v22, s[78:79]
    v_max3_f32 v20, v32, v33, v34
    v_max3_f32 v21, v35, v40, v41
    v_max_f32 v20, v20, v21
    v_mov_b32 v21, v20
    s_nop 1
    v_permlane16_swap_b32 v21, v20
    v_max_f32 v20, v20, v21
    v_mov_b32 v21, v20
    s_nop 1
    v_permlane32_swap_b32 v21, v20
    v_max_f32 v20, v20, v21
    v_mul_f32 v20, s80, v20
    v_fma_f32 v32, v32, s80, -v20
    v_fma_f32 v33, v33, s80, -v20
    v_fma_f32 v34, v34, s80, -v20
    v_fma_f32 v35, v35, s80, -v20
    v_fma_f32 v40, v40, s80, -v20
    v_fma_f32 v41, v41, s80, -v20
    v_exp_f32 v32, v32
    v_exp_f32 v33, v33
    v_exp_f32 v34, v34
    v_exp_f32 v35, v35
    v_exp_f32 v40, v40
    v_exp_f32 v41, v41
    s_nop 0
    v_cvt_pk_bf16_f32 v32, v32, v33
    v_cvt_pk_bf16_f32 v33, v34, v35
    v_mov_b32 v34, 0
    v_mov_b32 v35, 0
    v_cvt_pk_bf16_f32 v40, v40, v41
    v_mov_b32 v41, 0
    v_mov_b32 v42, 0
    v_mov_b32 v43, 0
    s_nop 1
    s_waitcnt vmcnt(30)
    ds_read_b64_tr_b16 v[56:57], v25 offset:0
    ds_read_b64_tr_b16 v[58:59], v25 offset:4096
    ds_read_b64_tr_b16 v[120:121], v26 offset:8192
    ds_read_b64_tr_b16 v[60:61], v25 offset:8
    ds_read_b64_tr_b16 v[62:63], v25 offset:4104
    ds_read_b64_tr_b16 v[122:123], v26 offset:8200
    ds_read_b64_tr_b16 v[64:65], v25 offset:1024
    ds_read_b64_tr_b16 v[66:67], v25 offset:5120
    ds_read_b64_tr_b16 v[124:125], v26 offset:8704
    ds_read_b64_tr_b16 v[68:69], v25 offset:1032
    ds_read_b64_tr_b16 v[70:71], v25 offset:5128
    ds_read_b64_tr_b16 v[126:127], v26 offset:8712
    ds_read_b64_tr_b16 v[72:73], v25 offset:2048
    ds_read_b64_tr_b16 v[74:75], v25 offset:6144
    ds_read_b64_tr_b16 v[128:129], v26 offset:9216
    ds_read_b64_tr_b16 v[76:77], v25 offset:2056
    ds_read_b64_tr_b16 v[78:79], v25 offset:6152
    ds_read_b64_tr_b16 v[130:131], v26 offset:9224
    ds_read_b64_tr_b16 v[80:81], v25 offset:3072
    ds_read_b64_tr_b16 v[82:83], v25 offset:7168
    ds_read_b64_tr_b16 v[132:133], v26 offset:9728
    ds_read_b64_tr_b16 v[84:85], v25 offset:3080
    ds_read_b64_tr_b16 v[86:87], v25 offset:7176
    ds_read_b64_tr_b16 v[134:135], v26 offset:9736
    v_cndmask_b32 v48, v48, v22, s[72:73]
    v_cndmask_b32 v49, v49, v22, s[74:75]
    v_cndmask_b32 v50, v50, v22, s[76:77]
    v_cndmask_b32 v51, v51, v22, s[78:79]
    v_max3_f32 v20, v44, v45, v46
    v_max3_f32 v21, v47, v48, v49
    v_max3_f32 v20, v20, v50, v51
    v_max3_f32 v21, v21, v52, v53
    v_max_f32 v20, v20, v21
    v_mov_b32 v21, v20
    s_nop 1
    v_permlane16_swap_b32 v21, v20
    v_max_f32 v20, v20, v21
    v_mov_b32 v21, v20
    s_nop 1
    v_permlane32_swap_b32 v21, v20
    v_max_f32 v20, v20, v21
    v_mul_f32 v20, s80, v20
    v_fma_f32 v44, v44, s80, -v20
    v_fma_f32 v45, v45, s80, -v20
    v_fma_f32 v46, v46, s80, -v20
    v_fma_f32 v47, v47, s80, -v20
    v_fma_f32 v48, v48, s80, -v20
    v_fma_f32 v49, v49, s80, -v20
    v_fma_f32 v50, v50, s80, -v20
    v_fma_f32 v51, v51, s80, -v20
    v_fma_f32 v52, v52, s80, -v20
    v_fma_f32 v53, v53, s80, -v20
    v_exp_f32 v44, v44
    v_exp_f32 v45, v45
    v_exp_f32 v46, v46
    v_exp_f32 v47, v47
    v_exp_f32 v48, v48
    v_exp_f32 v49, v49
    v_exp_f32 v50, v50
    v_exp_f32 v51, v51
    v_exp_f32 v52, v52
    v_exp_f32 v53, v53
    s_nop 0
    v_cvt_pk_bf16_f32 v44, v44, v45
    v_cvt_pk_bf16_f32 v45, v46, v47
    v_cvt_pk_bf16_f32 v46, v48, v49
    v_cvt_pk_bf16_f32 v47, v50, v51
    v_cvt_pk_bf16_f32 v52, v52, v53
    v_mov_b32 v53, 0
    v_mov_b32 v54, 0
    v_mov_b32 v55, 0
    s_nop 1
    s_waitcnt lgkmcnt(0)
    v_mfma_f32_16x16x32_bf16 v[36:39], v[28:31], v[32:35], 0
    v_mfma_f32_16x16x32_bf16 v[36:39], v[28:31], v[40:43], v[36:39]
    v_mfma_f32_16x16x32_bf16 v[88:91], v[56:59], v[32:35], 0
    v_mfma_f32_16x16x32_bf16 v[88:91], v[120:123], v[40:43], v[88:91]
    v_mfma_f32_16x16x32_bf16 v[92:95], v[60:63], v[32:35], 0
    v_mfma_f32_16x16x32_bf16 v[92:95], v[122:125], v[40:43], v[92:95]
    v_mfma_f32_16x16x32_bf16 v[96:99], v[64:67], v[32:35], 0
    v_mfma_f32_16x16x32_bf16 v[96:99], v[124:127], v[40:43], v[96:99]
    v_mfma_f32_16x16x32_bf16 v[100:103], v[68:71], v[32:35], 0
    v_mfma_f32_16x16x32_bf16 v[100:103], v[126:129], v[40:43], v[100:103]
    v_mfma_f32_16x16x32_bf16 v[104:107], v[72:75], v[32:35], 0
    v_mfma_f32_16x16x32_bf16 v[104:107], v[128:131], v[40:43], v[104:107]
    v_mfma_f32_16x16x32_bf16 v[108:111], v[76:79], v[32:35], 0
    v_mfma_f32_16x16x32_bf16 v[108:111], v[130:133], v[40:43], v[108:111]
    v_mfma_f32_16x16x32_bf16 v[112:115], v[80:83], v[32:35], 0
    v_mfma_f32_16x16x32_bf16 v[112:115], v[132:135], v[40:43], v[112:115]
    v_mfma_f32_16x16x32_bf16 v[116:119], v[84:87], v[32:35], 0
    v_mfma_f32_16x16x32_bf16 v[116:119], v[134:137], v[40:43], v[116:119]
    v_rcp_f32 v23, v36
    s_add_u32 s85, s81, 176160768
    v_mul_f32 v88, v88, v23
    v_mul_f32 v89, v89, v23
    v_mul_f32 v90, v90, v23
    v_mul_f32 v91, v91, v23
    v_mul_f32 v92, v92, v23
    v_mul_f32 v93, v93, v23
    v_mul_f32 v94, v94, v23
    v_mul_f32 v95, v95, v23
    v_cvt_pk_bf16_f32 v224, v88, v89
    v_cvt_pk_bf16_f32 v225, v90, v91
    v_cvt_pk_bf16_f32 v226, v92, v93
    v_cvt_pk_bf16_f32 v227, v94, v95
    buffer_store_dwordx4 v[224:227], v1, s[4:7], s85 offen offset:0 sc1
    v_mul_f32 v96, v96, v23
    v_mul_f32 v97, v97, v23
    v_mul_f32 v98, v98, v23
    v_mul_f32 v99, v99, v23
    v_mul_f32 v100, v100, v23
    v_mul_f32 v101, v101, v23
    v_mul_f32 v102, v102, v23
    v_mul_f32 v103, v103, v23
    v_cvt_pk_bf16_f32 v228, v96, v97
    v_cvt_pk_bf16_f32 v229, v98, v99
    v_cvt_pk_bf16_f32 v230, v100, v101
    v_cvt_pk_bf16_f32 v231, v102, v103
    buffer_store_dwordx4 v[228:231], v1, s[4:7], s85 offen offset:1024 sc1
    v_mul_f32 v104, v104, v23
    v_mul_f32 v105, v105, v23
    v_mul_f32 v106, v106, v23
    v_mul_f32 v107, v107, v23
    v_mul_f32 v108, v108, v23
    v_mul_f32 v109, v109, v23
    v_mul_f32 v110, v110, v23
    v_mul_f32 v111, v111, v23
    v_cvt_pk_bf16_f32 v232, v104, v105
    v_cvt_pk_bf16_f32 v233, v106, v107
    v_cvt_pk_bf16_f32 v234, v108, v109
    v_cvt_pk_bf16_f32 v235, v110, v111
    buffer_store_dwordx4 v[232:235], v1, s[4:7], s85 offen offset:2048 sc1
    v_mul_f32 v112, v112, v23
    v_mul_f32 v113, v113, v23
    v_mul_f32 v114, v114, v23
    v_mul_f32 v115, v115, v23
    v_mul_f32 v116, v116, v23
    v_mul_f32 v117, v117, v23
    v_mul_f32 v118, v118, v23
    v_mul_f32 v119, v119, v23
    v_cvt_pk_bf16_f32 v236, v112, v113
    v_cvt_pk_bf16_f32 v237, v114, v115
    v_cvt_pk_bf16_f32 v238, v116, v117
    v_cvt_pk_bf16_f32 v239, v118, v119
    buffer_store_dwordx4 v[236:239], v1, s[4:7], s85 offen offset:3072 sc1
    v_mfma_f32_16x16x32_bf16 v[48:51], v[28:31], v[44:47], 0
    v_mfma_f32_16x16x32_bf16 v[48:51], v[28:31], v[52:55], v[48:51]
    v_mfma_f32_16x16x32_bf16 v[88:91], v[56:59], v[44:47], 0
    v_mfma_f32_16x16x32_bf16 v[88:91], v[120:123], v[52:55], v[88:91]
    v_mfma_f32_16x16x32_bf16 v[92:95], v[60:63], v[44:47], 0
    v_mfma_f32_16x16x32_bf16 v[92:95], v[122:125], v[52:55], v[92:95]
    v_mfma_f32_16x16x32_bf16 v[96:99], v[64:67], v[44:47], 0
    v_mfma_f32_16x16x32_bf16 v[96:99], v[124:127], v[52:55], v[96:99]
    v_mfma_f32_16x16x32_bf16 v[100:103], v[68:71], v[44:47], 0
    v_mfma_f32_16x16x32_bf16 v[100:103], v[126:129], v[52:55], v[100:103]
    v_mfma_f32_16x16x32_bf16 v[104:107], v[72:75], v[44:47], 0
    v_mfma_f32_16x16x32_bf16 v[104:107], v[128:131], v[52:55], v[104:107]
    v_mfma_f32_16x16x32_bf16 v[108:111], v[76:79], v[44:47], 0
    v_mfma_f32_16x16x32_bf16 v[108:111], v[130:133], v[52:55], v[108:111]
    v_mfma_f32_16x16x32_bf16 v[112:115], v[80:83], v[44:47], 0
    v_mfma_f32_16x16x32_bf16 v[112:115], v[132:135], v[52:55], v[112:115]
    v_mfma_f32_16x16x32_bf16 v[116:119], v[84:87], v[44:47], 0
    v_mfma_f32_16x16x32_bf16 v[116:119], v[134:137], v[52:55], v[116:119]
    v_rcp_f32 v23, v48
    s_add_u32 s85, s81, 176291840
    v_mul_f32 v88, v88, v23
    v_mul_f32 v89, v89, v23
    v_mul_f32 v90, v90, v23
    v_mul_f32 v91, v91, v23
    v_mul_f32 v92, v92, v23
    v_mul_f32 v93, v93, v23
    v_mul_f32 v94, v94, v23
    v_mul_f32 v95, v95, v23
    v_cvt_pk_bf16_f32 v224, v88, v89
    v_cvt_pk_bf16_f32 v225, v90, v91
    v_cvt_pk_bf16_f32 v226, v92, v93
    v_cvt_pk_bf16_f32 v227, v94, v95
    buffer_store_dwordx4 v[224:227], v1, s[4:7], s85 offen offset:0 sc1
    v_mul_f32 v96, v96, v23
    v_mul_f32 v97, v97, v23
    v_mul_f32 v98, v98, v23
    v_mul_f32 v99, v99, v23
    v_mul_f32 v100, v100, v23
    v_mul_f32 v101, v101, v23
    v_mul_f32 v102, v102, v23
    v_mul_f32 v103, v103, v23
    v_cvt_pk_bf16_f32 v228, v96, v97
    v_cvt_pk_bf16_f32 v229, v98, v99
    v_cvt_pk_bf16_f32 v230, v100, v101
    v_cvt_pk_bf16_f32 v231, v102, v103
    buffer_store_dwordx4 v[228:231], v1, s[4:7], s85 offen offset:1024 sc1
    v_mul_f32 v104, v104, v23
    v_mul_f32 v105, v105, v23
    v_mul_f32 v106, v106, v23
    v_mul_f32 v107, v107, v23
    v_mul_f32 v108, v108, v23
    v_mul_f32 v109, v109, v23
    v_mul_f32 v110, v110, v23
    v_mul_f32 v111, v111, v23
    v_cvt_pk_bf16_f32 v232, v104, v105
    v_cvt_pk_bf16_f32 v233, v106, v107
    v_cvt_pk_bf16_f32 v234, v108, v109
    v_cvt_pk_bf16_f32 v235, v110, v111
    buffer_store_dwordx4 v[232:235], v1, s[4:7], s85 offen offset:2048 sc1
    v_mul_f32 v112, v112, v23
    v_mul_f32 v113, v113, v23
    v_mul_f32 v114, v114, v23
    v_mul_f32 v115, v115, v23
    v_mul_f32 v116, v116, v23
    v_mul_f32 v117, v117, v23
    v_mul_f32 v118, v118, v23
    v_mul_f32 v119, v119, v23
    v_cvt_pk_bf16_f32 v236, v112, v113
    v_cvt_pk_bf16_f32 v237, v114, v115
    v_cvt_pk_bf16_f32 v238, v116, v117
    v_cvt_pk_bf16_f32 v239, v118, v119
    buffer_store_dwordx4 v[236:239], v1, s[4:7], s85 offen offset:3072 sc1
    s_waitcnt vmcnt(18)
    v_mfma_f32_16x16x32_bf16 v[32:35], v[172:175], v[140:143], 0
    v_mfma_f32_16x16x32_bf16 v[40:43], v[204:207], v[140:143], 0
    v_mfma_f32_16x16x32_bf16 v[32:35], v[176:179], v[144:147], v[32:35]
    v_mfma_f32_16x16x32_bf16 v[40:43], v[208:211], v[144:147], v[40:43]
    v_mfma_f32_16x16x32_bf16 v[32:35], v[180:183], v[148:151], v[32:35]
    v_mfma_f32_16x16x32_bf16 v[40:43], v[212:215], v[148:151], v[40:43]
    v_mfma_f32_16x16x32_bf16 v[32:35], v[184:187], v[152:155], v[32:35]
    v_mfma_f32_16x16x32_bf16 v[40:43], v[216:219], v[152:155], v[40:43]
    v_mfma_f32_16x16x32_bf16 v[44:47], v[172:175], v[156:159], 0
    v_mfma_f32_16x16x32_bf16 v[48:51], v[188:191], v[156:159], 0
    v_mfma_f32_16x16x32_bf16 v[52:55], v[204:207], v[156:159], 0
    v_mfma_f32_16x16x32_bf16 v[44:47], v[176:179], v[160:163], v[44:47]
    v_mfma_f32_16x16x32_bf16 v[48:51], v[192:195], v[160:163], v[48:51]
    v_mfma_f32_16x16x32_bf16 v[52:55], v[208:211], v[160:163], v[52:55]
    v_mfma_f32_16x16x32_bf16 v[44:47], v[180:183], v[164:167], v[44:47]
    v_mfma_f32_16x16x32_bf16 v[48:51], v[196:199], v[164:167], v[48:51]
    v_mfma_f32_16x16x32_bf16 v[52:55], v[212:215], v[164:167], v[52:55]
    v_mfma_f32_16x16x32_bf16 v[44:47], v[184:187], v[168:171], v[44:47]
    v_mfma_f32_16x16x32_bf16 v[48:51], v[200:203], v[168:171], v[48:51]
    v_mfma_f32_16x16x32_bf16 v[52:55], v[216:219], v[168:171], v[52:55]
    v_cndmask_b32 v32, v32, v22, s[72:73]
    v_cndmask_b32 v33, v33, v22, s[74:75]
    v_cndmask_b32 v34, v34, v22, s[76:77]
    v_cndmask_b32 v35, v35, v22, s[78:79]
    v_max3_f32 v20, v32, v33, v34
    v_max3_f32 v21, v35, v40, v41
    v_max_f32 v20, v20, v21
    v_mov_b32 v21, v20
    s_nop 1
    v_permlane16_swap_b32 v21, v20
    v_max_f32 v20, v20, v21
    v_mov_b32 v21, v20
    s_nop 1
    v_permlane32_swap_b32 v21, v20
    v_max_f32 v20, v20, v21
    v_mul_f32 v20, s80, v20
    v_fma_f32 v32, v32, s80, -v20
    v_fma_f32 v33, v33, s80, -v20
    v_fma_f32 v34, v34, s80, -v20
    v_fma_f32 v35, v35, s80, -v20
    v_fma_f32 v40, v40, s80, -v20
    v_fma_f32 v41, v41, s80, -v20
    v_exp_f32 v32, v32
    v_exp_f32 v33, v33
    v_exp_f32 v34, v34
    v_exp_f32 v35, v35
    v_exp_f32 v40, v40
    v_exp_f32 v41, v41
    s_nop 0
    v_cvt_pk_bf16_f32 v32, v32, v33
    v_cvt_pk_bf16_f32 v33, v34, v35
    v_mov_b32 v34, 0
    v_mov_b32 v35, 0
    v_cvt_pk_bf16_f32 v40, v40, v41
    v_mov_b32 v41, 0
    v_mov_b32 v42, 0
    v_mov_b32 v43, 0
    s_nop 1
    s_waitcnt vmcnt(8)
    v_add_u32 v25, 81920, v25
    v_add_u32 v26, 81920, v26
    ds_read_b64_tr_b16 v[140:141], v25 offset:0
    ds_read_b64_tr_b16 v[142:143], v25 offset:4096
    ds_read_b64_tr_b16 v[204:205], v26 offset:8192
    ds_read_b64_tr_b16 v[144:145], v25 offset:8
    ds_read_b64_tr_b16 v[146:147], v25 offset:4104
    ds_read_b64_tr_b16 v[206:207], v26 offset:8200
    ds_read_b64_tr_b16 v[148:149], v25 offset:1024
    ds_read_b64_tr_b16 v[150:151], v25 offset:5120
    ds_read_b64_tr_b16 v[208:209], v26 offset:8704
    ds_read_b64_tr_b16 v[152:153], v25 offset:1032
    ds_read_b64_tr_b16 v[154:155], v25 offset:5128
    ds_read_b64_tr_b16 v[210:211], v26 offset:8712
    ds_read_b64_tr_b16 v[156:157], v25 offset:2048
    ds_read_b64_tr_b16 v[158:159], v25 offset:6144
    ds_read_b64_tr_b16 v[212:213], v26 offset:9216
    ds_read_b64_tr_b16 v[160:161], v25 offset:2056
    ds_read_b64_tr_b16 v[162:163], v25 offset:6152
    ds_read_b64_tr_b16 v[214:215], v26 offset:9224
    ds_read_b64_tr_b16 v[164:165], v25 offset:3072
    ds_read_b64_tr_b16 v[166:167], v25 offset:7168
    ds_read_b64_tr_b16 v[216:217], v26 offset:9728
    ds_read_b64_tr_b16 v[168:169], v25 offset:3080
    ds_read_b64_tr_b16 v[170:171], v25 offset:7176
    ds_read_b64_tr_b16 v[218:219], v26 offset:9736
    v_cndmask_b32 v48, v48, v22, s[72:73]
    v_cndmask_b32 v49, v49, v22, s[74:75]
    v_cndmask_b32 v50, v50, v22, s[76:77]
    v_cndmask_b32 v51, v51, v22, s[78:79]
    v_max3_f32 v20, v44, v45, v46
    v_max3_f32 v21, v47, v48, v49
    v_max3_f32 v20, v20, v50, v51
    v_max3_f32 v21, v21, v52, v53
    v_max_f32 v20, v20, v21
    v_mov_b32 v21, v20
    s_nop 1
    v_permlane16_swap_b32 v21, v20
    v_max_f32 v20, v20, v21
    v_mov_b32 v21, v20
    s_nop 1
    v_permlane32_swap_b32 v21, v20
    v_max_f32 v20, v20, v21
    v_mul_f32 v20, s80, v20
    v_fma_f32 v44, v44, s80, -v20
    v_fma_f32 v45, v45, s80, -v20
    v_fma_f32 v46, v46, s80, -v20
    v_fma_f32 v47, v47, s80, -v20
    v_fma_f32 v48, v48, s80, -v20
    v_fma_f32 v49, v49, s80, -v20
    v_fma_f32 v50, v50, s80, -v20
    v_fma_f32 v51, v51, s80, -v20
    v_fma_f32 v52, v52, s80, -v20
    v_fma_f32 v53, v53, s80, -v20
    v_exp_f32 v44, v44
    v_exp_f32 v45, v45
    v_exp_f32 v46, v46
    v_exp_f32 v47, v47
    v_exp_f32 v48, v48
    v_exp_f32 v49, v49
    v_exp_f32 v50, v50
    v_exp_f32 v51, v51
    v_exp_f32 v52, v52
    v_exp_f32 v53, v53
    s_nop 0
    v_cvt_pk_bf16_f32 v44, v44, v45
    v_cvt_pk_bf16_f32 v45, v46, v47
    v_cvt_pk_bf16_f32 v46, v48, v49
    v_cvt_pk_bf16_f32 v47, v50, v51
    v_cvt_pk_bf16_f32 v52, v52, v53
    v_mov_b32 v53, 0
    v_mov_b32 v54, 0
    v_mov_b32 v55, 0
    s_nop 1
    s_waitcnt lgkmcnt(0)
    v_mfma_f32_16x16x32_bf16 v[36:39], v[28:31], v[32:35], 0
    v_mfma_f32_16x16x32_bf16 v[36:39], v[28:31], v[40:43], v[36:39]
    v_mfma_f32_16x16x32_bf16 v[172:175], v[140:143], v[32:35], 0
    v_mfma_f32_16x16x32_bf16 v[172:175], v[204:207], v[40:43], v[172:175]
    v_mfma_f32_16x16x32_bf16 v[176:179], v[144:147], v[32:35], 0
    v_mfma_f32_16x16x32_bf16 v[176:179], v[206:209], v[40:43], v[176:179]
    v_mfma_f32_16x16x32_bf16 v[180:183], v[148:151], v[32:35], 0
    v_mfma_f32_16x16x32_bf16 v[180:183], v[208:211], v[40:43], v[180:183]
    v_mfma_f32_16x16x32_bf16 v[184:187], v[152:155], v[32:35], 0
    v_mfma_f32_16x16x32_bf16 v[184:187], v[210:213], v[40:43], v[184:187]
    v_mfma_f32_16x16x32_bf16 v[188:191], v[156:159], v[32:35], 0
    v_mfma_f32_16x16x32_bf16 v[188:191], v[212:215], v[40:43], v[188:191]
    v_mfma_f32_16x16x32_bf16 v[192:195], v[160:163], v[32:35], 0
    v_mfma_f32_16x16x32_bf16 v[192:195], v[214:217], v[40:43], v[192:195]
    v_mfma_f32_16x16x32_bf16 v[196:199], v[164:167], v[32:35], 0
    v_mfma_f32_16x16x32_bf16 v[196:199], v[216:219], v[40:43], v[196:199]
    v_mfma_f32_16x16x32_bf16 v[200:203], v[168:171], v[32:35], 0
    v_mfma_f32_16x16x32_bf16 v[200:203], v[218:221], v[40:43], v[200:203]
    v_rcp_f32 v23, v36
    s_add_u32 s85, s81, 176685056
    v_mul_f32 v172, v172, v23
    v_mul_f32 v173, v173, v23
    v_mul_f32 v174, v174, v23
    v_mul_f32 v175, v175, v23
    v_mul_f32 v176, v176, v23
    v_mul_f32 v177, v177, v23
    v_mul_f32 v178, v178, v23
    v_mul_f32 v179, v179, v23
    v_cvt_pk_bf16_f32 v224, v172, v173
    v_cvt_pk_bf16_f32 v225, v174, v175
    v_cvt_pk_bf16_f32 v226, v176, v177
    v_cvt_pk_bf16_f32 v227, v178, v179
    buffer_store_dwordx4 v[224:227], v1, s[4:7], s85 offen offset:0 sc1
    v_mul_f32 v180, v180, v23
    v_mul_f32 v181, v181, v23
    v_mul_f32 v182, v182, v23
    v_mul_f32 v183, v183, v23
    v_mul_f32 v184, v184, v23
    v_mul_f32 v185, v185, v23
    v_mul_f32 v186, v186, v23
    v_mul_f32 v187, v187, v23
    v_cvt_pk_bf16_f32 v228, v180, v181
    v_cvt_pk_bf16_f32 v229, v182, v183
    v_cvt_pk_bf16_f32 v230, v184, v185
    v_cvt_pk_bf16_f32 v231, v186, v187
    buffer_store_dwordx4 v[228:231], v1, s[4:7], s85 offen offset:1024 sc1
    v_mul_f32 v188, v188, v23
    v_mul_f32 v189, v189, v23
    v_mul_f32 v190, v190, v23
    v_mul_f32 v191, v191, v23
    v_mul_f32 v192, v192, v23
    v_mul_f32 v193, v193, v23
    v_mul_f32 v194, v194, v23
    v_mul_f32 v195, v195, v23
    v_cvt_pk_bf16_f32 v232, v188, v189
    v_cvt_pk_bf16_f32 v233, v190, v191
    v_cvt_pk_bf16_f32 v234, v192, v193
    v_cvt_pk_bf16_f32 v235, v194, v195
    buffer_store_dwordx4 v[232:235], v1, s[4:7], s85 offen offset:2048 sc1
    v_mul_f32 v196, v196, v23
    v_mul_f32 v197, v197, v23
    v_mul_f32 v198, v198, v23
    v_mul_f32 v199, v199, v23
    v_mul_f32 v200, v200, v23
    v_mul_f32 v201, v201, v23
    v_mul_f32 v202, v202, v23
    v_mul_f32 v203, v203, v23
    v_cvt_pk_bf16_f32 v236, v196, v197
    v_cvt_pk_bf16_f32 v237, v198, v199
    v_cvt_pk_bf16_f32 v238, v200, v201
    v_cvt_pk_bf16_f32 v239, v202, v203
    buffer_store_dwordx4 v[236:239], v1, s[4:7], s85 offen offset:3072 sc1
    v_mfma_f32_16x16x32_bf16 v[48:51], v[28:31], v[44:47], 0
    v_mfma_f32_16x16x32_bf16 v[48:51], v[28:31], v[52:55], v[48:51]
    v_mfma_f32_16x16x32_bf16 v[172:175], v[140:143], v[44:47], 0
    v_mfma_f32_16x16x32_bf16 v[172:175], v[204:207], v[52:55], v[172:175]
    v_mfma_f32_16x16x32_bf16 v[176:179], v[144:147], v[44:47], 0
    v_mfma_f32_16x16x32_bf16 v[176:179], v[206:209], v[52:55], v[176:179]
    v_mfma_f32_16x16x32_bf16 v[180:183], v[148:151], v[44:47], 0
    v_mfma_f32_16x16x32_bf16 v[180:183], v[208:211], v[52:55], v[180:183]
    v_mfma_f32_16x16x32_bf16 v[184:187], v[152:155], v[44:47], 0
    v_mfma_f32_16x16x32_bf16 v[184:187], v[210:213], v[52:55], v[184:187]
    v_mfma_f32_16x16x32_bf16 v[188:191], v[156:159], v[44:47], 0
    v_mfma_f32_16x16x32_bf16 v[188:191], v[212:215], v[52:55], v[188:191]
    v_mfma_f32_16x16x32_bf16 v[192:195], v[160:163], v[44:47], 0
    v_mfma_f32_16x16x32_bf16 v[192:195], v[214:217], v[52:55], v[192:195]
    v_mfma_f32_16x16x32_bf16 v[196:199], v[164:167], v[44:47], 0
    v_mfma_f32_16x16x32_bf16 v[196:199], v[216:219], v[52:55], v[196:199]
    v_mfma_f32_16x16x32_bf16 v[200:203], v[168:171], v[44:47], 0
    v_mfma_f32_16x16x32_bf16 v[200:203], v[218:221], v[52:55], v[200:203]
    v_rcp_f32 v23, v48
    s_add_u32 s85, s81, 176816128
    v_mul_f32 v172, v172, v23
    v_mul_f32 v173, v173, v23
    v_mul_f32 v174, v174, v23
    v_mul_f32 v175, v175, v23
    v_mul_f32 v176, v176, v23
    v_mul_f32 v177, v177, v23
    v_mul_f32 v178, v178, v23
    v_mul_f32 v179, v179, v23
    v_cvt_pk_bf16_f32 v224, v172, v173
    v_cvt_pk_bf16_f32 v225, v174, v175
    v_cvt_pk_bf16_f32 v226, v176, v177
    v_cvt_pk_bf16_f32 v227, v178, v179
    buffer_store_dwordx4 v[224:227], v1, s[4:7], s85 offen offset:0 sc1
    v_mul_f32 v180, v180, v23
    v_mul_f32 v181, v181, v23
    v_mul_f32 v182, v182, v23
    v_mul_f32 v183, v183, v23
    v_mul_f32 v184, v184, v23
    v_mul_f32 v185, v185, v23
    v_mul_f32 v186, v186, v23
    v_mul_f32 v187, v187, v23
    v_cvt_pk_bf16_f32 v228, v180, v181
    v_cvt_pk_bf16_f32 v229, v182, v183
    v_cvt_pk_bf16_f32 v230, v184, v185
    v_cvt_pk_bf16_f32 v231, v186, v187
    buffer_store_dwordx4 v[228:231], v1, s[4:7], s85 offen offset:1024 sc1
    v_mul_f32 v188, v188, v23
    v_mul_f32 v189, v189, v23
    v_mul_f32 v190, v190, v23
    v_mul_f32 v191, v191, v23
    v_mul_f32 v192, v192, v23
    v_mul_f32 v193, v193, v23
    v_mul_f32 v194, v194, v23
    v_mul_f32 v195, v195, v23
    v_cvt_pk_bf16_f32 v232, v188, v189
    v_cvt_pk_bf16_f32 v233, v190, v191
    v_cvt_pk_bf16_f32 v234, v192, v193
    v_cvt_pk_bf16_f32 v235, v194, v195
    buffer_store_dwordx4 v[232:235], v1, s[4:7], s85 offen offset:2048 sc1
    v_mul_f32 v196, v196, v23
    v_mul_f32 v197, v197, v23
    v_mul_f32 v198, v198, v23
    v_mul_f32 v199, v199, v23
    v_mul_f32 v200, v200, v23
    v_mul_f32 v201, v201, v23
    v_mul_f32 v202, v202, v23
    v_mul_f32 v203, v203, v23
    v_cvt_pk_bf16_f32 v236, v196, v197
    v_cvt_pk_bf16_f32 v237, v198, v199
    v_cvt_pk_bf16_f32 v238, v200, v201
    v_cvt_pk_bf16_f32 v239, v202, v203
    buffer_store_dwordx4 v[236:239], v1, s[4:7], s85 offen offset:3072 sc1
    s_mov_b32 s28, s46
    s_waitcnt vmcnt(0)
    s_barrier
    s_cmp_eq_u32 s28, 0
    s_cbranch_scc1 sig_11
    s_cmp_lg_u32 s3, 0
    s_cbranch_scc1 sig_11
    s_and_b32 s57, s28, 3
    v_mov_b32 v24, s57
    s_bfe_u32 s57, s28, 0x20002
    v_mov_b32 v25, s57
    s_andn2_b32 s28, s28, 15
    s_mov_b64 exec, 1
    buffer_atomic_add_x2 v[24:25], v17, s[4:7], s28 offen sc1
    s_mov_b64 exec, -1
sig_11:
    s_mov_b32 s28, 0
    s_cmp_lg_u32 s3, 0
    s_cbranch_scc1 pub_12
    v_mov_b32 v20, 131136
    s_mov_b64 exec, 1
    ds_write_b32 v20, v250
    s_mov_b64 exec, -1
    s_waitcnt lgkmcnt(0)
pub_12:
    s_barrier
    v_mov_b32 v20, 131136
    ds_read_b32 v20, v20
    s_waitcnt lgkmcnt(0)
    v_readfirstlane_b32 s59, v20
    s_add_u32 s59, s59, 32
    s_min_u32 s59, s59, 337
    s_lshl_b32 s57, s59, 6
    s_load_dwordx16 s[32:47], s[24:25], s57
    s_waitcnt lgkmcnt(0)
    s_branch w_cold
w_fin:
    s_load_dwordx2 s[8:9], s[0:1], 0
    s_load_dwordx2 s[12:13], s[0:1], 88
    v_mbcnt_lo_u32_b32 v1, -1, 0
    v_mbcnt_hi_u32_b32 v1, -1, v1
    s_mov_b32 s10, 4194304
    s_mov_b32 s11, 131072
    s_mov_b32 s14, 4194304
    s_mov_b32 s15, 131072
    s_mov_b32 s89, 0xbfb8aa3b
    v_lshlrev_b32 v3, 4, v1
    v_and_b32 v4, 15, v1
    v_lshrrev_b32 v5, 4, v1
    v_lshlrev_b32 v4, 11, v4
    v_lshl_add_u32 v4, v5, 4, v4
    v_and_b32 v5, 1, v5
    v_cmp_eq_u32 s[76:77], 1, v5
    v_and_b32 v6, 3, v1
    v_lshlrev_b32 v6, 7, v6
    s_mov_b32 s80, s39
    s_lshl_b32 s81, s36, 2
    s_and_b32 s82, s3, 3
    s_add_u32 s81, s81, s82
    s_lshr_b32 s82, s3, 2
    s_mov_b32 s84, 65536
    s_mov_b32 s85, 218112000
    s_waitcnt lgkmcnt(0)
    s_cmp_eq_u32 s32, 7
    s_cbranch_scc1 fin_tail
fin_job:
    s_lshl_b32 s72, s80, 1
    s_add_u32 s72, s72, s82
    s_lshl_b32 s74, s72, 15
    s_lshl_b32 s73, s81, 11
    s_add_u32 s73, s73, s74
    s_lshl_b32 s75, s81, 7
    s_add_u32 s74, s74, s75
    s_add_u32 s78, s73, 117440512
    s_add_u32 s79, s73, 75497472
    s_lshr_b32 s83, s80, 3
    s_lshl_b32 s83, s83, 6
    s_add_u32 s83, s83, 218106368
    s_add_u32 s87, s80, 1
    buffer_load_dwordx4 v[88:91], v4, s[8:11], s74 offen offset:0
    buffer_load_dwordx4 v[92:95], v4, s[8:11], s74 offen offset:64
    s_cmp_lg_u32 s3, 0
    s_cbranch_scc1 fin_ws_ok
fin_wd:
    buffer_load_dwordx2 v[8:9], off, s[4:7], s83 sc1
    s_waitcnt vmcnt(0)
    v_readfirstlane_b32 s86, v8
    v_readfirstlane_b32 s88, v9
    s_cmp_ge_u32 s80, 48
    s_cselect_b32 s88, 16, s88
    s_min_u32 s86, s86, s88
    s_cmp_ge_u32 s86, 16
    s_cbranch_scc1 fin_wd2
    s_sleep 64
    s_sub_u32 s84, s84, 1
    s_cbranch_scc0 fin_wd
    s_mov_b32 s84, 0
fin_wd2:
    s_cmp_lt_u32 s80, 48
    s_cbranch_scc1 fin_ws_ok
fin_ws:
    buffer_load_dword v7, v6, s[4:7], s85 offen sc1
    s_waitcnt vmcnt(0)
    v_cmp_gt_u32 vcc, s87, v7
    s_cbranch_vccz fin_ws_ok
    s_sleep 12
    s_sub_u32 s86, s87, 2
    v_cmp_gt_i32 vcc, s86, v7
    s_cbranch_vccz fin_ws_f
    s_sleep 64
    s_sub_u32 s86, s87, 6
    v_cmp_gt_i32 vcc, s86, v7
    s_cbranch_vccz fin_ws_f
    s_sleep 127
    s_sleep 127
fin_ws_f:
    s_sub_u32 s84, s84, 1
    s_cbranch_scc0 fin_ws
    s_mov_b32 s84, 0
fin_ws_ok:
    s_cmp_lg_u32 s3, 0
    s_cbranch_scc1 clm_13
    v_mov_b32 v250, 1
    s_mov_b64 exec, 1
    buffer_atomic_add v250, off, s[64:67], s71 sc0 sc1
    s_mov_b64 exec, -1
clm_13:
    s_barrier
    buffer_load_dwordx4 v[136:139], v3, s[4:7], s78 offen offset:0 sc1
    buffer_load_dwordx4 v[140:143], v3, s[4:7], s78 offen offset:1024 sc1
    s_add_u32 s78, s78, 4194304
    buffer_load_dwordx4 v[144:147], v3, s[4:7], s78 offen offset:0 sc1
    buffer_load_dwordx4 v[148:151], v3, s[4:7], s78 offen offset:1024 sc1
    s_add_u32 s78, s78, 4194304
    buffer_load_dwordx4 v[152:155], v3, s[4:7], s78 offen offset:0 sc1
    buffer_load_dwordx4 v[156:159], v3, s[4:7], s78 offen offset:1024 sc1
    s_add_u32 s78, s78, 4194304
    buffer_load_dwordx4 v[160:163], v3, s[4:7], s78 offen offset:0 sc1
    buffer_load_dwordx4 v[164:167], v3, s[4:7], s78 offen offset:1024 sc1
    s_add_u32 s78, s78, 4194304
    buffer_load_dwordx4 v[16:19], v3, s[4:7], s79 offen offset:0 sc1
    buffer_load_dwordx4 v[48:51], v3, s[4:7], s79 offen offset:1024 sc1
    s_add_u32 s79, s79, 4194304
    buffer_load_dwordx4 v[20:23], v3, s[4:7], s79 offen offset:0 sc1
    buffer_load_dwordx4 v[52:55], v3, s[4:7], s79 offen offset:1024 sc1
    s_add_u32 s79, s79, 4194304
    buffer_load_dwordx4 v[24:27], v3, s[4:7], s79 offen offset:0 sc1
    buffer_load_dwordx4 v[56:59], v3, s[4:7], s79 offen offset:1024 sc1
    s_add_u32 s79, s79, 4194304
    buffer_load_dwordx4 v[28:31], v3, s[4:7], s79 offen offset:0 sc1
    buffer_load_dwordx4 v[60:63], v3, s[4:7], s79 offen offset:1024 sc1
    s_add_u32 s79, s79, 4194304
    s_cmp_lt_u32 s80, 48
    s_cbranch_scc1 fin_4p
    buffer_load_dwordx4 v[32:35], v3, s[4:7], s79 offen offset:0 sc1
    buffer_load_dwordx4 v[64:67], v3, s[4:7], s79 offen offset:1024 sc1
    s_add_u32 s79, s79, 4194304
    buffer_load_dwordx4 v[36:39], v3, s[4:7], s79 offen offset:0 sc1
    buffer_load_dwordx4 v[68:71], v3, s[4:7], s79 offen offset:1024 sc1
    s_add_u32 s79, s79, 4194304
    buffer_load_dwordx4 v[40:43], v3, s[4:7], s79 offen offset:0 sc1
    buffer_load_dwordx4 v[72:75], v3, s[4:7], s79 offen offset:1024 sc1
    s_add_u32 s79, s79, 4194304
    buffer_load_dwordx4 v[44:47], v3, s[4:7], s79 offen offset:0 sc1
    buffer_load_dwordx4 v[76:79], v3, s[4:7], s79 offen offset:1024 sc1
    s_add_u32 s79, s79, 4194304
    s_waitcnt vmcnt(16)
    s_branch fin_8p
fin_4p:
    v_mov_b32 v32, 0
    v_mov_b32 v33, 0
    v_mov_b32 v34, 0
    v_mov_b32 v35, 0
    v_mov_b32 v36, 0
    v_mov_b32 v37, 0
    v_mov_b32 v38, 0
    v_mov_b32 v39, 0
    v_mov_b32 v40, 0
    v_mov_b32 v41, 0
    v_mov_b32 v42, 0
    v_mov_b32 v43, 0
    v_mov_b32 v44, 0
    v_mov_b32 v45, 0
    v_mov_b32 v46, 0
    v_mov_b32 v47, 0
    v_mov_b32 v64, 0
    v_mov_b32 v65, 0
    v_mov_b32 v66, 0
    v_mov_b32 v67, 0
    v_mov_b32 v68, 0
    v_mov_b32 v69, 0
    v_mov_b32 v70, 0
    v_mov_b32 v71, 0
    v_mov_b32 v72, 0
    v_mov_b32 v73, 0
    v_mov_b32 v74, 0
    v_mov_b32 v75, 0
    v_mov_b32 v76, 0
    v_mov_b32 v77, 0
    v_mov_b32 v78, 0
    v_mov_b32 v79, 0
    s_waitcnt vmcnt(8)
fin_8p:
    v_lshlrev_b32 v120, 16, v136
    v_and_b32 v121, 0xffff0000, v136
    v_lshlrev_b32 v136, 16, v144
    v_and_b32 v144, 0xffff0000, v144
    v_add_f32 v120, v120, v136
    v_add_f32 v121, v121, v144
    v_lshlrev_b32 v136, 16, v152
    v_and_b32 v152, 0xffff0000, v152
    v_add_f32 v120, v120, v136
    v_add_f32 v121, v121, v152
    v_lshlrev_b32 v136, 16, v160
    v_and_b32 v160, 0xffff0000, v160
    v_add_f32 v120, v120, v136
    v_add_f32 v121, v121, v160
    v_cvt_pk_bf16_f32 v136, v120, v121
    v_lshlrev_b32 v120, 16, v136
    v_and_b32 v121, 0xffff0000, v136
    v_mul_f32 v136, s89, v120
    v_mul_f32 v144, s89, v121
    v_lshlrev_b32 v122, 16, v137
    v_and_b32 v123, 0xffff0000, v137
    v_lshlrev_b32 v137, 16, v145
    v_and_b32 v145, 0xffff0000, v145
    v_add_f32 v122, v122, v137
    v_add_f32 v123, v123, v145
    v_lshlrev_b32 v137, 16, v153
    v_and_b32 v153, 0xffff0000, v153
    v_add_f32 v122, v122, v137
    v_add_f32 v123, v123, v153
    v_lshlrev_b32 v137, 16, v161
    v_and_b32 v161, 0xffff0000, v161
    v_add_f32 v122, v122, v137
    v_add_f32 v123, v123, v161
    v_cvt_pk_bf16_f32 v137, v122, v123
    v_lshlrev_b32 v122, 16, v137
    v_and_b32 v123, 0xffff0000, v137
    v_mul_f32 v137, s89, v122
    v_mul_f32 v145, s89, v123
    v_lshlrev_b32 v124, 16, v138
    v_and_b32 v125, 0xffff0000, v138
    v_lshlrev_b32 v138, 16, v146
    v_and_b32 v146, 0xffff0000, v146
    v_add_f32 v124, v124, v138
    v_add_f32 v125, v125, v146
    v_lshlrev_b32 v138, 16, v154
    v_and_b32 v154, 0xffff0000, v154
    v_add_f32 v124, v124, v138
    v_add_f32 v125, v125, v154
    v_lshlrev_b32 v138, 16, v162
    v_and_b32 v162, 0xffff0000, v162
    v_add_f32 v124, v124, v138
    v_add_f32 v125, v125, v162
    v_cvt_pk_bf16_f32 v138, v124, v125
    v_lshlrev_b32 v124, 16, v138
    v_and_b32 v125, 0xffff0000, v138
    v_mul_f32 v138, s89, v124
    v_mul_f32 v146, s89, v125
    v_lshlrev_b32 v126, 16, v139
    v_and_b32 v127, 0xffff0000, v139
    v_lshlrev_b32 v139, 16, v147
    v_and_b32 v147, 0xffff0000, v147
    v_add_f32 v126, v126, v139
    v_add_f32 v127, v127, v147
    v_lshlrev_b32 v139, 16, v155
    v_and_b32 v155, 0xffff0000, v155
    v_add_f32 v126, v126, v139
    v_add_f32 v127, v127, v155
    v_lshlrev_b32 v139, 16, v163
    v_and_b32 v163, 0xffff0000, v163
    v_add_f32 v126, v126, v139
    v_add_f32 v127, v127, v163
    v_cvt_pk_bf16_f32 v139, v126, v127
    v_lshlrev_b32 v126, 16, v139
    v_and_b32 v127, 0xffff0000, v139
    v_mul_f32 v139, s89, v126
    v_mul_f32 v147, s89, v127
    v_exp_f32 v136, v136
    v_exp_f32 v144, v144
    v_exp_f32 v137, v137
    v_exp_f32 v145, v145
    v_exp_f32 v138, v138
    v_exp_f32 v146, v146
    v_exp_f32 v139, v139
    v_exp_f32 v147, v147
    s_nop 0
    v_add_f32 v136, 1.0, v136
    v_add_f32 v144, 1.0, v144
    v_add_f32 v137, 1.0, v137
    v_add_f32 v145, 1.0, v145
    v_add_f32 v138, 1.0, v138
    v_add_f32 v146, 1.0, v146
    v_add_f32 v139, 1.0, v139
    v_add_f32 v147, 1.0, v147
    v_rcp_f32 v136, v136
    v_rcp_f32 v144, v144
    v_rcp_f32 v137, v137
    v_rcp_f32 v145, v145
    v_rcp_f32 v138, v138
    v_rcp_f32 v146, v146
    v_rcp_f32 v139, v139
    v_rcp_f32 v147, v147
    s_nop 0
    v_mul_f32 v120, v120, v136
    v_mul_f32 v121, v121, v144
    v_cvt_pk_bf16_f32 v136, v120, v121
    v_mul_f32 v122, v122, v137
    v_mul_f32 v123, v123, v145
    v_cvt_pk_bf16_f32 v137, v122, v123
    v_mul_f32 v124, v124, v138
    v_mul_f32 v125, v125, v146
    v_cvt_pk_bf16_f32 v138, v124, v125
    v_mul_f32 v126, v126, v139
    v_mul_f32 v127, v127, v147
    v_cvt_pk_bf16_f32 v139, v126, v127
    v_lshlrev_b32 v120, 16, v140
    v_and_b32 v121, 0xffff0000, v140
    v_lshlrev_b32 v140, 16, v148
    v_and_b32 v148, 0xffff0000, v148
    v_add_f32 v120, v120, v140
    v_add_f32 v121, v121, v148
    v_lshlrev_b32 v140, 16, v156
    v_and_b32 v156, 0xffff0000, v156
    v_add_f32 v120, v120, v140
    v_add_f32 v121, v121, v156
    v_lshlrev_b32 v140, 16, v164
    v_and_b32 v164, 0xffff0000, v164
    v_add_f32 v120, v120, v140
    v_add_f32 v121, v121, v164
    v_cvt_pk_bf16_f32 v140, v120, v121
    v_lshlrev_b32 v120, 16, v140
    v_and_b32 v121, 0xffff0000, v140
    v_mul_f32 v140, s89, v120
    v_mul_f32 v148, s89, v121
    v_lshlrev_b32 v122, 16, v141
    v_and_b32 v123, 0xffff0000, v141
    v_lshlrev_b32 v141, 16, v149
    v_and_b32 v149, 0xffff0000, v149
    v_add_f32 v122, v122, v141
    v_add_f32 v123, v123, v149
    v_lshlrev_b32 v141, 16, v157
    v_and_b32 v157, 0xffff0000, v157
    v_add_f32 v122, v122, v141
    v_add_f32 v123, v123, v157
    v_lshlrev_b32 v141, 16, v165
    v_and_b32 v165, 0xffff0000, v165
    v_add_f32 v122, v122, v141
    v_add_f32 v123, v123, v165
    v_cvt_pk_bf16_f32 v141, v122, v123
    v_lshlrev_b32 v122, 16, v141
    v_and_b32 v123, 0xffff0000, v141
    v_mul_f32 v141, s89, v122
    v_mul_f32 v149, s89, v123
    v_lshlrev_b32 v124, 16, v142
    v_and_b32 v125, 0xffff0000, v142
    v_lshlrev_b32 v142, 16, v150
    v_and_b32 v150, 0xffff0000, v150
    v_add_f32 v124, v124, v142
    v_add_f32 v125, v125, v150
    v_lshlrev_b32 v142, 16, v158
    v_and_b32 v158, 0xffff0000, v158
    v_add_f32 v124, v124, v142
    v_add_f32 v125, v125, v158
    v_lshlrev_b32 v142, 16, v166
    v_and_b32 v166, 0xffff0000, v166
    v_add_f32 v124, v124, v142
    v_add_f32 v125, v125, v166
    v_cvt_pk_bf16_f32 v142, v124, v125
    v_lshlrev_b32 v124, 16, v142
    v_and_b32 v125, 0xffff0000, v142
    v_mul_f32 v142, s89, v124
    v_mul_f32 v150, s89, v125
    v_lshlrev_b32 v126, 16, v143
    v_and_b32 v127, 0xffff0000, v143
    v_lshlrev_b32 v143, 16, v151
    v_and_b32 v151, 0xffff0000, v151
    v_add_f32 v126, v126, v143
    v_add_f32 v127, v127, v151
    v_lshlrev_b32 v143, 16, v159
    v_and_b32 v159, 0xffff0000, v159
    v_add_f32 v126, v126, v143
    v_add_f32 v127, v127, v159
    v_lshlrev_b32 v143, 16, v167
    v_and_b32 v167, 0xffff0000, v167
    v_add_f32 v126, v126, v143
    v_add_f32 v127, v127, v167
    v_cvt_pk_bf16_f32 v143, v126, v127
    v_lshlrev_b32 v126, 16, v143
    v_and_b32 v127, 0xffff0000, v143
    v_mul_f32 v143, s89, v126
    v_mul_f32 v151, s89, v127
    v_exp_f32 v140, v140
    v_exp_f32 v148, v148
    v_exp_f32 v141, v141
    v_exp_f32 v149, v149
    v_exp_f32 v142, v142
    v_exp_f32 v150, v150
    v_exp_f32 v143, v143
    v_exp_f32 v151, v151
    s_nop 0
    v_add_f32 v140, 1.0, v140
    v_add_f32 v148, 1.0, v148
    v_add_f32 v141, 1.0, v141
    v_add_f32 v149, 1.0, v149
    v_add_f32 v142, 1.0, v142
    v_add_f32 v150, 1.0, v150
    v_add_f32 v143, 1.0, v143
    v_add_f32 v151, 1.0, v151
    v_rcp_f32 v140, v140
    v_rcp_f32 v148, v148
    v_rcp_f32 v141, v141
    v_rcp_f32 v149, v149
    v_rcp_f32 v142, v142
    v_rcp_f32 v150, v150
    v_rcp_f32 v143, v143
    v_rcp_f32 v151, v151
    s_nop 0
    v_mul_f32 v120, v120, v140
    v_mul_f32 v121, v121, v148
    v_cvt_pk_bf16_f32 v140, v120, v121
    v_mul_f32 v122, v122, v141
    v_mul_f32 v123, v123, v149
    v_cvt_pk_bf16_f32 v141, v122, v123
    v_mul_f32 v124, v124, v142
    v_mul_f32 v125, v125, v150
    v_cvt_pk_bf16_f32 v142, v124, v125
    v_mul_f32 v126, v126, v143
    v_mul_f32 v127, v127, v151
    v_cvt_pk_bf16_f32 v143, v126, v127
    s_waitcnt vmcnt(0)
    v_lshlrev_b32 v96, 16, v16
    v_and_b32 v97, 0xffff0000, v16
    v_lshlrev_b32 v98, 16, v17
    v_and_b32 v99, 0xffff0000, v17
    v_lshlrev_b32 v100, 16, v18
    v_and_b32 v101, 0xffff0000, v18
    v_lshlrev_b32 v102, 16, v19
    v_and_b32 v103, 0xffff0000, v19
    v_lshlrev_b32 v120, 16, v20
    v_and_b32 v121, 0xffff0000, v20
    v_lshlrev_b32 v122, 16, v21
    v_and_b32 v123, 0xffff0000, v21
    v_lshlrev_b32 v124, 16, v22
    v_and_b32 v125, 0xffff0000, v22
    v_lshlrev_b32 v126, 16, v23
    v_and_b32 v127, 0xffff0000, v23
    v_add_f32 v96, v96, v120
    v_add_f32 v97, v97, v121
    v_add_f32 v98, v98, v122
    v_add_f32 v99, v99, v123
    v_add_f32 v100, v100, v124
    v_add_f32 v101, v101, v125
    v_add_f32 v102, v102, v126
    v_add_f32 v103, v103, v127
    v_lshlrev_b32 v120, 16, v24
    v_and_b32 v121, 0xffff0000, v24
    v_lshlrev_b32 v122, 16, v25
    v_and_b32 v123, 0xffff0000, v25
    v_lshlrev_b32 v124, 16, v26
    v_and_b32 v125, 0xffff0000, v26
    v_lshlrev_b32 v126, 16, v27
    v_and_b32 v127, 0xffff0000, v27
    v_add_f32 v96, v96, v120
    v_add_f32 v97, v97, v121
    v_add_f32 v98, v98, v122
    v_add_f32 v99, v99, v123
    v_add_f32 v100, v100, v124
    v_add_f32 v101, v101, v125
    v_add_f32 v102, v102, v126
    v_add_f32 v103, v103, v127
    v_lshlrev_b32 v120, 16, v28
    v_and_b32 v121, 0xffff0000, v28
    v_lshlrev_b32 v122, 16, v29
    v_and_b32 v123, 0xffff0000, v29
    v_lshlrev_b32 v124, 16, v30
    v_and_b32 v125, 0xffff0000, v30
    v_lshlrev_b32 v126, 16, v31
    v_and_b32 v127, 0xffff0000, v31
    v_add_f32 v96, v96, v120
    v_add_f32 v97, v97, v121
    v_add_f32 v98, v98, v122
    v_add_f32 v99, v99, v123
    v_add_f32 v100, v100, v124
    v_add_f32 v101, v101, v125
    v_add_f32 v102, v102, v126
    v_add_f32 v103, v103, v127
    v_lshlrev_b32 v120, 16, v32
    v_and_b32 v121, 0xffff0000, v32
    v_lshlrev_b32 v122, 16, v33
    v_and_b32 v123, 0xffff0000, v33
    v_lshlrev_b32 v124, 16, v34
    v_and_b32 v125, 0xffff0000, v34
    v_lshlrev_b32 v126, 16, v35
    v_and_b32 v127, 0xffff0000, v35
    v_add_f32 v96, v96, v120
    v_add_f32 v97, v97, v121
    v_add_f32 v98, v98, v122
    v_add_f32 v99, v99, v123
    v_add_f32 v100, v100, v124
    v_add_f32 v101, v101, v125
    v_add_f32 v102, v102, v126
    v_add_f32 v103, v103, v127
    v_lshlrev_b32 v120, 16, v36
    v_and_b32 v121, 0xffff0000, v36
    v_lshlrev_b32 v122, 16, v37
    v_and_b32 v123, 0xffff0000, v37
    v_lshlrev_b32 v124, 16, v38
    v_and_b32 v125, 0xffff0000, v38
    v_lshlrev_b32 v126, 16, v39
    v_and_b32 v127, 0xffff0000, v39
    v_add_f32 v96, v96, v120
    v_add_f32 v97, v97, v121
    v_add_f32 v98, v98, v122
    v_add_f32 v99, v99, v123
    v_add_f32 v100, v100, v124
    v_add_f32 v101, v101, v125
    v_add_f32 v102, v102, v126
    v_add_f32 v103, v103, v127
    v_lshlrev_b32 v120, 16, v40
    v_and_b32 v121, 0xffff0000, v40
    v_lshlrev_b32 v122, 16, v41
    v_and_b32 v123, 0xffff0000, v41
    v_lshlrev_b32 v124, 16, v42
    v_and_b32 v125, 0xffff0000, v42
    v_lshlrev_b32 v126, 16, v43
    v_and_b32 v127, 0xffff0000, v43
    v_add_f32 v96, v96, v120
    v_add_f32 v97, v97, v121
    v_add_f32 v98, v98, v122
    v_add_f32 v99, v99, v123
    v_add_f32 v100, v100, v124
    v_add_f32 v101, v101, v125
    v_add_f32 v102, v102, v126
    v_add_f32 v103, v103, v127
    v_lshlrev_b32 v120, 16, v44
    v_and_b32 v121, 0xffff0000, v44
    v_lshlrev_b32 v122, 16, v45
    v_and_b32 v123, 0xffff0000, v45
    v_lshlrev_b32 v124, 16, v46
    v_and_b32 v125, 0xffff0000, v46
    v_lshlrev_b32 v126, 16, v47
    v_and_b32 v127, 0xffff0000, v47
    v_add_f32 v96, v96, v120
    v_add_f32 v97, v97, v121
    v_add_f32 v98, v98, v122
    v_add_f32 v99, v99, v123
    v_add_f32 v100, v100, v124
    v_add_f32 v101, v101, v125
    v_add_f32 v102, v102, v126
    v_add_f32 v103, v103, v127
    v_cndmask_b32 v108, v88, v90, s[76:77]
    v_cndmask_b32 v109, v89, v91, s[76:77]
    v_cndmask_b32 v110, v90, v88, s[76:77]
    v_cndmask_b32 v111, v91, v89, s[76:77]
    v_cvt_pk_bf16_f32 v104, v96, v97
    v_lshlrev_b32 v96, 16, v104
    v_and_b32 v97, 0xffff0000, v104
    v_lshlrev_b32 v104, 16, v136
    v_and_b32 v105, 0xffff0000, v136
    v_mul_f32 v96, v96, v104
    v_mul_f32 v97, v97, v105
    v_cvt_pk_bf16_f32 v104, v96, v97
    v_lshlrev_b32 v96, 16, v104
    v_and_b32 v97, 0xffff0000, v104
    v_lshlrev_b32 v104, 16, v108
    v_and_b32 v105, 0xffff0000, v108
    v_add_f32 v96, v96, v104
    v_add_f32 v97, v97, v105
    v_cvt_pk_bf16_f32 v112, v96, v97
    v_cvt_pk_bf16_f32 v104, v98, v99
    v_lshlrev_b32 v98, 16, v104
    v_and_b32 v99, 0xffff0000, v104
    v_lshlrev_b32 v104, 16, v137
    v_and_b32 v105, 0xffff0000, v137
    v_mul_f32 v98, v98, v104
    v_mul_f32 v99, v99, v105
    v_cvt_pk_bf16_f32 v104, v98, v99
    v_lshlrev_b32 v98, 16, v104
    v_and_b32 v99, 0xffff0000, v104
    v_lshlrev_b32 v104, 16, v109
    v_and_b32 v105, 0xffff0000, v109
    v_add_f32 v98, v98, v104
    v_add_f32 v99, v99, v105
    v_cvt_pk_bf16_f32 v113, v98, v99
    v_cvt_pk_bf16_f32 v104, v100, v101
    v_lshlrev_b32 v100, 16, v104
    v_and_b32 v101, 0xffff0000, v104
    v_lshlrev_b32 v104, 16, v138
    v_and_b32 v105, 0xffff0000, v138
    v_mul_f32 v100, v100, v104
    v_mul_f32 v101, v101, v105
    v_cvt_pk_bf16_f32 v104, v100, v101
    v_lshlrev_b32 v100, 16, v104
    v_and_b32 v101, 0xffff0000, v104
    v_lshlrev_b32 v104, 16, v110
    v_and_b32 v105, 0xffff0000, v110
    v_add_f32 v100, v100, v104
    v_add_f32 v101, v101, v105
    v_cvt_pk_bf16_f32 v114, v100, v101
    v_cvt_pk_bf16_f32 v104, v102, v103
    v_lshlrev_b32 v102, 16, v104
    v_and_b32 v103, 0xffff0000, v104
    v_lshlrev_b32 v104, 16, v139
    v_and_b32 v105, 0xffff0000, v139
    v_mul_f32 v102, v102, v104
    v_mul_f32 v103, v103, v105
    v_cvt_pk_bf16_f32 v104, v102, v103
    v_lshlrev_b32 v102, 16, v104
    v_and_b32 v103, 0xffff0000, v104
    v_lshlrev_b32 v104, 16, v111
    v_and_b32 v105, 0xffff0000, v111
    v_add_f32 v102, v102, v104
    v_add_f32 v103, v103, v105
    v_cvt_pk_bf16_f32 v115, v102, v103
    v_cndmask_b32 v128, v112, v114, s[76:77]
    v_cndmask_b32 v129, v113, v115, s[76:77]
    v_cndmask_b32 v130, v114, v112, s[76:77]
    v_cndmask_b32 v131, v115, v113, s[76:77]
    buffer_store_dwordx4 v[128:131], v4, s[12:15], s74 offen offset:0
    v_lshlrev_b32 v96, 16, v48
    v_and_b32 v97, 0xffff0000, v48
    v_lshlrev_b32 v98, 16, v49
    v_and_b32 v99, 0xffff0000, v49
    v_lshlrev_b32 v100, 16, v50
    v_and_b32 v101, 0xffff0000, v50
    v_lshlrev_b32 v102, 16, v51
    v_and_b32 v103, 0xffff0000, v51
    v_lshlrev_b32 v120, 16, v52
    v_and_b32 v121, 0xffff0000, v52
    v_lshlrev_b32 v122, 16, v53
    v_and_b32 v123, 0xffff0000, v53
    v_lshlrev_b32 v124, 16, v54
    v_and_b32 v125, 0xffff0000, v54
    v_lshlrev_b32 v126, 16, v55
    v_and_b32 v127, 0xffff0000, v55
    v_add_f32 v96, v96, v120
    v_add_f32 v97, v97, v121
    v_add_f32 v98, v98, v122
    v_add_f32 v99, v99, v123
    v_add_f32 v100, v100, v124
    v_add_f32 v101, v101, v125
    v_add_f32 v102, v102, v126
    v_add_f32 v103, v103, v127
    v_lshlrev_b32 v120, 16, v56
    v_and_b32 v121, 0xffff0000, v56
    v_lshlrev_b32 v122, 16, v57
    v_and_b32 v123, 0xffff0000, v57
    v_lshlrev_b32 v124, 16, v58
    v_and_b32 v125, 0xffff0000, v58
    v_lshlrev_b32 v126, 16, v59
    v_and_b32 v127, 0xffff0000, v59
    v_add_f32 v96, v96, v120
    v_add_f32 v97, v97, v121
    v_add_f32 v98, v98, v122
    v_add_f32 v99, v99, v123
    v_add_f32 v100, v100, v124
    v_add_f32 v101, v101, v125
    v_add_f32 v102, v102, v126
    v_add_f32 v103, v103, v127
    v_lshlrev_b32 v120, 16, v60
    v_and_b32 v121, 0xffff0000, v60
    v_lshlrev_b32 v122, 16, v61
    v_and_b32 v123, 0xffff0000, v61
    v_lshlrev_b32 v124, 16, v62
    v_and_b32 v125, 0xffff0000, v62
    v_lshlrev_b32 v126, 16, v63
    v_and_b32 v127, 0xffff0000, v63
    v_add_f32 v96, v96, v120
    v_add_f32 v97, v97, v121
    v_add_f32 v98, v98, v122
    v_add_f32 v99, v99, v123
    v_add_f32 v100, v100, v124
    v_add_f32 v101, v101, v125
    v_add_f32 v102, v102, v126
    v_add_f32 v103, v103, v127
    v_lshlrev_b32 v120, 16, v64
    v_and_b32 v121, 0xffff0000, v64
    v_lshlrev_b32 v122, 16, v65
    v_and_b32 v123, 0xffff0000, v65
    v_lshlrev_b32 v124, 16, v66
    v_and_b32 v125, 0xffff0000, v66
    v_lshlrev_b32 v126, 16, v67
    v_and_b32 v127, 0xffff0000, v67
    v_add_f32 v96, v96, v120
    v_add_f32 v97, v97, v121
    v_add_f32 v98, v98, v122
    v_add_f32 v99, v99, v123
    v_add_f32 v100, v100, v124
    v_add_f32 v101, v101, v125
    v_add_f32 v102, v102, v126
    v_add_f32 v103, v103, v127
    v_lshlrev_b32 v120, 16, v68
    v_and_b32 v121, 0xffff0000, v68
    v_lshlrev_b32 v122, 16, v69
    v_and_b32 v123, 0xffff0000, v69
    v_lshlrev_b32 v124, 16, v70
    v_and_b32 v125, 0xffff0000, v70
    v_lshlrev_b32 v126, 16, v71
    v_and_b32 v127, 0xffff0000, v71
    v_add_f32 v96, v96, v120
    v_add_f32 v97, v97, v121
    v_add_f32 v98, v98, v122
    v_add_f32 v99, v99, v123
    v_add_f32 v100, v100, v124
    v_add_f32 v101, v101, v125
    v_add_f32 v102, v102, v126
    v_add_f32 v103, v103, v127
    v_lshlrev_b32 v120, 16, v72
    v_and_b32 v121, 0xffff0000, v72
    v_lshlrev_b32 v122, 16, v73
    v_and_b32 v123, 0xffff0000, v73
    v_lshlrev_b32 v124, 16, v74
    v_and_b32 v125, 0xffff0000, v74
    v_lshlrev_b32 v126, 16, v75
    v_and_b32 v127, 0xffff0000, v75
    v_add_f32 v96, v96, v120
    v_add_f32 v97, v97, v121
    v_add_f32 v98, v98, v122
    v_add_f32 v99, v99, v123
    v_add_f32 v100, v100, v124
    v_add_f32 v101, v101, v125
    v_add_f32 v102, v102, v126
    v_add_f32 v103, v103, v127
    v_lshlrev_b32 v120, 16, v76
    v_and_b32 v121, 0xffff0000, v76
    v_lshlrev_b32 v122, 16, v77
    v_and_b32 v123, 0xffff0000, v77
    v_lshlrev_b32 v124, 16, v78
    v_and_b32 v125, 0xffff0000, v78
    v_lshlrev_b32 v126, 16, v79
    v_and_b32 v127, 0xffff0000, v79
    v_add_f32 v96, v96, v120
    v_add_f32 v97, v97, v121
    v_add_f32 v98, v98, v122
    v_add_f32 v99, v99, v123
    v_add_f32 v100, v100, v124
    v_add_f32 v101, v101, v125
    v_add_f32 v102, v102, v126
    v_add_f32 v103, v103, v127
    v_cndmask_b32 v108, v92, v94, s[76:77]
    v_cndmask_b32 v109, v93, v95, s[76:77]
    v_cndmask_b32 v110, v94, v92, s[76:77]
    v_cndmask_b32 v111, v95, v93, s[76:77]
    v_cvt_pk_bf16_f32 v104, v96, v97
    v_lshlrev_b32 v96, 16, v104
    v_and_b32 v97, 0xffff0000, v104
    v_lshlrev_b32 v104, 16, v140
    v_and_b32 v105, 0xffff0000, v140
    v_mul_f32 v96, v96, v104
    v_mul_f32 v97, v97, v105
    v_cvt_pk_bf16_f32 v104, v96, v97
    v_lshlrev_b32 v96, 16, v104
    v_and_b32 v97, 0xffff0000, v104
    v_lshlrev_b32 v104, 16, v108
    v_and_b32 v105, 0xffff0000, v108
    v_add_f32 v96, v96, v104
    v_add_f32 v97, v97, v105
    v_cvt_pk_bf16_f32 v112, v96, v97
    v_cvt_pk_bf16_f32 v104, v98, v99
    v_lshlrev_b32 v98, 16, v104
    v_and_b32 v99, 0xffff0000, v104
    v_lshlrev_b32 v104, 16, v141
    v_and_b32 v105, 0xffff0000, v141
    v_mul_f32 v98, v98, v104
    v_mul_f32 v99, v99, v105
    v_cvt_pk_bf16_f32 v104, v98, v99
    v_lshlrev_b32 v98, 16, v104
    v_and_b32 v99, 0xffff0000, v104
    v_lshlrev_b32 v104, 16, v109
    v_and_b32 v105, 0xffff0000, v109
    v_add_f32 v98, v98, v104
    v_add_f32 v99, v99, v105
    v_cvt_pk_bf16_f32 v113, v98, v99
    v_cvt_pk_bf16_f32 v104, v100, v101
    v_lshlrev_b32 v100, 16, v104
    v_and_b32 v101, 0xffff0000, v104
    v_lshlrev_b32 v104, 16, v142
    v_and_b32 v105, 0xffff0000, v142
    v_mul_f32 v100, v100, v104
    v_mul_f32 v101, v101, v105
    v_cvt_pk_bf16_f32 v104, v100, v101
    v_lshlrev_b32 v100, 16, v104
    v_and_b32 v101, 0xffff0000, v104
    v_lshlrev_b32 v104, 16, v110
    v_and_b32 v105, 0xffff0000, v110
    v_add_f32 v100, v100, v104
    v_add_f32 v101, v101, v105
    v_cvt_pk_bf16_f32 v114, v100, v101
    v_cvt_pk_bf16_f32 v104, v102, v103
    v_lshlrev_b32 v102, 16, v104
    v_and_b32 v103, 0xffff0000, v104
    v_lshlrev_b32 v104, 16, v143
    v_and_b32 v105, 0xffff0000, v143
    v_mul_f32 v102, v102, v104
    v_mul_f32 v103, v103, v105
    v_cvt_pk_bf16_f32 v104, v102, v103
    v_lshlrev_b32 v102, 16, v104
    v_and_b32 v103, 0xffff0000, v104
    v_lshlrev_b32 v104, 16, v111
    v_and_b32 v105, 0xffff0000, v111
    v_add_f32 v102, v102, v104
    v_add_f32 v103, v103, v105
    v_cvt_pk_bf16_f32 v115, v102, v103
    v_cndmask_b32 v132, v112, v114, s[76:77]
    v_cndmask_b32 v133, v113, v115, s[76:77]
    v_cndmask_b32 v134, v114, v112, s[76:77]
    v_cndmask_b32 v135, v115, v113, s[76:77]
    buffer_store_dwordx4 v[132:135], v4, s[12:15], s74 offen offset:64
    s_branch w_fin_done
fin_tail:
    s_mov_b32 s81, s36
    s_lshl_b32 s81, s81, 2
    s_and_b32 s82, s3, 3
    s_add_u32 s81, s81, s82
    s_lshr_b32 s82, s81, 5
    s_and_b32 s81, s81, 31
    s_lshl_b32 s72, s80, 1
    s_add_u32 s72, s72, s82
    s_lshl_b32 s74, s72, 15
    s_lshl_b32 s73, s81, 10
    s_add_u32 s73, s73, s74
    s_lshl_b32 s75, s81, 6
    s_add_u32 s74, s74, s75
    s_add_u32 s78, s73, 117440512
    s_add_u32 s79, s73, 75497472
    s_mov_b32 s83, 218106816
    s_mov_b32 s84, 65536
    s_min_u32 s87, s80, 62
    v_and_b32 v8, 7, v1
    v_lshlrev_b32 v8, 22, v8
    s_cmp_lg_u32 s3, 0
    s_cbranch_scc1 ft_ok
ft_wd:
    buffer_load_dword v7, off, s[4:7], s83 sc1
    s_waitcnt vmcnt(0)
    v_readfirstlane_b32 s86, v7
    s_cmp_ge_u32 s86, 16
    s_cbranch_scc1 ft_wdok
    s_sleep 32
    s_sub_u32 s84, s84, 1
    s_cbranch_scc0 ft_wd
    s_mov_b32 s84, 0
ft_wdok:
ft_ok:
    s_barrier
    s_cmp_ge_u32 s3, 4
    s_cbranch_scc1 w_fin_done
    buffer_load_dwordx4 v[88:91], v4, s[8:11], s74 offen
    buffer_load_dwordx4 v[136:139], v3, s[4:7], s78 offen sc1
    s_add_u32 s78, s78, 4194304
    buffer_load_dwordx4 v[144:147], v3, s[4:7], s78 offen sc1
    s_add_u32 s78, s78, 4194304
    buffer_load_dwordx4 v[152:155], v3, s[4:7], s78 offen sc1
    s_add_u32 s78, s78, 4194304
    buffer_load_dwordx4 v[160:163], v3, s[4:7], s78 offen sc1
    s_add_u32 s78, s78, 4194304
    s_waitcnt vmcnt(0)
    v_lshlrev_b32 v120, 16, v136
    v_and_b32 v121, 0xffff0000, v136
    v_lshlrev_b32 v136, 16, v144
    v_and_b32 v144, 0xffff0000, v144
    v_add_f32 v120, v120, v136
    v_add_f32 v121, v121, v144
    v_lshlrev_b32 v136, 16, v152
    v_and_b32 v152, 0xffff0000, v152
    v_add_f32 v120, v120, v136
    v_add_f32 v121, v121, v152
    v_lshlrev_b32 v136, 16, v160
    v_and_b32 v160, 0xffff0000, v160
    v_add_f32 v120, v120, v136
    v_add_f32 v121, v121, v160
    v_cvt_pk_bf16_f32 v136, v120, v121
    v_lshlrev_b32 v120, 16, v136
    v_and_b32 v121, 0xffff0000, v136
    v_mul_f32 v136, s89, v120
    v_mul_f32 v144, s89, v121
    v_lshlrev_b32 v122, 16, v137
    v_and_b32 v123, 0xffff0000, v137
    v_lshlrev_b32 v137, 16, v145
    v_and_b32 v145, 0xffff0000, v145
    v_add_f32 v122, v122, v137
    v_add_f32 v123, v123, v145
    v_lshlrev_b32 v137, 16, v153
    v_and_b32 v153, 0xffff0000, v153
    v_add_f32 v122, v122, v137
    v_add_f32 v123, v123, v153
    v_lshlrev_b32 v137, 16, v161
    v_and_b32 v161, 0xffff0000, v161
    v_add_f32 v122, v122, v137
    v_add_f32 v123, v123, v161
    v_cvt_pk_bf16_f32 v137, v122, v123
    v_lshlrev_b32 v122, 16, v137
    v_and_b32 v123, 0xffff0000, v137
    v_mul_f32 v137, s89, v122
    v_mul_f32 v145, s89, v123
    v_lshlrev_b32 v124, 16, v138
    v_and_b32 v125, 0xffff0000, v138
    v_lshlrev_b32 v138, 16, v146
    v_and_b32 v146, 0xffff0000, v146
    v_add_f32 v124, v124, v138
    v_add_f32 v125, v125, v146
    v_lshlrev_b32 v138, 16, v154
    v_and_b32 v154, 0xffff0000, v154
    v_add_f32 v124, v124, v138
    v_add_f32 v125, v125, v154
    v_lshlrev_b32 v138, 16, v162
    v_and_b32 v162, 0xffff0000, v162
    v_add_f32 v124, v124, v138
    v_add_f32 v125, v125, v162
    v_cvt_pk_bf16_f32 v138, v124, v125
    v_lshlrev_b32 v124, 16, v138
    v_and_b32 v125, 0xffff0000, v138
    v_mul_f32 v138, s89, v124
    v_mul_f32 v146, s89, v125
    v_lshlrev_b32 v126, 16, v139
    v_and_b32 v127, 0xffff0000, v139
    v_lshlrev_b32 v139, 16, v147
    v_and_b32 v147, 0xffff0000, v147
    v_add_f32 v126, v126, v139
    v_add_f32 v127, v127, v147
    v_lshlrev_b32 v139, 16, v155
    v_and_b32 v155, 0xffff0000, v155
    v_add_f32 v126, v126, v139
    v_add_f32 v127, v127, v155
    v_lshlrev_b32 v139, 16, v163
    v_and_b32 v163, 0xffff0000, v163
    v_add_f32 v126, v126, v139
    v_add_f32 v127, v127, v163
    v_cvt_pk_bf16_f32 v139, v126, v127
    v_lshlrev_b32 v126, 16, v139
    v_and_b32 v127, 0xffff0000, v139
    v_mul_f32 v139, s89, v126
    v_mul_f32 v147, s89, v127
    v_exp_f32 v136, v136
    v_exp_f32 v144, v144
    v_exp_f32 v137, v137
    v_exp_f32 v145, v145
    v_exp_f32 v138, v138
    v_exp_f32 v146, v146
    v_exp_f32 v139, v139
    v_exp_f32 v147, v147
    s_nop 0
    v_add_f32 v136, 1.0, v136
    v_add_f32 v144, 1.0, v144
    v_add_f32 v137, 1.0, v137
    v_add_f32 v145, 1.0, v145
    v_add_f32 v138, 1.0, v138
    v_add_f32 v146, 1.0, v146
    v_add_f32 v139, 1.0, v139
    v_add_f32 v147, 1.0, v147
    v_rcp_f32 v136, v136
    v_rcp_f32 v144, v144
    v_rcp_f32 v137, v137
    v_rcp_f32 v145, v145
    v_rcp_f32 v138, v138
    v_rcp_f32 v146, v146
    v_rcp_f32 v139, v139
    v_rcp_f32 v147, v147
    s_nop 0
    v_mul_f32 v120, v120, v136
    v_mul_f32 v121, v121, v144
    v_cvt_pk_bf16_f32 v136, v120, v121
    v_mul_f32 v122, v122, v137
    v_mul_f32 v123, v123, v145
    v_cvt_pk_bf16_f32 v137, v122, v123
    v_mul_f32 v124, v124, v138
    v_mul_f32 v125, v125, v146
    v_cvt_pk_bf16_f32 v138, v124, v125
    v_mul_f32 v126, v126, v139
    v_mul_f32 v127, v127, v147
    v_cvt_pk_bf16_f32 v139, v126, v127
ft_ws:
    buffer_load_dword v7, v6, s[4:7], s85 offen sc1
    s_waitcnt vmcnt(0)
    v_cmp_gt_u32 vcc, s87, v7
    s_cbranch_vccz ft_p
    s_sleep 12
    v_cmp_gt_u32 vcc, 59, v7
    s_cbranch_vccz ft_wsf
    s_sleep 64
    v_cmp_gt_u32 vcc, 56, v7
    s_cbranch_vccz ft_wsf
    s_sleep 127
    s_sleep 127
ft_wsf:
    s_sub_u32 s84, s84, 1
    s_cbranch_scc0 ft_ws
    s_mov_b32 s84, 0
ft_p:
    buffer_load_dword v7, v8, s[4:7], s79 offen offset:1008 sc1
    s_waitcnt vmcnt(0)
    v_cmp_eq_u32 vcc, -1, v7
    s_cbranch_vccz ft_l0
    s_sleep 4
    s_sub_u32 s84, s84, 1
    s_cbranch_scc0 ft_p
    s_mov_b32 s84, 0
ft_l0:
    s_cmp_lg_u32 s3, 0
    s_cbranch_scc1 clm_14
    v_mov_b32 v250, 1
    s_mov_b64 exec, 1
    buffer_atomic_add v250, off, s[64:67], s71 sc0 sc1
    s_mov_b64 exec, -1
clm_14:
ft_l:
    s_mov_b32 s86, s79
    buffer_load_dwordx4 v[16:19], v3, s[4:7], s86 offen sc1
    s_add_u32 s86, s86, 4194304
    buffer_load_dwordx4 v[20:23], v3, s[4:7], s86 offen sc1
    s_add_u32 s86, s86, 4194304
    buffer_load_dwordx4 v[24:27], v3, s[4:7], s86 offen sc1
    s_add_u32 s86, s86, 4194304
    buffer_load_dwordx4 v[28:31], v3, s[4:7], s86 offen sc1
    s_add_u32 s86, s86, 4194304
    buffer_load_dwordx4 v[32:35], v3, s[4:7], s86 offen sc1
    s_add_u32 s86, s86, 4194304
    buffer_load_dwordx4 v[36:39], v3, s[4:7], s86 offen sc1
    s_add_u32 s86, s86, 4194304
    buffer_load_dwordx4 v[40:43], v3, s[4:7], s86 offen sc1
    s_add_u32 s86, s86, 4194304
    buffer_load_dwordx4 v[44:47], v3, s[4:7], s86 offen sc1
    s_waitcnt vmcnt(0)
    v_max3_u32 v7, v16, v20, v24
    v_max3_u32 v7, v7, v28, v32
    v_max3_u32 v7, v7, v36, v40
    v_max_u32 v7, v7, v44
    v_cmp_eq_u32 vcc, -1, v7
    s_cbranch_vccz ft_go
    s_sub_u32 s84, s84, 1
    s_cbranch_scc0 ft_l
ft_go:
    v_lshlrev_b32 v96, 16, v16
    v_and_b32 v97, 0xffff0000, v16
    v_lshlrev_b32 v98, 16, v17
    v_and_b32 v99, 0xffff0000, v17
    v_lshlrev_b32 v100, 16, v18
    v_and_b32 v101, 0xffff0000, v18
    v_lshlrev_b32 v102, 16, v19
    v_and_b32 v103, 0xffff0000, v19
    v_lshlrev_b32 v120, 16, v20
    v_and_b32 v121, 0xffff0000, v20
    v_lshlrev_b32 v122, 16, v21
    v_and_b32 v123, 0xffff0000, v21
    v_lshlrev_b32 v124, 16, v22
    v_and_b32 v125, 0xffff0000, v22
    v_lshlrev_b32 v126, 16, v23
    v_and_b32 v127, 0xffff0000, v23
    v_add_f32 v96, v96, v120
    v_add_f32 v97, v97, v121
    v_add_f32 v98, v98, v122
    v_add_f32 v99, v99, v123
    v_add_f32 v100, v100, v124
    v_add_f32 v101, v101, v125
    v_add_f32 v102, v102, v126
    v_add_f32 v103, v103, v127
    v_lshlrev_b32 v120, 16, v24
    v_and_b32 v121, 0xffff0000, v24
    v_lshlrev_b32 v122, 16, v25
    v_and_b32 v123, 0xffff0000, v25
    v_lshlrev_b32 v124, 16, v26
    v_and_b32 v125, 0xffff0000, v26
    v_lshlrev_b32 v126, 16, v27
    v_and_b32 v127, 0xffff0000, v27
    v_add_f32 v96, v96, v120
    v_add_f32 v97, v97, v121
    v_add_f32 v98, v98, v122
    v_add_f32 v99, v99, v123
    v_add_f32 v100, v100, v124
    v_add_f32 v101, v101, v125
    v_add_f32 v102, v102, v126
    v_add_f32 v103, v103, v127
    v_lshlrev_b32 v120, 16, v28
    v_and_b32 v121, 0xffff0000, v28
    v_lshlrev_b32 v122, 16, v29
    v_and_b32 v123, 0xffff0000, v29
    v_lshlrev_b32 v124, 16, v30
    v_and_b32 v125, 0xffff0000, v30
    v_lshlrev_b32 v126, 16, v31
    v_and_b32 v127, 0xffff0000, v31
    v_add_f32 v96, v96, v120
    v_add_f32 v97, v97, v121
    v_add_f32 v98, v98, v122
    v_add_f32 v99, v99, v123
    v_add_f32 v100, v100, v124
    v_add_f32 v101, v101, v125
    v_add_f32 v102, v102, v126
    v_add_f32 v103, v103, v127
    v_lshlrev_b32 v120, 16, v32
    v_and_b32 v121, 0xffff0000, v32
    v_lshlrev_b32 v122, 16, v33
    v_and_b32 v123, 0xffff0000, v33
    v_lshlrev_b32 v124, 16, v34
    v_and_b32 v125, 0xffff0000, v34
    v_lshlrev_b32 v126, 16, v35
    v_and_b32 v127, 0xffff0000, v35
    v_add_f32 v96, v96, v120
    v_add_f32 v97, v97, v121
    v_add_f32 v98, v98, v122
    v_add_f32 v99, v99, v123
    v_add_f32 v100, v100, v124
    v_add_f32 v101, v101, v125
    v_add_f32 v102, v102, v126
    v_add_f32 v103, v103, v127
    v_lshlrev_b32 v120, 16, v36
    v_and_b32 v121, 0xffff0000, v36
    v_lshlrev_b32 v122, 16, v37
    v_and_b32 v123, 0xffff0000, v37
    v_lshlrev_b32 v124, 16, v38
    v_and_b32 v125, 0xffff0000, v38
    v_lshlrev_b32 v126, 16, v39
    v_and_b32 v127, 0xffff0000, v39
    v_add_f32 v96, v96, v120
    v_add_f32 v97, v97, v121
    v_add_f32 v98, v98, v122
    v_add_f32 v99, v99, v123
    v_add_f32 v100, v100, v124
    v_add_f32 v101, v101, v125
    v_add_f32 v102, v102, v126
    v_add_f32 v103, v103, v127
    v_lshlrev_b32 v120, 16, v40
    v_and_b32 v121, 0xffff0000, v40
    v_lshlrev_b32 v122, 16, v41
    v_and_b32 v123, 0xffff0000, v41
    v_lshlrev_b32 v124, 16, v42
    v_and_b32 v125, 0xffff0000, v42
    v_lshlrev_b32 v126, 16, v43
    v_and_b32 v127, 0xffff0000, v43
    v_add_f32 v96, v96, v120
    v_add_f32 v97, v97, v121
    v_add_f32 v98, v98, v122
    v_add_f32 v99, v99, v123
    v_add_f32 v100, v100, v124
    v_add_f32 v101, v101, v125
    v_add_f32 v102, v102, v126
    v_add_f32 v103, v103, v127
    v_lshlrev_b32 v120, 16, v44
    v_and_b32 v121, 0xffff0000, v44
    v_lshlrev_b32 v122, 16, v45
    v_and_b32 v123, 0xffff0000, v45
    v_lshlrev_b32 v124, 16, v46
    v_and_b32 v125, 0xffff0000, v46
    v_lshlrev_b32 v126, 16, v47
    v_and_b32 v127, 0xffff0000, v47
    v_add_f32 v96, v96, v120
    v_add_f32 v97, v97, v121
    v_add_f32 v98, v98, v122
    v_add_f32 v99, v99, v123
    v_add_f32 v100, v100, v124
    v_add_f32 v101, v101, v125
    v_add_f32 v102, v102, v126
    v_add_f32 v103, v103, v127
    v_cndmask_b32 v108, v88, v90, s[76:77]
    v_cndmask_b32 v109, v89, v91, s[76:77]
    v_cndmask_b32 v110, v90, v88, s[76:77]
    v_cndmask_b32 v111, v91, v89, s[76:77]
    v_cvt_pk_bf16_f32 v104, v96, v97
    v_lshlrev_b32 v96, 16, v104
    v_and_b32 v97, 0xffff0000, v104
    v_lshlrev_b32 v104, 16, v136
    v_and_b32 v105, 0xffff0000, v136
    v_mul_f32 v96, v96, v104
    v_mul_f32 v97, v97, v105
    v_cvt_pk_bf16_f32 v104, v96, v97
    v_lshlrev_b32 v96, 16, v104
    v_and_b32 v97, 0xffff0000, v104
    v_lshlrev_b32 v104, 16, v108
    v_and_b32 v105, 0xffff0000, v108
    v_add_f32 v96, v96, v104
    v_add_f32 v97, v97, v105
    v_cvt_pk_bf16_f32 v112, v96, v97
    v_cvt_pk_bf16_f32 v104, v98, v99
    v_lshlrev_b32 v98, 16, v104
    v_and_b32 v99, 0xffff0000, v104
    v_lshlrev_b32 v104, 16, v137
    v_and_b32 v105, 0xffff0000, v137
    v_mul_f32 v98, v98, v104
    v_mul_f32 v99, v99, v105
    v_cvt_pk_bf16_f32 v104, v98, v99
    v_lshlrev_b32 v98, 16, v104
    v_and_b32 v99, 0xffff0000, v104
    v_lshlrev_b32 v104, 16, v109
    v_and_b32 v105, 0xffff0000, v109
    v_add_f32 v98, v98, v104
    v_add_f32 v99, v99, v105
    v_cvt_pk_bf16_f32 v113, v98, v99
    v_cvt_pk_bf16_f32 v104, v100, v101
    v_lshlrev_b32 v100, 16, v104
    v_and_b32 v101, 0xffff0000, v104
    v_lshlrev_b32 v104, 16, v138
    v_and_b32 v105, 0xffff0000, v138
    v_mul_f32 v100, v100, v104
    v_mul_f32 v101, v101, v105
    v_cvt_pk_bf16_f32 v104, v100, v101
    v_lshlrev_b32 v100, 16, v104
    v_and_b32 v101, 0xffff0000, v104
    v_lshlrev_b32 v104, 16, v110
    v_and_b32 v105, 0xffff0000, v110
    v_add_f32 v100, v100, v104
    v_add_f32 v101, v101, v105
    v_cvt_pk_bf16_f32 v114, v100, v101
    v_cvt_pk_bf16_f32 v104, v102, v103
    v_lshlrev_b32 v102, 16, v104
    v_and_b32 v103, 0xffff0000, v104
    v_lshlrev_b32 v104, 16, v139
    v_and_b32 v105, 0xffff0000, v139
    v_mul_f32 v102, v102, v104
    v_mul_f32 v103, v103, v105
    v_cvt_pk_bf16_f32 v104, v102, v103
    v_lshlrev_b32 v102, 16, v104
    v_and_b32 v103, 0xffff0000, v104
    v_lshlrev_b32 v104, 16, v111
    v_and_b32 v105, 0xffff0000, v111
    v_add_f32 v102, v102, v104
    v_add_f32 v103, v103, v105
    v_cvt_pk_bf16_f32 v115, v102, v103
    v_cndmask_b32 v128, v112, v114, s[76:77]
    v_cndmask_b32 v129, v113, v115, s[76:77]
    v_cndmask_b32 v130, v114, v112, s[76:77]
    v_cndmask_b32 v131, v115, v113, s[76:77]
    buffer_store_dwordx4 v[128:131], v4, s[12:15], s74 offen offset:0
    s_branch w_fin_done
w_fin_done:
    s_cmp_lg_u32 s3, 0
    s_cbranch_scc1 pub_15
    v_mov_b32 v20, 131136
    s_mov_b64 exec, 1
    ds_write_b32 v20, v250
    s_mov_b64 exec, -1
    s_waitcnt lgkmcnt(0)
pub_15:
    s_barrier
    v_mov_b32 v20, 131136
    ds_read_b32 v20, v20
    s_waitcnt lgkmcnt(0)
    v_readfirstlane_b32 s59, v20
    s_add_u32 s59, s59, 32
    s_min_u32 s59, s59, 337
    s_lshl_b32 s57, s59, 6
    s_load_dwordx16 s[32:47], s[24:25], s57
    s_waitcnt lgkmcnt(0)
    s_barrier
    s_sub_u32 s57, s32, 1
    s_cmp_ge_u32 s57, 5
    s_cbranch_scc1 w_cold
    v_and_b32 v20, 63, v0
    v_lshlrev_b32 v1, 4, v20
    v_add_u32 v19, 0x1000, v1
    v_lshrrev_b32 v4, 4, v20
    v_mov_b32 v17, 0
    v_mov_b32 v18, 1
    s_lshr_b32 s26, s3, 2
    s_and_b32 s27, s3, 3
    s_lshl_b32 s21, s3, 11
    s_lshl_b32 s22, s3, 10
    s_add_u32 s22, s22, 16384
    s_mov_b32 s11, 131072
    s_mov_b32 s15, 131072
    s_mov_b32 s28, 0
    v_and_b32 v21, 15, v20
    v_lshlrev_b32 v22, 2, v4
    v_xor_b32 v21, v21, v22
    s_lshr_b32 s30, s3, 1
    s_and_b32 s30, s30, 1
    v_xor_b32 v21, s30, v21
    v_lshlrev_b32 v3, 4, v21
    s_lshl_b32 s30, s26, 13
    v_add_u32 v5, s30, v1
    v_add_u32 v6, 0x10000, v5
    v_bfe_u32 v21, v20, 2, 2
    v_and_b32 v22, 3, v20
    v_and_b32 v23, 1, v4
    v_xor_b32 v24, s27, v21
    v_xor_b32 v25, v22, v23
    v_lshl_add_u32 v24, v24, 2, v25
    v_lshlrev_b32 v24, 4, v24
    v_lshl_add_u32 v25, v4, 3, v21
    v_lshl_add_u32 v24, v25, 8, v24
    v_and_b32 v22, 1, v22
    v_xor_b32 v25, 0, v23
    v_lshl_add_u32 v8, v25, 10, v24
    v_xor_b32 v25, 0, v22
    v_lshl_add_u32 v8, v25, 3, v8
    v_add_u32 v12, 0x10000, v8
    v_xor_b32 v25, 1, v23
    v_lshl_add_u32 v9, v25, 10, v24
    v_xor_b32 v25, 0, v22
    v_lshl_add_u32 v9, v25, 3, v9
    v_add_u32 v13, 0x10000, v9
    v_xor_b32 v25, 0, v23
    v_lshl_add_u32 v10, v25, 10, v24
    v_xor_b32 v25, 1, v22
    v_lshl_add_u32 v10, v25, 3, v10
    v_add_u32 v14, 0x10000, v10
    v_xor_b32 v25, 1, v23
    v_lshl_add_u32 v11, v25, 10, v24
    v_xor_b32 v25, 1, v22
    v_lshl_add_u32 v11, v25, 3, v11
    v_add_u32 v15, 0x10000, v11
    s_lshl_b32 s30, s3, 2
    s_add_u32 s30, s30, 131072
    v_mov_b32 v7, s30
    s_branch w_cold
chain_map:
    s_lshl_b32 s52, s12, 5
    s_add_u32 s52, s52, s13
    s_lshr_b32 s15, s52, 2
    s_lshr_b32 s14, s52, 4
    s_and_b32 s34, s13, 15
    s_and_b32 s53, s13, 3
    s_mov_b32 s16, 0
    s_mov_b32 s22, 131072
    s_mov_b32 s100, 131072
    s_getreg_b32 s40, hwreg(HW_REG_XCC_ID)
    s_and_b32 s40, s40, 15
    s_mul_i32 s19, s40, s40
    s_lshl_b32 s19, s19, 18
    s_lshl_b32 s40, s40, 8
    s_add_u32 s40, s40, s19
    s_add_u32 s40, s40, 1
    s_lshl_b32 s35, s14, 4
    s_add_u32 s35, s35, 218104320
    s_and_b32 s21, s3, 3
    s_mul_i32 s42, s21, 24576
    s_add_u32 s42, s42, 65536
    s_lshl_b32 s41, s14, 2
    s_add_u32 s41, s41, s21
    s_lshl_b32 s41, s41, 12
    s_cmp_ge_u32 s3, 4
    s_cbranch_scc1 ch_a_pro
    s_add_u32 s41, s41, 262144
    s_lshl_b32 s38, s15, 13
    s_add_u32 s38, s38, 214958080
    s_lshl_b32 s17, s13, 1
    s_and_b32 s18, s3, 1
    s_add_u32 s17, s17, s18
    s_lshl_b32 s17, s17, 1
    s_cmp_lt_u32 s3, 2
    s_cselect_b32 s56, 0xff, 0
    s_mov_b32 s57, s56
    s_lshr_b32 s18, s17, 1
    s_and_b32 s19, s17, 1
    s_lshl_b32 s20, s12, 14
    s_add_u32 s20, s20, 213909504
    s_lshl_b32 s36, s3, 12
    s_add_u32 s36, s36, s20
    s_lshl_b32 s37, s18, 8
    s_add_u32 s37, s37, s20
    s_lshl_b32 s20, s19, 5
    s_add_u32 s37, s37, s20
    s_lshr_b32 s39, s17, 3
    s_lshl_b32 s39, s39, 14
    s_and_b32 s20, s17, 7
    s_lshl_b32 s20, s20, 10
    s_add_u32 s39, s39, s20
    s_add_u32 s39, s39, 209715200
    s_lshl_b32 s30, s14, 22
    s_lshl_b32 s20, s34, 11
    s_add_u32 s30, s30, s20
    s_lshl_b32 s20, s3, 9
    s_add_u32 s30, s30, s20
    s_add_u32 s30, s30, 78643200
    s_lshl_b32 s55, s15, 13
    s_add_u32 s55, s55, 192937984
    s_mov_b32 s26, s38
    s_mov_b32 s54, s30
    s_mov_b32 s29, 2
    s_mov_b32 s58, 0
    s_mov_b32 s59, 0
    s_bfe_u32 s17, s34, 0x20001
    s_lshl_b32 s60, s14, 2
    s_add_u32 s60, s60, s17
    s_lshl_b32 s60, s60, 2
    s_add_u32 s60, s60, s3
    s_lshl_b32 s60, s60, 10
    s_and_b32 s17, s34, 1
    s_lshl_b32 s17, s17, 17
    s_add_u32 s60, s60, s17
    s_add_u32 s60, s60, 175898624
    s_mov_b32 s31, 786432
    v_and_b32 v20, 63, v0
    v_lshlrev_b32 v1, 4, v20
    v_mov_b32 v10, -1
    v_mov_b32 v11, -1
    v_lshrrev_b32 v21, 2, v20
    v_and_b32 v22, 3, v20
    v_lshlrev_b32 v21, 13, v21
    v_lshl_add_u32 v21, v22, 4, v21
    s_lshl_b32 s17, s3, 21
    s_lshl_b32 s18, s52, 6
    s_add_u32 s17, s17, s18
    s_lshl_b32 s19, s3, 15
    s_mov_b32 s10, 8388608
    s_mov_b32 s11, 131072
    v_lshrrev_b32 v24, 5, v20
    v_bfe_u32 v25, v20, 3, 1
    v_lshl_add_u32 v24, v24, 1, v25
    v_bfe_u32 v26, v20, 4, 1
    v_xor_b32 v26, v26, v25
    v_lshl_add_u32 v24, v24, 1, v26
    v_bfe_u32 v25, v20, 2, 1
    v_lshl_add_u32 v24, v24, 2, v25
    v_lshlrev_b32 v24, 6, v24
    v_lshl_add_u32 v24, v22, 3, v24
    v_add_u32 v24, s19, v24
    s_and_b32 s70, s13, 0
    s_lshl_b32 s72, s70, 20
    s_lshl_b32 s73, s70, 21
    s_lshl_b32 s70, s70, 13
    s_sub_u32 s71, s19, s70
    s_add_u32 s70, s19, s70
    s_load_dwordx2 s[8:9], s[0:1], 16
    s_add_u32 s20, s17, s72
    s_waitcnt lgkmcnt(0)
    s_add_u32 m0, s70, 0
    s_nop 0
    buffer_load_dwordx4 v21, s[8:11], s20 offen lds
    s_add_u32 s20, s20, 131072
    s_add_u32 m0, s70, 1024
    s_nop 0
    buffer_load_dwordx4 v21, s[8:11], s20 offen lds
    s_add_u32 s20, s20, 131072
    s_add_u32 m0, s70, 2048
    s_nop 0
    buffer_load_dwordx4 v21, s[8:11], s20 offen lds
    s_add_u32 s20, s20, 131072
    s_add_u32 m0, s70, 3072
    s_nop 0
    buffer_load_dwordx4 v21, s[8:11], s20 offen lds
    s_add_u32 s20, s20, 131072
    s_add_u32 m0, s70, 4096
    s_nop 0
    buffer_load_dwordx4 v21, s[8:11], s20 offen lds
    s_add_u32 s20, s20, 131072
    s_add_u32 m0, s70, 5120
    s_nop 0
    buffer_load_dwordx4 v21, s[8:11], s20 offen lds
    s_add_u32 s20, s20, 131072
    s_add_u32 m0, s70, 6144
    s_nop 0
    buffer_load_dwordx4 v21, s[8:11], s20 offen lds
    s_add_u32 s20, s20, 131072
    s_add_u32 m0, s70, 7168
    s_nop 0
    buffer_load_dwordx4 v21, s[8:11], s20 offen lds
    s_add_u32 s20, s20, 131072
    s_sub_u32 s20, s20, s73
    s_add_u32 m0, s71, 8192
    s_nop 0
    buffer_load_dwordx4 v21, s[8:11], s20 offen lds
    s_add_u32 s20, s20, 131072
    s_add_u32 m0, s71, 9216
    s_nop 0
    buffer_load_dwordx4 v21, s[8:11], s20 offen lds
    s_add_u32 s20, s20, 131072
    s_add_u32 m0, s71, 10240
    s_nop 0
    buffer_load_dwordx4 v21, s[8:11], s20 offen lds
    s_add_u32 s20, s20, 131072
    s_add_u32 m0, s71, 11264
    s_nop 0
    buffer_load_dwordx4 v21, s[8:11], s20 offen lds
    s_add_u32 s20, s20, 131072
    s_add_u32 m0, s71, 12288
    s_nop 0
    buffer_load_dwordx4 v21, s[8:11], s20 offen lds
    s_add_u32 s20, s20, 131072
    s_add_u32 m0, s71, 13312
    s_nop 0
    buffer_load_dwordx4 v21, s[8:11], s20 offen lds
    s_add_u32 s20, s20, 131072
    s_add_u32 m0, s71, 14336
    s_nop 0
    buffer_load_dwordx4 v21, s[8:11], s20 offen lds
    s_add_u32 s20, s20, 131072
    s_add_u32 m0, s71, 15360
    s_nop 0
    buffer_load_dwordx4 v21, s[8:11], s20 offen lds
    s_add_u32 s20, s20, 131072
    s_load_dwordx2 s[8:9], s[0:1], 24
    s_add_u32 s20, s17, s72
    s_waitcnt lgkmcnt(0)
    s_add_u32 m0, s70, 16384
    s_nop 0
    buffer_load_dwordx4 v21, s[8:11], s20 offen lds
    s_add_u32 s20, s20, 131072
    s_add_u32 m0, s70, 17408
    s_nop 0
    buffer_load_dwordx4 v21, s[8:11], s20 offen lds
    s_add_u32 s20, s20, 131072
    s_add_u32 m0, s70, 18432
    s_nop 0
    buffer_load_dwordx4 v21, s[8:11], s20 offen lds
    s_add_u32 s20, s20, 131072
    s_add_u32 m0, s70, 19456
    s_nop 0
    buffer_load_dwordx4 v21, s[8:11], s20 offen lds
    s_add_u32 s20, s20, 131072
    s_add_u32 m0, s70, 20480
    s_nop 0
    buffer_load_dwordx4 v21, s[8:11], s20 offen lds
    s_add_u32 s20, s20, 131072
    s_add_u32 m0, s70, 21504
    s_nop 0
    buffer_load_dwordx4 v21, s[8:11], s20 offen lds
    s_add_u32 s20, s20, 131072
    s_add_u32 m0, s70, 22528
    s_nop 0
    buffer_load_dwordx4 v21, s[8:11], s20 offen lds
    s_add_u32 s20, s20, 131072
    s_add_u32 m0, s70, 23552
    s_nop 0
    buffer_load_dwordx4 v21, s[8:11], s20 offen lds
    s_add_u32 s20, s20, 131072
    s_sub_u32 s20, s20, s73
    s_add_u32 m0, s71, 24576
    s_nop 0
    buffer_load_dwordx4 v21, s[8:11], s20 offen lds
    s_add_u32 s20, s20, 131072
    s_add_u32 m0, s71, 25600
    s_nop 0
    buffer_load_dwordx4 v21, s[8:11], s20 offen lds
    s_add_u32 s20, s20, 131072
    s_add_u32 m0, s71, 26624
    s_nop 0
    buffer_load_dwordx4 v21, s[8:11], s20 offen lds
    s_add_u32 s20, s20, 131072
    s_add_u32 m0, s71, 27648
    s_nop 0
    buffer_load_dwordx4 v21, s[8:11], s20 offen lds
    s_add_u32 s20, s20, 131072
    s_add_u32 m0, s71, 28672
    s_nop 0
    buffer_load_dwordx4 v21, s[8:11], s20 offen lds
    s_add_u32 s20, s20, 131072
    s_add_u32 m0, s71, 29696
    s_nop 0
    buffer_load_dwordx4 v21, s[8:11], s20 offen lds
    s_add_u32 s20, s20, 131072
    s_add_u32 m0, s71, 30720
    s_nop 0
    buffer_load_dwordx4 v21, s[8:11], s20 offen lds
    s_add_u32 s20, s20, 131072
    s_add_u32 m0, s71, 31744
    s_nop 0
    buffer_load_dwordx4 v21, s[8:11], s20 offen lds
    s_add_u32 s20, s20, 131072
    s_load_dwordx2 s[8:9], s[0:1], 32
    s_add_u32 s20, s17, s72
    s_waitcnt lgkmcnt(0)
    buffer_load_dwordx4 v[96:99], v21, s[8:11], s20 offen
    s_add_u32 s20, s20, 131072
    buffer_load_dwordx4 v[100:103], v21, s[8:11], s20 offen
    s_add_u32 s20, s20, 131072
    buffer_load_dwordx4 v[104:107], v21, s[8:11], s20 offen
    s_add_u32 s20, s20, 131072
    buffer_load_dwordx4 v[108:111], v21, s[8:11], s20 offen
    s_add_u32 s20, s20, 131072
    buffer_load_dwordx4 v[144:147], v21, s[8:11], s20 offen
    s_add_u32 s20, s20, 131072
    buffer_load_dwordx4 v[148:151], v21, s[8:11], s20 offen
    s_add_u32 s20, s20, 131072
    buffer_load_dwordx4 v[152:155], v21, s[8:11], s20 offen
    s_add_u32 s20, s20, 131072
    buffer_load_dwordx4 v[156:159], v21, s[8:11], s20 offen
    s_add_u32 s20, s20, 131072
    s_sub_u32 s20, s20, s73
    buffer_load_dwordx4 v[192:195], v21, s[8:11], s20 offen
    s_add_u32 s20, s20, 131072
    buffer_load_dwordx4 v[196:199], v21, s[8:11], s20 offen
    s_add_u32 s20, s20, 131072
    buffer_load_dwordx4 v[200:203], v21, s[8:11], s20 offen
    s_add_u32 s20, s20, 131072
    buffer_load_dwordx4 v[204:207], v21, s[8:11], s20 offen
    s_add_u32 s20, s20, 131072
    buffer_load_dwordx4 v[240:243], v21, s[8:11], s20 offen
    s_add_u32 s20, s20, 131072
    buffer_load_dwordx4 v[244:247], v21, s[8:11], s20 offen
    s_add_u32 s20, s20, 131072
    buffer_load_dwordx4 v[248:251], v21, s[8:11], s20 offen
    s_add_u32 s20, s20, 131072
    buffer_load_dwordx4 v[252:255], v21, s[8:11], s20 offen
    s_add_u32 s20, s20, 131072
    s_load_dwordx2 s[8:9], s[0:1], 8
    s_mov_b32 s10, 16384
    v_bfe_u32 v57, v20, 2, 2
    v_and_b32 v58, 1, v20
    v_lshl_add_u32 v57, v57, 1, v58
    v_lshlrev_b32 v57, 11, v57
    v_lshrrev_b32 v58, 4, v20
    v_lshl_add_u32 v57, v58, 5, v57
    v_bfe_u32 v58, v20, 1, 1
    v_lshl_add_u32 v57, v58, 4, v57
    v_lshl_add_u32 v59, v58, 3, v57
    v_xor_b32 v60, 8, v59
    s_lshl_b32 s20, s3, 9
    s_waitcnt lgkmcnt(0)
    buffer_load_dwordx2 v[32:33], v59, s[8:11], s20 offen offset:0
    buffer_load_dwordx2 v[34:35], v60, s[8:11], s20 offen offset:0
    buffer_load_dwordx2 v[36:37], v59, s[8:11], s20 offen offset:128
    buffer_load_dwordx2 v[38:39], v60, s[8:11], s20 offen offset:128
    buffer_load_dwordx2 v[40:41], v59, s[8:11], s20 offen offset:256
    buffer_load_dwordx2 v[42:43], v60, s[8:11], s20 offen offset:256
    buffer_load_dwordx2 v[44:45], v59, s[8:11], s20 offen offset:384
    buffer_load_dwordx2 v[46:47], v60, s[8:11], s20 offen offset:384
    s_barrier
    v_add_u32 v56, s70, v1
    v_add_u32 v26, s71, v1
    s_waitcnt vmcnt(40)
    ds_read_b64_tr_b16 v[64:65], v24 offset:0
    ds_read_b64_tr_b16 v[66:67], v24 offset:128
    ds_read_b64_tr_b16 v[68:69], v24 offset:2048
    ds_read_b64_tr_b16 v[70:71], v24 offset:2176
    ds_read_b64_tr_b16 v[72:73], v24 offset:32
    ds_read_b64_tr_b16 v[74:75], v24 offset:160
    ds_read_b64_tr_b16 v[76:77], v24 offset:2080
    ds_read_b64_tr_b16 v[78:79], v24 offset:2208
    s_waitcnt lgkmcnt(0)
    ds_read_b64_tr_b16 v[112:113], v24 offset:4096
    ds_read_b64_tr_b16 v[114:115], v24 offset:4224
    ds_read_b64_tr_b16 v[116:117], v24 offset:6144
    ds_read_b64_tr_b16 v[118:119], v24 offset:6272
    ds_read_b64_tr_b16 v[120:121], v24 offset:4128
    ds_read_b64_tr_b16 v[122:123], v24 offset:4256
    ds_read_b64_tr_b16 v[124:125], v24 offset:6176
    ds_read_b64_tr_b16 v[126:127], v24 offset:6304
    s_waitcnt lgkmcnt(0)
    ds_read_b64_tr_b16 v[160:161], v24 offset:8192
    ds_read_b64_tr_b16 v[162:163], v24 offset:8320
    ds_read_b64_tr_b16 v[164:165], v24 offset:10240
    ds_read_b64_tr_b16 v[166:167], v24 offset:10368
    ds_read_b64_tr_b16 v[168:169], v24 offset:8224
    ds_read_b64_tr_b16 v[170:171], v24 offset:8352
    ds_read_b64_tr_b16 v[172:173], v24 offset:10272
    ds_read_b64_tr_b16 v[174:175], v24 offset:10400
    s_waitcnt lgkmcnt(0)
    ds_read_b64_tr_b16 v[208:209], v24 offset:12288
    ds_read_b64_tr_b16 v[210:211], v24 offset:12416
    ds_read_b64_tr_b16 v[212:213], v24 offset:14336
    ds_read_b64_tr_b16 v[214:215], v24 offset:14464
    ds_read_b64_tr_b16 v[216:217], v24 offset:12320
    ds_read_b64_tr_b16 v[218:219], v24 offset:12448
    ds_read_b64_tr_b16 v[220:221], v24 offset:14368
    ds_read_b64_tr_b16 v[222:223], v24 offset:14496
    s_waitcnt lgkmcnt(0)
    s_waitcnt vmcnt(24)
    ds_read_b64_tr_b16 v[80:81], v24 offset:16384
    ds_read_b64_tr_b16 v[82:83], v24 offset:16512
    ds_read_b64_tr_b16 v[84:85], v24 offset:18432
    ds_read_b64_tr_b16 v[86:87], v24 offset:18560
    ds_read_b64_tr_b16 v[88:89], v24 offset:16416
    ds_read_b64_tr_b16 v[90:91], v24 offset:16544
    ds_read_b64_tr_b16 v[92:93], v24 offset:18464
    ds_read_b64_tr_b16 v[94:95], v24 offset:18592
    s_waitcnt lgkmcnt(0)
    ds_read_b64_tr_b16 v[128:129], v24 offset:20480
    ds_read_b64_tr_b16 v[130:131], v24 offset:20608
    ds_read_b64_tr_b16 v[132:133], v24 offset:22528
    ds_read_b64_tr_b16 v[134:135], v24 offset:22656
    ds_read_b64_tr_b16 v[136:137], v24 offset:20512
    ds_read_b64_tr_b16 v[138:139], v24 offset:20640
    ds_read_b64_tr_b16 v[140:141], v24 offset:22560
    ds_read_b64_tr_b16 v[142:143], v24 offset:22688
    s_waitcnt lgkmcnt(0)
    ds_read_b64_tr_b16 v[176:177], v24 offset:24576
    ds_read_b64_tr_b16 v[178:179], v24 offset:24704
    ds_read_b64_tr_b16 v[180:181], v24 offset:26624
    ds_read_b64_tr_b16 v[182:183], v24 offset:26752
    ds_read_b64_tr_b16 v[184:185], v24 offset:24608
    ds_read_b64_tr_b16 v[186:187], v24 offset:24736
    ds_read_b64_tr_b16 v[188:189], v24 offset:26656
    ds_read_b64_tr_b16 v[190:191], v24 offset:26784
    s_waitcnt lgkmcnt(0)
    ds_read_b64_tr_b16 v[224:225], v24 offset:28672
    ds_read_b64_tr_b16 v[226:227], v24 offset:28800
    ds_read_b64_tr_b16 v[228:229], v24 offset:30720
    ds_read_b64_tr_b16 v[230:231], v24 offset:30848
    ds_read_b64_tr_b16 v[232:233], v24 offset:28704
    ds_read_b64_tr_b16 v[234:235], v24 offset:28832
    ds_read_b64_tr_b16 v[236:237], v24 offset:30752
    ds_read_b64_tr_b16 v[238:239], v24 offset:30880
    s_waitcnt lgkmcnt(0)
    s_waitcnt vmcnt(8)
    ds_write_b128 v56, v[96:99] offset:0
    ds_write_b128 v56, v[100:103] offset:1024
    ds_write_b128 v56, v[104:107] offset:2048
    ds_write_b128 v56, v[108:111] offset:3072
    ds_write_b128 v56, v[144:147] offset:4096
    ds_write_b128 v56, v[148:151] offset:5120
    ds_write_b128 v56, v[152:155] offset:6144
    ds_write_b128 v56, v[156:159] offset:7168
    ds_write_b128 v26, v[192:195] offset:8192
    ds_write_b128 v26, v[196:199] offset:9216
    ds_write_b128 v26, v[200:203] offset:10240
    ds_write_b128 v26, v[204:207] offset:11264
    ds_write_b128 v26, v[240:243] offset:12288
    ds_write_b128 v26, v[244:247] offset:13312
    ds_write_b128 v26, v[248:251] offset:14336
    ds_write_b128 v26, v[252:255] offset:15360
    s_waitcnt lgkmcnt(0)
    ds_read_b64_tr_b16 v[96:97], v24 offset:0
    ds_read_b64_tr_b16 v[98:99], v24 offset:128
    ds_read_b64_tr_b16 v[100:101], v24 offset:2048
    ds_read_b64_tr_b16 v[102:103], v24 offset:2176
    ds_read_b64_tr_b16 v[104:105], v24 offset:32
    ds_read_b64_tr_b16 v[106:107], v24 offset:160
    ds_read_b64_tr_b16 v[108:109], v24 offset:2080
    ds_read_b64_tr_b16 v[110:111], v24 offset:2208
    s_waitcnt lgkmcnt(0)
    ds_read_b64_tr_b16 v[144:145], v24 offset:4096
    ds_read_b64_tr_b16 v[146:147], v24 offset:4224
    ds_read_b64_tr_b16 v[148:149], v24 offset:6144
    ds_read_b64_tr_b16 v[150:151], v24 offset:6272
    ds_read_b64_tr_b16 v[152:153], v24 offset:4128
    ds_read_b64_tr_b16 v[154:155], v24 offset:4256
    ds_read_b64_tr_b16 v[156:157], v24 offset:6176
    ds_read_b64_tr_b16 v[158:159], v24 offset:6304
    s_waitcnt lgkmcnt(0)
    ds_read_b64_tr_b16 v[192:193], v24 offset:8192
    ds_read_b64_tr_b16 v[194:195], v24 offset:8320
    ds_read_b64_tr_b16 v[196:197], v24 offset:10240
    ds_read_b64_tr_b16 v[198:199], v24 offset:10368
    ds_read_b64_tr_b16 v[200:201], v24 offset:8224
    ds_read_b64_tr_b16 v[202:203], v24 offset:8352
    ds_read_b64_tr_b16 v[204:205], v24 offset:10272
    ds_read_b64_tr_b16 v[206:207], v24 offset:10400
    s_waitcnt lgkmcnt(0)
    ds_read_b64_tr_b16 v[240:241], v24 offset:12288
    ds_read_b64_tr_b16 v[242:243], v24 offset:12416
    ds_read_b64_tr_b16 v[244:245], v24 offset:14336
    ds_read_b64_tr_b16 v[246:247], v24 offset:14464
    ds_read_b64_tr_b16 v[248:249], v24 offset:12320
    ds_read_b64_tr_b16 v[250:251], v24 offset:12448
    ds_read_b64_tr_b16 v[252:253], v24 offset:14368
    ds_read_b64_tr_b16 v[254:255], v24 offset:14496
    s_waitcnt lgkmcnt(0)
    v_mov_b32 v21, 0x44444444
    v_mov_b32 v22, 0xeeeeeeee
    v_and_b32 v23, 2, v20
    v_cmp_eq_u32 vcc, 0, v23
    s_nop 1
    v_cndmask_b32 v8, v22, v21, vcc
    v_bfe_u32 v21, v20, 2, 3
    v_lshrrev_b32 v22, 5, v20
    v_mul_u32_u24 v23, 160, v21
    v_mul_u32_u24 v24, 1280, v22
    v_add_u32 v23, v23, v24
    v_and_b32 v24, 3, v20
    v_lshl_add_u32 v27, v24, 4, v23
    v_lshrrev_b32 v23, 1, v21
    v_and_b32 v21, 1, v21
    v_lshl_add_u32 v21, v23, 2, v21
    v_xor_b32 v22, 1, v22
    v_lshl_add_u32 v21, v22, 1, v21
    v_bfe_u32 v22, v20, 1, 1
    v_lshl_add_u32 v21, v22, 4, v21
    v_xor_b32 v22, v20, v22
    v_and_b32 v22, 1, v22
    v_lshlrev_b32 v21, 4, v21
    v_lshl_add_u32 v25, v22, 3, v21
    v_lshrrev_b32 v21, 3, v20
    v_mul_u32_u24 v23, 160, v21
    v_and_b32 v24, 7, v20
    v_lshl_add_u32 v28, v24, 4, v23
    v_lshrrev_b32 v23, 1, v21
    v_and_b32 v21, 1, v21
    v_lshl_add_u32 v21, v23, 2, v21
    v_and_b32 v22, 1, v20
    v_lshl_add_u32 v21, v22, 1, v21
    v_bfe_u32 v22, v20, 2, 1
    v_lshl_add_u32 v21, v22, 4, v21
    v_bfe_u32 v22, v20, 1, 1
    v_lshlrev_b32 v21, 4, v21
    v_lshl_add_u32 v26, v22, 3, v21
    s_lshl_b32 s17, s53, 10
    s_lshl_b32 s18, s3, 9
    s_add_u32 s17, s17, s18
    s_lshl_b32 s18, s3, 6
    s_lshl_b32 s19, s53, 9
    s_add_u32 s19, s19, 4096
    s_cmp_ge_u32 s3, 2
    s_cselect_b32 s17, s19, s17
    s_cselect_b32 s18, 2560, s18
    s_cselect_b64 vcc, -1, 0
    v_cndmask_b32 v22, v25, v26, vcc
    v_cndmask_b32 v23, v27, v28, vcc
    v_add_u32 v2, s17, v22
    v_add_u32 v4, s18, v23
    v_lshrrev_b32 v21, 4, v20
    v_and_b32 v22, 15, v20
    v_mul_u32_u24 v23, 320, v21
    v_lshl_add_u32 v23, v22, 2, v23
    s_mul_i32 s17, s3, 3840
    v_add_u32 v3, s17, v23
    v_add_u32 v61, 1280, v3
    v_bfe_u32 v24, v20, 3, 1
    v_bfe_u32 v25, v20, 2, 1
    v_xor_b32 v25, v25, v24
    v_bfe_u32 v26, v20, 1, 1
    v_lshl_add_u32 v25, v26, 1, v25
    v_lshl_add_u32 v25, v24, 2, v25
    v_and_b32 v26, 1, v20
    v_lshl_add_u32 v25, v25, 1, v26
    v_sub_u32 v25, v25, v22
    v_lshl_add_u32 v25, v25, 2, v3
    v_add_u32 v62, 2560, v25
    v_lshlrev_b32 v23, 4, v22
    v_lshl_add_u32 v6, v21, 12, v23
    s_lshl_b32 s17, s3, 10
    s_add_u32 s17, s17, 32768
    v_add_u32 v6, s17, v6
    v_lshrrev_b32 v24, 1, v21
    v_lshl_add_u32 v23, v24, 15, v23
    v_and_b32 v24, 1, v21
    v_lshl_add_u32 v7, v24, 8, v23
    v_mov_b32 v58, 15872
    v_bfe_u32 v23, v20, 1, 2
    v_lshlrev_b32 v23, 6, v23
    v_and_b32 v25, 1, v20
    v_lshl_add_u32 v23, v25, 4, v23
    v_lshrrev_b32 v24, 5, v20
    v_lshl_add_u32 v5, v24, 5, v23
    v_and_b32 v23, 7, v20
    v_lshlrev_b32 v23, 7, v23
    v_bfe_u32 v24, v20, 3, 1
    v_lshl_add_u32 v23, v24, 17, v23
    v_lshrrev_b32 v24, 4, v20
    v_add_u32 v24, 1, v24
    v_cmp_le_u32 vcc, 3, v24
    s_nop 1
    v_cndmask_b32 v24, v24, 0, vcc
    v_lshl_add_u32 v23, v24, 24, v23
    s_lshl_b32 s17, s14, 14
    s_lshl_b32 s18, s34, 10
    s_add_u32 s17, s17, s18
    s_add_u32 s17, s17, 4194304
    v_add_u32 v0, s17, v23
    s_lshl_b32 s17, s3, 2
    s_add_u32 s17, s17, 15872
    v_mov_b32 v63, s17
    v_and_b32 v21, 15, v20
    v_and_b32 v22, 1, v21
    v_lshlrev_b32 v22, 4, v22
    v_mov_b32 v12, 0x3f80
    v_lshlrev_b32 v22, v22, v12
    v_lshrrev_b32 v21, 1, v21
    v_cmp_eq_u32 vcc, 0, v21
    s_nop 1
    v_cndmask_b32 v12, 0, v22, vcc
    v_cmp_eq_u32 vcc, 1, v21
    s_nop 1
    v_cndmask_b32 v13, 0, v22, vcc
    v_cmp_eq_u32 vcc, 2, v21
    s_nop 1
    v_cndmask_b32 v14, 0, v22, vcc
    v_cmp_eq_u32 vcc, 3, v21
    s_nop 1
    v_cndmask_b32 v15, 0, v22, vcc
    s_waitcnt vmcnt(0)
    v_mov_b32 v16, v32
    v_mov_b32 v17, v33
    v_mov_b32 v18, v34
    v_mov_b32 v19, v35
    v_mov_b32 v20, v36
    v_mov_b32 v21, v37
    v_mov_b32 v22, v38
    v_mov_b32 v23, v39
    v_mov_b32 v24, v40
    v_mov_b32 v25, v41
    v_mov_b32 v26, v42
    v_mov_b32 v27, v43
    v_mov_b32 v28, v44
    v_mov_b32 v29, v45
    v_mov_b32 v30, v46
    v_mov_b32 v31, v47
    v_mov_b32 v52, -1
    v_mov_b32 v53, -1
    v_mov_b32 v54, -1
    v_mov_b32 v55, -1
    s_add_u32 s17, s30, 851968
    buffer_store_dwordx4 v[52:55], v7, s[4:7], s17 offen sc1
    s_add_u32 s17, s30, 917504
    buffer_store_dwordx4 v[52:55], v7, s[4:7], s17 offen sc1
    s_add_u32 s17, s30, 983040
    buffer_store_dwordx4 v[52:55], v7, s[4:7], s17 offen sc1
    s_lshl_b32 s40, s40, 5
    s_barrier
    ds_write_b32 v63, v10
    ds_write_b32 v63, v10 offset:16
    ds_write_b32 v63, v10 offset:32
    ds_write_b32 v63, v10 offset:48
    v_mov_b32 v60, 12
    v_mov_b32 v56, 15968
    s_waitcnt lgkmcnt(0)
    s_barrier
    ds_read_b64 v[32:33], v56
    s_waitcnt lgkmcnt(0)
    v_cmp_ne_u32 vcc, s40, v32
    s_setprio 3
    v_readfirstlane_b32 s17, v33
    s_add_u32 s39, s39, s17
    s_cbranch_vccnz ch_p_slow
    v_mov_b32 v32, 0
    v_mov_b32 v33, 0
    v_mov_b32 v34, 0
    v_mov_b32 v35, 0
    v_mov_b32 v36, 0
    v_mov_b32 v37, 0
    v_mov_b32 v38, 0
    v_mov_b32 v39, 0
    v_mov_b32 v40, 0
    v_mov_b32 v41, 0
    v_mov_b32 v42, 0
    v_mov_b32 v43, 0
    v_mov_b32 v44, 0
    v_mov_b32 v45, 0
    v_mov_b32 v46, 0
    v_mov_b32 v47, 0
    v_mov_b32 v48, 0
    v_mov_b32 v49, 0
    v_mov_b32 v50, 0
    v_mov_b32 v51, 0
    v_mov_b32 v52, 0
    v_mov_b32 v53, 0
    v_mov_b32 v54, 0
    v_mov_b32 v55, 0
    v_mov_b32 v59, 0
    s_nop 1
    s_branch ploopL_17_nc
.p2align 6
    s_nop 0
    s_nop 0
    s_nop 0
    s_nop 0
    s_nop 0
    s_nop 0
    s_nop 0
    s_nop 0
    s_nop 0
    s_nop 0
    s_nop 0
ploopL_17:
    v_mov_b32 v32, 0
    v_mov_b32 v33, 0
    v_mov_b32 v34, 0
    v_mov_b32 v35, 0
    v_mov_b32 v36, 0
    v_mov_b32 v37, 0
    v_mov_b32 v38, 0
    v_mov_b32 v39, 0
    v_mov_b32 v40, 0
    v_mov_b32 v41, 0
    v_mov_b32 v42, 0
    v_mov_b32 v43, 0
    v_mov_b32 v44, 0
    v_mov_b32 v45, 0
    v_mov_b32 v46, 0
    v_mov_b32 v47, 0
    v_mov_b32 v48, 0
    v_mov_b32 v49, 0
    v_mov_b32 v50, 0
    v_mov_b32 v51, 0
    v_mov_b32 v52, 0
    v_mov_b32 v53, 0
    v_mov_b32 v54, 0
    v_mov_b32 v55, 0
    s_bitcmp1_b32 s29, 0
    s_cbranch_scc1 gate_18_ok
    s_add_u32 s21, s16, 1
    s_min_u32 s21, s21, 63
    s_cmp_ge_u32 s21, 16
    s_cselect_b32 s19, 12, 8
    s_and_b32 s32, s21, 4
    s_lshr_b32 s21, s21, 3
    s_lshl_b32 s21, s21, 8
    s_add_u32 s32, s32, s21
    s_add_u32 s32, s32, s35
gate_18:
    buffer_load_dword v9, off, s[4:7], s32 sc1
    s_waitcnt vmcnt(0)
    v_readfirstlane_b32 s21, v9
    s_cmp_ge_u32 s21, s19
    s_cbranch_scc1 gate_18_set
    s_sleep 8
    s_sub_u32 s22, s22, 1
    s_cbranch_scc0 gate_18
    s_mov_b32 s22, 0
gate_18_set:
    s_bitset1_b32 s29, 0
gate_18_ok:
    s_sleep 1
    buffer_load_dwordx4 v[16:19], v1, s[4:7], s23 offen offset:0 sc1
    buffer_load_dwordx4 v[20:23], v1, s[4:7], s23 offen offset:1024 sc1
    buffer_load_dwordx4 v[24:27], v1, s[4:7], s23 offen offset:2048 sc1
    buffer_load_dwordx4 v[28:31], v1, s[4:7], s23 offen offset:3072 sc1
    s_waitcnt vmcnt(3)
    v_cmp_eq_u32 vcc, -1, v16
    s_cbranch_vccnz ploopL_17_rm_0
ploopL_17_rm_0ok:
    v_smfmac_f32_16x16x64_bf16 v[32:35], v[16:19], v[64:71], v8
    v_smfmac_f32_16x16x64_bf16 v[36:39], v[16:19], v[72:79], v8
    s_waitcnt vmcnt(2)
    v_cmp_eq_u32 vcc, -1, v20
    v_smfmac_f32_16x16x64_bf16 v[40:43], v[16:19], v[80:87], v8
    v_smfmac_f32_16x16x64_bf16 v[44:47], v[16:19], v[88:95], v8
    v_smfmac_f32_16x16x64_bf16 v[48:51], v[16:19], v[96:103], v8
    v_smfmac_f32_16x16x64_bf16 v[52:55], v[16:19], v[104:111], v8
    s_cbranch_vccnz ploopL_17_rm_1
ploopL_17_rm_1ok:
    v_smfmac_f32_16x16x64_bf16 v[32:35], v[20:23], v[112:119], v8
    v_smfmac_f32_16x16x64_bf16 v[36:39], v[20:23], v[120:127], v8
    s_waitcnt vmcnt(1)
    v_cmp_eq_u32 vcc, -1, v24
    v_smfmac_f32_16x16x64_bf16 v[40:43], v[20:23], v[128:135], v8
    v_smfmac_f32_16x16x64_bf16 v[44:47], v[20:23], v[136:143], v8
    v_smfmac_f32_16x16x64_bf16 v[48:51], v[20:23], v[144:151], v8
    v_smfmac_f32_16x16x64_bf16 v[52:55], v[20:23], v[152:159], v8
    s_cbranch_vccnz ploopL_17_rm_2
ploopL_17_rm_2ok:
    v_smfmac_f32_16x16x64_bf16 v[32:35], v[24:27], v[160:167], v8
    v_smfmac_f32_16x16x64_bf16 v[36:39], v[24:27], v[168:175], v8
    s_waitcnt vmcnt(0)
    v_cmp_eq_u32 vcc, -1, v28
    v_smfmac_f32_16x16x64_bf16 v[40:43], v[24:27], v[176:183], v8
    v_smfmac_f32_16x16x64_bf16 v[44:47], v[24:27], v[184:191], v8
    v_smfmac_f32_16x16x64_bf16 v[48:51], v[24:27], v[192:199], v8
    v_smfmac_f32_16x16x64_bf16 v[52:55], v[24:27], v[200:207], v8
    s_cbranch_vccnz ploopL_17_rm_3
ploopL_17_rm_3ok:
    v_smfmac_f32_16x16x64_bf16 v[32:35], v[28:31], v[208:215], v8
    ds_write_b32 v63, v59 offset:32
    v_smfmac_f32_16x16x64_bf16 v[36:39], v[28:31], v[216:223], v8
    v_smfmac_f32_16x16x64_bf16 v[40:43], v[28:31], v[224:231], v8
    v_smfmac_f32_16x16x64_bf16 v[44:47], v[28:31], v[232:239], v8
    v_smfmac_f32_16x16x64_bf16 v[48:51], v[28:31], v[240:247], v8
    v_smfmac_f32_16x16x64_bf16 v[52:55], v[28:31], v[248:255], v8
    s_branch ploopL_17_mmd
ploopL_17_nc:
    v_smfmac_f32_16x16x64_bf16 v[32:35], v[16:19], v[64:71], v8
    v_smfmac_f32_16x16x64_bf16 v[36:39], v[16:19], v[72:79], v8
    v_smfmac_f32_16x16x64_bf16 v[40:43], v[16:19], v[80:87], v8
    v_smfmac_f32_16x16x64_bf16 v[44:47], v[16:19], v[88:95], v8
    v_smfmac_f32_16x16x64_bf16 v[48:51], v[16:19], v[96:103], v8
    v_smfmac_f32_16x16x64_bf16 v[52:55], v[16:19], v[104:111], v8
    v_smfmac_f32_16x16x64_bf16 v[32:35], v[20:23], v[112:119], v8
    v_smfmac_f32_16x16x64_bf16 v[36:39], v[20:23], v[120:127], v8
    v_smfmac_f32_16x16x64_bf16 v[40:43], v[20:23], v[128:135], v8
    v_smfmac_f32_16x16x64_bf16 v[44:47], v[20:23], v[136:143], v8
    v_smfmac_f32_16x16x64_bf16 v[48:51], v[20:23], v[144:151], v8
    v_smfmac_f32_16x16x64_bf16 v[52:55], v[20:23], v[152:159], v8
    v_smfmac_f32_16x16x64_bf16 v[32:35], v[24:27], v[160:167], v8
    v_smfmac_f32_16x16x64_bf16 v[36:39], v[24:27], v[168:175], v8
    v_smfmac_f32_16x16x64_bf16 v[40:43], v[24:27], v[176:183], v8
    v_smfmac_f32_16x16x64_bf16 v[44:47], v[24:27], v[184:191], v8
    v_smfmac_f32_16x16x64_bf16 v[48:51], v[24:27], v[192:199], v8
    v_smfmac_f32_16x16x64_bf16 v[52:55], v[24:27], v[200:207], v8
    v_smfmac_f32_16x16x64_bf16 v[32:35], v[28:31], v[208:215], v8
    ds_write_b32 v63, v59 offset:32
    v_smfmac_f32_16x16x64_bf16 v[36:39], v[28:31], v[216:223], v8
    v_smfmac_f32_16x16x64_bf16 v[40:43], v[28:31], v[224:231], v8
    v_smfmac_f32_16x16x64_bf16 v[44:47], v[28:31], v[232:239], v8
    v_smfmac_f32_16x16x64_bf16 v[48:51], v[28:31], v[240:247], v8
    v_smfmac_f32_16x16x64_bf16 v[52:55], v[28:31], v[248:255], v8
ploopL_17_mmd:
    s_cmp_eq_u32 s3, 3
    s_nop 1
    v_add_f32 v32, v32, v34
    v_add_f32 v33, v33, v35
    ds_write2_b32 v3, v32, v33 offset0:0 offset1:40
    v_add_f32 v36, v36, v38
    v_add_f32 v37, v37, v39
    ds_write2_b32 v3, v36, v37 offset0:16 offset1:56
    v_add_f32 v40, v40, v42
    v_add_f32 v41, v41, v43
    ds_write2_b32 v61, v40, v41 offset0:0 offset1:40
    v_add_f32 v44, v44, v46
    v_add_f32 v45, v45, v47
    ds_write2_b32 v61, v44, v45 offset0:16 offset1:56
    v_add_f32 v48, v48, v50
    v_add_f32 v49, v49, v51
    ds_write2_b32 v62, v48, v49 offset0:0 offset1:40
    v_add_f32 v52, v52, v54
    v_add_f32 v53, v53, v55
    ds_write2_b32 v62, v52, v53 offset0:16 offset1:56
    s_waitcnt lgkmcnt(0)
    s_barrier
    s_cbranch_scc1 ploopL_17_sk1
    ds_read_b128 v[32:35], v4 offset:0
    ds_read_b128 v[36:39], v4 offset:3840
    ds_read_b128 v[40:43], v4 offset:7680
    ds_read_b128 v[44:47], v4 offset:11520
    s_waitcnt lgkmcnt(2)
    v_add_f32 v32, v32, v36
    v_add_f32 v33, v33, v37
    v_add_f32 v34, v34, v38
    v_add_f32 v35, v35, v39
    s_waitcnt lgkmcnt(0)
    v_add_f32 v40, v40, v44
    v_add_f32 v41, v41, v45
    v_add_f32 v42, v42, v46
    v_add_f32 v43, v43, v47
    v_add_f32 v32, v32, v40
    v_add_f32 v33, v33, v41
    v_add_f32 v34, v34, v42
    v_add_f32 v35, v35, v43
    v_cvt_pk_bf16_f32 v56, v32, v33
    v_cvt_pk_bf16_f32 v57, v34, v35
    v_min_u32 v56, -2, v56
    buffer_store_dwordx2 v[56:57], v2, s[4:7], s26 offen
    s_add_u32 s27, s16, 2
    s_and_b32 s27, s27, 3
    s_lshl_b32 s27, s27, 18
    s_add_u32 s27, s27, s38
    buffer_store_dwordx2 v[10:11], v2, s[4:7], s27 offen
ploopL_17_sk1:
    s_setprio 0
    s_add_u32 s25, s16, 3
    s_and_b32 s25, s25, 3
    s_lshl_b32 s25, s25, 16
    s_add_u32 s25, s25, s37
    v_mov_b32 v44, -1
    v_mov_b32 v45, -1
    v_mov_b32 v46, -1
    v_mov_b32 v47, -1
    s_mov_b64 exec, s[56:57]
    buffer_store_dwordx4 v[44:47], v5, s[4:7], s25 offen
    s_mov_b64 exec, -1
    v_mov_b32_dpp v48, v12 row_ror:8 row_mask:0xf bank_mask:0xf
    v_mov_b32_dpp v49, v13 row_ror:8 row_mask:0xf bank_mask:0xf
    v_mov_b32_dpp v50, v14 row_ror:8 row_mask:0xf bank_mask:0xf
    v_mov_b32_dpp v51, v15 row_ror:8 row_mask:0xf bank_mask:0xf
    s_and_b32 s28, s16, 3
    s_lshl_b32 s28, s28, 18
    s_add_u32 s28, s28, s39
    s_add_u32 s24, s16, 1
    s_and_b32 s24, s24, 3
    s_lshl_b32 s24, s24, 16
    s_add_u32 s24, s24, s37
    s_add_u32 s23, s16, 1
    s_and_b32 s23, s23, 3
    s_lshl_b32 s23, s23, 16
    s_add_u32 s23, s23, s36
    s_add_u32 s26, s16, 1
    s_and_b32 s26, s26, 3
    s_lshl_b32 s26, s26, 18
    s_add_u32 s26, s26, s38
    s_cmp_eq_u32 s59, 0
    s_cbranch_scc1 ofl_19
    s_lshl_b32 s17, s3, 10
    v_add_u32 v39, s17, v1
    ds_read_b128 v[40:43], v39 offset:32768
ofl_19:
    s_cmp_ge_u32 s16, 16
    s_cbranch_scc1 ploopL_17_nx
    v_mov_b32 v40, v2
    v_mov_b32 v42, v56
    v_mov_b32 v43, v57
    s_cmp_lg_u32 s3, 2
    s_cbranch_scc1 ploopL_17_nx
    v_and_b32 v40, 0x60, v1
    v_lshlrev_b32 v40, 2, v40
    v_lshrrev_b32 v41, 3, v1
    v_and_b32 v41, 0x70, v41
    v_or_b32 v40, v40, v41
    v_bfe_u32 v41, v1, 4, 1
    v_lshl_or_b32 v40, v41, 3, v40
    s_lshl_b32 s17, s53, 9
    s_add_u32 s17, s17, 4096
    v_add_u32 v40, s17, v40
    s_mov_b32 vcc_lo, 0x55555555
    s_mov_b32 vcc_hi, 0x55555555
    v_cndmask_b32_dpp v42, v57, v56, vcc quad_perm:[1,0,3,2] row_mask:0xf bank_mask:0xf
    s_not_b64 vcc, vcc
    v_cndmask_b32_dpp v43, v56, v57, vcc quad_perm:[1,0,3,2] row_mask:0xf bank_mask:0xf
ploopL_17_nx:
    v_readfirstlane_b32 s21, v60
    s_lshr_b32 s29, s29, 1
    s_cmp_ge_u32 s21, s58
    s_cselect_b32 s21, 2, 0
    s_or_b32 s29, s29, s21
    s_cmp_eq_u32 s3, 3
    s_cselect_b32 s20, s21, 0
    s_add_u32 s21, s16, 4
    s_min_u32 s21, s21, 63
    s_cmp_ge_u32 s21, 16
    s_cselect_b32 s58, 12, 8
    s_and_b32 s33, s21, 4
    s_lshr_b32 s21, s21, 3
    s_lshl_b32 s21, s21, 8
    s_add_u32 s33, s33, s21
    s_add_u32 s33, s33, s35
    s_setprio 3
ploopL_17_fs:
    ds_read_b128 v[32:35], v58 offset:0
    s_waitcnt lgkmcnt(0)
    v_min3_i32 v32, v32, v33, v34
    v_min_i32 v32, v32, v35
    s_nop 0
    v_readfirstlane_b32 s18, v32
    s_cmp_ge_i32 s18, s16
    s_cbranch_scc1 ploopL_17_fsok
    s_sleep 1
    s_branch ploopL_17_fs
ploopL_17_fsok:
    s_setprio 1
    s_sleep 5
    s_cmp_eq_u32 s20, 0
    s_cbranch_scc1 ploopL_17_nt
    s_cmp_ge_u32 s16, 13
    s_cselect_b32 exec_hi, 0xffff, 0
    buffer_load_dword v60, v0, s[4:7], s31 offen sc1
    s_mov_b32 exec_hi, -1
ploopL_17_nt:
    s_cmp_eq_u32 s59, 0
    s_cbranch_scc1 ofl_20
    s_lshl_b32 s17, s16, 18
    s_add_u32 s17, s17, s60
    buffer_store_dwordx4 v[40:43], v1, s[4:7], s17 offen sc1
    s_mov_b32 s59, 0
ofl_20:
    s_lshr_b32 s17, s34, 3
    s_xor_b32 s17, s17, s16
    s_andn2_b32 s59, 1, s17
    s_cmp_ge_u32 s16, 16
    s_cselect_b32 s59, s59, 0
    s_cbranch_scc1 ploopL_17_nx2
    s_cmp_eq_u32 s3, 3
    s_cbranch_scc1 ploopL_17_nx2
    buffer_store_dwordx2 v[42:43], v40, s[4:7], s55 offen sc1
ploopL_17_nx2:
    s_add_u32 s55, s55, 262144
    s_barrier
    buffer_load_dword v60, off, s[4:7], s33 sc1
    s_add_u32 s16, s16, 1
    v_mov_b32 v59, s16
    s_add_u32 s41, s41, 262144
    s_add_u32 s31, s31, 262144
    s_setprio 3
    s_sleep 13
ploopL_17_pagain:
    buffer_load_dwordx4 v[16:19], v1, s[4:7], s28 offen offset:0 sc1
    buffer_load_dwordx4 v[20:23], v1, s[4:7], s28 offen offset:1024 sc1
    s_waitcnt vmcnt(1)
    v_mfma_f32_16x16x32_bf16 v[32:35], v[12:15], v[16:19], 0
    s_waitcnt vmcnt(0)
    v_mfma_f32_16x16x32_bf16 v[32:35], v[48:51], v[20:23], v[32:35]
    v_max_u32 v9, v16, v20
    v_cmp_eq_u32 vcc, -1, v9
    s_cbranch_vccnz ploopL_17_rp
ploopL_17_pgo:
    s_cmp_lt_u32 s16, 48
    s_nop 3
    v_add_f32_dpp v36, v32, v32 row_ror:8 row_mask:0xf bank_mask:0xf
    v_add_f32_dpp v37, v33, v33 row_ror:8 row_mask:0xf bank_mask:0xf
    v_add_f32_dpp v38, v34, v34 row_ror:8 row_mask:0xf bank_mask:0xf
    v_add_f32_dpp v39, v35, v35 row_ror:8 row_mask:0xf bank_mask:0xf
    v_cvt_pk_bf16_f32 v52, v36, v37
    v_cvt_pk_bf16_f32 v53, v38, v39
    s_nop 0
    v_permlane16_swap_b32 v52, v54
    v_permlane16_swap_b32 v53, v55
    s_mov_b64 exec, s[56:57]
    v_min_u32 v52, -2, v52
    buffer_store_dwordx4 v[52:55], v5, s[4:7], s24 offen
    s_mov_b64 exec, -1
    ds_write_b32 v63, v59 offset:16
    s_cbranch_scc1 ploopL_17
    s_branch ploopH_16
ploopL_17_rm_0:
    s_sub_u32 s22, s22, 1
    s_cbranch_scc1 ploopL_17_rm_0_g
    buffer_load_dwordx4 v[16:19], v1, s[4:7], s23 offen offset:0 sc1
    buffer_load_dwordx4 v[20:23], v1, s[4:7], s23 offen offset:1024 sc1
    buffer_load_dwordx4 v[24:27], v1, s[4:7], s23 offen offset:2048 sc1
    buffer_load_dwordx4 v[28:31], v1, s[4:7], s23 offen offset:3072 sc1
    s_waitcnt vmcnt(3)
    v_cmp_eq_u32 vcc, -1, v16
    s_cbranch_vccnz ploopL_17_rm_0
    s_branch ploopL_17_rm_0ok
ploopL_17_rm_0_g:
    s_mov_b32 s22, 0
    s_waitcnt vmcnt(0)
    s_branch ploopL_17_rm_0ok
ploopL_17_rm_1:
    s_sub_u32 s22, s22, 1
    s_cbranch_scc1 ploopL_17_rm_1_g
    buffer_load_dwordx4 v[20:23], v1, s[4:7], s23 offen offset:1024 sc1
    buffer_load_dwordx4 v[24:27], v1, s[4:7], s23 offen offset:2048 sc1
    buffer_load_dwordx4 v[28:31], v1, s[4:7], s23 offen offset:3072 sc1
    s_waitcnt vmcnt(2)
    v_cmp_eq_u32 vcc, -1, v20
    s_cbranch_vccnz ploopL_17_rm_1
    s_branch ploopL_17_rm_1ok
ploopL_17_rm_1_g:
    s_mov_b32 s22, 0
    s_waitcnt vmcnt(0)
    s_branch ploopL_17_rm_1ok
ploopL_17_rm_2:
    s_sub_u32 s22, s22, 1
    s_cbranch_scc1 ploopL_17_rm_2_g
    buffer_load_dwordx4 v[24:27], v1, s[4:7], s23 offen offset:2048 sc1
    buffer_load_dwordx4 v[28:31], v1, s[4:7], s23 offen offset:3072 sc1
    s_waitcnt vmcnt(1)
    v_cmp_eq_u32 vcc, -1, v24
    s_cbranch_vccnz ploopL_17_rm_2
    s_branch ploopL_17_rm_2ok
ploopL_17_rm_2_g:
    s_mov_b32 s22, 0
    s_waitcnt vmcnt(0)
    s_branch ploopL_17_rm_2ok
ploopL_17_rm_3:
    s_sub_u32 s22, s22, 1
    s_cbranch_scc1 ploopL_17_rm_3_g
    buffer_load_dwordx4 v[28:31], v1, s[4:7], s23 offen offset:3072 sc1
    s_waitcnt vmcnt(0)
    v_cmp_eq_u32 vcc, -1, v28
    s_cbranch_vccnz ploopL_17_rm_3
    s_branch ploopL_17_rm_3ok
ploopL_17_rm_3_g:
    s_mov_b32 s22, 0
    s_waitcnt vmcnt(0)
    s_branch ploopL_17_rm_3ok
ploopL_17_rp:
    s_sub_u32 s22, s22, 1
    s_cbranch_scc0 ploopL_17_pagain
    s_mov_b32 s22, 0
    s_branch ploopL_17_pgo
.p2align 6
    s_nop 0
    s_nop 0
    s_nop 0
    s_nop 0
    s_nop 0
    s_nop 0
    s_nop 0
    s_nop 0
    s_nop 0
    s_nop 0
    s_nop 0
ploopH_16:
    v_mov_b32 v32, 0
    v_mov_b32 v33, 0
    v_mov_b32 v34, 0
    v_mov_b32 v35, 0
    v_mov_b32 v36, 0
    v_mov_b32 v37, 0
    v_mov_b32 v38, 0
    v_mov_b32 v39, 0
    v_mov_b32 v40, 0
    v_mov_b32 v41, 0
    v_mov_b32 v42, 0
    v_mov_b32 v43, 0
    v_mov_b32 v44, 0
    v_mov_b32 v45, 0
    v_mov_b32 v46, 0
    v_mov_b32 v47, 0
    v_mov_b32 v48, 0
    v_mov_b32 v49, 0
    v_mov_b32 v50, 0
    v_mov_b32 v51, 0
    v_mov_b32 v52, 0
    v_mov_b32 v53, 0
    v_mov_b32 v54, 0
    v_mov_b32 v55, 0
    s_sleep 1
    buffer_load_dwordx4 v[16:19], v1, s[4:7], s23 offen offset:0 sc1
    buffer_load_dwordx4 v[20:23], v1, s[4:7], s23 offen offset:1024 sc1
    buffer_load_dwordx4 v[24:27], v1, s[4:7], s23 offen offset:2048 sc1
    buffer_load_dwordx4 v[28:31], v1, s[4:7], s23 offen offset:3072 sc1
    s_waitcnt vmcnt(3)
    v_cmp_eq_u32 vcc, -1, v16
    s_cbranch_vccnz ploopH_16_rm_0
ploopH_16_rm_0ok:
    v_smfmac_f32_16x16x64_bf16 v[32:35], v[16:19], v[64:71], v8
    v_smfmac_f32_16x16x64_bf16 v[36:39], v[16:19], v[72:79], v8
    s_waitcnt vmcnt(2)
    v_cmp_eq_u32 vcc, -1, v20
    v_smfmac_f32_16x16x64_bf16 v[40:43], v[16:19], v[80:87], v8
    v_smfmac_f32_16x16x64_bf16 v[44:47], v[16:19], v[88:95], v8
    v_smfmac_f32_16x16x64_bf16 v[48:51], v[16:19], v[96:103], v8
    v_smfmac_f32_16x16x64_bf16 v[52:55], v[16:19], v[104:111], v8
    s_cbranch_vccnz ploopH_16_rm_1
ploopH_16_rm_1ok:
    v_smfmac_f32_16x16x64_bf16 v[32:35], v[20:23], v[112:119], v8
    v_smfmac_f32_16x16x64_bf16 v[36:39], v[20:23], v[120:127], v8
    s_waitcnt vmcnt(1)
    v_cmp_eq_u32 vcc, -1, v24
    v_smfmac_f32_16x16x64_bf16 v[40:43], v[20:23], v[128:135], v8
    v_smfmac_f32_16x16x64_bf16 v[44:47], v[20:23], v[136:143], v8
    v_smfmac_f32_16x16x64_bf16 v[48:51], v[20:23], v[144:151], v8
    v_smfmac_f32_16x16x64_bf16 v[52:55], v[20:23], v[152:159], v8
    s_cbranch_vccnz ploopH_16_rm_2
ploopH_16_rm_2ok:
    v_smfmac_f32_16x16x64_bf16 v[32:35], v[24:27], v[160:167], v8
    v_smfmac_f32_16x16x64_bf16 v[36:39], v[24:27], v[168:175], v8
    s_waitcnt vmcnt(0)
    v_cmp_eq_u32 vcc, -1, v28
    v_smfmac_f32_16x16x64_bf16 v[40:43], v[24:27], v[176:183], v8
    v_smfmac_f32_16x16x64_bf16 v[44:47], v[24:27], v[184:191], v8
    v_smfmac_f32_16x16x64_bf16 v[48:51], v[24:27], v[192:199], v8
    v_smfmac_f32_16x16x64_bf16 v[52:55], v[24:27], v[200:207], v8
    s_cbranch_vccnz ploopH_16_rm_3
ploopH_16_rm_3ok:
    v_smfmac_f32_16x16x64_bf16 v[32:35], v[28:31], v[208:215], v8
    ds_write_b32 v63, v59 offset:32
    v_smfmac_f32_16x16x64_bf16 v[36:39], v[28:31], v[216:223], v8
    v_smfmac_f32_16x16x64_bf16 v[40:43], v[28:31], v[224:231], v8
    v_smfmac_f32_16x16x64_bf16 v[44:47], v[28:31], v[232:239], v8
    v_smfmac_f32_16x16x64_bf16 v[48:51], v[28:31], v[240:247], v8
    v_smfmac_f32_16x16x64_bf16 v[52:55], v[28:31], v[248:255], v8
    s_cmp_eq_u32 s3, 3
    s_nop 1
    v_add_f32 v32, v32, v34
    v_add_f32 v33, v33, v35
    ds_write2_b32 v3, v32, v33 offset0:0 offset1:40
    v_add_f32 v36, v36, v38
    v_add_f32 v37, v37, v39
    ds_write2_b32 v3, v36, v37 offset0:16 offset1:56
    v_add_f32 v40, v40, v42
    v_add_f32 v41, v41, v43
    ds_write2_b32 v61, v40, v41 offset0:0 offset1:40
    v_add_f32 v44, v44, v46
    v_add_f32 v45, v45, v47
    ds_write2_b32 v61, v44, v45 offset0:16 offset1:56
    v_add_f32 v48, v48, v50
    v_add_f32 v49, v49, v51
    ds_write2_b32 v62, v48, v49 offset0:0 offset1:40
    v_add_f32 v52, v52, v54
    v_add_f32 v53, v53, v55
    ds_write2_b32 v62, v52, v53 offset0:16 offset1:56
    s_waitcnt lgkmcnt(0)
    s_barrier
    s_cbranch_scc1 ploopH_16_sk1
    ds_read_b128 v[32:35], v4 offset:0
    ds_read_b128 v[36:39], v4 offset:3840
    ds_read_b128 v[40:43], v4 offset:7680
    ds_read_b128 v[44:47], v4 offset:11520
    s_waitcnt lgkmcnt(2)
    v_add_f32 v32, v32, v36
    v_add_f32 v33, v33, v37
    v_add_f32 v34, v34, v38
    v_add_f32 v35, v35, v39
    s_waitcnt lgkmcnt(0)
    v_add_f32 v40, v40, v44
    v_add_f32 v41, v41, v45
    v_add_f32 v42, v42, v46
    v_add_f32 v43, v43, v47
    v_add_f32 v32, v32, v40
    v_add_f32 v33, v33, v41
    v_add_f32 v34, v34, v42
    v_add_f32 v35, v35, v43
    v_cvt_pk_bf16_f32 v56, v32, v33
    v_cvt_pk_bf16_f32 v57, v34, v35
    v_min_u32 v56, -2, v56
    buffer_store_dwordx2 v[56:57], v2, s[4:7], s26 offen
    s_add_u32 s27, s16, 2
    s_and_b32 s27, s27, 3
    s_lshl_b32 s27, s27, 18
    s_add_u32 s27, s27, s38
    buffer_store_dwordx2 v[10:11], v2, s[4:7], s27 offen
ploopH_16_sk1:
    s_setprio 0
    s_add_u32 s25, s16, 3
    s_and_b32 s25, s25, 3
    s_lshl_b32 s25, s25, 16
    s_add_u32 s25, s25, s37
    v_mov_b32 v44, -1
    v_mov_b32 v45, -1
    v_mov_b32 v46, -1
    v_mov_b32 v47, -1
    s_mov_b64 exec, s[56:57]
    buffer_store_dwordx4 v[44:47], v5, s[4:7], s25 offen
    s_mov_b64 exec, -1
    v_mov_b32_dpp v48, v12 row_ror:8 row_mask:0xf bank_mask:0xf
    v_mov_b32_dpp v49, v13 row_ror:8 row_mask:0xf bank_mask:0xf
    v_mov_b32_dpp v50, v14 row_ror:8 row_mask:0xf bank_mask:0xf
    v_mov_b32_dpp v51, v15 row_ror:8 row_mask:0xf bank_mask:0xf
    s_and_b32 s28, s16, 3
    s_lshl_b32 s28, s28, 18
    s_add_u32 s28, s28, s39
    s_add_u32 s24, s16, 1
    s_and_b32 s24, s24, 3
    s_lshl_b32 s24, s24, 16
    s_add_u32 s24, s24, s37
    s_add_u32 s23, s16, 1
    s_and_b32 s23, s23, 3
    s_lshl_b32 s23, s23, 16
    s_add_u32 s23, s23, s36
    s_add_u32 s26, s16, 1
    s_and_b32 s26, s26, 3
    s_lshl_b32 s26, s26, 18
    s_add_u32 s26, s26, s38
    s_cmp_eq_u32 s59, 0
    s_cbranch_scc1 ofl_21
    s_lshl_b32 s17, s3, 10
    v_add_u32 v39, s17, v1
    ds_read_b128 v[40:43], v39 offset:32768
ofl_21:
    s_cmp_eq_u32 s16, 63
    s_cbranch_scc1 ploopH_16_tail
    s_cmp_eq_u32 s30, s54
    s_cbranch_scc1 pnoseg_22
    ds_read_b128 v[16:19], v6 offset:0
    ds_read_b128 v[20:23], v6 offset:256
    ds_read_b128 v[24:27], v6 offset:512
    ds_read_b128 v[28:31], v6 offset:768
    v_xor_b32 v6, 0x4000, v6
    s_waitcnt lgkmcnt(2)
    v_mfma_f32_16x16x32_bf16 v[40:43], v[12:15], v[16:19], 0
    v_mfma_f32_16x16x32_bf16 v[40:43], v[48:51], v[20:23], v[40:43]
    s_waitcnt lgkmcnt(0)
    v_mfma_f32_16x16x32_bf16 v[44:47], v[12:15], v[24:27], 0
    v_mfma_f32_16x16x32_bf16 v[44:47], v[48:51], v[28:31], v[44:47]
    s_nop 7
    v_cvt_pk_bf16_f32 v40, v40, v41
    v_cvt_pk_bf16_f32 v41, v42, v43
    v_cvt_pk_bf16_f32 v42, v44, v45
    v_cvt_pk_bf16_f32 v43, v46, v47
    s_nop 1
    v_permlane16_swap_b32 v40, v42
    v_permlane16_swap_b32 v41, v43
    s_nop 1
    v_min_u32 v40, -2, v40
pnoseg_22:
    s_bitcmp1_b32 s29, 0
    s_cbranch_scc1 gate_23_ok
    s_add_u32 s21, s16, 1
    s_min_u32 s21, s21, 63
    s_cmp_ge_u32 s21, 16
    s_cselect_b32 s19, 12, 8
    s_and_b32 s32, s21, 4
    s_lshr_b32 s21, s21, 3
    s_lshl_b32 s21, s21, 8
    s_add_u32 s32, s32, s21
    s_add_u32 s32, s32, s35
gate_23:
    buffer_load_dword v9, off, s[4:7], s32 sc1
    s_waitcnt vmcnt(0)
    v_readfirstlane_b32 s21, v9
    s_cmp_ge_u32 s21, s19
    s_cbranch_scc1 gate_23_set
    s_sleep 8
    s_sub_u32 s22, s22, 1
    s_cbranch_scc0 gate_23
    s_mov_b32 s22, 0
gate_23_set:
    s_bitset1_b32 s29, 0
gate_23_ok:
    v_readfirstlane_b32 s21, v60
    s_lshr_b32 s29, s29, 1
    s_cmp_ge_u32 s21, s58
    s_cselect_b32 s21, 2, 0
    s_or_b32 s29, s29, s21
    s_cmp_eq_u32 s3, 3
    s_cselect_b32 s20, s21, 0
    s_add_u32 s21, s16, 4
    s_min_u32 s21, s21, 63
    s_cmp_ge_u32 s21, 16
    s_cselect_b32 s58, 12, 8
    s_and_b32 s33, s21, 4
    s_lshr_b32 s21, s21, 3
    s_lshl_b32 s21, s21, 8
    s_add_u32 s33, s33, s21
    s_add_u32 s33, s33, s35
    s_setprio 3
ploopH_16_fs:
    ds_read_b128 v[32:35], v58 offset:0
    s_waitcnt lgkmcnt(0)
    v_min3_i32 v32, v32, v33, v34
    v_min_i32 v32, v32, v35
    s_nop 0
    v_readfirstlane_b32 s18, v32
    s_cmp_ge_i32 s18, s16
    s_cbranch_scc1 ploopH_16_fsok
    s_sleep 1
    s_branch ploopH_16_fs
ploopH_16_fsok:
    s_setprio 1
    s_add_u32 m0, s42, 0
    s_add_u32 s17, s41, 20971520
    buffer_load_dwordx4 v1, s[4:7], s17 offen offset:0 sc1 lds
    buffer_load_dwordx4 v1, s[4:7], s17 offen offset:1024 sc1 lds
    buffer_load_dwordx4 v1, s[4:7], s17 offen offset:2048 sc1 lds
    buffer_load_dwordx4 v1, s[4:7], s17 offen offset:3072 sc1 lds
    s_add_u32 m0, s42, 4096
    s_add_u32 s17, s41, 21102592
    buffer_load_dwordx4 v1, s[4:7], s17 offen offset:0 sc1 lds
    buffer_load_dwordx4 v1, s[4:7], s17 offen offset:1024 sc1 lds
    buffer_load_dwordx4 v1, s[4:7], s17 offen offset:2048 sc1 lds
    buffer_load_dwordx4 v1, s[4:7], s17 offen offset:3072 sc1 lds
    s_cmp_eq_u32 s20, 0
    s_cbranch_scc1 ploopH_16_nt
    s_mov_b32 exec_hi, 0xffff
    buffer_load_dword v60, v0, s[4:7], s31 offen sc1
    s_mov_b32 exec_hi, -1
ploopH_16_nt:
    s_cmp_eq_u32 s59, 0
    s_cbranch_scc1 ofl_24
    s_lshl_b32 s17, s16, 18
    s_add_u32 s17, s17, s60
    buffer_store_dwordx4 v[40:43], v1, s[4:7], s17 offen sc1
    s_mov_b32 s59, 0
ofl_24:
    s_cmp_eq_u32 s30, s54
    s_cbranch_scc1 pnoseg_25
    buffer_store_dwordx4 v[40:43], v7, s[4:7], s30 offen sc1
    s_add_u32 s30, s30, 65536
pnoseg_25:
    s_barrier
    buffer_load_dword v60, off, s[4:7], s33 sc1
    s_sleep 6
    s_add_u32 m0, s42, 8192
    s_add_u32 s17, s41, 37748736
    buffer_load_dwordx4 v1, s[4:7], s17 offen offset:0 sc1 lds
    buffer_load_dwordx4 v1, s[4:7], s17 offen offset:1024 sc1 lds
    buffer_load_dwordx4 v1, s[4:7], s17 offen offset:2048 sc1 lds
    buffer_load_dwordx4 v1, s[4:7], s17 offen offset:3072 sc1 lds
    s_add_u32 m0, s42, 12288
    s_add_u32 s17, s41, 37879808
    buffer_load_dwordx4 v1, s[4:7], s17 offen offset:0 sc1 lds
    buffer_load_dwordx4 v1, s[4:7], s17 offen offset:1024 sc1 lds
    buffer_load_dwordx4 v1, s[4:7], s17 offen offset:2048 sc1 lds
    buffer_load_dwordx4 v1, s[4:7], s17 offen offset:3072 sc1 lds
    s_add_u32 s16, s16, 1
    v_mov_b32 v59, s16
    s_add_u32 s41, s41, 262144
    s_add_u32 s31, s31, 262144
    s_mov_b32 s54, 0
    s_setprio 3
    s_sleep 1
ploopH_16_pagain:
    buffer_load_dwordx4 v[16:19], v1, s[4:7], s28 offen offset:0 sc1
    buffer_load_dwordx4 v[20:23], v1, s[4:7], s28 offen offset:1024 sc1
    s_waitcnt vmcnt(1)
    v_mfma_f32_16x16x32_bf16 v[32:35], v[12:15], v[16:19], 0
    s_waitcnt vmcnt(0)
    v_mfma_f32_16x16x32_bf16 v[32:35], v[48:51], v[20:23], v[32:35]
    v_max_u32 v9, v16, v20
    v_cmp_eq_u32 vcc, -1, v9
    s_cbranch_vccnz ploopH_16_rp
ploopH_16_pgo:
    s_nop 4
    v_add_f32_dpp v36, v32, v32 row_ror:8 row_mask:0xf bank_mask:0xf
    v_add_f32_dpp v37, v33, v33 row_ror:8 row_mask:0xf bank_mask:0xf
    v_add_f32_dpp v38, v34, v34 row_ror:8 row_mask:0xf bank_mask:0xf
    v_add_f32_dpp v39, v35, v35 row_ror:8 row_mask:0xf bank_mask:0xf
    v_cvt_pk_bf16_f32 v52, v36, v37
    v_cvt_pk_bf16_f32 v53, v38, v39
    s_nop 0
    v_permlane16_swap_b32 v52, v54
    v_permlane16_swap_b32 v53, v55
    s_mov_b64 exec, s[56:57]
    v_min_u32 v52, -2, v52
    buffer_store_dwordx4 v[52:55], v5, s[4:7], s24 offen
    s_mov_b64 exec, -1
    ds_write_b32 v63, v59 offset:16
    s_branch ploopH_16
ploopH_16_rm_0:
    s_sub_u32 s22, s22, 1
    s_cbranch_scc1 ploopH_16_rm_0_g
    buffer_load_dwordx4 v[16:19], v1, s[4:7], s23 offen offset:0 sc1
    buffer_load_dwordx4 v[20:23], v1, s[4:7], s23 offen offset:1024 sc1
    buffer_load_dwordx4 v[24:27], v1, s[4:7], s23 offen offset:2048 sc1
    buffer_load_dwordx4 v[28:31], v1, s[4:7], s23 offen offset:3072 sc1
    s_waitcnt vmcnt(3)
    v_cmp_eq_u32 vcc, -1, v16
    s_cbranch_vccnz ploopH_16_rm_0
    s_branch ploopH_16_rm_0ok
ploopH_16_rm_0_g:
    s_mov_b32 s22, 0
    s_waitcnt vmcnt(0)
    s_branch ploopH_16_rm_0ok
ploopH_16_rm_1:
    s_sub_u32 s22, s22, 1
    s_cbranch_scc1 ploopH_16_rm_1_g
    buffer_load_dwordx4 v[20:23], v1, s[4:7], s23 offen offset:1024 sc1
    buffer_load_dwordx4 v[24:27], v1, s[4:7], s23 offen offset:2048 sc1
    buffer_load_dwordx4 v[28:31], v1, s[4:7], s23 offen offset:3072 sc1
    s_waitcnt vmcnt(2)
    v_cmp_eq_u32 vcc, -1, v20
    s_cbranch_vccnz ploopH_16_rm_1
    s_branch ploopH_16_rm_1ok
ploopH_16_rm_1_g:
    s_mov_b32 s22, 0
    s_waitcnt vmcnt(0)
    s_branch ploopH_16_rm_1ok
ploopH_16_rm_2:
    s_sub_u32 s22, s22, 1
    s_cbranch_scc1 ploopH_16_rm_2_g
    buffer_load_dwordx4 v[24:27], v1, s[4:7], s23 offen offset:2048 sc1
    buffer_load_dwordx4 v[28:31], v1, s[4:7], s23 offen offset:3072 sc1
    s_waitcnt vmcnt(1)
    v_cmp_eq_u32 vcc, -1, v24
    s_cbranch_vccnz ploopH_16_rm_2
    s_branch ploopH_16_rm_2ok
ploopH_16_rm_2_g:
    s_mov_b32 s22, 0
    s_waitcnt vmcnt(0)
    s_branch ploopH_16_rm_2ok
ploopH_16_rm_3:
    s_sub_u32 s22, s22, 1
    s_cbranch_scc1 ploopH_16_rm_3_g
    buffer_load_dwordx4 v[28:31], v1, s[4:7], s23 offen offset:3072 sc1
    s_waitcnt vmcnt(0)
    v_cmp_eq_u32 vcc, -1, v28
    s_cbranch_vccnz ploopH_16_rm_3
    s_branch ploopH_16_rm_3ok
ploopH_16_rm_3_g:
    s_mov_b32 s22, 0
    s_waitcnt vmcnt(0)
    s_branch ploopH_16_rm_3ok
ploopH_16_rp:
    s_sub_u32 s22, s22, 1
    s_cbranch_scc0 ploopH_16_pagain
    s_mov_b32 s22, 0
    s_branch ploopH_16_pgo
ploopH_16_tail:
    ds_read_b128 v[16:19], v6 offset:0
    ds_read_b128 v[20:23], v6 offset:256
    ds_read_b128 v[24:27], v6 offset:512
    ds_read_b128 v[28:31], v6 offset:768
    v_xor_b32 v6, 0x4000, v6
    s_waitcnt lgkmcnt(2)
    v_mfma_f32_16x16x32_bf16 v[40:43], v[12:15], v[16:19], 0
    v_mfma_f32_16x16x32_bf16 v[40:43], v[48:51], v[20:23], v[40:43]
    s_waitcnt lgkmcnt(0)
    v_mfma_f32_16x16x32_bf16 v[44:47], v[12:15], v[24:27], 0
    v_mfma_f32_16x16x32_bf16 v[44:47], v[48:51], v[28:31], v[44:47]
    s_nop 7
    v_cvt_pk_bf16_f32 v40, v40, v41
    v_cvt_pk_bf16_f32 v41, v42, v43
    v_cvt_pk_bf16_f32 v42, v44, v45
    v_cvt_pk_bf16_f32 v43, v46, v47
    s_nop 1
    v_permlane16_swap_b32 v40, v42
    v_permlane16_swap_b32 v41, v43
    s_nop 1
    v_min_u32 v40, -2, v40
    buffer_store_dwordx4 v[40:43], v7, s[4:7], s30 offen sc1
    s_add_u32 s30, s30, 65536
    s_barrier
    ds_read_b128 v[16:19], v6 offset:0
    ds_read_b128 v[20:23], v6 offset:256
    ds_read_b128 v[24:27], v6 offset:512
    ds_read_b128 v[28:31], v6 offset:768
    v_xor_b32 v6, 0x4000, v6
    s_waitcnt lgkmcnt(2)
    v_mfma_f32_16x16x32_bf16 v[40:43], v[12:15], v[16:19], 0
    v_mfma_f32_16x16x32_bf16 v[40:43], v[48:51], v[20:23], v[40:43]
    s_waitcnt lgkmcnt(0)
    v_mfma_f32_16x16x32_bf16 v[44:47], v[12:15], v[24:27], 0
    v_mfma_f32_16x16x32_bf16 v[44:47], v[48:51], v[28:31], v[44:47]
    s_nop 7
    v_cvt_pk_bf16_f32 v40, v40, v41
    v_cvt_pk_bf16_f32 v41, v42, v43
    v_cvt_pk_bf16_f32 v42, v44, v45
    v_cvt_pk_bf16_f32 v43, v46, v47
    s_nop 1
    v_permlane16_swap_b32 v40, v42
    v_permlane16_swap_b32 v41, v43
    s_nop 1
    v_min_u32 v40, -2, v40
    buffer_store_dwordx4 v[40:43], v7, s[4:7], s30 offen sc1
    s_add_u32 s30, s30, 65536
    s_branch k_end
ch_p_slow:
    v_mov_b32 v32, 0
    v_mov_b32 v33, 0
    v_mov_b32 v34, 0
    v_mov_b32 v35, 0
    v_mov_b32 v36, 0
    v_mov_b32 v37, 0
    v_mov_b32 v38, 0
    v_mov_b32 v39, 0
    v_mov_b32 v40, 0
    v_mov_b32 v41, 0
    v_mov_b32 v42, 0
    v_mov_b32 v43, 0
    v_mov_b32 v44, 0
    v_mov_b32 v45, 0
    v_mov_b32 v46, 0
    v_mov_b32 v47, 0
    v_mov_b32 v48, 0
    v_mov_b32 v49, 0
    v_mov_b32 v50, 0
    v_mov_b32 v51, 0
    v_mov_b32 v52, 0
    v_mov_b32 v53, 0
    v_mov_b32 v54, 0
    v_mov_b32 v55, 0
    v_mov_b32 v59, 0
    s_nop 1
    s_branch ploopL_27_nc
.p2align 6
    s_nop 0
    s_nop 0
    s_nop 0
    s_nop 0
    s_nop 0
    s_nop 0
    s_nop 0
    s_nop 0
    s_nop 0
    s_nop 0
    s_nop 0
ploopL_27:
    v_mov_b32 v32, 0
    v_mov_b32 v33, 0
    v_mov_b32 v34, 0
    v_mov_b32 v35, 0
    v_mov_b32 v36, 0
    v_mov_b32 v37, 0
    v_mov_b32 v38, 0
    v_mov_b32 v39, 0
    v_mov_b32 v40, 0
    v_mov_b32 v41, 0
    v_mov_b32 v42, 0
    v_mov_b32 v43, 0
    v_mov_b32 v44, 0
    v_mov_b32 v45, 0
    v_mov_b32 v46, 0
    v_mov_b32 v47, 0
    v_mov_b32 v48, 0
    v_mov_b32 v49, 0
    v_mov_b32 v50, 0
    v_mov_b32 v51, 0
    v_mov_b32 v52, 0
    v_mov_b32 v53, 0
    v_mov_b32 v54, 0
    v_mov_b32 v55, 0
    s_bitcmp1_b32 s29, 0
    s_cbranch_scc1 gate_28_ok
    s_add_u32 s21, s16, 1
    s_min_u32 s21, s21, 63
    s_cmp_ge_u32 s21, 16
    s_cselect_b32 s19, 12, 8
    s_and_b32 s32, s21, 4
    s_lshr_b32 s21, s21, 3
    s_lshl_b32 s21, s21, 8
    s_add_u32 s32, s32, s21
    s_add_u32 s32, s32, s35
gate_28:
    buffer_load_dword v9, off, s[4:7], s32 sc1
    s_waitcnt vmcnt(0)
    v_readfirstlane_b32 s21, v9
    s_cmp_ge_u32 s21, s19
    s_cbranch_scc1 gate_28_set
    s_sleep 8
    s_sub_u32 s22, s22, 1
    s_cbranch_scc0 gate_28
    s_mov_b32 s22, 0
gate_28_set:
    s_bitset1_b32 s29, 0
gate_28_ok:
    s_sleep 1
    buffer_load_dwordx4 v[16:19], v1, s[4:7], s23 offen offset:0 sc1
    buffer_load_dwordx4 v[20:23], v1, s[4:7], s23 offen offset:1024 sc1
    buffer_load_dwordx4 v[24:27], v1, s[4:7], s23 offen offset:2048 sc1
    buffer_load_dwordx4 v[28:31], v1, s[4:7], s23 offen offset:3072 sc1
    s_waitcnt vmcnt(3)
    v_cmp_eq_u32 vcc, -1, v16
    s_cbranch_vccnz ploopL_27_rm_0
ploopL_27_rm_0ok:
    v_smfmac_f32_16x16x64_bf16 v[32:35], v[16:19], v[64:71], v8
    v_smfmac_f32_16x16x64_bf16 v[36:39], v[16:19], v[72:79], v8
    s_waitcnt vmcnt(2)
    v_cmp_eq_u32 vcc, -1, v20
    v_smfmac_f32_16x16x64_bf16 v[40:43], v[16:19], v[80:87], v8
    v_smfmac_f32_16x16x64_bf16 v[44:47], v[16:19], v[88:95], v8
    v_smfmac_f32_16x16x64_bf16 v[48:51], v[16:19], v[96:103], v8
    v_smfmac_f32_16x16x64_bf16 v[52:55], v[16:19], v[104:111], v8
    s_cbranch_vccnz ploopL_27_rm_1
ploopL_27_rm_1ok:
    v_smfmac_f32_16x16x64_bf16 v[32:35], v[20:23], v[112:119], v8
    v_smfmac_f32_16x16x64_bf16 v[36:39], v[20:23], v[120:127], v8
    s_waitcnt vmcnt(1)
    v_cmp_eq_u32 vcc, -1, v24
    v_smfmac_f32_16x16x64_bf16 v[40:43], v[20:23], v[128:135], v8
    v_smfmac_f32_16x16x64_bf16 v[44:47], v[20:23], v[136:143], v8
    v_smfmac_f32_16x16x64_bf16 v[48:51], v[20:23], v[144:151], v8
    v_smfmac_f32_16x16x64_bf16 v[52:55], v[20:23], v[152:159], v8
    s_cbranch_vccnz ploopL_27_rm_2
ploopL_27_rm_2ok:
    v_smfmac_f32_16x16x64_bf16 v[32:35], v[24:27], v[160:167], v8
    v_smfmac_f32_16x16x64_bf16 v[36:39], v[24:27], v[168:175], v8
    s_waitcnt vmcnt(0)
    v_cmp_eq_u32 vcc, -1, v28
    v_smfmac_f32_16x16x64_bf16 v[40:43], v[24:27], v[176:183], v8
    v_smfmac_f32_16x16x64_bf16 v[44:47], v[24:27], v[184:191], v8
    v_smfmac_f32_16x16x64_bf16 v[48:51], v[24:27], v[192:199], v8
    v_smfmac_f32_16x16x64_bf16 v[52:55], v[24:27], v[200:207], v8
    s_cbranch_vccnz ploopL_27_rm_3
ploopL_27_rm_3ok:
    v_smfmac_f32_16x16x64_bf16 v[32:35], v[28:31], v[208:215], v8
    ds_write_b32 v63, v59 offset:32
    v_smfmac_f32_16x16x64_bf16 v[36:39], v[28:31], v[216:223], v8
    v_smfmac_f32_16x16x64_bf16 v[40:43], v[28:31], v[224:231], v8
    v_smfmac_f32_16x16x64_bf16 v[44:47], v[28:31], v[232:239], v8
    v_smfmac_f32_16x16x64_bf16 v[48:51], v[28:31], v[240:247], v8
    v_smfmac_f32_16x16x64_bf16 v[52:55], v[28:31], v[248:255], v8
    s_branch ploopL_27_mmd
ploopL_27_nc:
    v_smfmac_f32_16x16x64_bf16 v[32:35], v[16:19], v[64:71], v8
    v_smfmac_f32_16x16x64_bf16 v[36:39], v[16:19], v[72:79], v8
    v_smfmac_f32_16x16x64_bf16 v[40:43], v[16:19], v[80:87], v8
    v_smfmac_f32_16x16x64_bf16 v[44:47], v[16:19], v[88:95], v8
    v_smfmac_f32_16x16x64_bf16 v[48:51], v[16:19], v[96:103], v8
    v_smfmac_f32_16x16x64_bf16 v[52:55], v[16:19], v[104:111], v8
    v_smfmac_f32_16x16x64_bf16 v[32:35], v[20:23], v[112:119], v8
    v_smfmac_f32_16x16x64_bf16 v[36:39], v[20:23], v[120:127], v8
    v_smfmac_f32_16x16x64_bf16 v[40:43], v[20:23], v[128:135], v8
    v_smfmac_f32_16x16x64_bf16 v[44:47], v[20:23], v[136:143], v8
    v_smfmac_f32_16x16x64_bf16 v[48:51], v[20:23], v[144:151], v8
    v_smfmac_f32_16x16x64_bf16 v[52:55], v[20:23], v[152:159], v8
    v_smfmac_f32_16x16x64_bf16 v[32:35], v[24:27], v[160:167], v8
    v_smfmac_f32_16x16x64_bf16 v[36:39], v[24:27], v[168:175], v8
    v_smfmac_f32_16x16x64_bf16 v[40:43], v[24:27], v[176:183], v8
    v_smfmac_f32_16x16x64_bf16 v[44:47], v[24:27], v[184:191], v8
    v_smfmac_f32_16x16x64_bf16 v[48:51], v[24:27], v[192:199], v8
    v_smfmac_f32_16x16x64_bf16 v[52:55], v[24:27], v[200:207], v8
    v_smfmac_f32_16x16x64_bf16 v[32:35], v[28:31], v[208:215], v8
    ds_write_b32 v63, v59 offset:32
    v_smfmac_f32_16x16x64_bf16 v[36:39], v[28:31], v[216:223], v8
    v_smfmac_f32_16x16x64_bf16 v[40:43], v[28:31], v[224:231], v8
    v_smfmac_f32_16x16x64_bf16 v[44:47], v[28:31], v[232:239], v8
    v_smfmac_f32_16x16x64_bf16 v[48:51], v[28:31], v[240:247], v8
    v_smfmac_f32_16x16x64_bf16 v[52:55], v[28:31], v[248:255], v8
ploopL_27_mmd:
    s_cmp_eq_u32 s3, 3
    s_nop 1
    v_add_f32 v32, v32, v34
    v_add_f32 v33, v33, v35
    ds_write2_b32 v3, v32, v33 offset0:0 offset1:40
    v_add_f32 v36, v36, v38
    v_add_f32 v37, v37, v39
    ds_write2_b32 v3, v36, v37 offset0:16 offset1:56
    v_add_f32 v40, v40, v42
    v_add_f32 v41, v41, v43
    ds_write2_b32 v61, v40, v41 offset0:0 offset1:40
    v_add_f32 v44, v44, v46
    v_add_f32 v45, v45, v47
    ds_write2_b32 v61, v44, v45 offset0:16 offset1:56
    v_add_f32 v48, v48, v50
    v_add_f32 v49, v49, v51
    ds_write2_b32 v62, v48, v49 offset0:0 offset1:40
    v_add_f32 v52, v52, v54
    v_add_f32 v53, v53, v55
    ds_write2_b32 v62, v52, v53 offset0:16 offset1:56
    s_waitcnt lgkmcnt(0)
    s_barrier
    s_cbranch_scc1 ploopL_27_sk1
    ds_read_b128 v[32:35], v4 offset:0
    ds_read_b128 v[36:39], v4 offset:3840
    ds_read_b128 v[40:43], v4 offset:7680
    ds_read_b128 v[44:47], v4 offset:11520
    s_waitcnt lgkmcnt(2)
    v_add_f32 v32, v32, v36
    v_add_f32 v33, v33, v37
    v_add_f32 v34, v34, v38
    v_add_f32 v35, v35, v39
    s_waitcnt lgkmcnt(0)
    v_add_f32 v40, v40, v44
    v_add_f32 v41, v41, v45
    v_add_f32 v42, v42, v46
    v_add_f32 v43, v43, v47
    v_add_f32 v32, v32, v40
    v_add_f32 v33, v33, v41
    v_add_f32 v34, v34, v42
    v_add_f32 v35, v35, v43
    v_cvt_pk_bf16_f32 v56, v32, v33
    v_cvt_pk_bf16_f32 v57, v34, v35
    v_min_u32 v56, -2, v56
    buffer_store_dwordx2 v[56:57], v2, s[4:7], s26 offen sc1
    s_add_u32 s27, s16, 2
    s_and_b32 s27, s27, 3
    s_lshl_b32 s27, s27, 18
    s_add_u32 s27, s27, s38
    buffer_store_dwordx2 v[10:11], v2, s[4:7], s27 offen sc1
ploopL_27_sk1:
    s_setprio 0
    s_add_u32 s25, s16, 3
    s_and_b32 s25, s25, 3
    s_lshl_b32 s25, s25, 16
    s_add_u32 s25, s25, s37
    v_mov_b32 v44, -1
    v_mov_b32 v45, -1
    v_mov_b32 v46, -1
    v_mov_b32 v47, -1
    s_mov_b64 exec, s[56:57]
    buffer_store_dwordx4 v[44:47], v5, s[4:7], s25 offen sc1
    s_mov_b64 exec, -1
    v_mov_b32_dpp v48, v12 row_ror:8 row_mask:0xf bank_mask:0xf
    v_mov_b32_dpp v49, v13 row_ror:8 row_mask:0xf bank_mask:0xf
    v_mov_b32_dpp v50, v14 row_ror:8 row_mask:0xf bank_mask:0xf
    v_mov_b32_dpp v51, v15 row_ror:8 row_mask:0xf bank_mask:0xf
    s_and_b32 s28, s16, 3
    s_lshl_b32 s28, s28, 18
    s_add_u32 s28, s28, s39
    s_add_u32 s24, s16, 1
    s_and_b32 s24, s24, 3
    s_lshl_b32 s24, s24, 16
    s_add_u32 s24, s24, s37
    s_add_u32 s23, s16, 1
    s_and_b32 s23, s23, 3
    s_lshl_b32 s23, s23, 16
    s_add_u32 s23, s23, s36
    s_add_u32 s26, s16, 1
    s_and_b32 s26, s26, 3
    s_lshl_b32 s26, s26, 18
    s_add_u32 s26, s26, s38
    s_cmp_eq_u32 s59, 0
    s_cbranch_scc1 ofl_29
    s_lshl_b32 s17, s3, 10
    v_add_u32 v39, s17, v1
    ds_read_b128 v[40:43], v39 offset:32768
ofl_29:
    s_cmp_ge_u32 s16, 16
    s_cbranch_scc1 ploopL_27_nx
    v_mov_b32 v40, v2
    v_mov_b32 v42, v56
    v_mov_b32 v43, v57
    s_cmp_lg_u32 s3, 2
    s_cbranch_scc1 ploopL_27_nx
    v_and_b32 v40, 0x60, v1
    v_lshlrev_b32 v40, 2, v40
    v_lshrrev_b32 v41, 3, v1
    v_and_b32 v41, 0x70, v41
    v_or_b32 v40, v40, v41
    v_bfe_u32 v41, v1, 4, 1
    v_lshl_or_b32 v40, v41, 3, v40
    s_lshl_b32 s17, s53, 9
    s_add_u32 s17, s17, 4096
    v_add_u32 v40, s17, v40
    s_mov_b32 vcc_lo, 0x55555555
    s_mov_b32 vcc_hi, 0x55555555
    v_cndmask_b32_dpp v42, v57, v56, vcc quad_perm:[1,0,3,2] row_mask:0xf bank_mask:0xf
    s_not_b64 vcc, vcc
    v_cndmask_b32_dpp v43, v56, v57, vcc quad_perm:[1,0,3,2] row_mask:0xf bank_mask:0xf
ploopL_27_nx:
    v_readfirstlane_b32 s21, v60
    s_lshr_b32 s29, s29, 1
    s_cmp_ge_u32 s21, s58
    s_cselect_b32 s21, 2, 0
    s_or_b32 s29, s29, s21
    s_cmp_eq_u32 s3, 3
    s_cselect_b32 s20, s21, 0
    s_add_u32 s21, s16, 4
    s_min_u32 s21, s21, 63
    s_cmp_ge_u32 s21, 16
    s_cselect_b32 s58, 12, 8
    s_and_b32 s33, s21, 4
    s_lshr_b32 s21, s21, 3
    s_lshl_b32 s21, s21, 8
    s_add_u32 s33, s33, s21
    s_add_u32 s33, s33, s35
    s_setprio 3
ploopL_27_fs:
    ds_read_b128 v[32:35], v58 offset:0
    s_waitcnt lgkmcnt(0)
    v_min3_i32 v32, v32, v33, v34
    v_min_i32 v32, v32, v35
    s_nop 0
    v_readfirstlane_b32 s18, v32
    s_cmp_ge_i32 s18, s16
    s_cbranch_scc1 ploopL_27_fsok
    s_sleep 1
    s_branch ploopL_27_fs
ploopL_27_fsok:
    s_setprio 1
    s_sleep 5
    s_cmp_eq_u32 s20, 0
    s_cbranch_scc1 ploopL_27_nt
    s_cmp_ge_u32 s16, 13
    s_cselect_b32 exec_hi, 0xffff, 0
    buffer_load_dword v60, v0, s[4:7], s31 offen sc1
    s_mov_b32 exec_hi, -1
ploopL_27_nt:
    s_cmp_eq_u32 s59, 0
    s_cbranch_scc1 ofl_30
    s_lshl_b32 s17, s16, 18
    s_add_u32 s17, s17, s60
    buffer_store_dwordx4 v[40:43], v1, s[4:7], s17 offen sc1
    s_mov_b32 s59, 0
ofl_30:
    s_lshr_b32 s17, s34, 3
    s_xor_b32 s17, s17, s16
    s_andn2_b32 s59, 1, s17
    s_cmp_ge_u32 s16, 16
    s_cselect_b32 s59, s59, 0
    s_cbranch_scc1 ploopL_27_nx2
    s_cmp_eq_u32 s3, 3
    s_cbranch_scc1 ploopL_27_nx2
    buffer_store_dwordx2 v[42:43], v40, s[4:7], s55 offen sc1
ploopL_27_nx2:
    s_add_u32 s55, s55, 262144
    s_barrier
    buffer_load_dword v60, off, s[4:7], s33 sc1
    s_add_u32 s16, s16, 1
    v_mov_b32 v59, s16
    s_add_u32 s41, s41, 262144
    s_add_u32 s31, s31, 262144
    s_setprio 3
    s_sleep 13
ploopL_27_pagain:
    buffer_load_dwordx4 v[16:19], v1, s[4:7], s28 offen offset:0 sc1
    buffer_load_dwordx4 v[20:23], v1, s[4:7], s28 offen offset:1024 sc1
    s_waitcnt vmcnt(1)
    v_mfma_f32_16x16x32_bf16 v[32:35], v[12:15], v[16:19], 0
    s_waitcnt vmcnt(0)
    v_mfma_f32_16x16x32_bf16 v[32:35], v[48:51], v[20:23], v[32:35]
    v_max_u32 v9, v16, v20
    v_cmp_eq_u32 vcc, -1, v9
    s_cbranch_vccnz ploopL_27_rp
ploopL_27_pgo:
    s_cmp_lt_u32 s16, 48
    s_nop 3
    v_add_f32_dpp v36, v32, v32 row_ror:8 row_mask:0xf bank_mask:0xf
    v_add_f32_dpp v37, v33, v33 row_ror:8 row_mask:0xf bank_mask:0xf
    v_add_f32_dpp v38, v34, v34 row_ror:8 row_mask:0xf bank_mask:0xf
    v_add_f32_dpp v39, v35, v35 row_ror:8 row_mask:0xf bank_mask:0xf
    v_cvt_pk_bf16_f32 v52, v36, v37
    v_cvt_pk_bf16_f32 v53, v38, v39
    s_nop 0
    v_permlane16_swap_b32 v52, v54
    v_permlane16_swap_b32 v53, v55
    s_mov_b64 exec, s[56:57]
    v_min_u32 v52, -2, v52
    buffer_store_dwordx4 v[52:55], v5, s[4:7], s24 offen sc1
    s_mov_b64 exec, -1
    ds_write_b32 v63, v59 offset:16
    s_cbranch_scc1 ploopL_27
    s_branch ploopH_26
ploopL_27_rm_0:
    s_sub_u32 s22, s22, 1
    s_cbranch_scc1 ploopL_27_rm_0_g
    buffer_load_dwordx4 v[16:19], v1, s[4:7], s23 offen offset:0 sc1
    buffer_load_dwordx4 v[20:23], v1, s[4:7], s23 offen offset:1024 sc1
    buffer_load_dwordx4 v[24:27], v1, s[4:7], s23 offen offset:2048 sc1
    buffer_load_dwordx4 v[28:31], v1, s[4:7], s23 offen offset:3072 sc1
    s_waitcnt vmcnt(3)
    v_cmp_eq_u32 vcc, -1, v16
    s_cbranch_vccnz ploopL_27_rm_0
    s_branch ploopL_27_rm_0ok
ploopL_27_rm_0_g:
    s_mov_b32 s22, 0
    s_waitcnt vmcnt(0)
    s_branch ploopL_27_rm_0ok
ploopL_27_rm_1:
    s_sub_u32 s22, s22, 1
    s_cbranch_scc1 ploopL_27_rm_1_g
    buffer_load_dwordx4 v[20:23], v1, s[4:7], s23 offen offset:1024 sc1
    buffer_load_dwordx4 v[24:27], v1, s[4:7], s23 offen offset:2048 sc1
    buffer_load_dwordx4 v[28:31], v1, s[4:7], s23 offen offset:3072 sc1
    s_waitcnt vmcnt(2)
    v_cmp_eq_u32 vcc, -1, v20
    s_cbranch_vccnz ploopL_27_rm_1
    s_branch ploopL_27_rm_1ok
ploopL_27_rm_1_g:
    s_mov_b32 s22, 0
    s_waitcnt vmcnt(0)
    s_branch ploopL_27_rm_1ok
ploopL_27_rm_2:
    s_sub_u32 s22, s22, 1
    s_cbranch_scc1 ploopL_27_rm_2_g
    buffer_load_dwordx4 v[24:27], v1, s[4:7], s23 offen offset:2048 sc1
    buffer_load_dwordx4 v[28:31], v1, s[4:7], s23 offen offset:3072 sc1
    s_waitcnt vmcnt(1)
    v_cmp_eq_u32 vcc, -1, v24
    s_cbranch_vccnz ploopL_27_rm_2
    s_branch ploopL_27_rm_2ok
ploopL_27_rm_2_g:
    s_mov_b32 s22, 0
    s_waitcnt vmcnt(0)
    s_branch ploopL_27_rm_2ok
ploopL_27_rm_3:
    s_sub_u32 s22, s22, 1
    s_cbranch_scc1 ploopL_27_rm_3_g
    buffer_load_dwordx4 v[28:31], v1, s[4:7], s23 offen offset:3072 sc1
    s_waitcnt vmcnt(0)
    v_cmp_eq_u32 vcc, -1, v28
    s_cbranch_vccnz ploopL_27_rm_3
    s_branch ploopL_27_rm_3ok
ploopL_27_rm_3_g:
    s_mov_b32 s22, 0
    s_waitcnt vmcnt(0)
    s_branch ploopL_27_rm_3ok
ploopL_27_rp:
    s_sub_u32 s22, s22, 1
    s_cbranch_scc0 ploopL_27_pagain
    s_mov_b32 s22, 0
    s_branch ploopL_27_pgo
.p2align 6
    s_nop 0
    s_nop 0
    s_nop 0
    s_nop 0
    s_nop 0
    s_nop 0
    s_nop 0
    s_nop 0
    s_nop 0
    s_nop 0
    s_nop 0
ploopH_26:
    v_mov_b32 v32, 0
    v_mov_b32 v33, 0
    v_mov_b32 v34, 0
    v_mov_b32 v35, 0
    v_mov_b32 v36, 0
    v_mov_b32 v37, 0
    v_mov_b32 v38, 0
    v_mov_b32 v39, 0
    v_mov_b32 v40, 0
    v_mov_b32 v41, 0
    v_mov_b32 v42, 0
    v_mov_b32 v43, 0
    v_mov_b32 v44, 0
    v_mov_b32 v45, 0
    v_mov_b32 v46, 0
    v_mov_b32 v47, 0
    v_mov_b32 v48, 0
    v_mov_b32 v49, 0
    v_mov_b32 v50, 0
    v_mov_b32 v51, 0
    v_mov_b32 v52, 0
    v_mov_b32 v53, 0
    v_mov_b32 v54, 0
    v_mov_b32 v55, 0
    s_sleep 1
    buffer_load_dwordx4 v[16:19], v1, s[4:7], s23 offen offset:0 sc1
    buffer_load_dwordx4 v[20:23], v1, s[4:7], s23 offen offset:1024 sc1
    buffer_load_dwordx4 v[24:27], v1, s[4:7], s23 offen offset:2048 sc1
    buffer_load_dwordx4 v[28:31], v1, s[4:7], s23 offen offset:3072 sc1
    s_waitcnt vmcnt(3)
    v_cmp_eq_u32 vcc, -1, v16
    s_cbranch_vccnz ploopH_26_rm_0
ploopH_26_rm_0ok:
    v_smfmac_f32_16x16x64_bf16 v[32:35], v[16:19], v[64:71], v8
    v_smfmac_f32_16x16x64_bf16 v[36:39], v[16:19], v[72:79], v8
    s_waitcnt vmcnt(2)
    v_cmp_eq_u32 vcc, -1, v20
    v_smfmac_f32_16x16x64_bf16 v[40:43], v[16:19], v[80:87], v8
    v_smfmac_f32_16x16x64_bf16 v[44:47], v[16:19], v[88:95], v8
    v_smfmac_f32_16x16x64_bf16 v[48:51], v[16:19], v[96:103], v8
    v_smfmac_f32_16x16x64_bf16 v[52:55], v[16:19], v[104:111], v8
    s_cbranch_vccnz ploopH_26_rm_1
ploopH_26_rm_1ok:
    v_smfmac_f32_16x16x64_bf16 v[32:35], v[20:23], v[112:119], v8
    v_smfmac_f32_16x16x64_bf16 v[36:39], v[20:23], v[120:127], v8
    s_waitcnt vmcnt(1)
    v_cmp_eq_u32 vcc, -1, v24
    v_smfmac_f32_16x16x64_bf16 v[40:43], v[20:23], v[128:135], v8
    v_smfmac_f32_16x16x64_bf16 v[44:47], v[20:23], v[136:143], v8
    v_smfmac_f32_16x16x64_bf16 v[48:51], v[20:23], v[144:151], v8
    v_smfmac_f32_16x16x64_bf16 v[52:55], v[20:23], v[152:159], v8
    s_cbranch_vccnz ploopH_26_rm_2
ploopH_26_rm_2ok:
    v_smfmac_f32_16x16x64_bf16 v[32:35], v[24:27], v[160:167], v8
    v_smfmac_f32_16x16x64_bf16 v[36:39], v[24:27], v[168:175], v8
    s_waitcnt vmcnt(0)
    v_cmp_eq_u32 vcc, -1, v28
    v_smfmac_f32_16x16x64_bf16 v[40:43], v[24:27], v[176:183], v8
    v_smfmac_f32_16x16x64_bf16 v[44:47], v[24:27], v[184:191], v8
    v_smfmac_f32_16x16x64_bf16 v[48:51], v[24:27], v[192:199], v8
    v_smfmac_f32_16x16x64_bf16 v[52:55], v[24:27], v[200:207], v8
    s_cbranch_vccnz ploopH_26_rm_3
ploopH_26_rm_3ok:
    v_smfmac_f32_16x16x64_bf16 v[32:35], v[28:31], v[208:215], v8
    ds_write_b32 v63, v59 offset:32
    v_smfmac_f32_16x16x64_bf16 v[36:39], v[28:31], v[216:223], v8
    v_smfmac_f32_16x16x64_bf16 v[40:43], v[28:31], v[224:231], v8
    v_smfmac_f32_16x16x64_bf16 v[44:47], v[28:31], v[232:239], v8
    v_smfmac_f32_16x16x64_bf16 v[48:51], v[28:31], v[240:247], v8
    v_smfmac_f32_16x16x64_bf16 v[52:55], v[28:31], v[248:255], v8
    s_cmp_eq_u32 s3, 3
    s_nop 1
    v_add_f32 v32, v32, v34
    v_add_f32 v33, v33, v35
    ds_write2_b32 v3, v32, v33 offset0:0 offset1:40
    v_add_f32 v36, v36, v38
    v_add_f32 v37, v37, v39
    ds_write2_b32 v3, v36, v37 offset0:16 offset1:56
    v_add_f32 v40, v40, v42
    v_add_f32 v41, v41, v43
    ds_write2_b32 v61, v40, v41 offset0:0 offset1:40
    v_add_f32 v44, v44, v46
    v_add_f32 v45, v45, v47
    ds_write2_b32 v61, v44, v45 offset0:16 offset1:56
    v_add_f32 v48, v48, v50
    v_add_f32 v49, v49, v51
    ds_write2_b32 v62, v48, v49 offset0:0 offset1:40
    v_add_f32 v52, v52, v54
    v_add_f32 v53, v53, v55
    ds_write2_b32 v62, v52, v53 offset0:16 offset1:56
    s_waitcnt lgkmcnt(0)
    s_barrier
    s_cbranch_scc1 ploopH_26_sk1
    ds_read_b128 v[32:35], v4 offset:0
    ds_read_b128 v[36:39], v4 offset:3840
    ds_read_b128 v[40:43], v4 offset:7680
    ds_read_b128 v[44:47], v4 offset:11520
    s_waitcnt lgkmcnt(2)
    v_add_f32 v32, v32, v36
    v_add_f32 v33, v33, v37
    v_add_f32 v34, v34, v38
    v_add_f32 v35, v35, v39
    s_waitcnt lgkmcnt(0)
    v_add_f32 v40, v40, v44
    v_add_f32 v41, v41, v45
    v_add_f32 v42, v42, v46
    v_add_f32 v43, v43, v47
    v_add_f32 v32, v32, v40
    v_add_f32 v33, v33, v41
    v_add_f32 v34, v34, v42
    v_add_f32 v35, v35, v43
    v_cvt_pk_bf16_f32 v56, v32, v33
    v_cvt_pk_bf16_f32 v57, v34, v35
    v_min_u32 v56, -2, v56
    buffer_store_dwordx2 v[56:57], v2, s[4:7], s26 offen sc1
    s_add_u32 s27, s16, 2
    s_and_b32 s27, s27, 3
    s_lshl_b32 s27, s27, 18
    s_add_u32 s27, s27, s38
    buffer_store_dwordx2 v[10:11], v2, s[4:7], s27 offen sc1
ploopH_26_sk1:
    s_setprio 0
    s_add_u32 s25, s16, 3
    s_and_b32 s25, s25, 3
    s_lshl_b32 s25, s25, 16
    s_add_u32 s25, s25, s37
    v_mov_b32 v44, -1
    v_mov_b32 v45, -1
    v_mov_b32 v46, -1
    v_mov_b32 v47, -1
    s_mov_b64 exec, s[56:57]
    buffer_store_dwordx4 v[44:47], v5, s[4:7], s25 offen sc1
    s_mov_b64 exec, -1
    v_mov_b32_dpp v48, v12 row_ror:8 row_mask:0xf bank_mask:0xf
    v_mov_b32_dpp v49, v13 row_ror:8 row_mask:0xf bank_mask:0xf
    v_mov_b32_dpp v50, v14 row_ror:8 row_mask:0xf bank_mask:0xf
    v_mov_b32_dpp v51, v15 row_ror:8 row_mask:0xf bank_mask:0xf
    s_and_b32 s28, s16, 3
    s_lshl_b32 s28, s28, 18
    s_add_u32 s28, s28, s39
    s_add_u32 s24, s16, 1
    s_and_b32 s24, s24, 3
    s_lshl_b32 s24, s24, 16
    s_add_u32 s24, s24, s37
    s_add_u32 s23, s16, 1
    s_and_b32 s23, s23, 3
    s_lshl_b32 s23, s23, 16
    s_add_u32 s23, s23, s36
    s_add_u32 s26, s16, 1
    s_and_b32 s26, s26, 3
    s_lshl_b32 s26, s26, 18
    s_add_u32 s26, s26, s38
    s_cmp_eq_u32 s59, 0
    s_cbranch_scc1 ofl_31
    s_lshl_b32 s17, s3, 10
    v_add_u32 v39, s17, v1
    ds_read_b128 v[40:43], v39 offset:32768
ofl_31:
    s_cmp_eq_u32 s16, 63
    s_cbranch_scc1 ploopH_26_tail
    s_cmp_eq_u32 s30, s54
    s_cbranch_scc1 pnoseg_32
    ds_read_b128 v[16:19], v6 offset:0
    ds_read_b128 v[20:23], v6 offset:256
    ds_read_b128 v[24:27], v6 offset:512
    ds_read_b128 v[28:31], v6 offset:768
    v_xor_b32 v6, 0x4000, v6
    s_waitcnt lgkmcnt(2)
    v_mfma_f32_16x16x32_bf16 v[40:43], v[12:15], v[16:19], 0
    v_mfma_f32_16x16x32_bf16 v[40:43], v[48:51], v[20:23], v[40:43]
    s_waitcnt lgkmcnt(0)
    v_mfma_f32_16x16x32_bf16 v[44:47], v[12:15], v[24:27], 0
    v_mfma_f32_16x16x32_bf16 v[44:47], v[48:51], v[28:31], v[44:47]
    s_nop 7
    v_cvt_pk_bf16_f32 v40, v40, v41
    v_cvt_pk_bf16_f32 v41, v42, v43
    v_cvt_pk_bf16_f32 v42, v44, v45
    v_cvt_pk_bf16_f32 v43, v46, v47
    s_nop 1
    v_permlane16_swap_b32 v40, v42
    v_permlane16_swap_b32 v41, v43
    s_nop 1
    v_min_u32 v40, -2, v40
pnoseg_32:
    s_bitcmp1_b32 s29, 0
    s_cbranch_scc1 gate_33_ok
    s_add_u32 s21, s16, 1
    s_min_u32 s21, s21, 63
    s_cmp_ge_u32 s21, 16
    s_cselect_b32 s19, 12, 8
    s_and_b32 s32, s21, 4
    s_lshr_b32 s21, s21, 3
    s_lshl_b32 s21, s21, 8
    s_add_u32 s32, s32, s21
    s_add_u32 s32, s32, s35
gate_33:
    buffer_load_dword v9, off, s[4:7], s32 sc1
    s_waitcnt vmcnt(0)
    v_readfirstlane_b32 s21, v9
    s_cmp_ge_u32 s21, s19
    s_cbranch_scc1 gate_33_set
    s_sleep 8
    s_sub_u32 s22, s22, 1
    s_cbranch_scc0 gate_33
    s_mov_b32 s22, 0
gate_33_set:
    s_bitset1_b32 s29, 0
gate_33_ok:
    v_readfirstlane_b32 s21, v60
    s_lshr_b32 s29, s29, 1
    s_cmp_ge_u32 s21, s58
    s_cselect_b32 s21, 2, 0
    s_or_b32 s29, s29, s21
    s_cmp_eq_u32 s3, 3
    s_cselect_b32 s20, s21, 0
    s_add_u32 s21, s16, 4
    s_min_u32 s21, s21, 63
    s_cmp_ge_u32 s21, 16
    s_cselect_b32 s58, 12, 8
    s_and_b32 s33, s21, 4
    s_lshr_b32 s21, s21, 3
    s_lshl_b32 s21, s21, 8
    s_add_u32 s33, s33, s21
    s_add_u32 s33, s33, s35
    s_setprio 3
ploopH_26_fs:
    ds_read_b128 v[32:35], v58 offset:0
    s_waitcnt lgkmcnt(0)
    v_min3_i32 v32, v32, v33, v34
    v_min_i32 v32, v32, v35
    s_nop 0
    v_readfirstlane_b32 s18, v32
    s_cmp_ge_i32 s18, s16
    s_cbranch_scc1 ploopH_26_fsok
    s_sleep 1
    s_branch ploopH_26_fs
ploopH_26_fsok:
    s_setprio 1
    s_add_u32 m0, s42, 0
    s_add_u32 s17, s41, 20971520
    buffer_load_dwordx4 v1, s[4:7], s17 offen offset:0 sc1 lds
    buffer_load_dwordx4 v1, s[4:7], s17 offen offset:1024 sc1 lds
    buffer_load_dwordx4 v1, s[4:7], s17 offen offset:2048 sc1 lds
    buffer_load_dwordx4 v1, s[4:7], s17 offen offset:3072 sc1 lds
    s_add_u32 m0, s42, 4096
    s_add_u32 s17, s41, 21102592
    buffer_load_dwordx4 v1, s[4:7], s17 offen offset:0 sc1 lds
    buffer_load_dwordx4 v1, s[4:7], s17 offen offset:1024 sc1 lds
    buffer_load_dwordx4 v1, s[4:7], s17 offen offset:2048 sc1 lds
    buffer_load_dwordx4 v1, s[4:7], s17 offen offset:3072 sc1 lds
    s_cmp_eq_u32 s20, 0
    s_cbranch_scc1 ploopH_26_nt
    s_mov_b32 exec_hi, 0xffff
    buffer_load_dword v60, v0, s[4:7], s31 offen sc1
    s_mov_b32 exec_hi, -1
ploopH_26_nt:
    s_cmp_eq_u32 s59, 0
    s_cbranch_scc1 ofl_34
    s_lshl_b32 s17, s16, 18
    s_add_u32 s17, s17, s60
    buffer_store_dwordx4 v[40:43], v1, s[4:7], s17 offen sc1
    s_mov_b32 s59, 0
ofl_34:
    s_cmp_eq_u32 s30, s54
    s_cbranch_scc1 pnoseg_35
    buffer_store_dwordx4 v[40:43], v7, s[4:7], s30 offen sc1
    s_add_u32 s30, s30, 65536
pnoseg_35:
    s_barrier
    buffer_load_dword v60, off, s[4:7], s33 sc1
    s_sleep 6
    s_add_u32 m0, s42, 8192
    s_add_u32 s17, s41, 37748736
    buffer_load_dwordx4 v1, s[4:7], s17 offen offset:0 sc1 lds
    buffer_load_dwordx4 v1, s[4:7], s17 offen offset:1024 sc1 lds
    buffer_load_dwordx4 v1, s[4:7], s17 offen offset:2048 sc1 lds
    buffer_load_dwordx4 v1, s[4:7], s17 offen offset:3072 sc1 lds
    s_add_u32 m0, s42, 12288
    s_add_u32 s17, s41, 37879808
    buffer_load_dwordx4 v1, s[4:7], s17 offen offset:0 sc1 lds
    buffer_load_dwordx4 v1, s[4:7], s17 offen offset:1024 sc1 lds
    buffer_load_dwordx4 v1, s[4:7], s17 offen offset:2048 sc1 lds
    buffer_load_dwordx4 v1, s[4:7], s17 offen offset:3072 sc1 lds
    s_add_u32 s16, s16, 1
    v_mov_b32 v59, s16
    s_add_u32 s41, s41, 262144
    s_add_u32 s31, s31, 262144
    s_mov_b32 s54, 0
    s_setprio 3
    s_sleep 1
ploopH_26_pagain:
    buffer_load_dwordx4 v[16:19], v1, s[4:7], s28 offen offset:0 sc1
    buffer_load_dwordx4 v[20:23], v1, s[4:7], s28 offen offset:1024 sc1
    s_waitcnt vmcnt(1)
    v_mfma_f32_16x16x32_bf16 v[32:35], v[12:15], v[16:19], 0
    s_waitcnt vmcnt(0)
    v_mfma_f32_16x16x32_bf16 v[32:35], v[48:51], v[20:23], v[32:35]
    v_max_u32 v9, v16, v20
    v_cmp_eq_u32 vcc, -1, v9
    s_cbranch_vccnz ploopH_26_rp
ploopH_26_pgo:
    s_nop 4
    v_add_f32_dpp v36, v32, v32 row_ror:8 row_mask:0xf bank_mask:0xf
    v_add_f32_dpp v37, v33, v33 row_ror:8 row_mask:0xf bank_mask:0xf
    v_add_f32_dpp v38, v34, v34 row_ror:8 row_mask:0xf bank_mask:0xf
    v_add_f32_dpp v39, v35, v35 row_ror:8 row_mask:0xf bank_mask:0xf
    v_cvt_pk_bf16_f32 v52, v36, v37
    v_cvt_pk_bf16_f32 v53, v38, v39
    s_nop 0
    v_permlane16_swap_b32 v52, v54
    v_permlane16_swap_b32 v53, v55
    s_mov_b64 exec, s[56:57]
    v_min_u32 v52, -2, v52
    buffer_store_dwordx4 v[52:55], v5, s[4:7], s24 offen sc1
    s_mov_b64 exec, -1
    ds_write_b32 v63, v59 offset:16
    s_branch ploopH_26
ploopH_26_rm_0:
    s_sub_u32 s22, s22, 1
    s_cbranch_scc1 ploopH_26_rm_0_g
    buffer_load_dwordx4 v[16:19], v1, s[4:7], s23 offen offset:0 sc1
    buffer_load_dwordx4 v[20:23], v1, s[4:7], s23 offen offset:1024 sc1
    buffer_load_dwordx4 v[24:27], v1, s[4:7], s23 offen offset:2048 sc1
    buffer_load_dwordx4 v[28:31], v1, s[4:7], s23 offen offset:3072 sc1
    s_waitcnt vmcnt(3)
    v_cmp_eq_u32 vcc, -1, v16
    s_cbranch_vccnz ploopH_26_rm_0
    s_branch ploopH_26_rm_0ok
ploopH_26_rm_0_g:
    s_mov_b32 s22, 0
    s_waitcnt vmcnt(0)
    s_branch ploopH_26_rm_0ok
ploopH_26_rm_1:
    s_sub_u32 s22, s22, 1
    s_cbranch_scc1 ploopH_26_rm_1_g
    buffer_load_dwordx4 v[20:23], v1, s[4:7], s23 offen offset:1024 sc1
    buffer_load_dwordx4 v[24:27], v1, s[4:7], s23 offen offset:2048 sc1
    buffer_load_dwordx4 v[28:31], v1, s[4:7], s23 offen offset:3072 sc1
    s_waitcnt vmcnt(2)
    v_cmp_eq_u32 vcc, -1, v20
    s_cbranch_vccnz ploopH_26_rm_1
    s_branch ploopH_26_rm_1ok
ploopH_26_rm_1_g:
    s_mov_b32 s22, 0
    s_waitcnt vmcnt(0)
    s_branch ploopH_26_rm_1ok
ploopH_26_rm_2:
    s_sub_u32 s22, s22, 1
    s_cbranch_scc1 ploopH_26_rm_2_g
    buffer_load_dwordx4 v[24:27], v1, s[4:7], s23 offen offset:2048 sc1
    buffer_load_dwordx4 v[28:31], v1, s[4:7], s23 offen offset:3072 sc1
    s_waitcnt vmcnt(1)
    v_cmp_eq_u32 vcc, -1, v24
    s_cbranch_vccnz ploopH_26_rm_2
    s_branch ploopH_26_rm_2ok
ploopH_26_rm_2_g:
    s_mov_b32 s22, 0
    s_waitcnt vmcnt(0)
    s_branch ploopH_26_rm_2ok
ploopH_26_rm_3:
    s_sub_u32 s22, s22, 1
    s_cbranch_scc1 ploopH_26_rm_3_g
    buffer_load_dwordx4 v[28:31], v1, s[4:7], s23 offen offset:3072 sc1
    s_waitcnt vmcnt(0)
    v_cmp_eq_u32 vcc, -1, v28
    s_cbranch_vccnz ploopH_26_rm_3
    s_branch ploopH_26_rm_3ok
ploopH_26_rm_3_g:
    s_mov_b32 s22, 0
    s_waitcnt vmcnt(0)
    s_branch ploopH_26_rm_3ok
ploopH_26_rp:
    s_sub_u32 s22, s22, 1
    s_cbranch_scc0 ploopH_26_pagain
    s_mov_b32 s22, 0
    s_branch ploopH_26_pgo
ploopH_26_tail:
    ds_read_b128 v[16:19], v6 offset:0
    ds_read_b128 v[20:23], v6 offset:256
    ds_read_b128 v[24:27], v6 offset:512
    ds_read_b128 v[28:31], v6 offset:768
    v_xor_b32 v6, 0x4000, v6
    s_waitcnt lgkmcnt(2)
    v_mfma_f32_16x16x32_bf16 v[40:43], v[12:15], v[16:19], 0
    v_mfma_f32_16x16x32_bf16 v[40:43], v[48:51], v[20:23], v[40:43]
    s_waitcnt lgkmcnt(0)
    v_mfma_f32_16x16x32_bf16 v[44:47], v[12:15], v[24:27], 0
    v_mfma_f32_16x16x32_bf16 v[44:47], v[48:51], v[28:31], v[44:47]
    s_nop 7
    v_cvt_pk_bf16_f32 v40, v40, v41
    v_cvt_pk_bf16_f32 v41, v42, v43
    v_cvt_pk_bf16_f32 v42, v44, v45
    v_cvt_pk_bf16_f32 v43, v46, v47
    s_nop 1
    v_permlane16_swap_b32 v40, v42
    v_permlane16_swap_b32 v41, v43
    s_nop 1
    v_min_u32 v40, -2, v40
    buffer_store_dwordx4 v[40:43], v7, s[4:7], s30 offen sc1
    s_add_u32 s30, s30, 65536
    s_barrier
    ds_read_b128 v[16:19], v6 offset:0
    ds_read_b128 v[20:23], v6 offset:256
    ds_read_b128 v[24:27], v6 offset:512
    ds_read_b128 v[28:31], v6 offset:768
    v_xor_b32 v6, 0x4000, v6
    s_waitcnt lgkmcnt(2)
    v_mfma_f32_16x16x32_bf16 v[40:43], v[12:15], v[16:19], 0
    v_mfma_f32_16x16x32_bf16 v[40:43], v[48:51], v[20:23], v[40:43]
    s_waitcnt lgkmcnt(0)
    v_mfma_f32_16x16x32_bf16 v[44:47], v[12:15], v[24:27], 0
    v_mfma_f32_16x16x32_bf16 v[44:47], v[48:51], v[28:31], v[44:47]
    s_nop 7
    v_cvt_pk_bf16_f32 v40, v40, v41
    v_cvt_pk_bf16_f32 v41, v42, v43
    v_cvt_pk_bf16_f32 v42, v44, v45
    v_cvt_pk_bf16_f32 v43, v46, v47
    s_nop 1
    v_permlane16_swap_b32 v40, v42
    v_permlane16_swap_b32 v41, v43
    s_nop 1
    v_min_u32 v40, -2, v40
    buffer_store_dwordx4 v[40:43], v7, s[4:7], s30 offen sc1
    s_add_u32 s30, s30, 65536
    s_branch k_end
ch_a_pro:
    s_sub_u32 s21, s3, 4
    s_lshl_b32 s15, s14, 2
    s_add_u32 s15, s15, s21
    s_lshl_b32 s38, s15, 13
    s_add_u32 s38, s38, 214958080
    s_min_u32 s20, s21, 2
    s_lshl_b32 s18, s20, 3
    s_add_u32 s18, s18, 16
    s_load_dwordx2 s[8:9], s[0:1], s18
    s_mov_b32 s10, 8388608
    s_mov_b32 s11, 131072
    v_and_b32 v20, 63, v0
    v_lshlrev_b32 v21, 13, v20
    s_lshl_b32 s17, s34, 19
    s_lshl_b32 s18, s14, 10
    s_add_u32 s17, s17, s18
    s_waitcnt lgkmcnt(0)
    buffer_load_dword v26, v21, s[8:11], s17 offen offset:384
    v_and_b32 v20, 63, v0
    v_lshrrev_b32 v21, 4, v20
    v_bfe_u32 v22, v20, 1, 1
    v_xor_b32 v22, 1, v22
    v_lshl_add_u32 v23, v22, 2, v21
    v_bfe_u32 v22, v20, 2, 2
    v_and_b32 v24, 1, v20
    v_lshl_add_u32 v22, v22, 1, v24
    v_lshl_add_u32 v23, v23, 3, v22
    v_and_b32 v22, 7, v20
    v_lshlrev_b32 v23, 4, v23
    s_lshl_b32 s17, s21, 10
    s_add_u32 s17, s17, 16384
    v_add_u32 v160, s17, v23
    v_and_b32 v24, 15, v20
    v_lshlrev_b32 v24, 4, v24
    v_lshl_add_u32 v23, v21, 10, v24
    s_lshl_b32 s17, s21, 8
    s_add_u32 s17, s17, 16384
    v_add_u32 v161, s17, v23
    v_lshl_add_u32 v23, v21, 9, v24
    s_lshl_b32 s17, s21, 12
    s_add_u32 s17, s17, 32768
    v_add_u32 v162, s17, v23
    v_bfe_u32 v23, v20, 3, 1
    v_lshlrev_b32 v23, 10, v23
    v_lshl_add_u32 v23, v22, 4, v23
    v_mov_b32 v1, v23
    s_lshl_b32 s39, s34, 14
    s_lshl_b32 s17, s21, 11
    s_add_u32 s39, s39, s17
    s_lshl_b32 s17, s14, 7
    s_add_u32 s39, s39, s17
    s_add_u32 s39, s39, 209715200
    v_mov_b32 v176, -1
    v_mov_b32 v177, -1
    v_mov_b32 v178, -1
    v_mov_b32 v179, -1
    v_lshlrev_b32 v24, 4, v0
    s_lshl_b32 s17, s52, 13
    s_add_u32 s19, s17, 209711104
    s_add_u32 s17, s17, 214953984
    s_lshl_b32 s18, s52, 12
    s_add_u32 s18, s18, 213905408
    buffer_store_dwordx4 v[176:179], v24, s[4:7], s19 offen sc1
    s_add_u32 s19, s19, 4096
    buffer_store_dwordx4 v[176:179], v24, s[4:7], s19 offen sc1
    buffer_store_dwordx4 v[176:179], v24, s[4:7], s17 offen sc1
    s_add_u32 s17, s17, 4096
    buffer_store_dwordx4 v[176:179], v24, s[4:7], s17 offen sc1
    buffer_store_dwordx4 v[176:179], v24, s[4:7], s18 offen sc1
    s_and_b32 s17, s13, 7
    s_sub_u32 s18, s21, 1
    s_cmp_lt_u32 s18, 2
    s_cselect_b32 s54, s17, 1
    s_lshr_b32 s19, s52, 3
    s_lshl_b32 s19, s19, 8
    s_lshl_b32 s18, s18, 7
    s_add_u32 s19, s19, s18
    s_add_u32 s55, s19, 210763776
    s_cmp_lg_u32 s54, 0
    s_cbranch_scc1 ch_nv0
    v_lshlrev_b32 v24, 13, v20
    s_mov_b64 exec, 0xffff
    buffer_store_dword v176, v24, s[4:7], s55 offen sc1
    s_mov_b64 exec, -1
ch_nv0:
    v_mov_b32 v2, s40
    s_lshl_b32 s17, s12, 2
    s_add_u32 s17, s17, 128
    s_waitcnt vmcnt(0)
    s_barrier
    s_cmp_lg_u32 s3, 4
    s_cbranch_scc1 ch_nox
    s_mov_b64 exec, 1
    buffer_atomic_add v2, off, s[64:67], s17 sc1
    s_mov_b64 exec, -1
ch_nox:
    v_and_b32 v20, 63, v0
    v_lshlrev_b32 v0, 4, v20
    s_lshl_b32 s17, s15, 18
    s_lshl_b32 s18, s34, 7
    s_add_u32 s17, s17, s18
    s_lshl_b32 s19, s21, 13
    s_add_u32 s19, s19, 131072
    s_load_dwordx2 s[8:9], s[0:1], 40
    s_mov_b32 s10, 8388608
    s_mov_b32 s11, 131072
    v_lshrrev_b32 v21, 3, v20
    v_and_b32 v22, 7, v20
    v_lshlrev_b32 v21, 11, v21
    v_lshl_add_u32 v21, v22, 4, v21
    v_lshrrev_b32 v28, 4, v20
    v_and_b32 v29, 1, v28
    v_xor_b32 v29, 0, v29
    v_lshlrev_b32 v29, 2, v29
    v_lshl_add_u32 v29, v28, 3, v29
    v_bfe_u32 v28, v20, 2, 2
    v_add_u32 v29, v29, v28
    v_lshlrev_b32 v29, 7, v29
    v_and_b32 v28, 3, v20
    v_lshl_add_u32 v29, v28, 4, v29
    v_and_b32 v28, 1, v28
    v_xor_b32 v28, 0, v28
    v_lshl_add_u32 v24, v28, 3, v29
    v_add_u32 v24, s19, v24
    v_lshrrev_b32 v28, 4, v20
    v_and_b32 v29, 1, v28
    v_xor_b32 v29, 1, v29
    v_lshlrev_b32 v29, 2, v29
    v_lshl_add_u32 v29, v28, 3, v29
    v_bfe_u32 v28, v20, 2, 2
    v_add_u32 v29, v29, v28
    v_lshlrev_b32 v29, 7, v29
    v_and_b32 v28, 3, v20
    v_lshl_add_u32 v29, v28, 4, v29
    v_and_b32 v28, 1, v28
    v_xor_b32 v28, 0, v28
    v_lshl_add_u32 v25, v28, 3, v29
    v_add_u32 v25, s19, v25
    v_lshrrev_b32 v28, 4, v20
    v_and_b32 v29, 1, v28
    v_xor_b32 v29, 0, v29
    v_lshlrev_b32 v29, 2, v29
    v_lshl_add_u32 v29, v28, 3, v29
    v_bfe_u32 v28, v20, 2, 2
    v_add_u32 v29, v29, v28
    v_lshlrev_b32 v29, 7, v29
    v_and_b32 v28, 3, v20
    v_lshl_add_u32 v29, v28, 4, v29
    v_and_b32 v28, 1, v28
    v_xor_b32 v28, 1, v28
    v_lshl_add_u32 v26, v28, 3, v29
    v_add_u32 v26, s19, v26
    v_lshrrev_b32 v28, 4, v20
    v_and_b32 v29, 1, v28
    v_xor_b32 v29, 1, v29
    v_lshlrev_b32 v29, 2, v29
    v_lshl_add_u32 v29, v28, 3, v29
    v_bfe_u32 v28, v20, 2, 2
    v_add_u32 v29, v29, v28
    v_lshlrev_b32 v29, 7, v29
    v_and_b32 v28, 3, v20
    v_lshl_add_u32 v29, v28, 4, v29
    v_and_b32 v28, 1, v28
    v_xor_b32 v28, 1, v28
    v_lshl_add_u32 v27, v28, 3, v29
    v_add_u32 v27, s19, v27
    s_waitcnt lgkmcnt(0)
    s_add_u32 m0, s19, 0
    s_nop 0
    buffer_load_dwordx4 v21, s[8:11], s17 offen lds
    s_add_u32 s17, s17, 16384
    s_add_u32 m0, s19, 1024
    s_nop 0
    buffer_load_dwordx4 v21, s[8:11], s17 offen lds
    s_add_u32 s17, s17, 16384
    s_add_u32 m0, s19, 2048
    s_nop 0
    buffer_load_dwordx4 v21, s[8:11], s17 offen lds
    s_add_u32 s17, s17, 16384
    s_add_u32 m0, s19, 3072
    s_nop 0
    buffer_load_dwordx4 v21, s[8:11], s17 offen lds
    s_add_u32 s17, s17, 16384
    s_add_u32 m0, s19, 4096
    s_nop 0
    buffer_load_dwordx4 v21, s[8:11], s17 offen lds
    s_add_u32 s17, s17, 16384
    s_add_u32 m0, s19, 5120
    s_nop 0
    buffer_load_dwordx4 v21, s[8:11], s17 offen lds
    s_add_u32 s17, s17, 16384
    s_add_u32 m0, s19, 6144
    s_nop 0
    buffer_load_dwordx4 v21, s[8:11], s17 offen lds
    s_add_u32 s17, s17, 16384
    s_add_u32 m0, s19, 7168
    s_nop 0
    buffer_load_dwordx4 v21, s[8:11], s17 offen lds
    s_add_u32 s17, s17, 16384
    buffer_load_dwordx4 v[96:99], v21, s[8:11], s17 offen
    s_add_u32 s17, s17, 16384
    buffer_load_dwordx4 v[100:103], v21, s[8:11], s17 offen
    s_add_u32 s17, s17, 16384
    buffer_load_dwordx4 v[104:107], v21, s[8:11], s17 offen
    s_add_u32 s17, s17, 16384
    buffer_load_dwordx4 v[108:111], v21, s[8:11], s17 offen
    s_add_u32 s17, s17, 16384
    buffer_load_dwordx4 v[112:115], v21, s[8:11], s17 offen
    s_add_u32 s17, s17, 16384
    buffer_load_dwordx4 v[116:119], v21, s[8:11], s17 offen
    s_add_u32 s17, s17, 16384
    buffer_load_dwordx4 v[120:123], v21, s[8:11], s17 offen
    s_add_u32 s17, s17, 16384
    buffer_load_dwordx4 v[124:127], v21, s[8:11], s17 offen
    s_add_u32 s17, s17, 16384
    s_cmp_lg_u32 s54, 0
    s_cbranch_scc1 ch_nv1
    s_mov_b32 s58, -1
    s_mov_b32 s59, -1
    s_memtime s[60:61]
    s_add_u32 s56, s55, 0
    s_waitcnt lgkmcnt(0)
    s_load_dword s57, s[4:5], s56 glc
    s_waitcnt lgkmcnt(0)
    s_memtime s[62:63]
    s_waitcnt lgkmcnt(0)
    s_sub_u32 s57, s62, s60
    s_min_u32 s58, s58, s57
    s_memtime s[60:61]
    s_add_u32 s56, s55, 8192
    s_waitcnt lgkmcnt(0)
    s_load_dword s57, s[4:5], s56 glc
    s_waitcnt lgkmcnt(0)
    s_memtime s[62:63]
    s_waitcnt lgkmcnt(0)
    s_sub_u32 s57, s62, s60
    s_min_u32 s59, s59, s57
    s_memtime s[60:61]
    s_add_u32 s56, s55, 16384
    s_waitcnt lgkmcnt(0)
    s_load_dword s57, s[4:5], s56 glc
    s_waitcnt lgkmcnt(0)
    s_memtime s[62:63]
    s_waitcnt lgkmcnt(0)
    s_sub_u32 s57, s62, s60
    s_min_u32 s58, s58, s57
    s_memtime s[60:61]
    s_add_u32 s56, s55, 24576
    s_waitcnt lgkmcnt(0)
    s_load_dword s57, s[4:5], s56 glc
    s_waitcnt lgkmcnt(0)
    s_memtime s[62:63]
    s_waitcnt lgkmcnt(0)
    s_sub_u32 s57, s62, s60
    s_min_u32 s59, s59, s57
    s_memtime s[60:61]
    s_add_u32 s56, s55, 32768
    s_waitcnt lgkmcnt(0)
    s_load_dword s57, s[4:5], s56 glc
    s_waitcnt lgkmcnt(0)
    s_memtime s[62:63]
    s_waitcnt lgkmcnt(0)
    s_sub_u32 s57, s62, s60
    s_min_u32 s58, s58, s57
    s_memtime s[60:61]
    s_add_u32 s56, s55, 40960
    s_waitcnt lgkmcnt(0)
    s_load_dword s57, s[4:5], s56 glc
    s_waitcnt lgkmcnt(0)
    s_memtime s[62:63]
    s_waitcnt lgkmcnt(0)
    s_sub_u32 s57, s62, s60
    s_min_u32 s59, s59, s57
    s_memtime s[60:61]
    s_add_u32 s56, s55, 49152
    s_waitcnt lgkmcnt(0)
    s_load_dword s57, s[4:5], s56 glc
    s_waitcnt lgkmcnt(0)
    s_memtime s[62:63]
    s_waitcnt lgkmcnt(0)
    s_sub_u32 s57, s62, s60
    s_min_u32 s58, s58, s57
    s_memtime s[60:61]
    s_add_u32 s56, s55, 57344
    s_waitcnt lgkmcnt(0)
    s_load_dword s57, s[4:5], s56 glc
    s_waitcnt lgkmcnt(0)
    s_memtime s[62:63]
    s_waitcnt lgkmcnt(0)
    s_sub_u32 s57, s62, s60
    s_min_u32 s59, s59, s57
    s_memtime s[60:61]
    s_add_u32 s56, s55, 65536
    s_waitcnt lgkmcnt(0)
    s_load_dword s57, s[4:5], s56 glc
    s_waitcnt lgkmcnt(0)
    s_memtime s[62:63]
    s_waitcnt lgkmcnt(0)
    s_sub_u32 s57, s62, s60
    s_min_u32 s58, s58, s57
    s_memtime s[60:61]
    s_add_u32 s56, s55, 73728
    s_waitcnt lgkmcnt(0)
    s_load_dword s57, s[4:5], s56 glc
    s_waitcnt lgkmcnt(0)
    s_memtime s[62:63]
    s_waitcnt lgkmcnt(0)
    s_sub_u32 s57, s62, s60
    s_min_u32 s59, s59, s57
    s_memtime s[60:61]
    s_add_u32 s56, s55, 81920
    s_waitcnt lgkmcnt(0)
    s_load_dword s57, s[4:5], s56 glc
    s_waitcnt lgkmcnt(0)
    s_memtime s[62:63]
    s_waitcnt lgkmcnt(0)
    s_sub_u32 s57, s62, s60
    s_min_u32 s58, s58, s57
    s_memtime s[60:61]
    s_add_u32 s56, s55, 90112
    s_waitcnt lgkmcnt(0)
    s_load_dword s57, s[4:5], s56 glc
    s_waitcnt lgkmcnt(0)
    s_memtime s[62:63]
    s_waitcnt lgkmcnt(0)
    s_sub_u32 s57, s62, s60
    s_min_u32 s59, s59, s57
    s_memtime s[60:61]
    s_add_u32 s56, s55, 98304
    s_waitcnt lgkmcnt(0)
    s_load_dword s57, s[4:5], s56 glc
    s_waitcnt lgkmcnt(0)
    s_memtime s[62:63]
    s_waitcnt lgkmcnt(0)
    s_sub_u32 s57, s62, s60
    s_min_u32 s58, s58, s57
    s_memtime s[60:61]
    s_add_u32 s56, s55, 106496
    s_waitcnt lgkmcnt(0)
    s_load_dword s57, s[4:5], s56 glc
    s_waitcnt lgkmcnt(0)
    s_memtime s[62:63]
    s_waitcnt lgkmcnt(0)
    s_sub_u32 s57, s62, s60
    s_min_u32 s59, s59, s57
    s_memtime s[60:61]
    s_add_u32 s56, s55, 114688
    s_waitcnt lgkmcnt(0)
    s_load_dword s57, s[4:5], s56 glc
    s_waitcnt lgkmcnt(0)
    s_memtime s[62:63]
    s_waitcnt lgkmcnt(0)
    s_sub_u32 s57, s62, s60
    s_min_u32 s58, s58, s57
    s_memtime s[60:61]
    s_add_u32 s56, s55, 122880
    s_waitcnt lgkmcnt(0)
    s_load_dword s57, s[4:5], s56 glc
    s_waitcnt lgkmcnt(0)
    s_memtime s[62:63]
    s_waitcnt lgkmcnt(0)
    s_sub_u32 s57, s62, s60
    s_min_u32 s59, s59, s57
    s_sub_i32 s57, s58, s59
    s_min_i32 s57, s57, 400
    s_max_i32 s57, s57, -400
    s_add_u32 s57, s57, 16777616
    s_getreg_b32 s56, hwreg(HW_REG_XCC_ID)
    s_and_b32 s56, s56, 0
    v_mov_b32 v2, s57
    s_mov_b64 exec, 1
    buffer_atomic_add v2, off, s[64:67], s56 offset:160 sc1
    s_mov_b64 exec, -1
    s_waitcnt vmcnt(0)
ch_nv1:
    s_lshl_b32 s19, s21, 13
    s_add_u32 s19, s19, 131072
    v_add_u32 v30, s19, v0
    s_waitcnt vmcnt(8)
    ds_read_b64_tr_b16 v[192:193], v24 offset:0
    ds_read_b64_tr_b16 v[194:195], v25 offset:0
    ds_read_b64_tr_b16 v[208:209], v26 offset:0
    ds_read_b64_tr_b16 v[210:211], v27 offset:0
    ds_read_b64_tr_b16 v[224:225], v24 offset:64
    ds_read_b64_tr_b16 v[226:227], v25 offset:64
    ds_read_b64_tr_b16 v[240:241], v26 offset:64
    ds_read_b64_tr_b16 v[242:243], v27 offset:64
    s_waitcnt lgkmcnt(0)
    ds_read_b64_tr_b16 v[196:197], v24 offset:4096
    ds_read_b64_tr_b16 v[198:199], v25 offset:4096
    ds_read_b64_tr_b16 v[212:213], v26 offset:4096
    ds_read_b64_tr_b16 v[214:215], v27 offset:4096
    ds_read_b64_tr_b16 v[228:229], v24 offset:4160
    ds_read_b64_tr_b16 v[230:231], v25 offset:4160
    ds_read_b64_tr_b16 v[244:245], v26 offset:4160
    ds_read_b64_tr_b16 v[246:247], v27 offset:4160
    s_waitcnt lgkmcnt(0)
    s_waitcnt vmcnt(0)
    ds_write_b128 v30, v[96:99] offset:0
    ds_write_b128 v30, v[100:103] offset:1024
    ds_write_b128 v30, v[104:107] offset:2048
    ds_write_b128 v30, v[108:111] offset:3072
    ds_write_b128 v30, v[112:115] offset:4096
    ds_write_b128 v30, v[116:119] offset:5120
    ds_write_b128 v30, v[120:123] offset:6144
    ds_write_b128 v30, v[124:127] offset:7168
    s_waitcnt lgkmcnt(0)
    ds_read_b64_tr_b16 v[200:201], v24 offset:0
    ds_read_b64_tr_b16 v[202:203], v25 offset:0
    ds_read_b64_tr_b16 v[216:217], v26 offset:0
    ds_read_b64_tr_b16 v[218:219], v27 offset:0
    ds_read_b64_tr_b16 v[232:233], v24 offset:64
    ds_read_b64_tr_b16 v[234:235], v25 offset:64
    ds_read_b64_tr_b16 v[248:249], v26 offset:64
    ds_read_b64_tr_b16 v[250:251], v27 offset:64
    s_waitcnt lgkmcnt(0)
    ds_read_b64_tr_b16 v[204:205], v24 offset:4096
    ds_read_b64_tr_b16 v[206:207], v25 offset:4096
    ds_read_b64_tr_b16 v[220:221], v26 offset:4096
    ds_read_b64_tr_b16 v[222:223], v27 offset:4096
    ds_read_b64_tr_b16 v[236:237], v24 offset:4160
    ds_read_b64_tr_b16 v[238:239], v25 offset:4160
    ds_read_b64_tr_b16 v[252:253], v26 offset:4160
    ds_read_b64_tr_b16 v[254:255], v27 offset:4160
    s_waitcnt lgkmcnt(0)
    v_lshrrev_b32 v21, 4, v20
    v_and_b32 v22, 2, v20
    v_cmp_eq_u32 s[56:57], 2, v22
    v_and_b32 v23, 15, v20
    v_lshlrev_b32 v21, 2, v21
    v_mov_b32 v8, 0x44444444
    v_mov_b32 v9, 0xeeeeeeee
    v_cndmask_b32 v166, v8, v9, s[56:57]
    v_mov_b32 v8, 0x3f803f80
    v_mov_b32 v9, 0
    v_mov_b32 v10, 0
    v_mov_b32 v11, 0
    v_mov_b32 v4, 0x3f803f80
    v_mov_b32 v5, 0x3f803f80
    v_mov_b32 v6, 0x3f803f80
    v_mov_b32 v7, 0x3f803f80
    s_mov_b32 s29, 0x3e0293ee
    s_lshl_b32 s27, s13, 2
    s_add_u32 s27, s27, s21
    s_lshl_b32 s28, s12, 7
    s_add_u32 s28, s28, 218112000
    v_add_u32 v163, s42, v0
    s_lshl_b32 s17, s21, 2
    s_add_u32 s17, s17, 15872
    v_mov_b32 v164, s17
    v_mov_b32 v167, 15872
    v_and_b32 v24, 15, v20
    v_and_b32 v25, 1, v24
    v_lshlrev_b32 v25, 4, v25
    v_mov_b32 v184, 0x3f80
    v_lshlrev_b32 v25, v25, v184
    v_lshrrev_b32 v24, 1, v24
    v_cmp_eq_u32 vcc, 0, v24
    s_nop 1
    v_cndmask_b32 v184, 0, v25, vcc
    v_cmp_eq_u32 vcc, 1, v24
    s_nop 1
    v_cndmask_b32 v185, 0, v25, vcc
    v_cmp_eq_u32 vcc, 2, v24
    s_nop 1
    v_cndmask_b32 v186, 0, v25, vcc
    v_cmp_eq_u32 vcc, 3, v24
    s_nop 1
    v_cndmask_b32 v187, 0, v25, vcc
    v_lshrrev_b32 v24, 4, v20
    v_bfe_u32 v25, v20, 2, 2
    v_and_b32 v26, 1, v20
    v_lshl_add_u32 v26, v25, 1, v26
    v_lshlrev_b32 v26, 4, v26
    v_lshl_add_u32 v26, v24, 8, v26
    v_bfe_u32 v27, v20, 1, 1
    v_lshl_add_u32 v26, v27, 2, v26
    s_add_u32 s17, s42, 20480
    v_add_u32 v180, s17, v26
    v_and_b32 v26, 3, v20
    v_lshl_add_u32 v27, v24, 2, v25
    v_lshl_add_u32 v27, v26, 4, v27
    v_lshlrev_b32 v27, 4, v27
    v_add_u32 v181, s42, v27
    v_and_b32 v25, 1, v25
    v_lshl_add_u32 v25, v24, 1, v25
    v_lshl_add_u32 v25, v26, 3, v25
    v_lshlrev_b32 v25, 4, v25
    v_add_u32 v182, s17, v25
    s_bfe_u32 s17, s34, 0x20001
    s_lshr_b32 s30, s34, 3
    s_cmp_eq_u32 s17, s21
    s_cselect_b32 s30, s30, 2
    s_and_b32 s33, s34, 1
    s_lshl_b32 s33, s33, 17
    s_mov_b32 s32, 0
    v_add_u32 v24, 0, v21
    v_cmp_gt_u32 s[44:45], v24, v23
    v_add_u32 v24, 1, v21
    v_cmp_gt_u32 s[46:47], v24, v23
    v_add_u32 v24, 2, v21
    v_cmp_gt_u32 s[48:49], v24, v23
    v_add_u32 v24, 3, v21
    v_cmp_gt_u32 s[50:51], v24, v23
    s_cmp_lg_u32 s3, 4
    s_cbranch_scc1 ch_xcc_skip
    v_lshrrev_b32 v56, 2, v0
    v_add_u32 v56, 128, v56
    v_writelane_b32 v56, 0, 10
    v_mov_b32 v59, 63
    v_mov_b32 v60, 32
    v_writelane_b32 v59, 0, 8
    v_writelane_b32 v60, 0, 8
    v_writelane_b32 v59, 0, 9
    v_writelane_b32 v60, 0, 9
    v_writelane_b32 v59, -1, 10
    s_movk_i32 s17, 128
    v_writelane_b32 v60, s17, 10
    s_mov_b64 exec, 0x70f
ch_xcc:
    buffer_load_dword v57, v56, s[64:67], 0 offen sc1
    s_waitcnt vmcnt(0)
    v_and_b32 v62, v59, v57
    v_cmp_ne_u32 vcc, v62, v60
    v_readlane_b32 s18, v57, 8
    v_readlane_b32 s19, v57, 9
    s_add_u32 s17, s18, s19
    s_lshr_b32 s17, s17, 24
    s_cmp_lg_u32 s17, 32
    s_cbranch_scc1 ch_xcc_w
    s_cbranch_vccz ch_xcc_ok
ch_xcc_w:
    s_sleep 16
    s_sub_u32 s22, s22, 1
    s_cbranch_scc0 ch_xcc
    s_mov_b32 s22, 0
ch_xcc_ok:
    s_getreg_b32 s17, hwreg(HW_REG_XCC_ID)
    s_bitcmp1_b32 s17, 2
    s_cselect_b32 s18, s18, s18
    v_readlane_b32 s17, v57, s12
    s_mov_b64 exec, -1
    s_lshr_b32 s19, s18, 24
    s_mul_i32 s19, s19, 400
    s_and_b32 s18, s18, 0xffffff
    s_cmp_gt_u32 s18, s19
    s_cselect_b32 s18, 8192, 0
    v_mov_b32 v58, 15968
    v_mov_b32 v60, s17
    v_mov_b32 v61, s18
    s_barrier
    ds_write_b64 v58, v[60:61]
    s_waitcnt lgkmcnt(0)
    s_branch ch_xcc_b3
ch_xcc_skip:
    s_barrier
ch_xcc_b3:
    s_barrier
    v_mov_b32 v58, 15968
    ds_read_b64 v[60:61], v58
    v_and_b32 v23, 7, v20
    v_lshlrev_b32 v23, 7, v23
    v_bfe_u32 v24, v20, 3, 1
    v_lshl_add_u32 v23, v24, 17, v23
    v_lshrrev_b32 v24, 4, v20
    v_lshl_add_u32 v23, v24, 24, v23
    s_lshl_b32 s19, s14, 14
    s_lshl_b32 s18, s34, 10
    s_add_u32 s19, s19, s18
    s_and_b32 s18, s21, 1
    s_lshl_b32 s18, s18, 18
    s_add_u32 s19, s19, s18
    s_add_u32 s19, s19, 4456448
    s_waitcnt lgkmcnt(0)
    v_readfirstlane_b32 s17, v61
    s_add_u32 s39, s39, s17
ch_g0:
    buffer_load_dword v57, off, s[4:7], s35 sc1
    s_waitcnt vmcnt(0)
    v_readfirstlane_b32 s17, v57
    s_cmp_ge_u32 s17, 8
    s_cbranch_scc1 ch_g0b
    s_sleep 12
    s_sub_u32 s22, s22, 1
    s_cbranch_scc0 ch_g0
    s_mov_b32 s22, 0
ch_g0b:
    s_add_u32 s23, s41, 37748736
    buffer_load_dwordx4 v[128:131], v0, s[4:7], s23 offen offset:0 sc1
    buffer_load_dwordx4 v[132:135], v0, s[4:7], s23 offen offset:1024 sc1
    buffer_load_dwordx4 v[136:139], v0, s[4:7], s23 offen offset:2048 sc1
    buffer_load_dwordx4 v[140:143], v0, s[4:7], s23 offen offset:3072 sc1
    s_add_u32 s24, s41, 37879808
    buffer_load_dwordx4 v[144:147], v0, s[4:7], s24 offen offset:0 sc1
    buffer_load_dwordx4 v[148:151], v0, s[4:7], s24 offen offset:1024 sc1
    buffer_load_dwordx4 v[152:155], v0, s[4:7], s24 offen offset:2048 sc1
    buffer_load_dwordx4 v[156:159], v0, s[4:7], s24 offen offset:3072 sc1
    s_add_u32 s23, s41, 20971520
    buffer_load_dwordx4 v[96:99], v0, s[4:7], s23 offen offset:0 sc1
    buffer_load_dwordx4 v[100:103], v0, s[4:7], s23 offen offset:1024 sc1
    buffer_load_dwordx4 v[104:107], v0, s[4:7], s23 offen offset:2048 sc1
    buffer_load_dwordx4 v[108:111], v0, s[4:7], s23 offen offset:3072 sc1
    s_add_u32 s24, s41, 21102592
    buffer_load_dwordx4 v[112:115], v0, s[4:7], s24 offen offset:0 sc1
    buffer_load_dwordx4 v[116:119], v0, s[4:7], s24 offen offset:1024 sc1
    buffer_load_dwordx4 v[120:123], v0, s[4:7], s24 offen offset:2048 sc1
    buffer_load_dwordx4 v[124:127], v0, s[4:7], s24 offen offset:3072 sc1
    s_mov_b32 exec_hi, 0xffff
    buffer_load_dword v175, v23, s[4:7], s19 offen sc1
    s_mov_b32 exec_hi, -1
    v_mov_b32 v165, 0
    s_waitcnt vmcnt(1)
    ds_write_b32 v164, v165 offset:16
.p2align 6
aloopL_37:
    s_and_b32 s23, s16, 3
    s_lshl_b32 s23, s23, 18
    s_add_u32 s23, s23, s38
    s_add_u32 s24, s23, 4096
    s_and_b32 s25, s16, 3
    s_lshl_b32 s25, s25, 18
    s_add_u32 s25, s25, s39
    s_add_u32 s26, s16, 2
    s_and_b32 s26, s26, 3
    s_lshl_b32 s26, s26, 18
    s_add_u32 s26, s26, s39
    v_mov_b32 v165, s16
    s_waitcnt vmcnt(8)
    s_and_b32 s31, s16, 1
    s_cmp_lt_u32 s16, 16
    s_cselect_b32 s31, 3, s31
    s_cmp_lg_u32 s31, s30
    s_cbranch_scc1 aloopL_37_nd0
    ds_write_b128 v163, v[128:131] offset:0
    ds_write_b128 v163, v[132:135] offset:1024
    ds_write_b128 v163, v[136:139] offset:2048
    ds_write_b128 v163, v[140:143] offset:3072
    ds_write_b128 v163, v[144:147] offset:4096
    ds_write_b128 v163, v[148:151] offset:5120
    ds_write_b128 v163, v[152:155] offset:6144
    ds_write_b128 v163, v[156:159] offset:7168
aloopL_37_nd0:
    v_mfma_f32_16x16x32_bf16 v[48:51], v[128:131], v[192:195], 0
    v_mfma_f32_16x16x32_bf16 v[52:55], v[128:131], v[208:211], 0
    v_mfma_f32_16x16x32_bf16 v[56:59], v[128:131], v[224:227], 0
    v_mfma_f32_16x16x32_bf16 v[60:63], v[128:131], v[240:243], 0
    v_mfma_f32_16x16x32_bf16 v[64:67], v[144:147], v[192:195], 0
    v_mfma_f32_16x16x32_bf16 v[68:71], v[144:147], v[208:211], 0
    v_mfma_f32_16x16x32_bf16 v[72:75], v[144:147], v[224:227], 0
    v_mfma_f32_16x16x32_bf16 v[76:79], v[144:147], v[240:243], 0
    v_mfma_f32_16x16x32_bf16 v[48:51], v[132:135], v[196:199], v[48:51]
    v_mfma_f32_16x16x32_bf16 v[52:55], v[132:135], v[212:215], v[52:55]
    v_mfma_f32_16x16x32_bf16 v[56:59], v[132:135], v[228:231], v[56:59]
    v_mfma_f32_16x16x32_bf16 v[60:63], v[132:135], v[244:247], v[60:63]
    v_mfma_f32_16x16x32_bf16 v[64:67], v[148:151], v[196:199], v[64:67]
    v_mfma_f32_16x16x32_bf16 v[68:71], v[148:151], v[212:215], v[68:71]
    v_mfma_f32_16x16x32_bf16 v[72:75], v[148:151], v[228:231], v[72:75]
    v_mfma_f32_16x16x32_bf16 v[76:79], v[148:151], v[244:247], v[76:79]
    v_mfma_f32_16x16x32_bf16 v[48:51], v[136:139], v[200:203], v[48:51]
    v_mfma_f32_16x16x32_bf16 v[52:55], v[136:139], v[216:219], v[52:55]
    v_mfma_f32_16x16x32_bf16 v[56:59], v[136:139], v[232:235], v[56:59]
    v_mfma_f32_16x16x32_bf16 v[60:63], v[136:139], v[248:251], v[60:63]
    v_mfma_f32_16x16x32_bf16 v[64:67], v[152:155], v[200:203], v[64:67]
    v_mfma_f32_16x16x32_bf16 v[68:71], v[152:155], v[216:219], v[68:71]
    v_mfma_f32_16x16x32_bf16 v[72:75], v[152:155], v[232:235], v[72:75]
    v_mfma_f32_16x16x32_bf16 v[76:79], v[152:155], v[248:251], v[76:79]
    v_mfma_f32_16x16x32_bf16 v[48:51], v[140:143], v[204:207], v[48:51]
    v_mfma_f32_16x16x32_bf16 v[52:55], v[140:143], v[220:223], v[52:55]
    v_mfma_f32_16x16x32_bf16 v[56:59], v[140:143], v[236:239], v[56:59]
    v_mfma_f32_16x16x32_bf16 v[60:63], v[140:143], v[252:255], v[60:63]
    v_mfma_f32_16x16x32_bf16 v[64:67], v[156:159], v[204:207], v[64:67]
    v_mfma_f32_16x16x32_bf16 v[68:71], v[156:159], v[220:223], v[68:71]
    v_mfma_f32_16x16x32_bf16 v[72:75], v[156:159], v[236:239], v[72:75]
    v_mfma_f32_16x16x32_bf16 v[76:79], v[156:159], v[252:255], v[76:79]
    s_nop 2
    v_cvt_pk_bf16_f32 v80, v48, v49
    v_cvt_pk_bf16_f32 v81, v50, v51
    v_cvt_pk_bf16_f32 v82, v64, v65
    v_cvt_pk_bf16_f32 v83, v66, v67
    v_cvt_pk_bf16_f32 v84, v52, v53
    v_cvt_pk_bf16_f32 v85, v54, v55
    v_cvt_pk_bf16_f32 v86, v68, v69
    v_cvt_pk_bf16_f32 v87, v70, v71
    v_cvt_pk_bf16_f32 v88, v56, v57
    v_cvt_pk_bf16_f32 v89, v58, v59
    v_cvt_pk_bf16_f32 v90, v72, v73
    v_cvt_pk_bf16_f32 v91, v74, v75
    v_cvt_pk_bf16_f32 v92, v60, v61
    v_cvt_pk_bf16_f32 v93, v62, v63
    v_cvt_pk_bf16_f32 v94, v76, v77
    v_cvt_pk_bf16_f32 v95, v78, v79
    s_cmp_eq_u32 s32, 0
    s_cbranch_scc1 aloopL_37_p2a
    s_mov_b32 s32, 0
    ds_read_b64_tr_b16 v[128:129], v181 offset:0
    ds_read_b64_tr_b16 v[130:131], v181 offset:4096
    ds_read_b64_tr_b16 v[64:65], v182 offset:0
    ds_read_b64_tr_b16 v[132:133], v181 offset:8
    ds_read_b64_tr_b16 v[134:135], v181 offset:4104
    ds_read_b64_tr_b16 v[66:67], v182 offset:8
    ds_read_b64_tr_b16 v[136:137], v181 offset:1024
    ds_read_b64_tr_b16 v[138:139], v181 offset:5120
    ds_read_b64_tr_b16 v[68:69], v182 offset:512
    ds_read_b64_tr_b16 v[140:141], v181 offset:1032
    ds_read_b64_tr_b16 v[142:143], v181 offset:5128
    ds_read_b64_tr_b16 v[70:71], v182 offset:520
    ds_read_b64_tr_b16 v[144:145], v181 offset:2048
    ds_read_b64_tr_b16 v[146:147], v181 offset:6144
    ds_read_b64_tr_b16 v[72:73], v182 offset:1024
    ds_read_b64_tr_b16 v[148:149], v181 offset:2056
    ds_read_b64_tr_b16 v[150:151], v181 offset:6152
    ds_read_b64_tr_b16 v[74:75], v182 offset:1032
    ds_read_b64_tr_b16 v[152:153], v181 offset:3072
    ds_read_b64_tr_b16 v[154:155], v181 offset:7168
    ds_read_b64_tr_b16 v[76:77], v182 offset:1536
    ds_read_b64_tr_b16 v[156:157], v181 offset:3080
    ds_read_b64_tr_b16 v[158:159], v181 offset:7176
    ds_read_b64_tr_b16 v[78:79], v182 offset:1544
    v_mov_b32 v188, 0xff61b1e6
    s_cmp_eq_u32 s33, 0
    s_cselect_b64 vcc, s[44:45], 0
    v_cndmask_b32 v12, v12, v188, vcc
    s_cselect_b64 vcc, -1, s[44:45]
    v_cndmask_b32 v16, v16, v188, vcc
    s_cselect_b64 vcc, s[46:47], 0
    v_cndmask_b32 v13, v13, v188, vcc
    s_cselect_b64 vcc, -1, s[46:47]
    v_cndmask_b32 v17, v17, v188, vcc
    s_cselect_b64 vcc, s[48:49], 0
    v_cndmask_b32 v14, v14, v188, vcc
    s_cselect_b64 vcc, -1, s[48:49]
    v_cndmask_b32 v18, v18, v188, vcc
    s_cselect_b64 vcc, s[50:51], 0
    v_cndmask_b32 v15, v15, v188, vcc
    s_cselect_b64 vcc, -1, s[50:51]
    v_cndmask_b32 v19, v19, v188, vcc
    v_max3_f32 v2, v12, v13, v14
    v_max3_f32 v3, v15, v16, v17
    v_max3_f32 v2, v2, v18, v19
    v_max3_f32 v3, v3, v20, v21
    v_max_f32 v2, v2, v3
    v_mov_b32 v3, v2
    s_nop 1
    v_permlane16_swap_b32 v3, v2
    v_max_f32 v2, v2, v3
    v_mov_b32 v3, v2
    s_nop 1
    v_permlane32_swap_b32 v3, v2
    v_max_f32 v2, v2, v3
    v_mul_f32 v2, s29, v2
    v_fma_f32 v12, v12, s29, -v2
    v_fma_f32 v13, v13, s29, -v2
    v_fma_f32 v14, v14, s29, -v2
    v_exp_f32 v12, v12
    v_fma_f32 v15, v15, s29, -v2
    v_exp_f32 v13, v13
    v_fma_f32 v16, v16, s29, -v2
    v_exp_f32 v14, v14
    v_fma_f32 v17, v17, s29, -v2
    v_exp_f32 v15, v15
    v_fma_f32 v18, v18, s29, -v2
    v_exp_f32 v16, v16
    v_fma_f32 v19, v19, s29, -v2
    v_exp_f32 v17, v17
    v_fma_f32 v20, v20, s29, -v2
    v_exp_f32 v18, v18
    v_fma_f32 v21, v21, s29, -v2
    v_exp_f32 v19, v19
    v_exp_f32 v20, v20
    v_exp_f32 v21, v21
    v_cvt_pk_bf16_f32 v12, v12, v13
    v_cvt_pk_bf16_f32 v13, v14, v15
    v_cvt_pk_bf16_f32 v14, v16, v17
    v_cvt_pk_bf16_f32 v15, v18, v19
    v_cvt_pk_bf16_f32 v20, v20, v21
    v_mov_b32 v22, 0
    v_mov_b32 v21, 0
    v_mov_b32 v23, 0
    s_waitcnt lgkmcnt(0)
    s_nop 0
    v_mfma_f32_16x16x32_bf16 v[16:19], v[4:7], v[12:15], 0
    v_mfma_f32_16x16x32_bf16 v[16:19], v[4:7], v[20:23], v[16:19]
    v_mfma_f32_16x16x32_bf16 v[24:27], v[128:131], v[12:15], 0
    v_mfma_f32_16x16x32_bf16 v[24:27], v[64:67], v[20:23], v[24:27]
    v_mfma_f32_16x16x32_bf16 v[28:31], v[132:135], v[12:15], 0
    v_mfma_f32_16x16x32_bf16 v[28:31], v[66:69], v[20:23], v[28:31]
    v_mfma_f32_16x16x32_bf16 v[32:35], v[136:139], v[12:15], 0
    v_mfma_f32_16x16x32_bf16 v[32:35], v[68:71], v[20:23], v[32:35]
    v_mfma_f32_16x16x32_bf16 v[36:39], v[140:143], v[12:15], 0
    v_mfma_f32_16x16x32_bf16 v[36:39], v[70:73], v[20:23], v[36:39]
    v_mfma_f32_16x16x32_bf16 v[48:51], v[144:147], v[12:15], 0
    v_mfma_f32_16x16x32_bf16 v[48:51], v[72:75], v[20:23], v[48:51]
    v_mfma_f32_16x16x32_bf16 v[52:55], v[148:151], v[12:15], 0
    v_mfma_f32_16x16x32_bf16 v[52:55], v[74:77], v[20:23], v[52:55]
    v_mfma_f32_16x16x32_bf16 v[56:59], v[152:155], v[12:15], 0
    v_mfma_f32_16x16x32_bf16 v[56:59], v[76:79], v[20:23], v[56:59]
    v_mfma_f32_16x16x32_bf16 v[60:63], v[156:159], v[12:15], 0
    v_mfma_f32_16x16x32_bf16 v[60:63], v[78:81], v[20:23], v[60:63]
    v_rcp_f32 v3, v16
    s_nop 0
    v_mul_f32 v24, v24, v3
    v_mul_f32 v25, v25, v3
    v_mul_f32 v26, v26, v3
    v_mul_f32 v27, v27, v3
    v_mul_f32 v28, v28, v3
    v_mul_f32 v29, v29, v3
    v_mul_f32 v30, v30, v3
    v_mul_f32 v31, v31, v3
    v_cvt_pk_bf16_f32 v24, v24, v25
    v_cvt_pk_bf16_f32 v25, v26, v27
    v_cvt_pk_bf16_f32 v26, v28, v29
    v_cvt_pk_bf16_f32 v27, v30, v31
    ds_write_b128 v0, v[24:27] offset:32768
    v_mul_f32 v32, v32, v3
    v_mul_f32 v33, v33, v3
    v_mul_f32 v34, v34, v3
    v_mul_f32 v35, v35, v3
    v_mul_f32 v36, v36, v3
    v_mul_f32 v37, v37, v3
    v_mul_f32 v38, v38, v3
    v_mul_f32 v39, v39, v3
    v_cvt_pk_bf16_f32 v32, v32, v33
    v_cvt_pk_bf16_f32 v33, v34, v35
    v_cvt_pk_bf16_f32 v34, v36, v37
    v_cvt_pk_bf16_f32 v35, v38, v39
    ds_write_b128 v0, v[32:35] offset:33792
    v_mul_f32 v48, v48, v3
    v_mul_f32 v49, v49, v3
    v_mul_f32 v50, v50, v3
    v_mul_f32 v51, v51, v3
    v_mul_f32 v52, v52, v3
    v_mul_f32 v53, v53, v3
    v_mul_f32 v54, v54, v3
    v_mul_f32 v55, v55, v3
    v_cvt_pk_bf16_f32 v48, v48, v49
    v_cvt_pk_bf16_f32 v49, v50, v51
    v_cvt_pk_bf16_f32 v50, v52, v53
    v_cvt_pk_bf16_f32 v51, v54, v55
    ds_write_b128 v0, v[48:51] offset:34816
    v_mul_f32 v56, v56, v3
    v_mul_f32 v57, v57, v3
    v_mul_f32 v58, v58, v3
    v_mul_f32 v59, v59, v3
    v_mul_f32 v60, v60, v3
    v_mul_f32 v61, v61, v3
    v_mul_f32 v62, v62, v3
    v_mul_f32 v63, v63, v3
    v_cvt_pk_bf16_f32 v56, v56, v57
    v_cvt_pk_bf16_f32 v57, v58, v59
    v_cvt_pk_bf16_f32 v58, v60, v61
    v_cvt_pk_bf16_f32 v59, v62, v63
    ds_write_b128 v0, v[56:59] offset:35840
aloopL_37_p2a:
    v_mov_b32 v24, 0
    v_mov_b32 v25, 0
    v_mov_b32 v26, 0
    v_mov_b32 v27, 0
    v_mov_b32 v28, 0
    v_mov_b32 v29, 0
    v_mov_b32 v30, 0
    v_mov_b32 v31, 0
    v_mov_b32 v32, 0
    v_mov_b32 v33, 0
    v_mov_b32 v34, 0
    v_mov_b32 v35, 0
    v_mov_b32 v36, 0
    v_mov_b32 v37, 0
    v_mov_b32 v38, 0
    v_mov_b32 v39, 0
    s_setprio 2
    s_cmp_lg_u32 s31, s30
    s_cbranch_scc1 aloopL_37_nd1
    s_add_u32 m0, s42, 16384
    s_add_u32 s17, s41, s33
    s_add_u32 s17, s17, 4194304
    buffer_load_dwordx4 v0, s[4:7], s17 offen offset:0 sc1 lds
    buffer_load_dwordx4 v0, s[4:7], s17 offen offset:1024 sc1 lds
    buffer_load_dwordx4 v0, s[4:7], s17 offen offset:2048 sc1 lds
    buffer_load_dwordx4 v0, s[4:7], s17 offen offset:3072 sc1 lds
aloopL_37_nd1:
    s_add_u32 s41, s41, 262144
    s_barrier
    s_sleep 9
    s_waitcnt lgkmcnt(0)
    buffer_load_dwordx4 v[48:51], v0, s[4:7], s23 offen offset:0 sc1
    buffer_load_dwordx4 v[52:55], v0, s[4:7], s23 offen offset:1024 sc1
    buffer_load_dwordx4 v[56:59], v0, s[4:7], s23 offen offset:2048 sc1
    buffer_load_dwordx4 v[60:63], v0, s[4:7], s23 offen offset:3072 sc1
    s_sleep 2
    buffer_load_dwordx4 v[64:67], v0, s[4:7], s24 offen offset:0 sc1
    buffer_load_dwordx4 v[68:71], v0, s[4:7], s24 offen offset:1024 sc1
    s_waitcnt vmcnt(5)
    v_mfma_f32_16x16x32_bf16 v[12:15], v[96:99], v[48:51], 0
    v_mfma_f32_16x16x32_bf16 v[16:19], v[112:115], v[48:51], 0
    v_max_u32 v3, v48, v50
    v_cmp_eq_u32 vcc, -1, v3
    v_mfma_f32_16x16x32_bf16 v[20:23], v[48:51], v[48:51], 0
    s_cbranch_vccnz aloopL_37_rq_0
    s_waitcnt vmcnt(4)
    v_mfma_f32_16x16x32_bf16 v[12:15], v[100:103], v[52:55], v[12:15]
    v_mfma_f32_16x16x32_bf16 v[16:19], v[116:119], v[52:55], v[16:19]
    v_max_u32 v3, v52, v54
    v_cmp_eq_u32 vcc, -1, v3
    v_mfma_f32_16x16x32_bf16 v[20:23], v[52:55], v[52:55], v[20:23]
    s_cbranch_vccnz aloopL_37_rq_1
    s_waitcnt vmcnt(3)
    v_mfma_f32_16x16x32_bf16 v[12:15], v[104:107], v[56:59], v[12:15]
    v_mfma_f32_16x16x32_bf16 v[16:19], v[120:123], v[56:59], v[16:19]
    v_max_u32 v3, v56, v58
    v_cmp_eq_u32 vcc, -1, v3
    v_mfma_f32_16x16x32_bf16 v[20:23], v[56:59], v[56:59], v[20:23]
    s_cbranch_vccnz aloopL_37_rq_2
    s_waitcnt vmcnt(2)
    v_mfma_f32_16x16x32_bf16 v[12:15], v[108:111], v[60:63], v[12:15]
    v_mfma_f32_16x16x32_bf16 v[16:19], v[124:127], v[60:63], v[16:19]
    v_max_u32 v3, v60, v62
    v_cmp_eq_u32 vcc, -1, v3
    v_mfma_f32_16x16x32_bf16 v[20:23], v[60:63], v[60:63], v[20:23]
    s_cbranch_vccnz aloopL_37_rq_3
aloopL_37_sdone:
    s_nop 1
    ds_write_b32 v164, v165
    s_nop 0
    v_max3_f32 v2, v12, v13, v14
    v_max3_f32 v3, v15, v16, v17
    v_max3_f32 v2, v2, v18, v19
    v_max3_f32 v3, v3, v20, v21
    v_max_f32 v2, v2, v3
    v_mov_b32 v3, v2
    s_nop 1
    v_permlane16_swap_b32 v3, v2
    v_max_f32 v2, v2, v3
    v_mov_b32 v3, v2
    s_waitcnt vmcnt(0)
    v_max3_u32 v188, v64, v66, v68
    v_permlane32_swap_b32 v3, v2
    v_max_f32 v2, v2, v3
    v_max_u32 v188, v188, v70
    v_mul_f32 v2, s29, v2
    v_cmp_eq_u32 vcc, -1, v188
    v_fma_f32 v12, v12, s29, -v2
    v_fma_f32 v13, v13, s29, -v2
    s_cbranch_vccnz aloopL_37_rq_v
aloopL_37_vok:
    v_smfmac_f32_16x16x64_bf16 v[24:27], v[64:67], v[192:199], v166
    v_fma_f32 v14, v14, s29, -v2
    v_exp_f32 v12, v12
    v_smfmac_f32_16x16x64_bf16 v[32:35], v[64:67], v[224:231], v166
    s_add_u32 s17, s41, 37748736
    buffer_load_dwordx4 v[128:131], v0, s[4:7], s17 offen offset:0 sc1
    v_fma_f32 v15, v15, s29, -v2
    v_exp_f32 v13, v13
    v_smfmac_f32_16x16x64_bf16 v[28:31], v[64:67], v[208:215], v166
    buffer_load_dwordx4 v[132:135], v0, s[4:7], s17 offen offset:1024 sc1
    v_fma_f32 v16, v16, s29, -v2
    v_exp_f32 v14, v14
    v_smfmac_f32_16x16x64_bf16 v[36:39], v[64:67], v[240:247], v166
    buffer_load_dwordx4 v[136:139], v0, s[4:7], s17 offen offset:2048 sc1
    v_fma_f32 v17, v17, s29, -v2
    v_exp_f32 v15, v15
    v_smfmac_f32_16x16x64_bf16 v[24:27], v[68:71], v[200:207], v166
    buffer_load_dwordx4 v[140:143], v0, s[4:7], s17 offen offset:3072 sc1
    v_fma_f32 v18, v18, s29, -v2
    v_exp_f32 v16, v16
    v_smfmac_f32_16x16x64_bf16 v[32:35], v[68:71], v[232:239], v166
    s_add_u32 s18, s41, 37879808
    buffer_load_dwordx4 v[144:147], v0, s[4:7], s18 offen offset:0 sc1
    v_fma_f32 v19, v19, s29, -v2
    v_exp_f32 v17, v17
    v_smfmac_f32_16x16x64_bf16 v[28:31], v[68:71], v[216:223], v166
    buffer_load_dwordx4 v[148:151], v0, s[4:7], s18 offen offset:1024 sc1
    v_fma_f32 v20, v20, s29, -v2
    v_exp_f32 v18, v18
    v_smfmac_f32_16x16x64_bf16 v[36:39], v[68:71], v[248:255], v166
    buffer_load_dwordx4 v[152:155], v0, s[4:7], s18 offen offset:2048 sc1
    v_fma_f32 v21, v21, s29, -v2
    v_exp_f32 v19, v19
    buffer_load_dwordx4 v[156:159], v0, s[4:7], s18 offen offset:3072 sc1
    v_exp_f32 v20, v20
    v_exp_f32 v21, v21
    v_cvt_pk_bf16_f32 v12, v12, v13
    v_cvt_pk_bf16_f32 v13, v14, v15
    v_cvt_pk_bf16_f32 v14, v16, v17
    v_cvt_pk_bf16_f32 v15, v18, v19
    v_cvt_pk_bf16_f32 v20, v20, v21
    v_mov_b32 v22, 0
    v_mfma_f32_16x16x32_bf16 v[16:19], v[4:7], v[12:15], 0
    v_mov_b32 v21, v20
    v_mov_b32 v23, 0
    v_cvt_pk_bf16_f32 v40, v24, v25
    v_cvt_pk_bf16_f32 v41, v26, v27
    v_mfma_f32_16x16x32_bf16 v[16:19], v[8:11], v[20:23], v[16:19]
    v_mfma_f32_16x16x32_bf16 v[24:27], v[80:83], v[12:15], 0
    v_cvt_pk_bf16_f32 v44, v32, v33
    v_cvt_pk_bf16_f32 v45, v34, v35
    v_mfma_f32_16x16x32_bf16 v[32:35], v[88:91], v[12:15], 0
    v_cvt_pk_bf16_f32 v42, v28, v29
    v_cvt_pk_bf16_f32 v43, v30, v31
    v_mfma_f32_16x16x32_bf16 v[28:31], v[84:87], v[12:15], 0
    v_cvt_pk_bf16_f32 v46, v36, v37
    v_cvt_pk_bf16_f32 v47, v38, v39
    v_mfma_f32_16x16x32_bf16 v[36:39], v[92:95], v[12:15], 0
aloopL_37_midE:
    s_mov_b64 vcc, s[56:57]
    v_rcp_f32 v3, v16
    v_mfma_f32_16x16x32_bf16 v[24:27], v[40:43], v[20:23], v[24:27]
    v_mfma_f32_16x16x32_bf16 v[32:35], v[44:47], v[20:23], v[32:35]
    v_mfma_f32_16x16x32_bf16 v[28:31], v[42:45], v[20:23], v[28:31]
    v_mfma_f32_16x16x32_bf16 v[36:39], v[46:49], v[20:23], v[36:39]
    v_mov_b32_dpp v3, v3 quad_perm:[2,3,2,3] row_mask:0xf bank_mask:0xf
    s_nop 4
    v_cndmask_b32_dpp v24, v32, v24, vcc quad_perm:[2,3,2,3] row_mask:0xf bank_mask:0xf
    v_cndmask_b32_dpp v25, v33, v25, vcc quad_perm:[2,3,2,3] row_mask:0xf bank_mask:0xf
    v_cndmask_b32_dpp v26, v34, v26, vcc quad_perm:[2,3,2,3] row_mask:0xf bank_mask:0xf
    v_cndmask_b32_dpp v27, v35, v27, vcc quad_perm:[2,3,2,3] row_mask:0xf bank_mask:0xf
    v_cndmask_b32_dpp v28, v36, v28, vcc quad_perm:[2,3,2,3] row_mask:0xf bank_mask:0xf
    v_cndmask_b32_dpp v29, v37, v29, vcc quad_perm:[2,3,2,3] row_mask:0xf bank_mask:0xf
    v_cndmask_b32_dpp v30, v38, v30, vcc quad_perm:[2,3,2,3] row_mask:0xf bank_mask:0xf
    v_cndmask_b32_dpp v31, v39, v31, vcc quad_perm:[2,3,2,3] row_mask:0xf bank_mask:0xf
    v_mul_f32 v24, v24, v3
    v_mul_f32 v25, v25, v3
    v_mul_f32 v26, v26, v3
    v_mul_f32 v27, v27, v3
    v_mul_f32 v28, v28, v3
    v_mul_f32 v29, v29, v3
    v_mul_f32 v30, v30, v3
    v_mul_f32 v31, v31, v3
    v_cvt_pk_bf16_f32 v168, v24, v25
    v_cvt_pk_bf16_f32 v169, v26, v27
    v_cvt_pk_bf16_f32 v170, v28, v29
    v_cvt_pk_bf16_f32 v171, v30, v31
    ds_write_b128 v160, v[168:171]
    s_waitcnt lgkmcnt(0)
    s_barrier
    ds_read_b128 v[172:175], v161
    s_waitcnt lgkmcnt(0)
    v_mfma_f32_16x16x32_bf16 v[24:27], v[184:187], v[172:175], 0
    s_nop 7
    v_cvt_pk_bf16_f32 v168, v24, v25
    v_cvt_pk_bf16_f32 v169, v26, v27
    s_nop 0
    v_permlane16_swap_b32 v168, v170
    v_permlane16_swap_b32 v169, v171
    s_mov_b64 exec, 0xffff
    v_min_u32 v168, -2, v168
    buffer_store_dwordx4 v[168:171], v1, s[4:7], s25 offen sc1
    s_setprio 0
    buffer_store_dwordx4 v[176:179], v1, s[4:7], s26 offen sc1
    s_mov_b64 exec, -1
    s_cmp_lg_u32 s27, 0
    s_cbranch_scc1 pg_38
    s_sub_u32 s21, s16, 1
    s_cbranch_scc1 pg_38
    s_and_b32 s17, s21, 3
    s_cmp_ge_u32 s16, 58
    s_cselect_b32 s17, 0, s17
    s_cmp_lg_u32 s17, 0
    s_cbranch_scc1 pg_38
    v_mov_b32 v3, s21
    s_mov_b64 exec, 1
    buffer_store_dword v3, off, s[4:7], s28 sc1
    s_mov_b64 exec, -1
pg_38:
    s_cmp_lg_u32 s31, s30
    s_cbranch_scc1 aloopL_37_nd2
    ds_read_b128 v[24:27], v163 offset:16384
    ds_read_b128 v[28:31], v163 offset:17408
    ds_read_b128 v[32:35], v163 offset:18432
    ds_read_b128 v[36:39], v163 offset:19456
    ds_write_b32 v180, v64 offset:0
    ds_write_b32 v180, v65 offset:8
    ds_write_b32 v180, v66 offset:128
    ds_write_b32 v180, v67 offset:136
    ds_write_b32 v180, v68 offset:1024
    ds_write_b32 v180, v69 offset:1032
    ds_write_b32 v180, v70 offset:1152
    ds_write_b32 v180, v71 offset:1160
    s_mov_b32 s32, 1
    s_waitcnt lgkmcnt(11)
    v_mfma_f32_16x16x32_bf16 v[12:15], v[96:99], v[24:27], 0
    v_mfma_f32_16x16x32_bf16 v[16:19], v[112:115], v[24:27], 0
    v_mfma_f32_16x16x32_bf16 v[20:23], v[48:51], v[24:27], 0
    s_waitcnt lgkmcnt(10)
    v_mfma_f32_16x16x32_bf16 v[12:15], v[100:103], v[28:31], v[12:15]
    v_mfma_f32_16x16x32_bf16 v[16:19], v[116:119], v[28:31], v[16:19]
    v_mfma_f32_16x16x32_bf16 v[20:23], v[52:55], v[28:31], v[20:23]
    s_waitcnt lgkmcnt(9)
    v_mfma_f32_16x16x32_bf16 v[12:15], v[104:107], v[32:35], v[12:15]
    v_mfma_f32_16x16x32_bf16 v[16:19], v[120:123], v[32:35], v[16:19]
    v_mfma_f32_16x16x32_bf16 v[20:23], v[56:59], v[32:35], v[20:23]
    s_waitcnt lgkmcnt(8)
    v_mfma_f32_16x16x32_bf16 v[12:15], v[108:111], v[36:39], v[12:15]
    v_mfma_f32_16x16x32_bf16 v[16:19], v[124:127], v[36:39], v[16:19]
    v_mfma_f32_16x16x32_bf16 v[20:23], v[60:63], v[36:39], v[20:23]
    s_waitcnt lgkmcnt(0)
    s_nop 3
aloopL_37_nd2:
    s_add_u32 s17, s41, 20971520
    buffer_load_dwordx4 v[96:99], v0, s[4:7], s17 offen offset:0 sc1
    buffer_load_dwordx4 v[100:103], v0, s[4:7], s17 offen offset:1024 sc1
    buffer_load_dwordx4 v[104:107], v0, s[4:7], s17 offen offset:2048 sc1
    buffer_load_dwordx4 v[108:111], v0, s[4:7], s17 offen offset:3072 sc1
    s_add_u32 s18, s41, 21102592
    buffer_load_dwordx4 v[112:115], v0, s[4:7], s18 offen offset:0 sc1
    buffer_load_dwordx4 v[116:119], v0, s[4:7], s18 offen offset:1024 sc1
    buffer_load_dwordx4 v[120:123], v0, s[4:7], s18 offen offset:2048 sc1
    buffer_load_dwordx4 v[124:127], v0, s[4:7], s18 offen offset:3072 sc1
    s_add_u32 s16, s16, 1
    s_cmp_lt_u32 s16, 48
    s_cbranch_scc1 aloopL_37
    s_waitcnt vmcnt(0)
    ds_write_b128 v163, v[128:131] offset:8192
    ds_write_b128 v163, v[132:135] offset:9216
    ds_write_b128 v163, v[136:139] offset:10240
    ds_write_b128 v163, v[140:143] offset:11264
    ds_write_b128 v163, v[144:147] offset:12288
    ds_write_b128 v163, v[148:151] offset:13312
    ds_write_b128 v163, v[152:155] offset:14336
    ds_write_b128 v163, v[156:159] offset:15360
    s_waitcnt lgkmcnt(0)
    s_cmp_eq_u32 s32, 0
    s_cbranch_scc1 aloopL_37_p2b
    s_mov_b32 s32, 0
    ds_read_b64_tr_b16 v[128:129], v181 offset:0
    ds_read_b64_tr_b16 v[130:131], v181 offset:4096
    ds_read_b64_tr_b16 v[64:65], v182 offset:0
    ds_read_b64_tr_b16 v[132:133], v181 offset:8
    ds_read_b64_tr_b16 v[134:135], v181 offset:4104
    ds_read_b64_tr_b16 v[66:67], v182 offset:8
    ds_read_b64_tr_b16 v[136:137], v181 offset:1024
    ds_read_b64_tr_b16 v[138:139], v181 offset:5120
    ds_read_b64_tr_b16 v[68:69], v182 offset:512
    ds_read_b64_tr_b16 v[140:141], v181 offset:1032
    ds_read_b64_tr_b16 v[142:143], v181 offset:5128
    ds_read_b64_tr_b16 v[70:71], v182 offset:520
    ds_read_b64_tr_b16 v[144:145], v181 offset:2048
    ds_read_b64_tr_b16 v[146:147], v181 offset:6144
    ds_read_b64_tr_b16 v[72:73], v182 offset:1024
    ds_read_b64_tr_b16 v[148:149], v181 offset:2056
    ds_read_b64_tr_b16 v[150:151], v181 offset:6152
    ds_read_b64_tr_b16 v[74:75], v182 offset:1032
    ds_read_b64_tr_b16 v[152:153], v181 offset:3072
    ds_read_b64_tr_b16 v[154:155], v181 offset:7168
    ds_read_b64_tr_b16 v[76:77], v182 offset:1536
    ds_read_b64_tr_b16 v[156:157], v181 offset:3080
    ds_read_b64_tr_b16 v[158:159], v181 offset:7176
    ds_read_b64_tr_b16 v[78:79], v182 offset:1544
    v_mov_b32 v188, 0xff61b1e6
    s_cmp_eq_u32 s33, 0
    s_cselect_b64 vcc, s[44:45], 0
    v_cndmask_b32 v12, v12, v188, vcc
    s_cselect_b64 vcc, -1, s[44:45]
    v_cndmask_b32 v16, v16, v188, vcc
    s_cselect_b64 vcc, s[46:47], 0
    v_cndmask_b32 v13, v13, v188, vcc
    s_cselect_b64 vcc, -1, s[46:47]
    v_cndmask_b32 v17, v17, v188, vcc
    s_cselect_b64 vcc, s[48:49], 0
    v_cndmask_b32 v14, v14, v188, vcc
    s_cselect_b64 vcc, -1, s[48:49]
    v_cndmask_b32 v18, v18, v188, vcc
    s_cselect_b64 vcc, s[50:51], 0
    v_cndmask_b32 v15, v15, v188, vcc
    s_cselect_b64 vcc, -1, s[50:51]
    v_cndmask_b32 v19, v19, v188, vcc
    v_max3_f32 v2, v12, v13, v14
    v_max3_f32 v3, v15, v16, v17
    v_max3_f32 v2, v2, v18, v19
    v_max3_f32 v3, v3, v20, v21
    v_max_f32 v2, v2, v3
    v_mov_b32 v3, v2
    s_nop 1
    v_permlane16_swap_b32 v3, v2
    v_max_f32 v2, v2, v3
    v_mov_b32 v3, v2
    s_nop 1
    v_permlane32_swap_b32 v3, v2
    v_max_f32 v2, v2, v3
    v_mul_f32 v2, s29, v2
    v_fma_f32 v12, v12, s29, -v2
    v_fma_f32 v13, v13, s29, -v2
    v_fma_f32 v14, v14, s29, -v2
    v_exp_f32 v12, v12
    v_fma_f32 v15, v15, s29, -v2
    v_exp_f32 v13, v13
    v_fma_f32 v16, v16, s29, -v2
    v_exp_f32 v14, v14
    v_fma_f32 v17, v17, s29, -v2
    v_exp_f32 v15, v15
    v_fma_f32 v18, v18, s29, -v2
    v_exp_f32 v16, v16
    v_fma_f32 v19, v19, s29, -v2
    v_exp_f32 v17, v17
    v_fma_f32 v20, v20, s29, -v2
    v_exp_f32 v18, v18
    v_fma_f32 v21, v21, s29, -v2
    v_exp_f32 v19, v19
    v_exp_f32 v20, v20
    v_exp_f32 v21, v21
    v_cvt_pk_bf16_f32 v12, v12, v13
    v_cvt_pk_bf16_f32 v13, v14, v15
    v_cvt_pk_bf16_f32 v14, v16, v17
    v_cvt_pk_bf16_f32 v15, v18, v19
    v_cvt_pk_bf16_f32 v20, v20, v21
    v_mov_b32 v22, 0
    v_mov_b32 v21, 0
    v_mov_b32 v23, 0
    s_waitcnt lgkmcnt(0)
    s_nop 0
    v_mfma_f32_16x16x32_bf16 v[16:19], v[4:7], v[12:15], 0
    v_mfma_f32_16x16x32_bf16 v[16:19], v[4:7], v[20:23], v[16:19]
    v_mfma_f32_16x16x32_bf16 v[24:27], v[128:131], v[12:15], 0
    v_mfma_f32_16x16x32_bf16 v[24:27], v[64:67], v[20:23], v[24:27]
    v_mfma_f32_16x16x32_bf16 v[28:31], v[132:135], v[12:15], 0
    v_mfma_f32_16x16x32_bf16 v[28:31], v[66:69], v[20:23], v[28:31]
    v_mfma_f32_16x16x32_bf16 v[32:35], v[136:139], v[12:15], 0
    v_mfma_f32_16x16x32_bf16 v[32:35], v[68:71], v[20:23], v[32:35]
    v_mfma_f32_16x16x32_bf16 v[36:39], v[140:143], v[12:15], 0
    v_mfma_f32_16x16x32_bf16 v[36:39], v[70:73], v[20:23], v[36:39]
    v_mfma_f32_16x16x32_bf16 v[48:51], v[144:147], v[12:15], 0
    v_mfma_f32_16x16x32_bf16 v[48:51], v[72:75], v[20:23], v[48:51]
    v_mfma_f32_16x16x32_bf16 v[52:55], v[148:151], v[12:15], 0
    v_mfma_f32_16x16x32_bf16 v[52:55], v[74:77], v[20:23], v[52:55]
    v_mfma_f32_16x16x32_bf16 v[56:59], v[152:155], v[12:15], 0
    v_mfma_f32_16x16x32_bf16 v[56:59], v[76:79], v[20:23], v[56:59]
    v_mfma_f32_16x16x32_bf16 v[60:63], v[156:159], v[12:15], 0
    v_mfma_f32_16x16x32_bf16 v[60:63], v[78:81], v[20:23], v[60:63]
    v_rcp_f32 v3, v16
    s_nop 0
    v_mul_f32 v24, v24, v3
    v_mul_f32 v25, v25, v3
    v_mul_f32 v26, v26, v3
    v_mul_f32 v27, v27, v3
    v_mul_f32 v28, v28, v3
    v_mul_f32 v29, v29, v3
    v_mul_f32 v30, v30, v3
    v_mul_f32 v31, v31, v3
    v_cvt_pk_bf16_f32 v24, v24, v25
    v_cvt_pk_bf16_f32 v25, v26, v27
    v_cvt_pk_bf16_f32 v26, v28, v29
    v_cvt_pk_bf16_f32 v27, v30, v31
    ds_write_b128 v0, v[24:27] offset:32768
    v_mul_f32 v32, v32, v3
    v_mul_f32 v33, v33, v3
    v_mul_f32 v34, v34, v3
    v_mul_f32 v35, v35, v3
    v_mul_f32 v36, v36, v3
    v_mul_f32 v37, v37, v3
    v_mul_f32 v38, v38, v3
    v_mul_f32 v39, v39, v3
    v_cvt_pk_bf16_f32 v32, v32, v33
    v_cvt_pk_bf16_f32 v33, v34, v35
    v_cvt_pk_bf16_f32 v34, v36, v37
    v_cvt_pk_bf16_f32 v35, v38, v39
    ds_write_b128 v0, v[32:35] offset:33792
    v_mul_f32 v48, v48, v3
    v_mul_f32 v49, v49, v3
    v_mul_f32 v50, v50, v3
    v_mul_f32 v51, v51, v3
    v_mul_f32 v52, v52, v3
    v_mul_f32 v53, v53, v3
    v_mul_f32 v54, v54, v3
    v_mul_f32 v55, v55, v3
    v_cvt_pk_bf16_f32 v48, v48, v49
    v_cvt_pk_bf16_f32 v49, v50, v51
    v_cvt_pk_bf16_f32 v50, v52, v53
    v_cvt_pk_bf16_f32 v51, v54, v55
    ds_write_b128 v0, v[48:51] offset:34816
    v_mul_f32 v56, v56, v3
    v_mul_f32 v57, v57, v3
    v_mul_f32 v58, v58, v3
    v_mul_f32 v59, v59, v3
    v_mul_f32 v60, v60, v3
    v_mul_f32 v61, v61, v3
    v_mul_f32 v62, v62, v3
    v_mul_f32 v63, v63, v3
    v_cvt_pk_bf16_f32 v56, v56, v57
    v_cvt_pk_bf16_f32 v57, v58, v59
    v_cvt_pk_bf16_f32 v58, v60, v61
    v_cvt_pk_bf16_f32 v59, v62, v63
    ds_write_b128 v0, v[56:59] offset:35840
aloopL_37_p2b:
    ds_write_b128 v163, v[96:99] offset:0
    ds_write_b128 v163, v[100:103] offset:1024
    ds_write_b128 v163, v[104:107] offset:2048
    ds_write_b128 v163, v[108:111] offset:3072
    ds_write_b128 v163, v[112:115] offset:4096
    ds_write_b128 v163, v[116:119] offset:5120
    ds_write_b128 v163, v[120:123] offset:6144
    ds_write_b128 v163, v[124:127] offset:7168
    s_waitcnt lgkmcnt(0)
    s_branch aloopH_36
aloopL_37_rq_0:
    s_sub_u32 s22, s22, 1
    s_cbranch_scc1 aloopL_37_rq_0_g
    buffer_load_dwordx4 v[48:51], v0, s[4:7], s23 offen offset:0 sc1
    buffer_load_dwordx4 v[52:55], v0, s[4:7], s23 offen offset:1024 sc1
    buffer_load_dwordx4 v[56:59], v0, s[4:7], s23 offen offset:2048 sc1
    buffer_load_dwordx4 v[60:63], v0, s[4:7], s23 offen offset:3072 sc1
    buffer_load_dwordx4 v[64:67], v0, s[4:7], s24 offen offset:0 sc1
    buffer_load_dwordx4 v[68:71], v0, s[4:7], s24 offen offset:1024 sc1
    s_waitcnt vmcnt(5)
    v_max_u32 v3, v48, v50
    v_cmp_eq_u32 vcc, -1, v3
    s_cbranch_vccnz aloopL_37_rq_0
    s_branch aloopL_37_again
aloopL_37_rq_0_g:
    s_mov_b32 s22, 0
    s_waitcnt vmcnt(0)
    s_branch aloopL_37_nochk
aloopL_37_rq_1:
    s_sub_u32 s22, s22, 1
    s_cbranch_scc1 aloopL_37_rq_1_g
    buffer_load_dwordx4 v[52:55], v0, s[4:7], s23 offen offset:1024 sc1
    buffer_load_dwordx4 v[56:59], v0, s[4:7], s23 offen offset:2048 sc1
    buffer_load_dwordx4 v[60:63], v0, s[4:7], s23 offen offset:3072 sc1
    buffer_load_dwordx4 v[64:67], v0, s[4:7], s24 offen offset:0 sc1
    buffer_load_dwordx4 v[68:71], v0, s[4:7], s24 offen offset:1024 sc1
    s_waitcnt vmcnt(4)
    v_max_u32 v3, v52, v54
    v_cmp_eq_u32 vcc, -1, v3
    s_cbranch_vccnz aloopL_37_rq_1
    s_branch aloopL_37_again
aloopL_37_rq_1_g:
    s_mov_b32 s22, 0
    s_waitcnt vmcnt(0)
    s_branch aloopL_37_nochk
aloopL_37_rq_2:
    s_sub_u32 s22, s22, 1
    s_cbranch_scc1 aloopL_37_rq_2_g
    buffer_load_dwordx4 v[56:59], v0, s[4:7], s23 offen offset:2048 sc1
    buffer_load_dwordx4 v[60:63], v0, s[4:7], s23 offen offset:3072 sc1
    buffer_load_dwordx4 v[64:67], v0, s[4:7], s24 offen offset:0 sc1
    buffer_load_dwordx4 v[68:71], v0, s[4:7], s24 offen offset:1024 sc1
    s_waitcnt vmcnt(3)
    v_max_u32 v3, v56, v58
    v_cmp_eq_u32 vcc, -1, v3
    s_cbranch_vccnz aloopL_37_rq_2
    s_branch aloopL_37_again
aloopL_37_rq_2_g:
    s_mov_b32 s22, 0
    s_waitcnt vmcnt(0)
    s_branch aloopL_37_nochk
aloopL_37_rq_3:
    s_sub_u32 s22, s22, 1
    s_cbranch_scc1 aloopL_37_rq_3_g
    buffer_load_dwordx4 v[60:63], v0, s[4:7], s23 offen offset:3072 sc1
    buffer_load_dwordx4 v[64:67], v0, s[4:7], s24 offen offset:0 sc1
    buffer_load_dwordx4 v[68:71], v0, s[4:7], s24 offen offset:1024 sc1
    s_waitcnt vmcnt(2)
    v_max_u32 v3, v60, v62
    v_cmp_eq_u32 vcc, -1, v3
    s_cbranch_vccnz aloopL_37_rq_3
    s_branch aloopL_37_again
aloopL_37_rq_3_g:
    s_mov_b32 s22, 0
    s_waitcnt vmcnt(0)
    s_branch aloopL_37_nochk
aloopL_37_again:
    s_waitcnt vmcnt(5)
    v_mfma_f32_16x16x32_bf16 v[12:15], v[96:99], v[48:51], 0
    v_mfma_f32_16x16x32_bf16 v[16:19], v[112:115], v[48:51], 0
    v_max_u32 v3, v48, v50
    v_cmp_eq_u32 vcc, -1, v3
    v_mfma_f32_16x16x32_bf16 v[20:23], v[48:51], v[48:51], 0
    s_cbranch_vccnz aloopL_37_rq_0
    s_waitcnt vmcnt(4)
    v_mfma_f32_16x16x32_bf16 v[12:15], v[100:103], v[52:55], v[12:15]
    v_mfma_f32_16x16x32_bf16 v[16:19], v[116:119], v[52:55], v[16:19]
    v_max_u32 v3, v52, v54
    v_cmp_eq_u32 vcc, -1, v3
    v_mfma_f32_16x16x32_bf16 v[20:23], v[52:55], v[52:55], v[20:23]
    s_cbranch_vccnz aloopL_37_rq_1
    s_waitcnt vmcnt(3)
    v_mfma_f32_16x16x32_bf16 v[12:15], v[104:107], v[56:59], v[12:15]
    v_mfma_f32_16x16x32_bf16 v[16:19], v[120:123], v[56:59], v[16:19]
    v_max_u32 v3, v56, v58
    v_cmp_eq_u32 vcc, -1, v3
    v_mfma_f32_16x16x32_bf16 v[20:23], v[56:59], v[56:59], v[20:23]
    s_cbranch_vccnz aloopL_37_rq_2
    s_waitcnt vmcnt(2)
    v_mfma_f32_16x16x32_bf16 v[12:15], v[108:111], v[60:63], v[12:15]
    v_mfma_f32_16x16x32_bf16 v[16:19], v[124:127], v[60:63], v[16:19]
    v_max_u32 v3, v60, v62
    v_cmp_eq_u32 vcc, -1, v3
    v_mfma_f32_16x16x32_bf16 v[20:23], v[60:63], v[60:63], v[20:23]
    s_cbranch_vccnz aloopL_37_rq_3
    s_branch aloopL_37_sdone
aloopL_37_rq_v:
    s_sub_u32 s22, s22, 1
    s_cbranch_scc1 aloopL_37_rq_vg
    buffer_load_dwordx4 v[64:67], v0, s[4:7], s24 offen offset:0 sc1
    buffer_load_dwordx4 v[68:71], v0, s[4:7], s24 offen offset:1024 sc1
    s_waitcnt vmcnt(0)
    v_max3_u32 v188, v64, v66, v68
    v_max_u32 v188, v188, v70
    v_cmp_eq_u32 vcc, -1, v188
    s_cbranch_vccnz aloopL_37_rq_v
    s_branch aloopL_37_vok
aloopL_37_rq_vg:
    s_mov_b32 s22, 0
    s_branch aloopL_37_vok
aloopL_37_nochk:
    v_mfma_f32_16x16x32_bf16 v[12:15], v[96:99], v[48:51], 0
    v_mfma_f32_16x16x32_bf16 v[16:19], v[112:115], v[48:51], 0
    v_mfma_f32_16x16x32_bf16 v[20:23], v[48:51], v[48:51], 0
    v_mfma_f32_16x16x32_bf16 v[12:15], v[100:103], v[52:55], v[12:15]
    v_mfma_f32_16x16x32_bf16 v[16:19], v[116:119], v[52:55], v[16:19]
    v_mfma_f32_16x16x32_bf16 v[20:23], v[52:55], v[52:55], v[20:23]
    v_mfma_f32_16x16x32_bf16 v[12:15], v[104:107], v[56:59], v[12:15]
    v_mfma_f32_16x16x32_bf16 v[16:19], v[120:123], v[56:59], v[16:19]
    v_mfma_f32_16x16x32_bf16 v[20:23], v[56:59], v[56:59], v[20:23]
    v_mfma_f32_16x16x32_bf16 v[12:15], v[108:111], v[60:63], v[12:15]
    v_mfma_f32_16x16x32_bf16 v[16:19], v[124:127], v[60:63], v[16:19]
    v_mfma_f32_16x16x32_bf16 v[20:23], v[60:63], v[60:63], v[20:23]
    s_nop 1
    s_branch aloopL_37_sdone
.p2align 6
aloopH_36:
    s_and_b32 s23, s16, 3
    s_lshl_b32 s23, s23, 18
    s_add_u32 s23, s23, s38
    s_add_u32 s24, s23, 4096
    s_and_b32 s25, s16, 3
    s_lshl_b32 s25, s25, 18
    s_add_u32 s25, s25, s39
    s_add_u32 s26, s16, 2
    s_and_b32 s26, s26, 3
    s_lshl_b32 s26, s26, 18
    s_add_u32 s26, s26, s39
    v_mov_b32 v165, s16
aloopH_36_wkv:
    ds_read_b32 v188, v164 offset:16
    s_waitcnt lgkmcnt(0)
    v_readfirstlane_b32 s19, v188
    s_cmp_ge_i32 s19, s16
    s_cbranch_scc1 aloopH_36_wkvok
    s_sleep 1
    s_branch aloopH_36_wkv
aloopH_36_wkvok:
    ds_read_b128 v[128:131], v163 offset:8192
    ds_read_b128 v[144:147], v163 offset:12288
    ds_read_b128 v[132:135], v163 offset:9216
    ds_read_b128 v[148:151], v163 offset:13312
    ds_read_b128 v[136:139], v163 offset:10240
    ds_read_b128 v[152:155], v163 offset:14336
    ds_read_b128 v[140:143], v163 offset:11264
    ds_read_b128 v[156:159], v163 offset:15360
    ds_read_b128 v[96:99], v163 offset:0
    ds_read_b128 v[100:103], v163 offset:1024
    ds_read_b128 v[104:107], v163 offset:2048
    ds_read_b128 v[108:111], v163 offset:3072
    ds_read_b128 v[112:115], v163 offset:4096
    ds_read_b128 v[116:119], v163 offset:5120
    ds_read_b128 v[120:123], v163 offset:6144
    ds_read_b128 v[124:127], v163 offset:7168
    s_waitcnt lgkmcnt(14)
    v_mfma_f32_16x16x32_bf16 v[48:51], v[128:131], v[192:195], 0
    v_mfma_f32_16x16x32_bf16 v[52:55], v[128:131], v[208:211], 0
    v_mfma_f32_16x16x32_bf16 v[56:59], v[128:131], v[224:227], 0
    v_mfma_f32_16x16x32_bf16 v[60:63], v[128:131], v[240:243], 0
    v_mfma_f32_16x16x32_bf16 v[64:67], v[144:147], v[192:195], 0
    v_mfma_f32_16x16x32_bf16 v[68:71], v[144:147], v[208:211], 0
    v_mfma_f32_16x16x32_bf16 v[72:75], v[144:147], v[224:227], 0
    v_mfma_f32_16x16x32_bf16 v[76:79], v[144:147], v[240:243], 0
    s_setprio 2
aloopH_36_wm:
    ds_read_b32 v188, v164 offset:32
    s_waitcnt lgkmcnt(0)
    v_readfirstlane_b32 s19, v188
    s_cmp_ge_i32 s19, s16
    s_cbranch_scc1 aloopH_36_wmok
    s_sleep 1
    s_branch aloopH_36_wm
aloopH_36_wmok:
    s_add_u32 m0, s42, 16384
    s_add_u32 s17, s41, 4194304
    buffer_load_dwordx4 v0, s[4:7], s17 offen offset:0 sc1 lds
    buffer_load_dwordx4 v0, s[4:7], s17 offen offset:1024 sc1 lds
    buffer_load_dwordx4 v0, s[4:7], s17 offen offset:2048 sc1 lds
    buffer_load_dwordx4 v0, s[4:7], s17 offen offset:3072 sc1 lds
    s_add_u32 m0, s42, 20480
    s_add_u32 s17, s41, 4325376
    buffer_load_dwordx4 v0, s[4:7], s17 offen offset:0 sc1 lds
    buffer_load_dwordx4 v0, s[4:7], s17 offen offset:1024 sc1 lds
    buffer_load_dwordx4 v0, s[4:7], s17 offen offset:2048 sc1 lds
    buffer_load_dwordx4 v0, s[4:7], s17 offen offset:3072 sc1 lds
    s_add_u32 s41, s41, 262144
    s_barrier
    s_waitcnt lgkmcnt(12)
    v_mfma_f32_16x16x32_bf16 v[48:51], v[132:135], v[196:199], v[48:51]
    v_mfma_f32_16x16x32_bf16 v[52:55], v[132:135], v[212:215], v[52:55]
    v_mfma_f32_16x16x32_bf16 v[56:59], v[132:135], v[228:231], v[56:59]
    v_mfma_f32_16x16x32_bf16 v[60:63], v[132:135], v[244:247], v[60:63]
    v_mfma_f32_16x16x32_bf16 v[64:67], v[148:151], v[196:199], v[64:67]
    v_mfma_f32_16x16x32_bf16 v[68:71], v[148:151], v[212:215], v[68:71]
    v_mfma_f32_16x16x32_bf16 v[72:75], v[148:151], v[228:231], v[72:75]
    v_mfma_f32_16x16x32_bf16 v[76:79], v[148:151], v[244:247], v[76:79]
    s_waitcnt lgkmcnt(10)
    v_mfma_f32_16x16x32_bf16 v[48:51], v[136:139], v[200:203], v[48:51]
    v_mfma_f32_16x16x32_bf16 v[52:55], v[136:139], v[216:219], v[52:55]
    v_mfma_f32_16x16x32_bf16 v[56:59], v[136:139], v[232:235], v[56:59]
    v_mfma_f32_16x16x32_bf16 v[60:63], v[136:139], v[248:251], v[60:63]
    v_mfma_f32_16x16x32_bf16 v[64:67], v[152:155], v[200:203], v[64:67]
    v_mfma_f32_16x16x32_bf16 v[68:71], v[152:155], v[216:219], v[68:71]
    v_mfma_f32_16x16x32_bf16 v[72:75], v[152:155], v[232:235], v[72:75]
    v_mfma_f32_16x16x32_bf16 v[76:79], v[152:155], v[248:251], v[76:79]
    s_waitcnt lgkmcnt(8)
    v_mfma_f32_16x16x32_bf16 v[48:51], v[140:143], v[204:207], v[48:51]
    v_mfma_f32_16x16x32_bf16 v[52:55], v[140:143], v[220:223], v[52:55]
    v_mfma_f32_16x16x32_bf16 v[56:59], v[140:143], v[236:239], v[56:59]
    v_mfma_f32_16x16x32_bf16 v[60:63], v[140:143], v[252:255], v[60:63]
    v_mfma_f32_16x16x32_bf16 v[64:67], v[156:159], v[204:207], v[64:67]
    v_mfma_f32_16x16x32_bf16 v[68:71], v[156:159], v[220:223], v[68:71]
    v_mfma_f32_16x16x32_bf16 v[72:75], v[156:159], v[236:239], v[72:75]
    v_mfma_f32_16x16x32_bf16 v[76:79], v[156:159], v[252:255], v[76:79]
    s_nop 2
    v_cvt_pk_bf16_f32 v80, v48, v49
    v_cvt_pk_bf16_f32 v81, v50, v51
    v_cvt_pk_bf16_f32 v82, v64, v65
    v_cvt_pk_bf16_f32 v83, v66, v67
    v_cvt_pk_bf16_f32 v84, v52, v53
    v_cvt_pk_bf16_f32 v85, v54, v55
    v_cvt_pk_bf16_f32 v86, v68, v69
    v_cvt_pk_bf16_f32 v87, v70, v71
    v_cvt_pk_bf16_f32 v88, v56, v57
    v_cvt_pk_bf16_f32 v89, v58, v59
    v_cvt_pk_bf16_f32 v90, v72, v73
    v_cvt_pk_bf16_f32 v91, v74, v75
    v_cvt_pk_bf16_f32 v92, v60, v61
    v_cvt_pk_bf16_f32 v93, v62, v63
    v_cvt_pk_bf16_f32 v94, v76, v77
    v_cvt_pk_bf16_f32 v95, v78, v79
    v_mov_b32 v24, 0
    v_mov_b32 v25, 0
    v_mov_b32 v26, 0
    v_mov_b32 v27, 0
    v_mov_b32 v28, 0
    v_mov_b32 v29, 0
    v_mov_b32 v30, 0
    v_mov_b32 v31, 0
    v_mov_b32 v32, 0
    v_mov_b32 v33, 0
    v_mov_b32 v34, 0
    v_mov_b32 v35, 0
    v_mov_b32 v36, 0
    v_mov_b32 v37, 0
    v_mov_b32 v38, 0
    v_mov_b32 v39, 0
    s_waitcnt lgkmcnt(0)
    buffer_load_dwordx4 v[48:51], v0, s[4:7], s23 offen offset:0 sc1
    buffer_load_dwordx4 v[52:55], v0, s[4:7], s23 offen offset:1024 sc1
    buffer_load_dwordx4 v[56:59], v0, s[4:7], s23 offen offset:2048 sc1
    buffer_load_dwordx4 v[60:63], v0, s[4:7], s23 offen offset:3072 sc1
    s_sleep 2
    buffer_load_dwordx4 v[64:67], v0, s[4:7], s24 offen offset:0 sc1
    buffer_load_dwordx4 v[68:71], v0, s[4:7], s24 offen offset:1024 sc1
    s_waitcnt vmcnt(5)
    v_mfma_f32_16x16x32_bf16 v[12:15], v[96:99], v[48:51], 0
    v_mfma_f32_16x16x32_bf16 v[16:19], v[112:115], v[48:51], 0
    v_max_u32 v3, v48, v50
    v_cmp_eq_u32 vcc, -1, v3
    v_mfma_f32_16x16x32_bf16 v[20:23], v[48:51], v[48:51], 0
    s_cbranch_vccnz aloopH_36_rq_0
    s_waitcnt vmcnt(4)
    v_mfma_f32_16x16x32_bf16 v[12:15], v[100:103], v[52:55], v[12:15]
    v_mfma_f32_16x16x32_bf16 v[16:19], v[116:119], v[52:55], v[16:19]
    v_max_u32 v3, v52, v54
    v_cmp_eq_u32 vcc, -1, v3
    v_mfma_f32_16x16x32_bf16 v[20:23], v[52:55], v[52:55], v[20:23]
    s_cbranch_vccnz aloopH_36_rq_1
    s_waitcnt vmcnt(3)
    v_mfma_f32_16x16x32_bf16 v[12:15], v[104:107], v[56:59], v[12:15]
    v_mfma_f32_16x16x32_bf16 v[16:19], v[120:123], v[56:59], v[16:19]
    v_max_u32 v3, v56, v58
    v_cmp_eq_u32 vcc, -1, v3
    v_mfma_f32_16x16x32_bf16 v[20:23], v[56:59], v[56:59], v[20:23]
    s_cbranch_vccnz aloopH_36_rq_2
    s_waitcnt vmcnt(2)
    v_mfma_f32_16x16x32_bf16 v[12:15], v[108:111], v[60:63], v[12:15]
    v_mfma_f32_16x16x32_bf16 v[16:19], v[124:127], v[60:63], v[16:19]
    v_max_u32 v3, v60, v62
    v_cmp_eq_u32 vcc, -1, v3
    v_mfma_f32_16x16x32_bf16 v[20:23], v[60:63], v[60:63], v[20:23]
    s_cbranch_vccnz aloopH_36_rq_3
aloopH_36_sdone:
    s_cmp_eq_u32 s16, 63
    s_cbranch_scc1 aloopH_36_lsk
    ds_write_b32 v164, v165
    s_nop 0
    v_max3_f32 v2, v12, v13, v14
    v_max3_f32 v3, v15, v16, v17
    v_max3_f32 v2, v2, v18, v19
    v_max3_f32 v3, v3, v20, v21
    v_max_f32 v2, v2, v3
    v_mov_b32 v3, v2
    s_nop 1
    v_permlane16_swap_b32 v3, v2
    v_max_f32 v2, v2, v3
    v_mov_b32 v3, v2
    s_waitcnt vmcnt(0)
    v_max3_u32 v188, v64, v66, v68
    v_permlane32_swap_b32 v3, v2
    v_max_f32 v2, v2, v3
    v_max_u32 v188, v188, v70
    v_mul_f32 v2, s29, v2
    v_cmp_eq_u32 vcc, -1, v188
    v_fma_f32 v12, v12, s29, -v2
    v_fma_f32 v13, v13, s29, -v2
    s_cbranch_vccnz aloopH_36_rq_v
aloopH_36_vok:
    v_smfmac_f32_16x16x64_bf16 v[24:27], v[64:67], v[192:199], v166
    v_fma_f32 v14, v14, s29, -v2
    v_exp_f32 v12, v12
    v_smfmac_f32_16x16x64_bf16 v[32:35], v[64:67], v[224:231], v166
    v_fma_f32 v15, v15, s29, -v2
    v_exp_f32 v13, v13
    v_smfmac_f32_16x16x64_bf16 v[28:31], v[64:67], v[208:215], v166
    v_fma_f32 v16, v16, s29, -v2
    v_exp_f32 v14, v14
    v_smfmac_f32_16x16x64_bf16 v[36:39], v[64:67], v[240:247], v166
    v_fma_f32 v17, v17, s29, -v2
    v_exp_f32 v15, v15
    v_smfmac_f32_16x16x64_bf16 v[24:27], v[68:71], v[200:207], v166
    v_fma_f32 v18, v18, s29, -v2
    v_exp_f32 v16, v16
    v_smfmac_f32_16x16x64_bf16 v[32:35], v[68:71], v[232:239], v166
    v_fma_f32 v19, v19, s29, -v2
    v_exp_f32 v17, v17
    v_smfmac_f32_16x16x64_bf16 v[28:31], v[68:71], v[216:223], v166
    v_fma_f32 v20, v20, s29, -v2
    v_exp_f32 v18, v18
    v_smfmac_f32_16x16x64_bf16 v[36:39], v[68:71], v[248:255], v166
    v_fma_f32 v21, v21, s29, -v2
    v_exp_f32 v19, v19
    v_exp_f32 v20, v20
    v_exp_f32 v21, v21
    v_cvt_pk_bf16_f32 v12, v12, v13
    v_cvt_pk_bf16_f32 v13, v14, v15
    v_cvt_pk_bf16_f32 v14, v16, v17
    v_cvt_pk_bf16_f32 v15, v18, v19
    v_cvt_pk_bf16_f32 v20, v20, v21
    v_mov_b32 v22, 0
    v_mfma_f32_16x16x32_bf16 v[16:19], v[4:7], v[12:15], 0
    v_mov_b32 v21, v20
    v_mov_b32 v23, 0
    v_cvt_pk_bf16_f32 v40, v24, v25
    v_cvt_pk_bf16_f32 v41, v26, v27
    v_mfma_f32_16x16x32_bf16 v[16:19], v[8:11], v[20:23], v[16:19]
    v_mfma_f32_16x16x32_bf16 v[24:27], v[80:83], v[12:15], 0
    v_cvt_pk_bf16_f32 v44, v32, v33
    v_cvt_pk_bf16_f32 v45, v34, v35
    v_mfma_f32_16x16x32_bf16 v[32:35], v[88:91], v[12:15], 0
    v_cvt_pk_bf16_f32 v42, v28, v29
    v_cvt_pk_bf16_f32 v43, v30, v31
    v_mfma_f32_16x16x32_bf16 v[28:31], v[84:87], v[12:15], 0
    v_cvt_pk_bf16_f32 v46, v36, v37
    v_cvt_pk_bf16_f32 v47, v38, v39
    v_mfma_f32_16x16x32_bf16 v[36:39], v[92:95], v[12:15], 0
aloopH_36_midE:
    s_mov_b64 vcc, s[56:57]
    v_rcp_f32 v3, v16
    v_mfma_f32_16x16x32_bf16 v[24:27], v[40:43], v[20:23], v[24:27]
    v_mfma_f32_16x16x32_bf16 v[32:35], v[44:47], v[20:23], v[32:35]
    v_mfma_f32_16x16x32_bf16 v[28:31], v[42:45], v[20:23], v[28:31]
    v_mfma_f32_16x16x32_bf16 v[36:39], v[46:49], v[20:23], v[36:39]
    v_mov_b32_dpp v3, v3 quad_perm:[2,3,2,3] row_mask:0xf bank_mask:0xf
    s_nop 4
    v_cndmask_b32_dpp v24, v32, v24, vcc quad_perm:[2,3,2,3] row_mask:0xf bank_mask:0xf
    v_cndmask_b32_dpp v25, v33, v25, vcc quad_perm:[2,3,2,3] row_mask:0xf bank_mask:0xf
    v_cndmask_b32_dpp v26, v34, v26, vcc quad_perm:[2,3,2,3] row_mask:0xf bank_mask:0xf
    v_cndmask_b32_dpp v27, v35, v27, vcc quad_perm:[2,3,2,3] row_mask:0xf bank_mask:0xf
    v_cndmask_b32_dpp v28, v36, v28, vcc quad_perm:[2,3,2,3] row_mask:0xf bank_mask:0xf
    v_cndmask_b32_dpp v29, v37, v29, vcc quad_perm:[2,3,2,3] row_mask:0xf bank_mask:0xf
    v_cndmask_b32_dpp v30, v38, v30, vcc quad_perm:[2,3,2,3] row_mask:0xf bank_mask:0xf
    v_cndmask_b32_dpp v31, v39, v31, vcc quad_perm:[2,3,2,3] row_mask:0xf bank_mask:0xf
    v_mul_f32 v24, v24, v3
    v_mul_f32 v25, v25, v3
    v_mul_f32 v26, v26, v3
    v_mul_f32 v27, v27, v3
    v_mul_f32 v28, v28, v3
    v_mul_f32 v29, v29, v3
    v_mul_f32 v30, v30, v3
    v_mul_f32 v31, v31, v3
    v_cvt_pk_bf16_f32 v168, v24, v25
    v_cvt_pk_bf16_f32 v169, v26, v27
    v_cvt_pk_bf16_f32 v170, v28, v29
    v_cvt_pk_bf16_f32 v171, v30, v31
    ds_write_b128 v160, v[168:171]
    s_waitcnt lgkmcnt(0)
    s_barrier
    ds_read_b128 v[172:175], v161
    s_waitcnt lgkmcnt(0)
    v_mfma_f32_16x16x32_bf16 v[24:27], v[184:187], v[172:175], 0
    s_nop 7
    v_cvt_pk_bf16_f32 v168, v24, v25
    v_cvt_pk_bf16_f32 v169, v26, v27
    s_nop 0
    v_permlane16_swap_b32 v168, v170
    v_permlane16_swap_b32 v169, v171
    s_mov_b64 exec, 0xffff
    v_min_u32 v168, -2, v168
    buffer_store_dwordx4 v[168:171], v1, s[4:7], s25 offen sc1
    s_setprio 0
    buffer_store_dwordx4 v[176:179], v1, s[4:7], s26 offen sc1
    s_mov_b64 exec, -1
    s_cmp_lg_u32 s27, 0
    s_cbranch_scc1 pg_39
    s_sub_u32 s21, s16, 1
    s_cbranch_scc1 pg_39
    s_and_b32 s17, s21, 3
    s_cmp_ge_u32 s16, 58
    s_cselect_b32 s17, 0, s17
    s_cmp_lg_u32 s17, 0
    s_cbranch_scc1 pg_39
    v_mov_b32 v3, s21
    s_mov_b64 exec, 1
    buffer_store_dword v3, off, s[4:7], s28 sc1
    s_mov_b64 exec, -1
pg_39:
aloopH_36_lskb:
    v_mov_b32 v64, 0xff61b1e6
    ds_read_b128 v[128:131], v163 offset:16384
    ds_read_b128 v[132:135], v163 offset:17408
    ds_read_b128 v[136:139], v163 offset:18432
    ds_read_b128 v[140:143], v163 offset:19456
    ds_read_b128 v[144:147], v163 offset:20480
    ds_read_b128 v[148:151], v163 offset:21504
    ds_read_b128 v[152:155], v163 offset:22528
    ds_read_b128 v[156:159], v163 offset:23552
    s_waitcnt lgkmcnt(4)
    v_mfma_f32_16x16x32_bf16 v[12:15], v[96:99], v[128:131], 0
    v_mfma_f32_16x16x32_bf16 v[20:23], v[48:51], v[128:131], 0
    v_mfma_f32_16x16x32_bf16 v[12:15], v[100:103], v[132:135], v[12:15]
    v_mfma_f32_16x16x32_bf16 v[20:23], v[52:55], v[132:135], v[20:23]
    v_mfma_f32_16x16x32_bf16 v[12:15], v[104:107], v[136:139], v[12:15]
    v_mfma_f32_16x16x32_bf16 v[20:23], v[56:59], v[136:139], v[20:23]
    v_mfma_f32_16x16x32_bf16 v[12:15], v[108:111], v[140:143], v[12:15]
    v_mfma_f32_16x16x32_bf16 v[20:23], v[60:63], v[140:143], v[20:23]
    s_waitcnt lgkmcnt(0)
    v_mfma_f32_16x16x32_bf16 v[68:71], v[96:99], v[144:147], 0
    v_mfma_f32_16x16x32_bf16 v[72:75], v[112:115], v[144:147], 0
    v_mfma_f32_16x16x32_bf16 v[76:79], v[48:51], v[144:147], 0
    v_mfma_f32_16x16x32_bf16 v[68:71], v[100:103], v[148:151], v[68:71]
    v_mfma_f32_16x16x32_bf16 v[72:75], v[116:119], v[148:151], v[72:75]
    v_mfma_f32_16x16x32_bf16 v[76:79], v[52:55], v[148:151], v[76:79]
    v_mfma_f32_16x16x32_bf16 v[68:71], v[104:107], v[152:155], v[68:71]
    v_mfma_f32_16x16x32_bf16 v[72:75], v[120:123], v[152:155], v[72:75]
    v_mfma_f32_16x16x32_bf16 v[76:79], v[56:59], v[152:155], v[76:79]
    v_mfma_f32_16x16x32_bf16 v[68:71], v[108:111], v[156:159], v[68:71]
    v_mfma_f32_16x16x32_bf16 v[72:75], v[124:127], v[156:159], v[72:75]
    v_mfma_f32_16x16x32_bf16 v[76:79], v[60:63], v[156:159], v[76:79]
    v_cndmask_b32 v12, v12, v64, s[44:45]
    v_cndmask_b32 v13, v13, v64, s[46:47]
    v_cndmask_b32 v14, v14, v64, s[48:49]
    v_cndmask_b32 v15, v15, v64, s[50:51]
    v_max3_f32 v2, v12, v13, v14
    v_max3_f32 v3, v15, v20, v21
    v_max_f32 v2, v2, v3
    v_mov_b32 v3, v2
    s_nop 1
    v_permlane16_swap_b32 v3, v2
    v_max_f32 v2, v2, v3
    v_mov_b32 v3, v2
    s_nop 1
    v_permlane32_swap_b32 v3, v2
    v_max_f32 v2, v2, v3
    v_mul_f32 v2, s29, v2
    v_fma_f32 v12, v12, s29, -v2
    v_fma_f32 v13, v13, s29, -v2
    v_fma_f32 v14, v14, s29, -v2
    v_exp_f32 v12, v12
    v_fma_f32 v15, v15, s29, -v2
    v_exp_f32 v13, v13
    v_fma_f32 v20, v20, s29, -v2
    v_exp_f32 v14, v14
    v_fma_f32 v21, v21, s29, -v2
    v_exp_f32 v15, v15
    v_exp_f32 v20, v20
    v_exp_f32 v21, v21
    v_cvt_pk_bf16_f32 v12, v12, v13
    v_cvt_pk_bf16_f32 v13, v14, v15
    v_mov_b32 v14, 0
    v_mov_b32 v15, 0
    v_cvt_pk_bf16_f32 v20, v20, v21
    v_mov_b32 v22, 0
    v_mov_b32 v21, v20
    v_mov_b32 v23, 0
    s_nop 1
    v_cndmask_b32 v72, v72, v64, s[44:45]
    v_mfma_f32_16x16x32_bf16 v[16:19], v[4:7], v[12:15], 0
    v_cndmask_b32 v73, v73, v64, s[46:47]
    v_cndmask_b32 v74, v74, v64, s[48:49]
    v_mfma_f32_16x16x32_bf16 v[16:19], v[8:11], v[20:23], v[16:19]
    v_cndmask_b32 v75, v75, v64, s[50:51]
    v_max3_f32 v2, v68, v69, v70
    v_mfma_f32_16x16x32_bf16 v[24:27], v[80:83], v[12:15], 0
    v_max3_f32 v3, v71, v72, v73
    v_max3_f32 v2, v2, v74, v75
    v_mfma_f32_16x16x32_bf16 v[24:27], v[40:43], v[20:23], v[24:27]
    v_max3_f32 v3, v3, v76, v77
    v_max_f32 v2, v2, v3
    v_mfma_f32_16x16x32_bf16 v[28:31], v[84:87], v[12:15], 0
    v_mov_b32 v3, v2
    s_nop 1
    v_mfma_f32_16x16x32_bf16 v[28:31], v[42:45], v[20:23], v[28:31]
    v_permlane16_swap_b32 v3, v2
    v_max_f32 v2, v2, v3
    v_mfma_f32_16x16x32_bf16 v[32:35], v[88:91], v[12:15], 0
    v_mov_b32 v3, v2
    s_nop 1
    v_mfma_f32_16x16x32_bf16 v[32:35], v[44:47], v[20:23], v[32:35]
    v_permlane32_swap_b32 v3, v2
    v_max_f32 v2, v2, v3
    v_mfma_f32_16x16x32_bf16 v[36:39], v[92:95], v[12:15], 0
    v_mul_f32 v2, s29, v2
    v_fma_f32 v68, v68, s29, -v2
    v_mfma_f32_16x16x32_bf16 v[36:39], v[46:49], v[20:23], v[36:39]
    v_fma_f32 v69, v69, s29, -v2
    v_fma_f32 v70, v70, s29, -v2
    v_exp_f32 v68, v68
    v_fma_f32 v71, v71, s29, -v2
    v_exp_f32 v69, v69
    v_fma_f32 v72, v72, s29, -v2
    v_exp_f32 v70, v70
    v_fma_f32 v73, v73, s29, -v2
    v_exp_f32 v71, v71
    v_fma_f32 v74, v74, s29, -v2
    v_exp_f32 v72, v72
    v_fma_f32 v75, v75, s29, -v2
    v_exp_f32 v73, v73
    v_fma_f32 v76, v76, s29, -v2
    v_exp_f32 v74, v74
    v_fma_f32 v77, v77, s29, -v2
    v_exp_f32 v75, v75
    v_exp_f32 v76, v76
    v_exp_f32 v77, v77
    v_cvt_pk_bf16_f32 v68, v68, v69
    v_cvt_pk_bf16_f32 v69, v70, v71
    v_cvt_pk_bf16_f32 v70, v72, v73
    v_cvt_pk_bf16_f32 v71, v74, v75
    v_cvt_pk_bf16_f32 v76, v76, v77
    v_mov_b32 v78, 0
    v_mov_b32 v77, v76
    v_mov_b32 v79, 0
    v_rcp_f32 v66, v16
    s_nop 0
    v_mul_f32 v24, v24, v66
    v_mul_f32 v25, v25, v66
    v_mul_f32 v26, v26, v66
    v_mul_f32 v27, v27, v66
    v_cvt_pk_bf16_f32 v168, v24, v25
    v_cvt_pk_bf16_f32 v169, v26, v27
    v_mul_f32 v28, v28, v66
    v_mul_f32 v29, v29, v66
    v_mul_f32 v30, v30, v66
    v_mul_f32 v31, v31, v66
    v_cvt_pk_bf16_f32 v170, v28, v29
    v_cvt_pk_bf16_f32 v171, v30, v31
    v_mul_f32 v32, v32, v66
    v_mul_f32 v33, v33, v66
    v_mul_f32 v34, v34, v66
    v_mul_f32 v35, v35, v66
    v_cvt_pk_bf16_f32 v172, v32, v33
    v_cvt_pk_bf16_f32 v173, v34, v35
    v_mul_f32 v36, v36, v66
    v_mul_f32 v37, v37, v66
    v_mul_f32 v38, v38, v66
    v_mul_f32 v39, v39, v66
    v_cvt_pk_bf16_f32 v174, v36, v37
    v_cvt_pk_bf16_f32 v175, v38, v39
    ds_write_b128 v162, v[168:171] offset:0
    ds_write_b128 v162, v[172:175] offset:2048
    v_mfma_f32_16x16x32_bf16 v[72:75], v[4:7], v[68:71], 0
    v_mfma_f32_16x16x32_bf16 v[72:75], v[8:11], v[76:79], v[72:75]
    v_mfma_f32_16x16x32_bf16 v[24:27], v[80:83], v[68:71], 0
    v_mfma_f32_16x16x32_bf16 v[24:27], v[40:43], v[76:79], v[24:27]
    v_mfma_f32_16x16x32_bf16 v[28:31], v[84:87], v[68:71], 0
    v_mfma_f32_16x16x32_bf16 v[28:31], v[42:45], v[76:79], v[28:31]
    v_mfma_f32_16x16x32_bf16 v[32:35], v[88:91], v[68:71], 0
    v_mfma_f32_16x16x32_bf16 v[32:35], v[44:47], v[76:79], v[32:35]
    v_mfma_f32_16x16x32_bf16 v[36:39], v[92:95], v[68:71], 0
    v_mfma_f32_16x16x32_bf16 v[36:39], v[46:49], v[76:79], v[36:39]
    v_rcp_f32 v3, v72
    s_nop 0
    v_mul_f32 v24, v24, v3
    v_mul_f32 v25, v25, v3
    v_mul_f32 v26, v26, v3
    v_mul_f32 v27, v27, v3
    v_cvt_pk_bf16_f32 v168, v24, v25
    v_cvt_pk_bf16_f32 v169, v26, v27
    v_mul_f32 v28, v28, v3
    v_mul_f32 v29, v29, v3
    v_mul_f32 v30, v30, v3
    v_mul_f32 v31, v31, v3
    v_cvt_pk_bf16_f32 v170, v28, v29
    v_cvt_pk_bf16_f32 v171, v30, v31
    v_mul_f32 v32, v32, v3
    v_mul_f32 v33, v33, v3
    v_mul_f32 v34, v34, v3
    v_mul_f32 v35, v35, v3
    v_cvt_pk_bf16_f32 v172, v32, v33
    v_cvt_pk_bf16_f32 v173, v34, v35
    v_mul_f32 v36, v36, v3
    v_mul_f32 v37, v37, v3
    v_mul_f32 v38, v38, v3
    v_mul_f32 v39, v39, v3
    v_cvt_pk_bf16_f32 v174, v36, v37
    v_cvt_pk_bf16_f32 v175, v38, v39
    ds_write_b128 v162, v[168:171] offset:256
    ds_write_b128 v162, v[172:175] offset:2304
    v_xor_b32 v162, 0x4000, v162
    s_add_u32 s16, s16, 1
    s_cmp_le_u32 s16, 63
    s_cbranch_scc1 aloopH_36
    s_waitcnt lgkmcnt(0)
    s_barrier
    s_waitcnt vmcnt(0)
    s_branch k_end
aloopH_36_rq_0:
    s_sub_u32 s22, s22, 1
    s_cbranch_scc1 aloopH_36_rq_0_g
    buffer_load_dwordx4 v[48:51], v0, s[4:7], s23 offen offset:0 sc1
    buffer_load_dwordx4 v[52:55], v0, s[4:7], s23 offen offset:1024 sc1
    buffer_load_dwordx4 v[56:59], v0, s[4:7], s23 offen offset:2048 sc1
    buffer_load_dwordx4 v[60:63], v0, s[4:7], s23 offen offset:3072 sc1
    buffer_load_dwordx4 v[64:67], v0, s[4:7], s24 offen offset:0 sc1
    buffer_load_dwordx4 v[68:71], v0, s[4:7], s24 offen offset:1024 sc1
    s_waitcnt vmcnt(5)
    v_max_u32 v3, v48, v50
    v_cmp_eq_u32 vcc, -1, v3
    s_cbranch_vccnz aloopH_36_rq_0
    s_branch aloopH_36_again
aloopH_36_rq_0_g:
    s_mov_b32 s22, 0
    s_waitcnt vmcnt(0)
    s_branch aloopH_36_nochk
aloopH_36_rq_1:
    s_sub_u32 s22, s22, 1
    s_cbranch_scc1 aloopH_36_rq_1_g
    buffer_load_dwordx4 v[52:55], v0, s[4:7], s23 offen offset:1024 sc1
    buffer_load_dwordx4 v[56:59], v0, s[4:7], s23 offen offset:2048 sc1
    buffer_load_dwordx4 v[60:63], v0, s[4:7], s23 offen offset:3072 sc1
    buffer_load_dwordx4 v[64:67], v0, s[4:7], s24 offen offset:0 sc1
    buffer_load_dwordx4 v[68:71], v0, s[4:7], s24 offen offset:1024 sc1
    s_waitcnt vmcnt(4)
    v_max_u32 v3, v52, v54
    v_cmp_eq_u32 vcc, -1, v3
    s_cbranch_vccnz aloopH_36_rq_1
    s_branch aloopH_36_again
aloopH_36_rq_1_g:
    s_mov_b32 s22, 0
    s_waitcnt vmcnt(0)
    s_branch aloopH_36_nochk
aloopH_36_rq_2:
    s_sub_u32 s22, s22, 1
    s_cbranch_scc1 aloopH_36_rq_2_g
    buffer_load_dwordx4 v[56:59], v0, s[4:7], s23 offen offset:2048 sc1
    buffer_load_dwordx4 v[60:63], v0, s[4:7], s23 offen offset:3072 sc1
    buffer_load_dwordx4 v[64:67], v0, s[4:7], s24 offen offset:0 sc1
    buffer_load_dwordx4 v[68:71], v0, s[4:7], s24 offen offset:1024 sc1
    s_waitcnt vmcnt(3)
    v_max_u32 v3, v56, v58
    v_cmp_eq_u32 vcc, -1, v3
    s_cbranch_vccnz aloopH_36_rq_2
    s_branch aloopH_36_again
aloopH_36_rq_2_g:
    s_mov_b32 s22, 0
    s_waitcnt vmcnt(0)
    s_branch aloopH_36_nochk
aloopH_36_rq_3:
    s_sub_u32 s22, s22, 1
    s_cbranch_scc1 aloopH_36_rq_3_g
    buffer_load_dwordx4 v[60:63], v0, s[4:7], s23 offen offset:3072 sc1
    buffer_load_dwordx4 v[64:67], v0, s[4:7], s24 offen offset:0 sc1
    buffer_load_dwordx4 v[68:71], v0, s[4:7], s24 offen offset:1024 sc1
    s_waitcnt vmcnt(2)
    v_max_u32 v3, v60, v62
    v_cmp_eq_u32 vcc, -1, v3
    s_cbranch_vccnz aloopH_36_rq_3
    s_branch aloopH_36_again
aloopH_36_rq_3_g:
    s_mov_b32 s22, 0
    s_waitcnt vmcnt(0)
    s_branch aloopH_36_nochk
aloopH_36_again:
    s_waitcnt vmcnt(5)
    v_mfma_f32_16x16x32_bf16 v[12:15], v[96:99], v[48:51], 0
    v_mfma_f32_16x16x32_bf16 v[16:19], v[112:115], v[48:51], 0
    v_max_u32 v3, v48, v50
    v_cmp_eq_u32 vcc, -1, v3
    v_mfma_f32_16x16x32_bf16 v[20:23], v[48:51], v[48:51], 0
    s_cbranch_vccnz aloopH_36_rq_0
    s_waitcnt vmcnt(4)
    v_mfma_f32_16x16x32_bf16 v[12:15], v[100:103], v[52:55], v[12:15]
    v_mfma_f32_16x16x32_bf16 v[16:19], v[116:119], v[52:55], v[16:19]
    v_max_u32 v3, v52, v54
    v_cmp_eq_u32 vcc, -1, v3
    v_mfma_f32_16x16x32_bf16 v[20:23], v[52:55], v[52:55], v[20:23]
    s_cbranch_vccnz aloopH_36_rq_1
    s_waitcnt vmcnt(3)
    v_mfma_f32_16x16x32_bf16 v[12:15], v[104:107], v[56:59], v[12:15]
    v_mfma_f32_16x16x32_bf16 v[16:19], v[120:123], v[56:59], v[16:19]
    v_max_u32 v3, v56, v58
    v_cmp_eq_u32 vcc, -1, v3
    v_mfma_f32_16x16x32_bf16 v[20:23], v[56:59], v[56:59], v[20:23]
    s_cbranch_vccnz aloopH_36_rq_2
    s_waitcnt vmcnt(2)
    v_mfma_f32_16x16x32_bf16 v[12:15], v[108:111], v[60:63], v[12:15]
    v_mfma_f32_16x16x32_bf16 v[16:19], v[124:127], v[60:63], v[16:19]
    v_max_u32 v3, v60, v62
    v_cmp_eq_u32 vcc, -1, v3
    v_mfma_f32_16x16x32_bf16 v[20:23], v[60:63], v[60:63], v[20:23]
    s_cbranch_vccnz aloopH_36_rq_3
    s_branch aloopH_36_sdone
aloopH_36_rq_v:
    s_sub_u32 s22, s22, 1
    s_cbranch_scc1 aloopH_36_rq_vg
    buffer_load_dwordx4 v[64:67], v0, s[4:7], s24 offen offset:0 sc1
    buffer_load_dwordx4 v[68:71], v0, s[4:7], s24 offen offset:1024 sc1
    s_waitcnt vmcnt(0)
    v_max3_u32 v188, v64, v66, v68
    v_max_u32 v188, v188, v70
    v_cmp_eq_u32 vcc, -1, v188
    s_cbranch_vccnz aloopH_36_rq_v
    s_branch aloopH_36_vok
aloopH_36_rq_vg:
    s_mov_b32 s22, 0
    s_branch aloopH_36_vok
aloopH_36_nochk:
    v_mfma_f32_16x16x32_bf16 v[12:15], v[96:99], v[48:51], 0
    v_mfma_f32_16x16x32_bf16 v[16:19], v[112:115], v[48:51], 0
    v_mfma_f32_16x16x32_bf16 v[20:23], v[48:51], v[48:51], 0
    v_mfma_f32_16x16x32_bf16 v[12:15], v[100:103], v[52:55], v[12:15]
    v_mfma_f32_16x16x32_bf16 v[16:19], v[116:119], v[52:55], v[16:19]
    v_mfma_f32_16x16x32_bf16 v[20:23], v[52:55], v[52:55], v[20:23]
    v_mfma_f32_16x16x32_bf16 v[12:15], v[104:107], v[56:59], v[12:15]
    v_mfma_f32_16x16x32_bf16 v[16:19], v[120:123], v[56:59], v[16:19]
    v_mfma_f32_16x16x32_bf16 v[20:23], v[56:59], v[56:59], v[20:23]
    v_mfma_f32_16x16x32_bf16 v[12:15], v[108:111], v[60:63], v[12:15]
    v_mfma_f32_16x16x32_bf16 v[16:19], v[124:127], v[60:63], v[16:19]
    v_mfma_f32_16x16x32_bf16 v[20:23], v[60:63], v[60:63], v[20:23]
    s_nop 1
    s_branch aloopH_36_sdone
aloopH_36_rq_v2:
    s_sub_u32 s22, s22, 1
    s_cbranch_scc1 aloopH_36_rq_v2g
    buffer_load_dwordx4 v[64:67], v0, s[4:7], s24 offen offset:0 sc1
    buffer_load_dwordx4 v[68:71], v0, s[4:7], s24 offen offset:1024 sc1
    s_waitcnt vmcnt(0)
    v_max3_u32 v188, v64, v66, v68
    v_max_u32 v188, v188, v70
    v_cmp_eq_u32 vcc, -1, v188
    s_cbranch_vccnz aloopH_36_rq_v2
    s_branch aloopH_36_lsk3
aloopH_36_rq_v2g:
    s_mov_b32 s22, 0
    s_branch aloopH_36_lsk3
aloopH_36_lsk:
    s_cmp_lg_u32 s27, 0
    s_cbranch_scc1 aloopH_36_lsk2
    v_mov_b32 v3, 62
    s_mov_b64 exec, 1
    buffer_store_dword v3, off, s[4:7], s28 sc1
    s_mov_b64 exec, -1
aloopH_36_lsk2:
    s_waitcnt vmcnt(0)
    v_max3_u32 v188, v64, v66, v68
    v_max_u32 v188, v188, v70
    v_cmp_eq_u32 vcc, -1, v188
    s_cbranch_vccnz aloopH_36_rq_v2
aloopH_36_lsk3:
    v_smfmac_f32_16x16x64_bf16 v[24:27], v[64:67], v[192:199], v166
    v_smfmac_f32_16x16x64_bf16 v[32:35], v[64:67], v[224:231], v166
    v_smfmac_f32_16x16x64_bf16 v[28:31], v[64:67], v[208:215], v166
    v_smfmac_f32_16x16x64_bf16 v[36:39], v[64:67], v[240:247], v166
    v_smfmac_f32_16x16x64_bf16 v[24:27], v[68:71], v[200:207], v166
    v_smfmac_f32_16x16x64_bf16 v[32:35], v[68:71], v[232:239], v166
    v_smfmac_f32_16x16x64_bf16 v[28:31], v[68:71], v[216:223], v166
    v_smfmac_f32_16x16x64_bf16 v[36:39], v[68:71], v[248:255], v166
    s_nop 7
    s_nop 1
    v_cvt_pk_bf16_f32 v40, v24, v25
    v_cvt_pk_bf16_f32 v41, v26, v27
    v_cvt_pk_bf16_f32 v42, v28, v29
    v_cvt_pk_bf16_f32 v43, v30, v31
    v_cvt_pk_bf16_f32 v44, v32, v33
    v_cvt_pk_bf16_f32 v45, v34, v35
    v_cvt_pk_bf16_f32 v46, v36, v37
    v_cvt_pk_bf16_f32 v47, v38, v39
    s_waitcnt lgkmcnt(0)
    s_branch aloopH_36_lskb
k_end:
k_exit:
    s_endpgm
.section .rodata,"a"
.p2align 6
jobtab:
    .long 4, 24, 24, 8192, 0, 262144, 8388608, 0, 32768, 4, 20971520, 131072, 0, 0, 218104321, 0
    .long 4, 24, 24, 8192, 256, 262400, 8388608, 0, 32768, 4, 20975616, 131072, 0, 0, 218104321, 0
    .long 4, 24, 24, 8192, 512, 262656, 8388608, 0, 32768, 4, 20979712, 131072, 0, 0, 218104321, 0
    .long 4, 24, 24, 8192, 768, 262912, 8388608, 0, 32768, 4, 20983808, 131072, 0, 0, 218104321, 0
    .long 4, 24, 24, 8192, 1024, 263168, 8388608, 0, 32768, 4, 20987904, 131072, 0, 0, 218104337, 0
    .long 4, 24, 24, 8192, 1280, 263424, 8388608, 0, 32768, 4, 20992000, 131072, 0, 0, 218104337, 0
    .long 4, 24, 24, 8192, 1536, 263680, 8388608, 0, 32768, 4, 20996096, 131072, 0, 0, 218104337, 0
    .long 4, 24, 24, 8192, 1792, 263936, 8388608, 0, 32768, 4, 21000192, 131072, 0, 0, 218104337, 0
    .long 4, 32, 32, 8192, 0, 262144, 8388608, 0, 32768, 4, 37748736, 131072, 0, 0, 218104321, 0
    .long 4, 32, 32, 8192, 256, 262400, 8388608, 0, 32768, 4, 37752832, 131072, 0, 0, 218104321, 0
    .long 4, 32, 32, 8192, 512, 262656, 8388608, 0, 32768, 4, 37756928, 131072, 0, 0, 218104321, 0
    .long 4, 32, 32, 8192, 768, 262912, 8388608, 0, 32768, 4, 37761024, 131072, 0, 0, 218104321, 0
    .long 4, 32, 32, 8192, 1024, 263168, 8388608, 0, 32768, 4, 37765120, 131072, 0, 0, 218104337, 0
    .long 4, 32, 32, 8192, 1280, 263424, 8388608, 0, 32768, 4, 37769216, 131072, 0, 0, 218104337, 0
    .long 4, 32, 32, 8192, 1536, 263680, 8388608, 0, 32768, 4, 37773312, 131072, 0, 0, 218104337, 0
    .long 4, 32, 32, 8192, 1792, 263936, 8388608, 0, 32768, 4, 37777408, 131072, 0, 0, 218104337, 0
    .long 4, 24, 24, 8192, 0, 262144, 8388608, 262144, 32768, 4, 22020096, 131072, 0, 0, 218104324, 0
    .long 4, 24, 24, 8192, 256, 262400, 8388608, 262144, 32768, 4, 22024192, 131072, 0, 0, 218104324, 0
    .long 4, 24, 24, 8192, 512, 262656, 8388608, 262144, 32768, 4, 22028288, 131072, 0, 0, 218104324, 0
    .long 4, 24, 24, 8192, 768, 262912, 8388608, 262144, 32768, 4, 22032384, 131072, 0, 0, 218104324, 0
    .long 4, 24, 24, 8192, 1024, 263168, 8388608, 262144, 32768, 4, 22036480, 131072, 0, 0, 218104340, 0
    .long 4, 24, 24, 8192, 1280, 263424, 8388608, 262144, 32768, 4, 22040576, 131072, 0, 0, 218104340, 0
    .long 4, 24, 24, 8192, 1536, 263680, 8388608, 262144, 32768, 4, 22044672, 131072, 0, 0, 218104340, 0
    .long 4, 24, 24, 8192, 1792, 263936, 8388608, 262144, 32768, 4, 22048768, 131072, 0, 0, 218104340, 0
    .long 4, 32, 32, 8192, 0, 262144, 8388608, 262144, 32768, 4, 38797312, 131072, 0, 0, 218104324, 0
    .long 4, 32, 32, 8192, 256, 262400, 8388608, 262144, 32768, 4, 38801408, 131072, 0, 0, 218104324, 0
    .long 4, 32, 32, 8192, 512, 262656, 8388608, 262144, 32768, 4, 38805504, 131072, 0, 0, 218104324, 0
    .long 4, 32, 32, 8192, 768, 262912, 8388608, 262144, 32768, 4, 38809600, 131072, 0, 0, 218104324, 0
    .long 4, 32, 32, 8192, 1024, 263168, 8388608, 262144, 32768, 4, 38813696, 131072, 0, 0, 218104340, 0
    .long 4, 32, 32, 8192, 1280, 263424, 8388608, 262144, 32768, 4, 38817792, 131072, 0, 0, 218104340, 0
    .long 4, 32, 32, 8192, 1536, 263680, 8388608, 262144, 32768, 4, 38821888, 131072, 0, 0, 218104340, 0
    .long 4, 32, 32, 8192, 1792, 263936, 8388608, 262144, 32768, 4, 38825984, 131072, 0, 0, 218104340, 0
    .long 4, 32, 32, 8192, 1024, 263168, 8388608, 524288, 32768, 4, 39862272, 131072, 0, 0, 218104593, 0
    .long 4, 32, 32, 8192, 768, 262912, 8388608, 524288, 32768, 4, 39858176, 131072, 0, 0, 218104577, 0
    .long 4, 32, 32, 8192, 1536, 263680, 8388608, 786432, 32768, 4, 40919040, 131072, 0, 0, 218104596, 0
    .long 4, 24, 24, 8192, 1536, 263680, 8388608, 524288, 32768, 4, 23093248, 131072, 0, 0, 218104593, 0
    .long 4, 32, 32, 8192, 1024, 263168, 8388608, 786432, 32768, 4, 40910848, 131072, 0, 0, 218104596, 0
    .long 4, 32, 32, 8192, 512, 262656, 8388608, 786432, 32768, 4, 40902656, 131072, 0, 0, 218104580, 0
    .long 4, 32, 32, 8192, 0, 262144, 8388608, 524288, 32768, 4, 39845888, 131072, 0, 0, 218104577, 0
    .long 4, 24, 24, 8192, 1024, 263168, 8388608, 786432, 32768, 4, 24133632, 131072, 0, 0, 218104596, 0
    .long 4, 24, 24, 8192, 0, 262144, 8388608, 524288, 32768, 4, 23068672, 131072, 0, 0, 218104577, 0
    .long 4, 32, 32, 8192, 1280, 263424, 8388608, 786432, 32768, 4, 40914944, 131072, 0, 0, 218104596, 0
    .long 4, 24, 24, 8192, 768, 262912, 8388608, 786432, 32768, 4, 24129536, 131072, 0, 0, 218104580, 0
    .long 4, 24, 24, 8192, 256, 262400, 8388608, 524288, 32768, 4, 23072768, 131072, 0, 0, 218104577, 0
    .long 4, 32, 32, 8192, 768, 262912, 8388608, 786432, 32768, 4, 40906752, 131072, 0, 0, 218104580, 0
    .long 4, 24, 24, 8192, 1280, 263424, 8388608, 524288, 32768, 4, 23089152, 131072, 0, 0, 218104593, 0
    .long 4, 24, 24, 8192, 1536, 263680, 8388608, 786432, 32768, 4, 24141824, 131072, 0, 0, 218104596, 0
    .long 4, 24, 24, 8192, 1792, 263936, 8388608, 524288, 32768, 4, 23097344, 131072, 0, 0, 218104593, 0
    .long 4, 32, 32, 8192, 512, 262656, 8388608, 524288, 32768, 4, 39854080, 131072, 0, 0, 218104577, 0
    .long 4, 32, 32, 8192, 1792, 263936, 8388608, 524288, 32768, 4, 39874560, 131072, 0, 0, 218104593, 0
    .long 4, 24, 24, 8192, 1280, 263424, 8388608, 786432, 32768, 4, 24137728, 131072, 0, 0, 218104596, 0
    .long 4, 32, 32, 8192, 256, 262400, 8388608, 524288, 32768, 4, 39849984, 131072, 0, 0, 218104577, 0
    .long 4, 32, 32, 8192, 0, 262144, 8388608, 786432, 32768, 4, 40894464, 131072, 0, 0, 218104580, 0
    .long 4, 24, 24, 8192, 256, 262400, 8388608, 786432, 32768, 4, 24121344, 131072, 0, 0, 218104580, 0
    .long 4, 32, 32, 8192, 1280, 263424, 8388608, 524288, 32768, 4, 39866368, 131072, 0, 0, 218104593, 0
    .long 4, 24, 24, 8192, 512, 262656, 8388608, 786432, 32768, 4, 24125440, 131072, 0, 0, 218104580, 0
    .long 4, 24, 24, 8192, 0, 262144, 8388608, 786432, 32768, 4, 24117248, 131072, 0, 0, 218104580, 0
    .long 4, 24, 24, 8192, 512, 262656, 8388608, 524288, 32768, 4, 23076864, 131072, 0, 0, 218104577, 0
    .long 4, 24, 24, 8192, 768, 262912, 8388608, 524288, 32768, 4, 23080960, 131072, 0, 0, 218104577, 0
    .long 2, 64, 72, 7168, 512, 512, 7340032, 1572864, 32768, 8, 60039168, 114688, 0, 0, 218104001, 0
    .long 4, 32, 32, 8192, 1536, 263680, 8388608, 524288, 32768, 4, 39870464, 131072, 0, 0, 218104593, 0
    .long 4, 24, 24, 8192, 1792, 263936, 8388608, 786432, 32768, 4, 24145920, 131072, 0, 0, 218104596, 0
    .long 4, 32, 32, 8192, 1792, 263936, 8388608, 786432, 32768, 4, 40923136, 131072, 0, 0, 218104596, 0
    .long 4, 24, 24, 8192, 1024, 263168, 8388608, 524288, 32768, 4, 23085056, 131072, 0, 0, 218104593, 0
    .long 1, 16, 16, 8192, 1536, 1792, 8388608, 1048576, 32768, 8, 8413184, 131072, 0, 0, 218104858, 0
    .long 1, 24, 24, 8192, 0, 256, 8388608, 1048576, 32768, 8, 25165824, 131072, 0, 0, 218104842, 0
    .long 1, 16, 16, 8192, 512, 768, 8388608, 1048576, 32768, 8, 8396800, 131072, 0, 0, 218104842, 0
    .long 1, 32, 32, 8192, 1536, 1792, 8388608, 1048576, 32768, 8, 41967616, 131072, 0, 0, 218104858, 0
    .long 1, 32, 32, 8192, 512, 768, 8388608, 1048576, 32768, 8, 41951232, 131072, 0, 0, 218104842, 0
    .long 1, 16, 16, 8192, 1024, 1280, 8388608, 1048576, 32768, 8, 8404992, 131072, 0, 0, 218104858, 0
    .long 1, 24, 24, 8192, 1024, 1280, 8388608, 1048576, 32768, 8, 25182208, 131072, 0, 0, 218104858, 0
    .long 1, 24, 24, 8192, 0, 256, 8388608, 1572864, 32768, 8, 27262976, 131072, 0, 0, 218105098, 0
    .long 1, 32, 32, 8192, 512, 768, 8388608, 1572864, 32768, 8, 44048384, 131072, 0, 0, 218105098, 0
    .long 1, 16, 16, 8192, 1536, 1792, 8388608, 1572864, 32768, 8, 10510336, 131072, 0, 0, 218105114, 0
    .long 1, 24, 24, 8192, 512, 768, 8388608, 1048576, 32768, 8, 25174016, 131072, 0, 0, 218104842, 0
    .long 1, 32, 32, 8192, 0, 256, 8388608, 1048576, 32768, 8, 41943040, 131072, 0, 0, 218104842, 0
    .long 4, 32, 32, 8192, 256, 262400, 8388608, 786432, 32768, 4, 40898560, 131072, 0, 0, 218104580, 0
    .long 1, 16, 16, 8192, 1536, 1792, 8388608, 2097152, 32768, 8, 12607488, 131072, 0, 0, 218105370, 0
    .long 1, 32, 32, 8192, 1024, 1280, 8388608, 1048576, 32768, 8, 41959424, 131072, 0, 0, 218104858, 0
    .long 1, 32, 32, 8192, 1024, 1280, 8388608, 1572864, 32768, 8, 44056576, 131072, 0, 0, 218105114, 0
    .long 1, 16, 16, 8192, 0, 256, 8388608, 1048576, 32768, 8, 8388608, 131072, 0, 0, 218104842, 0
    .long 1, 24, 24, 8192, 1536, 1792, 8388608, 1048576, 32768, 8, 25190400, 131072, 0, 0, 218104858, 0
    .long 1, 24, 24, 8192, 512, 768, 8388608, 2097152, 32768, 8, 29368320, 131072, 0, 0, 218105354, 0
    .long 1, 16, 16, 8192, 1024, 1280, 8388608, 2097152, 32768, 8, 12599296, 131072, 0, 0, 218105370, 0
    .long 1, 16, 16, 8192, 0, 256, 8388608, 1572864, 32768, 8, 10485760, 131072, 0, 0, 218105098, 0
    .long 1, 32, 32, 8192, 512, 768, 8388608, 2097152, 32768, 8, 46145536, 131072, 0, 0, 218105354, 0
    .long 1, 16, 16, 8192, 1024, 1280, 8388608, 1572864, 32768, 8, 10502144, 131072, 0, 0, 218105114, 0
    .long 1, 24, 24, 8192, 1536, 1792, 8388608, 1572864, 32768, 8, 27287552, 131072, 0, 0, 218105114, 0
    .long 1, 32, 32, 8192, 1536, 1792, 8388608, 1572864, 32768, 8, 44064768, 131072, 0, 0, 218105114, 0
    .long 1, 24, 24, 8192, 512, 768, 8388608, 1572864, 32768, 8, 27271168, 131072, 0, 0, 218105098, 0
    .long 1, 32, 32, 8192, 0, 256, 8388608, 2097152, 32768, 8, 46137344, 131072, 0, 0, 218105354, 0
    .long 1, 16, 16, 8192, 512, 768, 8388608, 1572864, 32768, 8, 10493952, 131072, 0, 0, 218105098, 0
    .long 1, 32, 32, 8192, 0, 256, 8388608, 1572864, 32768, 8, 44040192, 131072, 0, 0, 218105098, 0
    .long 1, 24, 24, 8192, 1024, 1280, 8388608, 1572864, 32768, 8, 27279360, 131072, 0, 0, 218105114, 0
    .long 1, 24, 24, 8192, 1024, 1280, 8388608, 2097152, 32768, 8, 29376512, 131072, 0, 0, 218105370, 0
    .long 1, 16, 16, 8192, 1024, 1280, 8388608, 2621440, 32768, 8, 14696448, 131072, 0, 0, 218105626, 0
    .long 2, 64, 72, 7168, 0, 0, 7340032, 1572864, 32768, 8, 60030976, 114688, 0, 0, 218104001, 0
    .long 1, 32, 32, 8192, 1024, 1280, 8388608, 2097152, 32768, 8, 46153728, 131072, 0, 0, 218105370, 0
    .long 1, 24, 24, 8192, 1536, 1792, 8388608, 2097152, 32768, 8, 29384704, 131072, 0, 0, 218105370, 0
    .long 2, 64, 72, 7168, 1024, 1024, 7340032, 3145728, 32768, 8, 65552384, 114688, 0, 0, 218104193, 0
    .long 1, 16, 16, 8192, 512, 768, 8388608, 2097152, 32768, 8, 12591104, 131072, 0, 0, 218105354, 0
    .long 1, 24, 24, 8192, 0, 256, 8388608, 2621440, 32768, 8, 31457280, 131072, 0, 0, 218105610, 0
    .long 2, 64, 72, 7168, 1280, 1280, 7340032, 2621440, 32768, 8, 63721472, 114688, 0, 0, 218104129, 0
    .long 1, 24, 24, 8192, 0, 256, 8388608, 3670016, 32768, 8, 35651584, 131072, 0, 0, 218106122, 0
    .long 1, 16, 16, 8192, 512, 768, 8388608, 524288, 32768, 8, 6299648, 131072, 0, 0, 218108170, 0
    .long 1, 32, 32, 8192, 1024, 1280, 8388608, 3145728, 32768, 8, 50348032, 131072, 0, 0, 218105882, 0
    .long 2, 64, 72, 7168, 0, 0, 7340032, 3145728, 32768, 8, 65536000, 114688, 0, 0, 218104193, 0
    .long 1, 24, 24, 8192, 512, 768, 8388608, 2621440, 32768, 8, 31465472, 131072, 0, 0, 218105610, 0
    .long 1, 16, 16, 8192, 512, 768, 8388608, 3670016, 32768, 8, 18882560, 131072, 0, 0, 218106122, 0
    .long 2, 64, 72, 7168, 1024, 1024, 7340032, 2621440, 32768, 8, 63717376, 114688, 0, 0, 218104129, 0
    .long 1, 24, 24, 8192, 1536, 1792, 8388608, 2621440, 32768, 8, 31481856, 131072, 0, 0, 218105626, 0
    .long 1, 24, 24, 8192, 0, 256, 8388608, 2097152, 32768, 8, 29360128, 131072, 0, 0, 218105354, 0
    .long 1, 24, 24, 8192, 512, 768, 8388608, 3145728, 32768, 8, 33562624, 131072, 0, 0, 218105866, 0
    .long 1, 32, 32, 8192, 1536, 1792, 8388608, 2097152, 32768, 8, 46161920, 131072, 0, 0, 218105370, 0
    .long 1, 32, 32, 8192, 1024, 1280, 8388608, 2621440, 32768, 8, 48250880, 131072, 0, 0, 218105626, 0
    .long 2, 64, 72, 7168, 1280, 1280, 7340032, 3670016, 32768, 8, 67391488, 114688, 0, 0, 218104257, 0
    .long 1, 32, 32, 8192, 1536, 1792, 8388608, 3145728, 32768, 8, 50356224, 131072, 0, 0, 218105882, 0
    .long 1, 16, 16, 8192, 0, 256, 8388608, 2621440, 32768, 8, 14680064, 131072, 0, 0, 218105610, 0
    .long 1, 32, 32, 8192, 1536, 1792, 8388608, 2621440, 32768, 8, 48259072, 131072, 0, 0, 218105626, 0
    .long 2, 64, 72, 7168, 0, 0, 7340032, 524288, 32768, 8, 56360960, 114688, 0, 0, 218103873, 0
    .long 1, 16, 16, 8192, 512, 768, 8388608, 2621440, 32768, 8, 14688256, 131072, 0, 0, 218105610, 0
    .long 2, 64, 72, 7168, 512, 512, 7340032, 2097152, 32768, 8, 61874176, 114688, 0, 0, 218104065, 0
    .long 1, 16, 16, 8192, 0, 256, 8388608, 3145728, 32768, 8, 16777216, 131072, 0, 0, 218105866, 0
    .long 1, 24, 24, 8192, 1536, 1792, 8388608, 3145728, 32768, 8, 33579008, 131072, 0, 0, 218105882, 0
    .long 1, 16, 16, 8192, 0, 256, 8388608, 2097152, 32768, 8, 12582912, 131072, 0, 0, 218105354, 0
    .long 2, 64, 72, 7168, 0, 0, 7340032, 2097152, 32768, 8, 61865984, 114688, 0, 0, 218104065, 0
    .long 1, 16, 16, 8192, 0, 256, 8388608, 524288, 32768, 8, 6291456, 131072, 0, 0, 218108170, 0
    .long 1, 32, 32, 8192, 512, 768, 8388608, 2621440, 32768, 8, 48242688, 131072, 0, 0, 218105610, 0
    .long 1, 16, 16, 8192, 1024, 1280, 8388608, 524288, 32768, 8, 6307840, 131072, 0, 0, 218108186, 0
    .long 2, 64, 72, 7168, 1280, 1280, 7340032, 1572864, 32768, 8, 60051456, 114688, 0, 0, 218104001, 0
    .long 1, 24, 24, 8192, 1024, 1280, 8388608, 2621440, 32768, 8, 31473664, 131072, 0, 0, 218105626, 0
    .long 1, 16, 16, 8192, 1536, 1792, 8388608, 2621440, 32768, 8, 14704640, 131072, 0, 0, 218105626, 0
    .long 1, 16, 16, 8192, 1536, 1792, 8388608, 3145728, 32768, 8, 16801792, 131072, 0, 0, 218105882, 0
    .long 2, 64, 72, 7168, 1280, 1280, 7340032, 1048576, 32768, 8, 58216448, 114688, 0, 0, 218103937, 0
    .long 2, 64, 72, 7168, 768, 768, 7340032, 2097152, 32768, 8, 61878272, 114688, 0, 0, 218104065, 0
    .long 1, 16, 16, 8192, 512, 768, 8388608, 3145728, 32768, 8, 16785408, 131072, 0, 0, 218105866, 0
    .long 2, 64, 72, 7168, 1536, 1536, 7340032, 1572864, 32768, 8, 60055552, 114688, 0, 0, 218104001, 0
    .long 2, 64, 72, 7168, 1536, 1536, 7340032, 3145728, 32768, 8, 65560576, 114688, 0, 0, 218104193, 0
    .long 2, 64, 72, 7168, 1024, 1024, 7340032, 1048576, 32768, 8, 58212352, 114688, 0, 0, 218103937, 0
    .long 1, 16, 16, 8192, 1536, 1792, 8388608, 0, 32768, 8, 4218880, 131072, 0, 0, 218107930, 0
    .long 2, 64, 72, 7168, 1536, 1536, 7340032, 2097152, 32768, 8, 61890560, 114688, 0, 0, 218104065, 0
    .long 1, 32, 32, 8192, 0, 256, 8388608, 2621440, 32768, 8, 48234496, 131072, 0, 0, 218105610, 0
    .long 2, 64, 72, 7168, 1024, 1024, 7340032, 2097152, 32768, 8, 61882368, 114688, 0, 0, 218104065, 0
    .long 2, 64, 72, 7168, 1536, 1536, 7340032, 1048576, 32768, 8, 58220544, 114688, 0, 0, 218103937, 0
    .long 2, 64, 72, 7168, 1280, 1280, 7340032, 3145728, 32768, 8, 65556480, 114688, 0, 0, 218104193, 0
    .long 2, 64, 72, 7168, 1024, 1024, 7340032, 1572864, 32768, 8, 60047360, 114688, 0, 0, 218104001, 0
    .long 2, 64, 72, 7168, 768, 768, 7340032, 524288, 32768, 8, 56373248, 114688, 0, 0, 218103873, 0
    .long 1, 16, 16, 8192, 1024, 1280, 8388608, 0, 32768, 8, 4210688, 131072, 0, 0, 218107930, 0
    .long 1, 16, 16, 8192, 1536, 1792, 8388608, 524288, 32768, 8, 6316032, 131072, 0, 0, 218108186, 0
    .long 2, 64, 72, 7168, 1280, 1280, 7340032, 0, 32768, 8, 54546432, 114688, 0, 0, 218103809, 0
    .long 2, 64, 72, 7168, 1024, 1024, 7340032, 524288, 32768, 8, 56377344, 114688, 0, 0, 218103873, 0
    .long 2, 64, 72, 7168, 768, 768, 7340032, 1572864, 32768, 8, 60043264, 114688, 0, 0, 218104001, 0
    .long 2, 64, 72, 7168, 1280, 1280, 7340032, 2097152, 32768, 8, 61886464, 114688, 0, 0, 218104065, 0
    .long 2, 64, 72, 7168, 1280, 1280, 7340032, 524288, 32768, 8, 56381440, 114688, 0, 0, 218103873, 0
    .long 2, 64, 72, 7168, 1024, 1024, 7340032, 0, 32768, 8, 54542336, 114688, 0, 0, 218103809, 0
    .long 1, 24, 24, 8192, 1024, 1280, 8388608, 3145728, 32768, 8, 33570816, 131072, 0, 0, 218105882, 0
    .long 2, 64, 72, 7168, 256, 256, 7340032, 2097152, 32768, 8, 61870080, 114688, 0, 0, 218104065, 0
    .long 2, 64, 72, 7168, 256, 256, 7340032, 1572864, 32768, 8, 60035072, 114688, 0, 0, 218104001, 0
    .long 1, 16, 16, 8192, 512, 768, 8388608, 0, 32768, 8, 4202496, 131072, 0, 0, 218107914, 0
    .long 5, 218108160, 0, 0, 0, 0, 0, 8, 0, 0, 0, 0, 218112000, 11, 218106945, 0
    .long 2, 64, 72, 7168, 256, 256, 7340032, 0, 32768, 8, 54530048, 114688, 0, 0, 218103809, 0
    .long 2, 64, 72, 7168, 256, 256, 7340032, 2621440, 32768, 8, 63705088, 114688, 0, 0, 218104129, 0
    .long 2, 64, 72, 7168, 256, 256, 7340032, 3145728, 32768, 8, 65540096, 114688, 0, 0, 218104193, 0
    .long 2, 64, 72, 7168, 1536, 1536, 7340032, 524288, 32768, 8, 56385536, 114688, 0, 0, 218103873, 0
    .long 1, 16, 16, 8192, 0, 256, 8388608, 0, 32768, 8, 4194304, 131072, 0, 0, 218107914, 0
    .long 2, 64, 72, 7168, 1536, 1536, 7340032, 2621440, 32768, 8, 63725568, 114688, 0, 0, 218104129, 0
    .long 1, 32, 32, 8192, 512, 768, 8388608, 3670016, 32768, 8, 52436992, 131072, 0, 0, 218106122, 0
    .long 1, 16, 16, 8192, 1024, 1280, 8388608, 3145728, 32768, 8, 16793600, 131072, 0, 0, 218105882, 0
    .long 2, 64, 72, 7168, 512, 512, 7340032, 2621440, 32768, 8, 63709184, 114688, 0, 0, 218104129, 0
    .long 2, 64, 72, 7168, 256, 256, 7340032, 524288, 32768, 8, 56365056, 114688, 0, 0, 218103873, 0
    .long 1, 16, 16, 8192, 0, 256, 8388608, 3670016, 32768, 8, 18874368, 131072, 0, 0, 218106122, 0
    .long 2, 64, 72, 7168, 768, 768, 7340032, 0, 32768, 8, 54538240, 114688, 0, 0, 218103809, 0
    .long 2, 64, 72, 7168, 512, 512, 7340032, 0, 32768, 8, 54534144, 114688, 0, 0, 218103809, 0
    .long 1, 16, 16, 8192, 1024, 1280, 8388608, 3670016, 32768, 8, 18890752, 131072, 0, 0, 218106138, 0
    .long 2, 64, 72, 7168, 1536, 1536, 7340032, 0, 32768, 8, 54550528, 114688, 0, 0, 218103809, 0
    .long 2, 64, 72, 7168, 768, 768, 7340032, 3670016, 32768, 8, 67383296, 114688, 0, 0, 218104257, 0
    .long 1, 24, 24, 8192, 0, 256, 8388608, 3145728, 32768, 8, 33554432, 131072, 0, 0, 218105866, 0
    .long 1, 32, 32, 8192, 512, 768, 8388608, 3145728, 32768, 8, 50339840, 131072, 0, 0, 218105866, 0
    .long 2, 64, 72, 7168, 0, 0, 7340032, 2621440, 32768, 8, 63700992, 114688, 0, 0, 218104129, 0
    .long 1, 40, 40, 2048, 0, 256, 8388608, 180355072, 131072, 8, 76546048, 32768, 218112000, 24, 218106500, 0
    .long 2, 64, 72, 7168, 512, 512, 7340032, 1048576, 32768, 8, 58204160, 114688, 0, 0, 218103937, 0
    .long 2, 64, 72, 7168, 768, 768, 7340032, 3145728, 32768, 8, 65548288, 114688, 0, 0, 218104193, 0
    .long 2, 64, 72, 7168, 768, 768, 7340032, 1048576, 32768, 8, 58208256, 114688, 0, 0, 218103937, 0
    .long 5, 218108176, 0, 0, 4, 0, 0, 12, 0, 0, 0, 0, 218112000, 15, 218106945, 0
    .long 1, 32, 32, 8192, 0, 256, 8388608, 3145728, 32768, 8, 50331648, 131072, 0, 0, 218105866, 0
    .long 2, 64, 72, 7168, 512, 512, 7340032, 3145728, 32768, 8, 65544192, 114688, 0, 0, 218104193, 0
    .long 2, 64, 72, 7168, 512, 512, 7340032, 524288, 32768, 8, 56369152, 114688, 0, 0, 218103873, 0
    .long 2, 64, 72, 7168, 256, 256, 7340032, 1048576, 32768, 8, 58200064, 114688, 0, 0, 218103937, 0
    .long 2, 64, 72, 7168, 0, 0, 7340032, 1048576, 32768, 8, 58195968, 114688, 0, 0, 218103937, 0
    .long 2, 64, 72, 7168, 0, 0, 7340032, 0, 32768, 8, 54525952, 114688, 0, 0, 218103809, 0
    .long 2, 64, 72, 7168, 768, 768, 7340032, 2621440, 32768, 8, 63713280, 114688, 0, 0, 218104129, 0
    .long 1, 80, 80, 2048, 1024, 1280, 7340032, 61865984, 114688, 7, 119554048, 32768, 218104064, 7, 218106625, 0
    .long 5, 218108160, 0, 0, 0, 0, 0, 12, 0, 0, 0, 0, 218112000, 15, 218106945, 0
    .long 1, 80, 80, 2048, 0, 256, 7340032, 61865984, 114688, 7, 119537664, 32768, 218104064, 7, 218106625, 0
    .long 1, 40, 40, 2048, 512, 768, 8388608, 180355072, 131072, 8, 76554240, 32768, 218112000, 24, 218106500, 0
    .long 1, 32, 32, 8192, 1024, 1280, 8388608, 3670016, 32768, 8, 52445184, 131072, 0, 0, 218106138, 0
    .long 1, 24, 24, 8192, 1024, 1280, 8388608, 3670016, 32768, 8, 35667968, 131072, 0, 0, 218106138, 0
    .long 1, 24, 24, 8192, 1536, 1792, 8388608, 3670016, 32768, 8, 35676160, 131072, 0, 0, 218106138, 0
    .long 5, 218107920, 0, 0, 4, 0, 0, 0, 0, 0, 0, 0, 218112000, 3, 218106881, 0
    .long 1, 32, 32, 8192, 0, 256, 8388608, 3670016, 32768, 8, 52428800, 131072, 0, 0, 218106122, 0
    .long 1, 16, 16, 8192, 1536, 1792, 8388608, 3670016, 32768, 8, 18898944, 131072, 0, 0, 218106138, 0
    .long 1, 80, 80, 2048, 512, 768, 7340032, 60030976, 114688, 7, 119021568, 32768, 218104000, 7, 218106561, 0
    .long 1, 40, 40, 2048, 512, 768, 8388608, 182452224, 131072, 8, 77078528, 32768, 218112000, 32, 218106564, 0
    .long 1, 32, 32, 8192, 1536, 1792, 8388608, 3670016, 32768, 8, 52453376, 131072, 0, 0, 218106138, 0
    .long 5, 218107904, 0, 0, 0, 0, 0, 0, 0, 0, 0, 0, 218112000, 3, 218106881, 0
    .long 2, 64, 72, 7168, 256, 256, 7340032, 3670016, 32768, 8, 67375104, 114688, 0, 0, 218104257, 0
    .long 5, 218107920, 0, 0, 4, 0, 0, 4, 0, 0, 0, 0, 218112000, 7, 218106881, 0
    .long 5, 218107904, 0, 0, 0, 0, 0, 4, 0, 0, 0, 0, 218112000, 7, 218106881, 0
    .long 2, 64, 72, 7168, 0, 0, 7340032, 3670016, 32768, 8, 67371008, 114688, 0, 0, 218104257, 0
    .long 1, 24, 24, 8192, 512, 768, 8388608, 3670016, 32768, 8, 35659776, 131072, 0, 0, 218106122, 0
    .long 2, 64, 72, 7168, 1536, 1536, 7340032, 3670016, 32768, 8, 67395584, 114688, 0, 0, 218104257, 0
    .long 5, 218108176, 0, 0, 4, 0, 0, 8, 0, 0, 0, 0, 218112000, 11, 218106945, 0
    .long 1, 40, 40, 2048, 1024, 1280, 8388608, 182452224, 131072, 8, 77086720, 32768, 218112000, 32, 218106564, 0
    .long 1, 40, 40, 2048, 0, 256, 8388608, 182452224, 131072, 8, 77070336, 32768, 218112000, 32, 218106564, 0
    .long 1, 40, 40, 2048, 1536, 1792, 8388608, 182452224, 131072, 8, 77094912, 32768, 218112000, 32, 218106564, 0
    .long 1, 40, 40, 2048, 1024, 1280, 8388608, 180355072, 131072, 8, 76562432, 32768, 218112000, 24, 218106500, 0
    .long 1, 40, 40, 2048, 1536, 1792, 8388608, 180355072, 131072, 8, 76570624, 32768, 218112000, 24, 218106500, 0
    .long 1, 80, 80, 2048, 0, 256, 7340032, 60030976, 114688, 7, 119013376, 32768, 218104000, 7, 218106561, 0
    .long 2, 64, 72, 7168, 512, 512, 7340032, 3670016, 32768, 8, 67379200, 114688, 0, 0, 218104257, 0
    .long 1, 80, 80, 2048, 1536, 1792, 7340032, 60030976, 114688, 7, 119037952, 32768, 218104000, 7, 218106561, 0
    .long 1, 80, 80, 2048, 0, 256, 7340032, 65536000, 114688, 7, 120586240, 32768, 218104192, 7, 218106753, 0
    .long 1, 80, 80, 2048, 1536, 1792, 7340032, 65536000, 114688, 7, 120610816, 32768, 218104192, 7, 218106753, 0
    .long 1, 80, 80, 2048, 1024, 1280, 7340032, 60030976, 114688, 7, 119029760, 32768, 218104000, 7, 218106561, 0
    .long 1, 80, 80, 2048, 512, 768, 7340032, 61865984, 114688, 7, 119545856, 32768, 218104064, 7, 218106625, 0
    .long 2, 64, 72, 7168, 1024, 1024, 7340032, 3670016, 32768, 8, 67387392, 114688, 0, 0, 218104257, 0
    .long 1, 80, 80, 2048, 1024, 1280, 7340032, 58195968, 114688, 7, 118505472, 32768, 218103936, 7, 218106497, 0
    .long 1, 80, 80, 2048, 512, 768, 7340032, 65536000, 114688, 7, 120594432, 32768, 218104192, 7, 218106753, 0
    .long 1, 80, 80, 2048, 1024, 1280, 7340032, 63700992, 114688, 7, 120078336, 32768, 218104128, 7, 218106689, 0
    .long 1, 80, 80, 2048, 1024, 1280, 7340032, 65536000, 114688, 7, 120602624, 32768, 218104192, 7, 218106753, 0
    .long 1, 80, 80, 2048, 512, 768, 7340032, 58195968, 114688, 7, 118497280, 32768, 218103936, 7, 218106497, 0
    .long 1, 40, 40, 2048, 1024, 1280, 8388608, 184549376, 131072, 8, 77611008, 32768, 218112000, 40, 218106628, 0
    .long 1, 80, 80, 2048, 0, 256, 7340032, 58195968, 114688, 7, 118489088, 32768, 218103936, 7, 218106497, 0
    .long 1, 40, 40, 2048, 512, 768, 8388608, 184549376, 131072, 8, 77602816, 32768, 218112000, 40, 218106628, 0
    .long 1, 80, 80, 2048, 1536, 1792, 7340032, 58195968, 114688, 7, 118513664, 32768, 218103936, 7, 218106497, 0
    .long 1, 80, 80, 2048, 1536, 1792, 7340032, 61865984, 114688, 7, 119562240, 32768, 218104064, 7, 218106625, 0
    .long 1, 40, 40, 2048, 0, 256, 8388608, 176160768, 131072, 8, 75497472, 32768, 218106880, 4, 218106372, 0
    .long 1, 40, 40, 2048, 0, 256, 8388608, 184549376, 131072, 8, 77594624, 32768, 218112000, 40, 218106628, 0
    .long 1, 40, 40, 2048, 1536, 1792, 8388608, 184549376, 131072, 8, 77619200, 32768, 218112000, 40, 218106628, 0
    .long 1, 40, 40, 2048, 1536, 1792, 8388608, 176160768, 131072, 8, 75522048, 32768, 218106880, 4, 218106372, 0
    .long 1, 40, 40, 2048, 1024, 1280, 8388608, 176160768, 131072, 8, 75513856, 32768, 218106880, 4, 218106372, 0
    .long 1, 40, 40, 2048, 512, 768, 8388608, 176160768, 131072, 8, 75505664, 32768, 218106880, 4, 218106372, 0
    .long 1, 80, 80, 2048, 1024, 1280, 7340032, 54525952, 114688, 7, 117456896, 32768, 218103808, 7, 218106369, 0
    .long 1, 80, 80, 2048, 0, 256, 7340032, 54525952, 114688, 7, 117440512, 32768, 218103808, 7, 218106369, 0
    .long 1, 40, 40, 2048, 0, 256, 8388608, 178257920, 131072, 8, 76021760, 32768, 218106944, 4, 218106436, 0
    .long 1, 40, 40, 2048, 1024, 1280, 8388608, 178257920, 131072, 8, 76038144, 32768, 218106944, 4, 218106436, 0
    .long 1, 40, 40, 2048, 1536, 1792, 8388608, 178257920, 131072, 8, 76046336, 32768, 218106944, 4, 218106436, 0
    .long 1, 40, 40, 2048, 512, 768, 8388608, 178257920, 131072, 8, 76029952, 32768, 218106944, 4, 218106436, 0
    .long 1, 80, 80, 2048, 1536, 1792, 7340032, 54525952, 114688, 7, 117465088, 32768, 218103808, 7, 218106369, 0
    .long 1, 80, 80, 2048, 0, 256, 7340032, 63700992, 114688, 7, 120061952, 32768, 218104128, 7, 218106689, 0
    .long 1, 80, 80, 2048, 1536, 1792, 7340032, 56360960, 114688, 7, 117989376, 32768, 218103872, 7, 218106433, 0
    .long 1, 80, 80, 2048, 0, 256, 7340032, 56360960, 114688, 7, 117964800, 32768, 218103872, 7, 218106433, 0
    .long 1, 80, 80, 2048, 1024, 1280, 7340032, 56360960, 114688, 7, 117981184, 32768, 218103872, 7, 218106433, 0
    .long 1, 80, 80, 2048, 512, 768, 7340032, 54525952, 114688, 7, 117448704, 32768, 218103808, 7, 218106369, 0
    .long 1, 80, 80, 2048, 1536, 1792, 7340032, 63700992, 114688, 7, 120086528, 32768, 218104128, 7, 218106689, 0
    .long 1, 80, 80, 2048, 512, 768, 7340032, 56360960, 114688, 7, 117972992, 32768, 218103872, 7, 218106433, 0
    .long 1, 80, 80, 2048, 512, 768, 7340032, 63700992, 114688, 7, 120070144, 32768, 218104128, 7, 218106689, 0
    .long 6, 0, 0, 0, 0, 0, 0, 27, 0, 0, 0, 0, 0, 0, 0, 0
    .long 1, 40, 40, 2048, 1536, 1792, 8388608, 186646528, 131072, 8, 78143488, 32768, 218112000, 48, 218106692, 0
    .long 1, 40, 40, 2048, 512, 768, 8388608, 186646528, 131072, 8, 78127104, 32768, 218112000, 48, 218106692, 0
    .long 1, 40, 40, 2048, 0, 256, 8388608, 186646528, 131072, 8, 78118912, 32768, 218112000, 48, 218106692, 0
    .long 1, 40, 40, 2048, 1024, 1280, 8388608, 186646528, 131072, 8, 78135296, 32768, 218112000, 48, 218106692, 0
    .long 1, 80, 80, 2048, 1536, 1792, 7340032, 67371008, 114688, 7, 121135104, 32768, 218104256, 7, 218106817, 0
    .long 1, 80, 80, 2048, 0, 256, 7340032, 67371008, 114688, 7, 121110528, 32768, 218104256, 7, 218106817, 0
    .long 1, 80, 80, 2048, 1024, 1280, 7340032, 67371008, 114688, 7, 121126912, 32768, 218104256, 7, 218106817, 0
    .long 1, 80, 80, 2048, 512, 768, 7340032, 67371008, 114688, 7, 121118720, 32768, 218104256, 7, 218106817, 0
    .long 6, 0, 0, 0, 0, 0, 0, 25, 0, 0, 0, 0, 0, 0, 0, 0
    .long 6, 0, 0, 0, 0, 0, 0, 22, 0, 0, 0, 0, 0, 0, 0, 0
    .long 6, 0, 0, 0, 0, 0, 0, 29, 0, 0, 0, 0, 0, 0, 0, 0
    .long 6, 0, 0, 0, 0, 0, 0, 38, 0, 0, 0, 0, 0, 0, 0, 0
    .long 6, 0, 0, 0, 0, 0, 0, 30, 0, 0, 0, 0, 0, 0, 0, 0
    .long 6, 0, 0, 0, 0, 0, 0, 20, 0, 0, 0, 0, 0, 0, 0, 0
    .long 6, 0, 0, 0, 0, 0, 0, 16, 0, 0, 0, 0, 0, 0, 0, 0
    .long 6, 0, 0, 0, 0, 0, 0, 26, 0, 0, 0, 0, 0, 0, 0, 0
    .long 6, 0, 0, 0, 0, 0, 0, 12, 0, 0, 0, 0, 0, 0, 0, 0
    .long 6, 0, 0, 0, 0, 0, 0, 39, 0, 0, 0, 0, 0, 0, 0, 0
    .long 6, 0, 0, 0, 0, 0, 0, 37, 0, 0, 0, 0, 0, 0, 0, 0
    .long 6, 0, 0, 0, 0, 0, 0, 36, 0, 0, 0, 0, 0, 0, 0, 0
    .long 6, 0, 0, 0, 0, 0, 0, 48, 0, 0, 0, 0, 0, 0, 0, 0
    .long 6, 0, 0, 0, 0, 0, 0, 4, 0, 0, 0, 0, 0, 0, 0, 0
    .long 6, 0, 0, 0, 0, 0, 0, 2, 0, 0, 0, 0, 0, 0, 0, 0
    .long 6, 0, 0, 0, 0, 0, 0, 31, 0, 0, 0, 0, 0, 0, 0, 0
    .long 6, 0, 0, 0, 0, 0, 0, 21, 0, 0, 0, 0, 0, 0, 0, 0
    .long 6, 0, 0, 0, 0, 0, 0, 24, 0, 0, 0, 0, 0, 0, 0, 0
    .long 6, 0, 0, 0, 0, 0, 0, 19, 0, 0, 0, 0, 0, 0, 0, 0
    .long 6, 0, 0, 0, 0, 0, 0, 33, 0, 0, 0, 0, 0, 0, 0, 0
    .long 6, 0, 0, 0, 0, 0, 0, 35, 0, 0, 0, 0, 0, 0, 0, 0
    .long 6, 0, 0, 0, 0, 0, 0, 3, 0, 0, 0, 0, 0, 0, 0, 0
    .long 6, 0, 0, 0, 0, 0, 0, 51, 0, 0, 0, 0, 0, 0, 0, 0
    .long 6, 0, 0, 0, 0, 0, 0, 6, 0, 0, 0, 0, 0, 0, 0, 0
    .long 6, 0, 0, 0, 0, 0, 0, 17, 0, 0, 0, 0, 0, 0, 0, 0
    .long 6, 0, 0, 0, 0, 0, 0, 18, 0, 0, 0, 0, 0, 0, 0, 0
    .long 6, 0, 0, 0, 0, 0, 0, 23, 0, 0, 0, 0, 0, 0, 0, 0
    .long 6, 0, 0, 0, 0, 0, 0, 0, 0, 0, 0, 0, 0, 0, 0, 0
    .long 6, 0, 0, 0, 0, 0, 0, 28, 0, 0, 0, 0, 0, 0, 0, 0
    .long 6, 0, 0, 0, 0, 0, 0, 5, 0, 0, 0, 0, 0, 0, 0, 0
    .long 6, 0, 0, 0, 0, 0, 0, 13, 0, 0, 0, 0, 0, 0, 0, 0
    .long 6, 0, 0, 0, 0, 0, 0, 32, 0, 0, 0, 0, 0, 0, 0, 0
    .long 6, 0, 0, 0, 0, 0, 0, 14, 0, 0, 0, 0, 0, 0, 0, 0
    .long 6, 0, 0, 0, 0, 0, 0, 34, 0, 0, 0, 0, 0, 0, 0, 0
    .long 6, 0, 0, 0, 0, 0, 0, 1, 0, 0, 0, 0, 0, 0, 0, 0
    .long 6, 0, 0, 0, 0, 0, 0, 9, 0, 0, 0, 0, 0, 0, 0, 0
    .long 6, 0, 0, 0, 0, 0, 0, 10, 0, 0, 0, 0, 0, 0, 0, 0
    .long 6, 0, 0, 0, 0, 0, 0, 11, 0, 0, 0, 0, 0, 0, 0, 0
    .long 6, 0, 0, 0, 0, 0, 0, 15, 0, 0, 0, 0, 0, 0, 0, 0
    .long 6, 0, 0, 0, 0, 0, 0, 50, 0, 0, 0, 0, 0, 0, 0, 0
    .long 6, 0, 0, 0, 0, 0, 0, 7, 0, 0, 0, 0, 0, 0, 0, 0
    .long 6, 0, 0, 0, 0, 0, 0, 8, 0, 0, 0, 0, 0, 0, 0, 0
    .long 6, 0, 0, 0, 0, 0, 0, 49, 0, 0, 0, 0, 0, 0, 0, 0
    .long 6, 0, 0, 0, 0, 0, 0, 54, 0, 0, 0, 0, 0, 0, 0, 0
    .long 6, 0, 0, 0, 0, 0, 0, 55, 0, 0, 0, 0, 0, 0, 0, 0
    .long 6, 0, 0, 0, 0, 0, 0, 53, 0, 0, 0, 0, 0, 0, 0, 0
    .long 6, 0, 0, 0, 0, 0, 0, 52, 0, 0, 0, 0, 0, 0, 0, 0
    .long 6, 0, 0, 0, 0, 0, 0, 40, 0, 0, 0, 0, 0, 0, 0, 0
    .long 6, 0, 0, 0, 0, 0, 0, 41, 0, 0, 0, 0, 0, 0, 0, 0
    .long 6, 0, 0, 0, 0, 0, 0, 42, 0, 0, 0, 0, 0, 0, 0, 0
    .long 6, 0, 0, 0, 0, 0, 0, 43, 0, 0, 0, 0, 0, 0, 0, 0
    .long 6, 0, 0, 0, 0, 0, 0, 44, 0, 0, 0, 0, 0, 0, 0, 0
    .long 6, 0, 0, 0, 0, 0, 0, 45, 0, 0, 0, 0, 0, 0, 0, 0
    .long 6, 0, 0, 0, 0, 0, 0, 46, 0, 0, 0, 0, 0, 0, 0, 0
    .long 6, 0, 0, 0, 0, 0, 0, 47, 0, 0, 0, 0, 0, 0, 0, 0
    .long 6, 0, 0, 0, 0, 0, 0, 56, 0, 0, 0, 0, 0, 0, 0, 0
    .long 6, 0, 0, 0, 0, 0, 0, 57, 0, 0, 0, 0, 0, 0, 0, 0
    .long 6, 0, 0, 0, 0, 0, 0, 58, 0, 0, 0, 0, 0, 0, 0, 0
    .long 6, 0, 0, 0, 0, 0, 0, 59, 0, 0, 0, 0, 0, 0, 0, 0
    .long 6, 0, 0, 0, 0, 0, 0, 60, 0, 0, 0, 0, 0, 0, 0, 0
    .long 7, 0, 0, 0, 0, 0, 0, 61, 0, 0, 0, 0, 0, 0, 0, 0
    .long 7, 0, 0, 0, 1, 0, 0, 61, 0, 0, 0, 0, 0, 0, 0, 0
    .long 7, 0, 0, 0, 2, 0, 0, 61, 0, 0, 0, 0, 0, 0, 0, 0
    .long 7, 0, 0, 0, 3, 0, 0, 61, 0, 0, 0, 0, 0, 0, 0, 0
    .long 7, 0, 0, 0, 0, 0, 0, 62, 0, 0, 0, 0, 0, 0, 0, 0
    .long 7, 0, 0, 0, 1, 0, 0, 62, 0, 0, 0, 0, 0, 0, 0, 0
    .long 7, 0, 0, 0, 2, 0, 0, 62, 0, 0, 0, 0, 0, 0, 0, 0
    .long 7, 0, 0, 0, 3, 0, 0, 62, 0, 0, 0, 0, 0, 0, 0, 0
    .long 7, 0, 0, 0, 0, 0, 0, 63, 0, 0, 0, 0, 0, 0, 0, 0
    .long 7, 0, 0, 0, 1, 0, 0, 63, 0, 0, 0, 0, 0, 0, 0, 0
    .long 7, 0, 0, 0, 2, 0, 0, 63, 0, 0, 0, 0, 0, 0, 0, 0
    .long 7, 0, 0, 0, 3, 0, 0, 63, 0, 0, 0, 0, 0, 0, 0, 0
    .long 0, 0, 0, 0, 0, 0, 0, 0, 0, 0, 0, 0, 0, 0, 0, 0
    .long 4, 24, 24, 8192, 2048, 264192, 8388608, 0, 32768, 4, 21004288, 131072, 0, 0, 218104353, 0
    .long 4, 24, 24, 8192, 2304, 264448, 8388608, 0, 32768, 4, 21008384, 131072, 0, 0, 218104353, 0
    .long 4, 24, 24, 8192, 2560, 264704, 8388608, 0, 32768, 4, 21012480, 131072, 0, 0, 218104353, 0
    .long 4, 24, 24, 8192, 2816, 264960, 8388608, 0, 32768, 4, 21016576, 131072, 0, 0, 218104353, 0
    .long 4, 24, 24, 8192, 3072, 265216, 8388608, 0, 32768, 4, 21020672, 131072, 0, 0, 218104369, 0
    .long 4, 24, 24, 8192, 3328, 265472, 8388608, 0, 32768, 4, 21024768, 131072, 0, 0, 218104369, 0
    .long 4, 24, 24, 8192, 3584, 265728, 8388608, 0, 32768, 4, 21028864, 131072, 0, 0, 218104369, 0
    .long 4, 24, 24, 8192, 3840, 265984, 8388608, 0, 32768, 4, 21032960, 131072, 0, 0, 218104369, 0
    .long 4, 32, 32, 8192, 2048, 264192, 8388608, 0, 32768, 4, 37781504, 131072, 0, 0, 218104353, 0
    .long 4, 32, 32, 8192, 2304, 264448, 8388608, 0, 32768, 4, 37785600, 131072, 0, 0, 218104353, 0
    .long 4, 32, 32, 8192, 2560, 264704, 8388608, 0, 32768, 4, 37789696, 131072, 0, 0, 218104353, 0
    .long 4, 32, 32, 8192, 2816, 264960, 8388608, 0, 32768, 4, 37793792, 131072, 0, 0, 218104353, 0
    .long 4, 32, 32, 8192, 3072, 265216, 8388608, 0, 32768, 4, 37797888, 131072, 0, 0, 218104369, 0
    .long 4, 32, 32, 8192, 3328, 265472, 8388608, 0, 32768, 4, 37801984, 131072, 0, 0, 218104369, 0
    .long 4, 32, 32, 8192, 3584, 265728, 8388608, 0, 32768, 4, 37806080, 131072, 0, 0, 218104369, 0
    .long 4, 32, 32, 8192, 3840, 265984, 8388608, 0, 32768, 4, 37810176, 131072, 0, 0, 218104369, 0
    .long 4, 24, 24, 8192, 2048, 264192, 8388608, 262144, 32768, 4, 22052864, 131072, 0, 0, 218104356, 0
    .long 4, 24, 24, 8192, 2304, 264448, 8388608, 262144, 32768, 4, 22056960, 131072, 0, 0, 218104356, 0
    .long 4, 24, 24, 8192, 2560, 264704, 8388608, 262144, 32768, 4, 22061056, 131072, 0, 0, 218104356, 0
    .long 4, 24, 24, 8192, 2816, 264960, 8388608, 262144, 32768, 4, 22065152, 131072, 0, 0, 218104356, 0
    .long 4, 24, 24, 8192, 3072, 265216, 8388608, 262144, 32768, 4, 22069248, 131072, 0, 0, 218104372, 0
    .long 4, 24, 24, 8192, 3328, 265472, 8388608, 262144, 32768, 4, 22073344, 131072, 0, 0, 218104372, 0
    .long 4, 24, 24, 8192, 3584, 265728, 8388608, 262144, 32768, 4, 22077440, 131072, 0, 0, 218104372, 0
    .long 4, 24, 24, 8192, 3840, 265984, 8388608, 262144, 32768, 4, 22081536, 131072, 0, 0, 218104372, 0
    .long 4, 32, 32, 8192, 2048, 264192, 8388608, 262144, 32768, 4, 38830080, 131072, 0, 0, 218104356, 0
    .long 4, 32, 32, 8192, 2304, 264448, 8388608, 262144, 32768, 4, 38834176, 131072, 0, 0, 218104356, 0
    .long 4, 32, 32, 8192, 2560, 264704, 8388608, 262144, 32768, 4, 38838272, 131072, 0, 0, 218104356, 0
    .long 4, 32, 32, 8192, 2816, 264960, 8388608, 262144, 32768, 4, 38842368, 131072, 0, 0, 218104356, 0
    .long 4, 32, 32, 8192, 3072, 265216, 8388608, 262144, 32768, 4, 38846464, 131072, 0, 0, 218104372, 0
    .long 4, 32, 32, 8192, 3328, 265472, 8388608, 262144, 32768, 4, 38850560, 131072, 0, 0, 218104372, 0
    .long 4, 32, 32, 8192, 3584, 265728, 8388608, 262144, 32768, 4, 38854656, 131072, 0, 0, 218104372, 0
    .long 4, 32, 32, 8192, 3840, 265984, 8388608, 262144, 32768, 4, 38858752, 131072, 0, 0, 218104372, 0
    .long 4, 32, 32, 8192, 3072, 265216, 8388608, 524288, 32768, 4, 39895040, 131072, 0, 0, 218104625, 0
    .long 4, 32, 32, 8192, 2816, 264960, 8388608, 524288, 32768, 4, 39890944, 131072, 0, 0, 218104609, 0
    .long 4, 32, 32, 8192, 3584, 265728, 8388608, 786432, 32768, 4, 40951808, 131072, 0, 0, 218104628, 0
    .long 4, 24, 24, 8192, 3584, 265728, 8388608, 524288, 32768, 4, 23126016, 131072, 0, 0, 218104625, 0
    .long 4, 32, 32, 8192, 3072, 265216, 8388608, 786432, 32768, 4, 40943616, 131072, 0, 0, 218104628, 0
    .long 4, 32, 32, 8192, 2560, 264704, 8388608, 786432, 32768, 4, 40935424, 131072, 0, 0, 218104612, 0
    .long 4, 32, 32, 8192, 2048, 264192, 8388608, 524288, 32768, 4, 39878656, 131072, 0, 0, 218104609, 0
    .long 4, 24, 24, 8192, 3072, 265216, 8388608, 786432, 32768, 4, 24166400, 131072, 0, 0, 218104628, 0
    .long 4, 24, 24, 8192, 2048, 264192, 8388608, 524288, 32768, 4, 23101440, 131072, 0, 0, 218104609, 0
    .long 4, 32, 32, 8192, 3328, 265472, 8388608, 786432, 32768, 4, 40947712, 131072, 0, 0, 218104628, 0
    .long 4, 24, 24, 8192, 2816, 264960, 8388608, 786432, 32768, 4, 24162304, 131072, 0, 0, 218104612, 0
    .long 4, 24, 24, 8192, 2304, 264448, 8388608, 524288, 32768, 4, 23105536, 131072, 0, 0, 218104609, 0
    .long 4, 32, 32, 8192, 2816, 264960, 8388608, 786432, 32768, 4, 40939520, 131072, 0, 0, 218104612, 0
    .long 4, 24, 24, 8192, 3328, 265472, 8388608, 524288, 32768, 4, 23121920, 131072, 0, 0, 218104625, 0
    .long 4, 24, 24, 8192, 3584, 265728, 8388608, 786432, 32768, 4, 24174592, 131072, 0, 0, 218104628, 0
    .long 4, 24, 24, 8192, 3840, 265984, 8388608, 524288, 32768, 4, 23130112, 131072, 0, 0, 218104625, 0
    .long 4, 32, 32, 8192, 2560, 264704, 8388608, 524288, 32768, 4, 39886848, 131072, 0, 0, 218104609, 0
    .long 4, 32, 32, 8192, 3840, 265984, 8388608, 524288, 32768, 4, 39907328, 131072, 0, 0, 218104625, 0
    .long 4, 24, 24, 8192, 3328, 265472, 8388608, 786432, 32768, 4, 24170496, 131072, 0, 0, 218104628, 0
    .long 4, 32, 32, 8192, 2304, 264448, 8388608, 524288, 32768, 4, 39882752, 131072, 0, 0, 218104609, 0
    .long 4, 32, 32, 8192, 2048, 264192, 8388608, 786432, 32768, 4, 40927232, 131072, 0, 0, 218104612, 0
    .long 4, 24, 24, 8192, 2304, 264448, 8388608, 786432, 32768, 4, 24154112, 131072, 0, 0, 218104612, 0
    .long 4, 32, 32, 8192, 3328, 265472, 8388608, 524288, 32768, 4, 39899136, 131072, 0, 0, 218104625, 0
    .long 4, 24, 24, 8192, 2560, 264704, 8388608, 786432, 32768, 4, 24158208, 131072, 0, 0, 218104612, 0
    .long 4, 24, 24, 8192, 2048, 264192, 8388608, 786432, 32768, 4, 24150016, 131072, 0, 0, 218104612, 0
    .long 4, 24, 24, 8192, 2560, 264704, 8388608, 524288, 32768, 4, 23109632, 131072, 0, 0, 218104609, 0
    .long 4, 24, 24, 8192, 2816, 264960, 8388608, 524288, 32768, 4, 23113728, 131072, 0, 0, 218104609, 0
    .long 2, 64, 72, 7168, 2304, 2304, 7340032, 1572864, 32768, 8, 60067840, 114688, 0, 0, 218104004, 0
    .long 4, 32, 32, 8192, 3584, 265728, 8388608, 524288, 32768, 4, 39903232, 131072, 0, 0, 218104625, 0
    .long 4, 24, 24, 8192, 3840, 265984, 8388608, 786432, 32768, 4, 24178688, 131072, 0, 0, 218104628, 0
    .long 4, 32, 32, 8192, 3840, 265984, 8388608, 786432, 32768, 4, 40955904, 131072, 0, 0, 218104628, 0
    .long 4, 24, 24, 8192, 3072, 265216, 8388608, 524288, 32768, 4, 23117824, 131072, 0, 0, 218104625, 0
    .long 1, 16, 16, 8192, 3584, 3840, 8388608, 1048576, 32768, 8, 8445952, 131072, 0, 0, 218104890, 0
    .long 1, 24, 24, 8192, 2048, 2304, 8388608, 1048576, 32768, 8, 25198592, 131072, 0, 0, 218104874, 0
    .long 1, 16, 16, 8192, 2560, 2816, 8388608, 1048576, 32768, 8, 8429568, 131072, 0, 0, 218104874, 0
    .long 1, 32, 32, 8192, 3584, 3840, 8388608, 1048576, 32768, 8, 42000384, 131072, 0, 0, 218104890, 0
    .long 1, 32, 32, 8192, 2560, 2816, 8388608, 1048576, 32768, 8, 41984000, 131072, 0, 0, 218104874, 0
    .long 1, 16, 16, 8192, 3072, 3328, 8388608, 1048576, 32768, 8, 8437760, 131072, 0, 0, 218104890, 0
    .long 1, 24, 24, 8192, 3072, 3328, 8388608, 1048576, 32768, 8, 25214976, 131072, 0, 0, 218104890, 0
    .long 1, 24, 24, 8192, 2048, 2304, 8388608, 1572864, 32768, 8, 27295744, 131072, 0, 0, 218105130, 0
    .long 1, 32, 32, 8192, 2560, 2816, 8388608, 1572864, 32768, 8, 44081152, 131072, 0, 0, 218105130, 0
    .long 1, 16, 16, 8192, 3584, 3840, 8388608, 1572864, 32768, 8, 10543104, 131072, 0, 0, 218105146, 0
    .long 1, 24, 24, 8192, 2560, 2816, 8388608, 1048576, 32768, 8, 25206784, 131072, 0, 0, 218104874, 0
    .long 1, 32, 32, 8192, 2048, 2304, 8388608, 1048576, 32768, 8, 41975808, 131072, 0, 0, 218104874, 0
    .long 4, 32, 32, 8192, 2304, 264448, 8388608, 786432, 32768, 4, 40931328, 131072, 0, 0, 218104612, 0
    .long 1, 16, 16, 8192, 3584, 3840, 8388608, 2097152, 32768, 8, 12640256, 131072, 0, 0, 218105402, 0
    .long 1, 32, 32, 8192, 3072, 3328, 8388608, 1048576, 32768, 8, 41992192, 131072, 0, 0, 218104890, 0
    .long 1, 32, 32, 8192, 3072, 3328, 8388608, 1572864, 32768, 8, 44089344, 131072, 0, 0, 218105146, 0
    .long 1, 16, 16, 8192, 2048, 2304, 8388608, 1048576, 32768, 8, 8421376, 131072, 0, 0, 218104874, 0
    .long 1, 24, 24, 8192, 3584, 3840, 8388608, 1048576, 32768, 8, 25223168, 131072, 0, 0, 218104890, 0
    .long 1, 24, 24, 8192, 2560, 2816, 8388608, 2097152, 32768, 8, 29401088, 131072, 0, 0, 218105386, 0
    .long 1, 16, 16, 8192, 3072, 3328, 8388608, 2097152, 32768, 8, 12632064, 131072, 0, 0, 218105402, 0
    .long 1, 16, 16, 8192, 2048, 2304, 8388608, 1572864, 32768, 8, 10518528, 131072, 0, 0, 218105130, 0
    .long 1, 32, 32, 8192, 2560, 2816, 8388608, 2097152, 32768, 8, 46178304, 131072, 0, 0, 218105386, 0
    .long 1, 16, 16, 8192, 3072, 3328, 8388608, 1572864, 32768, 8, 10534912, 131072, 0, 0, 218105146, 0
    .long 1, 24, 24, 8192, 3584, 3840, 8388608, 1572864, 32768, 8, 27320320, 131072, 0, 0, 218105146, 0
    .long 1, 32, 32, 8192, 3584, 3840, 8388608, 1572864, 32768, 8, 44097536, 131072, 0, 0, 218105146, 0
    .long 1, 24, 24, 8192, 2560, 2816, 8388608, 1572864, 32768, 8, 27303936, 131072, 0, 0, 218105130, 0
    .long 1, 32, 32, 8192, 2048, 2304, 8388608, 2097152, 32768, 8, 46170112, 131072, 0, 0, 218105386, 0
    .long 1, 16, 16, 8192, 2560, 2816, 8388608, 1572864, 32768, 8, 10526720, 131072, 0, 0, 218105130, 0
    .long 1, 32, 32, 8192, 2048, 2304, 8388608, 1572864, 32768, 8, 44072960, 131072, 0, 0, 218105130, 0
    .long 1, 24, 24, 8192, 3072, 3328, 8388608, 1572864, 32768, 8, 27312128, 131072, 0, 0, 218105146, 0
    .long 1, 24, 24, 8192, 3072, 3328, 8388608, 2097152, 32768, 8, 29409280, 131072, 0, 0, 218105402, 0
    .long 1, 16, 16, 8192, 3072, 3328, 8388608, 2621440, 32768, 8, 14729216, 131072, 0, 0, 218105658, 0
    .long 2, 64, 72, 7168, 1792, 1792, 7340032, 1572864, 32768, 8, 60059648, 114688, 0, 0, 218104004, 0
    .long 1, 32, 32, 8192, 3072, 3328, 8388608, 2097152, 32768, 8, 46186496, 131072, 0, 0, 218105402, 0
    .long 1, 24, 24, 8192, 3584, 3840, 8388608, 2097152, 32768, 8, 29417472, 131072, 0, 0, 218105402, 0
    .long 2, 64, 72, 7168, 2816, 2816, 7340032, 3145728, 32768, 8, 65581056, 114688, 0, 0, 218104196, 0
    .long 1, 16, 16, 8192, 2560, 2816, 8388608, 2097152, 32768, 8, 12623872, 131072, 0, 0, 218105386, 0
    .long 1, 24, 24, 8192, 2048, 2304, 8388608, 2621440, 32768, 8, 31490048, 131072, 0, 0, 218105642, 0
    .long 2, 64, 72, 7168, 3072, 3072, 7340032, 2621440, 32768, 8, 63750144, 114688, 0, 0, 218104132, 0
    .long 1, 24, 24, 8192, 2048, 2304, 8388608, 3670016, 32768, 8, 35684352, 131072, 0, 0, 218106154, 0
    .long 1, 16, 16, 8192, 2560, 2816, 8388608, 524288, 32768, 8, 6332416, 131072, 0, 0, 218108202, 0
    .long 1, 32, 32, 8192, 3072, 3328, 8388608, 3145728, 32768, 8, 50380800, 131072, 0, 0, 218105914, 0
    .long 2, 64, 72, 7168, 1792, 1792, 7340032, 3145728, 32768, 8, 65564672, 114688, 0, 0, 218104196, 0
    .long 1, 24, 24, 8192, 2560, 2816, 8388608, 2621440, 32768, 8, 31498240, 131072, 0, 0, 218105642, 0
    .long 1, 16, 16, 8192, 2560, 2816, 8388608, 3670016, 32768, 8, 18915328, 131072, 0, 0, 218106154, 0
    .long 2, 64, 72, 7168, 2816, 2816, 7340032, 2621440, 32768, 8, 63746048, 114688, 0, 0, 218104132, 0
    .long 1, 24, 24, 8192, 3584, 3840, 8388608, 2621440, 32768, 8, 31514624, 131072, 0, 0, 218105658, 0
    .long 1, 24, 24, 8192, 2048, 2304, 8388608, 2097152, 32768, 8, 29392896, 131072, 0, 0, 218105386, 0
    .long 1, 24, 24, 8192, 2560, 2816, 8388608, 3145728, 32768, 8, 33595392, 131072, 0, 0, 218105898, 0
    .long 1, 32, 32, 8192, 3584, 3840, 8388608, 2097152, 32768, 8, 46194688, 131072, 0, 0, 218105402, 0
    .long 1, 32, 32, 8192, 3072, 3328, 8388608, 2621440, 32768, 8, 48283648, 131072, 0, 0, 218105658, 0
    .long 2, 64, 72, 7168, 3072, 3072, 7340032, 3670016, 32768, 8, 67420160, 114688, 0, 0, 218104260, 0
    .long 1, 32, 32, 8192, 3584, 3840, 8388608, 3145728, 32768, 8, 50388992, 131072, 0, 0, 218105914, 0
    .long 1, 16, 16, 8192, 2048, 2304, 8388608, 2621440, 32768, 8, 14712832, 131072, 0, 0, 218105642, 0
    .long 1, 32, 32, 8192, 3584, 3840, 8388608, 2621440, 32768, 8, 48291840, 131072, 0, 0, 218105658, 0
    .long 2, 64, 72, 7168, 1792, 1792, 7340032, 524288, 32768, 8, 56389632, 114688, 0, 0, 218103876, 0
    .long 1, 16, 16, 8192, 2560, 2816, 8388608, 2621440, 32768, 8, 14721024, 131072, 0, 0, 218105642, 0
    .long 2, 64, 72, 7168, 2304, 2304, 7340032, 2097152, 32768, 8, 61902848, 114688, 0, 0, 218104068, 0
    .long 1, 16, 16, 8192, 2048, 2304, 8388608, 3145728, 32768, 8, 16809984, 131072, 0, 0, 218105898, 0
    .long 1, 24, 24, 8192, 3584, 3840, 8388608, 3145728, 32768, 8, 33611776, 131072, 0, 0, 218105914, 0
    .long 1, 16, 16, 8192, 2048, 2304, 8388608, 2097152, 32768, 8, 12615680, 131072, 0, 0, 218105386, 0
    .long 2, 64, 72, 7168, 1792, 1792, 7340032, 2097152, 32768, 8, 61894656, 114688, 0, 0, 218104068, 0
    .long 1, 16, 16, 8192, 2048, 2304, 8388608, 524288, 32768, 8, 6324224, 131072, 0, 0, 218108202, 0
    .long 1, 32, 32, 8192, 2560, 2816, 8388608, 2621440, 32768, 8, 48275456, 131072, 0, 0, 218105642, 0
    .long 1, 16, 16, 8192, 3072, 3328, 8388608, 524288, 32768, 8, 6340608, 131072, 0, 0, 218108218, 0
    .long 2, 64, 72, 7168, 3072, 3072, 7340032, 1572864, 32768, 8, 60080128, 114688, 0, 0, 218104004, 0
    .long 1, 24, 24, 8192, 3072, 3328, 8388608, 2621440, 32768, 8, 31506432, 131072, 0, 0, 218105658, 0
    .long 1, 16, 16, 8192, 3584, 3840, 8388608, 2621440, 32768, 8, 14737408, 131072, 0, 0, 218105658, 0
    .long 1, 16, 16, 8192, 3584, 3840, 8388608, 3145728, 32768, 8, 16834560, 131072, 0, 0, 218105914, 0
    .long 2, 64, 72, 7168, 3072, 3072, 7340032, 1048576, 32768, 8, 58245120, 114688, 0, 0, 218103940, 0
    .long 2, 64, 72, 7168, 2560, 2560, 7340032, 2097152, 32768, 8, 61906944, 114688, 0, 0, 218104068, 0
    .long 1, 16, 16, 8192, 2560, 2816, 8388608, 3145728, 32768, 8, 16818176, 131072, 0, 0, 218105898, 0
    .long 2, 64, 72, 7168, 3328, 3328, 7340032, 1572864, 32768, 8, 60084224, 114688, 0, 0, 218104004, 0
    .long 2, 64, 72, 7168, 3328, 3328, 7340032, 3145728, 32768, 8, 65589248, 114688, 0, 0, 218104196, 0
    .long 2, 64, 72, 7168, 2816, 2816, 7340032, 1048576, 32768, 8, 58241024, 114688, 0, 0, 218103940, 0
    .long 1, 16, 16, 8192, 3584, 3840, 8388608, 0, 32768, 8, 4251648, 131072, 0, 0, 218107962, 0
    .long 2, 64, 72, 7168, 3328, 3328, 7340032, 2097152, 32768, 8, 61919232, 114688, 0, 0, 218104068, 0
    .long 1, 32, 32, 8192, 2048, 2304, 8388608, 2621440, 32768, 8, 48267264, 131072, 0, 0, 218105642, 0
    .long 2, 64, 72, 7168, 2816, 2816, 7340032, 2097152, 32768, 8, 61911040, 114688, 0, 0, 218104068, 0
    .long 2, 64, 72, 7168, 3328, 3328, 7340032, 1048576, 32768, 8, 58249216, 114688, 0, 0, 218103940, 0
    .long 2, 64, 72, 7168, 3072, 3072, 7340032, 3145728, 32768, 8, 65585152, 114688, 0, 0, 218104196, 0
    .long 2, 64, 72, 7168, 2816, 2816, 7340032, 1572864, 32768, 8, 60076032, 114688, 0, 0, 218104004, 0
    .long 2, 64, 72, 7168, 2560, 2560, 7340032, 524288, 32768, 8, 56401920, 114688, 0, 0, 218103876, 0
    .long 1, 16, 16, 8192, 3072, 3328, 8388608, 0, 32768, 8, 4243456, 131072, 0, 0, 218107962, 0
    .long 1, 16, 16, 8192, 3584, 3840, 8388608, 524288, 32768, 8, 6348800, 131072, 0, 0, 218108218, 0
    .long 2, 64, 72, 7168, 3072, 3072, 7340032, 0, 32768, 8, 54575104, 114688, 0, 0, 218103812, 0
    .long 2, 64, 72, 7168, 2816, 2816, 7340032, 524288, 32768, 8, 56406016, 114688, 0, 0, 218103876, 0
    .long 2, 64, 72, 7168, 2560, 2560, 7340032, 1572864, 32768, 8, 60071936, 114688, 0, 0, 218104004, 0
    .long 2, 64, 72, 7168, 3072, 3072, 7340032, 2097152, 32768, 8, 61915136, 114688, 0, 0, 218104068, 0
    .long 2, 64, 72, 7168, 3072, 3072, 7340032, 524288, 32768, 8, 56410112, 114688, 0, 0, 218103876, 0
    .long 2, 64, 72, 7168, 2816, 2816, 7340032, 0, 32768, 8, 54571008, 114688, 0, 0, 218103812, 0
    .long 1, 24, 24, 8192, 3072, 3328, 8388608, 3145728, 32768, 8, 33603584, 131072, 0, 0, 218105914, 0
    .long 2, 64, 72, 7168, 2048, 2048, 7340032, 2097152, 32768, 8, 61898752, 114688, 0, 0, 218104068, 0
    .long 2, 64, 72, 7168, 2048, 2048, 7340032, 1572864, 32768, 8, 60063744, 114688, 0, 0, 218104004, 0
    .long 1, 16, 16, 8192, 2560, 2816, 8388608, 0, 32768, 8, 4235264, 131072, 0, 0, 218107946, 0
    .long 5, 218108192, 0, 0, 8, 0, 0, 8, 0, 0, 0, 0, 218112128, 11, 218106948, 0
    .long 2, 64, 72, 7168, 2048, 2048, 7340032, 0, 32768, 8, 54558720, 114688, 0, 0, 218103812, 0
    .long 2, 64, 72, 7168, 2048, 2048, 7340032, 2621440, 32768, 8, 63733760, 114688, 0, 0, 218104132, 0
    .long 2, 64, 72, 7168, 2048, 2048, 7340032, 3145728, 32768, 8, 65568768, 114688, 0, 0, 218104196, 0
    .long 2, 64, 72, 7168, 3328, 3328, 7340032, 524288, 32768, 8, 56414208, 114688, 0, 0, 218103876, 0
    .long 1, 16, 16, 8192, 2048, 2304, 8388608, 0, 32768, 8, 4227072, 131072, 0, 0, 218107946, 0
    .long 2, 64, 72, 7168, 3328, 3328, 7340032, 2621440, 32768, 8, 63754240, 114688, 0, 0, 218104132, 0
    .long 1, 32, 32, 8192, 2560, 2816, 8388608, 3670016, 32768, 8, 52469760, 131072, 0, 0, 218106154, 0
    .long 1, 16, 16, 8192, 3072, 3328, 8388608, 3145728, 32768, 8, 16826368, 131072, 0, 0, 218105914, 0
    .long 2, 64, 72, 7168, 2304, 2304, 7340032, 2621440, 32768, 8, 63737856, 114688, 0, 0, 218104132, 0
    .long 2, 64, 72, 7168, 2048, 2048, 7340032, 524288, 32768, 8, 56393728, 114688, 0, 0, 218103876, 0
    .long 1, 16, 16, 8192, 2048, 2304, 8388608, 3670016, 32768, 8, 18907136, 131072, 0, 0, 218106154, 0
    .long 2, 64, 72, 7168, 2560, 2560, 7340032, 0, 32768, 8, 54566912, 114688, 0, 0, 218103812, 0
    .long 2, 64, 72, 7168, 2304, 2304, 7340032, 0, 32768, 8, 54562816, 114688, 0, 0, 218103812, 0
    .long 1, 16, 16, 8192, 3072, 3328, 8388608, 3670016, 32768, 8, 18923520, 131072, 0, 0, 218106170, 0
    .long 2, 64, 72, 7168, 3328, 3328, 7340032, 0, 32768, 8, 54579200, 114688, 0, 0, 218103812, 0
    .long 2, 64, 72, 7168, 2560, 2560, 7340032, 3670016, 32768, 8, 67411968, 114688, 0, 0, 218104260, 0
    .long 1, 24, 24, 8192, 2048, 2304, 8388608, 3145728, 32768, 8, 33587200, 131072, 0, 0, 218105898, 0
    .long 1, 32, 32, 8192, 2560, 2816, 8388608, 3145728, 32768, 8, 50372608, 131072, 0, 0, 218105898, 0
    .long 2, 64, 72, 7168, 1792, 1792, 7340032, 2621440, 32768, 8, 63729664, 114688, 0, 0, 218104132, 0
    .long 1, 40, 40, 2048, 2097152, 2097408, 8388608, 180387840, 131072, 8, 80740352, 32768, 218112128, 24, 218106500, 0
    .long 2, 64, 72, 7168, 2304, 2304, 7340032, 1048576, 32768, 8, 58232832, 114688, 0, 0, 218103940, 0
    .long 2, 64, 72, 7168, 2560, 2560, 7340032, 3145728, 32768, 8, 65576960, 114688, 0, 0, 218104196, 0
    .long 2, 64, 72, 7168, 2560, 2560, 7340032, 1048576, 32768, 8, 58236928, 114688, 0, 0, 218103940, 0
    .long 5, 218108208, 0, 0, 12, 0, 0, 12, 0, 0, 0, 0, 218112128, 15, 218106948, 0
    .long 1, 32, 32, 8192, 2048, 2304, 8388608, 3145728, 32768, 8, 50364416, 131072, 0, 0, 218105898, 0
    .long 2, 64, 72, 7168, 2304, 2304, 7340032, 3145728, 32768, 8, 65572864, 114688, 0, 0, 218104196, 0
    .long 2, 64, 72, 7168, 2304, 2304, 7340032, 524288, 32768, 8, 56397824, 114688, 0, 0, 218103876, 0
    .long 2, 64, 72, 7168, 2048, 2048, 7340032, 1048576, 32768, 8, 58228736, 114688, 0, 0, 218103940, 0
    .long 2, 64, 72, 7168, 1792, 1792, 7340032, 1048576, 32768, 8, 58224640, 114688, 0, 0, 218103940, 0
    .long 2, 64, 72, 7168, 1792, 1792, 7340032, 0, 32768, 8, 54554624, 114688, 0, 0, 218103812, 0
    .long 2, 64, 72, 7168, 2560, 2560, 7340032, 2621440, 32768, 8, 63741952, 114688, 0, 0, 218104132, 0
    .long 1, 80, 80, 2048, 1836032, 1836288, 7340032, 61894656, 114688, 7, 123748352, 32768, 218104068, 7, 218106625, 0
    .long 5, 218108192, 0, 0, 8, 0, 0, 12, 0, 0, 0, 0, 218112128, 15, 218106948, 0
    .long 1, 80, 80, 2048, 1835008, 1835264, 7340032, 61894656, 114688, 7, 123731968, 32768, 218104068, 7, 218106625, 0
    .long 1, 40, 40, 2048, 2097664, 2097920, 8388608, 180387840, 131072, 8, 80748544, 32768, 218112128, 24, 218106500, 0
    .long 1, 32, 32, 8192, 3072, 3328, 8388608, 3670016, 32768, 8, 52477952, 131072, 0, 0, 218106170, 0
    .long 1, 24, 24, 8192, 3072, 3328, 8388608, 3670016, 32768, 8, 35700736, 131072, 0, 0, 218106170, 0
    .long 1, 24, 24, 8192, 3584, 3840, 8388608, 3670016, 32768, 8, 35708928, 131072, 0, 0, 218106170, 0
    .long 5, 218107952, 0, 0, 12, 0, 0, 0, 0, 0, 0, 0, 218112128, 3, 218106884, 0
    .long 1, 32, 32, 8192, 2048, 2304, 8388608, 3670016, 32768, 8, 52461568, 131072, 0, 0, 218106154, 0
    .long 1, 16, 16, 8192, 3584, 3840, 8388608, 3670016, 32768, 8, 18931712, 131072, 0, 0, 218106170, 0
    .long 1, 80, 80, 2048, 1835520, 1835776, 7340032, 60059648, 114688, 7, 123215872, 32768, 218104004, 7, 218106561, 0
    .long 1, 40, 40, 2048, 2097664, 2097920, 8388608, 182484992, 131072, 8, 81272832, 32768, 218112128, 32, 218106564, 0
    .long 1, 32, 32, 8192, 3584, 3840, 8388608, 3670016, 32768, 8, 52486144, 131072, 0, 0, 218106170, 0
    .long 5, 218107936, 0, 0, 8, 0, 0, 0, 0, 0, 0, 0, 218112128, 3, 218106884, 0
    .long 2, 64, 72, 7168, 2048, 2048, 7340032, 3670016, 32768, 8, 67403776, 114688, 0, 0, 218104260, 0
    .long 5, 218107952, 0, 0, 12, 0, 0, 4, 0, 0, 0, 0, 218112128, 7, 218106884, 0
    .long 5, 218107936, 0, 0, 8, 0, 0, 4, 0, 0, 0, 0, 218112128, 7, 218106884, 0
    .long 2, 64, 72, 7168, 1792, 1792, 7340032, 3670016, 32768, 8, 67399680, 114688, 0, 0, 218104260, 0
    .long 1, 24, 24, 8192, 2560, 2816, 8388608, 3670016, 32768, 8, 35692544, 131072, 0, 0, 218106154, 0
    .long 2, 64, 72, 7168, 3328, 3328, 7340032, 3670016, 32768, 8, 67424256, 114688, 0, 0, 218104260, 0
    .long 5, 218108208, 0, 0, 12, 0, 0, 8, 0, 0, 0, 0, 218112128, 11, 218106948, 0
    .long 1, 40, 40, 2048, 2098176, 2098432, 8388608, 182484992, 131072, 8, 81281024, 32768, 218112128, 32, 218106564, 0
    .long 1, 40, 40, 2048, 2097152, 2097408, 8388608, 182484992, 131072, 8, 81264640, 32768, 218112128, 32, 218106564, 0
    .long 1, 40, 40, 2048, 2098688, 2098944, 8388608, 182484992, 131072, 8, 81289216, 32768, 218112128, 32, 218106564, 0
    .long 1, 40, 40, 2048, 2098176, 2098432, 8388608, 180387840, 131072, 8, 80756736, 32768, 218112128, 24, 218106500, 0
    .long 1, 40, 40, 2048, 2098688, 2098944, 8388608, 180387840, 131072, 8, 80764928, 32768, 218112128, 24, 218106500, 0
    .long 1, 80, 80, 2048, 1835008, 1835264, 7340032, 60059648, 114688, 7, 123207680, 32768, 218104004, 7, 218106561, 0
    .long 2, 64, 72, 7168, 2304, 2304, 7340032, 3670016, 32768, 8, 67407872, 114688, 0, 0, 218104260, 0
    .long 1, 80, 80, 2048, 1836544, 1836800, 7340032, 60059648, 114688, 7, 123232256, 32768, 218104004, 7, 218106561, 0
    .long 1, 80, 80, 2048, 1835008, 1835264, 7340032, 65564672, 114688, 7, 124780544, 32768, 218104196, 7, 218106753, 0
    .long 1, 80, 80, 2048, 1836544, 1836800, 7340032, 65564672, 114688, 7, 124805120, 32768, 218104196, 7, 218106753, 0
    .long 1, 80, 80, 2048, 1836032, 1836288, 7340032, 60059648, 114688, 7, 123224064, 32768, 218104004, 7, 218106561, 0
    .long 1, 80, 80, 2048, 1835520, 1835776, 7340032, 61894656, 114688, 7, 123740160, 32768, 218104068, 7, 218106625, 0
    .long 2, 64, 72, 7168, 2816, 2816, 7340032, 3670016, 32768, 8, 67416064, 114688, 0, 0, 218104260, 0
    .long 1, 80, 80, 2048, 1836032, 1836288, 7340032, 58224640, 114688, 7, 122699776, 32768, 218103940, 7, 218106497, 0
    .long 1, 80, 80, 2048, 1835520, 1835776, 7340032, 65564672, 114688, 7, 124788736, 32768, 218104196, 7, 218106753, 0
    .long 1, 80, 80, 2048, 1836032, 1836288, 7340032, 63729664, 114688, 7, 124272640, 32768, 218104132, 7, 218106689, 0
    .long 1, 80, 80, 2048, 1836032, 1836288, 7340032, 65564672, 114688, 7, 124796928, 32768, 218104196, 7, 218106753, 0
    .long 1, 80, 80, 2048, 1835520, 1835776, 7340032, 58224640, 114688, 7, 122691584, 32768, 218103940, 7, 218106497, 0
    .long 1, 40, 40, 2048, 2098176, 2098432, 8388608, 184582144, 131072, 8, 81805312, 32768, 218112128, 40, 218106628, 0
    .long 1, 80, 80, 2048, 1835008, 1835264, 7340032, 58224640, 114688, 7, 122683392, 32768, 218103940, 7, 218106497, 0
    .long 1, 40, 40, 2048, 2097664, 2097920, 8388608, 184582144, 131072, 8, 81797120, 32768, 218112128, 40, 218106628, 0
    .long 1, 80, 80, 2048, 1836544, 1836800, 7340032, 58224640, 114688, 7, 122707968, 32768, 218103940, 7, 218106497, 0
    .long 1, 80, 80, 2048, 1836544, 1836800, 7340032, 61894656, 114688, 7, 123756544, 32768, 218104068, 7, 218106625, 0
    .long 1, 40, 40, 2048, 2097152, 2097408, 8388608, 176193536, 131072, 8, 79691776, 32768, 218106884, 4, 218106372, 0
    .long 1, 40, 40, 2048, 2097152, 2097408, 8388608, 184582144, 131072, 8, 81788928, 32768, 218112128, 40, 218106628, 0
    .long 1, 40, 40, 2048, 2098688, 2098944, 8388608, 184582144, 131072, 8, 81813504, 32768, 218112128, 40, 218106628, 0
    .long 1, 40, 40, 2048, 2098688, 2098944, 8388608, 176193536, 131072, 8, 79716352, 32768, 218106884, 4, 218106372, 0
    .long 1, 40, 40, 2048, 2098176, 2098432, 8388608, 176193536, 131072, 8, 79708160, 32768, 218106884, 4, 218106372, 0
    .long 1, 40, 40, 2048, 2097664, 2097920, 8388608, 176193536, 131072, 8, 79699968, 32768, 218106884, 4, 218106372, 0
    .long 1, 80, 80, 2048, 1836032, 1836288, 7340032, 54554624, 114688, 7, 121651200, 32768, 218103812, 7, 218106369, 0
    .long 1, 80, 80, 2048, 1835008, 1835264, 7340032, 54554624, 114688, 7, 121634816, 32768, 218103812, 7, 218106369, 0
    .long 1, 40, 40, 2048, 2097152, 2097408, 8388608, 178290688, 131072, 8, 80216064, 32768, 218106948, 4, 218106436, 0
    .long 1, 40, 40, 2048, 2098176, 2098432, 8388608, 178290688, 131072, 8, 80232448, 32768, 218106948, 4, 218106436, 0
    .long 1, 40, 40, 2048, 2098688, 2098944, 8388608, 178290688, 131072, 8, 80240640, 32768, 218106948, 4, 218106436, 0
    .long 1, 40, 40, 2048, 2097664, 2097920, 8388608, 178290688, 131072, 8, 80224256, 32768, 218106948, 4, 218106436, 0
    .long 1, 80, 80, 2048, 1836544, 1836800, 7340032, 54554624, 114688, 7, 121659392, 32768, 218103812, 7, 218106369, 0
    .long 1, 80, 80, 2048, 1835008, 1835264, 7340032, 63729664, 114688, 7, 124256256, 32768, 218104132, 7, 218106689, 0
    .long 1, 80, 80, 2048, 1836544, 1836800, 7340032, 56389632, 114688, 7, 122183680, 32768, 218103876, 7, 218106433, 0
    .long 1, 80, 80, 2048, 1835008, 1835264, 7340032, 56389632, 114688, 7, 122159104, 32768, 218103876, 7, 218106433, 0
    .long 1, 80, 80, 2048, 1836032, 1836288, 7340032, 56389632, 114688, 7, 122175488, 32768, 218103876, 7, 218106433, 0
    .long 1, 80, 80, 2048, 1835520, 1835776, 7340032, 54554624, 114688, 7, 121643008, 32768, 218103812, 7, 218106369, 0
    .long 1, 80, 80, 2048, 1836544, 1836800, 7340032, 63729664, 114688, 7, 124280832, 32768, 218104132, 7, 218106689, 0
    .long 1, 80, 80, 2048, 1835520, 1835776, 7340032, 56389632, 114688, 7, 122167296, 32768, 218103876, 7, 218106433, 0
    .long 1, 80, 80, 2048, 1835520, 1835776, 7340032, 63729664, 114688, 7, 124264448, 32768, 218104132, 7, 218106689, 0
    .long 6, 0, 0, 0, 1, 0, 0, 27, 0, 0, 0, 0, 0, 0, 0, 0
    .long 1, 40, 40, 2048, 2098688, 2098944, 8388608, 186679296, 131072, 8, 82337792, 32768, 218112128, 48, 218106692, 0
    .long 1, 40, 40, 2048, 2097664, 2097920, 8388608, 186679296, 131072, 8, 82321408, 32768, 218112128, 48, 218106692, 0
    .long 1, 40, 40, 2048, 2097152, 2097408, 8388608, 186679296, 131072, 8, 82313216, 32768, 218112128, 48, 218106692, 0
    .long 1, 40, 40, 2048, 2098176, 2098432, 8388608, 186679296, 131072, 8, 82329600, 32768, 218112128, 48, 218106692, 0
    .long 1, 80, 80, 2048, 1836544, 1836800, 7340032, 67399680, 114688, 7, 125329408, 32768, 218104260, 7, 218106817, 0
    .long 1, 80, 80, 2048, 1835008, 1835264, 7340032, 67399680, 114688, 7, 125304832, 32768, 218104260, 7, 218106817, 0
    .long 1, 80, 80, 2048, 1836032, 1836288, 7340032, 67399680, 114688, 7, 125321216, 32768, 218104260, 7, 218106817, 0
    .long 1, 80, 80, 2048, 1835520, 1835776, 7340032, 67399680, 114688, 7, 125313024, 32768, 218104260, 7, 218106817, 0
    .long 6, 0, 0, 0, 1, 0, 0, 25, 0, 0, 0, 0, 0, 0, 0, 0
    .long 6, 0, 0, 0, 1, 0, 0, 22, 0, 0, 0, 0, 0, 0, 0, 0
    .long 6, 0, 0, 0, 1, 0, 0, 29, 0, 0, 0, 0, 0, 0, 0, 0
    .long 6, 0, 0, 0, 1, 0, 0, 38, 0, 0, 0, 0, 0, 0, 0, 0
    .long 6, 0, 0, 0, 1, 0, 0, 30, 0, 0, 0, 0, 0, 0, 0, 0
    .long 6, 0, 0, 0, 1, 0, 0, 20, 0, 0, 0, 0, 0, 0, 0, 0
    .long 6, 0, 0, 0, 1, 0, 0, 16, 0, 0, 0, 0, 0, 0, 0, 0
    .long 6, 0, 0, 0, 1, 0, 0, 26, 0, 0, 0, 0, 0, 0, 0, 0
    .long 6, 0, 0, 0, 1, 0, 0, 12, 0, 0, 0, 0, 0, 0, 0, 0
    .long 6, 0, 0, 0, 1, 0, 0, 39, 0, 0, 0, 0, 0, 0, 0, 0
    .long 6, 0, 0, 0, 1, 0, 0, 37, 0, 0, 0, 0, 0, 0, 0, 0
    .long 6, 0, 0, 0, 1, 0, 0, 36, 0, 0, 0, 0, 0, 0, 0, 0
    .long 6, 0, 0, 0, 1, 0, 0, 48, 0, 0, 0, 0, 0, 0, 0, 0
    .long 6, 0, 0, 0, 1, 0, 0, 4, 0, 0, 0, 0, 0, 0, 0, 0
    .long 6, 0, 0, 0, 1, 0, 0, 2, 0, 0, 0, 0, 0, 0, 0, 0
    .long 6, 0, 0, 0, 1, 0, 0, 31, 0, 0, 0, 0, 0, 0, 0, 0
    .long 6, 0, 0, 0, 1, 0, 0, 21, 0, 0, 0, 0, 0, 0, 0, 0
    .long 6, 0, 0, 0, 1, 0, 0, 24, 0, 0, 0, 0, 0, 0, 0, 0
    .long 6, 0, 0, 0, 1, 0, 0, 19, 0, 0, 0, 0, 0, 0, 0, 0
    .long 6, 0, 0, 0, 1, 0, 0, 33, 0, 0, 0, 0, 0, 0, 0, 0
    .long 6, 0, 0, 0, 1, 0, 0, 35, 0, 0, 0, 0, 0, 0, 0, 0
    .long 6, 0, 0, 0, 1, 0, 0, 3, 0, 0, 0, 0, 0, 0, 0, 0
    .long 6, 0, 0, 0, 1, 0, 0, 51, 0, 0, 0, 0, 0, 0, 0, 0
    .long 6, 0, 0, 0, 1, 0, 0, 6, 0, 0, 0, 0, 0, 0, 0, 0
    .long 6, 0, 0, 0, 1, 0, 0, 17, 0, 0, 0, 0, 0, 0, 0, 0
    .long 6, 0, 0, 0, 1, 0, 0, 18, 0, 0, 0, 0, 0, 0, 0, 0
    .long 6, 0, 0, 0, 1, 0, 0, 23, 0, 0, 0, 0, 0, 0, 0, 0
    .long 6, 0, 0, 0, 1, 0, 0, 0, 0, 0, 0, 0, 0, 0, 0, 0
    .long 6, 0, 0, 0, 1, 0, 0, 28, 0, 0, 0, 0, 0, 0, 0, 0
    .long 6, 0, 0, 0, 1, 0, 0, 5, 0, 0, 0, 0, 0, 0, 0, 0
    .long 6, 0, 0, 0, 1, 0, 0, 13, 0, 0, 0, 0, 0, 0, 0, 0
    .long 6, 0, 0, 0, 1, 0, 0, 32, 0, 0, 0, 0, 0, 0, 0, 0
    .long 6, 0, 0, 0, 1, 0, 0, 14, 0, 0, 0, 0, 0, 0, 0, 0
    .long 6, 0, 0, 0, 1, 0, 0, 34, 0, 0, 0, 0, 0, 0, 0, 0
    .long 6, 0, 0, 0, 1, 0, 0, 1, 0, 0, 0, 0, 0, 0, 0, 0
    .long 6, 0, 0, 0, 1, 0, 0, 9, 0, 0, 0, 0, 0, 0, 0, 0
    .long 6, 0, 0, 0, 1, 0, 0, 10, 0, 0, 0, 0, 0, 0, 0, 0
    .long 6, 0, 0, 0, 1, 0, 0, 11, 0, 0, 0, 0, 0, 0, 0, 0
    .long 6, 0, 0, 0, 1, 0, 0, 15, 0, 0, 0, 0, 0, 0, 0, 0
    .long 6, 0, 0, 0, 1, 0, 0, 50, 0, 0, 0, 0, 0, 0, 0, 0
    .long 6, 0, 0, 0, 1, 0, 0, 7, 0, 0, 0, 0, 0, 0, 0, 0
    .long 6, 0, 0, 0, 1, 0, 0, 8, 0, 0, 0, 0, 0, 0, 0, 0
    .long 6, 0, 0, 0, 1, 0, 0, 49, 0, 0, 0, 0, 0, 0, 0, 0
    .long 6, 0, 0, 0, 1, 0, 0, 54, 0, 0, 0, 0, 0, 0, 0, 0
    .long 6, 0, 0, 0, 1, 0, 0, 55, 0, 0, 0, 0, 0, 0, 0, 0
    .long 6, 0, 0, 0, 1, 0, 0, 53, 0, 0, 0, 0, 0, 0, 0, 0
    .long 6, 0, 0, 0, 1, 0, 0, 52, 0, 0, 0, 0, 0, 0, 0, 0
    .long 6, 0, 0, 0, 1, 0, 0, 40, 0, 0, 0, 0, 0, 0, 0, 0
    .long 6, 0, 0, 0, 1, 0, 0, 41, 0, 0, 0, 0, 0, 0, 0, 0
    .long 6, 0, 0, 0, 1, 0, 0, 42, 0, 0, 0, 0, 0, 0, 0, 0
    .long 6, 0, 0, 0, 1, 0, 0, 43, 0, 0, 0, 0, 0, 0, 0, 0
    .long 6, 0, 0, 0, 1, 0, 0, 44, 0, 0, 0, 0, 0, 0, 0, 0
    .long 6, 0, 0, 0, 1, 0, 0, 45, 0, 0, 0, 0, 0, 0, 0, 0
    .long 6, 0, 0, 0, 1, 0, 0, 46, 0, 0, 0, 0, 0, 0, 0, 0
    .long 6, 0, 0, 0, 1, 0, 0, 47, 0, 0, 0, 0, 0, 0, 0, 0
    .long 6, 0, 0, 0, 1, 0, 0, 56, 0, 0, 0, 0, 0, 0, 0, 0
    .long 6, 0, 0, 0, 1, 0, 0, 57, 0, 0, 0, 0, 0, 0, 0, 0
    .long 6, 0, 0, 0, 1, 0, 0, 58, 0, 0, 0, 0, 0, 0, 0, 0
    .long 6, 0, 0, 0, 1, 0, 0, 59, 0, 0, 0, 0, 0, 0, 0, 0
    .long 6, 0, 0, 0, 1, 0, 0, 60, 0, 0, 0, 0, 0, 0, 0, 0
    .long 7, 0, 0, 0, 4, 0, 0, 61, 0, 0, 0, 0, 0, 0, 0, 0
    .long 7, 0, 0, 0, 5, 0, 0, 61, 0, 0, 0, 0, 0, 0, 0, 0
    .long 7, 0, 0, 0, 6, 0, 0, 61, 0, 0, 0, 0, 0, 0, 0, 0
    .long 7, 0, 0, 0, 7, 0, 0, 61, 0, 0, 0, 0, 0, 0, 0, 0
    .long 7, 0, 0, 0, 4, 0, 0, 62, 0, 0, 0, 0, 0, 0, 0, 0
    .long 7, 0, 0, 0, 5, 0, 0, 62, 0, 0, 0, 0, 0, 0, 0, 0
    .long 7, 0, 0, 0, 6, 0, 0, 62, 0, 0, 0, 0, 0, 0, 0, 0
    .long 7, 0, 0, 0, 7, 0, 0, 62, 0, 0, 0, 0, 0, 0, 0, 0
    .long 7, 0, 0, 0, 4, 0, 0, 63, 0, 0, 0, 0, 0, 0, 0, 0
    .long 7, 0, 0, 0, 5, 0, 0, 63, 0, 0, 0, 0, 0, 0, 0, 0
    .long 7, 0, 0, 0, 6, 0, 0, 63, 0, 0, 0, 0, 0, 0, 0, 0
    .long 7, 0, 0, 0, 7, 0, 0, 63, 0, 0, 0, 0, 0, 0, 0, 0
    .long 0, 0, 0, 0, 0, 0, 0, 0, 0, 0, 0, 0, 0, 0, 0, 0
    .long 4, 24, 24, 8192, 4096, 266240, 8388608, 0, 32768, 4, 21037056, 131072, 0, 0, 218104385, 0
    .long 4, 24, 24, 8192, 4352, 266496, 8388608, 0, 32768, 4, 21041152, 131072, 0, 0, 218104385, 0
    .long 4, 24, 24, 8192, 4608, 266752, 8388608, 0, 32768, 4, 21045248, 131072, 0, 0, 218104385, 0
    .long 4, 24, 24, 8192, 4864, 267008, 8388608, 0, 32768, 4, 21049344, 131072, 0, 0, 218104385, 0
    .long 4, 24, 24, 8192, 5120, 267264, 8388608, 0, 32768, 4, 21053440, 131072, 0, 0, 218104401, 0
    .long 4, 24, 24, 8192, 5376, 267520, 8388608, 0, 32768, 4, 21057536, 131072, 0, 0, 218104401, 0
    .long 4, 24, 24, 8192, 5632, 267776, 8388608, 0, 32768, 4, 21061632, 131072, 0, 0, 218104401, 0
    .long 4, 24, 24, 8192, 5888, 268032, 8388608, 0, 32768, 4, 21065728, 131072, 0, 0, 218104401, 0
    .long 4, 32, 32, 8192, 4096, 266240, 8388608, 0, 32768, 4, 37814272, 131072, 0, 0, 218104385, 0
    .long 4, 32, 32, 8192, 4352, 266496, 8388608, 0, 32768, 4, 37818368, 131072, 0, 0, 218104385, 0
    .long 4, 32, 32, 8192, 4608, 266752, 8388608, 0, 32768, 4, 37822464, 131072, 0, 0, 218104385, 0
    .long 4, 32, 32, 8192, 4864, 267008, 8388608, 0, 32768, 4, 37826560, 131072, 0, 0, 218104385, 0
    .long 4, 32, 32, 8192, 5120, 267264, 8388608, 0, 32768, 4, 37830656, 131072, 0, 0, 218104401, 0
    .long 4, 32, 32, 8192, 5376, 267520, 8388608, 0, 32768, 4, 37834752, 131072, 0, 0, 218104401, 0
    .long 4, 32, 32, 8192, 5632, 267776, 8388608, 0, 32768, 4, 37838848, 131072, 0, 0, 218104401, 0
    .long 4, 32, 32, 8192, 5888, 268032, 8388608, 0, 32768, 4, 37842944, 131072, 0, 0, 218104401, 0
    .long 4, 24, 24, 8192, 4096, 266240, 8388608, 262144, 32768, 4, 22085632, 131072, 0, 0, 218104388, 0
    .long 4, 24, 24, 8192, 4352, 266496, 8388608, 262144, 32768, 4, 22089728, 131072, 0, 0, 218104388, 0
    .long 4, 24, 24, 8192, 4608, 266752, 8388608, 262144, 32768, 4, 22093824, 131072, 0, 0, 218104388, 0
    .long 4, 24, 24, 8192, 4864, 267008, 8388608, 262144, 32768, 4, 22097920, 131072, 0, 0, 218104388, 0
    .long 4, 24, 24, 8192, 5120, 267264, 8388608, 262144, 32768, 4, 22102016, 131072, 0, 0, 218104404, 0
    .long 4, 24, 24, 8192, 5376, 267520, 8388608, 262144, 32768, 4, 22106112, 131072, 0, 0, 218104404, 0
    .long 4, 24, 24, 8192, 5632, 267776, 8388608, 262144, 32768, 4, 22110208, 131072, 0, 0, 218104404, 0
    .long 4, 24, 24, 8192, 5888, 268032, 8388608, 262144, 32768, 4, 22114304, 131072, 0, 0, 218104404, 0
    .long 4, 32, 32, 8192, 4096, 266240, 8388608, 262144, 32768, 4, 38862848, 131072, 0, 0, 218104388, 0
    .long 4, 32, 32, 8192, 4352, 266496, 8388608, 262144, 32768, 4, 38866944, 131072, 0, 0, 218104388, 0
    .long 4, 32, 32, 8192, 4608, 266752, 8388608, 262144, 32768, 4, 38871040, 131072, 0, 0, 218104388, 0
    .long 4, 32, 32, 8192, 4864, 267008, 8388608, 262144, 32768, 4, 38875136, 131072, 0, 0, 218104388, 0
    .long 4, 32, 32, 8192, 5120, 267264, 8388608, 262144, 32768, 4, 38879232, 131072, 0, 0, 218104404, 0
    .long 4, 32, 32, 8192, 5376, 267520, 8388608, 262144, 32768, 4, 38883328, 131072, 0, 0, 218104404, 0
    .long 4, 32, 32, 8192, 5632, 267776, 8388608, 262144, 32768, 4, 38887424, 131072, 0, 0, 218104404, 0
    .long 4, 32, 32, 8192, 5888, 268032, 8388608, 262144, 32768, 4, 38891520, 131072, 0, 0, 218104404, 0
    .long 4, 32, 32, 8192, 5120, 267264, 8388608, 524288, 32768, 4, 39927808, 131072, 0, 0, 218104657, 0
    .long 4, 32, 32, 8192, 4864, 267008, 8388608, 524288, 32768, 4, 39923712, 131072, 0, 0, 218104641, 0
    .long 4, 32, 32, 8192, 5632, 267776, 8388608, 786432, 32768, 4, 40984576, 131072, 0, 0, 218104660, 0
    .long 4, 24, 24, 8192, 5632, 267776, 8388608, 524288, 32768, 4, 23158784, 131072, 0, 0, 218104657, 0
    .long 4, 32, 32, 8192, 5120, 267264, 8388608, 786432, 32768, 4, 40976384, 131072, 0, 0, 218104660, 0
    .long 4, 32, 32, 8192, 4608, 266752, 8388608, 786432, 32768, 4, 40968192, 131072, 0, 0, 218104644, 0
    .long 4, 32, 32, 8192, 4096, 266240, 8388608, 524288, 32768, 4, 39911424, 131072, 0, 0, 218104641, 0
    .long 4, 24, 24, 8192, 5120, 267264, 8388608, 786432, 32768, 4, 24199168, 131072, 0, 0, 218104660, 0
    .long 4, 24, 24, 8192, 4096, 266240, 8388608, 524288, 32768, 4, 23134208, 131072, 0, 0, 218104641, 0
    .long 4, 32, 32, 8192, 5376, 267520, 8388608, 786432, 32768, 4, 40980480, 131072, 0, 0, 218104660, 0
    .long 4, 24, 24, 8192, 4864, 267008, 8388608, 786432, 32768, 4, 24195072, 131072, 0, 0, 218104644, 0
    .long 4, 24, 24, 8192, 4352, 266496, 8388608, 524288, 32768, 4, 23138304, 131072, 0, 0, 218104641, 0
    .long 4, 32, 32, 8192, 4864, 267008, 8388608, 786432, 32768, 4, 40972288, 131072, 0, 0, 218104644, 0
    .long 4, 24, 24, 8192, 5376, 267520, 8388608, 524288, 32768, 4, 23154688, 131072, 0, 0, 218104657, 0
    .long 4, 24, 24, 8192, 5632, 267776, 8388608, 786432, 32768, 4, 24207360, 131072, 0, 0, 218104660, 0
    .long 4, 24, 24, 8192, 5888, 268032, 8388608, 524288, 32768, 4, 23162880, 131072, 0, 0, 218104657, 0
    .long 4, 32, 32, 8192, 4608, 266752, 8388608, 524288, 32768, 4, 39919616, 131072, 0, 0, 218104641, 0
    .long 4, 32, 32, 8192, 5888, 268032, 8388608, 524288, 32768, 4, 39940096, 131072, 0, 0, 218104657, 0
    .long 4, 24, 24, 8192, 5376, 267520, 8388608, 786432, 32768, 4, 24203264, 131072, 0, 0, 218104660, 0
    .long 4, 32, 32, 8192, 4352, 266496, 8388608, 524288, 32768, 4, 39915520, 131072, 0, 0, 218104641, 0
    .long 4, 32, 32, 8192, 4096, 266240, 8388608, 786432, 32768, 4, 40960000, 131072, 0, 0, 218104644, 0
    .long 4, 24, 24, 8192, 4352, 266496, 8388608, 786432, 32768, 4, 24186880, 131072, 0, 0, 218104644, 0
    .long 4, 32, 32, 8192, 5376, 267520, 8388608, 524288, 32768, 4, 39931904, 131072, 0, 0, 218104657, 0
    .long 4, 24, 24, 8192, 4608, 266752, 8388608, 786432, 32768, 4, 24190976, 131072, 0, 0, 218104644, 0
    .long 4, 24, 24, 8192, 4096, 266240, 8388608, 786432, 32768, 4, 24182784, 131072, 0, 0, 218104644, 0
    .long 4, 24, 24, 8192, 4608, 266752, 8388608, 524288, 32768, 4, 23142400, 131072, 0, 0, 218104641, 0
    .long 4, 24, 24, 8192, 4864, 267008, 8388608, 524288, 32768, 4, 23146496, 131072, 0, 0, 218104641, 0
    .long 2, 64, 72, 7168, 4096, 4096, 7340032, 1572864, 32768, 8, 60096512, 114688, 0, 0, 218104017, 0
    .long 4, 32, 32, 8192, 5632, 267776, 8388608, 524288, 32768, 4, 39936000, 131072, 0, 0, 218104657, 0
    .long 4, 24, 24, 8192, 5888, 268032, 8388608, 786432, 32768, 4, 24211456, 131072, 0, 0, 218104660, 0
    .long 4, 32, 32, 8192, 5888, 268032, 8388608, 786432, 32768, 4, 40988672, 131072, 0, 0, 218104660, 0
    .long 4, 24, 24, 8192, 5120, 267264, 8388608, 524288, 32768, 4, 23150592, 131072, 0, 0, 218104657, 0
    .long 1, 16, 16, 8192, 5632, 5888, 8388608, 1048576, 32768, 8, 8478720, 131072, 0, 0, 218104922, 0
    .long 1, 24, 24, 8192, 4096, 4352, 8388608, 1048576, 32768, 8, 25231360, 131072, 0, 0, 218104906, 0
    .long 1, 16, 16, 8192, 4608, 4864, 8388608, 1048576, 32768, 8, 8462336, 131072, 0, 0, 218104906, 0
    .long 1, 32, 32, 8192, 5632, 5888, 8388608, 1048576, 32768, 8, 42033152, 131072, 0, 0, 218104922, 0
    .long 1, 32, 32, 8192, 4608, 4864, 8388608, 1048576, 32768, 8, 42016768, 131072, 0, 0, 218104906, 0
    .long 1, 16, 16, 8192, 5120, 5376, 8388608, 1048576, 32768, 8, 8470528, 131072, 0, 0, 218104922, 0
    .long 1, 24, 24, 8192, 5120, 5376, 8388608, 1048576, 32768, 8, 25247744, 131072, 0, 0, 218104922, 0
    .long 1, 24, 24, 8192, 4096, 4352, 8388608, 1572864, 32768, 8, 27328512, 131072, 0, 0, 218105162, 0
    .long 1, 32, 32, 8192, 4608, 4864, 8388608, 1572864, 32768, 8, 44113920, 131072, 0, 0, 218105162, 0
    .long 1, 16, 16, 8192, 5632, 5888, 8388608, 1572864, 32768, 8, 10575872, 131072, 0, 0, 218105178, 0
    .long 1, 24, 24, 8192, 4608, 4864, 8388608, 1048576, 32768, 8, 25239552, 131072, 0, 0, 218104906, 0
    .long 1, 32, 32, 8192, 4096, 4352, 8388608, 1048576, 32768, 8, 42008576, 131072, 0, 0, 218104906, 0
    .long 4, 32, 32, 8192, 4352, 266496, 8388608, 786432, 32768, 4, 40964096, 131072, 0, 0, 218104644, 0
    .long 1, 16, 16, 8192, 5632, 5888, 8388608, 2097152, 32768, 8, 12673024, 131072, 0, 0, 218105434, 0
    .long 1, 32, 32, 8192, 5120, 5376, 8388608, 1048576, 32768, 8, 42024960, 131072, 0, 0, 218104922, 0
    .long 1, 32, 32, 8192, 5120, 5376, 8388608, 1572864, 32768, 8, 44122112, 131072, 0, 0, 218105178, 0
    .long 1, 16, 16, 8192, 4096, 4352, 8388608, 1048576, 32768, 8, 8454144, 131072, 0, 0, 218104906, 0
    .long 1, 24, 24, 8192, 5632, 5888, 8388608, 1048576, 32768, 8, 25255936, 131072, 0, 0, 218104922, 0
    .long 1, 24, 24, 8192, 4608, 4864, 8388608, 2097152, 32768, 8, 29433856, 131072, 0, 0, 218105418, 0
    .long 1, 16, 16, 8192, 5120, 5376, 8388608, 2097152, 32768, 8, 12664832, 131072, 0, 0, 218105434, 0
    .long 1, 16, 16, 8192, 4096, 4352, 8388608, 1572864, 32768, 8, 10551296, 131072, 0, 0, 218105162, 0
    .long 1, 32, 32, 8192, 4608, 4864, 8388608, 2097152, 32768, 8, 46211072, 131072, 0, 0, 218105418, 0
    .long 1, 16, 16, 8192, 5120, 5376, 8388608, 1572864, 32768, 8, 10567680, 131072, 0, 0, 218105178, 0
    .long 1, 24, 24, 8192, 5632, 5888, 8388608, 1572864, 32768, 8, 27353088, 131072, 0, 0, 218105178, 0
    .long 1, 32, 32, 8192, 5632, 5888, 8388608, 1572864, 32768, 8, 44130304, 131072, 0, 0, 218105178, 0
    .long 1, 24, 24, 8192, 4608, 4864, 8388608, 1572864, 32768, 8, 27336704, 131072, 0, 0, 218105162, 0
    .long 1, 32, 32, 8192, 4096, 4352, 8388608, 2097152, 32768, 8, 46202880, 131072, 0, 0, 218105418, 0
    .long 1, 16, 16, 8192, 4608, 4864, 8388608, 1572864, 32768, 8, 10559488, 131072, 0, 0, 218105162, 0
    .long 1, 32, 32, 8192, 4096, 4352, 8388608, 1572864, 32768, 8, 44105728, 131072, 0, 0, 218105162, 0
    .long 1, 24, 24, 8192, 5120, 5376, 8388608, 1572864, 32768, 8, 27344896, 131072, 0, 0, 218105178, 0
    .long 1, 24, 24, 8192, 5120, 5376, 8388608, 2097152, 32768, 8, 29442048, 131072, 0, 0, 218105434, 0
    .long 1, 16, 16, 8192, 5120, 5376, 8388608, 2621440, 32768, 8, 14761984, 131072, 0, 0, 218105690, 0
    .long 2, 64, 72, 7168, 3584, 3584, 7340032, 1572864, 32768, 8, 60088320, 114688, 0, 0, 218104017, 0
    .long 1, 32, 32, 8192, 5120, 5376, 8388608, 2097152, 32768, 8, 46219264, 131072, 0, 0, 218105434, 0
    .long 1, 24, 24, 8192, 5632, 5888, 8388608, 2097152, 32768, 8, 29450240, 131072, 0, 0, 218105434, 0
    .long 2, 64, 72, 7168, 4608, 4608, 7340032, 3145728, 32768, 8, 65609728, 114688, 0, 0, 218104209, 0
    .long 1, 16, 16, 8192, 4608, 4864, 8388608, 2097152, 32768, 8, 12656640, 131072, 0, 0, 218105418, 0
    .long 1, 24, 24, 8192, 4096, 4352, 8388608, 2621440, 32768, 8, 31522816, 131072, 0, 0, 218105674, 0
    .long 2, 64, 72, 7168, 4864, 4864, 7340032, 2621440, 32768, 8, 63778816, 114688, 0, 0, 218104145, 0
    .long 1, 24, 24, 8192, 4096, 4352, 8388608, 3670016, 32768, 8, 35717120, 131072, 0, 0, 218106186, 0
    .long 1, 16, 16, 8192, 4608, 4864, 8388608, 524288, 32768, 8, 6365184, 131072, 0, 0, 218108234, 0
    .long 1, 32, 32, 8192, 5120, 5376, 8388608, 3145728, 32768, 8, 50413568, 131072, 0, 0, 218105946, 0
    .long 2, 64, 72, 7168, 3584, 3584, 7340032, 3145728, 32768, 8, 65593344, 114688, 0, 0, 218104209, 0
    .long 1, 24, 24, 8192, 4608, 4864, 8388608, 2621440, 32768, 8, 31531008, 131072, 0, 0, 218105674, 0
    .long 1, 16, 16, 8192, 4608, 4864, 8388608, 3670016, 32768, 8, 18948096, 131072, 0, 0, 218106186, 0
    .long 2, 64, 72, 7168, 4608, 4608, 7340032, 2621440, 32768, 8, 63774720, 114688, 0, 0, 218104145, 0
    .long 1, 24, 24, 8192, 5632, 5888, 8388608, 2621440, 32768, 8, 31547392, 131072, 0, 0, 218105690, 0
    .long 1, 24, 24, 8192, 4096, 4352, 8388608, 2097152, 32768, 8, 29425664, 131072, 0, 0, 218105418, 0
    .long 1, 24, 24, 8192, 4608, 4864, 8388608, 3145728, 32768, 8, 33628160, 131072, 0, 0, 218105930, 0
    .long 1, 32, 32, 8192, 5632, 5888, 8388608, 2097152, 32768, 8, 46227456, 131072, 0, 0, 218105434, 0
    .long 1, 32, 32, 8192, 5120, 5376, 8388608, 2621440, 32768, 8, 48316416, 131072, 0, 0, 218105690, 0
    .long 2, 64, 72, 7168, 4864, 4864, 7340032, 3670016, 32768, 8, 67448832, 114688, 0, 0, 218104273, 0
    .long 1, 32, 32, 8192, 5632, 5888, 8388608, 3145728, 32768, 8, 50421760, 131072, 0, 0, 218105946, 0
    .long 1, 16, 16, 8192, 4096, 4352, 8388608, 2621440, 32768, 8, 14745600, 131072, 0, 0, 218105674, 0
    .long 1, 32, 32, 8192, 5632, 5888, 8388608, 2621440, 32768, 8, 48324608, 131072, 0, 0, 218105690, 0
    .long 2, 64, 72, 7168, 3584, 3584, 7340032, 524288, 32768, 8, 56418304, 114688, 0, 0, 218103889, 0
    .long 1, 16, 16, 8192, 4608, 4864, 8388608, 2621440, 32768, 8, 14753792, 131072, 0, 0, 218105674, 0
    .long 2, 64, 72, 7168, 4096, 4096, 7340032, 2097152, 32768, 8, 61931520, 114688, 0, 0, 218104081, 0
    .long 1, 16, 16, 8192, 4096, 4352, 8388608, 3145728, 32768, 8, 16842752, 131072, 0, 0, 218105930, 0
    .long 1, 24, 24, 8192, 5632, 5888, 8388608, 3145728, 32768, 8, 33644544, 131072, 0, 0, 218105946, 0
    .long 1, 16, 16, 8192, 4096, 4352, 8388608, 2097152, 32768, 8, 12648448, 131072, 0, 0, 218105418, 0
    .long 2, 64, 72, 7168, 3584, 3584, 7340032, 2097152, 32768, 8, 61923328, 114688, 0, 0, 218104081, 0
    .long 1, 16, 16, 8192, 4096, 4352, 8388608, 524288, 32768, 8, 6356992, 131072, 0, 0, 218108234, 0
    .long 1, 32, 32, 8192, 4608, 4864, 8388608, 2621440, 32768, 8, 48308224, 131072, 0, 0, 218105674, 0
    .long 1, 16, 16, 8192, 5120, 5376, 8388608, 524288, 32768, 8, 6373376, 131072, 0, 0, 218108250, 0
    .long 2, 64, 72, 7168, 4864, 4864, 7340032, 1572864, 32768, 8, 60108800, 114688, 0, 0, 218104017, 0
    .long 1, 24, 24, 8192, 5120, 5376, 8388608, 2621440, 32768, 8, 31539200, 131072, 0, 0, 218105690, 0
    .long 1, 16, 16, 8192, 5632, 5888, 8388608, 2621440, 32768, 8, 14770176, 131072, 0, 0, 218105690, 0
    .long 1, 16, 16, 8192, 5632, 5888, 8388608, 3145728, 32768, 8, 16867328, 131072, 0, 0, 218105946, 0
    .long 2, 64, 72, 7168, 4864, 4864, 7340032, 1048576, 32768, 8, 58273792, 114688, 0, 0, 218103953, 0
    .long 2, 64, 72, 7168, 4352, 4352, 7340032, 2097152, 32768, 8, 61935616, 114688, 0, 0, 218104081, 0
    .long 1, 16, 16, 8192, 4608, 4864, 8388608, 3145728, 32768, 8, 16850944, 131072, 0, 0, 218105930, 0
    .long 2, 64, 72, 7168, 5120, 5120, 7340032, 1572864, 32768, 8, 60112896, 114688, 0, 0, 218104017, 0
    .long 2, 64, 72, 7168, 5120, 5120, 7340032, 3145728, 32768, 8, 65617920, 114688, 0, 0, 218104209, 0
    .long 2, 64, 72, 7168, 4608, 4608, 7340032, 1048576, 32768, 8, 58269696, 114688, 0, 0, 218103953, 0
    .long 1, 16, 16, 8192, 5632, 5888, 8388608, 0, 32768, 8, 4284416, 131072, 0, 0, 218107994, 0
    .long 2, 64, 72, 7168, 5120, 5120, 7340032, 2097152, 32768, 8, 61947904, 114688, 0, 0, 218104081, 0
    .long 1, 32, 32, 8192, 4096, 4352, 8388608, 2621440, 32768, 8, 48300032, 131072, 0, 0, 218105674, 0
    .long 2, 64, 72, 7168, 4608, 4608, 7340032, 2097152, 32768, 8, 61939712, 114688, 0, 0, 218104081, 0
    .long 2, 64, 72, 7168, 5120, 5120, 7340032, 1048576, 32768, 8, 58277888, 114688, 0, 0, 218103953, 0
    .long 2, 64, 72, 7168, 4864, 4864, 7340032, 3145728, 32768, 8, 65613824, 114688, 0, 0, 218104209, 0
    .long 2, 64, 72, 7168, 4608, 4608, 7340032, 1572864, 32768, 8, 60104704, 114688, 0, 0, 218104017, 0
    .long 2, 64, 72, 7168, 4352, 4352, 7340032, 524288, 32768, 8, 56430592, 114688, 0, 0, 218103889, 0
    .long 1, 16, 16, 8192, 5120, 5376, 8388608, 0, 32768, 8, 4276224, 131072, 0, 0, 218107994, 0
    .long 1, 16, 16, 8192, 5632, 5888, 8388608, 524288, 32768, 8, 6381568, 131072, 0, 0, 218108250, 0
    .long 2, 64, 72, 7168, 4864, 4864, 7340032, 0, 32768, 8, 54603776, 114688, 0, 0, 218103825, 0
    .long 2, 64, 72, 7168, 4608, 4608, 7340032, 524288, 32768, 8, 56434688, 114688, 0, 0, 218103889, 0
    .long 2, 64, 72, 7168, 4352, 4352, 7340032, 1572864, 32768, 8, 60100608, 114688, 0, 0, 218104017, 0
    .long 2, 64, 72, 7168, 4864, 4864, 7340032, 2097152, 32768, 8, 61943808, 114688, 0, 0, 218104081, 0
    .long 2, 64, 72, 7168, 4864, 4864, 7340032, 524288, 32768, 8, 56438784, 114688, 0, 0, 218103889, 0
    .long 2, 64, 72, 7168, 4608, 4608, 7340032, 0, 32768, 8, 54599680, 114688, 0, 0, 218103825, 0
    .long 1, 24, 24, 8192, 5120, 5376, 8388608, 3145728, 32768, 8, 33636352, 131072, 0, 0, 218105946, 0
    .long 2, 64, 72, 7168, 3840, 3840, 7340032, 2097152, 32768, 8, 61927424, 114688, 0, 0, 218104081, 0
    .long 2, 64, 72, 7168, 3840, 3840, 7340032, 1572864, 32768, 8, 60092416, 114688, 0, 0, 218104017, 0
    .long 1, 16, 16, 8192, 4608, 4864, 8388608, 0, 32768, 8, 4268032, 131072, 0, 0, 218107978, 0
    .long 5, 218108224, 0, 0, 16, 0, 0, 8, 0, 0, 0, 0, 218112256, 11, 218106961, 0
    .long 2, 64, 72, 7168, 3840, 3840, 7340032, 0, 32768, 8, 54587392, 114688, 0, 0, 218103825, 0
    .long 2, 64, 72, 7168, 3840, 3840, 7340032, 2621440, 32768, 8, 63762432, 114688, 0, 0, 218104145, 0
    .long 2, 64, 72, 7168, 3840, 3840, 7340032, 3145728, 32768, 8, 65597440, 114688, 0, 0, 218104209, 0
    .long 2, 64, 72, 7168, 5120, 5120, 7340032, 524288, 32768, 8, 56442880, 114688, 0, 0, 218103889, 0
    .long 1, 16, 16, 8192, 4096, 4352, 8388608, 0, 32768, 8, 4259840, 131072, 0, 0, 218107978, 0
    .long 2, 64, 72, 7168, 5120, 5120, 7340032, 2621440, 32768, 8, 63782912, 114688, 0, 0, 218104145, 0
    .long 1, 32, 32, 8192, 4608, 4864, 8388608, 3670016, 32768, 8, 52502528, 131072, 0, 0, 218106186, 0
    .long 1, 16, 16, 8192, 5120, 5376, 8388608, 3145728, 32768, 8, 16859136, 131072, 0, 0, 218105946, 0
    .long 2, 64, 72, 7168, 4096, 4096, 7340032, 2621440, 32768, 8, 63766528, 114688, 0, 0, 218104145, 0
    .long 2, 64, 72, 7168, 3840, 3840, 7340032, 524288, 32768, 8, 56422400, 114688, 0, 0, 218103889, 0
    .long 1, 16, 16, 8192, 4096, 4352, 8388608, 3670016, 32768, 8, 18939904, 131072, 0, 0, 218106186, 0
    .long 2, 64, 72, 7168, 4352, 4352, 7340032, 0, 32768, 8, 54595584, 114688, 0, 0, 218103825, 0
    .long 2, 64, 72, 7168, 4096, 4096, 7340032, 0, 32768, 8, 54591488, 114688, 0, 0, 218103825, 0
    .long 1, 16, 16, 8192, 5120, 5376, 8388608, 3670016, 32768, 8, 18956288, 131072, 0, 0, 218106202, 0
    .long 2, 64, 72, 7168, 5120, 5120, 7340032, 0, 32768, 8, 54607872, 114688, 0, 0, 218103825, 0
    .long 2, 64, 72, 7168, 4352, 4352, 7340032, 3670016, 32768, 8, 67440640, 114688, 0, 0, 218104273, 0
    .long 1, 24, 24, 8192, 4096, 4352, 8388608, 3145728, 32768, 8, 33619968, 131072, 0, 0, 218105930, 0
    .long 1, 32, 32, 8192, 4608, 4864, 8388608, 3145728, 32768, 8, 50405376, 131072, 0, 0, 218105930, 0
    .long 2, 64, 72, 7168, 3584, 3584, 7340032, 2621440, 32768, 8, 63758336, 114688, 0, 0, 218104145, 0
    .long 1, 40, 40, 2048, 4194304, 4194560, 8388608, 180420608, 131072, 8, 84934656, 32768, 218112256, 24, 218106500, 0
    .long 2, 64, 72, 7168, 4096, 4096, 7340032, 1048576, 32768, 8, 58261504, 114688, 0, 0, 218103953, 0
    .long 2, 64, 72, 7168, 4352, 4352, 7340032, 3145728, 32768, 8, 65605632, 114688, 0, 0, 218104209, 0
    .long 2, 64, 72, 7168, 4352, 4352, 7340032, 1048576, 32768, 8, 58265600, 114688, 0, 0, 218103953, 0
    .long 5, 218108240, 0, 0, 20, 0, 0, 12, 0, 0, 0, 0, 218112256, 15, 218106961, 0
    .long 1, 32, 32, 8192, 4096, 4352, 8388608, 3145728, 32768, 8, 50397184, 131072, 0, 0, 218105930, 0
    .long 2, 64, 72, 7168, 4096, 4096, 7340032, 3145728, 32768, 8, 65601536, 114688, 0, 0, 218104209, 0
    .long 2, 64, 72, 7168, 4096, 4096, 7340032, 524288, 32768, 8, 56426496, 114688, 0, 0, 218103889, 0
    .long 2, 64, 72, 7168, 3840, 3840, 7340032, 1048576, 32768, 8, 58257408, 114688, 0, 0, 218103953, 0
    .long 2, 64, 72, 7168, 3584, 3584, 7340032, 1048576, 32768, 8, 58253312, 114688, 0, 0, 218103953, 0
    .long 2, 64, 72, 7168, 3584, 3584, 7340032, 0, 32768, 8, 54583296, 114688, 0, 0, 218103825, 0
    .long 2, 64, 72, 7168, 4352, 4352, 7340032, 2621440, 32768, 8, 63770624, 114688, 0, 0, 218104145, 0
    .long 1, 80, 80, 2048, 3671040, 3671296, 7340032, 61923328, 114688, 7, 127942656, 32768, 218104080, 7, 218106625, 0
    .long 5, 218108224, 0, 0, 16, 0, 0, 12, 0, 0, 0, 0, 218112256, 15, 218106961, 0
    .long 1, 80, 80, 2048, 3670016, 3670272, 7340032, 61923328, 114688, 7, 127926272, 32768, 218104080, 7, 218106625, 0
    .long 1, 40, 40, 2048, 4194816, 4195072, 8388608, 180420608, 131072, 8, 84942848, 32768, 218112256, 24, 218106500, 0
    .long 1, 32, 32, 8192, 5120, 5376, 8388608, 3670016, 32768, 8, 52510720, 131072, 0, 0, 218106202, 0
    .long 1, 24, 24, 8192, 5120, 5376, 8388608, 3670016, 32768, 8, 35733504, 131072, 0, 0, 218106202, 0
    .long 1, 24, 24, 8192, 5632, 5888, 8388608, 3670016, 32768, 8, 35741696, 131072, 0, 0, 218106202, 0
    .long 5, 218107984, 0, 0, 20, 0, 0, 0, 0, 0, 0, 0, 218112256, 3, 218106897, 0
    .long 1, 32, 32, 8192, 4096, 4352, 8388608, 3670016, 32768, 8, 52494336, 131072, 0, 0, 218106186, 0
    .long 1, 16, 16, 8192, 5632, 5888, 8388608, 3670016, 32768, 8, 18964480, 131072, 0, 0, 218106202, 0
    .long 1, 80, 80, 2048, 3670528, 3670784, 7340032, 60088320, 114688, 7, 127410176, 32768, 218104016, 7, 218106561, 0
    .long 1, 40, 40, 2048, 4194816, 4195072, 8388608, 182517760, 131072, 8, 85467136, 32768, 218112256, 32, 218106564, 0
    .long 1, 32, 32, 8192, 5632, 5888, 8388608, 3670016, 32768, 8, 52518912, 131072, 0, 0, 218106202, 0
    .long 5, 218107968, 0, 0, 16, 0, 0, 0, 0, 0, 0, 0, 218112256, 3, 218106897, 0
    .long 2, 64, 72, 7168, 3840, 3840, 7340032, 3670016, 32768, 8, 67432448, 114688, 0, 0, 218104273, 0
    .long 5, 218107984, 0, 0, 20, 0, 0, 4, 0, 0, 0, 0, 218112256, 7, 218106897, 0
    .long 5, 218107968, 0, 0, 16, 0, 0, 4, 0, 0, 0, 0, 218112256, 7, 218106897, 0
    .long 2, 64, 72, 7168, 3584, 3584, 7340032, 3670016, 32768, 8, 67428352, 114688, 0, 0, 218104273, 0
    .long 1, 24, 24, 8192, 4608, 4864, 8388608, 3670016, 32768, 8, 35725312, 131072, 0, 0, 218106186, 0
    .long 2, 64, 72, 7168, 5120, 5120, 7340032, 3670016, 32768, 8, 67452928, 114688, 0, 0, 218104273, 0
    .long 5, 218108240, 0, 0, 20, 0, 0, 8, 0, 0, 0, 0, 218112256, 11, 218106961, 0
    .long 1, 40, 40, 2048, 4195328, 4195584, 8388608, 182517760, 131072, 8, 85475328, 32768, 218112256, 32, 218106564, 0
    .long 1, 40, 40, 2048, 4194304, 4194560, 8388608, 182517760, 131072, 8, 85458944, 32768, 218112256, 32, 218106564, 0
    .long 1, 40, 40, 2048, 4195840, 4196096, 8388608, 182517760, 131072, 8, 85483520, 32768, 218112256, 32, 218106564, 0
    .long 1, 40, 40, 2048, 4195328, 4195584, 8388608, 180420608, 131072, 8, 84951040, 32768, 218112256, 24, 218106500, 0
    .long 1, 40, 40, 2048, 4195840, 4196096, 8388608, 180420608, 131072, 8, 84959232, 32768, 218112256, 24, 218106500, 0
    .long 1, 80, 80, 2048, 3670016, 3670272, 7340032, 60088320, 114688, 7, 127401984, 32768, 218104016, 7, 218106561, 0
    .long 2, 64, 72, 7168, 4096, 4096, 7340032, 3670016, 32768, 8, 67436544, 114688, 0, 0, 218104273, 0
    .long 1, 80, 80, 2048, 3671552, 3671808, 7340032, 60088320, 114688, 7, 127426560, 32768, 218104016, 7, 218106561, 0
    .long 1, 80, 80, 2048, 3670016, 3670272, 7340032, 65593344, 114688, 7, 128974848, 32768, 218104208, 7, 218106753, 0
    .long 1, 80, 80, 2048, 3671552, 3671808, 7340032, 65593344, 114688, 7, 128999424, 32768, 218104208, 7, 218106753, 0
    .long 1, 80, 80, 2048, 3671040, 3671296, 7340032, 60088320, 114688, 7, 127418368, 32768, 218104016, 7, 218106561, 0
    .long 1, 80, 80, 2048, 3670528, 3670784, 7340032, 61923328, 114688, 7, 127934464, 32768, 218104080, 7, 218106625, 0
    .long 2, 64, 72, 7168, 4608, 4608, 7340032, 3670016, 32768, 8, 67444736, 114688, 0, 0, 218104273, 0
    .long 1, 80, 80, 2048, 3671040, 3671296, 7340032, 58253312, 114688, 7, 126894080, 32768, 218103952, 7, 218106497, 0
    .long 1, 80, 80, 2048, 3670528, 3670784, 7340032, 65593344, 114688, 7, 128983040, 32768, 218104208, 7, 218106753, 0
    .long 1, 80, 80, 2048, 3671040, 3671296, 7340032, 63758336, 114688, 7, 128466944, 32768, 218104144, 7, 218106689, 0
    .long 1, 80, 80, 2048, 3671040, 3671296, 7340032, 65593344, 114688, 7, 128991232, 32768, 218104208, 7, 218106753, 0
    .long 1, 80, 80, 2048, 3670528, 3670784, 7340032, 58253312, 114688, 7, 126885888, 32768, 218103952, 7, 218106497, 0
    .long 1, 40, 40, 2048, 4195328, 4195584, 8388608, 184614912, 131072, 8, 85999616, 32768, 218112256, 40, 218106628, 0
    .long 1, 80, 80, 2048, 3670016, 3670272, 7340032, 58253312, 114688, 7, 126877696, 32768, 218103952, 7, 218106497, 0
    .long 1, 40, 40, 2048, 4194816, 4195072, 8388608, 184614912, 131072, 8, 85991424, 32768, 218112256, 40, 218106628, 0
    .long 1, 80, 80, 2048, 3671552, 3671808, 7340032, 58253312, 114688, 7, 126902272, 32768, 218103952, 7, 218106497, 0
    .long 1, 80, 80, 2048, 3671552, 3671808, 7340032, 61923328, 114688, 7, 127950848, 32768, 218104080, 7, 218106625, 0
    .long 1, 40, 40, 2048, 4194304, 4194560, 8388608, 176226304, 131072, 8, 83886080, 32768, 218106896, 4, 218106372, 0
    .long 1, 40, 40, 2048, 4194304, 4194560, 8388608, 184614912, 131072, 8, 85983232, 32768, 218112256, 40, 218106628, 0
    .long 1, 40, 40, 2048, 4195840, 4196096, 8388608, 184614912, 131072, 8, 86007808, 32768, 218112256, 40, 218106628, 0
    .long 1, 40, 40, 2048, 4195840, 4196096, 8388608, 176226304, 131072, 8, 83910656, 32768, 218106896, 4, 218106372, 0
    .long 1, 40, 40, 2048, 4195328, 4195584, 8388608, 176226304, 131072, 8, 83902464, 32768, 218106896, 4, 218106372, 0
    .long 1, 40, 40, 2048, 4194816, 4195072, 8388608, 176226304, 131072, 8, 83894272, 32768, 218106896, 4, 218106372, 0
    .long 1, 80, 80, 2048, 3671040, 3671296, 7340032, 54583296, 114688, 7, 125845504, 32768, 218103824, 7, 218106369, 0
    .long 1, 80, 80, 2048, 3670016, 3670272, 7340032, 54583296, 114688, 7, 125829120, 32768, 218103824, 7, 218106369, 0
    .long 1, 40, 40, 2048, 4194304, 4194560, 8388608, 178323456, 131072, 8, 84410368, 32768, 218106960, 4, 218106436, 0
    .long 1, 40, 40, 2048, 4195328, 4195584, 8388608, 178323456, 131072, 8, 84426752, 32768, 218106960, 4, 218106436, 0
    .long 1, 40, 40, 2048, 4195840, 4196096, 8388608, 178323456, 131072, 8, 84434944, 32768, 218106960, 4, 218106436, 0
    .long 1, 40, 40, 2048, 4194816, 4195072, 8388608, 178323456, 131072, 8, 84418560, 32768, 218106960, 4, 218106436, 0
    .long 1, 80, 80, 2048, 3671552, 3671808, 7340032, 54583296, 114688, 7, 125853696, 32768, 218103824, 7, 218106369, 0
    .long 1, 80, 80, 2048, 3670016, 3670272, 7340032, 63758336, 114688, 7, 128450560, 32768, 218104144, 7, 218106689, 0
    .long 1, 80, 80, 2048, 3671552, 3671808, 7340032, 56418304, 114688, 7, 126377984, 32768, 218103888, 7, 218106433, 0
    .long 1, 80, 80, 2048, 3670016, 3670272, 7340032, 56418304, 114688, 7, 126353408, 32768, 218103888, 7, 218106433, 0
    .long 1, 80, 80, 2048, 3671040, 3671296, 7340032, 56418304, 114688, 7, 126369792, 32768, 218103888, 7, 218106433, 0
    .long 1, 80, 80, 2048, 3670528, 3670784, 7340032, 54583296, 114688, 7, 125837312, 32768, 218103824, 7, 218106369, 0
    .long 1, 80, 80, 2048, 3671552, 3671808, 7340032, 63758336, 114688, 7, 128475136, 32768, 218104144, 7, 218106689, 0
    .long 1, 80, 80, 2048, 3670528, 3670784, 7340032, 56418304, 114688, 7, 126361600, 32768, 218103888, 7, 218106433, 0
    .long 1, 80, 80, 2048, 3670528, 3670784, 7340032, 63758336, 114688, 7, 128458752, 32768, 218104144, 7, 218106689, 0
    .long 6, 0, 0, 0, 2, 0, 0, 27, 0, 0, 0, 0, 0, 0, 0, 0
    .long 1, 40, 40, 2048, 4195840, 4196096, 8388608, 186712064, 131072, 8, 86532096, 32768, 218112256, 48, 218106692, 0
    .long 1, 40, 40, 2048, 4194816, 4195072, 8388608, 186712064, 131072, 8, 86515712, 32768, 218112256, 48, 218106692, 0
    .long 1, 40, 40, 2048, 4194304, 4194560, 8388608, 186712064, 131072, 8, 86507520, 32768, 218112256, 48, 218106692, 0
    .long 1, 40, 40, 2048, 4195328, 4195584, 8388608, 186712064, 131072, 8, 86523904, 32768, 218112256, 48, 218106692, 0
    .long 1, 80, 80, 2048, 3671552, 3671808, 7340032, 67428352, 114688, 7, 129523712, 32768, 218104272, 7, 218106817, 0
    .long 1, 80, 80, 2048, 3670016, 3670272, 7340032, 67428352, 114688, 7, 129499136, 32768, 218104272, 7, 218106817, 0
    .long 1, 80, 80, 2048, 3671040, 3671296, 7340032, 67428352, 114688, 7, 129515520, 32768, 218104272, 7, 218106817, 0
    .long 1, 80, 80, 2048, 3670528, 3670784, 7340032, 67428352, 114688, 7, 129507328, 32768, 218104272, 7, 218106817, 0
    .long 6, 0, 0, 0, 2, 0, 0, 25, 0, 0, 0, 0, 0, 0, 0, 0
    .long 6, 0, 0, 0, 2, 0, 0, 22, 0, 0, 0, 0, 0, 0, 0, 0
    .long 6, 0, 0, 0, 2, 0, 0, 29, 0, 0, 0, 0, 0, 0, 0, 0
    .long 6, 0, 0, 0, 2, 0, 0, 38, 0, 0, 0, 0, 0, 0, 0, 0
    .long 6, 0, 0, 0, 2, 0, 0, 30, 0, 0, 0, 0, 0, 0, 0, 0
    .long 6, 0, 0, 0, 2, 0, 0, 20, 0, 0, 0, 0, 0, 0, 0, 0
    .long 6, 0, 0, 0, 2, 0, 0, 16, 0, 0, 0, 0, 0, 0, 0, 0
    .long 6, 0, 0, 0, 2, 0, 0, 26, 0, 0, 0, 0, 0, 0, 0, 0
    .long 6, 0, 0, 0, 2, 0, 0, 12, 0, 0, 0, 0, 0, 0, 0, 0
    .long 6, 0, 0, 0, 2, 0, 0, 39, 0, 0, 0, 0, 0, 0, 0, 0
    .long 6, 0, 0, 0, 2, 0, 0, 37, 0, 0, 0, 0, 0, 0, 0, 0
    .long 6, 0, 0, 0, 2, 0, 0, 36, 0, 0, 0, 0, 0, 0, 0, 0
    .long 6, 0, 0, 0, 2, 0, 0, 48, 0, 0, 0, 0, 0, 0, 0, 0
    .long 6, 0, 0, 0, 2, 0, 0, 4, 0, 0, 0, 0, 0, 0, 0, 0
    .long 6, 0, 0, 0, 2, 0, 0, 2, 0, 0, 0, 0, 0, 0, 0, 0
    .long 6, 0, 0, 0, 2, 0, 0, 31, 0, 0, 0, 0, 0, 0, 0, 0
    .long 6, 0, 0, 0, 2, 0, 0, 21, 0, 0, 0, 0, 0, 0, 0, 0
    .long 6, 0, 0, 0, 2, 0, 0, 24, 0, 0, 0, 0, 0, 0, 0, 0
    .long 6, 0, 0, 0, 2, 0, 0, 19, 0, 0, 0, 0, 0, 0, 0, 0
    .long 6, 0, 0, 0, 2, 0, 0, 33, 0, 0, 0, 0, 0, 0, 0, 0
    .long 6, 0, 0, 0, 2, 0, 0, 35, 0, 0, 0, 0, 0, 0, 0, 0
    .long 6, 0, 0, 0, 2, 0, 0, 3, 0, 0, 0, 0, 0, 0, 0, 0
    .long 6, 0, 0, 0, 2, 0, 0, 51, 0, 0, 0, 0, 0, 0, 0, 0
    .long 6, 0, 0, 0, 2, 0, 0, 6, 0, 0, 0, 0, 0, 0, 0, 0
    .long 6, 0, 0, 0, 2, 0, 0, 17, 0, 0, 0, 0, 0, 0, 0, 0
    .long 6, 0, 0, 0, 2, 0, 0, 18, 0, 0, 0, 0, 0, 0, 0, 0
    .long 6, 0, 0, 0, 2, 0, 0, 23, 0, 0, 0, 0, 0, 0, 0, 0
    .long 6, 0, 0, 0, 2, 0, 0, 0, 0, 0, 0, 0, 0, 0, 0, 0
    .long 6, 0, 0, 0, 2, 0, 0, 28, 0, 0, 0, 0, 0, 0, 0, 0
    .long 6, 0, 0, 0, 2, 0, 0, 5, 0, 0, 0, 0, 0, 0, 0, 0
    .long 6, 0, 0, 0, 2, 0, 0, 13, 0, 0, 0, 0, 0, 0, 0, 0
    .long 6, 0, 0, 0, 2, 0, 0, 32, 0, 0, 0, 0, 0, 0, 0, 0
    .long 6, 0, 0, 0, 2, 0, 0, 14, 0, 0, 0, 0, 0, 0, 0, 0
    .long 6, 0, 0, 0, 2, 0, 0, 34, 0, 0, 0, 0, 0, 0, 0, 0
    .long 6, 0, 0, 0, 2, 0, 0, 1, 0, 0, 0, 0, 0, 0, 0, 0
    .long 6, 0, 0, 0, 2, 0, 0, 9, 0, 0, 0, 0, 0, 0, 0, 0
    .long 6, 0, 0, 0, 2, 0, 0, 10, 0, 0, 0, 0, 0, 0, 0, 0
    .long 6, 0, 0, 0, 2, 0, 0, 11, 0, 0, 0, 0, 0, 0, 0, 0
    .long 6, 0, 0, 0, 2, 0, 0, 15, 0, 0, 0, 0, 0, 0, 0, 0
    .long 6, 0, 0, 0, 2, 0, 0, 50, 0, 0, 0, 0, 0, 0, 0, 0
    .long 6, 0, 0, 0, 2, 0, 0, 7, 0, 0, 0, 0, 0, 0, 0, 0
    .long 6, 0, 0, 0, 2, 0, 0, 8, 0, 0, 0, 0, 0, 0, 0, 0
    .long 6, 0, 0, 0, 2, 0, 0, 49, 0, 0, 0, 0, 0, 0, 0, 0
    .long 6, 0, 0, 0, 2, 0, 0, 54, 0, 0, 0, 0, 0, 0, 0, 0
    .long 6, 0, 0, 0, 2, 0, 0, 55, 0, 0, 0, 0, 0, 0, 0, 0
    .long 6, 0, 0, 0, 2, 0, 0, 53, 0, 0, 0, 0, 0, 0, 0, 0
    .long 6, 0, 0, 0, 2, 0, 0, 52, 0, 0, 0, 0, 0, 0, 0, 0
    .long 6, 0, 0, 0, 2, 0, 0, 40, 0, 0, 0, 0, 0, 0, 0, 0
    .long 6, 0, 0, 0, 2, 0, 0, 41, 0, 0, 0, 0, 0, 0, 0, 0
    .long 6, 0, 0, 0, 2, 0, 0, 42, 0, 0, 0, 0, 0, 0, 0, 0
    .long 6, 0, 0, 0, 2, 0, 0, 43, 0, 0, 0, 0, 0, 0, 0, 0
    .long 6, 0, 0, 0, 2, 0, 0, 44, 0, 0, 0, 0, 0, 0, 0, 0
    .long 6, 0, 0, 0, 2, 0, 0, 45, 0, 0, 0, 0, 0, 0, 0, 0
    .long 6, 0, 0, 0, 2, 0, 0, 46, 0, 0, 0, 0, 0, 0, 0, 0
    .long 6, 0, 0, 0, 2, 0, 0, 47, 0, 0, 0, 0, 0, 0, 0, 0
    .long 6, 0, 0, 0, 2, 0, 0, 56, 0, 0, 0, 0, 0, 0, 0, 0
    .long 6, 0, 0, 0, 2, 0, 0, 57, 0, 0, 0, 0, 0, 0, 0, 0
    .long 6, 0, 0, 0, 2, 0, 0, 58, 0, 0, 0, 0, 0, 0, 0, 0
    .long 6, 0, 0, 0, 2, 0, 0, 59, 0, 0, 0, 0, 0, 0, 0, 0
    .long 6, 0, 0, 0, 2, 0, 0, 60, 0, 0, 0, 0, 0, 0, 0, 0
    .long 7, 0, 0, 0, 8, 0, 0, 61, 0, 0, 0, 0, 0, 0, 0, 0
    .long 7, 0, 0, 0, 9, 0, 0, 61, 0, 0, 0, 0, 0, 0, 0, 0
    .long 7, 0, 0, 0, 10, 0, 0, 61, 0, 0, 0, 0, 0, 0, 0, 0
    .long 7, 0, 0, 0, 11, 0, 0, 61, 0, 0, 0, 0, 0, 0, 0, 0
    .long 7, 0, 0, 0, 8, 0, 0, 62, 0, 0, 0, 0, 0, 0, 0, 0
    .long 7, 0, 0, 0, 9, 0, 0, 62, 0, 0, 0, 0, 0, 0, 0, 0
    .long 7, 0, 0, 0, 10, 0, 0, 62, 0, 0, 0, 0, 0, 0, 0, 0
    .long 7, 0, 0, 0, 11, 0, 0, 62, 0, 0, 0, 0, 0, 0, 0, 0
    .long 7, 0, 0, 0, 8, 0, 0, 63, 0, 0, 0, 0, 0, 0, 0, 0
    .long 7, 0, 0, 0, 9, 0, 0, 63, 0, 0, 0, 0, 0, 0, 0, 0
    .long 7, 0, 0, 0, 10, 0, 0, 63, 0, 0, 0, 0, 0, 0, 0, 0
    .long 7, 0, 0, 0, 11, 0, 0, 63, 0, 0, 0, 0, 0, 0, 0, 0
    .long 0, 0, 0, 0, 0, 0, 0, 0, 0, 0, 0, 0, 0, 0, 0, 0
    .long 4, 24, 24, 8192, 6144, 268288, 8388608, 0, 32768, 4, 21069824, 131072, 0, 0, 218104417, 0
    .long 4, 24, 24, 8192, 6400, 268544, 8388608, 0, 32768, 4, 21073920, 131072, 0, 0, 218104417, 0
    .long 4, 24, 24, 8192, 6656, 268800, 8388608, 0, 32768, 4, 21078016, 131072, 0, 0, 218104417, 0
    .long 4, 24, 24, 8192, 6912, 269056, 8388608, 0, 32768, 4, 21082112, 131072, 0, 0, 218104417, 0
    .long 4, 24, 24, 8192, 7168, 269312, 8388608, 0, 32768, 4, 21086208, 131072, 0, 0, 218104433, 0
    .long 4, 24, 24, 8192, 7424, 269568, 8388608, 0, 32768, 4, 21090304, 131072, 0, 0, 218104433, 0
    .long 4, 24, 24, 8192, 7680, 269824, 8388608, 0, 32768, 4, 21094400, 131072, 0, 0, 218104433, 0
    .long 4, 24, 24, 8192, 7936, 270080, 8388608, 0, 32768, 4, 21098496, 131072, 0, 0, 218104433, 0
    .long 4, 32, 32, 8192, 6144, 268288, 8388608, 0, 32768, 4, 37847040, 131072, 0, 0, 218104417, 0
    .long 4, 32, 32, 8192, 6400, 268544, 8388608, 0, 32768, 4, 37851136, 131072, 0, 0, 218104417, 0
    .long 4, 32, 32, 8192, 6656, 268800, 8388608, 0, 32768, 4, 37855232, 131072, 0, 0, 218104417, 0
    .long 4, 32, 32, 8192, 6912, 269056, 8388608, 0, 32768, 4, 37859328, 131072, 0, 0, 218104417, 0
    .long 4, 32, 32, 8192, 7168, 269312, 8388608, 0, 32768, 4, 37863424, 131072, 0, 0, 218104433, 0
    .long 4, 32, 32, 8192, 7424, 269568, 8388608, 0, 32768, 4, 37867520, 131072, 0, 0, 218104433, 0
    .long 4, 32, 32, 8192, 7680, 269824, 8388608, 0, 32768, 4, 37871616, 131072, 0, 0, 218104433, 0
    .long 4, 32, 32, 8192, 7936, 270080, 8388608, 0, 32768, 4, 37875712, 131072, 0, 0, 218104433, 0
    .long 4, 24, 24, 8192, 6144, 268288, 8388608, 262144, 32768, 4, 22118400, 131072, 0, 0, 218104420, 0
    .long 4, 24, 24, 8192, 6400, 268544, 8388608, 262144, 32768, 4, 22122496, 131072, 0, 0, 218104420, 0
    .long 4, 24, 24, 8192, 6656, 268800, 8388608, 262144, 32768, 4, 22126592, 131072, 0, 0, 218104420, 0
    .long 4, 24, 24, 8192, 6912, 269056, 8388608, 262144, 32768, 4, 22130688, 131072, 0, 0, 218104420, 0
    .long 4, 24, 24, 8192, 7168, 269312, 8388608, 262144, 32768, 4, 22134784, 131072, 0, 0, 218104436, 0
    .long 4, 24, 24, 8192, 7424, 269568, 8388608, 262144, 32768, 4, 22138880, 131072, 0, 0, 218104436, 0
    .long 4, 24, 24, 8192, 7680, 269824, 8388608, 262144, 32768, 4, 22142976, 131072, 0, 0, 218104436, 0
    .long 4, 24, 24, 8192, 7936, 270080, 8388608, 262144, 32768, 4, 22147072, 131072, 0, 0, 218104436, 0
    .long 4, 32, 32, 8192, 6144, 268288, 8388608, 262144, 32768, 4, 38895616, 131072, 0, 0, 218104420, 0
    .long 4, 32, 32, 8192, 6400, 268544, 8388608, 262144, 32768, 4, 38899712, 131072, 0, 0, 218104420, 0
    .long 4, 32, 32, 8192, 6656, 268800, 8388608, 262144, 32768, 4, 38903808, 131072, 0, 0, 218104420, 0
    .long 4, 32, 32, 8192, 6912, 269056, 8388608, 262144, 32768, 4, 38907904, 131072, 0, 0, 218104420, 0
    .long 4, 32, 32, 8192, 7168, 269312, 8388608, 262144, 32768, 4, 38912000, 131072, 0, 0, 218104436, 0
    .long 4, 32, 32, 8192, 7424, 269568, 8388608, 262144, 32768, 4, 38916096, 131072, 0, 0, 218104436, 0
    .long 4, 32, 32, 8192, 7680, 269824, 8388608, 262144, 32768, 4, 38920192, 131072, 0, 0, 218104436, 0
    .long 4, 32, 32, 8192, 7936, 270080, 8388608, 262144, 32768, 4, 38924288, 131072, 0, 0, 218104436, 0
    .long 4, 32, 32, 8192, 7168, 269312, 8388608, 524288, 32768, 4, 39960576, 131072, 0, 0, 218104689, 0
    .long 4, 32, 32, 8192, 6912, 269056, 8388608, 524288, 32768, 4, 39956480, 131072, 0, 0, 218104673, 0
    .long 4, 32, 32, 8192, 7680, 269824, 8388608, 786432, 32768, 4, 41017344, 131072, 0, 0, 218104692, 0
    .long 4, 24, 24, 8192, 7680, 269824, 8388608, 524288, 32768, 4, 23191552, 131072, 0, 0, 218104689, 0
    .long 4, 32, 32, 8192, 7168, 269312, 8388608, 786432, 32768, 4, 41009152, 131072, 0, 0, 218104692, 0
    .long 4, 32, 32, 8192, 6656, 268800, 8388608, 786432, 32768, 4, 41000960, 131072, 0, 0, 218104676, 0
    .long 4, 32, 32, 8192, 6144, 268288, 8388608, 524288, 32768, 4, 39944192, 131072, 0, 0, 218104673, 0
    .long 4, 24, 24, 8192, 7168, 269312, 8388608, 786432, 32768, 4, 24231936, 131072, 0, 0, 218104692, 0
    .long 4, 24, 24, 8192, 6144, 268288, 8388608, 524288, 32768, 4, 23166976, 131072, 0, 0, 218104673, 0
    .long 4, 32, 32, 8192, 7424, 269568, 8388608, 786432, 32768, 4, 41013248, 131072, 0, 0, 218104692, 0
    .long 4, 24, 24, 8192, 6912, 269056, 8388608, 786432, 32768, 4, 24227840, 131072, 0, 0, 218104676, 0
    .long 4, 24, 24, 8192, 6400, 268544, 8388608, 524288, 32768, 4, 23171072, 131072, 0, 0, 218104673, 0
    .long 4, 32, 32, 8192, 6912, 269056, 8388608, 786432, 32768, 4, 41005056, 131072, 0, 0, 218104676, 0
    .long 4, 24, 24, 8192, 7424, 269568, 8388608, 524288, 32768, 4, 23187456, 131072, 0, 0, 218104689, 0
    .long 4, 24, 24, 8192, 7680, 269824, 8388608, 786432, 32768, 4, 24240128, 131072, 0, 0, 218104692, 0
    .long 4, 24, 24, 8192, 7936, 270080, 8388608, 524288, 32768, 4, 23195648, 131072, 0, 0, 218104689, 0
    .long 4, 32, 32, 8192, 6656, 268800, 8388608, 524288, 32768, 4, 39952384, 131072, 0, 0, 218104673, 0
    .long 4, 32, 32, 8192, 7936, 270080, 8388608, 524288, 32768, 4, 39972864, 131072, 0, 0, 218104689, 0
    .long 4, 24, 24, 8192, 7424, 269568, 8388608, 786432, 32768, 4, 24236032, 131072, 0, 0, 218104692, 0
    .long 4, 32, 32, 8192, 6400, 268544, 8388608, 524288, 32768, 4, 39948288, 131072, 0, 0, 218104673, 0
    .long 4, 32, 32, 8192, 6144, 268288, 8388608, 786432, 32768, 4, 40992768, 131072, 0, 0, 218104676, 0
    .long 4, 24, 24, 8192, 6400, 268544, 8388608, 786432, 32768, 4, 24219648, 131072, 0, 0, 218104676, 0
    .long 4, 32, 32, 8192, 7424, 269568, 8388608, 524288, 32768, 4, 39964672, 131072, 0, 0, 218104689, 0
    .long 4, 24, 24, 8192, 6656, 268800, 8388608, 786432, 32768, 4, 24223744, 131072, 0, 0, 218104676, 0
    .long 4, 24, 24, 8192, 6144, 268288, 8388608, 786432, 32768, 4, 24215552, 131072, 0, 0, 218104676, 0
    .long 4, 24, 24, 8192, 6656, 268800, 8388608, 524288, 32768, 4, 23175168, 131072, 0, 0, 218104673, 0
    .long 4, 24, 24, 8192, 6912, 269056, 8388608, 524288, 32768, 4, 23179264, 131072, 0, 0, 218104673, 0
    .long 2, 64, 72, 7168, 5888, 5888, 7340032, 1572864, 32768, 8, 60125184, 114688, 0, 0, 218104020, 0
    .long 4, 32, 32, 8192, 7680, 269824, 8388608, 524288, 32768, 4, 39968768, 131072, 0, 0, 218104689, 0
    .long 4, 24, 24, 8192, 7936, 270080, 8388608, 786432, 32768, 4, 24244224, 131072, 0, 0, 218104692, 0
    .long 4, 32, 32, 8192, 7936, 270080, 8388608, 786432, 32768, 4, 41021440, 131072, 0, 0, 218104692, 0
    .long 4, 24, 24, 8192, 7168, 269312, 8388608, 524288, 32768, 4, 23183360, 131072, 0, 0, 218104689, 0
    .long 1, 16, 16, 8192, 7680, 7936, 8388608, 1048576, 32768, 8, 8511488, 131072, 0, 0, 218104954, 0
    .long 1, 24, 24, 8192, 6144, 6400, 8388608, 1048576, 32768, 8, 25264128, 131072, 0, 0, 218104938, 0
    .long 1, 16, 16, 8192, 6656, 6912, 8388608, 1048576, 32768, 8, 8495104, 131072, 0, 0, 218104938, 0
    .long 1, 32, 32, 8192, 7680, 7936, 8388608, 1048576, 32768, 8, 42065920, 131072, 0, 0, 218104954, 0
    .long 1, 32, 32, 8192, 6656, 6912, 8388608, 1048576, 32768, 8, 42049536, 131072, 0, 0, 218104938, 0
    .long 1, 16, 16, 8192, 7168, 7424, 8388608, 1048576, 32768, 8, 8503296, 131072, 0, 0, 218104954, 0
    .long 1, 24, 24, 8192, 7168, 7424, 8388608, 1048576, 32768, 8, 25280512, 131072, 0, 0, 218104954, 0
    .long 1, 24, 24, 8192, 6144, 6400, 8388608, 1572864, 32768, 8, 27361280, 131072, 0, 0, 218105194, 0
    .long 1, 32, 32, 8192, 6656, 6912, 8388608, 1572864, 32768, 8, 44146688, 131072, 0, 0, 218105194, 0
    .long 1, 16, 16, 8192, 7680, 7936, 8388608, 1572864, 32768, 8, 10608640, 131072, 0, 0, 218105210, 0
    .long 1, 24, 24, 8192, 6656, 6912, 8388608, 1048576, 32768, 8, 25272320, 131072, 0, 0, 218104938, 0
    .long 1, 32, 32, 8192, 6144, 6400, 8388608, 1048576, 32768, 8, 42041344, 131072, 0, 0, 218104938, 0
    .long 4, 32, 32, 8192, 6400, 268544, 8388608, 786432, 32768, 4, 40996864, 131072, 0, 0, 218104676, 0
    .long 1, 16, 16, 8192, 7680, 7936, 8388608, 2097152, 32768, 8, 12705792, 131072, 0, 0, 218105466, 0
    .long 1, 32, 32, 8192, 7168, 7424, 8388608, 1048576, 32768, 8, 42057728, 131072, 0, 0, 218104954, 0
    .long 1, 32, 32, 8192, 7168, 7424, 8388608, 1572864, 32768, 8, 44154880, 131072, 0, 0, 218105210, 0
    .long 1, 16, 16, 8192, 6144, 6400, 8388608, 1048576, 32768, 8, 8486912, 131072, 0, 0, 218104938, 0
    .long 1, 24, 24, 8192, 7680, 7936, 8388608, 1048576, 32768, 8, 25288704, 131072, 0, 0, 218104954, 0
    .long 1, 24, 24, 8192, 6656, 6912, 8388608, 2097152, 32768, 8, 29466624, 131072, 0, 0, 218105450, 0
    .long 1, 16, 16, 8192, 7168, 7424, 8388608, 2097152, 32768, 8, 12697600, 131072, 0, 0, 218105466, 0
    .long 1, 16, 16, 8192, 6144, 6400, 8388608, 1572864, 32768, 8, 10584064, 131072, 0, 0, 218105194, 0
    .long 1, 32, 32, 8192, 6656, 6912, 8388608, 2097152, 32768, 8, 46243840, 131072, 0, 0, 218105450, 0
    .long 1, 16, 16, 8192, 7168, 7424, 8388608, 1572864, 32768, 8, 10600448, 131072, 0, 0, 218105210, 0
    .long 1, 24, 24, 8192, 7680, 7936, 8388608, 1572864, 32768, 8, 27385856, 131072, 0, 0, 218105210, 0
    .long 1, 32, 32, 8192, 7680, 7936, 8388608, 1572864, 32768, 8, 44163072, 131072, 0, 0, 218105210, 0
    .long 1, 24, 24, 8192, 6656, 6912, 8388608, 1572864, 32768, 8, 27369472, 131072, 0, 0, 218105194, 0
    .long 1, 32, 32, 8192, 6144, 6400, 8388608, 2097152, 32768, 8, 46235648, 131072, 0, 0, 218105450, 0
    .long 1, 16, 16, 8192, 6656, 6912, 8388608, 1572864, 32768, 8, 10592256, 131072, 0, 0, 218105194, 0
    .long 1, 32, 32, 8192, 6144, 6400, 8388608, 1572864, 32768, 8, 44138496, 131072, 0, 0, 218105194, 0
    .long 1, 24, 24, 8192, 7168, 7424, 8388608, 1572864, 32768, 8, 27377664, 131072, 0, 0, 218105210, 0
    .long 1, 24, 24, 8192, 7168, 7424, 8388608, 2097152, 32768, 8, 29474816, 131072, 0, 0, 218105466, 0
    .long 1, 16, 16, 8192, 7168, 7424, 8388608, 2621440, 32768, 8, 14794752, 131072, 0, 0, 218105722, 0
    .long 2, 64, 72, 7168, 5376, 5376, 7340032, 1572864, 32768, 8, 60116992, 114688, 0, 0, 218104020, 0
    .long 1, 32, 32, 8192, 7168, 7424, 8388608, 2097152, 32768, 8, 46252032, 131072, 0, 0, 218105466, 0
    .long 1, 24, 24, 8192, 7680, 7936, 8388608, 2097152, 32768, 8, 29483008, 131072, 0, 0, 218105466, 0
    .long 2, 64, 72, 7168, 6400, 6400, 7340032, 3145728, 32768, 8, 65638400, 114688, 0, 0, 218104212, 0
    .long 1, 16, 16, 8192, 6656, 6912, 8388608, 2097152, 32768, 8, 12689408, 131072, 0, 0, 218105450, 0
    .long 1, 24, 24, 8192, 6144, 6400, 8388608, 2621440, 32768, 8, 31555584, 131072, 0, 0, 218105706, 0
    .long 2, 64, 72, 7168, 6656, 6656, 7340032, 2621440, 32768, 8, 63807488, 114688, 0, 0, 218104148, 0
    .long 1, 24, 24, 8192, 6144, 6400, 8388608, 3670016, 32768, 8, 35749888, 131072, 0, 0, 218106218, 0
    .long 1, 16, 16, 8192, 6656, 6912, 8388608, 524288, 32768, 8, 6397952, 131072, 0, 0, 218108266, 0
    .long 1, 32, 32, 8192, 7168, 7424, 8388608, 3145728, 32768, 8, 50446336, 131072, 0, 0, 218105978, 0
    .long 2, 64, 72, 7168, 5376, 5376, 7340032, 3145728, 32768, 8, 65622016, 114688, 0, 0, 218104212, 0
    .long 1, 24, 24, 8192, 6656, 6912, 8388608, 2621440, 32768, 8, 31563776, 131072, 0, 0, 218105706, 0
    .long 1, 16, 16, 8192, 6656, 6912, 8388608, 3670016, 32768, 8, 18980864, 131072, 0, 0, 218106218, 0
    .long 2, 64, 72, 7168, 6400, 6400, 7340032, 2621440, 32768, 8, 63803392, 114688, 0, 0, 218104148, 0
    .long 1, 24, 24, 8192, 7680, 7936, 8388608, 2621440, 32768, 8, 31580160, 131072, 0, 0, 218105722, 0
    .long 1, 24, 24, 8192, 6144, 6400, 8388608, 2097152, 32768, 8, 29458432, 131072, 0, 0, 218105450, 0
    .long 1, 24, 24, 8192, 6656, 6912, 8388608, 3145728, 32768, 8, 33660928, 131072, 0, 0, 218105962, 0
    .long 1, 32, 32, 8192, 7680, 7936, 8388608, 2097152, 32768, 8, 46260224, 131072, 0, 0, 218105466, 0
    .long 1, 32, 32, 8192, 7168, 7424, 8388608, 2621440, 32768, 8, 48349184, 131072, 0, 0, 218105722, 0
    .long 2, 64, 72, 7168, 6656, 6656, 7340032, 3670016, 32768, 8, 67477504, 114688, 0, 0, 218104276, 0
    .long 1, 32, 32, 8192, 7680, 7936, 8388608, 3145728, 32768, 8, 50454528, 131072, 0, 0, 218105978, 0
    .long 1, 16, 16, 8192, 6144, 6400, 8388608, 2621440, 32768, 8, 14778368, 131072, 0, 0, 218105706, 0
    .long 1, 32, 32, 8192, 7680, 7936, 8388608, 2621440, 32768, 8, 48357376, 131072, 0, 0, 218105722, 0
    .long 2, 64, 72, 7168, 5376, 5376, 7340032, 524288, 32768, 8, 56446976, 114688, 0, 0, 218103892, 0
    .long 1, 16, 16, 8192, 6656, 6912, 8388608, 2621440, 32768, 8, 14786560, 131072, 0, 0, 218105706, 0
    .long 2, 64, 72, 7168, 5888, 5888, 7340032, 2097152, 32768, 8, 61960192, 114688, 0, 0, 218104084, 0
    .long 1, 16, 16, 8192, 6144, 6400, 8388608, 3145728, 32768, 8, 16875520, 131072, 0, 0, 218105962, 0
    .long 1, 24, 24, 8192, 7680, 7936, 8388608, 3145728, 32768, 8, 33677312, 131072, 0, 0, 218105978, 0
    .long 1, 16, 16, 8192, 6144, 6400, 8388608, 2097152, 32768, 8, 12681216, 131072, 0, 0, 218105450, 0
    .long 2, 64, 72, 7168, 5376, 5376, 7340032, 2097152, 32768, 8, 61952000, 114688, 0, 0, 218104084, 0
    .long 1, 16, 16, 8192, 6144, 6400, 8388608, 524288, 32768, 8, 6389760, 131072, 0, 0, 218108266, 0
    .long 1, 32, 32, 8192, 6656, 6912, 8388608, 2621440, 32768, 8, 48340992, 131072, 0, 0, 218105706, 0
    .long 1, 16, 16, 8192, 7168, 7424, 8388608, 524288, 32768, 8, 6406144, 131072, 0, 0, 218108282, 0
    .long 2, 64, 72, 7168, 6656, 6656, 7340032, 1572864, 32768, 8, 60137472, 114688, 0, 0, 218104020, 0
    .long 1, 24, 24, 8192, 7168, 7424, 8388608, 2621440, 32768, 8, 31571968, 131072, 0, 0, 218105722, 0
    .long 1, 16, 16, 8192, 7680, 7936, 8388608, 2621440, 32768, 8, 14802944, 131072, 0, 0, 218105722, 0
    .long 1, 16, 16, 8192, 7680, 7936, 8388608, 3145728, 32768, 8, 16900096, 131072, 0, 0, 218105978, 0
    .long 2, 64, 72, 7168, 6656, 6656, 7340032, 1048576, 32768, 8, 58302464, 114688, 0, 0, 218103956, 0
    .long 2, 64, 72, 7168, 6144, 6144, 7340032, 2097152, 32768, 8, 61964288, 114688, 0, 0, 218104084, 0
    .long 1, 16, 16, 8192, 6656, 6912, 8388608, 3145728, 32768, 8, 16883712, 131072, 0, 0, 218105962, 0
    .long 2, 64, 72, 7168, 6912, 6912, 7340032, 1572864, 32768, 8, 60141568, 114688, 0, 0, 218104020, 0
    .long 2, 64, 72, 7168, 6912, 6912, 7340032, 3145728, 32768, 8, 65646592, 114688, 0, 0, 218104212, 0
    .long 2, 64, 72, 7168, 6400, 6400, 7340032, 1048576, 32768, 8, 58298368, 114688, 0, 0, 218103956, 0
    .long 1, 16, 16, 8192, 7680, 7936, 8388608, 0, 32768, 8, 4317184, 131072, 0, 0, 218108026, 0
    .long 2, 64, 72, 7168, 6912, 6912, 7340032, 2097152, 32768, 8, 61976576, 114688, 0, 0, 218104084, 0
    .long 1, 32, 32, 8192, 6144, 6400, 8388608, 2621440, 32768, 8, 48332800, 131072, 0, 0, 218105706, 0
    .long 2, 64, 72, 7168, 6400, 6400, 7340032, 2097152, 32768, 8, 61968384, 114688, 0, 0, 218104084, 0
    .long 2, 64, 72, 7168, 6912, 6912, 7340032, 1048576, 32768, 8, 58306560, 114688, 0, 0, 218103956, 0
    .long 2, 64, 72, 7168, 6656, 6656, 7340032, 3145728, 32768, 8, 65642496, 114688, 0, 0, 218104212, 0
    .long 2, 64, 72, 7168, 6400, 6400, 7340032, 1572864, 32768, 8, 60133376, 114688, 0, 0, 218104020, 0
    .long 2, 64, 72, 7168, 6144, 6144, 7340032, 524288, 32768, 8, 56459264, 114688, 0, 0, 218103892, 0
    .long 1, 16, 16, 8192, 7168, 7424, 8388608, 0, 32768, 8, 4308992, 131072, 0, 0, 218108026, 0
    .long 1, 16, 16, 8192, 7680, 7936, 8388608, 524288, 32768, 8, 6414336, 131072, 0, 0, 218108282, 0
    .long 2, 64, 72, 7168, 6656, 6656, 7340032, 0, 32768, 8, 54632448, 114688, 0, 0, 218103828, 0
    .long 2, 64, 72, 7168, 6400, 6400, 7340032, 524288, 32768, 8, 56463360, 114688, 0, 0, 218103892, 0
    .long 2, 64, 72, 7168, 6144, 6144, 7340032, 1572864, 32768, 8, 60129280, 114688, 0, 0, 218104020, 0
    .long 2, 64, 72, 7168, 6656, 6656, 7340032, 2097152, 32768, 8, 61972480, 114688, 0, 0, 218104084, 0
    .long 2, 64, 72, 7168, 6656, 6656, 7340032, 524288, 32768, 8, 56467456, 114688, 0, 0, 218103892, 0
    .long 2, 64, 72, 7168, 6400, 6400, 7340032, 0, 32768, 8, 54628352, 114688, 0, 0, 218103828, 0
    .long 1, 24, 24, 8192, 7168, 7424, 8388608, 3145728, 32768, 8, 33669120, 131072, 0, 0, 218105978, 0
    .long 2, 64, 72, 7168, 5632, 5632, 7340032, 2097152, 32768, 8, 61956096, 114688, 0, 0, 218104084, 0
    .long 2, 64, 72, 7168, 5632, 5632, 7340032, 1572864, 32768, 8, 60121088, 114688, 0, 0, 218104020, 0
    .long 1, 16, 16, 8192, 6656, 6912, 8388608, 0, 32768, 8, 4300800, 131072, 0, 0, 218108010, 0
    .long 5, 218108256, 0, 0, 24, 0, 0, 8, 0, 0, 0, 0, 218112384, 11, 218106964, 0
    .long 2, 64, 72, 7168, 5632, 5632, 7340032, 0, 32768, 8, 54616064, 114688, 0, 0, 218103828, 0
    .long 2, 64, 72, 7168, 5632, 5632, 7340032, 2621440, 32768, 8, 63791104, 114688, 0, 0, 218104148, 0
    .long 2, 64, 72, 7168, 5632, 5632, 7340032, 3145728, 32768, 8, 65626112, 114688, 0, 0, 218104212, 0
    .long 2, 64, 72, 7168, 6912, 6912, 7340032, 524288, 32768, 8, 56471552, 114688, 0, 0, 218103892, 0
    .long 1, 16, 16, 8192, 6144, 6400, 8388608, 0, 32768, 8, 4292608, 131072, 0, 0, 218108010, 0
    .long 2, 64, 72, 7168, 6912, 6912, 7340032, 2621440, 32768, 8, 63811584, 114688, 0, 0, 218104148, 0
    .long 1, 32, 32, 8192, 6656, 6912, 8388608, 3670016, 32768, 8, 52535296, 131072, 0, 0, 218106218, 0
    .long 1, 16, 16, 8192, 7168, 7424, 8388608, 3145728, 32768, 8, 16891904, 131072, 0, 0, 218105978, 0
    .long 2, 64, 72, 7168, 5888, 5888, 7340032, 2621440, 32768, 8, 63795200, 114688, 0, 0, 218104148, 0
    .long 2, 64, 72, 7168, 5632, 5632, 7340032, 524288, 32768, 8, 56451072, 114688, 0, 0, 218103892, 0
    .long 1, 16, 16, 8192, 6144, 6400, 8388608, 3670016, 32768, 8, 18972672, 131072, 0, 0, 218106218, 0
    .long 2, 64, 72, 7168, 6144, 6144, 7340032, 0, 32768, 8, 54624256, 114688, 0, 0, 218103828, 0
    .long 2, 64, 72, 7168, 5888, 5888, 7340032, 0, 32768, 8, 54620160, 114688, 0, 0, 218103828, 0
    .long 1, 16, 16, 8192, 7168, 7424, 8388608, 3670016, 32768, 8, 18989056, 131072, 0, 0, 218106234, 0
    .long 2, 64, 72, 7168, 6912, 6912, 7340032, 0, 32768, 8, 54636544, 114688, 0, 0, 218103828, 0
    .long 2, 64, 72, 7168, 6144, 6144, 7340032, 3670016, 32768, 8, 67469312, 114688, 0, 0, 218104276, 0
    .long 1, 24, 24, 8192, 6144, 6400, 8388608, 3145728, 32768, 8, 33652736, 131072, 0, 0, 218105962, 0
    .long 1, 32, 32, 8192, 6656, 6912, 8388608, 3145728, 32768, 8, 50438144, 131072, 0, 0, 218105962, 0
    .long 2, 64, 72, 7168, 5376, 5376, 7340032, 2621440, 32768, 8, 63787008, 114688, 0, 0, 218104148, 0
    .long 1, 40, 40, 2048, 6291456, 6291712, 8388608, 180453376, 131072, 8, 89128960, 32768, 218112384, 24, 218106500, 0
    .long 2, 64, 72, 7168, 5888, 5888, 7340032, 1048576, 32768, 8, 58290176, 114688, 0, 0, 218103956, 0
    .long 2, 64, 72, 7168, 6144, 6144, 7340032, 3145728, 32768, 8, 65634304, 114688, 0, 0, 218104212, 0
    .long 2, 64, 72, 7168, 6144, 6144, 7340032, 1048576, 32768, 8, 58294272, 114688, 0, 0, 218103956, 0
    .long 5, 218108272, 0, 0, 28, 0, 0, 12, 0, 0, 0, 0, 218112384, 15, 218106964, 0
    .long 1, 32, 32, 8192, 6144, 6400, 8388608, 3145728, 32768, 8, 50429952, 131072, 0, 0, 218105962, 0
    .long 2, 64, 72, 7168, 5888, 5888, 7340032, 3145728, 32768, 8, 65630208, 114688, 0, 0, 218104212, 0
    .long 2, 64, 72, 7168, 5888, 5888, 7340032, 524288, 32768, 8, 56455168, 114688, 0, 0, 218103892, 0
    .long 2, 64, 72, 7168, 5632, 5632, 7340032, 1048576, 32768, 8, 58286080, 114688, 0, 0, 218103956, 0
    .long 2, 64, 72, 7168, 5376, 5376, 7340032, 1048576, 32768, 8, 58281984, 114688, 0, 0, 218103956, 0
    .long 2, 64, 72, 7168, 5376, 5376, 7340032, 0, 32768, 8, 54611968, 114688, 0, 0, 218103828, 0
    .long 2, 64, 72, 7168, 6144, 6144, 7340032, 2621440, 32768, 8, 63799296, 114688, 0, 0, 218104148, 0
    .long 1, 80, 80, 2048, 5506048, 5506304, 7340032, 61952000, 114688, 7, 132136960, 32768, 218104084, 7, 218106625, 0
    .long 5, 218108256, 0, 0, 24, 0, 0, 12, 0, 0, 0, 0, 218112384, 15, 218106964, 0
    .long 1, 80, 80, 2048, 5505024, 5505280, 7340032, 61952000, 114688, 7, 132120576, 32768, 218104084, 7, 218106625, 0
    .long 1, 40, 40, 2048, 6291968, 6292224, 8388608, 180453376, 131072, 8, 89137152, 32768, 218112384, 24, 218106500, 0
    .long 1, 32, 32, 8192, 7168, 7424, 8388608, 3670016, 32768, 8, 52543488, 131072, 0, 0, 218106234, 0
    .long 1, 24, 24, 8192, 7168, 7424, 8388608, 3670016, 32768, 8, 35766272, 131072, 0, 0, 218106234, 0
    .long 1, 24, 24, 8192, 7680, 7936, 8388608, 3670016, 32768, 8, 35774464, 131072, 0, 0, 218106234, 0
    .long 5, 218108016, 0, 0, 28, 0, 0, 0, 0, 0, 0, 0, 218112384, 3, 218106900, 0
    .long 1, 32, 32, 8192, 6144, 6400, 8388608, 3670016, 32768, 8, 52527104, 131072, 0, 0, 218106218, 0
    .long 1, 16, 16, 8192, 7680, 7936, 8388608, 3670016, 32768, 8, 18997248, 131072, 0, 0, 218106234, 0
    .long 1, 80, 80, 2048, 5505536, 5505792, 7340032, 60116992, 114688, 7, 131604480, 32768, 218104020, 7, 218106561, 0
    .long 1, 40, 40, 2048, 6291968, 6292224, 8388608, 182550528, 131072, 8, 89661440, 32768, 218112384, 32, 218106564, 0
    .long 1, 32, 32, 8192, 7680, 7936, 8388608, 3670016, 32768, 8, 52551680, 131072, 0, 0, 218106234, 0
    .long 5, 218108000, 0, 0, 24, 0, 0, 0, 0, 0, 0, 0, 218112384, 3, 218106900, 0
    .long 2, 64, 72, 7168, 5632, 5632, 7340032, 3670016, 32768, 8, 67461120, 114688, 0, 0, 218104276, 0
    .long 5, 218108016, 0, 0, 28, 0, 0, 4, 0, 0, 0, 0, 218112384, 7, 218106900, 0
    .long 5, 218108000, 0, 0, 24, 0, 0, 4, 0, 0, 0, 0, 218112384, 7, 218106900, 0
    .long 2, 64, 72, 7168, 5376, 5376, 7340032, 3670016, 32768, 8, 67457024, 114688, 0, 0, 218104276, 0
    .long 1, 24, 24, 8192, 6656, 6912, 8388608, 3670016, 32768, 8, 35758080, 131072, 0, 0, 218106218, 0
    .long 2, 64, 72, 7168, 6912, 6912, 7340032, 3670016, 32768, 8, 67481600, 114688, 0, 0, 218104276, 0
    .long 5, 218108272, 0, 0, 28, 0, 0, 8, 0, 0, 0, 0, 218112384, 11, 218106964, 0
    .long 1, 40, 40, 2048, 6292480, 6292736, 8388608, 182550528, 131072, 8, 89669632, 32768, 218112384, 32, 218106564, 0
    .long 1, 40, 40, 2048, 6291456, 6291712, 8388608, 182550528, 131072, 8, 89653248, 32768, 218112384, 32, 218106564, 0
    .long 1, 40, 40, 2048, 6292992, 6293248, 8388608, 182550528, 131072, 8, 89677824, 32768, 218112384, 32, 218106564, 0
    .long 1, 40, 40, 2048, 6292480, 6292736, 8388608, 180453376, 131072, 8, 89145344, 32768, 218112384, 24, 218106500, 0
    .long 1, 40, 40, 2048, 6292992, 6293248, 8388608, 180453376, 131072, 8, 89153536, 32768, 218112384, 24, 218106500, 0
    .long 1, 80, 80, 2048, 5505024, 5505280, 7340032, 60116992, 114688, 7, 131596288, 32768, 218104020, 7, 218106561, 0
    .long 2, 64, 72, 7168, 5888, 5888, 7340032, 3670016, 32768, 8, 67465216, 114688, 0, 0, 218104276, 0
    .long 1, 80, 80, 2048, 5506560, 5506816, 7340032, 60116992, 114688, 7, 131620864, 32768, 218104020, 7, 218106561, 0
    .long 1, 80, 80, 2048, 5505024, 5505280, 7340032, 65622016, 114688, 7, 133169152, 32768, 218104212, 7, 218106753, 0
    .long 1, 80, 80, 2048, 5506560, 5506816, 7340032, 65622016, 114688, 7, 133193728, 32768, 218104212, 7, 218106753, 0
    .long 1, 80, 80, 2048, 5506048, 5506304, 7340032, 60116992, 114688, 7, 131612672, 32768, 218104020, 7, 218106561, 0
    .long 1, 80, 80, 2048, 5505536, 5505792, 7340032, 61952000, 114688, 7, 132128768, 32768, 218104084, 7, 218106625, 0
    .long 2, 64, 72, 7168, 6400, 6400, 7340032, 3670016, 32768, 8, 67473408, 114688, 0, 0, 218104276, 0
    .long 1, 80, 80, 2048, 5506048, 5506304, 7340032, 58281984, 114688, 7, 131088384, 32768, 218103956, 7, 218106497, 0
    .long 1, 80, 80, 2048, 5505536, 5505792, 7340032, 65622016, 114688, 7, 133177344, 32768, 218104212, 7, 218106753, 0
    .long 1, 80, 80, 2048, 5506048, 5506304, 7340032, 63787008, 114688, 7, 132661248, 32768, 218104148, 7, 218106689, 0
    .long 1, 80, 80, 2048, 5506048, 5506304, 7340032, 65622016, 114688, 7, 133185536, 32768, 218104212, 7, 218106753, 0
    .long 1, 80, 80, 2048, 5505536, 5505792, 7340032, 58281984, 114688, 7, 131080192, 32768, 218103956, 7, 218106497, 0
    .long 1, 40, 40, 2048, 6292480, 6292736, 8388608, 184647680, 131072, 8, 90193920, 32768, 218112384, 40, 218106628, 0
    .long 1, 80, 80, 2048, 5505024, 5505280, 7340032, 58281984, 114688, 7, 131072000, 32768, 218103956, 7, 218106497, 0
    .long 1, 40, 40, 2048, 6291968, 6292224, 8388608, 184647680, 131072, 8, 90185728, 32768, 218112384, 40, 218106628, 0
    .long 1, 80, 80, 2048, 5506560, 5506816, 7340032, 58281984, 114688, 7, 131096576, 32768, 218103956, 7, 218106497, 0
    .long 1, 80, 80, 2048, 5506560, 5506816, 7340032, 61952000, 114688, 7, 132145152, 32768, 218104084, 7, 218106625, 0
    .long 1, 40, 40, 2048, 6291456, 6291712, 8388608, 176259072, 131072, 8, 88080384, 32768, 218106900, 4, 218106372, 0
    .long 1, 40, 40, 2048, 6291456, 6291712, 8388608, 184647680, 131072, 8, 90177536, 32768, 218112384, 40, 218106628, 0
    .long 1, 40, 40, 2048, 6292992, 6293248, 8388608, 184647680, 131072, 8, 90202112, 32768, 218112384, 40, 218106628, 0
    .long 1, 40, 40, 2048, 6292992, 6293248, 8388608, 176259072, 131072, 8, 88104960, 32768, 218106900, 4, 218106372, 0
    .long 1, 40, 40, 2048, 6292480, 6292736, 8388608, 176259072, 131072, 8, 88096768, 32768, 218106900, 4, 218106372, 0
    .long 1, 40, 40, 2048, 6291968, 6292224, 8388608, 176259072, 131072, 8, 88088576, 32768, 218106900, 4, 218106372, 0
    .long 1, 80, 80, 2048, 5506048, 5506304, 7340032, 54611968, 114688, 7, 130039808, 32768, 218103828, 7, 218106369, 0
    .long 1, 80, 80, 2048, 5505024, 5505280, 7340032, 54611968, 114688, 7, 130023424, 32768, 218103828, 7, 218106369, 0
    .long 1, 40, 40, 2048, 6291456, 6291712, 8388608, 178356224, 131072, 8, 88604672, 32768, 218106964, 4, 218106436, 0
    .long 1, 40, 40, 2048, 6292480, 6292736, 8388608, 178356224, 131072, 8, 88621056, 32768, 218106964, 4, 218106436, 0
    .long 1, 40, 40, 2048, 6292992, 6293248, 8388608, 178356224, 131072, 8, 88629248, 32768, 218106964, 4, 218106436, 0
    .long 1, 40, 40, 2048, 6291968, 6292224, 8388608, 178356224, 131072, 8, 88612864, 32768, 218106964, 4, 218106436, 0
    .long 1, 80, 80, 2048, 5506560, 5506816, 7340032, 54611968, 114688, 7, 130048000, 32768, 218103828, 7, 218106369, 0
    .long 1, 80, 80, 2048, 5505024, 5505280, 7340032, 63787008, 114688, 7, 132644864, 32768, 218104148, 7, 218106689, 0
    .long 1, 80, 80, 2048, 5506560, 5506816, 7340032, 56446976, 114688, 7, 130572288, 32768, 218103892, 7, 218106433, 0
    .long 1, 80, 80, 2048, 5505024, 5505280, 7340032, 56446976, 114688, 7, 130547712, 32768, 218103892, 7, 218106433, 0
    .long 1, 80, 80, 2048, 5506048, 5506304, 7340032, 56446976, 114688, 7, 130564096, 32768, 218103892, 7, 218106433, 0
    .long 1, 80, 80, 2048, 5505536, 5505792, 7340032, 54611968, 114688, 7, 130031616, 32768, 218103828, 7, 218106369, 0
    .long 1, 80, 80, 2048, 5506560, 5506816, 7340032, 63787008, 114688, 7, 132669440, 32768, 218104148, 7, 218106689, 0
    .long 1, 80, 80, 2048, 5505536, 5505792, 7340032, 56446976, 114688, 7, 130555904, 32768, 218103892, 7, 218106433, 0
    .long 1, 80, 80, 2048, 5505536, 5505792, 7340032, 63787008, 114688, 7, 132653056, 32768, 218104148, 7, 218106689, 0
    .long 6, 0, 0, 0, 3, 0, 0, 27, 0, 0, 0, 0, 0, 0, 0, 0
    .long 1, 40, 40, 2048, 6292992, 6293248, 8388608, 186744832, 131072, 8, 90726400, 32768, 218112384, 48, 218106692, 0
    .long 1, 40, 40, 2048, 6291968, 6292224, 8388608, 186744832, 131072, 8, 90710016, 32768, 218112384, 48, 218106692, 0
    .long 1, 40, 40, 2048, 6291456, 6291712, 8388608, 186744832, 131072, 8, 90701824, 32768, 218112384, 48, 218106692, 0
    .long 1, 40, 40, 2048, 6292480, 6292736, 8388608, 186744832, 131072, 8, 90718208, 32768, 218112384, 48, 218106692, 0
    .long 1, 80, 80, 2048, 5506560, 5506816, 7340032, 67457024, 114688, 7, 133718016, 32768, 218104276, 7, 218106817, 0
    .long 1, 80, 80, 2048, 5505024, 5505280, 7340032, 67457024, 114688, 7, 133693440, 32768, 218104276, 7, 218106817, 0
    .long 1, 80, 80, 2048, 5506048, 5506304, 7340032, 67457024, 114688, 7, 133709824, 32768, 218104276, 7, 218106817, 0
    .long 1, 80, 80, 2048, 5505536, 5505792, 7340032, 67457024, 114688, 7, 133701632, 32768, 218104276, 7, 218106817, 0
    .long 6, 0, 0, 0, 3, 0, 0, 25, 0, 0, 0, 0, 0, 0, 0, 0
    .long 6, 0, 0, 0, 3, 0, 0, 22, 0, 0, 0, 0, 0, 0, 0, 0
    .long 6, 0, 0, 0, 3, 0, 0, 29, 0, 0, 0, 0, 0, 0, 0, 0
    .long 6, 0, 0, 0, 3, 0, 0, 38, 0, 0, 0, 0, 0, 0, 0, 0
    .long 6, 0, 0, 0, 3, 0, 0, 30, 0, 0, 0, 0, 0, 0, 0, 0
    .long 6, 0, 0, 0, 3, 0, 0, 20, 0, 0, 0, 0, 0, 0, 0, 0
    .long 6, 0, 0, 0, 3, 0, 0, 16, 0, 0, 0, 0, 0, 0, 0, 0
    .long 6, 0, 0, 0, 3, 0, 0, 26, 0, 0, 0, 0, 0, 0, 0, 0
    .long 6, 0, 0, 0, 3, 0, 0, 12, 0, 0, 0, 0, 0, 0, 0, 0
    .long 6, 0, 0, 0, 3, 0, 0, 39, 0, 0, 0, 0, 0, 0, 0, 0
    .long 6, 0, 0, 0, 3, 0, 0, 37, 0, 0, 0, 0, 0, 0, 0, 0
    .long 6, 0, 0, 0, 3, 0, 0, 36, 0, 0, 0, 0, 0, 0, 0, 0
    .long 6, 0, 0, 0, 3, 0, 0, 48, 0, 0, 0, 0, 0, 0, 0, 0
    .long 6, 0, 0, 0, 3, 0, 0, 4, 0, 0, 0, 0, 0, 0, 0, 0
    .long 6, 0, 0, 0, 3, 0, 0, 2, 0, 0, 0, 0, 0, 0, 0, 0
    .long 6, 0, 0, 0, 3, 0, 0, 31, 0, 0, 0, 0, 0, 0, 0, 0
    .long 6, 0, 0, 0, 3, 0, 0, 21, 0, 0, 0, 0, 0, 0, 0, 0
    .long 6, 0, 0, 0, 3, 0, 0, 24, 0, 0, 0, 0, 0, 0, 0, 0
    .long 6, 0, 0, 0, 3, 0, 0, 19, 0, 0, 0, 0, 0, 0, 0, 0
    .long 6, 0, 0, 0, 3, 0, 0, 33, 0, 0, 0, 0, 0, 0, 0, 0
    .long 6, 0, 0, 0, 3, 0, 0, 35, 0, 0, 0, 0, 0, 0, 0, 0
    .long 6, 0, 0, 0, 3, 0, 0, 3, 0, 0, 0, 0, 0, 0, 0, 0
    .long 6, 0, 0, 0, 3, 0, 0, 51, 0, 0, 0, 0, 0, 0, 0, 0
    .long 6, 0, 0, 0, 3, 0, 0, 6, 0, 0, 0, 0, 0, 0, 0, 0
    .long 6, 0, 0, 0, 3, 0, 0, 17, 0, 0, 0, 0, 0, 0, 0, 0
    .long 6, 0, 0, 0, 3, 0, 0, 18, 0, 0, 0, 0, 0, 0, 0, 0
    .long 6, 0, 0, 0, 3, 0, 0, 23, 0, 0, 0, 0, 0, 0, 0, 0
    .long 6, 0, 0, 0, 3, 0, 0, 0, 0, 0, 0, 0, 0, 0, 0, 0
    .long 6, 0, 0, 0, 3, 0, 0, 28, 0, 0, 0, 0, 0, 0, 0, 0
    .long 6, 0, 0, 0, 3, 0, 0, 5, 0, 0, 0, 0, 0, 0, 0, 0
    .long 6, 0, 0, 0, 3, 0, 0, 13, 0, 0, 0, 0, 0, 0, 0, 0
    .long 6, 0, 0, 0, 3, 0, 0, 32, 0, 0, 0, 0, 0, 0, 0, 0
    .long 6, 0, 0, 0, 3, 0, 0, 14, 0, 0, 0, 0, 0, 0, 0, 0
    .long 6, 0, 0, 0, 3, 0, 0, 34, 0, 0, 0, 0, 0, 0, 0, 0
    .long 6, 0, 0, 0, 3, 0, 0, 1, 0, 0, 0, 0, 0, 0, 0, 0
    .long 6, 0, 0, 0, 3, 0, 0, 9, 0, 0, 0, 0, 0, 0, 0, 0
    .long 6, 0, 0, 0, 3, 0, 0, 10, 0, 0, 0, 0, 0, 0, 0, 0
    .long 6, 0, 0, 0, 3, 0, 0, 11, 0, 0, 0, 0, 0, 0, 0, 0
    .long 6, 0, 0, 0, 3, 0, 0, 15, 0, 0, 0, 0, 0, 0, 0, 0
    .long 6, 0, 0, 0, 3, 0, 0, 50, 0, 0, 0, 0, 0, 0, 0, 0
    .long 6, 0, 0, 0, 3, 0, 0, 7, 0, 0, 0, 0, 0, 0, 0, 0
    .long 6, 0, 0, 0, 3, 0, 0, 8, 0, 0, 0, 0, 0, 0, 0, 0
    .long 6, 0, 0, 0, 3, 0, 0, 49, 0, 0, 0, 0, 0, 0, 0, 0
    .long 6, 0, 0, 0, 3, 0, 0, 54, 0, 0, 0, 0, 0, 0, 0, 0
    .long 6, 0, 0, 0, 3, 0, 0, 55, 0, 0, 0, 0, 0, 0, 0, 0
    .long 6, 0, 0, 0, 3, 0, 0, 53, 0, 0, 0, 0, 0, 0, 0, 0
    .long 6, 0, 0, 0, 3, 0, 0, 52, 0, 0, 0, 0, 0, 0, 0, 0
    .long 6, 0, 0, 0, 3, 0, 0, 40, 0, 0, 0, 0, 0, 0, 0, 0
    .long 6, 0, 0, 0, 3, 0, 0, 41, 0, 0, 0, 0, 0, 0, 0, 0
    .long 6, 0, 0, 0, 3, 0, 0, 42, 0, 0, 0, 0, 0, 0, 0, 0
    .long 6, 0, 0, 0, 3, 0, 0, 43, 0, 0, 0, 0, 0, 0, 0, 0
    .long 6, 0, 0, 0, 3, 0, 0, 44, 0, 0, 0, 0, 0, 0, 0, 0
    .long 6, 0, 0, 0, 3, 0, 0, 45, 0, 0, 0, 0, 0, 0, 0, 0
    .long 6, 0, 0, 0, 3, 0, 0, 46, 0, 0, 0, 0, 0, 0, 0, 0
    .long 6, 0, 0, 0, 3, 0, 0, 47, 0, 0, 0, 0, 0, 0, 0, 0
    .long 6, 0, 0, 0, 3, 0, 0, 56, 0, 0, 0, 0, 0, 0, 0, 0
    .long 6, 0, 0, 0, 3, 0, 0, 57, 0, 0, 0, 0, 0, 0, 0, 0
    .long 6, 0, 0, 0, 3, 0, 0, 58, 0, 0, 0, 0, 0, 0, 0, 0
    .long 6, 0, 0, 0, 3, 0, 0, 59, 0, 0, 0, 0, 0, 0, 0, 0
    .long 6, 0, 0, 0, 3, 0, 0, 60, 0, 0, 0, 0, 0, 0, 0, 0
    .long 7, 0, 0, 0, 12, 0, 0, 61, 0, 0, 0, 0, 0, 0, 0, 0
    .long 7, 0, 0, 0, 13, 0, 0, 61, 0, 0, 0, 0, 0, 0, 0, 0
    .long 7, 0, 0, 0, 14, 0, 0, 61, 0, 0, 0, 0, 0, 0, 0, 0
    .long 7, 0, 0, 0, 15, 0, 0, 61, 0, 0, 0, 0, 0, 0, 0, 0
    .long 7, 0, 0, 0, 12, 0, 0, 62, 0, 0, 0, 0, 0, 0, 0, 0
    .long 7, 0, 0, 0, 13, 0, 0, 62, 0, 0, 0, 0, 0, 0, 0, 0
    .long 7, 0, 0, 0, 14, 0, 0, 62, 0, 0, 0, 0, 0, 0, 0, 0
    .long 7, 0, 0, 0, 15, 0, 0, 62, 0, 0, 0, 0, 0, 0, 0, 0
    .long 7, 0, 0, 0, 12, 0, 0, 63, 0, 0, 0, 0, 0, 0, 0, 0
    .long 7, 0, 0, 0, 13, 0, 0, 63, 0, 0, 0, 0, 0, 0, 0, 0
    .long 7, 0, 0, 0, 14, 0, 0, 63, 0, 0, 0, 0, 0, 0, 0, 0
    .long 7, 0, 0, 0, 15, 0, 0, 63, 0, 0, 0, 0, 0, 0, 0, 0
    .long 0, 0, 0, 0, 0, 0, 0, 0, 0, 0, 0, 0, 0, 0, 0, 0
.p2align 6
.amdhsa_kernel recurrent_scan__memory_aug_recurrent_mem_tr__glu_gated_glu__prompt_kernel
  .amdhsa_next_free_vgpr 256
  .amdhsa_next_free_sgpr 102
  .amdhsa_accum_offset 256
  .amdhsa_group_segment_fixed_size 0
  .amdhsa_kernarg_size 112
  .amdhsa_user_sgpr_count 2
  .amdhsa_user_sgpr_kernarg_segment_ptr 1
  .amdhsa_system_sgpr_workgroup_id_x 1
  .amdhsa_float_denorm_mode_32 3
.end_amdhsa_kernel
```

```asm
; @launch grid=(256,1,1) block=(512,1,1) lds=163840
.amdgcn_target "amdgcn-amd-amdhsa--gfx950"
.text
.globl recurrent_scan__memory_aug_recurrent_mem_tr__glu_gated_glu__prompt_kernel
.p2align 8
.type recurrent_scan__memory_aug_recurrent_mem_tr__glu_gated_glu__prompt_kernel,@function
recurrent_scan__memory_aug_recurrent_mem_tr__glu_gated_glu__prompt_kernel:
    s_cmp_ge_u32 s2, 256
    s_cbranch_scc1 k_exit
    s_mov_b32 s99, s2
    s_load_dwordx2 s[4:5], s[0:1], 104
    s_load_dwordx2 s[64:65], s[0:1], 96
    v_lshrrev_b32 v2, 6, v0
    s_mov_b32 s6, 268435456
    s_mov_b32 s7, 131072
    s_mov_b32 s66, 256
    s_mov_b32 s67, 131072
    v_readfirstlane_b32 s3, v2
    s_lshr_b32 s13, s2, 3
    s_and_b32 s12, s2, 3
    s_waitcnt lgkmcnt(0)
    s_bitcmp0_b32 s2, 2
    s_cbranch_scc1 chain_map
    s_lshl_b32 s63, s13, 2
    s_add_u32 s63, s63, s12
    s_cmp_ge_u32 s3, 4
    s_cbranch_scc1 ln_touch
    s_load_dwordx2 s[8:9], s[0:1], 0
    v_and_b32 v1, 63, v0
    s_mov_b32 s10, 4194304
    s_mov_b32 s11, 131072
    v_and_b32 v3, 15, v1
    v_lshrrev_b32 v4, 4, v1
    v_lshlrev_b32 v5, 11, v3
    v_lshl_add_u32 v5, v4, 4, v5
    s_lshl_b32 s12, s63, 15
    s_lshl_b32 s13, s3, 9
    s_add_u32 s12, s12, s13
    s_waitcnt lgkmcnt(0)
    buffer_load_dwordx4 v[16:19], v5, s[8:11], s12 offen offset:0
    buffer_load_dwordx4 v[20:23], v5, s[8:11], s12 offen offset:64
    buffer_load_dwordx4 v[24:27], v5, s[8:11], s12 offen offset:128
    buffer_load_dwordx4 v[28:31], v5, s[8:11], s12 offen offset:192
    buffer_load_dwordx4 v[32:35], v5, s[8:11], s12 offen offset:256
    buffer_load_dwordx4 v[36:39], v5, s[8:11], s12 offen offset:320
    buffer_load_dwordx4 v[40:43], v5, s[8:11], s12 offen offset:384
    buffer_load_dwordx4 v[44:47], v5, s[8:11], s12 offen offset:448
    v_mov_b32 v14, 0
    s_lshl_b32 s13, s63, 7
    s_add_u32 s13, s13, 218103808
    v_lshlrev_b32 v13, 2, v0
    v_cmp_gt_u32 vcc, 32, v0
    s_and_saveexec_b64 s[22:23], vcc
    s_cbranch_execz ln_nz
    buffer_store_dword v14, v13, s[4:7], s13 offen sc1
ln_nz:
    s_mov_b64 exec, -1
    v_lshlrev_b32 v6, 4, v3
    s_lshl_b32 s14, s3, 2
    v_add_u32 v7, s14, v6
    v_lshlrev_b32 v8, 4, v1
    s_lshl_b32 s15, s63, 15
    s_lshl_b32 s16, s3, 13
    s_add_u32 s15, s15, s16
    s_add_u32 s16, s15, 4096
    v_and_b32 v9, 1, v4
    v_cmp_eq_u32 s[20:21], 1, v9
    s_waitcnt vmcnt(1)
    v_lshlrev_b32 v48, 16, v16
    v_and_b32 v49, 0xffff0000, v16
    v_lshlrev_b32 v50, 16, v17
    v_and_b32 v51, 0xffff0000, v17
    v_lshlrev_b32 v52, 16, v18
    v_and_b32 v53, 0xffff0000, v18
    v_lshlrev_b32 v54, 16, v19
    v_and_b32 v55, 0xffff0000, v19
    v_lshlrev_b32 v56, 16, v20
    v_and_b32 v57, 0xffff0000, v20
    v_lshlrev_b32 v58, 16, v21
    v_and_b32 v59, 0xffff0000, v21
    v_lshlrev_b32 v60, 16, v22
    v_and_b32 v61, 0xffff0000, v22
    v_lshlrev_b32 v62, 16, v23
    v_and_b32 v63, 0xffff0000, v23
    v_lshlrev_b32 v64, 16, v24
    v_and_b32 v65, 0xffff0000, v24
    v_lshlrev_b32 v66, 16, v25
    v_and_b32 v67, 0xffff0000, v25
    v_lshlrev_b32 v68, 16, v26
    v_and_b32 v69, 0xffff0000, v26
    v_lshlrev_b32 v70, 16, v27
    v_and_b32 v71, 0xffff0000, v27
    v_lshlrev_b32 v72, 16, v28
    v_and_b32 v73, 0xffff0000, v28
    v_lshlrev_b32 v74, 16, v29
    v_and_b32 v75, 0xffff0000, v29
    v_lshlrev_b32 v76, 16, v30
    v_and_b32 v77, 0xffff0000, v30
    v_lshlrev_b32 v78, 16, v31
    v_and_b32 v79, 0xffff0000, v31
    v_lshlrev_b32 v80, 16, v32
    v_and_b32 v81, 0xffff0000, v32
    v_lshlrev_b32 v82, 16, v33
    v_and_b32 v83, 0xffff0000, v33
    v_lshlrev_b32 v84, 16, v34
    v_and_b32 v85, 0xffff0000, v34
    v_lshlrev_b32 v86, 16, v35
    v_and_b32 v87, 0xffff0000, v35
    v_lshlrev_b32 v88, 16, v36
    v_and_b32 v89, 0xffff0000, v36
    v_lshlrev_b32 v90, 16, v37
    v_and_b32 v91, 0xffff0000, v37
    v_lshlrev_b32 v92, 16, v38
    v_and_b32 v93, 0xffff0000, v38
    v_lshlrev_b32 v94, 16, v39
    v_and_b32 v95, 0xffff0000, v39
    v_lshlrev_b32 v96, 16, v40
    v_and_b32 v97, 0xffff0000, v40
    v_lshlrev_b32 v98, 16, v41
    v_and_b32 v99, 0xffff0000, v41
    v_lshlrev_b32 v100, 16, v42
    v_and_b32 v101, 0xffff0000, v42
    v_lshlrev_b32 v102, 16, v43
    v_and_b32 v103, 0xffff0000, v43
    v_lshlrev_b32 v104, 16, v44
    v_and_b32 v105, 0xffff0000, v44
    v_lshlrev_b32 v106, 16, v45
    v_and_b32 v107, 0xffff0000, v45
    v_lshlrev_b32 v108, 16, v46
    v_and_b32 v109, 0xffff0000, v46
    v_lshlrev_b32 v110, 16, v47
    v_and_b32 v111, 0xffff0000, v47
    v_add_f32 v112, v48, v80
    v_add_f32 v113, v49, v81
    v_add_f32 v114, v50, v82
    v_add_f32 v115, v51, v83
    v_add_f32 v116, v52, v84
    v_add_f32 v117, v53, v85
    v_add_f32 v118, v54, v86
    v_add_f32 v119, v55, v87
    v_add_f32 v120, v56, v88
    v_add_f32 v121, v57, v89
    v_add_f32 v122, v58, v90
    v_add_f32 v123, v59, v91
    v_add_f32 v124, v60, v92
    v_add_f32 v125, v61, v93
    v_add_f32 v126, v62, v94
    v_add_f32 v127, v63, v95
    v_add_f32 v128, v64, v96
    v_add_f32 v129, v65, v97
    v_add_f32 v130, v66, v98
    v_add_f32 v131, v67, v99
    v_add_f32 v132, v68, v100
    v_add_f32 v133, v69, v101
    v_add_f32 v134, v70, v102
    v_add_f32 v135, v71, v103
    v_add_f32 v136, v72, v104
    v_add_f32 v137, v73, v105
    v_add_f32 v138, v74, v106
    v_add_f32 v139, v75, v107
    v_add_f32 v140, v76, v108
    v_add_f32 v141, v77, v109
    v_add_f32 v142, v78, v110
    v_add_f32 v143, v79, v111
    v_add_f32 v112, v112, v128
    v_add_f32 v113, v113, v129
    v_add_f32 v114, v114, v130
    v_add_f32 v115, v115, v131
    v_add_f32 v116, v116, v132
    v_add_f32 v117, v117, v133
    v_add_f32 v118, v118, v134
    v_add_f32 v119, v119, v135
    v_add_f32 v120, v120, v136
    v_add_f32 v121, v121, v137
    v_add_f32 v122, v122, v138
    v_add_f32 v123, v123, v139
    v_add_f32 v124, v124, v140
    v_add_f32 v125, v125, v141
    v_add_f32 v126, v126, v142
    v_add_f32 v127, v127, v143
    v_add_f32 v112, v112, v120
    v_add_f32 v113, v113, v121
    v_add_f32 v114, v114, v122
    v_add_f32 v115, v115, v123
    v_add_f32 v116, v116, v124
    v_add_f32 v117, v117, v125
    v_add_f32 v118, v118, v126
    v_add_f32 v119, v119, v127
    v_add_f32 v112, v112, v116
    v_add_f32 v113, v113, v117
    v_add_f32 v114, v114, v118
    v_add_f32 v115, v115, v119
    v_add_f32 v112, v112, v114
    v_add_f32 v113, v113, v115
    v_add_f32 v112, v112, v113
    v_mov_b32 v113, v112
    s_nop 1
    v_permlane16_swap_b32 v113, v112
    v_add_f32 v112, v112, v113
    v_mov_b32 v113, v112
    s_nop 1
    v_permlane32_swap_b32 v113, v112
    v_add_f32 v112, v112, v113
    ds_write_b32 v7, v112
    s_waitcnt lgkmcnt(0)
    s_barrier
    ds_read_b128 v[112:115], v6
    s_waitcnt lgkmcnt(0)
    v_add_f32 v112, v112, v114
    v_add_f32 v113, v113, v115
    v_add_f32 v112, v112, v113
    v_mul_f32 v10, 0x3a800000, v112
    v_sub_f32 v176, v48, v10
    v_sub_f32 v177, v49, v10
    v_sub_f32 v178, v50, v10
    v_sub_f32 v179, v51, v10
    v_sub_f32 v180, v52, v10
    v_sub_f32 v181, v53, v10
    v_sub_f32 v182, v54, v10
    v_sub_f32 v183, v55, v10
    v_sub_f32 v184, v56, v10
    v_sub_f32 v185, v57, v10
    v_sub_f32 v186, v58, v10
    v_sub_f32 v187, v59, v10
    v_sub_f32 v188, v60, v10
    v_sub_f32 v189, v61, v10
    v_sub_f32 v190, v62, v10
    v_sub_f32 v191, v63, v10
    v_sub_f32 v192, v64, v10
    v_sub_f32 v193, v65, v10
    v_sub_f32 v194, v66, v10
    v_sub_f32 v195, v67, v10
    v_sub_f32 v196, v68, v10
    v_sub_f32 v197, v69, v10
    v_sub_f32 v198, v70, v10
    v_sub_f32 v199, v71, v10
    v_sub_f32 v200, v72, v10
    v_sub_f32 v201, v73, v10
    v_sub_f32 v202, v74, v10
    v_sub_f32 v203, v75, v10
    v_sub_f32 v204, v76, v10
    v_sub_f32 v205, v77, v10
    v_sub_f32 v206, v78, v10
    v_sub_f32 v207, v79, v10
    v_sub_f32 v208, v80, v10
    v_sub_f32 v209, v81, v10
    v_sub_f32 v210, v82, v10
    v_sub_f32 v211, v83, v10
    v_sub_f32 v212, v84, v10
    v_sub_f32 v213, v85, v10
    v_sub_f32 v214, v86, v10
    v_sub_f32 v215, v87, v10
    v_sub_f32 v216, v88, v10
    v_sub_f32 v217, v89, v10
    v_sub_f32 v218, v90, v10
    v_sub_f32 v219, v91, v10
    v_sub_f32 v220, v92, v10
    v_sub_f32 v221, v93, v10
    v_sub_f32 v222, v94, v10
    v_sub_f32 v223, v95, v10
    v_sub_f32 v224, v96, v10
    v_sub_f32 v225, v97, v10
    v_sub_f32 v226, v98, v10
    v_sub_f32 v227, v99, v10
    v_sub_f32 v228, v100, v10
    v_sub_f32 v229, v101, v10
    v_sub_f32 v230, v102, v10
    v_sub_f32 v231, v103, v10
    v_sub_f32 v232, v104, v10
    v_sub_f32 v233, v105, v10
    v_sub_f32 v234, v106, v10
    v_sub_f32 v235, v107, v10
    v_sub_f32 v236, v108, v10
    v_sub_f32 v237, v109, v10
    v_sub_f32 v238, v110, v10
    v_sub_f32 v239, v111, v10
    v_mul_f32 v112, v176, v176
    v_fmac_f32 v112, v208, v208
    v_mul_f32 v113, v177, v177
    v_fmac_f32 v113, v209, v209
    v_mul_f32 v114, v178, v178
    v_fmac_f32 v114, v210, v210
    v_mul_f32 v115, v179, v179
    v_fmac_f32 v115, v211, v211
    v_mul_f32 v116, v180, v180
    v_fmac_f32 v116, v212, v212
    v_mul_f32 v117, v181, v181
    v_fmac_f32 v117, v213, v213
    v_mul_f32 v118, v182, v182
    v_fmac_f32 v118, v214, v214
    v_mul_f32 v119, v183, v183
    v_fmac_f32 v119, v215, v215
    v_mul_f32 v120, v184, v184
    v_fmac_f32 v120, v216, v216
    v_mul_f32 v121, v185, v185
    v_fmac_f32 v121, v217, v217
    v_mul_f32 v122, v186, v186
    v_fmac_f32 v122, v218, v218
    v_mul_f32 v123, v187, v187
    v_fmac_f32 v123, v219, v219
    v_mul_f32 v124, v188, v188
    v_fmac_f32 v124, v220, v220
    v_mul_f32 v125, v189, v189
    v_fmac_f32 v125, v221, v221
    v_mul_f32 v126, v190, v190
    v_fmac_f32 v126, v222, v222
    v_mul_f32 v127, v191, v191
    v_fmac_f32 v127, v223, v223
    v_mul_f32 v128, v192, v192
    v_fmac_f32 v128, v224, v224
    v_mul_f32 v129, v193, v193
    v_fmac_f32 v129, v225, v225
    v_mul_f32 v130, v194, v194
    v_fmac_f32 v130, v226, v226
    v_mul_f32 v131, v195, v195
    v_fmac_f32 v131, v227, v227
    v_mul_f32 v132, v196, v196
    v_fmac_f32 v132, v228, v228
    v_mul_f32 v133, v197, v197
    v_fmac_f32 v133, v229, v229
    v_mul_f32 v134, v198, v198
    v_fmac_f32 v134, v230, v230
    v_mul_f32 v135, v199, v199
    v_fmac_f32 v135, v231, v231
    v_mul_f32 v136, v200, v200
    v_fmac_f32 v136, v232, v232
    v_mul_f32 v137, v201, v201
    v_fmac_f32 v137, v233, v233
    v_mul_f32 v138, v202, v202
    v_fmac_f32 v138, v234, v234
    v_mul_f32 v139, v203, v203
    v_fmac_f32 v139, v235, v235
    v_mul_f32 v140, v204, v204
    v_fmac_f32 v140, v236, v236
    v_mul_f32 v141, v205, v205
    v_fmac_f32 v141, v237, v237
    v_mul_f32 v142, v206, v206
    v_fmac_f32 v142, v238, v238
    v_mul_f32 v143, v207, v207
    v_fmac_f32 v143, v239, v239
    v_add_f32 v112, v112, v128
    v_add_f32 v113, v113, v129
    v_add_f32 v114, v114, v130
    v_add_f32 v115, v115, v131
    v_add_f32 v116, v116, v132
    v_add_f32 v117, v117, v133
    v_add_f32 v118, v118, v134
    v_add_f32 v119, v119, v135
    v_add_f32 v120, v120, v136
    v_add_f32 v121, v121, v137
    v_add_f32 v122, v122, v138
    v_add_f32 v123, v123, v139
    v_add_f32 v124, v124, v140
    v_add_f32 v125, v125, v141
    v_add_f32 v126, v126, v142
    v_add_f32 v127, v127, v143
    v_add_f32 v112, v112, v120
    v_add_f32 v113, v113, v121
    v_add_f32 v114, v114, v122
    v_add_f32 v115, v115, v123
    v_add_f32 v116, v116, v124
    v_add_f32 v117, v117, v125
    v_add_f32 v118, v118, v126
    v_add_f32 v119, v119, v127
    v_add_f32 v112, v112, v116
    v_add_f32 v113, v113, v117
    v_add_f32 v114, v114, v118
    v_add_f32 v115, v115, v119
    v_add_f32 v112, v112, v114
    v_add_f32 v113, v113, v115
    v_add_f32 v112, v112, v113
    v_mov_b32 v113, v112
    s_nop 1
    v_permlane16_swap_b32 v113, v112
    v_add_f32 v112, v112, v113
    v_mov_b32 v113, v112
    s_nop 1
    v_permlane32_swap_b32 v113, v112
    v_add_f32 v112, v112, v113
    ds_write_b32 v7, v112 offset:512
    s_waitcnt lgkmcnt(0)
    s_barrier
    ds_read_b128 v[112:115], v6 offset:512
    s_waitcnt lgkmcnt(0)
    v_add_f32 v112, v112, v114
    v_add_f32 v113, v113, v115
    v_add_f32 v112, v112, v113
    v_mul_f32 v11, 0x3a800000, v112
    v_cvt_pk_bf16_f32 v10, v10, v10
    v_lshlrev_b32 v10, 16, v10
    v_cvt_pk_bf16_f32 v11, v11, v11
    v_lshlrev_b32 v11, 16, v11
    v_add_f32 v11, 0x3727c5ac, v11
    v_cvt_pk_bf16_f32 v11, v11, v11
    v_lshlrev_b32 v11, 16, v11
    v_sqrt_f32 v11, v11
    s_nop 0
    v_cvt_pk_bf16_f32 v11, v11, v11
    v_lshlrev_b32 v11, 16, v11
    v_rcp_f32 v11, v11
    s_nop 0
    v_sub_f32 v48, v48, v10
    v_sub_f32 v49, v49, v10
    v_cvt_pk_bf16_f32 v16, v48, v49
    v_lshlrev_b32 v48, 16, v16
    v_and_b32 v49, 0xffff0000, v16
    v_mul_f32 v48, v48, v11
    v_mul_f32 v49, v49, v11
    v_cvt_pk_bf16_f32 v16, v48, v49
    v_sub_f32 v50, v50, v10
    v_sub_f32 v51, v51, v10
    v_cvt_pk_bf16_f32 v17, v50, v51
    v_lshlrev_b32 v50, 16, v17
    v_and_b32 v51, 0xffff0000, v17
    v_mul_f32 v50, v50, v11
    v_mul_f32 v51, v51, v11
    v_cvt_pk_bf16_f32 v17, v50, v51
    v_sub_f32 v52, v52, v10
    v_sub_f32 v53, v53, v10
    v_cvt_pk_bf16_f32 v18, v52, v53
    v_lshlrev_b32 v52, 16, v18
    v_and_b32 v53, 0xffff0000, v18
    v_mul_f32 v52, v52, v11
    v_mul_f32 v53, v53, v11
    v_cvt_pk_bf16_f32 v18, v52, v53
    v_sub_f32 v54, v54, v10
    v_sub_f32 v55, v55, v10
    v_cvt_pk_bf16_f32 v19, v54, v55
    v_lshlrev_b32 v54, 16, v19
    v_and_b32 v55, 0xffff0000, v19
    v_mul_f32 v54, v54, v11
    v_mul_f32 v55, v55, v11
    v_cvt_pk_bf16_f32 v19, v54, v55
    v_cndmask_b32 v112, v16, v18, s[20:21]
    v_cndmask_b32 v113, v17, v19, s[20:21]
    v_cndmask_b32 v114, v18, v16, s[20:21]
    v_cndmask_b32 v115, v19, v17, s[20:21]
    buffer_store_dwordx4 v[112:115], v8, s[4:7], s15 offen offset:0 sc1
    v_sub_f32 v56, v56, v10
    v_sub_f32 v57, v57, v10
    v_cvt_pk_bf16_f32 v20, v56, v57
    v_lshlrev_b32 v56, 16, v20
    v_and_b32 v57, 0xffff0000, v20
    v_mul_f32 v56, v56, v11
    v_mul_f32 v57, v57, v11
    v_cvt_pk_bf16_f32 v20, v56, v57
    v_sub_f32 v58, v58, v10
    v_sub_f32 v59, v59, v10
    v_cvt_pk_bf16_f32 v21, v58, v59
    v_lshlrev_b32 v58, 16, v21
    v_and_b32 v59, 0xffff0000, v21
    v_mul_f32 v58, v58, v11
    v_mul_f32 v59, v59, v11
    v_cvt_pk_bf16_f32 v21, v58, v59
    v_sub_f32 v60, v60, v10
    v_sub_f32 v61, v61, v10
    v_cvt_pk_bf16_f32 v22, v60, v61
    v_lshlrev_b32 v60, 16, v22
    v_and_b32 v61, 0xffff0000, v22
    v_mul_f32 v60, v60, v11
    v_mul_f32 v61, v61, v11
    v_cvt_pk_bf16_f32 v22, v60, v61
    v_sub_f32 v62, v62, v10
    v_sub_f32 v63, v63, v10
    v_cvt_pk_bf16_f32 v23, v62, v63
    v_lshlrev_b32 v62, 16, v23
    v_and_b32 v63, 0xffff0000, v23
    v_mul_f32 v62, v62, v11
    v_mul_f32 v63, v63, v11
    v_cvt_pk_bf16_f32 v23, v62, v63
    v_cndmask_b32 v116, v20, v22, s[20:21]
    v_cndmask_b32 v117, v21, v23, s[20:21]
    v_cndmask_b32 v118, v22, v20, s[20:21]
    v_cndmask_b32 v119, v23, v21, s[20:21]
    buffer_store_dwordx4 v[116:119], v8, s[4:7], s15 offen offset:1024 sc1
    v_sub_f32 v64, v64, v10
    v_sub_f32 v65, v65, v10
    v_cvt_pk_bf16_f32 v24, v64, v65
    v_lshlrev_b32 v64, 16, v24
    v_and_b32 v65, 0xffff0000, v24
    v_mul_f32 v64, v64, v11
    v_mul_f32 v65, v65, v11
    v_cvt_pk_bf16_f32 v24, v64, v65
    v_sub_f32 v66, v66, v10
    v_sub_f32 v67, v67, v10
    v_cvt_pk_bf16_f32 v25, v66, v67
    v_lshlrev_b32 v66, 16, v25
    v_and_b32 v67, 0xffff0000, v25
    v_mul_f32 v66, v66, v11
    v_mul_f32 v67, v67, v11
    v_cvt_pk_bf16_f32 v25, v66, v67
    v_sub_f32 v68, v68, v10
    v_sub_f32 v69, v69, v10
    v_cvt_pk_bf16_f32 v26, v68, v69
    v_lshlrev_b32 v68, 16, v26
    v_and_b32 v69, 0xffff0000, v26
    v_mul_f32 v68, v68, v11
    v_mul_f32 v69, v69, v11
    v_cvt_pk_bf16_f32 v26, v68, v69
    v_sub_f32 v70, v70, v10
    v_sub_f32 v71, v71, v10
    v_cvt_pk_bf16_f32 v27, v70, v71
    v_lshlrev_b32 v70, 16, v27
    v_and_b32 v71, 0xffff0000, v27
    v_mul_f32 v70, v70, v11
    v_mul_f32 v71, v71, v11
    v_cvt_pk_bf16_f32 v27, v70, v71
    v_cndmask_b32 v120, v24, v26, s[20:21]
    v_cndmask_b32 v121, v25, v27, s[20:21]
    v_cndmask_b32 v122, v26, v24, s[20:21]
    v_cndmask_b32 v123, v27, v25, s[20:21]
    buffer_store_dwordx4 v[120:123], v8, s[4:7], s15 offen offset:2048 sc1
    v_sub_f32 v72, v72, v10
    v_sub_f32 v73, v73, v10
    v_cvt_pk_bf16_f32 v28, v72, v73
    v_lshlrev_b32 v72, 16, v28
    v_and_b32 v73, 0xffff0000, v28
    v_mul_f32 v72, v72, v11
    v_mul_f32 v73, v73, v11
    v_cvt_pk_bf16_f32 v28, v72, v73
    v_sub_f32 v74, v74, v10
    v_sub_f32 v75, v75, v10
    v_cvt_pk_bf16_f32 v29, v74, v75
    v_lshlrev_b32 v74, 16, v29
    v_and_b32 v75, 0xffff0000, v29
    v_mul_f32 v74, v74, v11
    v_mul_f32 v75, v75, v11
    v_cvt_pk_bf16_f32 v29, v74, v75
    v_sub_f32 v76, v76, v10
    v_sub_f32 v77, v77, v10
    v_cvt_pk_bf16_f32 v30, v76, v77
    v_lshlrev_b32 v76, 16, v30
    v_and_b32 v77, 0xffff0000, v30
    v_mul_f32 v76, v76, v11
    v_mul_f32 v77, v77, v11
    v_cvt_pk_bf16_f32 v30, v76, v77
    v_sub_f32 v78, v78, v10
    v_sub_f32 v79, v79, v10
    v_cvt_pk_bf16_f32 v31, v78, v79
    v_lshlrev_b32 v78, 16, v31
    v_and_b32 v79, 0xffff0000, v31
    v_mul_f32 v78, v78, v11
    v_mul_f32 v79, v79, v11
    v_cvt_pk_bf16_f32 v31, v78, v79
    v_cndmask_b32 v124, v28, v30, s[20:21]
    v_cndmask_b32 v125, v29, v31, s[20:21]
    v_cndmask_b32 v126, v30, v28, s[20:21]
    v_cndmask_b32 v127, v31, v29, s[20:21]
    buffer_store_dwordx4 v[124:127], v8, s[4:7], s15 offen offset:3072 sc1
    v_sub_f32 v80, v80, v10
    v_sub_f32 v81, v81, v10
    v_cvt_pk_bf16_f32 v32, v80, v81
    v_lshlrev_b32 v80, 16, v32
    v_and_b32 v81, 0xffff0000, v32
    v_mul_f32 v80, v80, v11
    v_mul_f32 v81, v81, v11
    v_cvt_pk_bf16_f32 v32, v80, v81
    v_sub_f32 v82, v82, v10
    v_sub_f32 v83, v83, v10
    v_cvt_pk_bf16_f32 v33, v82, v83
    v_lshlrev_b32 v82, 16, v33
    v_and_b32 v83, 0xffff0000, v33
    v_mul_f32 v82, v82, v11
    v_mul_f32 v83, v83, v11
    v_cvt_pk_bf16_f32 v33, v82, v83
    v_sub_f32 v84, v84, v10
    v_sub_f32 v85, v85, v10
    v_cvt_pk_bf16_f32 v34, v84, v85
    v_lshlrev_b32 v84, 16, v34
    v_and_b32 v85, 0xffff0000, v34
    v_mul_f32 v84, v84, v11
    v_mul_f32 v85, v85, v11
    v_cvt_pk_bf16_f32 v34, v84, v85
    v_sub_f32 v86, v86, v10
    v_sub_f32 v87, v87, v10
    v_cvt_pk_bf16_f32 v35, v86, v87
    v_lshlrev_b32 v86, 16, v35
    v_and_b32 v87, 0xffff0000, v35
    v_mul_f32 v86, v86, v11
    v_mul_f32 v87, v87, v11
    v_cvt_pk_bf16_f32 v35, v86, v87
    v_cndmask_b32 v128, v32, v34, s[20:21]
    v_cndmask_b32 v129, v33, v35, s[20:21]
    v_cndmask_b32 v130, v34, v32, s[20:21]
    v_cndmask_b32 v131, v35, v33, s[20:21]
    buffer_store_dwordx4 v[128:131], v8, s[4:7], s16 offen offset:0 sc1
    v_sub_f32 v88, v88, v10
    v_sub_f32 v89, v89, v10
    v_cvt_pk_bf16_f32 v36, v88, v89
    v_lshlrev_b32 v88, 16, v36
    v_and_b32 v89, 0xffff0000, v36
    v_mul_f32 v88, v88, v11
    v_mul_f32 v89, v89, v11
    v_cvt_pk_bf16_f32 v36, v88, v89
    v_sub_f32 v90, v90, v10
    v_sub_f32 v91, v91, v10
    v_cvt_pk_bf16_f32 v37, v90, v91
    v_lshlrev_b32 v90, 16, v37
    v_and_b32 v91, 0xffff0000, v37
    v_mul_f32 v90, v90, v11
    v_mul_f32 v91, v91, v11
    v_cvt_pk_bf16_f32 v37, v90, v91
    v_sub_f32 v92, v92, v10
    v_sub_f32 v93, v93, v10
    v_cvt_pk_bf16_f32 v38, v92, v93
    v_lshlrev_b32 v92, 16, v38
    v_and_b32 v93, 0xffff0000, v38
    v_mul_f32 v92, v92, v11
    v_mul_f32 v93, v93, v11
    v_cvt_pk_bf16_f32 v38, v92, v93
    v_sub_f32 v94, v94, v10
    v_sub_f32 v95, v95, v10
    v_cvt_pk_bf16_f32 v39, v94, v95
    v_lshlrev_b32 v94, 16, v39
    v_and_b32 v95, 0xffff0000, v39
    v_mul_f32 v94, v94, v11
    v_mul_f32 v95, v95, v11
    v_cvt_pk_bf16_f32 v39, v94, v95
    v_cndmask_b32 v132, v36, v38, s[20:21]
    v_cndmask_b32 v133, v37, v39, s[20:21]
    v_cndmask_b32 v134, v38, v36, s[20:21]
    v_cndmask_b32 v135, v39, v37, s[20:21]
    buffer_store_dwordx4 v[132:135], v8, s[4:7], s16 offen offset:1024 sc1
    v_sub_f32 v96, v96, v10
    v_sub_f32 v97, v97, v10
    v_cvt_pk_bf16_f32 v40, v96, v97
    v_lshlrev_b32 v96, 16, v40
    v_and_b32 v97, 0xffff0000, v40
    v_mul_f32 v96, v96, v11
    v_mul_f32 v97, v97, v11
    v_cvt_pk_bf16_f32 v40, v96, v97
    v_sub_f32 v98, v98, v10
    v_sub_f32 v99, v99, v10
    v_cvt_pk_bf16_f32 v41, v98, v99
    v_lshlrev_b32 v98, 16, v41
    v_and_b32 v99, 0xffff0000, v41
    v_mul_f32 v98, v98, v11
    v_mul_f32 v99, v99, v11
    v_cvt_pk_bf16_f32 v41, v98, v99
    v_sub_f32 v100, v100, v10
    v_sub_f32 v101, v101, v10
    v_cvt_pk_bf16_f32 v42, v100, v101
    v_lshlrev_b32 v100, 16, v42
    v_and_b32 v101, 0xffff0000, v42
    v_mul_f32 v100, v100, v11
    v_mul_f32 v101, v101, v11
    v_cvt_pk_bf16_f32 v42, v100, v101
    v_sub_f32 v102, v102, v10
    v_sub_f32 v103, v103, v10
    v_cvt_pk_bf16_f32 v43, v102, v103
    v_lshlrev_b32 v102, 16, v43
    v_and_b32 v103, 0xffff0000, v43
    v_mul_f32 v102, v102, v11
    v_mul_f32 v103, v103, v11
    v_cvt_pk_bf16_f32 v43, v102, v103
    v_cndmask_b32 v136, v40, v42, s[20:21]
    v_cndmask_b32 v137, v41, v43, s[20:21]
    v_cndmask_b32 v138, v42, v40, s[20:21]
    v_cndmask_b32 v139, v43, v41, s[20:21]
    buffer_store_dwordx4 v[136:139], v8, s[4:7], s16 offen offset:2048 sc1
    v_sub_f32 v104, v104, v10
    v_sub_f32 v105, v105, v10
    v_cvt_pk_bf16_f32 v44, v104, v105
    v_lshlrev_b32 v104, 16, v44
    v_and_b32 v105, 0xffff0000, v44
    v_mul_f32 v104, v104, v11
    v_mul_f32 v105, v105, v11
    v_cvt_pk_bf16_f32 v44, v104, v105
    v_sub_f32 v106, v106, v10
    v_sub_f32 v107, v107, v10
    v_cvt_pk_bf16_f32 v45, v106, v107
    v_lshlrev_b32 v106, 16, v45
    v_and_b32 v107, 0xffff0000, v45
    v_mul_f32 v106, v106, v11
    v_mul_f32 v107, v107, v11
    v_cvt_pk_bf16_f32 v45, v106, v107
    v_sub_f32 v108, v108, v10
    v_sub_f32 v109, v109, v10
    v_cvt_pk_bf16_f32 v46, v108, v109
    v_lshlrev_b32 v108, 16, v46
    v_and_b32 v109, 0xffff0000, v46
    v_mul_f32 v108, v108, v11
    v_mul_f32 v109, v109, v11
    v_cvt_pk_bf16_f32 v46, v108, v109
    v_sub_f32 v110, v110, v10
    v_sub_f32 v111, v111, v10
    v_cvt_pk_bf16_f32 v47, v110, v111
    v_lshlrev_b32 v110, 16, v47
    v_and_b32 v111, 0xffff0000, v47
    v_mul_f32 v110, v110, v11
    v_mul_f32 v111, v111, v11
    v_cvt_pk_bf16_f32 v47, v110, v111
    v_cndmask_b32 v140, v44, v46, s[20:21]
    v_cndmask_b32 v141, v45, v47, s[20:21]
    v_cndmask_b32 v142, v46, v44, s[20:21]
    v_cndmask_b32 v143, v47, v45, s[20:21]
    buffer_store_dwordx4 v[140:143], v8, s[4:7], s16 offen offset:3072 sc1
    s_waitcnt vmcnt(0)
    s_barrier
    s_cmp_lg_u32 s3, 0
    s_cbranch_scc1 ln_sig
    v_mov_b32 v2, 1
    s_mov_b64 exec, 1
    s_cmp_ge_u32 s63, 8
    s_cbranch_scc1 ln_sb
    buffer_atomic_add v2, off, s[64:67], 0 offset:192 sc1
ln_sb:
    buffer_atomic_add v2, off, s[64:67], 0 offset:0 sc1
    s_mov_b64 exec, -1
    s_branch ln_sig
ln_touch:
    s_getpc_b64 s[24:25]
    s_add_u32 s24, s24, jobtab@rel32@lo+4
    s_addc_u32 s25, s25, jobtab@rel32@hi+12
    s_and_b32 s30, s63, 3
    s_mul_i32 s30, s30, 320
    s_lshr_b32 s31, s63, 2
    s_add_u32 s30, s30, s31
    s_lshl_b32 s30, s30, 6
    s_add_u32 s24, s24, s30
    s_addc_u32 s25, s25, 0
    s_load_dwordx16 s[32:47], s[24:25], 0
    s_mov_b32 s11, 131072
    v_and_b32 v20, 63, v0
    s_waitcnt lgkmcnt(0)
    s_load_dwordx2 s[8:9], s[0:1], s33
    s_mov_b32 s10, s38
    s_lshl_b32 s30, s35, 4
    v_mul_lo_u32 v21, s30, v20
    v_and_b32 v22, 15, v20
    v_mul_lo_u32 v22, s43, v22
    s_waitcnt lgkmcnt(0)
    s_cmp_eq_u32 s3, 4
    s_cbranch_scc0 tlb_1_1
    buffer_load_dword v23, v21, s[8:11], s36 offen
    s_branch tlb_1
tlb_1_1:
    s_cmp_eq_u32 s3, 5
    s_cbranch_scc0 tlb_1
    buffer_load_dword v23, v22, s[4:7], s42 offen
    buffer_load_dword v23, off, s[4:7], s46
tlb_1:
    s_barrier
    s_barrier
    s_barrier
ln_sig:
    s_mov_b32 s29, s63
    v_and_b32 v20, 63, v0
    v_lshlrev_b32 v1, 4, v20
    v_add_u32 v19, 0x1000, v1
    v_lshrrev_b32 v4, 4, v20
    v_mov_b32 v17, 0
    v_mov_b32 v18, 1
    s_lshr_b32 s26, s3, 2
    s_and_b32 s27, s3, 3
    s_lshl_b32 s21, s3, 11
    s_lshl_b32 s22, s3, 10
    s_add_u32 s22, s22, 16384
    s_mov_b32 s11, 131072
    s_mov_b32 s15, 131072
    s_mov_b32 s28, 0
    v_and_b32 v21, 15, v20
    v_lshlrev_b32 v22, 2, v4
    v_xor_b32 v21, v21, v22
    s_lshr_b32 s30, s3, 1
    s_and_b32 s30, s30, 1
    v_xor_b32 v21, s30, v21
    v_lshlrev_b32 v3, 4, v21
    s_lshl_b32 s30, s26, 13
    v_add_u32 v5, s30, v1
    v_add_u32 v6, 0x10000, v5
    v_bfe_u32 v21, v20, 2, 2
    v_and_b32 v22, 3, v20
    v_and_b32 v23, 1, v4
    v_xor_b32 v24, s27, v21
    v_xor_b32 v25, v22, v23
    v_lshl_add_u32 v24, v24, 2, v25
    v_lshlrev_b32 v24, 4, v24
    v_lshl_add_u32 v25, v4, 3, v21
    v_lshl_add_u32 v24, v25, 8, v24
    v_and_b32 v22, 1, v22
    v_xor_b32 v25, 0, v23
    v_lshl_add_u32 v8, v25, 10, v24
    v_xor_b32 v25, 0, v22
    v_lshl_add_u32 v8, v25, 3, v8
    v_add_u32 v12, 0x10000, v8
    v_xor_b32 v25, 1, v23
    v_lshl_add_u32 v9, v25, 10, v24
    v_xor_b32 v25, 0, v22
    v_lshl_add_u32 v9, v25, 3, v9
    v_add_u32 v13, 0x10000, v9
    v_xor_b32 v25, 0, v23
    v_lshl_add_u32 v10, v25, 10, v24
    v_xor_b32 v25, 1, v22
    v_lshl_add_u32 v10, v25, 3, v10
    v_add_u32 v14, 0x10000, v10
    v_xor_b32 v25, 1, v23
    v_lshl_add_u32 v11, v25, 10, v24
    v_xor_b32 v25, 1, v22
    v_lshl_add_u32 v11, v25, 3, v11
    v_add_u32 v15, 0x10000, v11
    s_lshl_b32 s30, s3, 2
    s_add_u32 s30, s30, 131072
    v_mov_b32 v7, s30
    s_cmp_ge_u32 s3, 4
    s_cbranch_scc0 w_np
    s_setprio 1
w_np:
    s_getpc_b64 s[24:25]
    s_add_u32 s24, s24, jobtab@rel32@lo+4
    s_addc_u32 s25, s25, jobtab@rel32@hi+12
    s_and_b32 s31, s29, 3
    s_mul_i32 s30, s31, 20480
    s_add_u32 s24, s24, s30
    s_addc_u32 s25, s25, 0
    s_lshl_b32 s71, s31, 2
    s_add_u32 s71, s71, 64
    s_lshr_b32 s59, s29, 2
    s_lshl_b32 s30, s59, 6
    s_load_dwordx16 s[32:47], s[24:25], s30
    s_waitcnt lgkmcnt(0)
    s_cmp_lg_u32 s32, 4
    s_cbranch_scc1 w_nopre
    s_load_dwordx2 s[8:9], s[0:1], s33
    s_load_dwordx2 s[12:13], s[0:1], s34
    s_mov_b32 s10, s38
    s_mov_b32 s14, s38
    s_cmp_eq_u32 s32, 4
    s_cselect_b32 s31, 0, 1
    s_lshl_b32 s30, s3, s31
    s_mul_i32 s30, s30, s40
    s_add_u32 s16, s39, s30
    s_cmp_eq_u32 s32, 4
    s_cselect_b32 s30, 1024, s40
    s_cselect_b32 s31, 6, 5
    s_lshl_b32 s62, 32, s31
    s_add_u32 s17, s16, s30
    s_lshl_b32 s30, s3, 2
    s_mul_i32 s30, s30, s35
    s_add_u32 s18, s36, s30
    s_add_u32 s19, s37, s30
    s_lshl_b32 s20, s35, s31
    v_mul_u32_u24 v2, s35, v4
    v_add_u32 v2, v2, v3
    s_waitcnt lgkmcnt(0)
    s_add_u32 m0, s22, 0
    s_nop 0
    buffer_load_dwordx4 v2, s[8:11], s18 offen lds
    s_add_u32 s18, s18, s20
    s_add_u32 m0, s22, 8192
    s_nop 0
    buffer_load_dwordx4 v2, s[12:15], s19 offen lds
    s_add_u32 s19, s19, s20
    s_add_u32 m0, s22, 32768
    s_nop 0
    buffer_load_dwordx4 v2, s[8:11], s18 offen lds
    s_add_u32 s18, s18, s20
    s_add_u32 m0, s22, 40960
    s_nop 0
    buffer_load_dwordx4 v2, s[12:15], s19 offen lds
    s_add_u32 s19, s19, s20
    s_add_u32 m0, s22, 65536
    s_nop 0
    buffer_load_dwordx4 v2, s[8:11], s18 offen lds
    s_add_u32 s18, s18, s20
    s_add_u32 m0, s22, 73728
    s_nop 0
    buffer_load_dwordx4 v2, s[12:15], s19 offen lds
    s_add_u32 s19, s19, s20
    s_add_u32 m0, s22, 98304
    s_nop 0
    buffer_load_dwordx4 v2, s[8:11], s18 offen lds
    s_add_u32 s18, s18, s20
    s_add_u32 m0, s22, 106496
    s_nop 0
    buffer_load_dwordx4 v2, s[12:15], s19 offen lds
    s_add_u32 s19, s19, s20
    s_cmp_eq_u32 s32, 4
    s_cselect_b32 s70, 1, 0
    s_cmp_eq_u32 s39, 0
    s_cselect_b32 s70, s70, 0
    s_cmp_lg_u32 s3, 0
    s_cbranch_scc1 lnwp_ok
    s_cmp_eq_u32 s70, 0
    s_cbranch_scc1 lnwp_full
    s_mov_b32 s69, 65536
lnwap:
    buffer_load_dword v20, off, s[64:67], 0 offset:192 sc1
    s_waitcnt vmcnt(0)
    v_readfirstlane_b32 s68, v20
    s_cmp_ge_u32 s68, 8
    s_cbranch_scc1 lnwap_ok
    s_sleep 8
    s_sub_u32 s69, s69, 1
    s_cbranch_scc0 lnwap
lnwap_ok:
    s_branch lnwp_ok
lnwp_full:
    s_mov_b32 s69, 65536
lnwp:
    buffer_load_dword v20, off, s[64:67], 0 offset:0 sc1
    s_waitcnt vmcnt(0)
    v_readfirstlane_b32 s68, v20
    s_cmp_ge_u32 s68, 128
    s_cbranch_scc1 lnwp_ok
    s_sleep 8
    s_sub_u32 s69, s69, 1
    s_cbranch_scc0 lnwp
lnwp_ok:
    s_barrier
    s_add_u32 m0, s21, 0
    s_nop 0
    buffer_load_dwordx4 v1, s[4:7], s16 offen sc1 lds
    s_add_u32 s16, s16, s62
    s_add_u32 m0, s21, 1024
    s_nop 0
    buffer_load_dwordx4 v1, s[4:7], s17 offen sc1 lds
    s_add_u32 s17, s17, s62
    s_add_u32 m0, s21, 32768
    s_nop 0
    buffer_load_dwordx4 v1, s[4:7], s16 offen sc1 lds
    s_add_u32 s16, s16, s62
    s_add_u32 m0, s21, 33792
    s_nop 0
    buffer_load_dwordx4 v1, s[4:7], s17 offen sc1 lds
    s_add_u32 s17, s17, s62
    s_add_u32 m0, s21, 65536
    s_nop 0
    buffer_load_dwordx4 v1, s[4:7], s16 offen sc1 lds
    s_add_u32 s16, s16, s62
    s_add_u32 m0, s21, 66560
    s_nop 0
    buffer_load_dwordx4 v1, s[4:7], s17 offen sc1 lds
    s_add_u32 s17, s17, s62
    s_add_u32 m0, s21, 98304
    s_nop 0
    buffer_load_dwordx4 v1, s[4:7], s16 offen sc1 lds
    s_add_u32 s16, s16, s62
    s_add_u32 m0, s21, 99328
    s_nop 0
    buffer_load_dwordx4 v1, s[4:7], s17 offen sc1 lds
    s_add_u32 s17, s17, s62
    s_branch w_adopt
w_nopre:
    s_cmp_eq_u32 s32, 4
    s_cselect_b32 s70, 1, 0
    s_cmp_eq_u32 s39, 0
    s_cselect_b32 s70, s70, 0
    s_cmp_lg_u32 s3, 0
    s_cbranch_scc1 lnw_ok
    s_cmp_eq_u32 s70, 0
    s_cbranch_scc1 lnw_full
    s_mov_b32 s69, 65536
lnwa:
    buffer_load_dword v20, off, s[64:67], 0 offset:192 sc1
    s_waitcnt vmcnt(0)
    v_readfirstlane_b32 s68, v20
    s_cmp_ge_u32 s68, 8
    s_cbranch_scc1 lnwa_ok
    s_sleep 8
    s_sub_u32 s69, s69, 1
    s_cbranch_scc0 lnwa
lnwa_ok:
    s_branch lnw_ok
lnw_full:
    s_mov_b32 s69, 65536
lnw:
    buffer_load_dword v20, off, s[64:67], 0 offset:0 sc1
    s_waitcnt vmcnt(0)
    v_readfirstlane_b32 s68, v20
    s_cmp_ge_u32 s68, 128
    s_cbranch_scc1 lnw_ok
    s_sleep 8
    s_sub_u32 s69, s69, 1
    s_cbranch_scc0 lnw
lnw_ok:
    s_barrier
w_cold:
    s_cmp_eq_u32 s32, 0
    s_cbranch_scc1 k_end
    s_cmp_ge_u32 s32, 6
    s_cbranch_scc1 w_fin
    s_cmp_lg_u32 s3, 0
    s_cbranch_scc1 w_depok
    s_cmp_eq_u32 s45, 0
    s_cbranch_scc1 w_depok
    s_mov_b32 s31, 0x40000
w_waitdep:
    buffer_load_dword v16, v17, s[4:7], s44 offen sc1
    s_waitcnt vmcnt(0)
    v_readfirstlane_b32 s30, v16
    s_cmp_ge_u32 s30, s45
    s_cbranch_scc1 w_depok
    s_sleep 16
    s_sub_u32 s31, s31, 1
    s_cbranch_scc0 w_waitdep
w_depok:
    s_cmp_eq_u32 s32, 5
    s_cbranch_scc1 w_att
    s_load_dwordx2 s[8:9], s[0:1], s33
    s_load_dwordx2 s[12:13], s[0:1], s34
    s_mov_b32 s10, s38
    s_mov_b32 s14, s38
    s_cmp_eq_u32 s32, 4
    s_cselect_b32 s31, 0, 1
    s_lshl_b32 s30, s3, s31
    s_mul_i32 s30, s30, s40
    s_add_u32 s16, s39, s30
    s_cmp_eq_u32 s32, 4
    s_cselect_b32 s30, 1024, s40
    s_cselect_b32 s31, 6, 5
    s_lshl_b32 s62, 32, s31
    s_add_u32 s17, s16, s30
    s_lshl_b32 s30, s3, 2
    s_mul_i32 s30, s30, s35
    s_add_u32 s18, s36, s30
    s_add_u32 s19, s37, s30
    s_lshl_b32 s20, s35, s31
    v_mul_u32_u24 v2, s35, v4
    v_add_u32 v2, v2, v3
    s_waitcnt lgkmcnt(0)
    s_barrier
    s_add_u32 m0, s21, 0
    s_nop 0
    buffer_load_dwordx4 v1, s[4:7], s16 offen sc1 lds
    s_add_u32 s16, s16, s62
    s_add_u32 m0, s21, 1024
    s_nop 0
    buffer_load_dwordx4 v1, s[4:7], s17 offen sc1 lds
    s_add_u32 s17, s17, s62
    s_add_u32 m0, s22, 0
    s_nop 0
    buffer_load_dwordx4 v2, s[8:11], s18 offen lds
    s_add_u32 s18, s18, s20
    s_add_u32 m0, s22, 8192
    s_nop 0
    buffer_load_dwordx4 v2, s[12:15], s19 offen lds
    s_add_u32 s19, s19, s20
    s_add_u32 m0, s21, 32768
    s_nop 0
    buffer_load_dwordx4 v1, s[4:7], s16 offen sc1 lds
    s_add_u32 s16, s16, s62
    s_add_u32 m0, s21, 33792
    s_nop 0
    buffer_load_dwordx4 v1, s[4:7], s17 offen sc1 lds
    s_add_u32 s17, s17, s62
    s_add_u32 m0, s22, 32768
    s_nop 0
    buffer_load_dwordx4 v2, s[8:11], s18 offen lds
    s_add_u32 s18, s18, s20
    s_add_u32 m0, s22, 40960
    s_nop 0
    buffer_load_dwordx4 v2, s[12:15], s19 offen lds
    s_add_u32 s19, s19, s20
    s_add_u32 m0, s21, 65536
    s_nop 0
    buffer_load_dwordx4 v1, s[4:7], s16 offen sc1 lds
    s_add_u32 s16, s16, s62
    s_add_u32 m0, s21, 66560
    s_nop 0
    buffer_load_dwordx4 v1, s[4:7], s17 offen sc1 lds
    s_add_u32 s17, s17, s62
    s_add_u32 m0, s22, 65536
    s_nop 0
    buffer_load_dwordx4 v2, s[8:11], s18 offen lds
    s_add_u32 s18, s18, s20
    s_add_u32 m0, s22, 73728
    s_nop 0
    buffer_load_dwordx4 v2, s[12:15], s19 offen lds
    s_add_u32 s19, s19, s20
    s_add_u32 m0, s21, 98304
    s_nop 0
    buffer_load_dwordx4 v1, s[4:7], s16 offen sc1 lds
    s_add_u32 s16, s16, s62
    s_add_u32 m0, s21, 99328
    s_nop 0
    buffer_load_dwordx4 v1, s[4:7], s17 offen sc1 lds
    s_add_u32 s17, s17, s62
    s_add_u32 m0, s22, 98304
    s_nop 0
    buffer_load_dwordx4 v2, s[8:11], s18 offen lds
    s_add_u32 s18, s18, s20
    s_add_u32 m0, s22, 106496
    s_nop 0
    buffer_load_dwordx4 v2, s[12:15], s19 offen lds
    s_add_u32 s19, s19, s20
w_adopt:
    s_mov_b32 s48, s32
    s_cmp_eq_u32 s32, 4
    s_cselect_b32 s30, 2, 3
    s_lshl_b32 s30, s26, s30
    s_mul_i32 s30, s30, s43
    s_add_u32 s49, s42, s30
    s_mov_b32 s50, s43
    s_mov_b32 s51, s46
    s_mov_b32 s23, s41
    s_mov_b32 s53, s41
    s_waitcnt vmcnt(0)
    s_barrier
    ds_read_b64_tr_b16 v[64:65], v8 offset:16384
    ds_read_b64_tr_b16 v[66:67], v9 offset:16384
    ds_read_b64_tr_b16 v[68:69], v10 offset:16384
    ds_read_b64_tr_b16 v[70:71], v11 offset:16384
    ds_read_b64_tr_b16 v[72:73], v8 offset:24576
    ds_read_b64_tr_b16 v[74:75], v9 offset:24576
    ds_read_b64_tr_b16 v[76:77], v10 offset:24576
    ds_read_b64_tr_b16 v[78:79], v11 offset:24576
    ds_read_b128 v[32:35], v5 offset:0
    ds_read_b128 v[36:39], v5 offset:1024
    ds_read_b128 v[40:43], v5 offset:2048
    ds_read_b128 v[44:47], v5 offset:3072
    ds_read_b128 v[48:51], v5 offset:4096
    ds_read_b128 v[52:55], v5 offset:5120
    ds_read_b128 v[56:59], v5 offset:6144
    ds_read_b128 v[60:63], v5 offset:7168
    s_waitcnt lgkmcnt(0)
    s_cmp_eq_u32 s48, 4
    s_cbranch_scc1 w_firstH
    s_branch w_first16
w_first4:
    s_waitcnt vmcnt(12)
    s_barrier
    v_mfma_f32_16x16x32_bf16 v[128:131], v[64:67], v[32:35], 0
    s_add_u32 m0, s21, 0
    s_nop 0
    buffer_load_dwordx4 v1, s[4:7], s16 offen sc1 lds
    s_add_u32 s16, s16, s62
    v_mfma_f32_16x16x32_bf16 v[132:135], v[68:71], v[32:35], 0
    ds_read_b64_tr_b16 v[112:113], v8 offset:49152
    v_mfma_f32_16x16x32_bf16 v[136:139], v[72:75], v[32:35], 0
    ds_read_b64_tr_b16 v[114:115], v9 offset:49152
    v_mfma_f32_16x16x32_bf16 v[140:143], v[76:79], v[32:35], 0
    ds_read_b64_tr_b16 v[116:117], v10 offset:49152
    v_mfma_f32_16x16x32_bf16 v[144:147], v[64:67], v[36:39], 0
    s_add_u32 m0, s21, 1024
    s_nop 0
    buffer_load_dwordx4 v1, s[4:7], s17 offen sc1 lds
    s_add_u32 s17, s17, s62
    v_mfma_f32_16x16x32_bf16 v[148:151], v[68:71], v[36:39], 0
    ds_read_b64_tr_b16 v[118:119], v11 offset:49152
    v_mfma_f32_16x16x32_bf16 v[152:155], v[72:75], v[36:39], 0
    ds_read_b64_tr_b16 v[120:121], v8 offset:57344
    v_mfma_f32_16x16x32_bf16 v[156:159], v[76:79], v[36:39], 0
    ds_read_b64_tr_b16 v[122:123], v9 offset:57344
    v_mfma_f32_16x16x32_bf16 v[160:163], v[64:67], v[40:43], 0
    s_add_u32 m0, s22, 0
    s_nop 0
    buffer_load_dwordx4 v2, s[8:11], s18 offen lds
    s_add_u32 s18, s18, s20
    v_mfma_f32_16x16x32_bf16 v[164:167], v[68:71], v[40:43], 0
    ds_read_b64_tr_b16 v[124:125], v10 offset:57344
    v_mfma_f32_16x16x32_bf16 v[168:171], v[72:75], v[40:43], 0
    ds_read_b64_tr_b16 v[126:127], v11 offset:57344
    v_mfma_f32_16x16x32_bf16 v[172:175], v[76:79], v[40:43], 0
    ds_read_b128 v[80:83], v5 offset:32768
    v_mfma_f32_16x16x32_bf16 v[176:179], v[64:67], v[44:47], 0
    s_add_u32 m0, s22, 8192
    s_nop 0
    buffer_load_dwordx4 v2, s[12:15], s19 offen lds
    s_add_u32 s19, s19, s20
    v_mfma_f32_16x16x32_bf16 v[180:183], v[68:71], v[44:47], 0
    ds_read_b128 v[84:87], v5 offset:33792
    v_mfma_f32_16x16x32_bf16 v[184:187], v[72:75], v[44:47], 0
    ds_read_b128 v[88:91], v5 offset:34816
    v_mfma_f32_16x16x32_bf16 v[188:191], v[76:79], v[44:47], 0
    ds_read_b128 v[92:95], v5 offset:35840
    v_mfma_f32_16x16x32_bf16 v[192:195], v[64:67], v[48:51], 0
    ds_read_b128 v[96:99], v5 offset:36864
    v_mfma_f32_16x16x32_bf16 v[196:199], v[68:71], v[48:51], 0
    ds_read_b128 v[100:103], v5 offset:37888
    v_mfma_f32_16x16x32_bf16 v[200:203], v[72:75], v[48:51], 0
    ds_read_b128 v[104:107], v5 offset:38912
    v_mfma_f32_16x16x32_bf16 v[204:207], v[76:79], v[48:51], 0
    ds_read_b128 v[108:111], v5 offset:39936
    v_mfma_f32_16x16x32_bf16 v[208:211], v[64:67], v[52:55], 0
    v_mfma_f32_16x16x32_bf16 v[212:215], v[68:71], v[52:55], 0
    v_mfma_f32_16x16x32_bf16 v[216:219], v[72:75], v[52:55], 0
    v_mfma_f32_16x16x32_bf16 v[220:223], v[76:79], v[52:55], 0
    v_mfma_f32_16x16x32_bf16 v[224:227], v[64:67], v[56:59], 0
    v_mfma_f32_16x16x32_bf16 v[228:231], v[68:71], v[56:59], 0
    v_mfma_f32_16x16x32_bf16 v[232:235], v[72:75], v[56:59], 0
    v_mfma_f32_16x16x32_bf16 v[236:239], v[76:79], v[56:59], 0
    v_mfma_f32_16x16x32_bf16 v[240:243], v[64:67], v[60:63], 0
    v_mfma_f32_16x16x32_bf16 v[244:247], v[68:71], v[60:63], 0
    v_mfma_f32_16x16x32_bf16 v[248:251], v[72:75], v[60:63], 0
    v_mfma_f32_16x16x32_bf16 v[252:255], v[76:79], v[60:63], 0
    s_waitcnt lgkmcnt(0)
    s_waitcnt vmcnt(12)
    s_barrier
    v_mfma_f32_16x16x32_bf16 v[128:131], v[112:115], v[80:83], v[128:131]
    s_add_u32 m0, s21, 32768
    s_nop 0
    buffer_load_dwordx4 v1, s[4:7], s16 offen sc1 lds
    s_add_u32 s16, s16, s62
    v_mfma_f32_16x16x32_bf16 v[132:135], v[116:119], v[80:83], v[132:135]
    ds_read_b64_tr_b16 v[64:65], v12 offset:16384
    v_mfma_f32_16x16x32_bf16 v[136:139], v[120:123], v[80:83], v[136:139]
    ds_read_b64_tr_b16 v[66:67], v13 offset:16384
    v_mfma_f32_16x16x32_bf16 v[140:143], v[124:127], v[80:83], v[140:143]
    ds_read_b64_tr_b16 v[68:69], v14 offset:16384
    v_mfma_f32_16x16x32_bf16 v[144:147], v[112:115], v[84:87], v[144:147]
    s_add_u32 m0, s21, 33792
    s_nop 0
    buffer_load_dwordx4 v1, s[4:7], s17 offen sc1 lds
    s_add_u32 s17, s17, s62
    v_mfma_f32_16x16x32_bf16 v[148:151], v[116:119], v[84:87], v[148:151]
    ds_read_b64_tr_b16 v[70:71], v15 offset:16384
    v_mfma_f32_16x16x32_bf16 v[152:155], v[120:123], v[84:87], v[152:155]
    ds_read_b64_tr_b16 v[72:73], v12 offset:24576
    v_mfma_f32_16x16x32_bf16 v[156:159], v[124:127], v[84:87], v[156:159]
    ds_read_b64_tr_b16 v[74:75], v13 offset:24576
    v_mfma_f32_16x16x32_bf16 v[160:163], v[112:115], v[88:91], v[160:163]
    s_add_u32 m0, s22, 32768
    s_nop 0
    buffer_load_dwordx4 v2, s[8:11], s18 offen lds
    s_add_u32 s18, s18, s20
    v_mfma_f32_16x16x32_bf16 v[164:167], v[116:119], v[88:91], v[164:167]
    ds_read_b64_tr_b16 v[76:77], v14 offset:24576
    v_mfma_f32_16x16x32_bf16 v[168:171], v[120:123], v[88:91], v[168:171]
    ds_read_b64_tr_b16 v[78:79], v15 offset:24576
    v_mfma_f32_16x16x32_bf16 v[172:175], v[124:127], v[88:91], v[172:175]
    ds_read_b128 v[32:35], v6 offset:0
    v_mfma_f32_16x16x32_bf16 v[176:179], v[112:115], v[92:95], v[176:179]
    s_add_u32 m0, s22, 40960
    s_nop 0
    buffer_load_dwordx4 v2, s[12:15], s19 offen lds
    s_add_u32 s19, s19, s20
    v_mfma_f32_16x16x32_bf16 v[180:183], v[116:119], v[92:95], v[180:183]
    ds_read_b128 v[36:39], v6 offset:1024
    v_mfma_f32_16x16x32_bf16 v[184:187], v[120:123], v[92:95], v[184:187]
    ds_read_b128 v[40:43], v6 offset:2048
    v_mfma_f32_16x16x32_bf16 v[188:191], v[124:127], v[92:95], v[188:191]
    ds_read_b128 v[44:47], v6 offset:3072
    v_mfma_f32_16x16x32_bf16 v[192:195], v[112:115], v[96:99], v[192:195]
    ds_read_b128 v[48:51], v6 offset:4096
    v_mfma_f32_16x16x32_bf16 v[196:199], v[116:119], v[96:99], v[196:199]
    ds_read_b128 v[52:55], v6 offset:5120
    v_mfma_f32_16x16x32_bf16 v[200:203], v[120:123], v[96:99], v[200:203]
    ds_read_b128 v[56:59], v6 offset:6144
    v_mfma_f32_16x16x32_bf16 v[204:207], v[124:127], v[96:99], v[204:207]
    ds_read_b128 v[60:63], v6 offset:7168
    v_mfma_f32_16x16x32_bf16 v[208:211], v[112:115], v[100:103], v[208:211]
    v_mfma_f32_16x16x32_bf16 v[212:215], v[116:119], v[100:103], v[212:215]
    v_mfma_f32_16x16x32_bf16 v[216:219], v[120:123], v[100:103], v[216:219]
    v_mfma_f32_16x16x32_bf16 v[220:223], v[124:127], v[100:103], v[220:223]
    v_mfma_f32_16x16x32_bf16 v[224:227], v[112:115], v[104:107], v[224:227]
    v_mfma_f32_16x16x32_bf16 v[228:231], v[116:119], v[104:107], v[228:231]
    v_mfma_f32_16x16x32_bf16 v[232:235], v[120:123], v[104:107], v[232:235]
    v_mfma_f32_16x16x32_bf16 v[236:239], v[124:127], v[104:107], v[236:239]
    v_mfma_f32_16x16x32_bf16 v[240:243], v[112:115], v[108:111], v[240:243]
    v_mfma_f32_16x16x32_bf16 v[244:247], v[116:119], v[108:111], v[244:247]
    v_mfma_f32_16x16x32_bf16 v[248:251], v[120:123], v[108:111], v[248:251]
    v_mfma_f32_16x16x32_bf16 v[252:255], v[124:127], v[108:111], v[252:255]
    s_waitcnt lgkmcnt(0)
    s_waitcnt vmcnt(12)
    s_barrier
    v_mfma_f32_16x16x32_bf16 v[128:131], v[64:67], v[32:35], v[128:131]
    s_add_u32 m0, s21, 65536
    s_nop 0
    buffer_load_dwordx4 v1, s[4:7], s16 offen sc1 lds
    s_add_u32 s16, s16, s62
    v_mfma_f32_16x16x32_bf16 v[132:135], v[68:71], v[32:35], v[132:135]
    ds_read_b64_tr_b16 v[112:113], v12 offset:49152
    v_mfma_f32_16x16x32_bf16 v[136:139], v[72:75], v[32:35], v[136:139]
    ds_read_b64_tr_b16 v[114:115], v13 offset:49152
    v_mfma_f32_16x16x32_bf16 v[140:143], v[76:79], v[32:35], v[140:143]
    ds_read_b64_tr_b16 v[116:117], v14 offset:49152
    v_mfma_f32_16x16x32_bf16 v[144:147], v[64:67], v[36:39], v[144:147]
    s_add_u32 m0, s21, 66560
    s_nop 0
    buffer_load_dwordx4 v1, s[4:7], s17 offen sc1 lds
    s_add_u32 s17, s17, s62
    v_mfma_f32_16x16x32_bf16 v[148:151], v[68:71], v[36:39], v[148:151]
    ds_read_b64_tr_b16 v[118:119], v15 offset:49152
    v_mfma_f32_16x16x32_bf16 v[152:155], v[72:75], v[36:39], v[152:155]
    ds_read_b64_tr_b16 v[120:121], v12 offset:57344
    v_mfma_f32_16x16x32_bf16 v[156:159], v[76:79], v[36:39], v[156:159]
    ds_read_b64_tr_b16 v[122:123], v13 offset:57344
    v_mfma_f32_16x16x32_bf16 v[160:163], v[64:67], v[40:43], v[160:163]
    s_add_u32 m0, s22, 65536
    s_nop 0
    buffer_load_dwordx4 v2, s[8:11], s18 offen lds
    s_add_u32 s18, s18, s20
    v_mfma_f32_16x16x32_bf16 v[164:167], v[68:71], v[40:43], v[164:167]
    ds_read_b64_tr_b16 v[124:125], v14 offset:57344
    v_mfma_f32_16x16x32_bf16 v[168:171], v[72:75], v[40:43], v[168:171]
    ds_read_b64_tr_b16 v[126:127], v15 offset:57344
    v_mfma_f32_16x16x32_bf16 v[172:175], v[76:79], v[40:43], v[172:175]
    ds_read_b128 v[80:83], v6 offset:32768
    v_mfma_f32_16x16x32_bf16 v[176:179], v[64:67], v[44:47], v[176:179]
    s_add_u32 m0, s22, 73728
    s_nop 0
    buffer_load_dwordx4 v2, s[12:15], s19 offen lds
    s_add_u32 s19, s19, s20
    v_mfma_f32_16x16x32_bf16 v[180:183], v[68:71], v[44:47], v[180:183]
    ds_read_b128 v[84:87], v6 offset:33792
    v_mfma_f32_16x16x32_bf16 v[184:187], v[72:75], v[44:47], v[184:187]
    ds_read_b128 v[88:91], v6 offset:34816
    v_mfma_f32_16x16x32_bf16 v[188:191], v[76:79], v[44:47], v[188:191]
    ds_read_b128 v[92:95], v6 offset:35840
    v_mfma_f32_16x16x32_bf16 v[192:195], v[64:67], v[48:51], v[192:195]
    ds_read_b128 v[96:99], v6 offset:36864
    v_mfma_f32_16x16x32_bf16 v[196:199], v[68:71], v[48:51], v[196:199]
    ds_read_b128 v[100:103], v6 offset:37888
    v_mfma_f32_16x16x32_bf16 v[200:203], v[72:75], v[48:51], v[200:203]
    ds_read_b128 v[104:107], v6 offset:38912
    v_mfma_f32_16x16x32_bf16 v[204:207], v[76:79], v[48:51], v[204:207]
    ds_read_b128 v[108:111], v6 offset:39936
    v_mfma_f32_16x16x32_bf16 v[208:211], v[64:67], v[52:55], v[208:211]
    v_mfma_f32_16x16x32_bf16 v[212:215], v[68:71], v[52:55], v[212:215]
    v_mfma_f32_16x16x32_bf16 v[216:219], v[72:75], v[52:55], v[216:219]
    v_mfma_f32_16x16x32_bf16 v[220:223], v[76:79], v[52:55], v[220:223]
    v_mfma_f32_16x16x32_bf16 v[224:227], v[64:67], v[56:59], v[224:227]
    v_mfma_f32_16x16x32_bf16 v[228:231], v[68:71], v[56:59], v[228:231]
    v_mfma_f32_16x16x32_bf16 v[232:235], v[72:75], v[56:59], v[232:235]
    v_mfma_f32_16x16x32_bf16 v[236:239], v[76:79], v[56:59], v[236:239]
    v_mfma_f32_16x16x32_bf16 v[240:243], v[64:67], v[60:63], v[240:243]
    v_mfma_f32_16x16x32_bf16 v[244:247], v[68:71], v[60:63], v[244:247]
    v_mfma_f32_16x16x32_bf16 v[248:251], v[72:75], v[60:63], v[248:251]
    v_mfma_f32_16x16x32_bf16 v[252:255], v[76:79], v[60:63], v[252:255]
    s_waitcnt lgkmcnt(0)
    s_waitcnt vmcnt(8)
    s_barrier
    s_cmp_eq_u32 s28, 0
    s_cbranch_scc1 sig_2
    s_cmp_lg_u32 s3, 0
    s_cbranch_scc1 sig_2
    s_and_b32 s57, s28, 3
    v_mov_b32 v24, s57
    s_bfe_u32 s57, s28, 0x20002
    v_mov_b32 v25, s57
    s_andn2_b32 s28, s28, 15
    s_mov_b64 exec, 1
    buffer_atomic_add_x2 v[24:25], v17, s[4:7], s28 offen sc1
    s_mov_b64 exec, -1
sig_2:
    s_mov_b32 s28, 0
    v_mfma_f32_16x16x32_bf16 v[128:131], v[112:115], v[80:83], v[128:131]
    s_add_u32 m0, s21, 98304
    s_nop 0
    buffer_load_dwordx4 v1, s[4:7], s16 offen sc1 lds
    s_add_u32 s16, s16, s62
    v_mfma_f32_16x16x32_bf16 v[132:135], v[116:119], v[80:83], v[132:135]
    ds_read_b64_tr_b16 v[64:65], v8 offset:16384
    v_mfma_f32_16x16x32_bf16 v[136:139], v[120:123], v[80:83], v[136:139]
    ds_read_b64_tr_b16 v[66:67], v9 offset:16384
    v_mfma_f32_16x16x32_bf16 v[140:143], v[124:127], v[80:83], v[140:143]
    ds_read_b64_tr_b16 v[68:69], v10 offset:16384
    v_mfma_f32_16x16x32_bf16 v[144:147], v[112:115], v[84:87], v[144:147]
    s_add_u32 m0, s21, 99328
    s_nop 0
    buffer_load_dwordx4 v1, s[4:7], s17 offen sc1 lds
    s_add_u32 s17, s17, s62
    v_mfma_f32_16x16x32_bf16 v[148:151], v[116:119], v[84:87], v[148:151]
    ds_read_b64_tr_b16 v[70:71], v11 offset:16384
    v_mfma_f32_16x16x32_bf16 v[152:155], v[120:123], v[84:87], v[152:155]
    ds_read_b64_tr_b16 v[72:73], v8 offset:24576
    v_mfma_f32_16x16x32_bf16 v[156:159], v[124:127], v[84:87], v[156:159]
    ds_read_b64_tr_b16 v[74:75], v9 offset:24576
    v_mfma_f32_16x16x32_bf16 v[160:163], v[112:115], v[88:91], v[160:163]
    s_add_u32 m0, s22, 98304
    s_nop 0
    buffer_load_dwordx4 v2, s[8:11], s18 offen lds
    s_add_u32 s18, s18, s20
    v_mfma_f32_16x16x32_bf16 v[164:167], v[116:119], v[88:91], v[164:167]
    ds_read_b64_tr_b16 v[76:77], v10 offset:24576
    v_mfma_f32_16x16x32_bf16 v[168:171], v[120:123], v[88:91], v[168:171]
    ds_read_b64_tr_b16 v[78:79], v11 offset:24576
    v_mfma_f32_16x16x32_bf16 v[172:175], v[124:127], v[88:91], v[172:175]
    ds_read_b128 v[32:35], v5 offset:0
    v_mfma_f32_16x16x32_bf16 v[176:179], v[112:115], v[92:95], v[176:179]
    s_add_u32 m0, s22, 106496
    s_nop 0
    buffer_load_dwordx4 v2, s[12:15], s19 offen lds
    s_add_u32 s19, s19, s20
    v_mfma_f32_16x16x32_bf16 v[180:183], v[116:119], v[92:95], v[180:183]
    ds_read_b128 v[36:39], v5 offset:1024
    v_mfma_f32_16x16x32_bf16 v[184:187], v[120:123], v[92:95], v[184:187]
    ds_read_b128 v[40:43], v5 offset:2048
    v_mfma_f32_16x16x32_bf16 v[188:191], v[124:127], v[92:95], v[188:191]
    ds_read_b128 v[44:47], v5 offset:3072
    v_mfma_f32_16x16x32_bf16 v[192:195], v[112:115], v[96:99], v[192:195]
    ds_read_b128 v[48:51], v5 offset:4096
    v_mfma_f32_16x16x32_bf16 v[196:199], v[116:119], v[96:99], v[196:199]
    ds_read_b128 v[52:55], v5 offset:5120
    v_mfma_f32_16x16x32_bf16 v[200:203], v[120:123], v[96:99], v[200:203]
    ds_read_b128 v[56:59], v5 offset:6144
    v_mfma_f32_16x16x32_bf16 v[204:207], v[124:127], v[96:99], v[204:207]
    ds_read_b128 v[60:63], v5 offset:7168
    v_mfma_f32_16x16x32_bf16 v[208:211], v[112:115], v[100:103], v[208:211]
    v_mfma_f32_16x16x32_bf16 v[212:215], v[116:119], v[100:103], v[212:215]
    v_mfma_f32_16x16x32_bf16 v[216:219], v[120:123], v[100:103], v[216:219]
    v_mfma_f32_16x16x32_bf16 v[220:223], v[124:127], v[100:103], v[220:223]
    v_mfma_f32_16x16x32_bf16 v[224:227], v[112:115], v[104:107], v[224:227]
    v_mfma_f32_16x16x32_bf16 v[228:231], v[116:119], v[104:107], v[228:231]
    v_mfma_f32_16x16x32_bf16 v[232:235], v[120:123], v[104:107], v[232:235]
    v_mfma_f32_16x16x32_bf16 v[236:239], v[124:127], v[104:107], v[236:239]
    v_mfma_f32_16x16x32_bf16 v[240:243], v[112:115], v[108:111], v[240:243]
    v_mfma_f32_16x16x32_bf16 v[244:247], v[116:119], v[108:111], v[244:247]
    v_mfma_f32_16x16x32_bf16 v[248:251], v[120:123], v[108:111], v[248:251]
    v_mfma_f32_16x16x32_bf16 v[252:255], v[124:127], v[108:111], v[252:255]
    s_waitcnt lgkmcnt(0)
    s_branch w_loop_chk
w_first8:
    s_waitcnt vmcnt(16)
    s_barrier
    v_mfma_f32_16x16x32_bf16 v[128:131], v[64:67], v[32:35], 0
    s_add_u32 m0, s21, 0
    s_nop 0
    buffer_load_dwordx4 v1, s[4:7], s16 offen sc1 lds
    s_add_u32 s16, s16, s62
    v_mfma_f32_16x16x32_bf16 v[132:135], v[68:71], v[32:35], 0
    ds_read_b64_tr_b16 v[112:113], v8 offset:49152
    v_mfma_f32_16x16x32_bf16 v[136:139], v[72:75], v[32:35], 0
    ds_read_b64_tr_b16 v[114:115], v9 offset:49152
    v_mfma_f32_16x16x32_bf16 v[140:143], v[76:79], v[32:35], 0
    ds_read_b64_tr_b16 v[116:117], v10 offset:49152
    v_mfma_f32_16x16x32_bf16 v[144:147], v[64:67], v[36:39], 0
    s_add_u32 m0, s21, 1024
    s_nop 0
    buffer_load_dwordx4 v1, s[4:7], s17 offen sc1 lds
    s_add_u32 s17, s17, s62
    v_mfma_f32_16x16x32_bf16 v[148:151], v[68:71], v[36:39], 0
    ds_read_b64_tr_b16 v[118:119], v11 offset:49152
    v_mfma_f32_16x16x32_bf16 v[152:155], v[72:75], v[36:39], 0
    ds_read_b64_tr_b16 v[120:121], v8 offset:57344
    v_mfma_f32_16x16x32_bf16 v[156:159], v[76:79], v[36:39], 0
    ds_read_b64_tr_b16 v[122:123], v9 offset:57344
    v_mfma_f32_16x16x32_bf16 v[160:163], v[64:67], v[40:43], 0
    s_add_u32 m0, s22, 0
    s_nop 0
    buffer_load_dwordx4 v2, s[8:11], s18 offen lds
    s_add_u32 s18, s18, s20
    v_mfma_f32_16x16x32_bf16 v[164:167], v[68:71], v[40:43], 0
    ds_read_b64_tr_b16 v[124:125], v10 offset:57344
    v_mfma_f32_16x16x32_bf16 v[168:171], v[72:75], v[40:43], 0
    ds_read_b64_tr_b16 v[126:127], v11 offset:57344
    v_mfma_f32_16x16x32_bf16 v[172:175], v[76:79], v[40:43], 0
    ds_read_b128 v[80:83], v5 offset:32768
    v_mfma_f32_16x16x32_bf16 v[176:179], v[64:67], v[44:47], 0
    s_add_u32 m0, s22, 8192
    s_nop 0
    buffer_load_dwordx4 v2, s[12:15], s19 offen lds
    s_add_u32 s19, s19, s20
    v_mfma_f32_16x16x32_bf16 v[180:183], v[68:71], v[44:47], 0
    ds_read_b128 v[84:87], v5 offset:33792
    v_mfma_f32_16x16x32_bf16 v[184:187], v[72:75], v[44:47], 0
    ds_read_b128 v[88:91], v5 offset:34816
    v_mfma_f32_16x16x32_bf16 v[188:191], v[76:79], v[44:47], 0
    ds_read_b128 v[92:95], v5 offset:35840
    v_mfma_f32_16x16x32_bf16 v[192:195], v[64:67], v[48:51], 0
    ds_read_b128 v[96:99], v5 offset:36864
    v_mfma_f32_16x16x32_bf16 v[196:199], v[68:71], v[48:51], 0
    ds_read_b128 v[100:103], v5 offset:37888
    v_mfma_f32_16x16x32_bf16 v[200:203], v[72:75], v[48:51], 0
    ds_read_b128 v[104:107], v5 offset:38912
    v_mfma_f32_16x16x32_bf16 v[204:207], v[76:79], v[48:51], 0
    ds_read_b128 v[108:111], v5 offset:39936
    v_mfma_f32_16x16x32_bf16 v[208:211], v[64:67], v[52:55], 0
    v_mfma_f32_16x16x32_bf16 v[212:215], v[68:71], v[52:55], 0
    v_mfma_f32_16x16x32_bf16 v[216:219], v[72:75], v[52:55], 0
    v_mfma_f32_16x16x32_bf16 v[220:223], v[76:79], v[52:55], 0
    v_mfma_f32_16x16x32_bf16 v[224:227], v[64:67], v[56:59], 0
    v_mfma_f32_16x16x32_bf16 v[228:231], v[68:71], v[56:59], 0
    v_mfma_f32_16x16x32_bf16 v[232:235], v[72:75], v[56:59], 0
    v_mfma_f32_16x16x32_bf16 v[236:239], v[76:79], v[56:59], 0
    v_mfma_f32_16x16x32_bf16 v[240:243], v[64:67], v[60:63], 0
    v_mfma_f32_16x16x32_bf16 v[244:247], v[68:71], v[60:63], 0
    v_mfma_f32_16x16x32_bf16 v[248:251], v[72:75], v[60:63], 0
    v_mfma_f32_16x16x32_bf16 v[252:255], v[76:79], v[60:63], 0
    s_waitcnt lgkmcnt(0)
    s_waitcnt vmcnt(16)
    s_barrier
    v_mfma_f32_16x16x32_bf16 v[128:131], v[112:115], v[80:83], v[128:131]
    s_add_u32 m0, s21, 32768
    s_nop 0
    buffer_load_dwordx4 v1, s[4:7], s16 offen sc1 lds
    s_add_u32 s16, s16, s62
    v_mfma_f32_16x16x32_bf16 v[132:135], v[116:119], v[80:83], v[132:135]
    ds_read_b64_tr_b16 v[64:65], v12 offset:16384
    v_mfma_f32_16x16x32_bf16 v[136:139], v[120:123], v[80:83], v[136:139]
    ds_read_b64_tr_b16 v[66:67], v13 offset:16384
    v_mfma_f32_16x16x32_bf16 v[140:143], v[124:127], v[80:83], v[140:143]
    ds_read_b64_tr_b16 v[68:69], v14 offset:16384
    v_mfma_f32_16x16x32_bf16 v[144:147], v[112:115], v[84:87], v[144:147]
    s_add_u32 m0, s21, 33792
    s_nop 0
    buffer_load_dwordx4 v1, s[4:7], s17 offen sc1 lds
    s_add_u32 s17, s17, s62
    v_mfma_f32_16x16x32_bf16 v[148:151], v[116:119], v[84:87], v[148:151]
    ds_read_b64_tr_b16 v[70:71], v15 offset:16384
    v_mfma_f32_16x16x32_bf16 v[152:155], v[120:123], v[84:87], v[152:155]
    ds_read_b64_tr_b16 v[72:73], v12 offset:24576
    v_mfma_f32_16x16x32_bf16 v[156:159], v[124:127], v[84:87], v[156:159]
    ds_read_b64_tr_b16 v[74:75], v13 offset:24576
    v_mfma_f32_16x16x32_bf16 v[160:163], v[112:115], v[88:91], v[160:163]
    s_add_u32 m0, s22, 32768
    s_nop 0
    buffer_load_dwordx4 v2, s[8:11], s18 offen lds
    s_add_u32 s18, s18, s20
    v_mfma_f32_16x16x32_bf16 v[164:167], v[116:119], v[88:91], v[164:167]
    ds_read_b64_tr_b16 v[76:77], v14 offset:24576
    v_mfma_f32_16x16x32_bf16 v[168:171], v[120:123], v[88:91], v[168:171]
    ds_read_b64_tr_b16 v[78:79], v15 offset:24576
    v_mfma_f32_16x16x32_bf16 v[172:175], v[124:127], v[88:91], v[172:175]
    ds_read_b128 v[32:35], v6 offset:0
    v_mfma_f32_16x16x32_bf16 v[176:179], v[112:115], v[92:95], v[176:179]
    s_add_u32 m0, s22, 40960
    s_nop 0
    buffer_load_dwordx4 v2, s[12:15], s19 offen lds
    s_add_u32 s19, s19, s20
    v_mfma_f32_16x16x32_bf16 v[180:183], v[116:119], v[92:95], v[180:183]
    ds_read_b128 v[36:39], v6 offset:1024
    v_mfma_f32_16x16x32_bf16 v[184:187], v[120:123], v[92:95], v[184:187]
    ds_read_b128 v[40:43], v6 offset:2048
    v_mfma_f32_16x16x32_bf16 v[188:191], v[124:127], v[92:95], v[188:191]
    ds_read_b128 v[44:47], v6 offset:3072
    v_mfma_f32_16x16x32_bf16 v[192:195], v[112:115], v[96:99], v[192:195]
    ds_read_b128 v[48:51], v6 offset:4096
    v_mfma_f32_16x16x32_bf16 v[196:199], v[116:119], v[96:99], v[196:199]
    ds_read_b128 v[52:55], v6 offset:5120
    v_mfma_f32_16x16x32_bf16 v[200:203], v[120:123], v[96:99], v[200:203]
    ds_read_b128 v[56:59], v6 offset:6144
    v_mfma_f32_16x16x32_bf16 v[204:207], v[124:127], v[96:99], v[204:207]
    ds_read_b128 v[60:63], v6 offset:7168
    v_mfma_f32_16x16x32_bf16 v[208:211], v[112:115], v[100:103], v[208:211]
    v_mfma_f32_16x16x32_bf16 v[212:215], v[116:119], v[100:103], v[212:215]
    v_mfma_f32_16x16x32_bf16 v[216:219], v[120:123], v[100:103], v[216:219]
    v_mfma_f32_16x16x32_bf16 v[220:223], v[124:127], v[100:103], v[220:223]
    v_mfma_f32_16x16x32_bf16 v[224:227], v[112:115], v[104:107], v[224:227]
    v_mfma_f32_16x16x32_bf16 v[228:231], v[116:119], v[104:107], v[228:231]
    v_mfma_f32_16x16x32_bf16 v[232:235], v[120:123], v[104:107], v[232:235]
    v_mfma_f32_16x16x32_bf16 v[236:239], v[124:127], v[104:107], v[236:239]
    v_mfma_f32_16x16x32_bf16 v[240:243], v[112:115], v[108:111], v[240:243]
    v_mfma_f32_16x16x32_bf16 v[244:247], v[116:119], v[108:111], v[244:247]
    v_mfma_f32_16x16x32_bf16 v[248:251], v[120:123], v[108:111], v[248:251]
    v_mfma_f32_16x16x32_bf16 v[252:255], v[124:127], v[108:111], v[252:255]
    s_waitcnt lgkmcnt(0)
    s_waitcnt vmcnt(16)
    s_barrier
    v_mfma_f32_16x16x32_bf16 v[128:131], v[64:67], v[32:35], v[128:131]
    s_add_u32 m0, s21, 65536
    s_nop 0
    buffer_load_dwordx4 v1, s[4:7], s16 offen sc1 lds
    s_add_u32 s16, s16, s62
    v_mfma_f32_16x16x32_bf16 v[132:135], v[68:71], v[32:35], v[132:135]
    ds_read_b64_tr_b16 v[112:113], v12 offset:49152
    v_mfma_f32_16x16x32_bf16 v[136:139], v[72:75], v[32:35], v[136:139]
    ds_read_b64_tr_b16 v[114:115], v13 offset:49152
    v_mfma_f32_16x16x32_bf16 v[140:143], v[76:79], v[32:35], v[140:143]
    ds_read_b64_tr_b16 v[116:117], v14 offset:49152
    v_mfma_f32_16x16x32_bf16 v[144:147], v[64:67], v[36:39], v[144:147]
    s_add_u32 m0, s21, 66560
    s_nop 0
    buffer_load_dwordx4 v1, s[4:7], s17 offen sc1 lds
    s_add_u32 s17, s17, s62
    v_mfma_f32_16x16x32_bf16 v[148:151], v[68:71], v[36:39], v[148:151]
    ds_read_b64_tr_b16 v[118:119], v15 offset:49152
    v_mfma_f32_16x16x32_bf16 v[152:155], v[72:75], v[36:39], v[152:155]
    ds_read_b64_tr_b16 v[120:121], v12 offset:57344
    v_mfma_f32_16x16x32_bf16 v[156:159], v[76:79], v[36:39], v[156:159]
    ds_read_b64_tr_b16 v[122:123], v13 offset:57344
    v_mfma_f32_16x16x32_bf16 v[160:163], v[64:67], v[40:43], v[160:163]
    s_add_u32 m0, s22, 65536
    s_nop 0
    buffer_load_dwordx4 v2, s[8:11], s18 offen lds
    s_add_u32 s18, s18, s20
    v_mfma_f32_16x16x32_bf16 v[164:167], v[68:71], v[40:43], v[164:167]
    ds_read_b64_tr_b16 v[124:125], v14 offset:57344
    v_mfma_f32_16x16x32_bf16 v[168:171], v[72:75], v[40:43], v[168:171]
    ds_read_b64_tr_b16 v[126:127], v15 offset:57344
    v_mfma_f32_16x16x32_bf16 v[172:175], v[76:79], v[40:43], v[172:175]
    ds_read_b128 v[80:83], v6 offset:32768
    v_mfma_f32_16x16x32_bf16 v[176:179], v[64:67], v[44:47], v[176:179]
    s_add_u32 m0, s22, 73728
    s_nop 0
    buffer_load_dwordx4 v2, s[12:15], s19 offen lds
    s_add_u32 s19, s19, s20
    v_mfma_f32_16x16x32_bf16 v[180:183], v[68:71], v[44:47], v[180:183]
    ds_read_b128 v[84:87], v6 offset:33792
    v_mfma_f32_16x16x32_bf16 v[184:187], v[72:75], v[44:47], v[184:187]
    ds_read_b128 v[88:91], v6 offset:34816
    v_mfma_f32_16x16x32_bf16 v[188:191], v[76:79], v[44:47], v[188:191]
    ds_read_b128 v[92:95], v6 offset:35840
    v_mfma_f32_16x16x32_bf16 v[192:195], v[64:67], v[48:51], v[192:195]
    ds_read_b128 v[96:99], v6 offset:36864
    v_mfma_f32_16x16x32_bf16 v[196:199], v[68:71], v[48:51], v[196:199]
    ds_read_b128 v[100:103], v6 offset:37888
    v_mfma_f32_16x16x32_bf16 v[200:203], v[72:75], v[48:51], v[200:203]
    ds_read_b128 v[104:107], v6 offset:38912
    v_mfma_f32_16x16x32_bf16 v[204:207], v[76:79], v[48:51], v[204:207]
    ds_read_b128 v[108:111], v6 offset:39936
    v_mfma_f32_16x16x32_bf16 v[208:211], v[64:67], v[52:55], v[208:211]
    v_mfma_f32_16x16x32_bf16 v[212:215], v[68:71], v[52:55], v[212:215]
    v_mfma_f32_16x16x32_bf16 v[216:219], v[72:75], v[52:55], v[216:219]
    v_mfma_f32_16x16x32_bf16 v[220:223], v[76:79], v[52:55], v[220:223]
    v_mfma_f32_16x16x32_bf16 v[224:227], v[64:67], v[56:59], v[224:227]
    v_mfma_f32_16x16x32_bf16 v[228:231], v[68:71], v[56:59], v[228:231]
    v_mfma_f32_16x16x32_bf16 v[232:235], v[72:75], v[56:59], v[232:235]
    v_mfma_f32_16x16x32_bf16 v[236:239], v[76:79], v[56:59], v[236:239]
    v_mfma_f32_16x16x32_bf16 v[240:243], v[64:67], v[60:63], v[240:243]
    v_mfma_f32_16x16x32_bf16 v[244:247], v[68:71], v[60:63], v[244:247]
    v_mfma_f32_16x16x32_bf16 v[248:251], v[72:75], v[60:63], v[248:251]
    v_mfma_f32_16x16x32_bf16 v[252:255], v[76:79], v[60:63], v[252:255]
    s_waitcnt lgkmcnt(0)
    s_waitcnt vmcnt(8)
    s_barrier
    s_cmp_eq_u32 s28, 0
    s_cbranch_scc1 sig_3
    s_cmp_lg_u32 s3, 0
    s_cbranch_scc1 sig_3
    s_and_b32 s57, s28, 3
    v_mov_b32 v24, s57
    s_bfe_u32 s57, s28, 0x20002
    v_mov_b32 v25, s57
    s_andn2_b32 s28, s28, 15
    s_mov_b64 exec, 1
    buffer_atomic_add_x2 v[24:25], v17, s[4:7], s28 offen sc1
    s_mov_b64 exec, -1
sig_3:
    s_mov_b32 s28, 0
    v_mfma_f32_16x16x32_bf16 v[128:131], v[112:115], v[80:83], v[128:131]
    s_add_u32 m0, s21, 98304
    s_nop 0
    buffer_load_dwordx4 v1, s[4:7], s16 offen sc1 lds
    s_add_u32 s16, s16, s62
    v_mfma_f32_16x16x32_bf16 v[132:135], v[116:119], v[80:83], v[132:135]
    ds_read_b64_tr_b16 v[64:65], v8 offset:16384
    v_mfma_f32_16x16x32_bf16 v[136:139], v[120:123], v[80:83], v[136:139]
    ds_read_b64_tr_b16 v[66:67], v9 offset:16384
    v_mfma_f32_16x16x32_bf16 v[140:143], v[124:127], v[80:83], v[140:143]
    ds_read_b64_tr_b16 v[68:69], v10 offset:16384
    v_mfma_f32_16x16x32_bf16 v[144:147], v[112:115], v[84:87], v[144:147]
    s_add_u32 m0, s21, 99328
    s_nop 0
    buffer_load_dwordx4 v1, s[4:7], s17 offen sc1 lds
    s_add_u32 s17, s17, s62
    v_mfma_f32_16x16x32_bf16 v[148:151], v[116:119], v[84:87], v[148:151]
    ds_read_b64_tr_b16 v[70:71], v11 offset:16384
    v_mfma_f32_16x16x32_bf16 v[152:155], v[120:123], v[84:87], v[152:155]
    ds_read_b64_tr_b16 v[72:73], v8 offset:24576
    v_mfma_f32_16x16x32_bf16 v[156:159], v[124:127], v[84:87], v[156:159]
    ds_read_b64_tr_b16 v[74:75], v9 offset:24576
    v_mfma_f32_16x16x32_bf16 v[160:163], v[112:115], v[88:91], v[160:163]
    s_add_u32 m0, s22, 98304
    s_nop 0
    buffer_load_dwordx4 v2, s[8:11], s18 offen lds
    s_add_u32 s18, s18, s20
    v_mfma_f32_16x16x32_bf16 v[164:167], v[116:119], v[88:91], v[164:167]
    ds_read_b64_tr_b16 v[76:77], v10 offset:24576
    v_mfma_f32_16x16x32_bf16 v[168:171], v[120:123], v[88:91], v[168:171]
    ds_read_b64_tr_b16 v[78:79], v11 offset:24576
    v_mfma_f32_16x16x32_bf16 v[172:175], v[124:127], v[88:91], v[172:175]
    ds_read_b128 v[32:35], v5 offset:0
    v_mfma_f32_16x16x32_bf16 v[176:179], v[112:115], v[92:95], v[176:179]
    s_add_u32 m0, s22, 106496
    s_nop 0
    buffer_load_dwordx4 v2, s[12:15], s19 offen lds
    s_add_u32 s19, s19, s20
    v_mfma_f32_16x16x32_bf16 v[180:183], v[116:119], v[92:95], v[180:183]
    ds_read_b128 v[36:39], v5 offset:1024
    v_mfma_f32_16x16x32_bf16 v[184:187], v[120:123], v[92:95], v[184:187]
    ds_read_b128 v[40:43], v5 offset:2048
    v_mfma_f32_16x16x32_bf16 v[188:191], v[124:127], v[92:95], v[188:191]
    ds_read_b128 v[44:47], v5 offset:3072
    v_mfma_f32_16x16x32_bf16 v[192:195], v[112:115], v[96:99], v[192:195]
    ds_read_b128 v[48:51], v5 offset:4096
    v_mfma_f32_16x16x32_bf16 v[196:199], v[116:119], v[96:99], v[196:199]
    ds_read_b128 v[52:55], v5 offset:5120
    v_mfma_f32_16x16x32_bf16 v[200:203], v[120:123], v[96:99], v[200:203]
    ds_read_b128 v[56:59], v5 offset:6144
    v_mfma_f32_16x16x32_bf16 v[204:207], v[124:127], v[96:99], v[204:207]
    ds_read_b128 v[60:63], v5 offset:7168
    v_mfma_f32_16x16x32_bf16 v[208:211], v[112:115], v[100:103], v[208:211]
    v_mfma_f32_16x16x32_bf16 v[212:215], v[116:119], v[100:103], v[212:215]
    v_mfma_f32_16x16x32_bf16 v[216:219], v[120:123], v[100:103], v[216:219]
    v_mfma_f32_16x16x32_bf16 v[220:223], v[124:127], v[100:103], v[220:223]
    v_mfma_f32_16x16x32_bf16 v[224:227], v[112:115], v[104:107], v[224:227]
    v_mfma_f32_16x16x32_bf16 v[228:231], v[116:119], v[104:107], v[228:231]
    v_mfma_f32_16x16x32_bf16 v[232:235], v[120:123], v[104:107], v[232:235]
    v_mfma_f32_16x16x32_bf16 v[236:239], v[124:127], v[104:107], v[236:239]
    v_mfma_f32_16x16x32_bf16 v[240:243], v[112:115], v[108:111], v[240:243]
    v_mfma_f32_16x16x32_bf16 v[244:247], v[116:119], v[108:111], v[244:247]
    v_mfma_f32_16x16x32_bf16 v[248:251], v[120:123], v[108:111], v[248:251]
    v_mfma_f32_16x16x32_bf16 v[252:255], v[124:127], v[108:111], v[252:255]
    s_waitcnt lgkmcnt(0)
    s_branch w_loop_chk
w_first16:
    s_waitcnt vmcnt(24)
    s_barrier
    v_mfma_f32_16x16x32_bf16 v[128:131], v[64:67], v[32:35], 0
    s_add_u32 m0, s21, 0
    s_nop 0
    buffer_load_dwordx4 v1, s[4:7], s16 offen sc1 lds
    s_add_u32 s16, s16, s62
    v_mfma_f32_16x16x32_bf16 v[132:135], v[68:71], v[32:35], 0
    ds_read_b64_tr_b16 v[112:113], v8 offset:49152
    v_mfma_f32_16x16x32_bf16 v[136:139], v[72:75], v[32:35], 0
    ds_read_b64_tr_b16 v[114:115], v9 offset:49152
    v_mfma_f32_16x16x32_bf16 v[140:143], v[76:79], v[32:35], 0
    ds_read_b64_tr_b16 v[116:117], v10 offset:49152
    v_mfma_f32_16x16x32_bf16 v[144:147], v[64:67], v[36:39], 0
    s_add_u32 m0, s21, 1024
    s_nop 0
    buffer_load_dwordx4 v1, s[4:7], s17 offen sc1 lds
    s_add_u32 s17, s17, s62
    v_mfma_f32_16x16x32_bf16 v[148:151], v[68:71], v[36:39], 0
    ds_read_b64_tr_b16 v[118:119], v11 offset:49152
    v_mfma_f32_16x16x32_bf16 v[152:155], v[72:75], v[36:39], 0
    ds_read_b64_tr_b16 v[120:121], v8 offset:57344
    v_mfma_f32_16x16x32_bf16 v[156:159], v[76:79], v[36:39], 0
    ds_read_b64_tr_b16 v[122:123], v9 offset:57344
    v_mfma_f32_16x16x32_bf16 v[160:163], v[64:67], v[40:43], 0
    s_add_u32 m0, s22, 0
    s_nop 0
    buffer_load_dwordx4 v2, s[8:11], s18 offen lds
    s_add_u32 s18, s18, s20
    v_mfma_f32_16x16x32_bf16 v[164:167], v[68:71], v[40:43], 0
    ds_read_b64_tr_b16 v[124:125], v10 offset:57344
    v_mfma_f32_16x16x32_bf16 v[168:171], v[72:75], v[40:43], 0
    ds_read_b64_tr_b16 v[126:127], v11 offset:57344
    v_mfma_f32_16x16x32_bf16 v[172:175], v[76:79], v[40:43], 0
    ds_read_b128 v[80:83], v5 offset:32768
    v_mfma_f32_16x16x32_bf16 v[176:179], v[64:67], v[44:47], 0
    s_add_u32 m0, s22, 8192
    s_nop 0
    buffer_load_dwordx4 v2, s[12:15], s19 offen lds
    s_add_u32 s19, s19, s20
    v_mfma_f32_16x16x32_bf16 v[180:183], v[68:71], v[44:47], 0
    ds_read_b128 v[84:87], v5 offset:33792
    v_mfma_f32_16x16x32_bf16 v[184:187], v[72:75], v[44:47], 0
    ds_read_b128 v[88:91], v5 offset:34816
    v_mfma_f32_16x16x32_bf16 v[188:191], v[76:79], v[44:47], 0
    ds_read_b128 v[92:95], v5 offset:35840
    v_mfma_f32_16x16x32_bf16 v[192:195], v[64:67], v[48:51], 0
    ds_read_b128 v[96:99], v5 offset:36864
    v_mfma_f32_16x16x32_bf16 v[196:199], v[68:71], v[48:51], 0
    ds_read_b128 v[100:103], v5 offset:37888
    v_mfma_f32_16x16x32_bf16 v[200:203], v[72:75], v[48:51], 0
    ds_read_b128 v[104:107], v5 offset:38912
    v_mfma_f32_16x16x32_bf16 v[204:207], v[76:79], v[48:51], 0
    ds_read_b128 v[108:111], v5 offset:39936
    v_mfma_f32_16x16x32_bf16 v[208:211], v[64:67], v[52:55], 0
    v_mfma_f32_16x16x32_bf16 v[212:215], v[68:71], v[52:55], 0
    v_mfma_f32_16x16x32_bf16 v[216:219], v[72:75], v[52:55], 0
    v_mfma_f32_16x16x32_bf16 v[220:223], v[76:79], v[52:55], 0
    v_mfma_f32_16x16x32_bf16 v[224:227], v[64:67], v[56:59], 0
    v_mfma_f32_16x16x32_bf16 v[228:231], v[68:71], v[56:59], 0
    v_mfma_f32_16x16x32_bf16 v[232:235], v[72:75], v[56:59], 0
    v_mfma_f32_16x16x32_bf16 v[236:239], v[76:79], v[56:59], 0
    v_mfma_f32_16x16x32_bf16 v[240:243], v[64:67], v[60:63], 0
    v_mfma_f32_16x16x32_bf16 v[244:247], v[68:71], v[60:63], 0
    v_mfma_f32_16x16x32_bf16 v[248:251], v[72:75], v[60:63], 0
    v_mfma_f32_16x16x32_bf16 v[252:255], v[76:79], v[60:63], 0
    s_waitcnt lgkmcnt(0)
    s_waitcnt vmcnt(24)
    s_barrier
    v_mfma_f32_16x16x32_bf16 v[128:131], v[112:115], v[80:83], v[128:131]
    s_add_u32 m0, s21, 32768
    s_nop 0
    buffer_load_dwordx4 v1, s[4:7], s16 offen sc1 lds
    s_add_u32 s16, s16, s62
    v_mfma_f32_16x16x32_bf16 v[132:135], v[116:119], v[80:83], v[132:135]
    ds_read_b64_tr_b16 v[64:65], v12 offset:16384
    v_mfma_f32_16x16x32_bf16 v[136:139], v[120:123], v[80:83], v[136:139]
    ds_read_b64_tr_b16 v[66:67], v13 offset:16384
    v_mfma_f32_16x16x32_bf16 v[140:143], v[124:127], v[80:83], v[140:143]
    ds_read_b64_tr_b16 v[68:69], v14 offset:16384
    v_mfma_f32_16x16x32_bf16 v[144:147], v[112:115], v[84:87], v[144:147]
    s_add_u32 m0, s21, 33792
    s_nop 0
    buffer_load_dwordx4 v1, s[4:7], s17 offen sc1 lds
    s_add_u32 s17, s17, s62
    v_mfma_f32_16x16x32_bf16 v[148:151], v[116:119], v[84:87], v[148:151]
    ds_read_b64_tr_b16 v[70:71], v15 offset:16384
    v_mfma_f32_16x16x32_bf16 v[152:155], v[120:123], v[84:87], v[152:155]
    ds_read_b64_tr_b16 v[72:73], v12 offset:24576
    v_mfma_f32_16x16x32_bf16 v[156:159], v[124:127], v[84:87], v[156:159]
    ds_read_b64_tr_b16 v[74:75], v13 offset:24576
    v_mfma_f32_16x16x32_bf16 v[160:163], v[112:115], v[88:91], v[160:163]
    s_add_u32 m0, s22, 32768
    s_nop 0
    buffer_load_dwordx4 v2, s[8:11], s18 offen lds
    s_add_u32 s18, s18, s20
    v_mfma_f32_16x16x32_bf16 v[164:167], v[116:119], v[88:91], v[164:167]
    ds_read_b64_tr_b16 v[76:77], v14 offset:24576
    v_mfma_f32_16x16x32_bf16 v[168:171], v[120:123], v[88:91], v[168:171]
    ds_read_b64_tr_b16 v[78:79], v15 offset:24576
    v_mfma_f32_16x16x32_bf16 v[172:175], v[124:127], v[88:91], v[172:175]
    ds_read_b128 v[32:35], v6 offset:0
    v_mfma_f32_16x16x32_bf16 v[176:179], v[112:115], v[92:95], v[176:179]
    s_add_u32 m0, s22, 40960
    s_nop 0
    buffer_load_dwordx4 v2, s[12:15], s19 offen lds
    s_add_u32 s19, s19, s20
    v_mfma_f32_16x16x32_bf16 v[180:183], v[116:119], v[92:95], v[180:183]
    ds_read_b128 v[36:39], v6 offset:1024
    v_mfma_f32_16x16x32_bf16 v[184:187], v[120:123], v[92:95], v[184:187]
    ds_read_b128 v[40:43], v6 offset:2048
    v_mfma_f32_16x16x32_bf16 v[188:191], v[124:127], v[92:95], v[188:191]
    ds_read_b128 v[44:47], v6 offset:3072
    v_mfma_f32_16x16x32_bf16 v[192:195], v[112:115], v[96:99], v[192:195]
    ds_read_b128 v[48:51], v6 offset:4096
    v_mfma_f32_16x16x32_bf16 v[196:199], v[116:119], v[96:99], v[196:199]
    ds_read_b128 v[52:55], v6 offset:5120
    v_mfma_f32_16x16x32_bf16 v[200:203], v[120:123], v[96:99], v[200:203]
    ds_read_b128 v[56:59], v6 offset:6144
    v_mfma_f32_16x16x32_bf16 v[204:207], v[124:127], v[96:99], v[204:207]
    ds_read_b128 v[60:63], v6 offset:7168
    v_mfma_f32_16x16x32_bf16 v[208:211], v[112:115], v[100:103], v[208:211]
    v_mfma_f32_16x16x32_bf16 v[212:215], v[116:119], v[100:103], v[212:215]
    v_mfma_f32_16x16x32_bf16 v[216:219], v[120:123], v[100:103], v[216:219]
    v_mfma_f32_16x16x32_bf16 v[220:223], v[124:127], v[100:103], v[220:223]
    v_mfma_f32_16x16x32_bf16 v[224:227], v[112:115], v[104:107], v[224:227]
    v_mfma_f32_16x16x32_bf16 v[228:231], v[116:119], v[104:107], v[228:231]
    v_mfma_f32_16x16x32_bf16 v[232:235], v[120:123], v[104:107], v[232:235]
    v_mfma_f32_16x16x32_bf16 v[236:239], v[124:127], v[104:107], v[236:239]
    v_mfma_f32_16x16x32_bf16 v[240:243], v[112:115], v[108:111], v[240:243]
    v_mfma_f32_16x16x32_bf16 v[244:247], v[116:119], v[108:111], v[244:247]
    v_mfma_f32_16x16x32_bf16 v[248:251], v[120:123], v[108:111], v[248:251]
    v_mfma_f32_16x16x32_bf16 v[252:255], v[124:127], v[108:111], v[252:255]
    s_waitcnt lgkmcnt(0)
    s_waitcnt vmcnt(24)
    s_barrier
    v_mfma_f32_16x16x32_bf16 v[128:131], v[64:67], v[32:35], v[128:131]
    s_add_u32 m0, s21, 65536
    s_nop 0
    buffer_load_dwordx4 v1, s[4:7], s16 offen sc1 lds
    s_add_u32 s16, s16, s62
    v_mfma_f32_16x16x32_bf16 v[132:135], v[68:71], v[32:35], v[132:135]
    ds_read_b64_tr_b16 v[112:113], v12 offset:49152
    v_mfma_f32_16x16x32_bf16 v[136:139], v[72:75], v[32:35], v[136:139]
    ds_read_b64_tr_b16 v[114:115], v13 offset:49152
    v_mfma_f32_16x16x32_bf16 v[140:143], v[76:79], v[32:35], v[140:143]
    ds_read_b64_tr_b16 v[116:117], v14 offset:49152
    v_mfma_f32_16x16x32_bf16 v[144:147], v[64:67], v[36:39], v[144:147]
    s_add_u32 m0, s21, 66560
    s_nop 0
    buffer_load_dwordx4 v1, s[4:7], s17 offen sc1 lds
    s_add_u32 s17, s17, s62
    v_mfma_f32_16x16x32_bf16 v[148:151], v[68:71], v[36:39], v[148:151]
    ds_read_b64_tr_b16 v[118:119], v15 offset:49152
    v_mfma_f32_16x16x32_bf16 v[152:155], v[72:75], v[36:39], v[152:155]
    ds_read_b64_tr_b16 v[120:121], v12 offset:57344
    v_mfma_f32_16x16x32_bf16 v[156:159], v[76:79], v[36:39], v[156:159]
    ds_read_b64_tr_b16 v[122:123], v13 offset:57344
    v_mfma_f32_16x16x32_bf16 v[160:163], v[64:67], v[40:43], v[160:163]
    s_add_u32 m0, s22, 65536
    s_nop 0
    buffer_load_dwordx4 v2, s[8:11], s18 offen lds
    s_add_u32 s18, s18, s20
    v_mfma_f32_16x16x32_bf16 v[164:167], v[68:71], v[40:43], v[164:167]
    ds_read_b64_tr_b16 v[124:125], v14 offset:57344
    v_mfma_f32_16x16x32_bf16 v[168:171], v[72:75], v[40:43], v[168:171]
    ds_read_b64_tr_b16 v[126:127], v15 offset:57344
    v_mfma_f32_16x16x32_bf16 v[172:175], v[76:79], v[40:43], v[172:175]
    ds_read_b128 v[80:83], v6 offset:32768
    v_mfma_f32_16x16x32_bf16 v[176:179], v[64:67], v[44:47], v[176:179]
    s_add_u32 m0, s22, 73728
    s_nop 0
    buffer_load_dwordx4 v2, s[12:15], s19 offen lds
    s_add_u32 s19, s19, s20
    v_mfma_f32_16x16x32_bf16 v[180:183], v[68:71], v[44:47], v[180:183]
    ds_read_b128 v[84:87], v6 offset:33792
    v_mfma_f32_16x16x32_bf16 v[184:187], v[72:75], v[44:47], v[184:187]
    ds_read_b128 v[88:91], v6 offset:34816
    v_mfma_f32_16x16x32_bf16 v[188:191], v[76:79], v[44:47], v[188:191]
    ds_read_b128 v[92:95], v6 offset:35840
    v_mfma_f32_16x16x32_bf16 v[192:195], v[64:67], v[48:51], v[192:195]
    ds_read_b128 v[96:99], v6 offset:36864
    v_mfma_f32_16x16x32_bf16 v[196:199], v[68:71], v[48:51], v[196:199]
    ds_read_b128 v[100:103], v6 offset:37888
    v_mfma_f32_16x16x32_bf16 v[200:203], v[72:75], v[48:51], v[200:203]
    ds_read_b128 v[104:107], v6 offset:38912
    v_mfma_f32_16x16x32_bf16 v[204:207], v[76:79], v[48:51], v[204:207]
    ds_read_b128 v[108:111], v6 offset:39936
    v_mfma_f32_16x16x32_bf16 v[208:211], v[64:67], v[52:55], v[208:211]
    v_mfma_f32_16x16x32_bf16 v[212:215], v[68:71], v[52:55], v[212:215]
    v_mfma_f32_16x16x32_bf16 v[216:219], v[72:75], v[52:55], v[216:219]
    v_mfma_f32_16x16x32_bf16 v[220:223], v[76:79], v[52:55], v[220:223]
    v_mfma_f32_16x16x32_bf16 v[224:227], v[64:67], v[56:59], v[224:227]
    v_mfma_f32_16x16x32_bf16 v[228:231], v[68:71], v[56:59], v[228:231]
    v_mfma_f32_16x16x32_bf16 v[232:235], v[72:75], v[56:59], v[232:235]
    v_mfma_f32_16x16x32_bf16 v[236:239], v[76:79], v[56:59], v[236:239]
    v_mfma_f32_16x16x32_bf16 v[240:243], v[64:67], v[60:63], v[240:243]
    v_mfma_f32_16x16x32_bf16 v[244:247], v[68:71], v[60:63], v[244:247]
    v_mfma_f32_16x16x32_bf16 v[248:251], v[72:75], v[60:63], v[248:251]
    v_mfma_f32_16x16x32_bf16 v[252:255], v[76:79], v[60:63], v[252:255]
    s_waitcnt lgkmcnt(0)
    s_waitcnt vmcnt(8)
    s_barrier
    s_cmp_eq_u32 s28, 0
    s_cbranch_scc1 sig_4
    s_cmp_lg_u32 s3, 0
    s_cbranch_scc1 sig_4
    s_and_b32 s57, s28, 3
    v_mov_b32 v24, s57
    s_bfe_u32 s57, s28, 0x20002
    v_mov_b32 v25, s57
    s_andn2_b32 s28, s28, 15
    s_mov_b64 exec, 1
    buffer_atomic_add_x2 v[24:25], v17, s[4:7], s28 offen sc1
    s_mov_b64 exec, -1
sig_4:
    s_mov_b32 s28, 0
    v_mfma_f32_16x16x32_bf16 v[128:131], v[112:115], v[80:83], v[128:131]
    s_add_u32 m0, s21, 98304
    s_nop 0
    buffer_load_dwordx4 v1, s[4:7], s16 offen sc1 lds
    s_add_u32 s16, s16, s62
    v_mfma_f32_16x16x32_bf16 v[132:135], v[116:119], v[80:83], v[132:135]
    ds_read_b64_tr_b16 v[64:65], v8 offset:16384
    v_mfma_f32_16x16x32_bf16 v[136:139], v[120:123], v[80:83], v[136:139]
    ds_read_b64_tr_b16 v[66:67], v9 offset:16384
    v_mfma_f32_16x16x32_bf16 v[140:143], v[124:127], v[80:83], v[140:143]
    ds_read_b64_tr_b16 v[68:69], v10 offset:16384
    v_mfma_f32_16x16x32_bf16 v[144:147], v[112:115], v[84:87], v[144:147]
    s_add_u32 m0, s21, 99328
    s_nop 0
    buffer_load_dwordx4 v1, s[4:7], s17 offen sc1 lds
    s_add_u32 s17, s17, s62
    v_mfma_f32_16x16x32_bf16 v[148:151], v[116:119], v[84:87], v[148:151]
    ds_read_b64_tr_b16 v[70:71], v11 offset:16384
    v_mfma_f32_16x16x32_bf16 v[152:155], v[120:123], v[84:87], v[152:155]
    ds_read_b64_tr_b16 v[72:73], v8 offset:24576
    v_mfma_f32_16x16x32_bf16 v[156:159], v[124:127], v[84:87], v[156:159]
    ds_read_b64_tr_b16 v[74:75], v9 offset:24576
    v_mfma_f32_16x16x32_bf16 v[160:163], v[112:115], v[88:91], v[160:163]
    s_add_u32 m0, s22, 98304
    s_nop 0
    buffer_load_dwordx4 v2, s[8:11], s18 offen lds
    s_add_u32 s18, s18, s20
    v_mfma_f32_16x16x32_bf16 v[164:167], v[116:119], v[88:91], v[164:167]
    ds_read_b64_tr_b16 v[76:77], v10 offset:24576
    v_mfma_f32_16x16x32_bf16 v[168:171], v[120:123], v[88:91], v[168:171]
    ds_read_b64_tr_b16 v[78:79], v11 offset:24576
    v_mfma_f32_16x16x32_bf16 v[172:175], v[124:127], v[88:91], v[172:175]
    ds_read_b128 v[32:35], v5 offset:0
    v_mfma_f32_16x16x32_bf16 v[176:179], v[112:115], v[92:95], v[176:179]
    s_add_u32 m0, s22, 106496
    s_nop 0
    buffer_load_dwordx4 v2, s[12:15], s19 offen lds
    s_add_u32 s19, s19, s20
    v_mfma_f32_16x16x32_bf16 v[180:183], v[116:119], v[92:95], v[180:183]
    ds_read_b128 v[36:39], v5 offset:1024
    v_mfma_f32_16x16x32_bf16 v[184:187], v[120:123], v[92:95], v[184:187]
    ds_read_b128 v[40:43], v5 offset:2048
    v_mfma_f32_16x16x32_bf16 v[188:191], v[124:127], v[92:95], v[188:191]
    ds_read_b128 v[44:47], v5 offset:3072
    v_mfma_f32_16x16x32_bf16 v[192:195], v[112:115], v[96:99], v[192:195]
    ds_read_b128 v[48:51], v5 offset:4096
    v_mfma_f32_16x16x32_bf16 v[196:199], v[116:119], v[96:99], v[196:199]
    ds_read_b128 v[52:55], v5 offset:5120
    v_mfma_f32_16x16x32_bf16 v[200:203], v[120:123], v[96:99], v[200:203]
    ds_read_b128 v[56:59], v5 offset:6144
    v_mfma_f32_16x16x32_bf16 v[204:207], v[124:127], v[96:99], v[204:207]
    ds_read_b128 v[60:63], v5 offset:7168
    v_mfma_f32_16x16x32_bf16 v[208:211], v[112:115], v[100:103], v[208:211]
    v_mfma_f32_16x16x32_bf16 v[212:215], v[116:119], v[100:103], v[212:215]
    v_mfma_f32_16x16x32_bf16 v[216:219], v[120:123], v[100:103], v[216:219]
    v_mfma_f32_16x16x32_bf16 v[220:223], v[124:127], v[100:103], v[220:223]
    v_mfma_f32_16x16x32_bf16 v[224:227], v[112:115], v[104:107], v[224:227]
    v_mfma_f32_16x16x32_bf16 v[228:231], v[116:119], v[104:107], v[228:231]
    v_mfma_f32_16x16x32_bf16 v[232:235], v[120:123], v[104:107], v[232:235]
    v_mfma_f32_16x16x32_bf16 v[236:239], v[124:127], v[104:107], v[236:239]
    v_mfma_f32_16x16x32_bf16 v[240:243], v[112:115], v[108:111], v[240:243]
    v_mfma_f32_16x16x32_bf16 v[244:247], v[116:119], v[108:111], v[244:247]
    v_mfma_f32_16x16x32_bf16 v[248:251], v[120:123], v[108:111], v[248:251]
    v_mfma_f32_16x16x32_bf16 v[252:255], v[124:127], v[108:111], v[252:255]
    s_waitcnt lgkmcnt(0)
w_loop_chk:
    s_sub_u32 s23, s23, 1
w_loop:
    s_cmp_gt_u32 s23, 3
    s_cbranch_scc1 w_body
    s_cmp_lg_u32 s23, 3
    s_cbranch_scc1 w_l2
    s_cmp_lg_u32 s3, 0
    s_cbranch_scc1 clm_5
    v_mov_b32 v26, 1
    s_mov_b64 exec, 1
    buffer_atomic_add v26, off, s[64:67], s71 sc0 sc1
    s_mov_b64 exec, -1
clm_5:
    s_branch w_body
w_l2:
    s_cmp_lg_u32 s23, 2
    s_cbranch_scc1 w_l1
    s_cmp_lg_u32 s3, 0
    s_cbranch_scc1 pub_6
    v_mov_b32 v20, 131136
    s_mov_b64 exec, 1
    ds_write_b32 v20, v26
    s_mov_b64 exec, -1
    s_waitcnt lgkmcnt(0)
pub_6:
    s_branch w_body
w_l1:
    s_waitcnt vmcnt(8)
    v_readfirstlane_b32 s30, v16
    s_cmp_ge_u32 s30, s45
    s_cselect_b32 s30, 0, 1
    s_or_b32 s30, s30, s70
    s_cmp_eq_u32 s32, 4
    s_cselect_b32 s30, 1, s30
    s_sub_u32 s57, s32, 1
    s_cmp_ge_u32 s57, 4
    s_cselect_b32 s30, 1, s30
    v_mov_b32 v20, s30
    ds_write_b32 v7, v20
    s_cbranch_scc1 w_body
    s_load_dwordx2 s[8:9], s[0:1], s33
    s_load_dwordx2 s[12:13], s[0:1], s34
    s_mov_b32 s10, s38
    s_mov_b32 s14, s38
    s_cmp_eq_u32 s32, 4
    s_cselect_b32 s31, 0, 1
    s_lshl_b32 s30, s3, s31
    s_mul_i32 s30, s30, s40
    s_add_u32 s16, s39, s30
    s_cmp_eq_u32 s32, 4
    s_cselect_b32 s30, 1024, s40
    s_cselect_b32 s31, 6, 5
    s_lshl_b32 s62, 32, s31
    s_add_u32 s17, s16, s30
    s_lshl_b32 s30, s3, 2
    s_mul_i32 s30, s30, s35
    s_add_u32 s18, s36, s30
    s_add_u32 s19, s37, s30
    s_lshl_b32 s20, s35, s31
    v_mul_u32_u24 v2, s35, v4
    v_add_u32 v2, v2, v3
    s_waitcnt lgkmcnt(0)
w_body:
    s_waitcnt vmcnt(8)
    s_barrier
    s_cmp_lg_u32 s23, 2
    s_cbranch_scc1 w_nf
    v_mov_b32 v20, 131136
    ds_read_b32 v20, v20
    s_waitcnt lgkmcnt(0)
    v_readfirstlane_b32 s59, v20
    s_add_u32 s59, s59, 32
    s_min_u32 s59, s59, 319
    s_lshl_b32 s57, s59, 6
    s_load_dwordx16 s[32:47], s[24:25], s57
w_nf:
    v_mfma_f32_16x16x32_bf16 v[128:131], v[64:67], v[32:35], v[128:131]
    s_add_u32 m0, s21, 0
    s_nop 0
    buffer_load_dwordx4 v1, s[4:7], s16 offen sc1 lds
    s_add_u32 s16, s16, s62
    v_mfma_f32_16x16x32_bf16 v[132:135], v[68:71], v[32:35], v[132:135]
    ds_read_b64_tr_b16 v[112:113], v8 offset:49152
    v_mfma_f32_16x16x32_bf16 v[136:139], v[72:75], v[32:35], v[136:139]
    ds_read_b64_tr_b16 v[114:115], v9 offset:49152
    v_mfma_f32_16x16x32_bf16 v[140:143], v[76:79], v[32:35], v[140:143]
    ds_read_b64_tr_b16 v[116:117], v10 offset:49152
    v_mfma_f32_16x16x32_bf16 v[144:147], v[64:67], v[36:39], v[144:147]
    s_add_u32 m0, s21, 1024
    s_nop 0
    buffer_load_dwordx4 v1, s[4:7], s17 offen sc1 lds
    s_add_u32 s17, s17, s62
    v_mfma_f32_16x16x32_bf16 v[148:151], v[68:71], v[36:39], v[148:151]
    ds_read_b64_tr_b16 v[118:119], v11 offset:49152
    v_mfma_f32_16x16x32_bf16 v[152:155], v[72:75], v[36:39], v[152:155]
    ds_read_b64_tr_b16 v[120:121], v8 offset:57344
    v_mfma_f32_16x16x32_bf16 v[156:159], v[76:79], v[36:39], v[156:159]
    ds_read_b64_tr_b16 v[122:123], v9 offset:57344
    v_mfma_f32_16x16x32_bf16 v[160:163], v[64:67], v[40:43], v[160:163]
    s_add_u32 m0, s22, 0
    s_nop 0
    buffer_load_dwordx4 v2, s[8:11], s18 offen lds
    s_add_u32 s18, s18, s20
    v_mfma_f32_16x16x32_bf16 v[164:167], v[68:71], v[40:43], v[164:167]
    ds_read_b64_tr_b16 v[124:125], v10 offset:57344
    v_mfma_f32_16x16x32_bf16 v[168:171], v[72:75], v[40:43], v[168:171]
    ds_read_b64_tr_b16 v[126:127], v11 offset:57344
    v_mfma_f32_16x16x32_bf16 v[172:175], v[76:79], v[40:43], v[172:175]
    ds_read_b128 v[80:83], v5 offset:32768
    v_mfma_f32_16x16x32_bf16 v[176:179], v[64:67], v[44:47], v[176:179]
    s_add_u32 m0, s22, 8192
    s_nop 0
    buffer_load_dwordx4 v2, s[12:15], s19 offen lds
    s_add_u32 s19, s19, s20
    v_mfma_f32_16x16x32_bf16 v[180:183], v[68:71], v[44:47], v[180:183]
    ds_read_b128 v[84:87], v5 offset:33792
    v_mfma_f32_16x16x32_bf16 v[184:187], v[72:75], v[44:47], v[184:187]
    ds_read_b128 v[88:91], v5 offset:34816
    v_mfma_f32_16x16x32_bf16 v[188:191], v[76:79], v[44:47], v[188:191]
    ds_read_b128 v[92:95], v5 offset:35840
    v_mfma_f32_16x16x32_bf16 v[192:195], v[64:67], v[48:51], v[192:195]
    ds_read_b128 v[96:99], v5 offset:36864
    v_mfma_f32_16x16x32_bf16 v[196:199], v[68:71], v[48:51], v[196:199]
    ds_read_b128 v[100:103], v5 offset:37888
    v_mfma_f32_16x16x32_bf16 v[200:203], v[72:75], v[48:51], v[200:203]
    ds_read_b128 v[104:107], v5 offset:38912
    v_mfma_f32_16x16x32_bf16 v[204:207], v[76:79], v[48:51], v[204:207]
    ds_read_b128 v[108:111], v5 offset:39936
    v_mfma_f32_16x16x32_bf16 v[208:211], v[64:67], v[52:55], v[208:211]
    v_mfma_f32_16x16x32_bf16 v[212:215], v[68:71], v[52:55], v[212:215]
    v_mfma_f32_16x16x32_bf16 v[216:219], v[72:75], v[52:55], v[216:219]
    v_mfma_f32_16x16x32_bf16 v[220:223], v[76:79], v[52:55], v[220:223]
    v_mfma_f32_16x16x32_bf16 v[224:227], v[64:67], v[56:59], v[224:227]
    v_mfma_f32_16x16x32_bf16 v[228:231], v[68:71], v[56:59], v[228:231]
    v_mfma_f32_16x16x32_bf16 v[232:235], v[72:75], v[56:59], v[232:235]
    v_mfma_f32_16x16x32_bf16 v[236:239], v[76:79], v[56:59], v[236:239]
    v_mfma_f32_16x16x32_bf16 v[240:243], v[64:67], v[60:63], v[240:243]
    v_mfma_f32_16x16x32_bf16 v[244:247], v[68:71], v[60:63], v[244:247]
    v_mfma_f32_16x16x32_bf16 v[248:251], v[72:75], v[60:63], v[248:251]
    v_mfma_f32_16x16x32_bf16 v[252:255], v[76:79], v[60:63], v[252:255]
    s_waitcnt lgkmcnt(0)
    s_waitcnt vmcnt(8)
    s_barrier
    buffer_load_dword v16, v17, s[4:7], s44 offen sc1
    v_mfma_f32_16x16x32_bf16 v[128:131], v[112:115], v[80:83], v[128:131]
    s_add_u32 m0, s21, 32768
    s_nop 0
    buffer_load_dwordx4 v1, s[4:7], s16 offen sc1 lds
    s_add_u32 s16, s16, s62
    v_mfma_f32_16x16x32_bf16 v[132:135], v[116:119], v[80:83], v[132:135]
    ds_read_b64_tr_b16 v[64:65], v12 offset:16384
    v_mfma_f32_16x16x32_bf16 v[136:139], v[120:123], v[80:83], v[136:139]
    ds_read_b64_tr_b16 v[66:67], v13 offset:16384
    v_mfma_f32_16x16x32_bf16 v[140:143], v[124:127], v[80:83], v[140:143]
    ds_read_b64_tr_b16 v[68:69], v14 offset:16384
    v_mfma_f32_16x16x32_bf16 v[144:147], v[112:115], v[84:87], v[144:147]
    s_add_u32 m0, s21, 33792
    s_nop 0
    buffer_load_dwordx4 v1, s[4:7], s17 offen sc1 lds
    s_add_u32 s17, s17, s62
    v_mfma_f32_16x16x32_bf16 v[148:151], v[116:119], v[84:87], v[148:151]
    ds_read_b64_tr_b16 v[70:71], v15 offset:16384
    v_mfma_f32_16x16x32_bf16 v[152:155], v[120:123], v[84:87], v[152:155]
    ds_read_b64_tr_b16 v[72:73], v12 offset:24576
    v_mfma_f32_16x16x32_bf16 v[156:159], v[124:127], v[84:87], v[156:159]
    ds_read_b64_tr_b16 v[74:75], v13 offset:24576
    v_mfma_f32_16x16x32_bf16 v[160:163], v[112:115], v[88:91], v[160:163]
    s_add_u32 m0, s22, 32768
    s_nop 0
    buffer_load_dwordx4 v2, s[8:11], s18 offen lds
    s_add_u32 s18, s18, s20
    v_mfma_f32_16x16x32_bf16 v[164:167], v[116:119], v[88:91], v[164:167]
    ds_read_b64_tr_b16 v[76:77], v14 offset:24576
    v_mfma_f32_16x16x32_bf16 v[168:171], v[120:123], v[88:91], v[168:171]
    ds_read_b64_tr_b16 v[78:79], v15 offset:24576
    v_mfma_f32_16x16x32_bf16 v[172:175], v[124:127], v[88:91], v[172:175]
    ds_read_b128 v[32:35], v6 offset:0
    v_mfma_f32_16x16x32_bf16 v[176:179], v[112:115], v[92:95], v[176:179]
    s_add_u32 m0, s22, 40960
    s_nop 0
    buffer_load_dwordx4 v2, s[12:15], s19 offen lds
    s_add_u32 s19, s19, s20
    v_mfma_f32_16x16x32_bf16 v[180:183], v[116:119], v[92:95], v[180:183]
    ds_read_b128 v[36:39], v6 offset:1024
    v_mfma_f32_16x16x32_bf16 v[184:187], v[120:123], v[92:95], v[184:187]
    ds_read_b128 v[40:43], v6 offset:2048
    v_mfma_f32_16x16x32_bf16 v[188:191], v[124:127], v[92:95], v[188:191]
    ds_read_b128 v[44:47], v6 offset:3072
    v_mfma_f32_16x16x32_bf16 v[192:195], v[112:115], v[96:99], v[192:195]
    ds_read_b128 v[48:51], v6 offset:4096
    v_mfma_f32_16x16x32_bf16 v[196:199], v[116:119], v[96:99], v[196:199]
    ds_read_b128 v[52:55], v6 offset:5120
    v_mfma_f32_16x16x32_bf16 v[200:203], v[120:123], v[96:99], v[200:203]
    ds_read_b128 v[56:59], v6 offset:6144
    v_mfma_f32_16x16x32_bf16 v[204:207], v[124:127], v[96:99], v[204:207]
    ds_read_b128 v[60:63], v6 offset:7168
    v_mfma_f32_16x16x32_bf16 v[208:211], v[112:115], v[100:103], v[208:211]
    v_mfma_f32_16x16x32_bf16 v[212:215], v[116:119], v[100:103], v[212:215]
    v_mfma_f32_16x16x32_bf16 v[216:219], v[120:123], v[100:103], v[216:219]
    v_mfma_f32_16x16x32_bf16 v[220:223], v[124:127], v[100:103], v[220:223]
    v_mfma_f32_16x16x32_bf16 v[224:227], v[112:115], v[104:107], v[224:227]
    v_mfma_f32_16x16x32_bf16 v[228:231], v[116:119], v[104:107], v[228:231]
    v_mfma_f32_16x16x32_bf16 v[232:235], v[120:123], v[104:107], v[232:235]
    v_mfma_f32_16x16x32_bf16 v[236:239], v[124:127], v[104:107], v[236:239]
    v_mfma_f32_16x16x32_bf16 v[240:243], v[112:115], v[108:111], v[240:243]
    v_mfma_f32_16x16x32_bf16 v[244:247], v[116:119], v[108:111], v[244:247]
    v_mfma_f32_16x16x32_bf16 v[248:251], v[120:123], v[108:111], v[248:251]
    v_mfma_f32_16x16x32_bf16 v[252:255], v[124:127], v[108:111], v[252:255]
    s_waitcnt lgkmcnt(0)
    s_waitcnt vmcnt(8)
    s_barrier
    v_mfma_f32_16x16x32_bf16 v[128:131], v[64:67], v[32:35], v[128:131]
    s_add_u32 m0, s21, 65536
    s_nop 0
    buffer_load_dwordx4 v1, s[4:7], s16 offen sc1 lds
    s_add_u32 s16, s16, s62
    v_mfma_f32_16x16x32_bf16 v[132:135], v[68:71], v[32:35], v[132:135]
    ds_read_b64_tr_b16 v[112:113], v12 offset:49152
    v_mfma_f32_16x16x32_bf16 v[136:139], v[72:75], v[32:35], v[136:139]
    ds_read_b64_tr_b16 v[114:115], v13 offset:49152
    v_mfma_f32_16x16x32_bf16 v[140:143], v[76:79], v[32:35], v[140:143]
    ds_read_b64_tr_b16 v[116:117], v14 offset:49152
    v_mfma_f32_16x16x32_bf16 v[144:147], v[64:67], v[36:39], v[144:147]
    s_add_u32 m0, s21, 66560
    s_nop 0
    buffer_load_dwordx4 v1, s[4:7], s17 offen sc1 lds
    s_add_u32 s17, s17, s62
    v_mfma_f32_16x16x32_bf16 v[148:151], v[68:71], v[36:39], v[148:151]
    ds_read_b64_tr_b16 v[118:119], v15 offset:49152
    v_mfma_f32_16x16x32_bf16 v[152:155], v[72:75], v[36:39], v[152:155]
    ds_read_b64_tr_b16 v[120:121], v12 offset:57344
    v_mfma_f32_16x16x32_bf16 v[156:159], v[76:79], v[36:39], v[156:159]
    ds_read_b64_tr_b16 v[122:123], v13 offset:57344
    v_mfma_f32_16x16x32_bf16 v[160:163], v[64:67], v[40:43], v[160:163]
    s_add_u32 m0, s22, 65536
    s_nop 0
    buffer_load_dwordx4 v2, s[8:11], s18 offen lds
    s_add_u32 s18, s18, s20
    v_mfma_f32_16x16x32_bf16 v[164:167], v[68:71], v[40:43], v[164:167]
    ds_read_b64_tr_b16 v[124:125], v14 offset:57344
    v_mfma_f32_16x16x32_bf16 v[168:171], v[72:75], v[40:43], v[168:171]
    ds_read_b64_tr_b16 v[126:127], v15 offset:57344
    v_mfma_f32_16x16x32_bf16 v[172:175], v[76:79], v[40:43], v[172:175]
    ds_read_b128 v[80:83], v6 offset:32768
    v_mfma_f32_16x16x32_bf16 v[176:179], v[64:67], v[44:47], v[176:179]
    s_add_u32 m0, s22, 73728
    s_nop 0
    buffer_load_dwordx4 v2, s[12:15], s19 offen lds
    s_add_u32 s19, s19, s20
    v_mfma_f32_16x16x32_bf16 v[180:183], v[68:71], v[44:47], v[180:183]
    ds_read_b128 v[84:87], v6 offset:33792
    v_mfma_f32_16x16x32_bf16 v[184:187], v[72:75], v[44:47], v[184:187]
    ds_read_b128 v[88:91], v6 offset:34816
    v_mfma_f32_16x16x32_bf16 v[188:191], v[76:79], v[44:47], v[188:191]
    ds_read_b128 v[92:95], v6 offset:35840
    v_mfma_f32_16x16x32_bf16 v[192:195], v[64:67], v[48:51], v[192:195]
    ds_read_b128 v[96:99], v6 offset:36864
    v_mfma_f32_16x16x32_bf16 v[196:199], v[68:71], v[48:51], v[196:199]
    ds_read_b128 v[100:103], v6 offset:37888
    v_mfma_f32_16x16x32_bf16 v[200:203], v[72:75], v[48:51], v[200:203]
    ds_read_b128 v[104:107], v6 offset:38912
    v_mfma_f32_16x16x32_bf16 v[204:207], v[76:79], v[48:51], v[204:207]
    ds_read_b128 v[108:111], v6 offset:39936
    v_mfma_f32_16x16x32_bf16 v[208:211], v[64:67], v[52:55], v[208:211]
    v_mfma_f32_16x16x32_bf16 v[212:215], v[68:71], v[52:55], v[212:215]
    v_mfma_f32_16x16x32_bf16 v[216:219], v[72:75], v[52:55], v[216:219]
    v_mfma_f32_16x16x32_bf16 v[220:223], v[76:79], v[52:55], v[220:223]
    v_mfma_f32_16x16x32_bf16 v[224:227], v[64:67], v[56:59], v[224:227]
    v_mfma_f32_16x16x32_bf16 v[228:231], v[68:71], v[56:59], v[228:231]
    v_mfma_f32_16x16x32_bf16 v[232:235], v[72:75], v[56:59], v[232:235]
    v_mfma_f32_16x16x32_bf16 v[236:239], v[76:79], v[56:59], v[236:239]
    v_mfma_f32_16x16x32_bf16 v[240:243], v[64:67], v[60:63], v[240:243]
    v_mfma_f32_16x16x32_bf16 v[244:247], v[68:71], v[60:63], v[244:247]
    v_mfma_f32_16x16x32_bf16 v[248:251], v[72:75], v[60:63], v[248:251]
    v_mfma_f32_16x16x32_bf16 v[252:255], v[76:79], v[60:63], v[252:255]
    s_waitcnt lgkmcnt(0)
    s_waitcnt vmcnt(8)
    s_barrier
    v_mfma_f32_16x16x32_bf16 v[128:131], v[112:115], v[80:83], v[128:131]
    s_add_u32 m0, s21, 98304
    s_nop 0
    buffer_load_dwordx4 v1, s[4:7], s16 offen sc1 lds
    s_add_u32 s16, s16, s62
    v_mfma_f32_16x16x32_bf16 v[132:135], v[116:119], v[80:83], v[132:135]
    ds_read_b64_tr_b16 v[64:65], v8 offset:16384
    v_mfma_f32_16x16x32_bf16 v[136:139], v[120:123], v[80:83], v[136:139]
    ds_read_b64_tr_b16 v[66:67], v9 offset:16384
    v_mfma_f32_16x16x32_bf16 v[140:143], v[124:127], v[80:83], v[140:143]
    ds_read_b64_tr_b16 v[68:69], v10 offset:16384
    v_mfma_f32_16x16x32_bf16 v[144:147], v[112:115], v[84:87], v[144:147]
    s_add_u32 m0, s21, 99328
    s_nop 0
    buffer_load_dwordx4 v1, s[4:7], s17 offen sc1 lds
    s_add_u32 s17, s17, s62
    v_mfma_f32_16x16x32_bf16 v[148:151], v[116:119], v[84:87], v[148:151]
    ds_read_b64_tr_b16 v[70:71], v11 offset:16384
    v_mfma_f32_16x16x32_bf16 v[152:155], v[120:123], v[84:87], v[152:155]
    ds_read_b64_tr_b16 v[72:73], v8 offset:24576
    v_mfma_f32_16x16x32_bf16 v[156:159], v[124:127], v[84:87], v[156:159]
    ds_read_b64_tr_b16 v[74:75], v9 offset:24576
    v_mfma_f32_16x16x32_bf16 v[160:163], v[112:115], v[88:91], v[160:163]
    s_add_u32 m0, s22, 98304
    s_nop 0
    buffer_load_dwordx4 v2, s[8:11], s18 offen lds
    s_add_u32 s18, s18, s20
    v_mfma_f32_16x16x32_bf16 v[164:167], v[116:119], v[88:91], v[164:167]
    ds_read_b64_tr_b16 v[76:77], v10 offset:24576
    v_mfma_f32_16x16x32_bf16 v[168:171], v[120:123], v[88:91], v[168:171]
    ds_read_b64_tr_b16 v[78:79], v11 offset:24576
    v_mfma_f32_16x16x32_bf16 v[172:175], v[124:127], v[88:91], v[172:175]
    ds_read_b128 v[32:35], v5 offset:0
    v_mfma_f32_16x16x32_bf16 v[176:179], v[112:115], v[92:95], v[176:179]
    s_add_u32 m0, s22, 106496
    s_nop 0
    buffer_load_dwordx4 v2, s[12:15], s19 offen lds
    s_add_u32 s19, s19, s20
    v_mfma_f32_16x16x32_bf16 v[180:183], v[116:119], v[92:95], v[180:183]
    ds_read_b128 v[36:39], v5 offset:1024
    v_mfma_f32_16x16x32_bf16 v[184:187], v[120:123], v[92:95], v[184:187]
    ds_read_b128 v[40:43], v5 offset:2048
    v_mfma_f32_16x16x32_bf16 v[188:191], v[124:127], v[92:95], v[188:191]
    ds_read_b128 v[44:47], v5 offset:3072
    v_mfma_f32_16x16x32_bf16 v[192:195], v[112:115], v[96:99], v[192:195]
    ds_read_b128 v[48:51], v5 offset:4096
    v_mfma_f32_16x16x32_bf16 v[196:199], v[116:119], v[96:99], v[196:199]
    ds_read_b128 v[52:55], v5 offset:5120
    v_mfma_f32_16x16x32_bf16 v[200:203], v[120:123], v[96:99], v[200:203]
    ds_read_b128 v[56:59], v5 offset:6144
    v_mfma_f32_16x16x32_bf16 v[204:207], v[124:127], v[96:99], v[204:207]
    ds_read_b128 v[60:63], v5 offset:7168
    v_mfma_f32_16x16x32_bf16 v[208:211], v[112:115], v[100:103], v[208:211]
    v_mfma_f32_16x16x32_bf16 v[212:215], v[116:119], v[100:103], v[212:215]
    v_mfma_f32_16x16x32_bf16 v[216:219], v[120:123], v[100:103], v[216:219]
    v_mfma_f32_16x16x32_bf16 v[220:223], v[124:127], v[100:103], v[220:223]
    v_mfma_f32_16x16x32_bf16 v[224:227], v[112:115], v[104:107], v[224:227]
    v_mfma_f32_16x16x32_bf16 v[228:231], v[116:119], v[104:107], v[228:231]
    v_mfma_f32_16x16x32_bf16 v[232:235], v[120:123], v[104:107], v[232:235]
    v_mfma_f32_16x16x32_bf16 v[236:239], v[124:127], v[104:107], v[236:239]
    v_mfma_f32_16x16x32_bf16 v[240:243], v[112:115], v[108:111], v[240:243]
    v_mfma_f32_16x16x32_bf16 v[244:247], v[116:119], v[108:111], v[244:247]
    v_mfma_f32_16x16x32_bf16 v[248:251], v[120:123], v[108:111], v[248:251]
    v_mfma_f32_16x16x32_bf16 v[252:255], v[124:127], v[108:111], v[252:255]
    s_waitcnt lgkmcnt(0)
    s_sub_u32 s23, s23, 1
    s_cmp_lg_u32 s23, 0
    s_cbranch_scc1 w_loop
    v_mov_b32 v20, 131072
    ds_read_b128 v[24:27], v20
    ds_read_b128 v[28:31], v20 offset:16
    s_cmp_eq_u32 s48, 2
    s_cbranch_scc1 w_epi_glu
    s_lshl_b32 s30, s27, 10
    s_add_u32 s30, s30, s49
    s_nop 7
    v_cvt_pk_bf16_f32 v80, v128, v129
    v_cvt_pk_bf16_f32 v81, v130, v131
    v_cvt_pk_bf16_f32 v82, v132, v133
    v_cvt_pk_bf16_f32 v83, v134, v135
    buffer_store_dwordx4 v[80:83], v1, s[4:7], s30 offen sc1
    v_cvt_pk_bf16_f32 v84, v136, v137
    v_cvt_pk_bf16_f32 v85, v138, v139
    v_cvt_pk_bf16_f32 v86, v140, v141
    v_cvt_pk_bf16_f32 v87, v142, v143
    buffer_store_dwordx4 v[84:87], v19, s[4:7], s30 offen sc1
    s_add_u32 s30, s30, s50
    v_cvt_pk_bf16_f32 v88, v144, v145
    v_cvt_pk_bf16_f32 v89, v146, v147
    v_cvt_pk_bf16_f32 v90, v148, v149
    v_cvt_pk_bf16_f32 v91, v150, v151
    buffer_store_dwordx4 v[88:91], v1, s[4:7], s30 offen sc1
    v_cvt_pk_bf16_f32 v92, v152, v153
    v_cvt_pk_bf16_f32 v93, v154, v155
    v_cvt_pk_bf16_f32 v94, v156, v157
    v_cvt_pk_bf16_f32 v95, v158, v159
    buffer_store_dwordx4 v[92:95], v19, s[4:7], s30 offen sc1
    s_add_u32 s30, s30, s50
    v_cvt_pk_bf16_f32 v80, v160, v161
    v_cvt_pk_bf16_f32 v81, v162, v163
    v_cvt_pk_bf16_f32 v82, v164, v165
    v_cvt_pk_bf16_f32 v83, v166, v167
    buffer_store_dwordx4 v[80:83], v1, s[4:7], s30 offen sc1
    v_cvt_pk_bf16_f32 v84, v168, v169
    v_cvt_pk_bf16_f32 v85, v170, v171
    v_cvt_pk_bf16_f32 v86, v172, v173
    v_cvt_pk_bf16_f32 v87, v174, v175
    buffer_store_dwordx4 v[84:87], v19, s[4:7], s30 offen sc1
    s_add_u32 s30, s30, s50
    v_cvt_pk_bf16_f32 v88, v176, v177
    v_cvt_pk_bf16_f32 v89, v178, v179
    v_cvt_pk_bf16_f32 v90, v180, v181
    v_cvt_pk_bf16_f32 v91, v182, v183
    buffer_store_dwordx4 v[88:91], v1, s[4:7], s30 offen sc1
    v_cvt_pk_bf16_f32 v92, v184, v185
    v_cvt_pk_bf16_f32 v93, v186, v187
    v_cvt_pk_bf16_f32 v94, v188, v189
    v_cvt_pk_bf16_f32 v95, v190, v191
    buffer_store_dwordx4 v[92:95], v19, s[4:7], s30 offen sc1
    s_add_u32 s30, s30, s50
    v_cvt_pk_bf16_f32 v80, v192, v193
    v_cvt_pk_bf16_f32 v81, v194, v195
    v_cvt_pk_bf16_f32 v82, v196, v197
    v_cvt_pk_bf16_f32 v83, v198, v199
    buffer_store_dwordx4 v[80:83], v1, s[4:7], s30 offen sc1
    v_cvt_pk_bf16_f32 v84, v200, v201
    v_cvt_pk_bf16_f32 v85, v202, v203
    v_cvt_pk_bf16_f32 v86, v204, v205
    v_cvt_pk_bf16_f32 v87, v206, v207
    buffer_store_dwordx4 v[84:87], v19, s[4:7], s30 offen sc1
    s_add_u32 s30, s30, s50
    v_cvt_pk_bf16_f32 v88, v208, v209
    v_cvt_pk_bf16_f32 v89, v210, v211
    v_cvt_pk_bf16_f32 v90, v212, v213
    v_cvt_pk_bf16_f32 v91, v214, v215
    buffer_store_dwordx4 v[88:91], v1, s[4:7], s30 offen sc1
    v_cvt_pk_bf16_f32 v92, v216, v217
    v_cvt_pk_bf16_f32 v93, v218, v219
    v_cvt_pk_bf16_f32 v94, v220, v221
    v_cvt_pk_bf16_f32 v95, v222, v223
    buffer_store_dwordx4 v[92:95], v19, s[4:7], s30 offen sc1
    s_add_u32 s30, s30, s50
    v_cvt_pk_bf16_f32 v80, v224, v225
    v_cvt_pk_bf16_f32 v81, v226, v227
    v_cvt_pk_bf16_f32 v82, v228, v229
    v_cvt_pk_bf16_f32 v83, v230, v231
    buffer_store_dwordx4 v[80:83], v1, s[4:7], s30 offen sc1
    v_cvt_pk_bf16_f32 v84, v232, v233
    v_cvt_pk_bf16_f32 v85, v234, v235
    v_cvt_pk_bf16_f32 v86, v236, v237
    v_cvt_pk_bf16_f32 v87, v238, v239
    buffer_store_dwordx4 v[84:87], v19, s[4:7], s30 offen sc1
    s_add_u32 s30, s30, s50
    v_cvt_pk_bf16_f32 v88, v240, v241
    v_cvt_pk_bf16_f32 v89, v242, v243
    v_cvt_pk_bf16_f32 v90, v244, v245
    v_cvt_pk_bf16_f32 v91, v246, v247
    buffer_store_dwordx4 v[88:91], v1, s[4:7], s30 offen sc1
    v_cvt_pk_bf16_f32 v92, v248, v249
    v_cvt_pk_bf16_f32 v93, v250, v251
    v_cvt_pk_bf16_f32 v94, v252, v253
    v_cvt_pk_bf16_f32 v95, v254, v255
    buffer_store_dwordx4 v[92:95], v19, s[4:7], s30 offen sc1
    s_waitcnt lgkmcnt(0)
    v_or3_b32 v24, v24, v25, v26
    v_or3_b32 v28, v28, v29, v30
    v_or3_b32 v24, v24, v27, v31
    v_or_b32 v24, v24, v28
    s_mov_b32 s28, s51
    v_readfirstlane_b32 s30, v24
    s_cmp_lg_u32 s30, 0
    s_cbranch_scc1 w_drain
    s_mov_b32 s48, s32
    s_cmp_eq_u32 s32, 4
    s_cselect_b32 s30, 2, 3
    s_lshl_b32 s30, s26, s30
    s_mul_i32 s30, s30, s43
    s_add_u32 s49, s42, s30
    s_mov_b32 s50, s43
    s_mov_b32 s51, s46
    s_mov_b32 s23, s41
    s_mov_b32 s53, s41
    s_branch w_first16
w_epi_glu:
    s_lshl_b32 s30, s27, 10
    s_add_u32 s30, s30, s49
    s_mov_b32 s54, 0xbfb8aa3b
    s_nop 7
    v_cvt_pk_bf16_f32 v80, v128, v129
    v_cvt_pk_bf16_f32 v81, v130, v131
    v_cvt_pk_bf16_f32 v82, v132, v133
    v_cvt_pk_bf16_f32 v83, v134, v135
    v_lshlrev_b32 v96, 16, v80
    v_and_b32 v97, 0xffff0000, v80
    v_lshlrev_b32 v98, 16, v81
    v_and_b32 v99, 0xffff0000, v81
    v_lshlrev_b32 v100, 16, v82
    v_and_b32 v101, 0xffff0000, v82
    v_lshlrev_b32 v102, 16, v83
    v_and_b32 v103, 0xffff0000, v83
    v_mul_f32 v96, s54, v96
    v_mul_f32 v97, s54, v97
    v_mul_f32 v98, s54, v98
    v_mul_f32 v99, s54, v99
    v_mul_f32 v100, s54, v100
    v_mul_f32 v101, s54, v101
    v_mul_f32 v102, s54, v102
    v_mul_f32 v103, s54, v103
    v_exp_f32 v96, v96
    v_exp_f32 v97, v97
    v_exp_f32 v98, v98
    v_exp_f32 v99, v99
    v_exp_f32 v100, v100
    v_exp_f32 v101, v101
    v_exp_f32 v102, v102
    v_exp_f32 v103, v103
    v_add_f32 v96, 1.0, v96
    v_add_f32 v97, 1.0, v97
    v_add_f32 v98, 1.0, v98
    v_add_f32 v99, 1.0, v99
    v_add_f32 v100, 1.0, v100
    v_add_f32 v101, 1.0, v101
    v_add_f32 v102, 1.0, v102
    v_add_f32 v103, 1.0, v103
    v_rcp_f32 v96, v96
    v_rcp_f32 v97, v97
    v_rcp_f32 v98, v98
    v_rcp_f32 v99, v99
    v_rcp_f32 v100, v100
    v_rcp_f32 v101, v101
    v_rcp_f32 v102, v102
    v_rcp_f32 v103, v103
    v_mul_f32 v96, v96, v136
    v_mul_f32 v97, v97, v137
    v_mul_f32 v98, v98, v138
    v_mul_f32 v99, v99, v139
    v_mul_f32 v100, v100, v140
    v_mul_f32 v101, v101, v141
    v_mul_f32 v102, v102, v142
    v_mul_f32 v103, v103, v143
    v_cvt_pk_bf16_f32 v80, v96, v97
    v_cvt_pk_bf16_f32 v81, v98, v99
    v_cvt_pk_bf16_f32 v82, v100, v101
    v_cvt_pk_bf16_f32 v83, v102, v103
    buffer_store_dwordx4 v[80:83], v1, s[4:7], s30 offen sc1
    s_add_u32 s30, s30, s50
    v_cvt_pk_bf16_f32 v84, v144, v145
    v_cvt_pk_bf16_f32 v85, v146, v147
    v_cvt_pk_bf16_f32 v86, v148, v149
    v_cvt_pk_bf16_f32 v87, v150, v151
    v_lshlrev_b32 v104, 16, v84
    v_and_b32 v105, 0xffff0000, v84
    v_lshlrev_b32 v106, 16, v85
    v_and_b32 v107, 0xffff0000, v85
    v_lshlrev_b32 v108, 16, v86
    v_and_b32 v109, 0xffff0000, v86
    v_lshlrev_b32 v110, 16, v87
    v_and_b32 v111, 0xffff0000, v87
    v_mul_f32 v104, s54, v104
    v_mul_f32 v105, s54, v105
    v_mul_f32 v106, s54, v106
    v_mul_f32 v107, s54, v107
    v_mul_f32 v108, s54, v108
    v_mul_f32 v109, s54, v109
    v_mul_f32 v110, s54, v110
    v_mul_f32 v111, s54, v111
    v_exp_f32 v104, v104
    v_exp_f32 v105, v105
    v_exp_f32 v106, v106
    v_exp_f32 v107, v107
    v_exp_f32 v108, v108
    v_exp_f32 v109, v109
    v_exp_f32 v110, v110
    v_exp_f32 v111, v111
    v_add_f32 v104, 1.0, v104
    v_add_f32 v105, 1.0, v105
    v_add_f32 v106, 1.0, v106
    v_add_f32 v107, 1.0, v107
    v_add_f32 v108, 1.0, v108
    v_add_f32 v109, 1.0, v109
    v_add_f32 v110, 1.0, v110
    v_add_f32 v111, 1.0, v111
    v_rcp_f32 v104, v104
    v_rcp_f32 v105, v105
    v_rcp_f32 v106, v106
    v_rcp_f32 v107, v107
    v_rcp_f32 v108, v108
    v_rcp_f32 v109, v109
    v_rcp_f32 v110, v110
    v_rcp_f32 v111, v111
    v_mul_f32 v104, v104, v152
    v_mul_f32 v105, v105, v153
    v_mul_f32 v106, v106, v154
    v_mul_f32 v107, v107, v155
    v_mul_f32 v108, v108, v156
    v_mul_f32 v109, v109, v157
    v_mul_f32 v110, v110, v158
    v_mul_f32 v111, v111, v159
    v_cvt_pk_bf16_f32 v84, v104, v105
    v_cvt_pk_bf16_f32 v85, v106, v107
    v_cvt_pk_bf16_f32 v86, v108, v109
    v_cvt_pk_bf16_f32 v87, v110, v111
    buffer_store_dwordx4 v[84:87], v1, s[4:7], s30 offen sc1
    s_add_u32 s30, s30, s50
    v_cvt_pk_bf16_f32 v88, v160, v161
    v_cvt_pk_bf16_f32 v89, v162, v163
    v_cvt_pk_bf16_f32 v90, v164, v165
    v_cvt_pk_bf16_f32 v91, v166, v167
    v_lshlrev_b32 v96, 16, v88
    v_and_b32 v97, 0xffff0000, v88
    v_lshlrev_b32 v98, 16, v89
    v_and_b32 v99, 0xffff0000, v89
    v_lshlrev_b32 v100, 16, v90
    v_and_b32 v101, 0xffff0000, v90
    v_lshlrev_b32 v102, 16, v91
    v_and_b32 v103, 0xffff0000, v91
    v_mul_f32 v96, s54, v96
    v_mul_f32 v97, s54, v97
    v_mul_f32 v98, s54, v98
    v_mul_f32 v99, s54, v99
    v_mul_f32 v100, s54, v100
    v_mul_f32 v101, s54, v101
    v_mul_f32 v102, s54, v102
    v_mul_f32 v103, s54, v103
    v_exp_f32 v96, v96
    v_exp_f32 v97, v97
    v_exp_f32 v98, v98
    v_exp_f32 v99, v99
    v_exp_f32 v100, v100
    v_exp_f32 v101, v101
    v_exp_f32 v102, v102
    v_exp_f32 v103, v103
    v_add_f32 v96, 1.0, v96
    v_add_f32 v97, 1.0, v97
    v_add_f32 v98, 1.0, v98
    v_add_f32 v99, 1.0, v99
    v_add_f32 v100, 1.0, v100
    v_add_f32 v101, 1.0, v101
    v_add_f32 v102, 1.0, v102
    v_add_f32 v103, 1.0, v103
    v_rcp_f32 v96, v96
    v_rcp_f32 v97, v97
    v_rcp_f32 v98, v98
    v_rcp_f32 v99, v99
    v_rcp_f32 v100, v100
    v_rcp_f32 v101, v101
    v_rcp_f32 v102, v102
    v_rcp_f32 v103, v103
    v_mul_f32 v96, v96, v168
    v_mul_f32 v97, v97, v169
    v_mul_f32 v98, v98, v170
    v_mul_f32 v99, v99, v171
    v_mul_f32 v100, v100, v172
    v_mul_f32 v101, v101, v173
    v_mul_f32 v102, v102, v174
    v_mul_f32 v103, v103, v175
    v_cvt_pk_bf16_f32 v88, v96, v97
    v_cvt_pk_bf16_f32 v89, v98, v99
    v_cvt_pk_bf16_f32 v90, v100, v101
    v_cvt_pk_bf16_f32 v91, v102, v103
    buffer_store_dwordx4 v[88:91], v1, s[4:7], s30 offen sc1
    s_add_u32 s30, s30, s50
    v_cvt_pk_bf16_f32 v92, v176, v177
    v_cvt_pk_bf16_f32 v93, v178, v179
    v_cvt_pk_bf16_f32 v94, v180, v181
    v_cvt_pk_bf16_f32 v95, v182, v183
    v_lshlrev_b32 v104, 16, v92
    v_and_b32 v105, 0xffff0000, v92
    v_lshlrev_b32 v106, 16, v93
    v_and_b32 v107, 0xffff0000, v93
    v_lshlrev_b32 v108, 16, v94
    v_and_b32 v109, 0xffff0000, v94
    v_lshlrev_b32 v110, 16, v95
    v_and_b32 v111, 0xffff0000, v95
    v_mul_f32 v104, s54, v104
    v_mul_f32 v105, s54, v105
    v_mul_f32 v106, s54, v106
    v_mul_f32 v107, s54, v107
    v_mul_f32 v108, s54, v108
    v_mul_f32 v109, s54, v109
    v_mul_f32 v110, s54, v110
    v_mul_f32 v111, s54, v111
    v_exp_f32 v104, v104
    v_exp_f32 v105, v105
    v_exp_f32 v106, v106
    v_exp_f32 v107, v107
    v_exp_f32 v108, v108
    v_exp_f32 v109, v109
    v_exp_f32 v110, v110
    v_exp_f32 v111, v111
    v_add_f32 v104, 1.0, v104
    v_add_f32 v105, 1.0, v105
    v_add_f32 v106, 1.0, v106
    v_add_f32 v107, 1.0, v107
    v_add_f32 v108, 1.0, v108
    v_add_f32 v109, 1.0, v109
    v_add_f32 v110, 1.0, v110
    v_add_f32 v111, 1.0, v111
    v_rcp_f32 v104, v104
    v_rcp_f32 v105, v105
    v_rcp_f32 v106, v106
    v_rcp_f32 v107, v107
    v_rcp_f32 v108, v108
    v_rcp_f32 v109, v109
    v_rcp_f32 v110, v110
    v_rcp_f32 v111, v111
    v_mul_f32 v104, v104, v184
    v_mul_f32 v105, v105, v185
    v_mul_f32 v106, v106, v186
    v_mul_f32 v107, v107, v187
    v_mul_f32 v108, v108, v188
    v_mul_f32 v109, v109, v189
    v_mul_f32 v110, v110, v190
    v_mul_f32 v111, v111, v191
    v_cvt_pk_bf16_f32 v92, v104, v105
    v_cvt_pk_bf16_f32 v93, v106, v107
    v_cvt_pk_bf16_f32 v94, v108, v109
    v_cvt_pk_bf16_f32 v95, v110, v111
    buffer_store_dwordx4 v[92:95], v1, s[4:7], s30 offen sc1
    s_add_u32 s30, s30, s50
    v_cvt_pk_bf16_f32 v80, v192, v193
    v_cvt_pk_bf16_f32 v81, v194, v195
    v_cvt_pk_bf16_f32 v82, v196, v197
    v_cvt_pk_bf16_f32 v83, v198, v199
    v_lshlrev_b32 v96, 16, v80
    v_and_b32 v97, 0xffff0000, v80
    v_lshlrev_b32 v98, 16, v81
    v_and_b32 v99, 0xffff0000, v81
    v_lshlrev_b32 v100, 16, v82
    v_and_b32 v101, 0xffff0000, v82
    v_lshlrev_b32 v102, 16, v83
    v_and_b32 v103, 0xffff0000, v83
    v_mul_f32 v96, s54, v96
    v_mul_f32 v97, s54, v97
    v_mul_f32 v98, s54, v98
    v_mul_f32 v99, s54, v99
    v_mul_f32 v100, s54, v100
    v_mul_f32 v101, s54, v101
    v_mul_f32 v102, s54, v102
    v_mul_f32 v103, s54, v103
    v_exp_f32 v96, v96
    v_exp_f32 v97, v97
    v_exp_f32 v98, v98
    v_exp_f32 v99, v99
    v_exp_f32 v100, v100
    v_exp_f32 v101, v101
    v_exp_f32 v102, v102
    v_exp_f32 v103, v103
    v_add_f32 v96, 1.0, v96
    v_add_f32 v97, 1.0, v97
    v_add_f32 v98, 1.0, v98
    v_add_f32 v99, 1.0, v99
    v_add_f32 v100, 1.0, v100
    v_add_f32 v101, 1.0, v101
    v_add_f32 v102, 1.0, v102
    v_add_f32 v103, 1.0, v103
    v_rcp_f32 v96, v96
    v_rcp_f32 v97, v97
    v_rcp_f32 v98, v98
    v_rcp_f32 v99, v99
    v_rcp_f32 v100, v100
    v_rcp_f32 v101, v101
    v_rcp_f32 v102, v102
    v_rcp_f32 v103, v103
    v_mul_f32 v96, v96, v200
    v_mul_f32 v97, v97, v201
    v_mul_f32 v98, v98, v202
    v_mul_f32 v99, v99, v203
    v_mul_f32 v100, v100, v204
    v_mul_f32 v101, v101, v205
    v_mul_f32 v102, v102, v206
    v_mul_f32 v103, v103, v207
    v_cvt_pk_bf16_f32 v80, v96, v97
    v_cvt_pk_bf16_f32 v81, v98, v99
    v_cvt_pk_bf16_f32 v82, v100, v101
    v_cvt_pk_bf16_f32 v83, v102, v103
    buffer_store_dwordx4 v[80:83], v1, s[4:7], s30 offen sc1
    s_add_u32 s30, s30, s50
    v_cvt_pk_bf16_f32 v84, v208, v209
    v_cvt_pk_bf16_f32 v85, v210, v211
    v_cvt_pk_bf16_f32 v86, v212, v213
    v_cvt_pk_bf16_f32 v87, v214, v215
    v_lshlrev_b32 v104, 16, v84
    v_and_b32 v105, 0xffff0000, v84
    v_lshlrev_b32 v106, 16, v85
    v_and_b32 v107, 0xffff0000, v85
    v_lshlrev_b32 v108, 16, v86
    v_and_b32 v109, 0xffff0000, v86
    v_lshlrev_b32 v110, 16, v87
    v_and_b32 v111, 0xffff0000, v87
    v_mul_f32 v104, s54, v104
    v_mul_f32 v105, s54, v105
    v_mul_f32 v106, s54, v106
    v_mul_f32 v107, s54, v107
    v_mul_f32 v108, s54, v108
    v_mul_f32 v109, s54, v109
    v_mul_f32 v110, s54, v110
    v_mul_f32 v111, s54, v111
    v_exp_f32 v104, v104
    v_exp_f32 v105, v105
    v_exp_f32 v106, v106
    v_exp_f32 v107, v107
    v_exp_f32 v108, v108
    v_exp_f32 v109, v109
    v_exp_f32 v110, v110
    v_exp_f32 v111, v111
    v_add_f32 v104, 1.0, v104
    v_add_f32 v105, 1.0, v105
    v_add_f32 v106, 1.0, v106
    v_add_f32 v107, 1.0, v107
    v_add_f32 v108, 1.0, v108
    v_add_f32 v109, 1.0, v109
    v_add_f32 v110, 1.0, v110
    v_add_f32 v111, 1.0, v111
    v_rcp_f32 v104, v104
    v_rcp_f32 v105, v105
    v_rcp_f32 v106, v106
    v_rcp_f32 v107, v107
    v_rcp_f32 v108, v108
    v_rcp_f32 v109, v109
    v_rcp_f32 v110, v110
    v_rcp_f32 v111, v111
    v_mul_f32 v104, v104, v216
    v_mul_f32 v105, v105, v217
    v_mul_f32 v106, v106, v218
    v_mul_f32 v107, v107, v219
    v_mul_f32 v108, v108, v220
    v_mul_f32 v109, v109, v221
    v_mul_f32 v110, v110, v222
    v_mul_f32 v111, v111, v223
    v_cvt_pk_bf16_f32 v84, v104, v105
    v_cvt_pk_bf16_f32 v85, v106, v107
    v_cvt_pk_bf16_f32 v86, v108, v109
    v_cvt_pk_bf16_f32 v87, v110, v111
    buffer_store_dwordx4 v[84:87], v1, s[4:7], s30 offen sc1
    s_add_u32 s30, s30, s50
    v_cvt_pk_bf16_f32 v88, v224, v225
    v_cvt_pk_bf16_f32 v89, v226, v227
    v_cvt_pk_bf16_f32 v90, v228, v229
    v_cvt_pk_bf16_f32 v91, v230, v231
    v_lshlrev_b32 v96, 16, v88
    v_and_b32 v97, 0xffff0000, v88
    v_lshlrev_b32 v98, 16, v89
    v_and_b32 v99, 0xffff0000, v89
    v_lshlrev_b32 v100, 16, v90
    v_and_b32 v101, 0xffff0000, v90
    v_lshlrev_b32 v102, 16, v91
    v_and_b32 v103, 0xffff0000, v91
    v_mul_f32 v96, s54, v96
    v_mul_f32 v97, s54, v97
    v_mul_f32 v98, s54, v98
    v_mul_f32 v99, s54, v99
    v_mul_f32 v100, s54, v100
    v_mul_f32 v101, s54, v101
    v_mul_f32 v102, s54, v102
    v_mul_f32 v103, s54, v103
    v_exp_f32 v96, v96
    v_exp_f32 v97, v97
    v_exp_f32 v98, v98
    v_exp_f32 v99, v99
    v_exp_f32 v100, v100
    v_exp_f32 v101, v101
    v_exp_f32 v102, v102
    v_exp_f32 v103, v103
    v_add_f32 v96, 1.0, v96
    v_add_f32 v97, 1.0, v97
    v_add_f32 v98, 1.0, v98
    v_add_f32 v99, 1.0, v99
    v_add_f32 v100, 1.0, v100
    v_add_f32 v101, 1.0, v101
    v_add_f32 v102, 1.0, v102
    v_add_f32 v103, 1.0, v103
    v_rcp_f32 v96, v96
    v_rcp_f32 v97, v97
    v_rcp_f32 v98, v98
    v_rcp_f32 v99, v99
    v_rcp_f32 v100, v100
    v_rcp_f32 v101, v101
    v_rcp_f32 v102, v102
    v_rcp_f32 v103, v103
    v_mul_f32 v96, v96, v232
    v_mul_f32 v97, v97, v233
    v_mul_f32 v98, v98, v234
    v_mul_f32 v99, v99, v235
    v_mul_f32 v100, v100, v236
    v_mul_f32 v101, v101, v237
    v_mul_f32 v102, v102, v238
    v_mul_f32 v103, v103, v239
    v_cvt_pk_bf16_f32 v88, v96, v97
    v_cvt_pk_bf16_f32 v89, v98, v99
    v_cvt_pk_bf16_f32 v90, v100, v101
    v_cvt_pk_bf16_f32 v91, v102, v103
    buffer_store_dwordx4 v[88:91], v1, s[4:7], s30 offen sc1
    s_add_u32 s30, s30, s50
    v_cvt_pk_bf16_f32 v92, v240, v241
    v_cvt_pk_bf16_f32 v93, v242, v243
    v_cvt_pk_bf16_f32 v94, v244, v245
    v_cvt_pk_bf16_f32 v95, v246, v247
    v_lshlrev_b32 v104, 16, v92
    v_and_b32 v105, 0xffff0000, v92
    v_lshlrev_b32 v106, 16, v93
    v_and_b32 v107, 0xffff0000, v93
    v_lshlrev_b32 v108, 16, v94
    v_and_b32 v109, 0xffff0000, v94
    v_lshlrev_b32 v110, 16, v95
    v_and_b32 v111, 0xffff0000, v95
    v_mul_f32 v104, s54, v104
    v_mul_f32 v105, s54, v105
    v_mul_f32 v106, s54, v106
    v_mul_f32 v107, s54, v107
    v_mul_f32 v108, s54, v108
    v_mul_f32 v109, s54, v109
    v_mul_f32 v110, s54, v110
    v_mul_f32 v111, s54, v111
    v_exp_f32 v104, v104
    v_exp_f32 v105, v105
    v_exp_f32 v106, v106
    v_exp_f32 v107, v107
    v_exp_f32 v108, v108
    v_exp_f32 v109, v109
    v_exp_f32 v110, v110
    v_exp_f32 v111, v111
    v_add_f32 v104, 1.0, v104
    v_add_f32 v105, 1.0, v105
    v_add_f32 v106, 1.0, v106
    v_add_f32 v107, 1.0, v107
    v_add_f32 v108, 1.0, v108
    v_add_f32 v109, 1.0, v109
    v_add_f32 v110, 1.0, v110
    v_add_f32 v111, 1.0, v111
    v_rcp_f32 v104, v104
    v_rcp_f32 v105, v105
    v_rcp_f32 v106, v106
    v_rcp_f32 v107, v107
    v_rcp_f32 v108, v108
    v_rcp_f32 v109, v109
    v_rcp_f32 v110, v110
    v_rcp_f32 v111, v111
    v_mul_f32 v104, v104, v248
    v_mul_f32 v105, v105, v249
    v_mul_f32 v106, v106, v250
    v_mul_f32 v107, v107, v251
    v_mul_f32 v108, v108, v252
    v_mul_f32 v109, v109, v253
    v_mul_f32 v110, v110, v254
    v_mul_f32 v111, v111, v255
    v_cvt_pk_bf16_f32 v92, v104, v105
    v_cvt_pk_bf16_f32 v93, v106, v107
    v_cvt_pk_bf16_f32 v94, v108, v109
    v_cvt_pk_bf16_f32 v95, v110, v111
    buffer_store_dwordx4 v[92:95], v1, s[4:7], s30 offen sc1
    s_waitcnt lgkmcnt(0)
    v_or3_b32 v24, v24, v25, v26
    v_or3_b32 v28, v28, v29, v30
    v_or3_b32 v24, v24, v27, v31
    v_or_b32 v24, v24, v28
    s_mov_b32 s28, s51
    v_readfirstlane_b32 s30, v24
    s_cmp_lg_u32 s30, 0
    s_cbranch_scc1 w_drain
    s_mov_b32 s48, s32
    s_cmp_eq_u32 s32, 4
    s_cselect_b32 s30, 2, 3
    s_lshl_b32 s30, s26, s30
    s_mul_i32 s30, s30, s43
    s_add_u32 s49, s42, s30
    s_mov_b32 s50, s43
    s_mov_b32 s51, s46
    s_mov_b32 s23, s41
    s_mov_b32 s53, s41
    s_branch w_first8
w_firstH:
    s_waitcnt vmcnt(8)
    s_barrier
    s_add_u32 m0, s21, 0
    s_nop 0
    buffer_load_dwordx4 v1, s[4:7], s16 offen sc1 lds
    s_add_u32 s16, s16, s62
    s_add_u32 m0, s21, 1024
    s_nop 0
    buffer_load_dwordx4 v1, s[4:7], s17 offen sc1 lds
    s_add_u32 s17, s17, s62
    s_add_u32 m0, s22, 0
    s_nop 0
    buffer_load_dwordx4 v2, s[8:11], s18 offen lds
    s_add_u32 s18, s18, s20
    s_add_u32 m0, s22, 8192
    s_nop 0
    buffer_load_dwordx4 v2, s[12:15], s19 offen lds
    s_add_u32 s19, s19, s20
    v_mfma_f32_16x16x32_bf16 v[128:131], v[64:67], v[32:35], 0
    ds_read_b64_tr_b16 v[112:113], v8 offset:49152
    v_mfma_f32_16x16x32_bf16 v[132:135], v[68:71], v[32:35], 0
    ds_read_b64_tr_b16 v[114:115], v9 offset:49152
    v_mfma_f32_16x16x32_bf16 v[144:147], v[64:67], v[40:43], 0
    ds_read_b64_tr_b16 v[116:117], v10 offset:49152
    v_mfma_f32_16x16x32_bf16 v[148:151], v[68:71], v[40:43], 0
    ds_read_b64_tr_b16 v[118:119], v11 offset:49152
    v_mfma_f32_16x16x32_bf16 v[160:163], v[64:67], v[48:51], 0
    ds_read_b64_tr_b16 v[120:121], v8 offset:57344
    v_mfma_f32_16x16x32_bf16 v[164:167], v[68:71], v[48:51], 0
    ds_read_b64_tr_b16 v[122:123], v9 offset:57344
    v_mfma_f32_16x16x32_bf16 v[176:179], v[64:67], v[56:59], 0
    ds_read_b64_tr_b16 v[124:125], v10 offset:57344
    v_mfma_f32_16x16x32_bf16 v[180:183], v[68:71], v[56:59], 0
    ds_read_b64_tr_b16 v[126:127], v11 offset:57344
    v_mfma_f32_16x16x32_bf16 v[128:131], v[72:75], v[36:39], v[128:131]
    ds_read_b128 v[80:83], v5 offset:32768
    v_mfma_f32_16x16x32_bf16 v[132:135], v[76:79], v[36:39], v[132:135]
    ds_read_b128 v[84:87], v5 offset:33792
    v_mfma_f32_16x16x32_bf16 v[144:147], v[72:75], v[44:47], v[144:147]
    ds_read_b128 v[88:91], v5 offset:34816
    v_mfma_f32_16x16x32_bf16 v[148:151], v[76:79], v[44:47], v[148:151]
    ds_read_b128 v[92:95], v5 offset:35840
    v_mfma_f32_16x16x32_bf16 v[160:163], v[72:75], v[52:55], v[160:163]
    ds_read_b128 v[96:99], v5 offset:36864
    v_mfma_f32_16x16x32_bf16 v[164:167], v[76:79], v[52:55], v[164:167]
    ds_read_b128 v[100:103], v5 offset:37888
    v_mfma_f32_16x16x32_bf16 v[176:179], v[72:75], v[60:63], v[176:179]
    ds_read_b128 v[104:107], v5 offset:38912
    v_mfma_f32_16x16x32_bf16 v[180:183], v[76:79], v[60:63], v[180:183]
    ds_read_b128 v[108:111], v5 offset:39936
    s_waitcnt lgkmcnt(0)
    s_waitcnt vmcnt(8)
    s_barrier
    s_add_u32 m0, s21, 32768
    s_nop 0
    buffer_load_dwordx4 v1, s[4:7], s16 offen sc1 lds
    s_add_u32 s16, s16, s62
    s_add_u32 m0, s21, 33792
    s_nop 0
    buffer_load_dwordx4 v1, s[4:7], s17 offen sc1 lds
    s_add_u32 s17, s17, s62
    s_add_u32 m0, s22, 32768
    s_nop 0
    buffer_load_dwordx4 v2, s[8:11], s18 offen lds
    s_add_u32 s18, s18, s20
    s_add_u32 m0, s22, 40960
    s_nop 0
    buffer_load_dwordx4 v2, s[12:15], s19 offen lds
    s_add_u32 s19, s19, s20
    v_mfma_f32_16x16x32_bf16 v[128:131], v[112:115], v[80:83], v[128:131]
    ds_read_b64_tr_b16 v[64:65], v12 offset:16384
    v_mfma_f32_16x16x32_bf16 v[132:135], v[116:119], v[80:83], v[132:135]
    ds_read_b64_tr_b16 v[66:67], v13 offset:16384
    v_mfma_f32_16x16x32_bf16 v[144:147], v[112:115], v[88:91], v[144:147]
    ds_read_b64_tr_b16 v[68:69], v14 offset:16384
    v_mfma_f32_16x16x32_bf16 v[148:151], v[116:119], v[88:91], v[148:151]
    ds_read_b64_tr_b16 v[70:71], v15 offset:16384
    v_mfma_f32_16x16x32_bf16 v[160:163], v[112:115], v[96:99], v[160:163]
    ds_read_b64_tr_b16 v[72:73], v12 offset:24576
    v_mfma_f32_16x16x32_bf16 v[164:167], v[116:119], v[96:99], v[164:167]
    ds_read_b64_tr_b16 v[74:75], v13 offset:24576
    v_mfma_f32_16x16x32_bf16 v[176:179], v[112:115], v[104:107], v[176:179]
    ds_read_b64_tr_b16 v[76:77], v14 offset:24576
    v_mfma_f32_16x16x32_bf16 v[180:183], v[116:119], v[104:107], v[180:183]
    ds_read_b64_tr_b16 v[78:79], v15 offset:24576
    v_mfma_f32_16x16x32_bf16 v[128:131], v[120:123], v[84:87], v[128:131]
    ds_read_b128 v[32:35], v6 offset:0
    v_mfma_f32_16x16x32_bf16 v[132:135], v[124:127], v[84:87], v[132:135]
    ds_read_b128 v[36:39], v6 offset:1024
    v_mfma_f32_16x16x32_bf16 v[144:147], v[120:123], v[92:95], v[144:147]
    ds_read_b128 v[40:43], v6 offset:2048
    v_mfma_f32_16x16x32_bf16 v[148:151], v[124:127], v[92:95], v[148:151]
    ds_read_b128 v[44:47], v6 offset:3072
    v_mfma_f32_16x16x32_bf16 v[160:163], v[120:123], v[100:103], v[160:163]
    ds_read_b128 v[48:51], v6 offset:4096
    v_mfma_f32_16x16x32_bf16 v[164:167], v[124:127], v[100:103], v[164:167]
    ds_read_b128 v[52:55], v6 offset:5120
    v_mfma_f32_16x16x32_bf16 v[176:179], v[120:123], v[108:111], v[176:179]
    ds_read_b128 v[56:59], v6 offset:6144
    v_mfma_f32_16x16x32_bf16 v[180:183], v[124:127], v[108:111], v[180:183]
    ds_read_b128 v[60:63], v6 offset:7168
    s_waitcnt lgkmcnt(0)
    s_waitcnt vmcnt(8)
    s_barrier
    s_add_u32 m0, s21, 65536
    s_nop 0
    buffer_load_dwordx4 v1, s[4:7], s16 offen sc1 lds
    s_add_u32 s16, s16, s62
    s_add_u32 m0, s21, 66560
    s_nop 0
    buffer_load_dwordx4 v1, s[4:7], s17 offen sc1 lds
    s_add_u32 s17, s17, s62
    s_add_u32 m0, s22, 65536
    s_nop 0
    buffer_load_dwordx4 v2, s[8:11], s18 offen lds
    s_add_u32 s18, s18, s20
    s_add_u32 m0, s22, 73728
    s_nop 0
    buffer_load_dwordx4 v2, s[12:15], s19 offen lds
    s_add_u32 s19, s19, s20
    v_mfma_f32_16x16x32_bf16 v[128:131], v[64:67], v[32:35], v[128:131]
    ds_read_b64_tr_b16 v[112:113], v12 offset:49152
    v_mfma_f32_16x16x32_bf16 v[132:135], v[68:71], v[32:35], v[132:135]
    ds_read_b64_tr_b16 v[114:115], v13 offset:49152
    v_mfma_f32_16x16x32_bf16 v[144:147], v[64:67], v[40:43], v[144:147]
    ds_read_b64_tr_b16 v[116:117], v14 offset:49152
    v_mfma_f32_16x16x32_bf16 v[148:151], v[68:71], v[40:43], v[148:151]
    ds_read_b64_tr_b16 v[118:119], v15 offset:49152
    v_mfma_f32_16x16x32_bf16 v[160:163], v[64:67], v[48:51], v[160:163]
    ds_read_b64_tr_b16 v[120:121], v12 offset:57344
    v_mfma_f32_16x16x32_bf16 v[164:167], v[68:71], v[48:51], v[164:167]
    ds_read_b64_tr_b16 v[122:123], v13 offset:57344
    v_mfma_f32_16x16x32_bf16 v[176:179], v[64:67], v[56:59], v[176:179]
    ds_read_b64_tr_b16 v[124:125], v14 offset:57344
    v_mfma_f32_16x16x32_bf16 v[180:183], v[68:71], v[56:59], v[180:183]
    ds_read_b64_tr_b16 v[126:127], v15 offset:57344
    v_mfma_f32_16x16x32_bf16 v[128:131], v[72:75], v[36:39], v[128:131]
    ds_read_b128 v[80:83], v6 offset:32768
    v_mfma_f32_16x16x32_bf16 v[132:135], v[76:79], v[36:39], v[132:135]
    ds_read_b128 v[84:87], v6 offset:33792
    v_mfma_f32_16x16x32_bf16 v[144:147], v[72:75], v[44:47], v[144:147]
    ds_read_b128 v[88:91], v6 offset:34816
    v_mfma_f32_16x16x32_bf16 v[148:151], v[76:79], v[44:47], v[148:151]
    ds_read_b128 v[92:95], v6 offset:35840
    v_mfma_f32_16x16x32_bf16 v[160:163], v[72:75], v[52:55], v[160:163]
    ds_read_b128 v[96:99], v6 offset:36864
    v_mfma_f32_16x16x32_bf16 v[164:167], v[76:79], v[52:55], v[164:167]
    ds_read_b128 v[100:103], v6 offset:37888
    v_mfma_f32_16x16x32_bf16 v[176:179], v[72:75], v[60:63], v[176:179]
    ds_read_b128 v[104:107], v6 offset:38912
    v_mfma_f32_16x16x32_bf16 v[180:183], v[76:79], v[60:63], v[180:183]
    ds_read_b128 v[108:111], v6 offset:39936
    s_waitcnt lgkmcnt(0)
    s_waitcnt vmcnt(8)
    s_barrier
    s_add_u32 m0, s21, 98304
    s_nop 0
    buffer_load_dwordx4 v1, s[4:7], s16 offen sc1 lds
    s_add_u32 s16, s16, s62
    s_add_u32 m0, s21, 99328
    s_nop 0
    buffer_load_dwordx4 v1, s[4:7], s17 offen sc1 lds
    s_add_u32 s17, s17, s62
    s_add_u32 m0, s22, 98304
    s_nop 0
    buffer_load_dwordx4 v2, s[8:11], s18 offen lds
    s_add_u32 s18, s18, s20
    s_add_u32 m0, s22, 106496
    s_nop 0
    buffer_load_dwordx4 v2, s[12:15], s19 offen lds
    s_add_u32 s19, s19, s20
    v_mfma_f32_16x16x32_bf16 v[128:131], v[112:115], v[80:83], v[128:131]
    ds_read_b64_tr_b16 v[64:65], v8 offset:16384
    v_mfma_f32_16x16x32_bf16 v[132:135], v[116:119], v[80:83], v[132:135]
    ds_read_b64_tr_b16 v[66:67], v9 offset:16384
    v_mfma_f32_16x16x32_bf16 v[144:147], v[112:115], v[88:91], v[144:147]
    ds_read_b64_tr_b16 v[68:69], v10 offset:16384
    v_mfma_f32_16x16x32_bf16 v[148:151], v[116:119], v[88:91], v[148:151]
    ds_read_b64_tr_b16 v[70:71], v11 offset:16384
    v_mfma_f32_16x16x32_bf16 v[160:163], v[112:115], v[96:99], v[160:163]
    ds_read_b64_tr_b16 v[72:73], v8 offset:24576
    v_mfma_f32_16x16x32_bf16 v[164:167], v[116:119], v[96:99], v[164:167]
    ds_read_b64_tr_b16 v[74:75], v9 offset:24576
    v_mfma_f32_16x16x32_bf16 v[176:179], v[112:115], v[104:107], v[176:179]
    ds_read_b64_tr_b16 v[76:77], v10 offset:24576
    v_mfma_f32_16x16x32_bf16 v[180:183], v[116:119], v[104:107], v[180:183]
    ds_read_b64_tr_b16 v[78:79], v11 offset:24576
    v_mfma_f32_16x16x32_bf16 v[128:131], v[120:123], v[84:87], v[128:131]
    ds_read_b128 v[32:35], v5 offset:0
    v_mfma_f32_16x16x32_bf16 v[132:135], v[124:127], v[84:87], v[132:135]
    ds_read_b128 v[36:39], v5 offset:1024
    v_mfma_f32_16x16x32_bf16 v[144:147], v[120:123], v[92:95], v[144:147]
    ds_read_b128 v[40:43], v5 offset:2048
    v_mfma_f32_16x16x32_bf16 v[148:151], v[124:127], v[92:95], v[148:151]
    ds_read_b128 v[44:47], v5 offset:3072
    v_mfma_f32_16x16x32_bf16 v[160:163], v[120:123], v[100:103], v[160:163]
    ds_read_b128 v[48:51], v5 offset:4096
    v_mfma_f32_16x16x32_bf16 v[164:167], v[124:127], v[100:103], v[164:167]
    ds_read_b128 v[52:55], v5 offset:5120
    v_mfma_f32_16x16x32_bf16 v[176:179], v[120:123], v[108:111], v[176:179]
    ds_read_b128 v[56:59], v5 offset:6144
    v_mfma_f32_16x16x32_bf16 v[180:183], v[124:127], v[108:111], v[180:183]
    ds_read_b128 v[60:63], v5 offset:7168
    s_waitcnt lgkmcnt(0)
w_loop_chkH:
    s_sub_u32 s23, s23, 1
w_loopH:
    s_cmp_gt_u32 s23, 3
    s_cbranch_scc1 w_bodyH
    s_cmp_lg_u32 s23, 3
    s_cbranch_scc1 w_l2H
    s_cmp_lg_u32 s3, 0
    s_cbranch_scc1 clm_7
    v_mov_b32 v26, 1
    s_mov_b64 exec, 1
    buffer_atomic_add v26, off, s[64:67], s71 sc0 sc1
    s_mov_b64 exec, -1
clm_7:
    s_branch w_bodyH
w_l2H:
    s_cmp_lg_u32 s23, 2
    s_cbranch_scc1 w_l1H
    s_cmp_lg_u32 s3, 0
    s_cbranch_scc1 pub_8
    v_mov_b32 v20, 131136
    s_mov_b64 exec, 1
    ds_write_b32 v20, v26
    s_mov_b64 exec, -1
    s_waitcnt lgkmcnt(0)
pub_8:
    s_branch w_bodyH
w_l1H:
    s_waitcnt vmcnt(8)
    buffer_load_dword v22, off, s[64:67], 0 sc1
    v_readfirstlane_b32 s30, v16
    s_cmp_ge_u32 s30, s45
    s_cselect_b32 s30, 0, 1
    s_or_b32 s30, s30, s70
    s_cmp_eq_u32 s32, 4
    s_cselect_b32 s30, 1, s30
    s_sub_u32 s57, s32, 1
    s_cmp_ge_u32 s57, 4
    s_cselect_b32 s30, 1, s30
    v_mov_b32 v20, s30
    ds_write_b32 v7, v20
    s_cbranch_scc1 w_bodyH
    s_load_dwordx2 s[8:9], s[0:1], s33
    s_load_dwordx2 s[12:13], s[0:1], s34
    s_mov_b32 s10, s38
    s_mov_b32 s14, s38
    s_cmp_eq_u32 s32, 4
    s_cselect_b32 s31, 0, 1
    s_lshl_b32 s30, s3, s31
    s_mul_i32 s30, s30, s40
    s_add_u32 s16, s39, s30
    s_cmp_eq_u32 s32, 4
    s_cselect_b32 s30, 1024, s40
    s_cselect_b32 s31, 6, 5
    s_lshl_b32 s62, 32, s31
    s_add_u32 s17, s16, s30
    s_lshl_b32 s30, s3, 2
    s_mul_i32 s30, s30, s35
    s_add_u32 s18, s36, s30
    s_add_u32 s19, s37, s30
    s_lshl_b32 s20, s35, s31
    v_mul_u32_u24 v2, s35, v4
    v_add_u32 v2, v2, v3
    s_waitcnt lgkmcnt(0)
w_bodyH:
    s_waitcnt vmcnt(8)
    s_barrier
    s_cmp_lg_u32 s23, 2
    s_cbranch_scc1 w_nfH
    v_mov_b32 v20, 131136
    ds_read_b32 v20, v20
    s_waitcnt lgkmcnt(0)
    v_readfirstlane_b32 s59, v20
    s_add_u32 s59, s59, 32
    s_min_u32 s59, s59, 319
    s_lshl_b32 s57, s59, 6
    s_load_dwordx16 s[32:47], s[24:25], s57
w_nfH:
    s_add_u32 m0, s21, 0
    s_nop 0
    buffer_load_dwordx4 v1, s[4:7], s16 offen sc1 lds
    s_add_u32 s16, s16, s62
    s_add_u32 m0, s21, 1024
    s_nop 0
    buffer_load_dwordx4 v1, s[4:7], s17 offen sc1 lds
    s_add_u32 s17, s17, s62
    s_add_u32 m0, s22, 0
    s_nop 0
    buffer_load_dwordx4 v2, s[8:11], s18 offen lds
    s_add_u32 s18, s18, s20
    s_add_u32 m0, s22, 8192
    s_nop 0
    buffer_load_dwordx4 v2, s[12:15], s19 offen lds
    s_add_u32 s19, s19, s20
    v_mfma_f32_16x16x32_bf16 v[128:131], v[64:67], v[32:35], v[128:131]
    ds_read_b64_tr_b16 v[112:113], v8 offset:49152
    v_mfma_f32_16x16x32_bf16 v[132:135], v[68:71], v[32:35], v[132:135]
    ds_read_b64_tr_b16 v[114:115], v9 offset:49152
    v_mfma_f32_16x16x32_bf16 v[144:147], v[64:67], v[40:43], v[144:147]
    ds_read_b64_tr_b16 v[116:117], v10 offset:49152
    v_mfma_f32_16x16x32_bf16 v[148:151], v[68:71], v[40:43], v[148:151]
    ds_read_b64_tr_b16 v[118:119], v11 offset:49152
    v_mfma_f32_16x16x32_bf16 v[160:163], v[64:67], v[48:51], v[160:163]
    ds_read_b64_tr_b16 v[120:121], v8 offset:57344
    v_mfma_f32_16x16x32_bf16 v[164:167], v[68:71], v[48:51], v[164:167]
    ds_read_b64_tr_b16 v[122:123], v9 offset:57344
    v_mfma_f32_16x16x32_bf16 v[176:179], v[64:67], v[56:59], v[176:179]
    ds_read_b64_tr_b16 v[124:125], v10 offset:57344
    v_mfma_f32_16x16x32_bf16 v[180:183], v[68:71], v[56:59], v[180:183]
    ds_read_b64_tr_b16 v[126:127], v11 offset:57344
    v_mfma_f32_16x16x32_bf16 v[128:131], v[72:75], v[36:39], v[128:131]
    ds_read_b128 v[80:83], v5 offset:32768
    v_mfma_f32_16x16x32_bf16 v[132:135], v[76:79], v[36:39], v[132:135]
    ds_read_b128 v[84:87], v5 offset:33792
    v_mfma_f32_16x16x32_bf16 v[144:147], v[72:75], v[44:47], v[144:147]
    ds_read_b128 v[88:91], v5 offset:34816
    v_mfma_f32_16x16x32_bf16 v[148:151], v[76:79], v[44:47], v[148:151]
    ds_read_b128 v[92:95], v5 offset:35840
    v_mfma_f32_16x16x32_bf16 v[160:163], v[72:75], v[52:55], v[160:163]
    ds_read_b128 v[96:99], v5 offset:36864
    v_mfma_f32_16x16x32_bf16 v[164:167], v[76:79], v[52:55], v[164:167]
    ds_read_b128 v[100:103], v5 offset:37888
    v_mfma_f32_16x16x32_bf16 v[176:179], v[72:75], v[60:63], v[176:179]
    ds_read_b128 v[104:107], v5 offset:38912
    v_mfma_f32_16x16x32_bf16 v[180:183], v[76:79], v[60:63], v[180:183]
    ds_read_b128 v[108:111], v5 offset:39936
    s_waitcnt lgkmcnt(0)
    s_waitcnt vmcnt(8)
    s_barrier
    buffer_load_dword v16, v17, s[4:7], s44 offen sc1
    s_add_u32 m0, s21, 32768
    s_nop 0
    buffer_load_dwordx4 v1, s[4:7], s16 offen sc1 lds
    s_add_u32 s16, s16, s62
    s_add_u32 m0, s21, 33792
    s_nop 0
    buffer_load_dwordx4 v1, s[4:7], s17 offen sc1 lds
    s_add_u32 s17, s17, s62
    s_add_u32 m0, s22, 32768
    s_nop 0
    buffer_load_dwordx4 v2, s[8:11], s18 offen lds
    s_add_u32 s18, s18, s20
    s_add_u32 m0, s22, 40960
    s_nop 0
    buffer_load_dwordx4 v2, s[12:15], s19 offen lds
    s_add_u32 s19, s19, s20
    v_mfma_f32_16x16x32_bf16 v[128:131], v[112:115], v[80:83], v[128:131]
    ds_read_b64_tr_b16 v[64:65], v12 offset:16384
    v_mfma_f32_16x16x32_bf16 v[132:135], v[116:119], v[80:83], v[132:135]
    ds_read_b64_tr_b16 v[66:67], v13 offset:16384
    v_mfma_f32_16x16x32_bf16 v[144:147], v[112:115], v[88:91], v[144:147]
    ds_read_b64_tr_b16 v[68:69], v14 offset:16384
    v_mfma_f32_16x16x32_bf16 v[148:151], v[116:119], v[88:91], v[148:151]
    ds_read_b64_tr_b16 v[70:71], v15 offset:16384
    v_mfma_f32_16x16x32_bf16 v[160:163], v[112:115], v[96:99], v[160:163]
    ds_read_b64_tr_b16 v[72:73], v12 offset:24576
    v_mfma_f32_16x16x32_bf16 v[164:167], v[116:119], v[96:99], v[164:167]
    ds_read_b64_tr_b16 v[74:75], v13 offset:24576
    v_mfma_f32_16x16x32_bf16 v[176:179], v[112:115], v[104:107], v[176:179]
    ds_read_b64_tr_b16 v[76:77], v14 offset:24576
    v_mfma_f32_16x16x32_bf16 v[180:183], v[116:119], v[104:107], v[180:183]
    ds_read_b64_tr_b16 v[78:79], v15 offset:24576
    v_mfma_f32_16x16x32_bf16 v[128:131], v[120:123], v[84:87], v[128:131]
    ds_read_b128 v[32:35], v6 offset:0
    v_mfma_f32_16x16x32_bf16 v[132:135], v[124:127], v[84:87], v[132:135]
    ds_read_b128 v[36:39], v6 offset:1024
    v_mfma_f32_16x16x32_bf16 v[144:147], v[120:123], v[92:95], v[144:147]
    ds_read_b128 v[40:43], v6 offset:2048
    v_mfma_f32_16x16x32_bf16 v[148:151], v[124:127], v[92:95], v[148:151]
    ds_read_b128 v[44:47], v6 offset:3072
    v_mfma_f32_16x16x32_bf16 v[160:163], v[120:123], v[100:103], v[160:163]
    ds_read_b128 v[48:51], v6 offset:4096
    v_mfma_f32_16x16x32_bf16 v[164:167], v[124:127], v[100:103], v[164:167]
    ds_read_b128 v[52:55], v6 offset:5120
    v_mfma_f32_16x16x32_bf16 v[176:179], v[120:123], v[108:111], v[176:179]
    ds_read_b128 v[56:59], v6 offset:6144
    v_mfma_f32_16x16x32_bf16 v[180:183], v[124:127], v[108:111], v[180:183]
    ds_read_b128 v[60:63], v6 offset:7168
    s_waitcnt lgkmcnt(0)
    s_waitcnt vmcnt(8)
    s_barrier
    s_add_u32 m0, s21, 65536
    s_nop 0
    buffer_load_dwordx4 v1, s[4:7], s16 offen sc1 lds
    s_add_u32 s16, s16, s62
    s_add_u32 m0, s21, 66560
    s_nop 0
    buffer_load_dwordx4 v1, s[4:7], s17 offen sc1 lds
    s_add_u32 s17, s17, s62
    s_add_u32 m0, s22, 65536
    s_nop 0
    buffer_load_dwordx4 v2, s[8:11], s18 offen lds
    s_add_u32 s18, s18, s20
    s_add_u32 m0, s22, 73728
    s_nop 0
    buffer_load_dwordx4 v2, s[12:15], s19 offen lds
    s_add_u32 s19, s19, s20
    v_mfma_f32_16x16x32_bf16 v[128:131], v[64:67], v[32:35], v[128:131]
    ds_read_b64_tr_b16 v[112:113], v12 offset:49152
    v_mfma_f32_16x16x32_bf16 v[132:135], v[68:71], v[32:35], v[132:135]
    ds_read_b64_tr_b16 v[114:115], v13 offset:49152
    v_mfma_f32_16x16x32_bf16 v[144:147], v[64:67], v[40:43], v[144:147]
    ds_read_b64_tr_b16 v[116:117], v14 offset:49152
    v_mfma_f32_16x16x32_bf16 v[148:151], v[68:71], v[40:43], v[148:151]
    ds_read_b64_tr_b16 v[118:119], v15 offset:49152
    v_mfma_f32_16x16x32_bf16 v[160:163], v[64:67], v[48:51], v[160:163]
    ds_read_b64_tr_b16 v[120:121], v12 offset:57344
    v_mfma_f32_16x16x32_bf16 v[164:167], v[68:71], v[48:51], v[164:167]
    ds_read_b64_tr_b16 v[122:123], v13 offset:57344
    v_mfma_f32_16x16x32_bf16 v[176:179], v[64:67], v[56:59], v[176:179]
    ds_read_b64_tr_b16 v[124:125], v14 offset:57344
    v_mfma_f32_16x16x32_bf16 v[180:183], v[68:71], v[56:59], v[180:183]
    ds_read_b64_tr_b16 v[126:127], v15 offset:57344
    v_mfma_f32_16x16x32_bf16 v[128:131], v[72:75], v[36:39], v[128:131]
    ds_read_b128 v[80:83], v6 offset:32768
    v_mfma_f32_16x16x32_bf16 v[132:135], v[76:79], v[36:39], v[132:135]
    ds_read_b128 v[84:87], v6 offset:33792
    v_mfma_f32_16x16x32_bf16 v[144:147], v[72:75], v[44:47], v[144:147]
    ds_read_b128 v[88:91], v6 offset:34816
    v_mfma_f32_16x16x32_bf16 v[148:151], v[76:79], v[44:47], v[148:151]
    ds_read_b128 v[92:95], v6 offset:35840
    v_mfma_f32_16x16x32_bf16 v[160:163], v[72:75], v[52:55], v[160:163]
    ds_read_b128 v[96:99], v6 offset:36864
    v_mfma_f32_16x16x32_bf16 v[164:167], v[76:79], v[52:55], v[164:167]
    ds_read_b128 v[100:103], v6 offset:37888
    v_mfma_f32_16x16x32_bf16 v[176:179], v[72:75], v[60:63], v[176:179]
    ds_read_b128 v[104:107], v6 offset:38912
    v_mfma_f32_16x16x32_bf16 v[180:183], v[76:79], v[60:63], v[180:183]
    ds_read_b128 v[108:111], v6 offset:39936
    s_waitcnt lgkmcnt(0)
    s_waitcnt vmcnt(8)
    s_barrier
    s_add_u32 m0, s21, 98304
    s_nop 0
    buffer_load_dwordx4 v1, s[4:7], s16 offen sc1 lds
    s_add_u32 s16, s16, s62
    s_add_u32 m0, s21, 99328
    s_nop 0
    buffer_load_dwordx4 v1, s[4:7], s17 offen sc1 lds
    s_add_u32 s17, s17, s62
    s_add_u32 m0, s22, 98304
    s_nop 0
    buffer_load_dwordx4 v2, s[8:11], s18 offen lds
    s_add_u32 s18, s18, s20
    s_add_u32 m0, s22, 106496
    s_nop 0
    buffer_load_dwordx4 v2, s[12:15], s19 offen lds
    s_add_u32 s19, s19, s20
    v_mfma_f32_16x16x32_bf16 v[128:131], v[112:115], v[80:83], v[128:131]
    ds_read_b64_tr_b16 v[64:65], v8 offset:16384
    v_mfma_f32_16x16x32_bf16 v[132:135], v[116:119], v[80:83], v[132:135]
    ds_read_b64_tr_b16 v[66:67], v9 offset:16384
    v_mfma_f32_16x16x32_bf16 v[144:147], v[112:115], v[88:91], v[144:147]
    ds_read_b64_tr_b16 v[68:69], v10 offset:16384
    v_mfma_f32_16x16x32_bf16 v[148:151], v[116:119], v[88:91], v[148:151]
    ds_read_b64_tr_b16 v[70:71], v11 offset:16384
    v_mfma_f32_16x16x32_bf16 v[160:163], v[112:115], v[96:99], v[160:163]
    ds_read_b64_tr_b16 v[72:73], v8 offset:24576
    v_mfma_f32_16x16x32_bf16 v[164:167], v[116:119], v[96:99], v[164:167]
    ds_read_b64_tr_b16 v[74:75], v9 offset:24576
    v_mfma_f32_16x16x32_bf16 v[176:179], v[112:115], v[104:107], v[176:179]
    ds_read_b64_tr_b16 v[76:77], v10 offset:24576
    v_mfma_f32_16x16x32_bf16 v[180:183], v[116:119], v[104:107], v[180:183]
    ds_read_b64_tr_b16 v[78:79], v11 offset:24576
    v_mfma_f32_16x16x32_bf16 v[128:131], v[120:123], v[84:87], v[128:131]
    ds_read_b128 v[32:35], v5 offset:0
    v_mfma_f32_16x16x32_bf16 v[132:135], v[124:127], v[84:87], v[132:135]
    ds_read_b128 v[36:39], v5 offset:1024
    v_mfma_f32_16x16x32_bf16 v[144:147], v[120:123], v[92:95], v[144:147]
    ds_read_b128 v[40:43], v5 offset:2048
    v_mfma_f32_16x16x32_bf16 v[148:151], v[124:127], v[92:95], v[148:151]
    ds_read_b128 v[44:47], v5 offset:3072
    v_mfma_f32_16x16x32_bf16 v[160:163], v[120:123], v[100:103], v[160:163]
    ds_read_b128 v[48:51], v5 offset:4096
    v_mfma_f32_16x16x32_bf16 v[164:167], v[124:127], v[100:103], v[164:167]
    ds_read_b128 v[52:55], v5 offset:5120
    v_mfma_f32_16x16x32_bf16 v[176:179], v[120:123], v[108:111], v[176:179]
    ds_read_b128 v[56:59], v5 offset:6144
    v_mfma_f32_16x16x32_bf16 v[180:183], v[124:127], v[108:111], v[180:183]
    ds_read_b128 v[60:63], v5 offset:7168
    s_waitcnt lgkmcnt(0)
    s_sub_u32 s23, s23, 1
    s_cmp_lg_u32 s23, 0
    s_cbranch_scc1 w_loopH
    v_mov_b32 v20, 131072
    ds_read_b128 v[24:27], v20
    ds_read_b128 v[28:31], v20 offset:16
    s_lshl_b32 s30, s27, 10
    s_add_u32 s30, s30, s49
    s_nop 7
    v_cvt_pk_bf16_f32 v80, v128, v129
    v_cvt_pk_bf16_f32 v81, v130, v131
    v_cvt_pk_bf16_f32 v82, v132, v133
    v_cvt_pk_bf16_f32 v83, v134, v135
    buffer_store_dwordx4 v[80:83], v1, s[4:7], s30 offen sc1
    s_add_u32 s30, s30, s50
    v_cvt_pk_bf16_f32 v84, v144, v145
    v_cvt_pk_bf16_f32 v85, v146, v147
    v_cvt_pk_bf16_f32 v86, v148, v149
    v_cvt_pk_bf16_f32 v87, v150, v151
    buffer_store_dwordx4 v[84:87], v1, s[4:7], s30 offen sc1
    s_add_u32 s30, s30, s50
    v_cvt_pk_bf16_f32 v88, v160, v161
    v_cvt_pk_bf16_f32 v89, v162, v163
    v_cvt_pk_bf16_f32 v90, v164, v165
    v_cvt_pk_bf16_f32 v91, v166, v167
    buffer_store_dwordx4 v[88:91], v1, s[4:7], s30 offen sc1
    s_add_u32 s30, s30, s50
    v_cvt_pk_bf16_f32 v92, v176, v177
    v_cvt_pk_bf16_f32 v93, v178, v179
    v_cvt_pk_bf16_f32 v94, v180, v181
    v_cvt_pk_bf16_f32 v95, v182, v183
    buffer_store_dwordx4 v[92:95], v1, s[4:7], s30 offen sc1
    s_add_u32 s30, s30, s50
    s_waitcnt lgkmcnt(0)
    v_or3_b32 v24, v24, v25, v26
    v_or3_b32 v28, v28, v29, v30
    v_or3_b32 v24, v24, v27, v31
    v_or_b32 v24, v24, v28
    s_mov_b32 s28, s51
    v_readfirstlane_b32 s30, v24
    s_cmp_lg_u32 s30, 0
    s_cbranch_scc1 w_drain
    s_mov_b32 s48, s32
    s_cmp_eq_u32 s32, 4
    s_cselect_b32 s30, 2, 3
    s_lshl_b32 s30, s26, s30
    s_mul_i32 s30, s30, s43
    s_add_u32 s49, s42, s30
    s_mov_b32 s50, s43
    s_mov_b32 s51, s46
    s_mov_b32 s23, s41
    s_mov_b32 s53, s41
    s_branch w_first4
w_drain:
    s_waitcnt vmcnt(0)
    s_barrier
    s_cmp_eq_u32 s70, 0
    s_cbranch_scc1 drw_ok
    s_mov_b32 s70, 0
    s_cmp_lg_u32 s3, 0
    s_cbranch_scc1 drw_ok
    v_readfirstlane_b32 s68, v22
    s_cmp_ge_u32 s68, 128
    s_cbranch_scc1 drw_ok
    s_mov_b32 s69, 65536
drw:
    buffer_load_dword v20, off, s[64:67], 0 offset:0 sc1
    s_waitcnt vmcnt(0)
    v_readfirstlane_b32 s68, v20
    s_cmp_ge_u32 s68, 128
    s_cbranch_scc1 drw_ok
    s_sleep 8
    s_sub_u32 s69, s69, 1
    s_cbranch_scc0 drw
drw_ok:
    s_cmp_eq_u32 s28, 0
    s_cbranch_scc1 sig_9
    s_cmp_lg_u32 s3, 0
    s_cbranch_scc1 sig_9
    s_and_b32 s57, s28, 3
    v_mov_b32 v24, s57
    s_bfe_u32 s57, s28, 0x20002
    v_mov_b32 v25, s57
    s_andn2_b32 s28, s28, 15
    s_mov_b64 exec, 1
    buffer_atomic_add_x2 v[24:25], v17, s[4:7], s28 offen sc1
    s_mov_b64 exec, -1
sig_9:
    s_mov_b32 s28, 0
    s_cmp_ge_u32 s53, 4
    s_cbranch_scc1 w_cold
    s_cmp_lg_u32 s3, 0
    s_cbranch_scc1 clm_10
    v_mov_b32 v26, 1
    s_mov_b64 exec, 1
    buffer_atomic_add v26, off, s[64:67], s71 sc0 sc1
    s_mov_b64 exec, -1
clm_10:
    s_waitcnt vmcnt(0)
    s_cmp_lg_u32 s3, 0
    s_cbranch_scc1 pub_11
    v_mov_b32 v20, 131136
    s_mov_b64 exec, 1
    ds_write_b32 v20, v26
    s_mov_b64 exec, -1
    s_waitcnt lgkmcnt(0)
pub_11:
    s_barrier
    v_mov_b32 v20, 131136
    ds_read_b32 v20, v20
    s_waitcnt lgkmcnt(0)
    v_readfirstlane_b32 s59, v20
    s_add_u32 s59, s59, 32
    s_min_u32 s59, s59, 319
    s_lshl_b32 s57, s59, 6
    s_load_dwordx16 s[32:47], s[24:25], s57
    s_waitcnt lgkmcnt(0)
    s_barrier
    s_branch w_cold
w_att:
    s_cmp_lg_u32 s3, 0
    s_cbranch_scc1 w_att_go
    s_mov_b32 s31, 0x40000
w_att_w:
    buffer_load_dwordx2 v[20:21], off, s[4:7], s33 sc1
    s_waitcnt vmcnt(0)
    v_add_u32 v20, v20, v21
    s_nop 0
    v_readfirstlane_b32 s30, v20
    s_cmp_ge_u32 s30, 8
    s_cbranch_scc1 w_att_go
    s_sleep 16
    s_sub_u32 s31, s31, 1
    s_cbranch_scc0 w_att_w
w_att_go:
    s_cmp_lg_u32 s3, 0
    s_cbranch_scc1 clm_12
    v_mov_b32 v250, 1
    s_mov_b64 exec, 1
    buffer_atomic_add v250, off, s[64:67], s71 sc0 sc1
    s_mov_b64 exec, -1
clm_12:
    s_barrier
    v_lshrrev_b32 v20, 4, v1
    v_lshrrev_b32 v21, 4, v20
    v_and_b32 v22, 15, v20
    v_lshlrev_b32 v23, 2, v21
    v_add_u32 v24, 0, v23
    v_cmp_gt_u32 s[72:73], v24, v22
    v_add_u32 v24, 1, v23
    v_cmp_gt_u32 s[74:75], v24, v22
    v_add_u32 v24, 2, v23
    v_cmp_gt_u32 s[76:77], v24, v22
    v_add_u32 v24, 3, v23
    v_cmp_gt_u32 s[78:79], v24, v22
    s_mul_i32 s83, s3, 10240
    v_and_b32 v22, 3, v20
    v_bfe_u32 v24, v20, 2, 2
    v_add_u32 v23, v23, v24
    v_lshl_add_u32 v23, v22, 4, v23
    v_lshlrev_b32 v23, 4, v23
    v_add_u32 v25, s83, v23
    v_and_b32 v24, 1, v24
    v_lshl_add_u32 v24, v21, 1, v24
    v_lshl_add_u32 v24, v22, 3, v24
    v_lshlrev_b32 v24, 4, v24
    v_add_u32 v26, s83, v24
    v_mov_b32 v22, 0xff61b1e6
    v_mov_b32 v136, 0
    v_mov_b32 v137, 0
    v_mov_b32 v220, 0
    v_mov_b32 v221, 0
    s_mov_b32 s80, 0x3e0293ee
    s_lshr_b32 s85, s3, 2
    s_add_u32 s85, s85, s39
    s_lshl_b32 s81, s85, 18
    s_and_b32 s85, s3, 3
    s_add_u32 s85, s85, s36
    s_lshl_b32 s82, s85, 13
    s_add_u32 s82, s82, s81
    s_add_u32 s82, s82, 192937984
    s_lshl_b32 s85, s85, 12
    s_add_u32 s81, s81, s85
    v_mov_b32 v28, 0x3f803f80
    v_mov_b32 v29, 0x3f803f80
    v_mov_b32 v30, 0x3f803f80
    v_mov_b32 v31, 0x3f803f80
    s_add_u32 s86, s82, 0
    buffer_load_dwordx4 v[120:123], v1, s[4:7], s86 offen offset:0 sc1
    buffer_load_dwordx4 v[124:127], v1, s[4:7], s86 offen offset:1024 sc1
    buffer_load_dwordx4 v[128:131], v1, s[4:7], s86 offen offset:2048 sc1
    buffer_load_dwordx4 v[132:135], v1, s[4:7], s86 offen offset:3072 sc1
    s_add_u32 s85, s81, 4194304
    buffer_load_dwordx4 v[56:59], v1, s[4:7], s85 offen offset:0 sc1
    buffer_load_dwordx4 v[60:63], v1, s[4:7], s85 offen offset:1024 sc1
    buffer_load_dwordx4 v[64:67], v1, s[4:7], s85 offen offset:2048 sc1
    buffer_load_dwordx4 v[68:71], v1, s[4:7], s85 offen offset:3072 sc1
    s_add_u32 s85, s81, 4325376
    buffer_load_dwordx4 v[72:75], v1, s[4:7], s85 offen offset:0 sc1
    buffer_load_dwordx4 v[76:79], v1, s[4:7], s85 offen offset:1024 sc1
    buffer_load_dwordx4 v[80:83], v1, s[4:7], s85 offen offset:2048 sc1
    buffer_load_dwordx4 v[84:87], v1, s[4:7], s85 offen offset:3072 sc1
    s_add_u32 s85, s81, 20971520
    buffer_load_dwordx4 v[88:91], v1, s[4:7], s85 offen offset:0 sc1
    buffer_load_dwordx4 v[92:95], v1, s[4:7], s85 offen offset:1024 sc1
    buffer_load_dwordx4 v[96:99], v1, s[4:7], s85 offen offset:2048 sc1
    buffer_load_dwordx4 v[100:103], v1, s[4:7], s85 offen offset:3072 sc1
    s_add_u32 s85, s81, 21102592
    buffer_load_dwordx4 v[104:107], v1, s[4:7], s85 offen offset:0 sc1
    buffer_load_dwordx4 v[108:111], v1, s[4:7], s85 offen offset:1024 sc1
    buffer_load_dwordx4 v[112:115], v1, s[4:7], s85 offen offset:2048 sc1
    buffer_load_dwordx4 v[116:119], v1, s[4:7], s85 offen offset:3072 sc1
    s_add_u32 m0, s83, 0
    s_add_u32 s85, s81, 37748736
    buffer_load_dwordx4 v1, s[4:7], s85 offen offset:0 sc1 lds
    buffer_load_dwordx4 v1, s[4:7], s85 offen offset:1024 sc1 lds
    buffer_load_dwordx4 v1, s[4:7], s85 offen offset:2048 sc1 lds
    buffer_load_dwordx4 v1, s[4:7], s85 offen offset:3072 sc1 lds
    s_add_u32 m0, s83, 4096
    s_add_u32 s85, s81, 37879808
    buffer_load_dwordx4 v1, s[4:7], s85 offen offset:0 sc1 lds
    buffer_load_dwordx4 v1, s[4:7], s85 offen offset:1024 sc1 lds
    buffer_load_dwordx4 v1, s[4:7], s85 offen offset:2048 sc1 lds
    buffer_load_dwordx4 v1, s[4:7], s85 offen offset:3072 sc1 lds
    s_add_u32 m0, s83, 8192
    s_add_u32 s85, s82, 4096
    buffer_load_dwordx4 v1, s[4:7], s85 offen offset:0 sc1 lds
    buffer_load_dwordx4 v1, s[4:7], s85 offen offset:1024 sc1 lds
    s_add_u32 s86, s82, 524288
    buffer_load_dwordx4 v[204:207], v1, s[4:7], s86 offen offset:0 sc1
    buffer_load_dwordx4 v[208:211], v1, s[4:7], s86 offen offset:1024 sc1
    buffer_load_dwordx4 v[212:215], v1, s[4:7], s86 offen offset:2048 sc1
    buffer_load_dwordx4 v[216:219], v1, s[4:7], s86 offen offset:3072 sc1
    s_add_u32 s85, s81, 4718592
    buffer_load_dwordx4 v[140:143], v1, s[4:7], s85 offen offset:0 sc1
    buffer_load_dwordx4 v[144:147], v1, s[4:7], s85 offen offset:1024 sc1
    buffer_load_dwordx4 v[148:151], v1, s[4:7], s85 offen offset:2048 sc1
    buffer_load_dwordx4 v[152:155], v1, s[4:7], s85 offen offset:3072 sc1
    s_add_u32 s85, s81, 4849664
    buffer_load_dwordx4 v[156:159], v1, s[4:7], s85 offen offset:0 sc1
    buffer_load_dwordx4 v[160:163], v1, s[4:7], s85 offen offset:1024 sc1
    buffer_load_dwordx4 v[164:167], v1, s[4:7], s85 offen offset:2048 sc1
    buffer_load_dwordx4 v[168:171], v1, s[4:7], s85 offen offset:3072 sc1
    s_add_u32 s85, s81, 21495808
    buffer_load_dwordx4 v[172:175], v1, s[4:7], s85 offen offset:0 sc1
    buffer_load_dwordx4 v[176:179], v1, s[4:7], s85 offen offset:1024 sc1
    buffer_load_dwordx4 v[180:183], v1, s[4:7], s85 offen offset:2048 sc1
    buffer_load_dwordx4 v[184:187], v1, s[4:7], s85 offen offset:3072 sc1
    s_add_u32 s85, s81, 21626880
    buffer_load_dwordx4 v[188:191], v1, s[4:7], s85 offen offset:0 sc1
    buffer_load_dwordx4 v[192:195], v1, s[4:7], s85 offen offset:1024 sc1
    buffer_load_dwordx4 v[196:199], v1, s[4:7], s85 offen offset:2048 sc1
    buffer_load_dwordx4 v[200:203], v1, s[4:7], s85 offen offset:3072 sc1
    s_add_u32 m0, s83, 81920
    s_add_u32 s85, s81, 38273024
    buffer_load_dwordx4 v1, s[4:7], s85 offen offset:0 sc1 lds
    buffer_load_dwordx4 v1, s[4:7], s85 offen offset:1024 sc1 lds
    buffer_load_dwordx4 v1, s[4:7], s85 offen offset:2048 sc1 lds
    buffer_load_dwordx4 v1, s[4:7], s85 offen offset:3072 sc1 lds
    s_add_u32 m0, s83, 86016
    s_add_u32 s85, s81, 38404096
    buffer_load_dwordx4 v1, s[4:7], s85 offen offset:0 sc1 lds
    buffer_load_dwordx4 v1, s[4:7], s85 offen offset:1024 sc1 lds
    buffer_load_dwordx4 v1, s[4:7], s85 offen offset:2048 sc1 lds
    buffer_load_dwordx4 v1, s[4:7], s85 offen offset:3072 sc1 lds
    s_add_u32 m0, s83, 90112
    s_add_u32 s85, s82, 528384
    buffer_load_dwordx4 v1, s[4:7], s85 offen offset:0 sc1 lds
    buffer_load_dwordx4 v1, s[4:7], s85 offen offset:1024 sc1 lds
    s_waitcnt vmcnt(40)
    v_mfma_f32_16x16x32_bf16 v[32:35], v[88:91], v[56:59], 0
    v_mfma_f32_16x16x32_bf16 v[40:43], v[120:123], v[56:59], 0
    v_mfma_f32_16x16x32_bf16 v[32:35], v[92:95], v[60:63], v[32:35]
    v_mfma_f32_16x16x32_bf16 v[40:43], v[124:127], v[60:63], v[40:43]
    v_mfma_f32_16x16x32_bf16 v[32:35], v[96:99], v[64:67], v[32:35]
    v_mfma_f32_16x16x32_bf16 v[40:43], v[128:131], v[64:67], v[40:43]
    v_mfma_f32_16x16x32_bf16 v[32:35], v[100:103], v[68:71], v[32:35]
    v_mfma_f32_16x16x32_bf16 v[40:43], v[132:135], v[68:71], v[40:43]
    v_mfma_f32_16x16x32_bf16 v[44:47], v[88:91], v[72:75], 0
    v_mfma_f32_16x16x32_bf16 v[48:51], v[104:107], v[72:75], 0
    v_mfma_f32_16x16x32_bf16 v[52:55], v[120:123], v[72:75], 0
    v_mfma_f32_16x16x32_bf16 v[44:47], v[92:95], v[76:79], v[44:47]
    v_mfma_f32_16x16x32_bf16 v[48:51], v[108:111], v[76:79], v[48:51]
    v_mfma_f32_16x16x32_bf16 v[52:55], v[124:127], v[76:79], v[52:55]
    v_mfma_f32_16x16x32_bf16 v[44:47], v[96:99], v[80:83], v[44:47]
    v_mfma_f32_16x16x32_bf16 v[48:51], v[112:115], v[80:83], v[48:51]
    v_mfma_f32_16x16x32_bf16 v[52:55], v[128:131], v[80:83], v[52:55]
    v_mfma_f32_16x16x32_bf16 v[44:47], v[100:103], v[84:87], v[44:47]
    v_mfma_f32_16x16x32_bf16 v[48:51], v[116:119], v[84:87], v[48:51]
    v_mfma_f32_16x16x32_bf16 v[52:55], v[132:135], v[84:87], v[52:55]
    v_cndmask_b32 v32, v32, v22, s[72:73]
    v_cndmask_b32 v33, v33, v22, s[74:75]
    v_cndmask_b32 v34, v34, v22, s[76:77]
    v_cndmask_b32 v35, v35, v22, s[78:79]
    v_max3_f32 v20, v32, v33, v34
    v_max3_f32 v21, v35, v40, v41
    v_max_f32 v20, v20, v21
    v_mov_b32 v21, v20
    s_nop 1
    v_permlane16_swap_b32 v21, v20
    v_max_f32 v20, v20, v21
    v_mov_b32 v21, v20
    s_nop 1
    v_permlane32_swap_b32 v21, v20
    v_max_f32 v20, v20, v21
    v_mul_f32 v20, s80, v20
    v_fma_f32 v32, v32, s80, -v20
    v_fma_f32 v33, v33, s80, -v20
    v_fma_f32 v34, v34, s80, -v20
    v_fma_f32 v35, v35, s80, -v20
    v_fma_f32 v40, v40, s80, -v20
    v_fma_f32 v41, v41, s80, -v20
    v_exp_f32 v32, v32
    v_exp_f32 v33, v33
    v_exp_f32 v34, v34
    v_exp_f32 v35, v35
    v_exp_f32 v40, v40
    v_exp_f32 v41, v41
    s_nop 0
    v_cvt_pk_bf16_f32 v32, v32, v33
    v_cvt_pk_bf16_f32 v33, v34, v35
    v_mov_b32 v34, 0
    v_mov_b32 v35, 0
    v_cvt_pk_bf16_f32 v40, v40, v41
    v_mov_b32 v41, 0
    v_mov_b32 v42, 0
    v_mov_b32 v43, 0
    s_nop 1
    s_waitcnt vmcnt(30)
    ds_read_b64_tr_b16 v[56:57], v25 offset:0
    ds_read_b64_tr_b16 v[58:59], v25 offset:4096
    ds_read_b64_tr_b16 v[120:121], v26 offset:8192
    ds_read_b64_tr_b16 v[60:61], v25 offset:8
    ds_read_b64_tr_b16 v[62:63], v25 offset:4104
    ds_read_b64_tr_b16 v[122:123], v26 offset:8200
    ds_read_b64_tr_b16 v[64:65], v25 offset:1024
    ds_read_b64_tr_b16 v[66:67], v25 offset:5120
    ds_read_b64_tr_b16 v[124:125], v26 offset:8704
    ds_read_b64_tr_b16 v[68:69], v25 offset:1032
    ds_read_b64_tr_b16 v[70:71], v25 offset:5128
    ds_read_b64_tr_b16 v[126:127], v26 offset:8712
    ds_read_b64_tr_b16 v[72:73], v25 offset:2048
    ds_read_b64_tr_b16 v[74:75], v25 offset:6144
    ds_read_b64_tr_b16 v[128:129], v26 offset:9216
    ds_read_b64_tr_b16 v[76:77], v25 offset:2056
    ds_read_b64_tr_b16 v[78:79], v25 offset:6152
    ds_read_b64_tr_b16 v[130:131], v26 offset:9224
    ds_read_b64_tr_b16 v[80:81], v25 offset:3072
    ds_read_b64_tr_b16 v[82:83], v25 offset:7168
    ds_read_b64_tr_b16 v[132:133], v26 offset:9728
    ds_read_b64_tr_b16 v[84:85], v25 offset:3080
    ds_read_b64_tr_b16 v[86:87], v25 offset:7176
    ds_read_b64_tr_b16 v[134:135], v26 offset:9736
    v_cndmask_b32 v48, v48, v22, s[72:73]
    v_cndmask_b32 v49, v49, v22, s[74:75]
    v_cndmask_b32 v50, v50, v22, s[76:77]
    v_cndmask_b32 v51, v51, v22, s[78:79]
    v_max3_f32 v20, v44, v45, v46
    v_max3_f32 v21, v47, v48, v49
    v_max3_f32 v20, v20, v50, v51
    v_max3_f32 v21, v21, v52, v53
    v_max_f32 v20, v20, v21
    v_mov_b32 v21, v20
    s_nop 1
    v_permlane16_swap_b32 v21, v20
    v_max_f32 v20, v20, v21
    v_mov_b32 v21, v20
    s_nop 1
    v_permlane32_swap_b32 v21, v20
    v_max_f32 v20, v20, v21
    v_mul_f32 v20, s80, v20
    v_fma_f32 v44, v44, s80, -v20
    v_fma_f32 v45, v45, s80, -v20
    v_fma_f32 v46, v46, s80, -v20
    v_fma_f32 v47, v47, s80, -v20
    v_fma_f32 v48, v48, s80, -v20
    v_fma_f32 v49, v49, s80, -v20
    v_fma_f32 v50, v50, s80, -v20
    v_fma_f32 v51, v51, s80, -v20
    v_fma_f32 v52, v52, s80, -v20
    v_fma_f32 v53, v53, s80, -v20
    v_exp_f32 v44, v44
    v_exp_f32 v45, v45
    v_exp_f32 v46, v46
    v_exp_f32 v47, v47
    v_exp_f32 v48, v48
    v_exp_f32 v49, v49
    v_exp_f32 v50, v50
    v_exp_f32 v51, v51
    v_exp_f32 v52, v52
    v_exp_f32 v53, v53
    s_nop 0
    v_cvt_pk_bf16_f32 v44, v44, v45
    v_cvt_pk_bf16_f32 v45, v46, v47
    v_cvt_pk_bf16_f32 v46, v48, v49
    v_cvt_pk_bf16_f32 v47, v50, v51
    v_cvt_pk_bf16_f32 v52, v52, v53
    v_mov_b32 v53, 0
    v_mov_b32 v54, 0
    v_mov_b32 v55, 0
    s_nop 1
    s_waitcnt lgkmcnt(0)
    v_mfma_f32_16x16x32_bf16 v[36:39], v[28:31], v[32:35], 0
    v_mfma_f32_16x16x32_bf16 v[36:39], v[28:31], v[40:43], v[36:39]
    v_mfma_f32_16x16x32_bf16 v[88:91], v[56:59], v[32:35], 0
    v_mfma_f32_16x16x32_bf16 v[88:91], v[120:123], v[40:43], v[88:91]
    v_mfma_f32_16x16x32_bf16 v[92:95], v[60:63], v[32:35], 0
    v_mfma_f32_16x16x32_bf16 v[92:95], v[122:125], v[40:43], v[92:95]
    v_mfma_f32_16x16x32_bf16 v[96:99], v[64:67], v[32:35], 0
    v_mfma_f32_16x16x32_bf16 v[96:99], v[124:127], v[40:43], v[96:99]
    v_mfma_f32_16x16x32_bf16 v[100:103], v[68:71], v[32:35], 0
    v_mfma_f32_16x16x32_bf16 v[100:103], v[126:129], v[40:43], v[100:103]
    v_mfma_f32_16x16x32_bf16 v[104:107], v[72:75], v[32:35], 0
    v_mfma_f32_16x16x32_bf16 v[104:107], v[128:131], v[40:43], v[104:107]
    v_mfma_f32_16x16x32_bf16 v[108:111], v[76:79], v[32:35], 0
    v_mfma_f32_16x16x32_bf16 v[108:111], v[130:133], v[40:43], v[108:111]
    v_mfma_f32_16x16x32_bf16 v[112:115], v[80:83], v[32:35], 0
    v_mfma_f32_16x16x32_bf16 v[112:115], v[132:135], v[40:43], v[112:115]
    v_mfma_f32_16x16x32_bf16 v[116:119], v[84:87], v[32:35], 0
    v_mfma_f32_16x16x32_bf16 v[116:119], v[134:137], v[40:43], v[116:119]
    v_rcp_f32 v23, v36
    s_add_u32 s85, s81, 176160768
    v_mul_f32 v88, v88, v23
    v_mul_f32 v89, v89, v23
    v_mul_f32 v90, v90, v23
    v_mul_f32 v91, v91, v23
    v_mul_f32 v92, v92, v23
    v_mul_f32 v93, v93, v23
    v_mul_f32 v94, v94, v23
    v_mul_f32 v95, v95, v23
    v_cvt_pk_bf16_f32 v224, v88, v89
    v_cvt_pk_bf16_f32 v225, v90, v91
    v_cvt_pk_bf16_f32 v226, v92, v93
    v_cvt_pk_bf16_f32 v227, v94, v95
    buffer_store_dwordx4 v[224:227], v1, s[4:7], s85 offen offset:0 sc1
    v_mul_f32 v96, v96, v23
    v_mul_f32 v97, v97, v23
    v_mul_f32 v98, v98, v23
    v_mul_f32 v99, v99, v23
    v_mul_f32 v100, v100, v23
    v_mul_f32 v101, v101, v23
    v_mul_f32 v102, v102, v23
    v_mul_f32 v103, v103, v23
    v_cvt_pk_bf16_f32 v228, v96, v97
    v_cvt_pk_bf16_f32 v229, v98, v99
    v_cvt_pk_bf16_f32 v230, v100, v101
    v_cvt_pk_bf16_f32 v231, v102, v103
    buffer_store_dwordx4 v[228:231], v1, s[4:7], s85 offen offset:1024 sc1
    v_mul_f32 v104, v104, v23
    v_mul_f32 v105, v105, v23
    v_mul_f32 v106, v106, v23
    v_mul_f32 v107, v107, v23
    v_mul_f32 v108, v108, v23
    v_mul_f32 v109, v109, v23
    v_mul_f32 v110, v110, v23
    v_mul_f32 v111, v111, v23
    v_cvt_pk_bf16_f32 v232, v104, v105
    v_cvt_pk_bf16_f32 v233, v106, v107
    v_cvt_pk_bf16_f32 v234, v108, v109
    v_cvt_pk_bf16_f32 v235, v110, v111
    buffer_store_dwordx4 v[232:235], v1, s[4:7], s85 offen offset:2048 sc1
    v_mul_f32 v112, v112, v23
    v_mul_f32 v113, v113, v23
    v_mul_f32 v114, v114, v23
    v_mul_f32 v115, v115, v23
    v_mul_f32 v116, v116, v23
    v_mul_f32 v117, v117, v23
    v_mul_f32 v118, v118, v23
    v_mul_f32 v119, v119, v23
    v_cvt_pk_bf16_f32 v236, v112, v113
    v_cvt_pk_bf16_f32 v237, v114, v115
    v_cvt_pk_bf16_f32 v238, v116, v117
    v_cvt_pk_bf16_f32 v239, v118, v119
    buffer_store_dwordx4 v[236:239], v1, s[4:7], s85 offen offset:3072 sc1
    v_mfma_f32_16x16x32_bf16 v[48:51], v[28:31], v[44:47], 0
    v_mfma_f32_16x16x32_bf16 v[48:51], v[28:31], v[52:55], v[48:51]
    v_mfma_f32_16x16x32_bf16 v[88:91], v[56:59], v[44:47], 0
    v_mfma_f32_16x16x32_bf16 v[88:91], v[120:123], v[52:55], v[88:91]
    v_mfma_f32_16x16x32_bf16 v[92:95], v[60:63], v[44:47], 0
    v_mfma_f32_16x16x32_bf16 v[92:95], v[122:125], v[52:55], v[92:95]
    v_mfma_f32_16x16x32_bf16 v[96:99], v[64:67], v[44:47], 0
    v_mfma_f32_16x16x32_bf16 v[96:99], v[124:127], v[52:55], v[96:99]
    v_mfma_f32_16x16x32_bf16 v[100:103], v[68:71], v[44:47], 0
    v_mfma_f32_16x16x32_bf16 v[100:103], v[126:129], v[52:55], v[100:103]
    v_mfma_f32_16x16x32_bf16 v[104:107], v[72:75], v[44:47], 0
    v_mfma_f32_16x16x32_bf16 v[104:107], v[128:131], v[52:55], v[104:107]
    v_mfma_f32_16x16x32_bf16 v[108:111], v[76:79], v[44:47], 0
    v_mfma_f32_16x16x32_bf16 v[108:111], v[130:133], v[52:55], v[108:111]
    v_mfma_f32_16x16x32_bf16 v[112:115], v[80:83], v[44:47], 0
    v_mfma_f32_16x16x32_bf16 v[112:115], v[132:135], v[52:55], v[112:115]
    v_mfma_f32_16x16x32_bf16 v[116:119], v[84:87], v[44:47], 0
    v_mfma_f32_16x16x32_bf16 v[116:119], v[134:137], v[52:55], v[116:119]
    v_rcp_f32 v23, v48
    s_add_u32 s85, s81, 176291840
    v_mul_f32 v88, v88, v23
    v_mul_f32 v89, v89, v23
    v_mul_f32 v90, v90, v23
    v_mul_f32 v91, v91, v23
    v_mul_f32 v92, v92, v23
    v_mul_f32 v93, v93, v23
    v_mul_f32 v94, v94, v23
    v_mul_f32 v95, v95, v23
    v_cvt_pk_bf16_f32 v224, v88, v89
    v_cvt_pk_bf16_f32 v225, v90, v91
    v_cvt_pk_bf16_f32 v226, v92, v93
    v_cvt_pk_bf16_f32 v227, v94, v95
    buffer_store_dwordx4 v[224:227], v1, s[4:7], s85 offen offset:0 sc1
    v_mul_f32 v96, v96, v23
    v_mul_f32 v97, v97, v23
    v_mul_f32 v98, v98, v23
    v_mul_f32 v99, v99, v23
    v_mul_f32 v100, v100, v23
    v_mul_f32 v101, v101, v23
    v_mul_f32 v102, v102, v23
    v_mul_f32 v103, v103, v23
    v_cvt_pk_bf16_f32 v228, v96, v97
    v_cvt_pk_bf16_f32 v229, v98, v99
    v_cvt_pk_bf16_f32 v230, v100, v101
    v_cvt_pk_bf16_f32 v231, v102, v103
    buffer_store_dwordx4 v[228:231], v1, s[4:7], s85 offen offset:1024 sc1
    v_mul_f32 v104, v104, v23
    v_mul_f32 v105, v105, v23
    v_mul_f32 v106, v106, v23
    v_mul_f32 v107, v107, v23
    v_mul_f32 v108, v108, v23
    v_mul_f32 v109, v109, v23
    v_mul_f32 v110, v110, v23
    v_mul_f32 v111, v111, v23
    v_cvt_pk_bf16_f32 v232, v104, v105
    v_cvt_pk_bf16_f32 v233, v106, v107
    v_cvt_pk_bf16_f32 v234, v108, v109
    v_cvt_pk_bf16_f32 v235, v110, v111
    buffer_store_dwordx4 v[232:235], v1, s[4:7], s85 offen offset:2048 sc1
    v_mul_f32 v112, v112, v23
    v_mul_f32 v113, v113, v23
    v_mul_f32 v114, v114, v23
    v_mul_f32 v115, v115, v23
    v_mul_f32 v116, v116, v23
    v_mul_f32 v117, v117, v23
    v_mul_f32 v118, v118, v23
    v_mul_f32 v119, v119, v23
    v_cvt_pk_bf16_f32 v236, v112, v113
    v_cvt_pk_bf16_f32 v237, v114, v115
    v_cvt_pk_bf16_f32 v238, v116, v117
    v_cvt_pk_bf16_f32 v239, v118, v119
    buffer_store_dwordx4 v[236:239], v1, s[4:7], s85 offen offset:3072 sc1
    s_waitcnt vmcnt(18)
    v_mfma_f32_16x16x32_bf16 v[32:35], v[172:175], v[140:143], 0
    v_mfma_f32_16x16x32_bf16 v[40:43], v[204:207], v[140:143], 0
    v_mfma_f32_16x16x32_bf16 v[32:35], v[176:179], v[144:147], v[32:35]
    v_mfma_f32_16x16x32_bf16 v[40:43], v[208:211], v[144:147], v[40:43]
    v_mfma_f32_16x16x32_bf16 v[32:35], v[180:183], v[148:151], v[32:35]
    v_mfma_f32_16x16x32_bf16 v[40:43], v[212:215], v[148:151], v[40:43]
    v_mfma_f32_16x16x32_bf16 v[32:35], v[184:187], v[152:155], v[32:35]
    v_mfma_f32_16x16x32_bf16 v[40:43], v[216:219], v[152:155], v[40:43]
    v_mfma_f32_16x16x32_bf16 v[44:47], v[172:175], v[156:159], 0
    v_mfma_f32_16x16x32_bf16 v[48:51], v[188:191], v[156:159], 0
    v_mfma_f32_16x16x32_bf16 v[52:55], v[204:207], v[156:159], 0
    v_mfma_f32_16x16x32_bf16 v[44:47], v[176:179], v[160:163], v[44:47]
    v_mfma_f32_16x16x32_bf16 v[48:51], v[192:195], v[160:163], v[48:51]
    v_mfma_f32_16x16x32_bf16 v[52:55], v[208:211], v[160:163], v[52:55]
    v_mfma_f32_16x16x32_bf16 v[44:47], v[180:183], v[164:167], v[44:47]
    v_mfma_f32_16x16x32_bf16 v[48:51], v[196:199], v[164:167], v[48:51]
    v_mfma_f32_16x16x32_bf16 v[52:55], v[212:215], v[164:167], v[52:55]
    v_mfma_f32_16x16x32_bf16 v[44:47], v[184:187], v[168:171], v[44:47]
    v_mfma_f32_16x16x32_bf16 v[48:51], v[200:203], v[168:171], v[48:51]
    v_mfma_f32_16x16x32_bf16 v[52:55], v[216:219], v[168:171], v[52:55]
    v_cndmask_b32 v32, v32, v22, s[72:73]
    v_cndmask_b32 v33, v33, v22, s[74:75]
    v_cndmask_b32 v34, v34, v22, s[76:77]
    v_cndmask_b32 v35, v35, v22, s[78:79]
    v_max3_f32 v20, v32, v33, v34
    v_max3_f32 v21, v35, v40, v41
    v_max_f32 v20, v20, v21
    v_mov_b32 v21, v20
    s_nop 1
    v_permlane16_swap_b32 v21, v20
    v_max_f32 v20, v20, v21
    v_mov_b32 v21, v20
    s_nop 1
    v_permlane32_swap_b32 v21, v20
    v_max_f32 v20, v20, v21
    v_mul_f32 v20, s80, v20
    v_fma_f32 v32, v32, s80, -v20
    v_fma_f32 v33, v33, s80, -v20
    v_fma_f32 v34, v34, s80, -v20
    v_fma_f32 v35, v35, s80, -v20
    v_fma_f32 v40, v40, s80, -v20
    v_fma_f32 v41, v41, s80, -v20
    v_exp_f32 v32, v32
    v_exp_f32 v33, v33
    v_exp_f32 v34, v34
    v_exp_f32 v35, v35
    v_exp_f32 v40, v40
    v_exp_f32 v41, v41
    s_nop 0
    v_cvt_pk_bf16_f32 v32, v32, v33
    v_cvt_pk_bf16_f32 v33, v34, v35
    v_mov_b32 v34, 0
    v_mov_b32 v35, 0
    v_cvt_pk_bf16_f32 v40, v40, v41
    v_mov_b32 v41, 0
    v_mov_b32 v42, 0
    v_mov_b32 v43, 0
    s_nop 1
    s_waitcnt vmcnt(8)
    v_add_u32 v25, 81920, v25
    v_add_u32 v26, 81920, v26
    ds_read_b64_tr_b16 v[140:141], v25 offset:0
    ds_read_b64_tr_b16 v[142:143], v25 offset:4096
    ds_read_b64_tr_b16 v[204:205], v26 offset:8192
    ds_read_b64_tr_b16 v[144:145], v25 offset:8
    ds_read_b64_tr_b16 v[146:147], v25 offset:4104
    ds_read_b64_tr_b16 v[206:207], v26 offset:8200
    ds_read_b64_tr_b16 v[148:149], v25 offset:1024
    ds_read_b64_tr_b16 v[150:151], v25 offset:5120
    ds_read_b64_tr_b16 v[208:209], v26 offset:8704
    ds_read_b64_tr_b16 v[152:153], v25 offset:1032
    ds_read_b64_tr_b16 v[154:155], v25 offset:5128
    ds_read_b64_tr_b16 v[210:211], v26 offset:8712
    ds_read_b64_tr_b16 v[156:157], v25 offset:2048
    ds_read_b64_tr_b16 v[158:159], v25 offset:6144
    ds_read_b64_tr_b16 v[212:213], v26 offset:9216
    ds_read_b64_tr_b16 v[160:161], v25 offset:2056
    ds_read_b64_tr_b16 v[162:163], v25 offset:6152
    ds_read_b64_tr_b16 v[214:215], v26 offset:9224
    ds_read_b64_tr_b16 v[164:165], v25 offset:3072
    ds_read_b64_tr_b16 v[166:167], v25 offset:7168
    ds_read_b64_tr_b16 v[216:217], v26 offset:9728
    ds_read_b64_tr_b16 v[168:169], v25 offset:3080
    ds_read_b64_tr_b16 v[170:171], v25 offset:7176
    ds_read_b64_tr_b16 v[218:219], v26 offset:9736
    v_cndmask_b32 v48, v48, v22, s[72:73]
    v_cndmask_b32 v49, v49, v22, s[74:75]
    v_cndmask_b32 v50, v50, v22, s[76:77]
    v_cndmask_b32 v51, v51, v22, s[78:79]
    v_max3_f32 v20, v44, v45, v46
    v_max3_f32 v21, v47, v48, v49
    v_max3_f32 v20, v20, v50, v51
    v_max3_f32 v21, v21, v52, v53
    v_max_f32 v20, v20, v21
    v_mov_b32 v21, v20
    s_nop 1
    v_permlane16_swap_b32 v21, v20
    v_max_f32 v20, v20, v21
    v_mov_b32 v21, v20
    s_nop 1
    v_permlane32_swap_b32 v21, v20
    v_max_f32 v20, v20, v21
    v_mul_f32 v20, s80, v20
    v_fma_f32 v44, v44, s80, -v20
    v_fma_f32 v45, v45, s80, -v20
    v_fma_f32 v46, v46, s80, -v20
    v_fma_f32 v47, v47, s80, -v20
    v_fma_f32 v48, v48, s80, -v20
    v_fma_f32 v49, v49, s80, -v20
    v_fma_f32 v50, v50, s80, -v20
    v_fma_f32 v51, v51, s80, -v20
    v_fma_f32 v52, v52, s80, -v20
    v_fma_f32 v53, v53, s80, -v20
    v_exp_f32 v44, v44
    v_exp_f32 v45, v45
    v_exp_f32 v46, v46
    v_exp_f32 v47, v47
    v_exp_f32 v48, v48
    v_exp_f32 v49, v49
    v_exp_f32 v50, v50
    v_exp_f32 v51, v51
    v_exp_f32 v52, v52
    v_exp_f32 v53, v53
    s_nop 0
    v_cvt_pk_bf16_f32 v44, v44, v45
    v_cvt_pk_bf16_f32 v45, v46, v47
    v_cvt_pk_bf16_f32 v46, v48, v49
    v_cvt_pk_bf16_f32 v47, v50, v51
    v_cvt_pk_bf16_f32 v52, v52, v53
    v_mov_b32 v53, 0
    v_mov_b32 v54, 0
    v_mov_b32 v55, 0
    s_nop 1
    s_waitcnt lgkmcnt(0)
    v_mfma_f32_16x16x32_bf16 v[36:39], v[28:31], v[32:35], 0
    v_mfma_f32_16x16x32_bf16 v[36:39], v[28:31], v[40:43], v[36:39]
    v_mfma_f32_16x16x32_bf16 v[172:175], v[140:143], v[32:35], 0
    v_mfma_f32_16x16x32_bf16 v[172:175], v[204:207], v[40:43], v[172:175]
    v_mfma_f32_16x16x32_bf16 v[176:179], v[144:147], v[32:35], 0
    v_mfma_f32_16x16x32_bf16 v[176:179], v[206:209], v[40:43], v[176:179]
    v_mfma_f32_16x16x32_bf16 v[180:183], v[148:151], v[32:35], 0
    v_mfma_f32_16x16x32_bf16 v[180:183], v[208:211], v[40:43], v[180:183]
    v_mfma_f32_16x16x32_bf16 v[184:187], v[152:155], v[32:35], 0
    v_mfma_f32_16x16x32_bf16 v[184:187], v[210:213], v[40:43], v[184:187]
    v_mfma_f32_16x16x32_bf16 v[188:191], v[156:159], v[32:35], 0
    v_mfma_f32_16x16x32_bf16 v[188:191], v[212:215], v[40:43], v[188:191]
    v_mfma_f32_16x16x32_bf16 v[192:195], v[160:163], v[32:35], 0
    v_mfma_f32_16x16x32_bf16 v[192:195], v[214:217], v[40:43], v[192:195]
    v_mfma_f32_16x16x32_bf16 v[196:199], v[164:167], v[32:35], 0
    v_mfma_f32_16x16x32_bf16 v[196:199], v[216:219], v[40:43], v[196:199]
    v_mfma_f32_16x16x32_bf16 v[200:203], v[168:171], v[32:35], 0
    v_mfma_f32_16x16x32_bf16 v[200:203], v[218:221], v[40:43], v[200:203]
    v_rcp_f32 v23, v36
    s_add_u32 s85, s81, 176685056
    v_mul_f32 v172, v172, v23
    v_mul_f32 v173, v173, v23
    v_mul_f32 v174, v174, v23
    v_mul_f32 v175, v175, v23
    v_mul_f32 v176, v176, v23
    v_mul_f32 v177, v177, v23
    v_mul_f32 v178, v178, v23
    v_mul_f32 v179, v179, v23
    v_cvt_pk_bf16_f32 v224, v172, v173
    v_cvt_pk_bf16_f32 v225, v174, v175
    v_cvt_pk_bf16_f32 v226, v176, v177
    v_cvt_pk_bf16_f32 v227, v178, v179
    buffer_store_dwordx4 v[224:227], v1, s[4:7], s85 offen offset:0 sc1
    v_mul_f32 v180, v180, v23
    v_mul_f32 v181, v181, v23
    v_mul_f32 v182, v182, v23
    v_mul_f32 v183, v183, v23
    v_mul_f32 v184, v184, v23
    v_mul_f32 v185, v185, v23
    v_mul_f32 v186, v186, v23
    v_mul_f32 v187, v187, v23
    v_cvt_pk_bf16_f32 v228, v180, v181
    v_cvt_pk_bf16_f32 v229, v182, v183
    v_cvt_pk_bf16_f32 v230, v184, v185
    v_cvt_pk_bf16_f32 v231, v186, v187
    buffer_store_dwordx4 v[228:231], v1, s[4:7], s85 offen offset:1024 sc1
    v_mul_f32 v188, v188, v23
    v_mul_f32 v189, v189, v23
    v_mul_f32 v190, v190, v23
    v_mul_f32 v191, v191, v23
    v_mul_f32 v192, v192, v23
    v_mul_f32 v193, v193, v23
    v_mul_f32 v194, v194, v23
    v_mul_f32 v195, v195, v23
    v_cvt_pk_bf16_f32 v232, v188, v189
    v_cvt_pk_bf16_f32 v233, v190, v191
    v_cvt_pk_bf16_f32 v234, v192, v193
    v_cvt_pk_bf16_f32 v235, v194, v195
    buffer_store_dwordx4 v[232:235], v1, s[4:7], s85 offen offset:2048 sc1
    v_mul_f32 v196, v196, v23
    v_mul_f32 v197, v197, v23
    v_mul_f32 v198, v198, v23
    v_mul_f32 v199, v199, v23
    v_mul_f32 v200, v200, v23
    v_mul_f32 v201, v201, v23
    v_mul_f32 v202, v202, v23
    v_mul_f32 v203, v203, v23
    v_cvt_pk_bf16_f32 v236, v196, v197
    v_cvt_pk_bf16_f32 v237, v198, v199
    v_cvt_pk_bf16_f32 v238, v200, v201
    v_cvt_pk_bf16_f32 v239, v202, v203
    buffer_store_dwordx4 v[236:239], v1, s[4:7], s85 offen offset:3072 sc1
    v_mfma_f32_16x16x32_bf16 v[48:51], v[28:31], v[44:47], 0
    v_mfma_f32_16x16x32_bf16 v[48:51], v[28:31], v[52:55], v[48:51]
    v_mfma_f32_16x16x32_bf16 v[172:175], v[140:143], v[44:47], 0
    v_mfma_f32_16x16x32_bf16 v[172:175], v[204:207], v[52:55], v[172:175]
    v_mfma_f32_16x16x32_bf16 v[176:179], v[144:147], v[44:47], 0
    v_mfma_f32_16x16x32_bf16 v[176:179], v[206:209], v[52:55], v[176:179]
    v_mfma_f32_16x16x32_bf16 v[180:183], v[148:151], v[44:47], 0
    v_mfma_f32_16x16x32_bf16 v[180:183], v[208:211], v[52:55], v[180:183]
    v_mfma_f32_16x16x32_bf16 v[184:187], v[152:155], v[44:47], 0
    v_mfma_f32_16x16x32_bf16 v[184:187], v[210:213], v[52:55], v[184:187]
    v_mfma_f32_16x16x32_bf16 v[188:191], v[156:159], v[44:47], 0
    v_mfma_f32_16x16x32_bf16 v[188:191], v[212:215], v[52:55], v[188:191]
    v_mfma_f32_16x16x32_bf16 v[192:195], v[160:163], v[44:47], 0
    v_mfma_f32_16x16x32_bf16 v[192:195], v[214:217], v[52:55], v[192:195]
    v_mfma_f32_16x16x32_bf16 v[196:199], v[164:167], v[44:47], 0
    v_mfma_f32_16x16x32_bf16 v[196:199], v[216:219], v[52:55], v[196:199]
    v_mfma_f32_16x16x32_bf16 v[200:203], v[168:171], v[44:47], 0
    v_mfma_f32_16x16x32_bf16 v[200:203], v[218:221], v[52:55], v[200:203]
    v_rcp_f32 v23, v48
    s_add_u32 s85, s81, 176816128
    v_mul_f32 v172, v172, v23
    v_mul_f32 v173, v173, v23
    v_mul_f32 v174, v174, v23
    v_mul_f32 v175, v175, v23
    v_mul_f32 v176, v176, v23
    v_mul_f32 v177, v177, v23
    v_mul_f32 v178, v178, v23
    v_mul_f32 v179, v179, v23
    v_cvt_pk_bf16_f32 v224, v172, v173
    v_cvt_pk_bf16_f32 v225, v174, v175
    v_cvt_pk_bf16_f32 v226, v176, v177
    v_cvt_pk_bf16_f32 v227, v178, v179
    buffer_store_dwordx4 v[224:227], v1, s[4:7], s85 offen offset:0 sc1
    v_mul_f32 v180, v180, v23
    v_mul_f32 v181, v181, v23
    v_mul_f32 v182, v182, v23
    v_mul_f32 v183, v183, v23
    v_mul_f32 v184, v184, v23
    v_mul_f32 v185, v185, v23
    v_mul_f32 v186, v186, v23
    v_mul_f32 v187, v187, v23
    v_cvt_pk_bf16_f32 v228, v180, v181
    v_cvt_pk_bf16_f32 v229, v182, v183
    v_cvt_pk_bf16_f32 v230, v184, v185
    v_cvt_pk_bf16_f32 v231, v186, v187
    buffer_store_dwordx4 v[228:231], v1, s[4:7], s85 offen offset:1024 sc1
    v_mul_f32 v188, v188, v23
    v_mul_f32 v189, v189, v23
    v_mul_f32 v190, v190, v23
    v_mul_f32 v191, v191, v23
    v_mul_f32 v192, v192, v23
    v_mul_f32 v193, v193, v23
    v_mul_f32 v194, v194, v23
    v_mul_f32 v195, v195, v23
    v_cvt_pk_bf16_f32 v232, v188, v189
    v_cvt_pk_bf16_f32 v233, v190, v191
    v_cvt_pk_bf16_f32 v234, v192, v193
    v_cvt_pk_bf16_f32 v235, v194, v195
    buffer_store_dwordx4 v[232:235], v1, s[4:7], s85 offen offset:2048 sc1
    v_mul_f32 v196, v196, v23
    v_mul_f32 v197, v197, v23
    v_mul_f32 v198, v198, v23
    v_mul_f32 v199, v199, v23
    v_mul_f32 v200, v200, v23
    v_mul_f32 v201, v201, v23
    v_mul_f32 v202, v202, v23
    v_mul_f32 v203, v203, v23
    v_cvt_pk_bf16_f32 v236, v196, v197
    v_cvt_pk_bf16_f32 v237, v198, v199
    v_cvt_pk_bf16_f32 v238, v200, v201
    v_cvt_pk_bf16_f32 v239, v202, v203
    buffer_store_dwordx4 v[236:239], v1, s[4:7], s85 offen offset:3072 sc1
    s_mov_b32 s28, s46
    s_waitcnt vmcnt(0)
    s_barrier
    s_cmp_eq_u32 s28, 0
    s_cbranch_scc1 sig_13
    s_cmp_lg_u32 s3, 0
    s_cbranch_scc1 sig_13
    s_and_b32 s57, s28, 3
    v_mov_b32 v24, s57
    s_bfe_u32 s57, s28, 0x20002
    v_mov_b32 v25, s57
    s_andn2_b32 s28, s28, 15
    s_mov_b64 exec, 1
    buffer_atomic_add_x2 v[24:25], v17, s[4:7], s28 offen sc1
    s_mov_b64 exec, -1
sig_13:
    s_mov_b32 s28, 0
    s_cmp_lg_u32 s3, 0
    s_cbranch_scc1 pub_14
    v_mov_b32 v20, 131136
    s_mov_b64 exec, 1
    ds_write_b32 v20, v250
    s_mov_b64 exec, -1
    s_waitcnt lgkmcnt(0)
pub_14:
    s_barrier
    v_mov_b32 v20, 131136
    ds_read_b32 v20, v20
    s_waitcnt lgkmcnt(0)
    v_readfirstlane_b32 s59, v20
    s_add_u32 s59, s59, 32
    s_min_u32 s59, s59, 319
    s_lshl_b32 s57, s59, 6
    s_load_dwordx16 s[32:47], s[24:25], s57
    s_waitcnt lgkmcnt(0)
    s_branch w_cold
w_fin:
    s_load_dwordx2 s[8:9], s[0:1], 0
    s_load_dwordx2 s[12:13], s[0:1], 88
    v_mbcnt_lo_u32_b32 v1, -1, 0
    v_mbcnt_hi_u32_b32 v1, -1, v1
    s_mov_b32 s10, 4194304
    s_mov_b32 s11, 131072
    s_mov_b32 s14, 4194304
    s_mov_b32 s15, 131072
    s_mov_b32 s89, 0xbfb8aa3b
    v_lshlrev_b32 v3, 4, v1
    v_and_b32 v4, 15, v1
    v_lshrrev_b32 v5, 4, v1
    v_lshlrev_b32 v4, 11, v4
    v_lshl_add_u32 v4, v5, 4, v4
    v_and_b32 v5, 1, v5
    v_cmp_eq_u32 s[76:77], 1, v5
    v_and_b32 v6, 3, v1
    v_lshlrev_b32 v6, 7, v6
    s_mov_b32 s80, s39
    s_lshl_b32 s81, s36, 2
    s_and_b32 s82, s3, 3
    s_add_u32 s81, s81, s82
    s_lshr_b32 s82, s3, 2
    s_mov_b32 s84, 65536
    s_mov_b32 s85, 218112000
    s_waitcnt lgkmcnt(0)
    s_cmp_eq_u32 s32, 7
    s_cbranch_scc1 fin_tail
fin_job:
    s_lshl_b32 s72, s80, 1
    s_add_u32 s72, s72, s82
    s_lshl_b32 s74, s72, 15
    s_lshl_b32 s73, s81, 11
    s_add_u32 s73, s73, s74
    s_lshl_b32 s75, s81, 7
    s_add_u32 s74, s74, s75
    s_add_u32 s78, s73, 117440512
    s_add_u32 s79, s73, 75497472
    s_lshr_b32 s83, s80, 3
    s_lshl_b32 s83, s83, 6
    s_add_u32 s83, s83, 218106368
    s_add_u32 s87, s80, 1
    buffer_load_dwordx4 v[88:91], v4, s[8:11], s74 offen offset:0
    buffer_load_dwordx4 v[92:95], v4, s[8:11], s74 offen offset:64
    s_cmp_lg_u32 s3, 0
    s_cbranch_scc1 fin_ws_ok
fin_wd:
    buffer_load_dwordx2 v[8:9], off, s[4:7], s83 sc1
    s_waitcnt vmcnt(0)
    v_readfirstlane_b32 s86, v8
    v_readfirstlane_b32 s88, v9
    s_cmp_ge_u32 s88, s37
    s_cselect_b32 s86, s86, 0
    s_cmp_ge_u32 s86, 16
    s_cbranch_scc1 fin_wd2
    s_sleep 64
    s_sub_u32 s84, s84, 1
    s_cbranch_scc0 fin_wd
    s_mov_b32 s84, 0
fin_wd2:
    s_cmp_lg_u32 s37, 0
    s_cbranch_scc1 fin_ws_ok
fin_ws:
    buffer_load_dword v7, v6, s[4:7], s85 offen sc1
    s_waitcnt vmcnt(0)
    v_cmp_gt_u32 vcc, s87, v7
    s_cbranch_vccz fin_ws_ok
    s_sleep 12
    s_sub_u32 s86, s87, 2
    v_cmp_gt_i32 vcc, s86, v7
    s_cbranch_vccz fin_ws_f
    s_sleep 64
    s_sub_u32 s86, s87, 6
    v_cmp_gt_i32 vcc, s86, v7
    s_cbranch_vccz fin_ws_f
    s_sleep 127
    s_sleep 127
fin_ws_f:
    s_sub_u32 s84, s84, 1
    s_cbranch_scc0 fin_ws
    s_mov_b32 s84, 0
fin_ws_ok:
    s_cmp_lg_u32 s3, 0
    s_cbranch_scc1 clm_15
    v_mov_b32 v250, 1
    s_mov_b64 exec, 1
    buffer_atomic_add v250, off, s[64:67], s71 sc0 sc1
    s_mov_b64 exec, -1
clm_15:
    s_barrier
    buffer_load_dwordx4 v[136:139], v3, s[4:7], s78 offen offset:0 sc1
    buffer_load_dwordx4 v[140:143], v3, s[4:7], s78 offen offset:1024 sc1
    s_add_u32 s78, s78, 4194304
    buffer_load_dwordx4 v[144:147], v3, s[4:7], s78 offen offset:0 sc1
    buffer_load_dwordx4 v[148:151], v3, s[4:7], s78 offen offset:1024 sc1
    s_add_u32 s78, s78, 4194304
    s_cmp_lg_u32 s33, 0
    s_cbranch_scc1 fin_g2
    buffer_load_dwordx4 v[152:155], v3, s[4:7], s78 offen offset:0 sc1
    buffer_load_dwordx4 v[156:159], v3, s[4:7], s78 offen offset:1024 sc1
    s_add_u32 s78, s78, 4194304
    buffer_load_dwordx4 v[160:163], v3, s[4:7], s78 offen offset:0 sc1
    buffer_load_dwordx4 v[164:167], v3, s[4:7], s78 offen offset:1024 sc1
    s_add_u32 s78, s78, 4194304
    s_branch fin_g4
fin_g2:
    v_mov_b32 v152, 0
    v_mov_b32 v153, 0
    v_mov_b32 v154, 0
    v_mov_b32 v155, 0
    v_mov_b32 v156, 0
    v_mov_b32 v157, 0
    v_mov_b32 v158, 0
    v_mov_b32 v159, 0
    v_mov_b32 v160, 0
    v_mov_b32 v161, 0
    v_mov_b32 v162, 0
    v_mov_b32 v163, 0
    v_mov_b32 v164, 0
    v_mov_b32 v165, 0
    v_mov_b32 v166, 0
    v_mov_b32 v167, 0
fin_g4:
    buffer_load_dwordx4 v[16:19], v3, s[4:7], s79 offen offset:0 sc1
    buffer_load_dwordx4 v[48:51], v3, s[4:7], s79 offen offset:1024 sc1
    s_add_u32 s79, s79, 4194304
    buffer_load_dwordx4 v[20:23], v3, s[4:7], s79 offen offset:0 sc1
    buffer_load_dwordx4 v[52:55], v3, s[4:7], s79 offen offset:1024 sc1
    s_add_u32 s79, s79, 4194304
    s_cmp_ge_u32 s35, 2
    s_cbranch_scc1 fin_2p
    buffer_load_dwordx4 v[24:27], v3, s[4:7], s79 offen offset:0 sc1
    buffer_load_dwordx4 v[56:59], v3, s[4:7], s79 offen offset:1024 sc1
    s_add_u32 s79, s79, 4194304
    buffer_load_dwordx4 v[28:31], v3, s[4:7], s79 offen offset:0 sc1
    buffer_load_dwordx4 v[60:63], v3, s[4:7], s79 offen offset:1024 sc1
    s_add_u32 s79, s79, 4194304
    s_cmp_ge_u32 s35, 1
    s_cbranch_scc1 fin_4p
    buffer_load_dwordx4 v[32:35], v3, s[4:7], s79 offen offset:0 sc1
    buffer_load_dwordx4 v[64:67], v3, s[4:7], s79 offen offset:1024 sc1
    s_add_u32 s79, s79, 4194304
    buffer_load_dwordx4 v[36:39], v3, s[4:7], s79 offen offset:0 sc1
    buffer_load_dwordx4 v[68:71], v3, s[4:7], s79 offen offset:1024 sc1
    s_add_u32 s79, s79, 4194304
    buffer_load_dwordx4 v[40:43], v3, s[4:7], s79 offen offset:0 sc1
    buffer_load_dwordx4 v[72:75], v3, s[4:7], s79 offen offset:1024 sc1
    s_add_u32 s79, s79, 4194304
    buffer_load_dwordx4 v[44:47], v3, s[4:7], s79 offen offset:0 sc1
    buffer_load_dwordx4 v[76:79], v3, s[4:7], s79 offen offset:1024 sc1
    s_add_u32 s79, s79, 4194304
    s_waitcnt vmcnt(16)
    s_branch fin_8p
fin_2p:
    v_mov_b32 v24, 0
    v_mov_b32 v25, 0
    v_mov_b32 v26, 0
    v_mov_b32 v27, 0
    v_mov_b32 v28, 0
    v_mov_b32 v29, 0
    v_mov_b32 v30, 0
    v_mov_b32 v31, 0
    v_mov_b32 v32, 0
    v_mov_b32 v33, 0
    v_mov_b32 v34, 0
    v_mov_b32 v35, 0
    v_mov_b32 v36, 0
    v_mov_b32 v37, 0
    v_mov_b32 v38, 0
    v_mov_b32 v39, 0
    v_mov_b32 v40, 0
    v_mov_b32 v41, 0
    v_mov_b32 v42, 0
    v_mov_b32 v43, 0
    v_mov_b32 v44, 0
    v_mov_b32 v45, 0
    v_mov_b32 v46, 0
    v_mov_b32 v47, 0
    v_mov_b32 v56, 0
    v_mov_b32 v57, 0
    v_mov_b32 v58, 0
    v_mov_b32 v59, 0
    v_mov_b32 v60, 0
    v_mov_b32 v61, 0
    v_mov_b32 v62, 0
    v_mov_b32 v63, 0
    v_mov_b32 v64, 0
    v_mov_b32 v65, 0
    v_mov_b32 v66, 0
    v_mov_b32 v67, 0
    v_mov_b32 v68, 0
    v_mov_b32 v69, 0
    v_mov_b32 v70, 0
    v_mov_b32 v71, 0
    v_mov_b32 v72, 0
    v_mov_b32 v73, 0
    v_mov_b32 v74, 0
    v_mov_b32 v75, 0
    v_mov_b32 v76, 0
    v_mov_b32 v77, 0
    v_mov_b32 v78, 0
    v_mov_b32 v79, 0
    s_waitcnt vmcnt(4)
    s_branch fin_8p
fin_4p:
    v_mov_b32 v32, 0
    v_mov_b32 v33, 0
    v_mov_b32 v34, 0
    v_mov_b32 v35, 0
    v_mov_b32 v36, 0
    v_mov_b32 v37, 0
    v_mov_b32 v38, 0
    v_mov_b32 v39, 0
    v_mov_b32 v40, 0
    v_mov_b32 v41, 0
    v_mov_b32 v42, 0
    v_mov_b32 v43, 0
    v_mov_b32 v44, 0
    v_mov_b32 v45, 0
    v_mov_b32 v46, 0
    v_mov_b32 v47, 0
    v_mov_b32 v64, 0
    v_mov_b32 v65, 0
    v_mov_b32 v66, 0
    v_mov_b32 v67, 0
    v_mov_b32 v68, 0
    v_mov_b32 v69, 0
    v_mov_b32 v70, 0
    v_mov_b32 v71, 0
    v_mov_b32 v72, 0
    v_mov_b32 v73, 0
    v_mov_b32 v74, 0
    v_mov_b32 v75, 0
    v_mov_b32 v76, 0
    v_mov_b32 v77, 0
    v_mov_b32 v78, 0
    v_mov_b32 v79, 0
    s_waitcnt vmcnt(8)
fin_8p:
    v_lshlrev_b32 v120, 16, v136
    v_and_b32 v121, 0xffff0000, v136
    v_lshlrev_b32 v136, 16, v144
    v_and_b32 v144, 0xffff0000, v144
    v_add_f32 v120, v120, v136
    v_add_f32 v121, v121, v144
    v_lshlrev_b32 v136, 16, v152
    v_and_b32 v152, 0xffff0000, v152
    v_add_f32 v120, v120, v136
    v_add_f32 v121, v121, v152
    v_lshlrev_b32 v136, 16, v160
    v_and_b32 v160, 0xffff0000, v160
    v_add_f32 v120, v120, v136
    v_add_f32 v121, v121, v160
    v_cvt_pk_bf16_f32 v136, v120, v121
    v_lshlrev_b32 v120, 16, v136
    v_and_b32 v121, 0xffff0000, v136
    v_mul_f32 v136, s89, v120
    v_mul_f32 v144, s89, v121
    v_lshlrev_b32 v122, 16, v137
    v_and_b32 v123, 0xffff0000, v137
    v_lshlrev_b32 v137, 16, v145
    v_and_b32 v145, 0xffff0000, v145
    v_add_f32 v122, v122, v137
    v_add_f32 v123, v123, v145
    v_lshlrev_b32 v137, 16, v153
    v_and_b32 v153, 0xffff0000, v153
    v_add_f32 v122, v122, v137
    v_add_f32 v123, v123, v153
    v_lshlrev_b32 v137, 16, v161
    v_and_b32 v161, 0xffff0000, v161
    v_add_f32 v122, v122, v137
    v_add_f32 v123, v123, v161
    v_cvt_pk_bf16_f32 v137, v122, v123
    v_lshlrev_b32 v122, 16, v137
    v_and_b32 v123, 0xffff0000, v137
    v_mul_f32 v137, s89, v122
    v_mul_f32 v145, s89, v123
    v_lshlrev_b32 v124, 16, v138
    v_and_b32 v125, 0xffff0000, v138
    v_lshlrev_b32 v138, 16, v146
    v_and_b32 v146, 0xffff0000, v146
    v_add_f32 v124, v124, v138
    v_add_f32 v125, v125, v146
    v_lshlrev_b32 v138, 16, v154
    v_and_b32 v154, 0xffff0000, v154
    v_add_f32 v124, v124, v138
    v_add_f32 v125, v125, v154
    v_lshlrev_b32 v138, 16, v162
    v_and_b32 v162, 0xffff0000, v162
    v_add_f32 v124, v124, v138
    v_add_f32 v125, v125, v162
    v_cvt_pk_bf16_f32 v138, v124, v125
    v_lshlrev_b32 v124, 16, v138
    v_and_b32 v125, 0xffff0000, v138
    v_mul_f32 v138, s89, v124
    v_mul_f32 v146, s89, v125
    v_lshlrev_b32 v126, 16, v139
    v_and_b32 v127, 0xffff0000, v139
    v_lshlrev_b32 v139, 16, v147
    v_and_b32 v147, 0xffff0000, v147
    v_add_f32 v126, v126, v139
    v_add_f32 v127, v127, v147
    v_lshlrev_b32 v139, 16, v155
    v_and_b32 v155, 0xffff0000, v155
    v_add_f32 v126, v126, v139
    v_add_f32 v127, v127, v155
    v_lshlrev_b32 v139, 16, v163
    v_and_b32 v163, 0xffff0000, v163
    v_add_f32 v126, v126, v139
    v_add_f32 v127, v127, v163
    v_cvt_pk_bf16_f32 v139, v126, v127
    v_lshlrev_b32 v126, 16, v139
    v_and_b32 v127, 0xffff0000, v139
    v_mul_f32 v139, s89, v126
    v_mul_f32 v147, s89, v127
    v_exp_f32 v136, v136
    v_exp_f32 v144, v144
    v_exp_f32 v137, v137
    v_exp_f32 v145, v145
    v_exp_f32 v138, v138
    v_exp_f32 v146, v146
    v_exp_f32 v139, v139
    v_exp_f32 v147, v147
    s_nop 0
    v_add_f32 v136, 1.0, v136
    v_add_f32 v144, 1.0, v144
    v_add_f32 v137, 1.0, v137
    v_add_f32 v145, 1.0, v145
    v_add_f32 v138, 1.0, v138
    v_add_f32 v146, 1.0, v146
    v_add_f32 v139, 1.0, v139
    v_add_f32 v147, 1.0, v147
    v_rcp_f32 v136, v136
    v_rcp_f32 v144, v144
    v_rcp_f32 v137, v137
    v_rcp_f32 v145, v145
    v_rcp_f32 v138, v138
    v_rcp_f32 v146, v146
    v_rcp_f32 v139, v139
    v_rcp_f32 v147, v147
    s_nop 0
    v_mul_f32 v120, v120, v136
    v_mul_f32 v121, v121, v144
    v_cvt_pk_bf16_f32 v136, v120, v121
    v_mul_f32 v122, v122, v137
    v_mul_f32 v123, v123, v145
    v_cvt_pk_bf16_f32 v137, v122, v123
    v_mul_f32 v124, v124, v138
    v_mul_f32 v125, v125, v146
    v_cvt_pk_bf16_f32 v138, v124, v125
    v_mul_f32 v126, v126, v139
    v_mul_f32 v127, v127, v147
    v_cvt_pk_bf16_f32 v139, v126, v127
    v_lshlrev_b32 v120, 16, v140
    v_and_b32 v121, 0xffff0000, v140
    v_lshlrev_b32 v140, 16, v148
    v_and_b32 v148, 0xffff0000, v148
    v_add_f32 v120, v120, v140
    v_add_f32 v121, v121, v148
    v_lshlrev_b32 v140, 16, v156
    v_and_b32 v156, 0xffff0000, v156
    v_add_f32 v120, v120, v140
    v_add_f32 v121, v121, v156
    v_lshlrev_b32 v140, 16, v164
    v_and_b32 v164, 0xffff0000, v164
    v_add_f32 v120, v120, v140
    v_add_f32 v121, v121, v164
    v_cvt_pk_bf16_f32 v140, v120, v121
    v_lshlrev_b32 v120, 16, v140
    v_and_b32 v121, 0xffff0000, v140
    v_mul_f32 v140, s89, v120
    v_mul_f32 v148, s89, v121
    v_lshlrev_b32 v122, 16, v141
    v_and_b32 v123, 0xffff0000, v141
    v_lshlrev_b32 v141, 16, v149
    v_and_b32 v149, 0xffff0000, v149
    v_add_f32 v122, v122, v141
    v_add_f32 v123, v123, v149
    v_lshlrev_b32 v141, 16, v157
    v_and_b32 v157, 0xffff0000, v157
    v_add_f32 v122, v122, v141
    v_add_f32 v123, v123, v157
    v_lshlrev_b32 v141, 16, v165
    v_and_b32 v165, 0xffff0000, v165
    v_add_f32 v122, v122, v141
    v_add_f32 v123, v123, v165
    v_cvt_pk_bf16_f32 v141, v122, v123
    v_lshlrev_b32 v122, 16, v141
    v_and_b32 v123, 0xffff0000, v141
    v_mul_f32 v141, s89, v122
    v_mul_f32 v149, s89, v123
    v_lshlrev_b32 v124, 16, v142
    v_and_b32 v125, 0xffff0000, v142
    v_lshlrev_b32 v142, 16, v150
    v_and_b32 v150, 0xffff0000, v150
    v_add_f32 v124, v124, v142
    v_add_f32 v125, v125, v150
    v_lshlrev_b32 v142, 16, v158
    v_and_b32 v158, 0xffff0000, v158
    v_add_f32 v124, v124, v142
    v_add_f32 v125, v125, v158
    v_lshlrev_b32 v142, 16, v166
    v_and_b32 v166, 0xffff0000, v166
    v_add_f32 v124, v124, v142
    v_add_f32 v125, v125, v166
    v_cvt_pk_bf16_f32 v142, v124, v125
    v_lshlrev_b32 v124, 16, v142
    v_and_b32 v125, 0xffff0000, v142
    v_mul_f32 v142, s89, v124
    v_mul_f32 v150, s89, v125
    v_lshlrev_b32 v126, 16, v143
    v_and_b32 v127, 0xffff0000, v143
    v_lshlrev_b32 v143, 16, v151
    v_and_b32 v151, 0xffff0000, v151
    v_add_f32 v126, v126, v143
    v_add_f32 v127, v127, v151
    v_lshlrev_b32 v143, 16, v159
    v_and_b32 v159, 0xffff0000, v159
    v_add_f32 v126, v126, v143
    v_add_f32 v127, v127, v159
    v_lshlrev_b32 v143, 16, v167
    v_and_b32 v167, 0xffff0000, v167
    v_add_f32 v126, v126, v143
    v_add_f32 v127, v127, v167
    v_cvt_pk_bf16_f32 v143, v126, v127
    v_lshlrev_b32 v126, 16, v143
    v_and_b32 v127, 0xffff0000, v143
    v_mul_f32 v143, s89, v126
    v_mul_f32 v151, s89, v127
    v_exp_f32 v140, v140
    v_exp_f32 v148, v148
    v_exp_f32 v141, v141
    v_exp_f32 v149, v149
    v_exp_f32 v142, v142
    v_exp_f32 v150, v150
    v_exp_f32 v143, v143
    v_exp_f32 v151, v151
    s_nop 0
    v_add_f32 v140, 1.0, v140
    v_add_f32 v148, 1.0, v148
    v_add_f32 v141, 1.0, v141
    v_add_f32 v149, 1.0, v149
    v_add_f32 v142, 1.0, v142
    v_add_f32 v150, 1.0, v150
    v_add_f32 v143, 1.0, v143
    v_add_f32 v151, 1.0, v151
    v_rcp_f32 v140, v140
    v_rcp_f32 v148, v148
    v_rcp_f32 v141, v141
    v_rcp_f32 v149, v149
    v_rcp_f32 v142, v142
    v_rcp_f32 v150, v150
    v_rcp_f32 v143, v143
    v_rcp_f32 v151, v151
    s_nop 0
    v_mul_f32 v120, v120, v140
    v_mul_f32 v121, v121, v148
    v_cvt_pk_bf16_f32 v140, v120, v121
    v_mul_f32 v122, v122, v141
    v_mul_f32 v123, v123, v149
    v_cvt_pk_bf16_f32 v141, v122, v123
    v_mul_f32 v124, v124, v142
    v_mul_f32 v125, v125, v150
    v_cvt_pk_bf16_f32 v142, v124, v125
    v_mul_f32 v126, v126, v143
    v_mul_f32 v127, v127, v151
    v_cvt_pk_bf16_f32 v143, v126, v127
    s_waitcnt vmcnt(0)
    v_lshlrev_b32 v96, 16, v16
    v_and_b32 v97, 0xffff0000, v16
    v_lshlrev_b32 v98, 16, v17
    v_and_b32 v99, 0xffff0000, v17
    v_lshlrev_b32 v100, 16, v18
    v_and_b32 v101, 0xffff0000, v18
    v_lshlrev_b32 v102, 16, v19
    v_and_b32 v103, 0xffff0000, v19
    v_lshlrev_b32 v120, 16, v20
    v_and_b32 v121, 0xffff0000, v20
    v_lshlrev_b32 v122, 16, v21
    v_and_b32 v123, 0xffff0000, v21
    v_lshlrev_b32 v124, 16, v22
    v_and_b32 v125, 0xffff0000, v22
    v_lshlrev_b32 v126, 16, v23
    v_and_b32 v127, 0xffff0000, v23
    v_add_f32 v96, v96, v120
    v_add_f32 v97, v97, v121
    v_add_f32 v98, v98, v122
    v_add_f32 v99, v99, v123
    v_add_f32 v100, v100, v124
    v_add_f32 v101, v101, v125
    v_add_f32 v102, v102, v126
    v_add_f32 v103, v103, v127
    v_lshlrev_b32 v120, 16, v24
    v_and_b32 v121, 0xffff0000, v24
    v_lshlrev_b32 v122, 16, v25
    v_and_b32 v123, 0xffff0000, v25
    v_lshlrev_b32 v124, 16, v26
    v_and_b32 v125, 0xffff0000, v26
    v_lshlrev_b32 v126, 16, v27
    v_and_b32 v127, 0xffff0000, v27
    v_add_f32 v96, v96, v120
    v_add_f32 v97, v97, v121
    v_add_f32 v98, v98, v122
    v_add_f32 v99, v99, v123
    v_add_f32 v100, v100, v124
    v_add_f32 v101, v101, v125
    v_add_f32 v102, v102, v126
    v_add_f32 v103, v103, v127
    v_lshlrev_b32 v120, 16, v28
    v_and_b32 v121, 0xffff0000, v28
    v_lshlrev_b32 v122, 16, v29
    v_and_b32 v123, 0xffff0000, v29
    v_lshlrev_b32 v124, 16, v30
    v_and_b32 v125, 0xffff0000, v30
    v_lshlrev_b32 v126, 16, v31
    v_and_b32 v127, 0xffff0000, v31
    v_add_f32 v96, v96, v120
    v_add_f32 v97, v97, v121
    v_add_f32 v98, v98, v122
    v_add_f32 v99, v99, v123
    v_add_f32 v100, v100, v124
    v_add_f32 v101, v101, v125
    v_add_f32 v102, v102, v126
    v_add_f32 v103, v103, v127
    v_lshlrev_b32 v120, 16, v32
    v_and_b32 v121, 0xffff0000, v32
    v_lshlrev_b32 v122, 16, v33
    v_and_b32 v123, 0xffff0000, v33
    v_lshlrev_b32 v124, 16, v34
    v_and_b32 v125, 0xffff0000, v34
    v_lshlrev_b32 v126, 16, v35
    v_and_b32 v127, 0xffff0000, v35
    v_add_f32 v96, v96, v120
    v_add_f32 v97, v97, v121
    v_add_f32 v98, v98, v122
    v_add_f32 v99, v99, v123
    v_add_f32 v100, v100, v124
    v_add_f32 v101, v101, v125
    v_add_f32 v102, v102, v126
    v_add_f32 v103, v103, v127
    v_lshlrev_b32 v120, 16, v36
    v_and_b32 v121, 0xffff0000, v36
    v_lshlrev_b32 v122, 16, v37
    v_and_b32 v123, 0xffff0000, v37
    v_lshlrev_b32 v124, 16, v38
    v_and_b32 v125, 0xffff0000, v38
    v_lshlrev_b32 v126, 16, v39
    v_and_b32 v127, 0xffff0000, v39
    v_add_f32 v96, v96, v120
    v_add_f32 v97, v97, v121
    v_add_f32 v98, v98, v122
    v_add_f32 v99, v99, v123
    v_add_f32 v100, v100, v124
    v_add_f32 v101, v101, v125
    v_add_f32 v102, v102, v126
    v_add_f32 v103, v103, v127
    v_lshlrev_b32 v120, 16, v40
    v_and_b32 v121, 0xffff0000, v40
    v_lshlrev_b32 v122, 16, v41
    v_and_b32 v123, 0xffff0000, v41
    v_lshlrev_b32 v124, 16, v42
    v_and_b32 v125, 0xffff0000, v42
    v_lshlrev_b32 v126, 16, v43
    v_and_b32 v127, 0xffff0000, v43
    v_add_f32 v96, v96, v120
    v_add_f32 v97, v97, v121
    v_add_f32 v98, v98, v122
    v_add_f32 v99, v99, v123
    v_add_f32 v100, v100, v124
    v_add_f32 v101, v101, v125
    v_add_f32 v102, v102, v126
    v_add_f32 v103, v103, v127
    v_lshlrev_b32 v120, 16, v44
    v_and_b32 v121, 0xffff0000, v44
    v_lshlrev_b32 v122, 16, v45
    v_and_b32 v123, 0xffff0000, v45
    v_lshlrev_b32 v124, 16, v46
    v_and_b32 v125, 0xffff0000, v46
    v_lshlrev_b32 v126, 16, v47
    v_and_b32 v127, 0xffff0000, v47
    v_add_f32 v96, v96, v120
    v_add_f32 v97, v97, v121
    v_add_f32 v98, v98, v122
    v_add_f32 v99, v99, v123
    v_add_f32 v100, v100, v124
    v_add_f32 v101, v101, v125
    v_add_f32 v102, v102, v126
    v_add_f32 v103, v103, v127
    v_cndmask_b32 v108, v88, v90, s[76:77]
    v_cndmask_b32 v109, v89, v91, s[76:77]
    v_cndmask_b32 v110, v90, v88, s[76:77]
    v_cndmask_b32 v111, v91, v89, s[76:77]
    v_cvt_pk_bf16_f32 v104, v96, v97
    v_lshlrev_b32 v96, 16, v104
    v_and_b32 v97, 0xffff0000, v104
    v_lshlrev_b32 v104, 16, v136
    v_and_b32 v105, 0xffff0000, v136
    v_mul_f32 v96, v96, v104
    v_mul_f32 v97, v97, v105
    v_cvt_pk_bf16_f32 v104, v96, v97
    v_lshlrev_b32 v96, 16, v104
    v_and_b32 v97, 0xffff0000, v104
    v_lshlrev_b32 v104, 16, v108
    v_and_b32 v105, 0xffff0000, v108
    v_add_f32 v96, v96, v104
    v_add_f32 v97, v97, v105
    v_cvt_pk_bf16_f32 v112, v96, v97
    v_cvt_pk_bf16_f32 v104, v98, v99
    v_lshlrev_b32 v98, 16, v104
    v_and_b32 v99, 0xffff0000, v104
    v_lshlrev_b32 v104, 16, v137
    v_and_b32 v105, 0xffff0000, v137
    v_mul_f32 v98, v98, v104
    v_mul_f32 v99, v99, v105
    v_cvt_pk_bf16_f32 v104, v98, v99
    v_lshlrev_b32 v98, 16, v104
    v_and_b32 v99, 0xffff0000, v104
    v_lshlrev_b32 v104, 16, v109
    v_and_b32 v105, 0xffff0000, v109
    v_add_f32 v98, v98, v104
    v_add_f32 v99, v99, v105
    v_cvt_pk_bf16_f32 v113, v98, v99
    v_cvt_pk_bf16_f32 v104, v100, v101
    v_lshlrev_b32 v100, 16, v104
    v_and_b32 v101, 0xffff0000, v104
    v_lshlrev_b32 v104, 16, v138
    v_and_b32 v105, 0xffff0000, v138
    v_mul_f32 v100, v100, v104
    v_mul_f32 v101, v101, v105
    v_cvt_pk_bf16_f32 v104, v100, v101
    v_lshlrev_b32 v100, 16, v104
    v_and_b32 v101, 0xffff0000, v104
    v_lshlrev_b32 v104, 16, v110
    v_and_b32 v105, 0xffff0000, v110
    v_add_f32 v100, v100, v104
    v_add_f32 v101, v101, v105
    v_cvt_pk_bf16_f32 v114, v100, v101
    v_cvt_pk_bf16_f32 v104, v102, v103
    v_lshlrev_b32 v102, 16, v104
    v_and_b32 v103, 0xffff0000, v104
    v_lshlrev_b32 v104, 16, v139
    v_and_b32 v105, 0xffff0000, v139
    v_mul_f32 v102, v102, v104
    v_mul_f32 v103, v103, v105
    v_cvt_pk_bf16_f32 v104, v102, v103
    v_lshlrev_b32 v102, 16, v104
    v_and_b32 v103, 0xffff0000, v104
    v_lshlrev_b32 v104, 16, v111
    v_and_b32 v105, 0xffff0000, v111
    v_add_f32 v102, v102, v104
    v_add_f32 v103, v103, v105
    v_cvt_pk_bf16_f32 v115, v102, v103
    v_cndmask_b32 v128, v112, v114, s[76:77]
    v_cndmask_b32 v129, v113, v115, s[76:77]
    v_cndmask_b32 v130, v114, v112, s[76:77]
    v_cndmask_b32 v131, v115, v113, s[76:77]
    buffer_store_dwordx4 v[128:131], v4, s[12:15], s74 offen offset:0
    v_lshlrev_b32 v96, 16, v48
    v_and_b32 v97, 0xffff0000, v48
    v_lshlrev_b32 v98, 16, v49
    v_and_b32 v99, 0xffff0000, v49
    v_lshlrev_b32 v100, 16, v50
    v_and_b32 v101, 0xffff0000, v50
    v_lshlrev_b32 v102, 16, v51
    v_and_b32 v103, 0xffff0000, v51
    v_lshlrev_b32 v120, 16, v52
    v_and_b32 v121, 0xffff0000, v52
    v_lshlrev_b32 v122, 16, v53
    v_and_b32 v123, 0xffff0000, v53
    v_lshlrev_b32 v124, 16, v54
    v_and_b32 v125, 0xffff0000, v54
    v_lshlrev_b32 v126, 16, v55
    v_and_b32 v127, 0xffff0000, v55
    v_add_f32 v96, v96, v120
    v_add_f32 v97, v97, v121
    v_add_f32 v98, v98, v122
    v_add_f32 v99, v99, v123
    v_add_f32 v100, v100, v124
    v_add_f32 v101, v101, v125
    v_add_f32 v102, v102, v126
    v_add_f32 v103, v103, v127
    v_lshlrev_b32 v120, 16, v56
    v_and_b32 v121, 0xffff0000, v56
    v_lshlrev_b32 v122, 16, v57
    v_and_b32 v123, 0xffff0000, v57
    v_lshlrev_b32 v124, 16, v58
    v_and_b32 v125, 0xffff0000, v58
    v_lshlrev_b32 v126, 16, v59
    v_and_b32 v127, 0xffff0000, v59
    v_add_f32 v96, v96, v120
    v_add_f32 v97, v97, v121
    v_add_f32 v98, v98, v122
    v_add_f32 v99, v99, v123
    v_add_f32 v100, v100, v124
    v_add_f32 v101, v101, v125
    v_add_f32 v102, v102, v126
    v_add_f32 v103, v103, v127
    v_lshlrev_b32 v120, 16, v60
    v_and_b32 v121, 0xffff0000, v60
    v_lshlrev_b32 v122, 16, v61
    v_and_b32 v123, 0xffff0000, v61
    v_lshlrev_b32 v124, 16, v62
    v_and_b32 v125, 0xffff0000, v62
    v_lshlrev_b32 v126, 16, v63
    v_and_b32 v127, 0xffff0000, v63
    v_add_f32 v96, v96, v120
    v_add_f32 v97, v97, v121
    v_add_f32 v98, v98, v122
    v_add_f32 v99, v99, v123
    v_add_f32 v100, v100, v124
    v_add_f32 v101, v101, v125
    v_add_f32 v102, v102, v126
    v_add_f32 v103, v103, v127
    v_lshlrev_b32 v120, 16, v64
    v_and_b32 v121, 0xffff0000, v64
    v_lshlrev_b32 v122, 16, v65
    v_and_b32 v123, 0xffff0000, v65
    v_lshlrev_b32 v124, 16, v66
    v_and_b32 v125, 0xffff0000, v66
    v_lshlrev_b32 v126, 16, v67
    v_and_b32 v127, 0xffff0000, v67
    v_add_f32 v96, v96, v120
    v_add_f32 v97, v97, v121
    v_add_f32 v98, v98, v122
    v_add_f32 v99, v99, v123
    v_add_f32 v100, v100, v124
    v_add_f32 v101, v101, v125
    v_add_f32 v102, v102, v126
    v_add_f32 v103, v103, v127
    v_lshlrev_b32 v120, 16, v68
    v_and_b32 v121, 0xffff0000, v68
    v_lshlrev_b32 v122, 16, v69
    v_and_b32 v123, 0xffff0000, v69
    v_lshlrev_b32 v124, 16, v70
    v_and_b32 v125, 0xffff0000, v70
    v_lshlrev_b32 v126, 16, v71
    v_and_b32 v127, 0xffff0000, v71
    v_add_f32 v96, v96, v120
    v_add_f32 v97, v97, v121
    v_add_f32 v98, v98, v122
    v_add_f32 v99, v99, v123
    v_add_f32 v100, v100, v124
    v_add_f32 v101, v101, v125
    v_add_f32 v102, v102, v126
    v_add_f32 v103, v103, v127
    v_lshlrev_b32 v120, 16, v72
    v_and_b32 v121, 0xffff0000, v72
    v_lshlrev_b32 v122, 16, v73
    v_and_b32 v123, 0xffff0000, v73
    v_lshlrev_b32 v124, 16, v74
    v_and_b32 v125, 0xffff0000, v74
    v_lshlrev_b32 v126, 16, v75
    v_and_b32 v127, 0xffff0000, v75
    v_add_f32 v96, v96, v120
    v_add_f32 v97, v97, v121
    v_add_f32 v98, v98, v122
    v_add_f32 v99, v99, v123
    v_add_f32 v100, v100, v124
    v_add_f32 v101, v101, v125
    v_add_f32 v102, v102, v126
    v_add_f32 v103, v103, v127
    v_lshlrev_b32 v120, 16, v76
    v_and_b32 v121, 0xffff0000, v76
    v_lshlrev_b32 v122, 16, v77
    v_and_b32 v123, 0xffff0000, v77
    v_lshlrev_b32 v124, 16, v78
    v_and_b32 v125, 0xffff0000, v78
    v_lshlrev_b32 v126, 16, v79
    v_and_b32 v127, 0xffff0000, v79
    v_add_f32 v96, v96, v120
    v_add_f32 v97, v97, v121
    v_add_f32 v98, v98, v122
    v_add_f32 v99, v99, v123
    v_add_f32 v100, v100, v124
    v_add_f32 v101, v101, v125
    v_add_f32 v102, v102, v126
    v_add_f32 v103, v103, v127
    v_cndmask_b32 v108, v92, v94, s[76:77]
    v_cndmask_b32 v109, v93, v95, s[76:77]
    v_cndmask_b32 v110, v94, v92, s[76:77]
    v_cndmask_b32 v111, v95, v93, s[76:77]
    v_cvt_pk_bf16_f32 v104, v96, v97
    v_lshlrev_b32 v96, 16, v104
    v_and_b32 v97, 0xffff0000, v104
    v_lshlrev_b32 v104, 16, v140
    v_and_b32 v105, 0xffff0000, v140
    v_mul_f32 v96, v96, v104
    v_mul_f32 v97, v97, v105
    v_cvt_pk_bf16_f32 v104, v96, v97
    v_lshlrev_b32 v96, 16, v104
    v_and_b32 v97, 0xffff0000, v104
    v_lshlrev_b32 v104, 16, v108
    v_and_b32 v105, 0xffff0000, v108
    v_add_f32 v96, v96, v104
    v_add_f32 v97, v97, v105
    v_cvt_pk_bf16_f32 v112, v96, v97
    v_cvt_pk_bf16_f32 v104, v98, v99
    v_lshlrev_b32 v98, 16, v104
    v_and_b32 v99, 0xffff0000, v104
    v_lshlrev_b32 v104, 16, v141
    v_and_b32 v105, 0xffff0000, v141
    v_mul_f32 v98, v98, v104
    v_mul_f32 v99, v99, v105
    v_cvt_pk_bf16_f32 v104, v98, v99
    v_lshlrev_b32 v98, 16, v104
    v_and_b32 v99, 0xffff0000, v104
    v_lshlrev_b32 v104, 16, v109
    v_and_b32 v105, 0xffff0000, v109
    v_add_f32 v98, v98, v104
    v_add_f32 v99, v99, v105
    v_cvt_pk_bf16_f32 v113, v98, v99
    v_cvt_pk_bf16_f32 v104, v100, v101
    v_lshlrev_b32 v100, 16, v104
    v_and_b32 v101, 0xffff0000, v104
    v_lshlrev_b32 v104, 16, v142
    v_and_b32 v105, 0xffff0000, v142
    v_mul_f32 v100, v100, v104
    v_mul_f32 v101, v101, v105
    v_cvt_pk_bf16_f32 v104, v100, v101
    v_lshlrev_b32 v100, 16, v104
    v_and_b32 v101, 0xffff0000, v104
    v_lshlrev_b32 v104, 16, v110
    v_and_b32 v105, 0xffff0000, v110
    v_add_f32 v100, v100, v104
    v_add_f32 v101, v101, v105
    v_cvt_pk_bf16_f32 v114, v100, v101
    v_cvt_pk_bf16_f32 v104, v102, v103
    v_lshlrev_b32 v102, 16, v104
    v_and_b32 v103, 0xffff0000, v104
    v_lshlrev_b32 v104, 16, v143
    v_and_b32 v105, 0xffff0000, v143
    v_mul_f32 v102, v102, v104
    v_mul_f32 v103, v103, v105
    v_cvt_pk_bf16_f32 v104, v102, v103
    v_lshlrev_b32 v102, 16, v104
    v_and_b32 v103, 0xffff0000, v104
    v_lshlrev_b32 v104, 16, v111
    v_and_b32 v105, 0xffff0000, v111
    v_add_f32 v102, v102, v104
    v_add_f32 v103, v103, v105
    v_cvt_pk_bf16_f32 v115, v102, v103
    v_cndmask_b32 v132, v112, v114, s[76:77]
    v_cndmask_b32 v133, v113, v115, s[76:77]
    v_cndmask_b32 v134, v114, v112, s[76:77]
    v_cndmask_b32 v135, v115, v113, s[76:77]
    buffer_store_dwordx4 v[132:135], v4, s[12:15], s74 offen offset:64
    s_branch w_fin_done
fin_tail:
    s_mov_b32 s81, s36
    s_lshl_b32 s81, s81, 2
    s_and_b32 s82, s3, 3
    s_add_u32 s81, s81, s82
    s_lshr_b32 s82, s81, 5
    s_and_b32 s81, s81, 31
    s_lshl_b32 s72, s80, 1
    s_add_u32 s72, s72, s82
    s_lshl_b32 s74, s72, 15
    s_lshl_b32 s73, s81, 10
    s_add_u32 s73, s73, s74
    s_lshl_b32 s75, s81, 6
    s_add_u32 s74, s74, s75
    s_add_u32 s78, s73, 117440512
    s_add_u32 s79, s73, 75497472
    s_mov_b32 s83, 218106816
    s_mov_b32 s84, 65536
    s_min_u32 s87, s80, 62
    v_and_b32 v8, 7, v1
    v_lshlrev_b32 v8, 22, v8
    s_cmp_lg_u32 s3, 0
    s_cbranch_scc1 ft_ok
ft_wd:
    buffer_load_dword v7, off, s[4:7], s83 sc1
    s_waitcnt vmcnt(0)
    v_readfirstlane_b32 s86, v7
    s_cmp_ge_u32 s86, 16
    s_cbranch_scc1 ft_wdok
    s_sleep 32
    s_sub_u32 s84, s84, 1
    s_cbranch_scc0 ft_wd
    s_mov_b32 s84, 0
ft_wdok:
ft_ok:
    s_barrier
    s_cmp_ge_u32 s3, 4
    s_cbranch_scc1 w_fin_done
    buffer_load_dwordx4 v[88:91], v4, s[8:11], s74 offen
    buffer_load_dwordx4 v[136:139], v3, s[4:7], s78 offen sc1
    s_add_u32 s78, s78, 4194304
    buffer_load_dwordx4 v[144:147], v3, s[4:7], s78 offen sc1
    s_add_u32 s78, s78, 4194304
    buffer_load_dwordx4 v[152:155], v3, s[4:7], s78 offen sc1
    s_add_u32 s78, s78, 4194304
    buffer_load_dwordx4 v[160:163], v3, s[4:7], s78 offen sc1
    s_add_u32 s78, s78, 4194304
    s_waitcnt vmcnt(0)
    v_lshlrev_b32 v120, 16, v136
    v_and_b32 v121, 0xffff0000, v136
    v_lshlrev_b32 v136, 16, v144
    v_and_b32 v144, 0xffff0000, v144
    v_add_f32 v120, v120, v136
    v_add_f32 v121, v121, v144
    v_lshlrev_b32 v136, 16, v152
    v_and_b32 v152, 0xffff0000, v152
    v_add_f32 v120, v120, v136
    v_add_f32 v121, v121, v152
    v_lshlrev_b32 v136, 16, v160
    v_and_b32 v160, 0xffff0000, v160
    v_add_f32 v120, v120, v136
    v_add_f32 v121, v121, v160
    v_cvt_pk_bf16_f32 v136, v120, v121
    v_lshlrev_b32 v120, 16, v136
    v_and_b32 v121, 0xffff0000, v136
    v_mul_f32 v136, s89, v120
    v_mul_f32 v144, s89, v121
    v_lshlrev_b32 v122, 16, v137
    v_and_b32 v123, 0xffff0000, v137
    v_lshlrev_b32 v137, 16, v145
    v_and_b32 v145, 0xffff0000, v145
    v_add_f32 v122, v122, v137
    v_add_f32 v123, v123, v145
    v_lshlrev_b32 v137, 16, v153
    v_and_b32 v153, 0xffff0000, v153
    v_add_f32 v122, v122, v137
    v_add_f32 v123, v123, v153
    v_lshlrev_b32 v137, 16, v161
    v_and_b32 v161, 0xffff0000, v161
    v_add_f32 v122, v122, v137
    v_add_f32 v123, v123, v161
    v_cvt_pk_bf16_f32 v137, v122, v123
    v_lshlrev_b32 v122, 16, v137
    v_and_b32 v123, 0xffff0000, v137
    v_mul_f32 v137, s89, v122
    v_mul_f32 v145, s89, v123
    v_lshlrev_b32 v124, 16, v138
    v_and_b32 v125, 0xffff0000, v138
    v_lshlrev_b32 v138, 16, v146
    v_and_b32 v146, 0xffff0000, v146
    v_add_f32 v124, v124, v138
    v_add_f32 v125, v125, v146
    v_lshlrev_b32 v138, 16, v154
    v_and_b32 v154, 0xffff0000, v154
    v_add_f32 v124, v124, v138
    v_add_f32 v125, v125, v154
    v_lshlrev_b32 v138, 16, v162
    v_and_b32 v162, 0xffff0000, v162
    v_add_f32 v124, v124, v138
    v_add_f32 v125, v125, v162
    v_cvt_pk_bf16_f32 v138, v124, v125
    v_lshlrev_b32 v124, 16, v138
    v_and_b32 v125, 0xffff0000, v138
    v_mul_f32 v138, s89, v124
    v_mul_f32 v146, s89, v125
    v_lshlrev_b32 v126, 16, v139
    v_and_b32 v127, 0xffff0000, v139
    v_lshlrev_b32 v139, 16, v147
    v_and_b32 v147, 0xffff0000, v147
    v_add_f32 v126, v126, v139
    v_add_f32 v127, v127, v147
    v_lshlrev_b32 v139, 16, v155
    v_and_b32 v155, 0xffff0000, v155
    v_add_f32 v126, v126, v139
    v_add_f32 v127, v127, v155
    v_lshlrev_b32 v139, 16, v163
    v_and_b32 v163, 0xffff0000, v163
    v_add_f32 v126, v126, v139
    v_add_f32 v127, v127, v163
    v_cvt_pk_bf16_f32 v139, v126, v127
    v_lshlrev_b32 v126, 16, v139
    v_and_b32 v127, 0xffff0000, v139
    v_mul_f32 v139, s89, v126
    v_mul_f32 v147, s89, v127
    v_exp_f32 v136, v136
    v_exp_f32 v144, v144
    v_exp_f32 v137, v137
    v_exp_f32 v145, v145
    v_exp_f32 v138, v138
    v_exp_f32 v146, v146
    v_exp_f32 v139, v139
    v_exp_f32 v147, v147
    s_nop 0
    v_add_f32 v136, 1.0, v136
    v_add_f32 v144, 1.0, v144
    v_add_f32 v137, 1.0, v137
    v_add_f32 v145, 1.0, v145
    v_add_f32 v138, 1.0, v138
    v_add_f32 v146, 1.0, v146
    v_add_f32 v139, 1.0, v139
    v_add_f32 v147, 1.0, v147
    v_rcp_f32 v136, v136
    v_rcp_f32 v144, v144
    v_rcp_f32 v137, v137
    v_rcp_f32 v145, v145
    v_rcp_f32 v138, v138
    v_rcp_f32 v146, v146
    v_rcp_f32 v139, v139
    v_rcp_f32 v147, v147
    s_nop 0
    v_mul_f32 v120, v120, v136
    v_mul_f32 v121, v121, v144
    v_cvt_pk_bf16_f32 v136, v120, v121
    v_mul_f32 v122, v122, v137
    v_mul_f32 v123, v123, v145
    v_cvt_pk_bf16_f32 v137, v122, v123
    v_mul_f32 v124, v124, v138
    v_mul_f32 v125, v125, v146
    v_cvt_pk_bf16_f32 v138, v124, v125
    v_mul_f32 v126, v126, v139
    v_mul_f32 v127, v127, v147
    v_cvt_pk_bf16_f32 v139, v126, v127
ft_ws:
    buffer_load_dword v7, v6, s[4:7], s85 offen sc1
    s_waitcnt vmcnt(0)
    v_cmp_gt_u32 vcc, s87, v7
    s_cbranch_vccz ft_p
    s_sleep 12
    v_cmp_gt_u32 vcc, 59, v7
    s_cbranch_vccz ft_wsf
    s_sleep 64
    v_cmp_gt_u32 vcc, 56, v7
    s_cbranch_vccz ft_wsf
    s_sleep 127
    s_sleep 127
ft_wsf:
    s_sub_u32 s84, s84, 1
    s_cbranch_scc0 ft_ws
    s_mov_b32 s84, 0
ft_p:
    buffer_load_dword v7, v8, s[4:7], s79 offen offset:1008 sc1
    s_waitcnt vmcnt(0)
    v_cmp_eq_u32 vcc, -1, v7
    s_cbranch_vccz ft_l0
    s_sleep 4
    s_sub_u32 s84, s84, 1
    s_cbranch_scc0 ft_p
    s_mov_b32 s84, 0
ft_l0:
    s_cmp_lg_u32 s3, 0
    s_cbranch_scc1 clm_16
    v_mov_b32 v250, 1
    s_mov_b64 exec, 1
    buffer_atomic_add v250, off, s[64:67], s71 sc0 sc1
    s_mov_b64 exec, -1
clm_16:
ft_l:
    s_mov_b32 s86, s79
    buffer_load_dwordx4 v[16:19], v3, s[4:7], s86 offen sc1
    s_add_u32 s86, s86, 4194304
    buffer_load_dwordx4 v[20:23], v3, s[4:7], s86 offen sc1
    s_add_u32 s86, s86, 4194304
    buffer_load_dwordx4 v[24:27], v3, s[4:7], s86 offen sc1
    s_add_u32 s86, s86, 4194304
    buffer_load_dwordx4 v[28:31], v3, s[4:7], s86 offen sc1
    s_add_u32 s86, s86, 4194304
    buffer_load_dwordx4 v[32:35], v3, s[4:7], s86 offen sc1
    s_add_u32 s86, s86, 4194304
    buffer_load_dwordx4 v[36:39], v3, s[4:7], s86 offen sc1
    s_add_u32 s86, s86, 4194304
    buffer_load_dwordx4 v[40:43], v3, s[4:7], s86 offen sc1
    s_add_u32 s86, s86, 4194304
    buffer_load_dwordx4 v[44:47], v3, s[4:7], s86 offen sc1
    s_waitcnt vmcnt(0)
    v_max3_u32 v7, v16, v20, v24
    v_max3_u32 v7, v7, v28, v32
    v_max3_u32 v7, v7, v36, v40
    v_max_u32 v7, v7, v44
    v_cmp_eq_u32 vcc, -1, v7
    s_cbranch_vccz ft_go
    s_sub_u32 s84, s84, 1
    s_cbranch_scc0 ft_l
ft_go:
    v_lshlrev_b32 v96, 16, v16
    v_and_b32 v97, 0xffff0000, v16
    v_lshlrev_b32 v98, 16, v17
    v_and_b32 v99, 0xffff0000, v17
    v_lshlrev_b32 v100, 16, v18
    v_and_b32 v101, 0xffff0000, v18
    v_lshlrev_b32 v102, 16, v19
    v_and_b32 v103, 0xffff0000, v19
    v_lshlrev_b32 v120, 16, v20
    v_and_b32 v121, 0xffff0000, v20
    v_lshlrev_b32 v122, 16, v21
    v_and_b32 v123, 0xffff0000, v21
    v_lshlrev_b32 v124, 16, v22
    v_and_b32 v125, 0xffff0000, v22
    v_lshlrev_b32 v126, 16, v23
    v_and_b32 v127, 0xffff0000, v23
    v_add_f32 v96, v96, v120
    v_add_f32 v97, v97, v121
    v_add_f32 v98, v98, v122
    v_add_f32 v99, v99, v123
    v_add_f32 v100, v100, v124
    v_add_f32 v101, v101, v125
    v_add_f32 v102, v102, v126
    v_add_f32 v103, v103, v127
    v_lshlrev_b32 v120, 16, v24
    v_and_b32 v121, 0xffff0000, v24
    v_lshlrev_b32 v122, 16, v25
    v_and_b32 v123, 0xffff0000, v25
    v_lshlrev_b32 v124, 16, v26
    v_and_b32 v125, 0xffff0000, v26
    v_lshlrev_b32 v126, 16, v27
    v_and_b32 v127, 0xffff0000, v27
    v_add_f32 v96, v96, v120
    v_add_f32 v97, v97, v121
    v_add_f32 v98, v98, v122
    v_add_f32 v99, v99, v123
    v_add_f32 v100, v100, v124
    v_add_f32 v101, v101, v125
    v_add_f32 v102, v102, v126
    v_add_f32 v103, v103, v127
    v_lshlrev_b32 v120, 16, v28
    v_and_b32 v121, 0xffff0000, v28
    v_lshlrev_b32 v122, 16, v29
    v_and_b32 v123, 0xffff0000, v29
    v_lshlrev_b32 v124, 16, v30
    v_and_b32 v125, 0xffff0000, v30
    v_lshlrev_b32 v126, 16, v31
    v_and_b32 v127, 0xffff0000, v31
    v_add_f32 v96, v96, v120
    v_add_f32 v97, v97, v121
    v_add_f32 v98, v98, v122
    v_add_f32 v99, v99, v123
    v_add_f32 v100, v100, v124
    v_add_f32 v101, v101, v125
    v_add_f32 v102, v102, v126
    v_add_f32 v103, v103, v127
    v_lshlrev_b32 v120, 16, v32
    v_and_b32 v121, 0xffff0000, v32
    v_lshlrev_b32 v122, 16, v33
    v_and_b32 v123, 0xffff0000, v33
    v_lshlrev_b32 v124, 16, v34
    v_and_b32 v125, 0xffff0000, v34
    v_lshlrev_b32 v126, 16, v35
    v_and_b32 v127, 0xffff0000, v35
    v_add_f32 v96, v96, v120
    v_add_f32 v97, v97, v121
    v_add_f32 v98, v98, v122
    v_add_f32 v99, v99, v123
    v_add_f32 v100, v100, v124
    v_add_f32 v101, v101, v125
    v_add_f32 v102, v102, v126
    v_add_f32 v103, v103, v127
    v_lshlrev_b32 v120, 16, v36
    v_and_b32 v121, 0xffff0000, v36
    v_lshlrev_b32 v122, 16, v37
    v_and_b32 v123, 0xffff0000, v37
    v_lshlrev_b32 v124, 16, v38
    v_and_b32 v125, 0xffff0000, v38
    v_lshlrev_b32 v126, 16, v39
    v_and_b32 v127, 0xffff0000, v39
    v_add_f32 v96, v96, v120
    v_add_f32 v97, v97, v121
    v_add_f32 v98, v98, v122
    v_add_f32 v99, v99, v123
    v_add_f32 v100, v100, v124
    v_add_f32 v101, v101, v125
    v_add_f32 v102, v102, v126
    v_add_f32 v103, v103, v127
    v_lshlrev_b32 v120, 16, v40
    v_and_b32 v121, 0xffff0000, v40
    v_lshlrev_b32 v122, 16, v41
    v_and_b32 v123, 0xffff0000, v41
    v_lshlrev_b32 v124, 16, v42
    v_and_b32 v125, 0xffff0000, v42
    v_lshlrev_b32 v126, 16, v43
    v_and_b32 v127, 0xffff0000, v43
    v_add_f32 v96, v96, v120
    v_add_f32 v97, v97, v121
    v_add_f32 v98, v98, v122
    v_add_f32 v99, v99, v123
    v_add_f32 v100, v100, v124
    v_add_f32 v101, v101, v125
    v_add_f32 v102, v102, v126
    v_add_f32 v103, v103, v127
    v_lshlrev_b32 v120, 16, v44
    v_and_b32 v121, 0xffff0000, v44
    v_lshlrev_b32 v122, 16, v45
    v_and_b32 v123, 0xffff0000, v45
    v_lshlrev_b32 v124, 16, v46
    v_and_b32 v125, 0xffff0000, v46
    v_lshlrev_b32 v126, 16, v47
    v_and_b32 v127, 0xffff0000, v47
    v_add_f32 v96, v96, v120
    v_add_f32 v97, v97, v121
    v_add_f32 v98, v98, v122
    v_add_f32 v99, v99, v123
    v_add_f32 v100, v100, v124
    v_add_f32 v101, v101, v125
    v_add_f32 v102, v102, v126
    v_add_f32 v103, v103, v127
    v_cndmask_b32 v108, v88, v90, s[76:77]
    v_cndmask_b32 v109, v89, v91, s[76:77]
    v_cndmask_b32 v110, v90, v88, s[76:77]
    v_cndmask_b32 v111, v91, v89, s[76:77]
    v_cvt_pk_bf16_f32 v104, v96, v97
    v_lshlrev_b32 v96, 16, v104
    v_and_b32 v97, 0xffff0000, v104
    v_lshlrev_b32 v104, 16, v136
    v_and_b32 v105, 0xffff0000, v136
    v_mul_f32 v96, v96, v104
    v_mul_f32 v97, v97, v105
    v_cvt_pk_bf16_f32 v104, v96, v97
    v_lshlrev_b32 v96, 16, v104
    v_and_b32 v97, 0xffff0000, v104
    v_lshlrev_b32 v104, 16, v108
    v_and_b32 v105, 0xffff0000, v108
    v_add_f32 v96, v96, v104
    v_add_f32 v97, v97, v105
    v_cvt_pk_bf16_f32 v112, v96, v97
    v_cvt_pk_bf16_f32 v104, v98, v99
    v_lshlrev_b32 v98, 16, v104
    v_and_b32 v99, 0xffff0000, v104
    v_lshlrev_b32 v104, 16, v137
    v_and_b32 v105, 0xffff0000, v137
    v_mul_f32 v98, v98, v104
    v_mul_f32 v99, v99, v105
    v_cvt_pk_bf16_f32 v104, v98, v99
    v_lshlrev_b32 v98, 16, v104
    v_and_b32 v99, 0xffff0000, v104
    v_lshlrev_b32 v104, 16, v109
    v_and_b32 v105, 0xffff0000, v109
    v_add_f32 v98, v98, v104
    v_add_f32 v99, v99, v105
    v_cvt_pk_bf16_f32 v113, v98, v99
    v_cvt_pk_bf16_f32 v104, v100, v101
    v_lshlrev_b32 v100, 16, v104
    v_and_b32 v101, 0xffff0000, v104
    v_lshlrev_b32 v104, 16, v138
    v_and_b32 v105, 0xffff0000, v138
    v_mul_f32 v100, v100, v104
    v_mul_f32 v101, v101, v105
    v_cvt_pk_bf16_f32 v104, v100, v101
    v_lshlrev_b32 v100, 16, v104
    v_and_b32 v101, 0xffff0000, v104
    v_lshlrev_b32 v104, 16, v110
    v_and_b32 v105, 0xffff0000, v110
    v_add_f32 v100, v100, v104
    v_add_f32 v101, v101, v105
    v_cvt_pk_bf16_f32 v114, v100, v101
    v_cvt_pk_bf16_f32 v104, v102, v103
    v_lshlrev_b32 v102, 16, v104
    v_and_b32 v103, 0xffff0000, v104
    v_lshlrev_b32 v104, 16, v139
    v_and_b32 v105, 0xffff0000, v139
    v_mul_f32 v102, v102, v104
    v_mul_f32 v103, v103, v105
    v_cvt_pk_bf16_f32 v104, v102, v103
    v_lshlrev_b32 v102, 16, v104
    v_and_b32 v103, 0xffff0000, v104
    v_lshlrev_b32 v104, 16, v111
    v_and_b32 v105, 0xffff0000, v111
    v_add_f32 v102, v102, v104
    v_add_f32 v103, v103, v105
    v_cvt_pk_bf16_f32 v115, v102, v103
    v_cndmask_b32 v128, v112, v114, s[76:77]
    v_cndmask_b32 v129, v113, v115, s[76:77]
    v_cndmask_b32 v130, v114, v112, s[76:77]
    v_cndmask_b32 v131, v115, v113, s[76:77]
    buffer_store_dwordx4 v[128:131], v4, s[12:15], s74 offen offset:0
    s_branch w_fin_done
w_fin_done:
    s_cmp_lg_u32 s3, 0
    s_cbranch_scc1 pub_17
    v_mov_b32 v20, 131136
    s_mov_b64 exec, 1
    ds_write_b32 v20, v250
    s_mov_b64 exec, -1
    s_waitcnt lgkmcnt(0)
pub_17:
    s_barrier
    v_mov_b32 v20, 131136
    ds_read_b32 v20, v20
    s_waitcnt lgkmcnt(0)
    v_readfirstlane_b32 s59, v20
    s_add_u32 s59, s59, 32
    s_min_u32 s59, s59, 319
    s_lshl_b32 s57, s59, 6
    s_load_dwordx16 s[32:47], s[24:25], s57
    s_waitcnt lgkmcnt(0)
    s_barrier
    s_sub_u32 s57, s32, 1
    s_cmp_ge_u32 s57, 5
    s_cbranch_scc1 w_cold
    v_and_b32 v20, 63, v0
    v_lshlrev_b32 v1, 4, v20
    v_add_u32 v19, 0x1000, v1
    v_lshrrev_b32 v4, 4, v20
    v_mov_b32 v17, 0
    v_mov_b32 v18, 1
    s_lshr_b32 s26, s3, 2
    s_and_b32 s27, s3, 3
    s_lshl_b32 s21, s3, 11
    s_lshl_b32 s22, s3, 10
    s_add_u32 s22, s22, 16384
    s_mov_b32 s11, 131072
    s_mov_b32 s15, 131072
    s_mov_b32 s28, 0
    v_and_b32 v21, 15, v20
    v_lshlrev_b32 v22, 2, v4
    v_xor_b32 v21, v21, v22
    s_lshr_b32 s30, s3, 1
    s_and_b32 s30, s30, 1
    v_xor_b32 v21, s30, v21
    v_lshlrev_b32 v3, 4, v21
    s_lshl_b32 s30, s26, 13
    v_add_u32 v5, s30, v1
    v_add_u32 v6, 0x10000, v5
    v_bfe_u32 v21, v20, 2, 2
    v_and_b32 v22, 3, v20
    v_and_b32 v23, 1, v4
    v_xor_b32 v24, s27, v21
    v_xor_b32 v25, v22, v23
    v_lshl_add_u32 v24, v24, 2, v25
    v_lshlrev_b32 v24, 4, v24
    v_lshl_add_u32 v25, v4, 3, v21
    v_lshl_add_u32 v24, v25, 8, v24
    v_and_b32 v22, 1, v22
    v_xor_b32 v25, 0, v23
    v_lshl_add_u32 v8, v25, 10, v24
    v_xor_b32 v25, 0, v22
    v_lshl_add_u32 v8, v25, 3, v8
    v_add_u32 v12, 0x10000, v8
    v_xor_b32 v25, 1, v23
    v_lshl_add_u32 v9, v25, 10, v24
    v_xor_b32 v25, 0, v22
    v_lshl_add_u32 v9, v25, 3, v9
    v_add_u32 v13, 0x10000, v9
    v_xor_b32 v25, 0, v23
    v_lshl_add_u32 v10, v25, 10, v24
    v_xor_b32 v25, 1, v22
    v_lshl_add_u32 v10, v25, 3, v10
    v_add_u32 v14, 0x10000, v10
    v_xor_b32 v25, 1, v23
    v_lshl_add_u32 v11, v25, 10, v24
    v_xor_b32 v25, 1, v22
    v_lshl_add_u32 v11, v25, 3, v11
    v_add_u32 v15, 0x10000, v11
    s_lshl_b32 s30, s3, 2
    s_add_u32 s30, s30, 131072
    v_mov_b32 v7, s30
    s_branch w_cold
chain_map:
    s_lshl_b32 s52, s12, 5
    s_add_u32 s52, s52, s13
    s_lshr_b32 s15, s52, 2
    s_lshr_b32 s14, s52, 4
    s_and_b32 s34, s13, 15
    s_and_b32 s53, s13, 3
    s_mov_b32 s16, 0
    s_mov_b32 s22, 131072
    s_mov_b32 s100, 131072
    s_getreg_b32 s40, hwreg(HW_REG_XCC_ID)
    s_and_b32 s40, s40, 15
    s_mul_i32 s19, s40, s40
    s_lshl_b32 s19, s19, 18
    s_lshl_b32 s40, s40, 8
    s_add_u32 s40, s40, s19
    s_add_u32 s40, s40, 1
    s_lshl_b32 s35, s14, 4
    s_add_u32 s35, s35, 218104320
    s_and_b32 s21, s3, 3
    s_mul_i32 s42, s21, 24576
    s_add_u32 s42, s42, 65536
    s_lshl_b32 s41, s14, 2
    s_add_u32 s41, s41, s21
    s_lshl_b32 s41, s41, 12
    s_add_u32 s101, s42, 8192
    s_bfe_u32 s17, s34, 0x20001
    s_cmp_eq_u32 s17, s21
    s_cselect_b32 s68, 20480, s42
    s_xor_b32 s68, s68, s101
    s_lshl_b32 s43, s21, 13
    s_add_u32 s43, s43, 138412032
    s_lshl_b32 s69, s21, 24
    s_lshl_b32 s17, s52, 10
    s_add_u32 s69, s69, s17
    s_add_u32 s69, s69, 20971520
    s_cmp_ge_u32 s3, 4
    s_cbranch_scc1 ch_a_pro
    s_add_u32 s41, s41, 262144
    s_lshl_b32 s38, s15, 13
    s_add_u32 s38, s38, 214958080
    s_lshl_b32 s17, s13, 1
    s_and_b32 s18, s3, 1
    s_add_u32 s17, s17, s18
    s_lshl_b32 s17, s17, 1
    s_cmp_lt_u32 s3, 2
    s_cselect_b32 s56, 0xff, 0
    s_mov_b32 s57, s56
    s_lshr_b32 s18, s17, 1
    s_and_b32 s19, s17, 1
    s_lshl_b32 s20, s12, 14
    s_add_u32 s20, s20, 213909504
    s_lshl_b32 s36, s3, 12
    s_add_u32 s36, s36, s20
    s_lshl_b32 s37, s18, 8
    s_add_u32 s37, s37, s20
    s_lshl_b32 s20, s19, 5
    s_add_u32 s37, s37, s20
    s_lshr_b32 s39, s17, 3
    s_lshl_b32 s39, s39, 14
    s_and_b32 s20, s17, 7
    s_lshl_b32 s20, s20, 10
    s_add_u32 s39, s39, s20
    s_add_u32 s39, s39, 209715200
    s_lshl_b32 s30, s14, 22
    s_lshl_b32 s20, s34, 11
    s_add_u32 s30, s30, s20
    s_lshl_b32 s20, s3, 9
    s_add_u32 s30, s30, s20
    s_add_u32 s30, s30, 78643200
    s_lshl_b32 s55, s15, 13
    s_add_u32 s55, s55, 192937984
    s_mov_b32 s26, s38
    s_mov_b32 s54, s30
    s_mov_b32 s29, 2
    s_mov_b32 s58, 0
    s_mov_b32 s59, 0
    s_bfe_u32 s17, s34, 0x20001
    s_lshl_b32 s60, s14, 2
    s_add_u32 s60, s60, s17
    s_lshl_b32 s60, s60, 2
    s_add_u32 s60, s60, s3
    s_lshl_b32 s60, s60, 10
    s_and_b32 s17, s34, 1
    s_lshl_b32 s17, s17, 17
    s_add_u32 s60, s60, s17
    s_add_u32 s60, s60, 175898624
    s_mov_b32 s31, 786432
    v_and_b32 v20, 63, v0
    v_lshlrev_b32 v1, 4, v20
    v_mov_b32 v10, -1
    v_mov_b32 v11, -1
    v_lshrrev_b32 v21, 2, v20
    v_and_b32 v22, 3, v20
    v_lshlrev_b32 v21, 13, v21
    v_lshl_add_u32 v21, v22, 4, v21
    s_lshl_b32 s17, s3, 21
    s_lshl_b32 s18, s52, 6
    s_add_u32 s17, s17, s18
    s_lshl_b32 s19, s3, 15
    s_mov_b32 s10, 8388608
    s_mov_b32 s11, 131072
    v_lshrrev_b32 v24, 5, v20
    v_bfe_u32 v25, v20, 3, 1
    v_lshl_add_u32 v24, v24, 1, v25
    v_bfe_u32 v26, v20, 4, 1
    v_xor_b32 v26, v26, v25
    v_lshl_add_u32 v24, v24, 1, v26
    v_bfe_u32 v25, v20, 2, 1
    v_lshl_add_u32 v24, v24, 2, v25
    v_lshlrev_b32 v24, 6, v24
    v_lshl_add_u32 v24, v22, 3, v24
    v_add_u32 v24, s19, v24
    s_and_b32 s70, s13, 0
    s_lshl_b32 s72, s70, 20
    s_lshl_b32 s73, s70, 21
    s_lshl_b32 s70, s70, 13
    s_sub_u32 s71, s19, s70
    s_add_u32 s70, s19, s70
    s_load_dwordx2 s[8:9], s[0:1], 16
    s_add_u32 s20, s17, s72
    s_waitcnt lgkmcnt(0)
    s_add_u32 m0, s70, 0
    s_nop 0
    buffer_load_dwordx4 v21, s[8:11], s20 offen lds
    s_add_u32 s20, s20, 131072
    s_add_u32 m0, s70, 1024
    s_nop 0
    buffer_load_dwordx4 v21, s[8:11], s20 offen lds
    s_add_u32 s20, s20, 131072
    s_add_u32 m0, s70, 2048
    s_nop 0
    buffer_load_dwordx4 v21, s[8:11], s20 offen lds
    s_add_u32 s20, s20, 131072
    s_add_u32 m0, s70, 3072
    s_nop 0
    buffer_load_dwordx4 v21, s[8:11], s20 offen lds
    s_add_u32 s20, s20, 131072
    s_add_u32 m0, s70, 4096
    s_nop 0
    buffer_load_dwordx4 v21, s[8:11], s20 offen lds
    s_add_u32 s20, s20, 131072
    s_add_u32 m0, s70, 5120
    s_nop 0
    buffer_load_dwordx4 v21, s[8:11], s20 offen lds
    s_add_u32 s20, s20, 131072
    s_add_u32 m0, s70, 6144
    s_nop 0
    buffer_load_dwordx4 v21, s[8:11], s20 offen lds
    s_add_u32 s20, s20, 131072
    s_add_u32 m0, s70, 7168
    s_nop 0
    buffer_load_dwordx4 v21, s[8:11], s20 offen lds
    s_add_u32 s20, s20, 131072
    s_sub_u32 s20, s20, s73
    s_add_u32 m0, s71, 8192
    s_nop 0
    buffer_load_dwordx4 v21, s[8:11], s20 offen lds
    s_add_u32 s20, s20, 131072
    s_add_u32 m0, s71, 9216
    s_nop 0
    buffer_load_dwordx4 v21, s[8:11], s20 offen lds
    s_add_u32 s20, s20, 131072
    s_add_u32 m0, s71, 10240
    s_nop 0
    buffer_load_dwordx4 v21, s[8:11], s20 offen lds
    s_add_u32 s20, s20, 131072
    s_add_u32 m0, s71, 11264
    s_nop 0
    buffer_load_dwordx4 v21, s[8:11], s20 offen lds
    s_add_u32 s20, s20, 131072
    s_add_u32 m0, s71, 12288
    s_nop 0
    buffer_load_dwordx4 v21, s[8:11], s20 offen lds
    s_add_u32 s20, s20, 131072
    s_add_u32 m0, s71, 13312
    s_nop 0
    buffer_load_dwordx4 v21, s[8:11], s20 offen lds
    s_add_u32 s20, s20, 131072
    s_add_u32 m0, s71, 14336
    s_nop 0
    buffer_load_dwordx4 v21, s[8:11], s20 offen lds
    s_add_u32 s20, s20, 131072
    s_add_u32 m0, s71, 15360
    s_nop 0
    buffer_load_dwordx4 v21, s[8:11], s20 offen lds
    s_add_u32 s20, s20, 131072
    s_load_dwordx2 s[8:9], s[0:1], 24
    s_add_u32 s20, s17, s72
    s_waitcnt lgkmcnt(0)
    s_add_u32 m0, s70, 16384
    s_nop 0
    buffer_load_dwordx4 v21, s[8:11], s20 offen lds
    s_add_u32 s20, s20, 131072
    s_add_u32 m0, s70, 17408
    s_nop 0
    buffer_load_dwordx4 v21, s[8:11], s20 offen lds
    s_add_u32 s20, s20, 131072
    s_add_u32 m0, s70, 18432
    s_nop 0
    buffer_load_dwordx4 v21, s[8:11], s20 offen lds
    s_add_u32 s20, s20, 131072
    s_add_u32 m0, s70, 19456
    s_nop 0
    buffer_load_dwordx4 v21, s[8:11], s20 offen lds
    s_add_u32 s20, s20, 131072
    s_add_u32 m0, s70, 20480
    s_nop 0
    buffer_load_dwordx4 v21, s[8:11], s20 offen lds
    s_add_u32 s20, s20, 131072
    s_add_u32 m0, s70, 21504
    s_nop 0
    buffer_load_dwordx4 v21, s[8:11], s20 offen lds
    s_add_u32 s20, s20, 131072
    s_add_u32 m0, s70, 22528
    s_nop 0
    buffer_load_dwordx4 v21, s[8:11], s20 offen lds
    s_add_u32 s20, s20, 131072
    s_add_u32 m0, s70, 23552
    s_nop 0
    buffer_load_dwordx4 v21, s[8:11], s20 offen lds
    s_add_u32 s20, s20, 131072
    s_sub_u32 s20, s20, s73
    s_add_u32 m0, s71, 24576
    s_nop 0
    buffer_load_dwordx4 v21, s[8:11], s20 offen lds
    s_add_u32 s20, s20, 131072
    s_add_u32 m0, s71, 25600
    s_nop 0
    buffer_load_dwordx4 v21, s[8:11], s20 offen lds
    s_add_u32 s20, s20, 131072
    s_add_u32 m0, s71, 26624
    s_nop 0
    buffer_load_dwordx4 v21, s[8:11], s20 offen lds
    s_add_u32 s20, s20, 131072
    s_add_u32 m0, s71, 27648
    s_nop 0
    buffer_load_dwordx4 v21, s[8:11], s20 offen lds
    s_add_u32 s20, s20, 131072
    s_add_u32 m0, s71, 28672
    s_nop 0
    buffer_load_dwordx4 v21, s[8:11], s20 offen lds
    s_add_u32 s20, s20, 131072
    s_add_u32 m0, s71, 29696
    s_nop 0
    buffer_load_dwordx4 v21, s[8:11], s20 offen lds
    s_add_u32 s20, s20, 131072
    s_add_u32 m0, s71, 30720
    s_nop 0
    buffer_load_dwordx4 v21, s[8:11], s20 offen lds
    s_add_u32 s20, s20, 131072
    s_add_u32 m0, s71, 31744
    s_nop 0
    buffer_load_dwordx4 v21, s[8:11], s20 offen lds
    s_add_u32 s20, s20, 131072
    s_load_dwordx2 s[8:9], s[0:1], 32
    s_add_u32 s20, s17, s72
    s_waitcnt lgkmcnt(0)
    buffer_load_dwordx4 v[96:99], v21, s[8:11], s20 offen
    s_add_u32 s20, s20, 131072
    buffer_load_dwordx4 v[100:103], v21, s[8:11], s20 offen
    s_add_u32 s20, s20, 131072
    buffer_load_dwordx4 v[104:107], v21, s[8:11], s20 offen
    s_add_u32 s20, s20, 131072
    buffer_load_dwordx4 v[108:111], v21, s[8:11], s20 offen
    s_add_u32 s20, s20, 131072
    buffer_load_dwordx4 v[144:147], v21, s[8:11], s20 offen
    s_add_u32 s20, s20, 131072
    buffer_load_dwordx4 v[148:151], v21, s[8:11], s20 offen
    s_add_u32 s20, s20, 131072
    buffer_load_dwordx4 v[152:155], v21, s[8:11], s20 offen
    s_add_u32 s20, s20, 131072
    buffer_load_dwordx4 v[156:159], v21, s[8:11], s20 offen
    s_add_u32 s20, s20, 131072
    s_sub_u32 s20, s20, s73
    buffer_load_dwordx4 v[192:195], v21, s[8:11], s20 offen
    s_add_u32 s20, s20, 131072
    buffer_load_dwordx4 v[196:199], v21, s[8:11], s20 offen
    s_add_u32 s20, s20, 131072
    buffer_load_dwordx4 v[200:203], v21, s[8:11], s20 offen
    s_add_u32 s20, s20, 131072
    buffer_load_dwordx4 v[204:207], v21, s[8:11], s20 offen
    s_add_u32 s20, s20, 131072
    buffer_load_dwordx4 v[240:243], v21, s[8:11], s20 offen
    s_add_u32 s20, s20, 131072
    buffer_load_dwordx4 v[244:247], v21, s[8:11], s20 offen
    s_add_u32 s20, s20, 131072
    buffer_load_dwordx4 v[248:251], v21, s[8:11], s20 offen
    s_add_u32 s20, s20, 131072
    buffer_load_dwordx4 v[252:255], v21, s[8:11], s20 offen
    s_add_u32 s20, s20, 131072
    s_load_dwordx2 s[8:9], s[0:1], 8
    s_mov_b32 s10, 16384
    v_bfe_u32 v57, v20, 2, 2
    v_and_b32 v58, 1, v20
    v_lshl_add_u32 v57, v57, 1, v58
    v_lshlrev_b32 v57, 11, v57
    v_lshrrev_b32 v58, 4, v20
    v_lshl_add_u32 v57, v58, 5, v57
    v_bfe_u32 v58, v20, 1, 1
    v_lshl_add_u32 v57, v58, 4, v57
    v_lshl_add_u32 v59, v58, 3, v57
    v_xor_b32 v60, 8, v59
    s_lshl_b32 s20, s3, 9
    s_waitcnt lgkmcnt(0)
    buffer_load_dwordx2 v[32:33], v59, s[8:11], s20 offen offset:0
    buffer_load_dwordx2 v[34:35], v60, s[8:11], s20 offen offset:0
    buffer_load_dwordx2 v[36:37], v59, s[8:11], s20 offen offset:128
    buffer_load_dwordx2 v[38:39], v60, s[8:11], s20 offen offset:128
    buffer_load_dwordx2 v[40:41], v59, s[8:11], s20 offen offset:256
    buffer_load_dwordx2 v[42:43], v60, s[8:11], s20 offen offset:256
    buffer_load_dwordx2 v[44:45], v59, s[8:11], s20 offen offset:384
    buffer_load_dwordx2 v[46:47], v60, s[8:11], s20 offen offset:384
    s_barrier
    v_add_u32 v56, s70, v1
    v_add_u32 v26, s71, v1
    s_waitcnt vmcnt(40)
    ds_read_b64_tr_b16 v[64:65], v24 offset:0
    ds_read_b64_tr_b16 v[66:67], v24 offset:128
    ds_read_b64_tr_b16 v[68:69], v24 offset:2048
    ds_read_b64_tr_b16 v[70:71], v24 offset:2176
    ds_read_b64_tr_b16 v[72:73], v24 offset:32
    ds_read_b64_tr_b16 v[74:75], v24 offset:160
    ds_read_b64_tr_b16 v[76:77], v24 offset:2080
    ds_read_b64_tr_b16 v[78:79], v24 offset:2208
    s_waitcnt lgkmcnt(0)
    ds_read_b64_tr_b16 v[112:113], v24 offset:4096
    ds_read_b64_tr_b16 v[114:115], v24 offset:4224
    ds_read_b64_tr_b16 v[116:117], v24 offset:6144
    ds_read_b64_tr_b16 v[118:119], v24 offset:6272
    ds_read_b64_tr_b16 v[120:121], v24 offset:4128
    ds_read_b64_tr_b16 v[122:123], v24 offset:4256
    ds_read_b64_tr_b16 v[124:125], v24 offset:6176
    ds_read_b64_tr_b16 v[126:127], v24 offset:6304
    s_waitcnt lgkmcnt(0)
    ds_read_b64_tr_b16 v[160:161], v24 offset:8192
    ds_read_b64_tr_b16 v[162:163], v24 offset:8320
    ds_read_b64_tr_b16 v[164:165], v24 offset:10240
    ds_read_b64_tr_b16 v[166:167], v24 offset:10368
    ds_read_b64_tr_b16 v[168:169], v24 offset:8224
    ds_read_b64_tr_b16 v[170:171], v24 offset:8352
    ds_read_b64_tr_b16 v[172:173], v24 offset:10272
    ds_read_b64_tr_b16 v[174:175], v24 offset:10400
    s_waitcnt lgkmcnt(0)
    ds_read_b64_tr_b16 v[208:209], v24 offset:12288
    ds_read_b64_tr_b16 v[210:211], v24 offset:12416
    ds_read_b64_tr_b16 v[212:213], v24 offset:14336
    ds_read_b64_tr_b16 v[214:215], v24 offset:14464
    ds_read_b64_tr_b16 v[216:217], v24 offset:12320
    ds_read_b64_tr_b16 v[218:219], v24 offset:12448
    ds_read_b64_tr_b16 v[220:221], v24 offset:14368
    ds_read_b64_tr_b16 v[222:223], v24 offset:14496
    s_waitcnt lgkmcnt(0)
    s_waitcnt vmcnt(24)
    ds_read_b64_tr_b16 v[80:81], v24 offset:16384
    ds_read_b64_tr_b16 v[82:83], v24 offset:16512
    ds_read_b64_tr_b16 v[84:85], v24 offset:18432
    ds_read_b64_tr_b16 v[86:87], v24 offset:18560
    ds_read_b64_tr_b16 v[88:89], v24 offset:16416
    ds_read_b64_tr_b16 v[90:91], v24 offset:16544
    ds_read_b64_tr_b16 v[92:93], v24 offset:18464
    ds_read_b64_tr_b16 v[94:95], v24 offset:18592
    s_waitcnt lgkmcnt(0)
    ds_read_b64_tr_b16 v[128:129], v24 offset:20480
    ds_read_b64_tr_b16 v[130:131], v24 offset:20608
    ds_read_b64_tr_b16 v[132:133], v24 offset:22528
    ds_read_b64_tr_b16 v[134:135], v24 offset:22656
    ds_read_b64_tr_b16 v[136:137], v24 offset:20512
    ds_read_b64_tr_b16 v[138:139], v24 offset:20640
    ds_read_b64_tr_b16 v[140:141], v24 offset:22560
    ds_read_b64_tr_b16 v[142:143], v24 offset:22688
    s_waitcnt lgkmcnt(0)
    ds_read_b64_tr_b16 v[176:177], v24 offset:24576
    ds_read_b64_tr_b16 v[178:179], v24 offset:24704
    ds_read_b64_tr_b16 v[180:181], v24 offset:26624
    ds_read_b64_tr_b16 v[182:183], v24 offset:26752
    ds_read_b64_tr_b16 v[184:185], v24 offset:24608
    ds_read_b64_tr_b16 v[186:187], v24 offset:24736
    ds_read_b64_tr_b16 v[188:189], v24 offset:26656
    ds_read_b64_tr_b16 v[190:191], v24 offset:26784
    s_waitcnt lgkmcnt(0)
    ds_read_b64_tr_b16 v[224:225], v24 offset:28672
    ds_read_b64_tr_b16 v[226:227], v24 offset:28800
    ds_read_b64_tr_b16 v[228:229], v24 offset:30720
    ds_read_b64_tr_b16 v[230:231], v24 offset:30848
    ds_read_b64_tr_b16 v[232:233], v24 offset:28704
    ds_read_b64_tr_b16 v[234:235], v24 offset:28832
    ds_read_b64_tr_b16 v[236:237], v24 offset:30752
    ds_read_b64_tr_b16 v[238:239], v24 offset:30880
    s_waitcnt lgkmcnt(0)
    s_waitcnt vmcnt(8)
    ds_write_b128 v56, v[96:99] offset:0
    ds_write_b128 v56, v[100:103] offset:1024
    ds_write_b128 v56, v[104:107] offset:2048
    ds_write_b128 v56, v[108:111] offset:3072
    ds_write_b128 v56, v[144:147] offset:4096
    ds_write_b128 v56, v[148:151] offset:5120
    ds_write_b128 v56, v[152:155] offset:6144
    ds_write_b128 v56, v[156:159] offset:7168
    ds_write_b128 v26, v[192:195] offset:8192
    ds_write_b128 v26, v[196:199] offset:9216
    ds_write_b128 v26, v[200:203] offset:10240
    ds_write_b128 v26, v[204:207] offset:11264
    ds_write_b128 v26, v[240:243] offset:12288
    ds_write_b128 v26, v[244:247] offset:13312
    ds_write_b128 v26, v[248:251] offset:14336
    ds_write_b128 v26, v[252:255] offset:15360
    s_waitcnt lgkmcnt(0)
    ds_read_b64_tr_b16 v[96:97], v24 offset:0
    ds_read_b64_tr_b16 v[98:99], v24 offset:128
    ds_read_b64_tr_b16 v[100:101], v24 offset:2048
    ds_read_b64_tr_b16 v[102:103], v24 offset:2176
    ds_read_b64_tr_b16 v[104:105], v24 offset:32
    ds_read_b64_tr_b16 v[106:107], v24 offset:160
    ds_read_b64_tr_b16 v[108:109], v24 offset:2080
    ds_read_b64_tr_b16 v[110:111], v24 offset:2208
    s_waitcnt lgkmcnt(0)
    ds_read_b64_tr_b16 v[144:145], v24 offset:4096
    ds_read_b64_tr_b16 v[146:147], v24 offset:4224
    ds_read_b64_tr_b16 v[148:149], v24 offset:6144
    ds_read_b64_tr_b16 v[150:151], v24 offset:6272
    ds_read_b64_tr_b16 v[152:153], v24 offset:4128
    ds_read_b64_tr_b16 v[154:155], v24 offset:4256
    ds_read_b64_tr_b16 v[156:157], v24 offset:6176
    ds_read_b64_tr_b16 v[158:159], v24 offset:6304
    s_waitcnt lgkmcnt(0)
    ds_read_b64_tr_b16 v[192:193], v24 offset:8192
    ds_read_b64_tr_b16 v[194:195], v24 offset:8320
    ds_read_b64_tr_b16 v[196:197], v24 offset:10240
    ds_read_b64_tr_b16 v[198:199], v24 offset:10368
    ds_read_b64_tr_b16 v[200:201], v24 offset:8224
    ds_read_b64_tr_b16 v[202:203], v24 offset:8352
    ds_read_b64_tr_b16 v[204:205], v24 offset:10272
    ds_read_b64_tr_b16 v[206:207], v24 offset:10400
    s_waitcnt lgkmcnt(0)
    ds_read_b64_tr_b16 v[240:241], v24 offset:12288
    ds_read_b64_tr_b16 v[242:243], v24 offset:12416
    ds_read_b64_tr_b16 v[244:245], v24 offset:14336
    ds_read_b64_tr_b16 v[246:247], v24 offset:14464
    ds_read_b64_tr_b16 v[248:249], v24 offset:12320
    ds_read_b64_tr_b16 v[250:251], v24 offset:12448
    ds_read_b64_tr_b16 v[252:253], v24 offset:14368
    ds_read_b64_tr_b16 v[254:255], v24 offset:14496
    s_waitcnt lgkmcnt(0)
    v_mov_b32 v21, 0x44444444
    v_mov_b32 v22, 0xeeeeeeee
    v_and_b32 v23, 2, v20
    v_cmp_eq_u32 vcc, 0, v23
    s_nop 1
    v_cndmask_b32 v8, v22, v21, vcc
    v_bfe_u32 v21, v20, 2, 3
    v_lshrrev_b32 v22, 5, v20
    v_mul_u32_u24 v23, 160, v21
    v_mul_u32_u24 v24, 1280, v22
    v_add_u32 v23, v23, v24
    v_and_b32 v24, 3, v20
    v_lshl_add_u32 v27, v24, 4, v23
    v_lshrrev_b32 v23, 1, v21
    v_and_b32 v21, 1, v21
    v_lshl_add_u32 v21, v23, 2, v21
    v_xor_b32 v22, 1, v22
    v_lshl_add_u32 v21, v22, 1, v21
    v_bfe_u32 v22, v20, 1, 1
    v_lshl_add_u32 v21, v22, 4, v21
    v_xor_b32 v22, v20, v22
    v_and_b32 v22, 1, v22
    v_lshlrev_b32 v21, 4, v21
    v_lshl_add_u32 v25, v22, 3, v21
    v_lshrrev_b32 v21, 3, v20
    v_mul_u32_u24 v23, 160, v21
    v_and_b32 v24, 7, v20
    v_lshl_add_u32 v28, v24, 4, v23
    v_lshrrev_b32 v23, 1, v21
    v_and_b32 v21, 1, v21
    v_lshl_add_u32 v21, v23, 2, v21
    v_and_b32 v22, 1, v20
    v_lshl_add_u32 v21, v22, 1, v21
    v_bfe_u32 v22, v20, 2, 1
    v_lshl_add_u32 v21, v22, 4, v21
    v_bfe_u32 v22, v20, 1, 1
    v_lshlrev_b32 v21, 4, v21
    v_lshl_add_u32 v26, v22, 3, v21
    s_lshl_b32 s17, s53, 10
    s_lshl_b32 s18, s3, 9
    s_add_u32 s17, s17, s18
    s_lshl_b32 s18, s3, 6
    s_lshl_b32 s19, s53, 9
    s_add_u32 s19, s19, 4096
    s_cmp_ge_u32 s3, 2
    s_cselect_b32 s17, s19, s17
    s_cselect_b32 s18, 2560, s18
    s_cselect_b64 vcc, -1, 0
    v_cndmask_b32 v22, v25, v26, vcc
    v_cndmask_b32 v23, v27, v28, vcc
    v_add_u32 v2, s17, v22
    v_add_u32 v4, s18, v23
    v_lshrrev_b32 v21, 4, v20
    v_and_b32 v22, 15, v20
    v_mul_u32_u24 v23, 320, v21
    v_lshl_add_u32 v23, v22, 2, v23
    s_mul_i32 s17, s3, 3840
    v_add_u32 v3, s17, v23
    v_add_u32 v61, 1280, v3
    v_bfe_u32 v24, v20, 3, 1
    v_bfe_u32 v25, v20, 2, 1
    v_xor_b32 v25, v25, v24
    v_bfe_u32 v26, v20, 1, 1
    v_lshl_add_u32 v25, v26, 1, v25
    v_lshl_add_u32 v25, v24, 2, v25
    v_and_b32 v26, 1, v20
    v_lshl_add_u32 v25, v25, 1, v26
    v_sub_u32 v25, v25, v22
    v_lshl_add_u32 v25, v25, 2, v3
    v_add_u32 v62, 2560, v25
    v_lshlrev_b32 v23, 4, v22
    v_lshl_add_u32 v6, v21, 12, v23
    s_lshl_b32 s17, s3, 10
    s_add_u32 s17, s17, 32768
    v_add_u32 v6, s17, v6
    v_lshrrev_b32 v24, 1, v21
    v_lshl_add_u32 v23, v24, 15, v23
    v_and_b32 v24, 1, v21
    v_lshl_add_u32 v7, v24, 8, v23
    v_mov_b32 v58, 15872
    v_bfe_u32 v23, v20, 1, 2
    v_lshlrev_b32 v23, 6, v23
    v_and_b32 v25, 1, v20
    v_lshl_add_u32 v23, v25, 4, v23
    v_lshrrev_b32 v24, 5, v20
    v_lshl_add_u32 v5, v24, 5, v23
    v_and_b32 v23, 7, v20
    v_lshlrev_b32 v23, 7, v23
    v_bfe_u32 v24, v20, 3, 1
    v_lshl_add_u32 v23, v24, 17, v23
    v_lshrrev_b32 v24, 4, v20
    v_add_u32 v24, 1, v24
    v_cmp_le_u32 vcc, 3, v24
    s_nop 1
    v_cndmask_b32 v24, v24, 0, vcc
    v_lshl_add_u32 v23, v24, 24, v23
    s_lshl_b32 s17, s14, 14
    s_lshl_b32 s18, s34, 10
    s_add_u32 s17, s17, s18
    s_add_u32 s17, s17, 4194304
    v_add_u32 v0, s17, v23
    s_lshl_b32 s17, s3, 2
    s_add_u32 s17, s17, 15872
    v_mov_b32 v63, s17
    v_and_b32 v21, 15, v20
    v_and_b32 v22, 1, v21
    v_lshlrev_b32 v22, 4, v22
    v_mov_b32 v12, 0x3f80
    v_lshlrev_b32 v22, v22, v12
    v_lshrrev_b32 v21, 1, v21
    v_cmp_eq_u32 vcc, 0, v21
    s_nop 1
    v_cndmask_b32 v12, 0, v22, vcc
    v_cmp_eq_u32 vcc, 1, v21
    s_nop 1
    v_cndmask_b32 v13, 0, v22, vcc
    v_cmp_eq_u32 vcc, 2, v21
    s_nop 1
    v_cndmask_b32 v14, 0, v22, vcc
    v_cmp_eq_u32 vcc, 3, v21
    s_nop 1
    v_cndmask_b32 v15, 0, v22, vcc
    s_waitcnt vmcnt(0)
    v_mov_b32 v16, v32
    v_mov_b32 v17, v33
    v_mov_b32 v18, v34
    v_mov_b32 v19, v35
    v_mov_b32 v20, v36
    v_mov_b32 v21, v37
    v_mov_b32 v22, v38
    v_mov_b32 v23, v39
    v_mov_b32 v24, v40
    v_mov_b32 v25, v41
    v_mov_b32 v26, v42
    v_mov_b32 v27, v43
    v_mov_b32 v28, v44
    v_mov_b32 v29, v45
    v_mov_b32 v30, v46
    v_mov_b32 v31, v47
    v_mov_b32 v52, -1
    v_mov_b32 v53, -1
    v_mov_b32 v54, -1
    v_mov_b32 v55, -1
    s_add_u32 s17, s30, 851968
    buffer_store_dwordx4 v[52:55], v7, s[4:7], s17 offen sc1
    s_add_u32 s17, s30, 917504
    buffer_store_dwordx4 v[52:55], v7, s[4:7], s17 offen sc1
    s_add_u32 s17, s30, 983040
    buffer_store_dwordx4 v[52:55], v7, s[4:7], s17 offen sc1
    s_lshl_b32 s40, s40, 5
    s_barrier
    ds_write_b32 v63, v10
    ds_write_b32 v63, v10 offset:16
    ds_write_b32 v63, v10 offset:32
    ds_write_b32 v63, v10 offset:48
    v_mov_b32 v60, 12
    v_mov_b32 v56, 15968
    s_waitcnt lgkmcnt(0)
    s_barrier
    ds_read_b64 v[32:33], v56
    s_waitcnt lgkmcnt(0)
    v_cmp_ne_u32 vcc, s40, v32
    s_setprio 3
    v_readfirstlane_b32 s17, v33
    s_add_u32 s39, s39, s17
    s_cbranch_vccnz ch_p_slow
    v_mov_b32 v32, 0
    v_mov_b32 v33, 0
    v_mov_b32 v34, 0
    v_mov_b32 v35, 0
    v_mov_b32 v36, 0
    v_mov_b32 v37, 0
    v_mov_b32 v38, 0
    v_mov_b32 v39, 0
    v_mov_b32 v40, 0
    v_mov_b32 v41, 0
    v_mov_b32 v42, 0
    v_mov_b32 v43, 0
    v_mov_b32 v44, 0
    v_mov_b32 v45, 0
    v_mov_b32 v46, 0
    v_mov_b32 v47, 0
    v_mov_b32 v48, 0
    v_mov_b32 v49, 0
    v_mov_b32 v50, 0
    v_mov_b32 v51, 0
    v_mov_b32 v52, 0
    v_mov_b32 v53, 0
    v_mov_b32 v54, 0
    v_mov_b32 v55, 0
    v_mov_b32 v59, 0
    s_nop 1
    s_branch ploopL_19_nc
.p2align 6
    s_nop 0
    s_nop 0
    s_nop 0
    s_nop 0
    s_nop 0
    s_nop 0
    s_nop 0
    s_nop 0
    s_nop 0
    s_nop 0
    s_nop 0
ploopL_19:
    v_mov_b32 v32, 0
    v_mov_b32 v33, 0
    v_mov_b32 v34, 0
    v_mov_b32 v35, 0
    v_mov_b32 v36, 0
    v_mov_b32 v37, 0
    v_mov_b32 v38, 0
    v_mov_b32 v39, 0
    v_mov_b32 v40, 0
    v_mov_b32 v41, 0
    v_mov_b32 v42, 0
    v_mov_b32 v43, 0
    v_mov_b32 v44, 0
    v_mov_b32 v45, 0
    v_mov_b32 v46, 0
    v_mov_b32 v47, 0
    v_mov_b32 v48, 0
    v_mov_b32 v49, 0
    v_mov_b32 v50, 0
    v_mov_b32 v51, 0
    v_mov_b32 v52, 0
    v_mov_b32 v53, 0
    v_mov_b32 v54, 0
    v_mov_b32 v55, 0
    s_bitcmp1_b32 s29, 0
    s_cbranch_scc1 gate_20_ok
    s_add_u32 s21, s16, 1
    s_min_u32 s21, s21, 63
    s_cmp_ge_u32 s21, 16
    s_cselect_b32 s19, 12, 8
    s_and_b32 s32, s21, 4
    s_lshr_b32 s21, s21, 3
    s_lshl_b32 s21, s21, 8
    s_add_u32 s32, s32, s21
    s_add_u32 s32, s32, s35
gate_20:
    buffer_load_dword v9, off, s[4:7], s32 sc1
    s_waitcnt vmcnt(0)
    v_readfirstlane_b32 s21, v9
    s_cmp_ge_u32 s21, s19
    s_cbranch_scc1 gate_20_set
    s_sleep 8
    s_sub_u32 s22, s22, 1
    s_cbranch_scc0 gate_20
    s_mov_b32 s22, 0
gate_20_set:
    s_bitset1_b32 s29, 0
gate_20_ok:
    s_sleep 1
    buffer_load_dwordx4 v[16:19], v1, s[4:7], s23 offen offset:0 sc1
    buffer_load_dwordx4 v[20:23], v1, s[4:7], s23 offen offset:1024 sc1
    buffer_load_dwordx4 v[24:27], v1, s[4:7], s23 offen offset:2048 sc1
    buffer_load_dwordx4 v[28:31], v1, s[4:7], s23 offen offset:3072 sc1
    s_waitcnt vmcnt(3)
    v_cmp_eq_u32 vcc, -1, v16
    s_cbranch_vccnz ploopL_19_rm_0
ploopL_19_rm_0ok:
    v_smfmac_f32_16x16x64_bf16 v[32:35], v[16:19], v[64:71], v8
    v_smfmac_f32_16x16x64_bf16 v[36:39], v[16:19], v[72:79], v8
    s_waitcnt vmcnt(2)
    v_cmp_eq_u32 vcc, -1, v20
    v_smfmac_f32_16x16x64_bf16 v[40:43], v[16:19], v[80:87], v8
    v_smfmac_f32_16x16x64_bf16 v[44:47], v[16:19], v[88:95], v8
    v_smfmac_f32_16x16x64_bf16 v[48:51], v[16:19], v[96:103], v8
    v_smfmac_f32_16x16x64_bf16 v[52:55], v[16:19], v[104:111], v8
    s_cbranch_vccnz ploopL_19_rm_1
ploopL_19_rm_1ok:
    v_smfmac_f32_16x16x64_bf16 v[32:35], v[20:23], v[112:119], v8
    v_smfmac_f32_16x16x64_bf16 v[36:39], v[20:23], v[120:127], v8
    s_waitcnt vmcnt(1)
    v_cmp_eq_u32 vcc, -1, v24
    v_smfmac_f32_16x16x64_bf16 v[40:43], v[20:23], v[128:135], v8
    v_smfmac_f32_16x16x64_bf16 v[44:47], v[20:23], v[136:143], v8
    v_smfmac_f32_16x16x64_bf16 v[48:51], v[20:23], v[144:151], v8
    v_smfmac_f32_16x16x64_bf16 v[52:55], v[20:23], v[152:159], v8
    s_cbranch_vccnz ploopL_19_rm_2
ploopL_19_rm_2ok:
    v_smfmac_f32_16x16x64_bf16 v[32:35], v[24:27], v[160:167], v8
    v_smfmac_f32_16x16x64_bf16 v[36:39], v[24:27], v[168:175], v8
    s_waitcnt vmcnt(0)
    v_cmp_eq_u32 vcc, -1, v28
    v_smfmac_f32_16x16x64_bf16 v[40:43], v[24:27], v[176:183], v8
    v_smfmac_f32_16x16x64_bf16 v[44:47], v[24:27], v[184:191], v8
    v_smfmac_f32_16x16x64_bf16 v[48:51], v[24:27], v[192:199], v8
    v_smfmac_f32_16x16x64_bf16 v[52:55], v[24:27], v[200:207], v8
    s_cbranch_vccnz ploopL_19_rm_3
ploopL_19_rm_3ok:
    v_smfmac_f32_16x16x64_bf16 v[32:35], v[28:31], v[208:215], v8
    ds_write_b32 v63, v59 offset:32
    v_smfmac_f32_16x16x64_bf16 v[36:39], v[28:31], v[216:223], v8
    v_smfmac_f32_16x16x64_bf16 v[40:43], v[28:31], v[224:231], v8
    v_smfmac_f32_16x16x64_bf16 v[44:47], v[28:31], v[232:239], v8
    v_smfmac_f32_16x16x64_bf16 v[48:51], v[28:31], v[240:247], v8
    v_smfmac_f32_16x16x64_bf16 v[52:55], v[28:31], v[248:255], v8
    s_branch ploopL_19_mmd
ploopL_19_nc:
    v_smfmac_f32_16x16x64_bf16 v[32:35], v[16:19], v[64:71], v8
    v_smfmac_f32_16x16x64_bf16 v[36:39], v[16:19], v[72:79], v8
    v_smfmac_f32_16x16x64_bf16 v[40:43], v[16:19], v[80:87], v8
    v_smfmac_f32_16x16x64_bf16 v[44:47], v[16:19], v[88:95], v8
    v_smfmac_f32_16x16x64_bf16 v[48:51], v[16:19], v[96:103], v8
    v_smfmac_f32_16x16x64_bf16 v[52:55], v[16:19], v[104:111], v8
    v_smfmac_f32_16x16x64_bf16 v[32:35], v[20:23], v[112:119], v8
    v_smfmac_f32_16x16x64_bf16 v[36:39], v[20:23], v[120:127], v8
    v_smfmac_f32_16x16x64_bf16 v[40:43], v[20:23], v[128:135], v8
    v_smfmac_f32_16x16x64_bf16 v[44:47], v[20:23], v[136:143], v8
    v_smfmac_f32_16x16x64_bf16 v[48:51], v[20:23], v[144:151], v8
    v_smfmac_f32_16x16x64_bf16 v[52:55], v[20:23], v[152:159], v8
    v_smfmac_f32_16x16x64_bf16 v[32:35], v[24:27], v[160:167], v8
    v_smfmac_f32_16x16x64_bf16 v[36:39], v[24:27], v[168:175], v8
    v_smfmac_f32_16x16x64_bf16 v[40:43], v[24:27], v[176:183], v8
    v_smfmac_f32_16x16x64_bf16 v[44:47], v[24:27], v[184:191], v8
    v_smfmac_f32_16x16x64_bf16 v[48:51], v[24:27], v[192:199], v8
    v_smfmac_f32_16x16x64_bf16 v[52:55], v[24:27], v[200:207], v8
    v_smfmac_f32_16x16x64_bf16 v[32:35], v[28:31], v[208:215], v8
    ds_write_b32 v63, v59 offset:32
    v_smfmac_f32_16x16x64_bf16 v[36:39], v[28:31], v[216:223], v8
    v_smfmac_f32_16x16x64_bf16 v[40:43], v[28:31], v[224:231], v8
    v_smfmac_f32_16x16x64_bf16 v[44:47], v[28:31], v[232:239], v8
    v_smfmac_f32_16x16x64_bf16 v[48:51], v[28:31], v[240:247], v8
    v_smfmac_f32_16x16x64_bf16 v[52:55], v[28:31], v[248:255], v8
ploopL_19_mmd:
    s_cmp_eq_u32 s3, 3
    s_nop 1
    v_add_f32 v32, v32, v34
    v_add_f32 v33, v33, v35
    ds_write2_b32 v3, v32, v33 offset0:0 offset1:40
    v_add_f32 v36, v36, v38
    v_add_f32 v37, v37, v39
    ds_write2_b32 v3, v36, v37 offset0:16 offset1:56
    v_add_f32 v40, v40, v42
    v_add_f32 v41, v41, v43
    ds_write2_b32 v61, v40, v41 offset0:0 offset1:40
    v_add_f32 v44, v44, v46
    v_add_f32 v45, v45, v47
    ds_write2_b32 v61, v44, v45 offset0:16 offset1:56
    v_add_f32 v48, v48, v50
    v_add_f32 v49, v49, v51
    ds_write2_b32 v62, v48, v49 offset0:0 offset1:40
    v_add_f32 v52, v52, v54
    v_add_f32 v53, v53, v55
    ds_write2_b32 v62, v52, v53 offset0:16 offset1:56
    s_waitcnt lgkmcnt(0)
    s_barrier
    s_cbranch_scc1 ploopL_19_sk1
    ds_read_b128 v[32:35], v4 offset:0
    ds_read_b128 v[36:39], v4 offset:3840
    ds_read_b128 v[40:43], v4 offset:7680
    ds_read_b128 v[44:47], v4 offset:11520
    s_waitcnt lgkmcnt(2)
    v_add_f32 v32, v32, v36
    v_add_f32 v33, v33, v37
    v_add_f32 v34, v34, v38
    v_add_f32 v35, v35, v39
    s_waitcnt lgkmcnt(0)
    v_add_f32 v40, v40, v44
    v_add_f32 v41, v41, v45
    v_add_f32 v42, v42, v46
    v_add_f32 v43, v43, v47
    v_add_f32 v32, v32, v40
    v_add_f32 v33, v33, v41
    v_add_f32 v34, v34, v42
    v_add_f32 v35, v35, v43
    v_cvt_pk_bf16_f32 v56, v32, v33
    v_cvt_pk_bf16_f32 v57, v34, v35
    v_min_u32 v56, -2, v56
    buffer_store_dwordx2 v[56:57], v2, s[4:7], s26 offen
    s_add_u32 s27, s16, 2
    s_and_b32 s27, s27, 3
    s_lshl_b32 s27, s27, 18
    s_add_u32 s27, s27, s38
    buffer_store_dwordx2 v[10:11], v2, s[4:7], s27 offen
ploopL_19_sk1:
    s_setprio 0
    s_add_u32 s25, s16, 3
    s_and_b32 s25, s25, 3
    s_lshl_b32 s25, s25, 16
    s_add_u32 s25, s25, s37
    v_mov_b32 v44, -1
    v_mov_b32 v45, -1
    v_mov_b32 v46, -1
    v_mov_b32 v47, -1
    s_mov_b64 exec, s[56:57]
    buffer_store_dwordx4 v[44:47], v5, s[4:7], s25 offen
    s_mov_b64 exec, -1
    v_mov_b32_dpp v48, v12 row_ror:8 row_mask:0xf bank_mask:0xf
    v_mov_b32_dpp v49, v13 row_ror:8 row_mask:0xf bank_mask:0xf
    v_mov_b32_dpp v50, v14 row_ror:8 row_mask:0xf bank_mask:0xf
    v_mov_b32_dpp v51, v15 row_ror:8 row_mask:0xf bank_mask:0xf
    s_and_b32 s28, s16, 3
    s_lshl_b32 s28, s28, 18
    s_add_u32 s28, s28, s39
    s_add_u32 s24, s16, 1
    s_and_b32 s24, s24, 3
    s_lshl_b32 s24, s24, 16
    s_add_u32 s24, s24, s37
    s_add_u32 s23, s16, 1
    s_and_b32 s23, s23, 3
    s_lshl_b32 s23, s23, 16
    s_add_u32 s23, s23, s36
    s_add_u32 s26, s16, 1
    s_and_b32 s26, s26, 3
    s_lshl_b32 s26, s26, 18
    s_add_u32 s26, s26, s38
    s_cmp_eq_u32 s59, 0
    s_cbranch_scc1 ofl_21
    s_lshl_b32 s17, s3, 10
    v_add_u32 v39, s17, v1
    ds_read_b128 v[40:43], v39 offset:32768
ofl_21:
    s_cmp_ge_u32 s16, 16
    s_cbranch_scc1 ploopL_19_nx
    v_mov_b32 v40, v2
    v_mov_b32 v42, v56
    v_mov_b32 v43, v57
    s_cmp_lg_u32 s3, 2
    s_cbranch_scc1 ploopL_19_nx
    v_and_b32 v40, 0x60, v1
    v_lshlrev_b32 v40, 2, v40
    v_lshrrev_b32 v41, 3, v1
    v_and_b32 v41, 0x70, v41
    v_or_b32 v40, v40, v41
    v_bfe_u32 v41, v1, 4, 1
    v_lshl_or_b32 v40, v41, 3, v40
    s_lshl_b32 s17, s53, 9
    s_add_u32 s17, s17, 4096
    v_add_u32 v40, s17, v40
    s_mov_b32 vcc_lo, 0x55555555
    s_mov_b32 vcc_hi, 0x55555555
    v_cndmask_b32_dpp v42, v57, v56, vcc quad_perm:[1,0,3,2] row_mask:0xf bank_mask:0xf
    s_not_b64 vcc, vcc
    v_cndmask_b32_dpp v43, v56, v57, vcc quad_perm:[1,0,3,2] row_mask:0xf bank_mask:0xf
ploopL_19_nx:
    v_readfirstlane_b32 s21, v60
    s_lshr_b32 s29, s29, 1
    s_cmp_ge_u32 s21, s58
    s_cselect_b32 s21, 2, 0
    s_or_b32 s29, s29, s21
    s_cmp_eq_u32 s3, 3
    s_cselect_b32 s20, s21, 0
    s_add_u32 s21, s16, 4
    s_min_u32 s21, s21, 63
    s_cmp_ge_u32 s21, 16
    s_cselect_b32 s58, 12, 8
    s_and_b32 s33, s21, 4
    s_lshr_b32 s21, s21, 3
    s_lshl_b32 s21, s21, 8
    s_add_u32 s33, s33, s21
    s_add_u32 s33, s33, s35
    s_setprio 3
ploopL_19_fs:
    ds_read_b128 v[32:35], v58 offset:0
    s_waitcnt lgkmcnt(0)
    v_min3_i32 v32, v32, v33, v34
    v_min_i32 v32, v32, v35
    s_nop 0
    v_readfirstlane_b32 s18, v32
    s_cmp_ge_i32 s18, s16
    s_cbranch_scc1 ploopL_19_fsok
    s_sleep 1
    s_branch ploopL_19_fs
ploopL_19_fsok:
    s_setprio 1
    s_sleep 5
ploopL_19_nofd:
    s_cmp_eq_u32 s20, 0
    s_cbranch_scc1 ploopL_19_nt
    s_cmp_ge_u32 s16, 13
    s_cselect_b32 exec_hi, 0xffff, 0
    buffer_load_dword v60, v0, s[4:7], s31 offen sc1
    s_mov_b32 exec_hi, -1
ploopL_19_nt:
    s_cmp_eq_u32 s59, 0
    s_cbranch_scc1 ofl_22
    s_lshl_b32 s17, s16, 18
    s_add_u32 s17, s17, s60
    buffer_store_dwordx4 v[40:43], v1, s[4:7], s17 offen sc1
    s_mov_b32 s59, 0
ofl_22:
    s_lshr_b32 s17, s34, 3
    s_xor_b32 s17, s17, s16
    s_andn2_b32 s59, 1, s17
    s_cmp_ge_u32 s16, 16
    s_cselect_b32 s59, s59, 0
    s_cbranch_scc1 ploopL_19_nx2
    s_cmp_eq_u32 s3, 3
    s_cbranch_scc1 ploopL_19_nx2
    buffer_store_dwordx2 v[42:43], v40, s[4:7], s55 offen sc1
ploopL_19_nx2:
    s_add_u32 s55, s55, 262144
    s_barrier
    buffer_load_dword v60, off, s[4:7], s33 sc1
    s_add_u32 s16, s16, 1
    v_mov_b32 v59, s16
    s_add_u32 s41, s41, 262144
    s_add_u32 s31, s31, 262144
    s_setprio 3
    s_sleep 13
ploopL_19_pagain:
    buffer_load_dwordx4 v[16:19], v1, s[4:7], s28 offen offset:0 sc1
    buffer_load_dwordx4 v[20:23], v1, s[4:7], s28 offen offset:1024 sc1
    s_waitcnt vmcnt(1)
    v_mfma_f32_16x16x32_bf16 v[32:35], v[12:15], v[16:19], 0
    s_waitcnt vmcnt(0)
    v_mfma_f32_16x16x32_bf16 v[32:35], v[48:51], v[20:23], v[32:35]
    v_max_u32 v9, v16, v20
    v_cmp_eq_u32 vcc, -1, v9
    s_cbranch_vccnz ploopL_19_rp
ploopL_19_pgo:
    s_cmp_lt_u32 s16, 48
    s_nop 3
    v_add_f32_dpp v36, v32, v32 row_ror:8 row_mask:0xf bank_mask:0xf
    v_add_f32_dpp v37, v33, v33 row_ror:8 row_mask:0xf bank_mask:0xf
    v_add_f32_dpp v38, v34, v34 row_ror:8 row_mask:0xf bank_mask:0xf
    v_add_f32_dpp v39, v35, v35 row_ror:8 row_mask:0xf bank_mask:0xf
    v_cvt_pk_bf16_f32 v52, v36, v37
    v_cvt_pk_bf16_f32 v53, v38, v39
    s_nop 0
    v_permlane16_swap_b32 v52, v54
    v_permlane16_swap_b32 v53, v55
    s_mov_b64 exec, s[56:57]
    v_min_u32 v52, -2, v52
    buffer_store_dwordx4 v[52:55], v5, s[4:7], s24 offen
    s_mov_b64 exec, -1
    ds_write_b32 v63, v59 offset:16
    s_cbranch_scc1 ploopL_19
    s_branch ploopH_18
ploopL_19_rm_0:
    s_sub_u32 s22, s22, 1
    s_cbranch_scc1 ploopL_19_rm_0_g
    buffer_load_dwordx4 v[16:19], v1, s[4:7], s23 offen offset:0 sc1
    buffer_load_dwordx4 v[20:23], v1, s[4:7], s23 offen offset:1024 sc1
    buffer_load_dwordx4 v[24:27], v1, s[4:7], s23 offen offset:2048 sc1
    buffer_load_dwordx4 v[28:31], v1, s[4:7], s23 offen offset:3072 sc1
    s_waitcnt vmcnt(3)
    v_cmp_eq_u32 vcc, -1, v16
    s_cbranch_vccnz ploopL_19_rm_0
    s_branch ploopL_19_rm_0ok
ploopL_19_rm_0_g:
    s_mov_b32 s22, 0
    s_waitcnt vmcnt(0)
    s_branch ploopL_19_rm_0ok
ploopL_19_rm_1:
    s_sub_u32 s22, s22, 1
    s_cbranch_scc1 ploopL_19_rm_1_g
    buffer_load_dwordx4 v[20:23], v1, s[4:7], s23 offen offset:1024 sc1
    buffer_load_dwordx4 v[24:27], v1, s[4:7], s23 offen offset:2048 sc1
    buffer_load_dwordx4 v[28:31], v1, s[4:7], s23 offen offset:3072 sc1
    s_waitcnt vmcnt(2)
    v_cmp_eq_u32 vcc, -1, v20
    s_cbranch_vccnz ploopL_19_rm_1
    s_branch ploopL_19_rm_1ok
ploopL_19_rm_1_g:
    s_mov_b32 s22, 0
    s_waitcnt vmcnt(0)
    s_branch ploopL_19_rm_1ok
ploopL_19_rm_2:
    s_sub_u32 s22, s22, 1
    s_cbranch_scc1 ploopL_19_rm_2_g
    buffer_load_dwordx4 v[24:27], v1, s[4:7], s23 offen offset:2048 sc1
    buffer_load_dwordx4 v[28:31], v1, s[4:7], s23 offen offset:3072 sc1
    s_waitcnt vmcnt(1)
    v_cmp_eq_u32 vcc, -1, v24
    s_cbranch_vccnz ploopL_19_rm_2
    s_branch ploopL_19_rm_2ok
ploopL_19_rm_2_g:
    s_mov_b32 s22, 0
    s_waitcnt vmcnt(0)
    s_branch ploopL_19_rm_2ok
ploopL_19_rm_3:
    s_sub_u32 s22, s22, 1
    s_cbranch_scc1 ploopL_19_rm_3_g
    buffer_load_dwordx4 v[28:31], v1, s[4:7], s23 offen offset:3072 sc1
    s_waitcnt vmcnt(0)
    v_cmp_eq_u32 vcc, -1, v28
    s_cbranch_vccnz ploopL_19_rm_3
    s_branch ploopL_19_rm_3ok
ploopL_19_rm_3_g:
    s_mov_b32 s22, 0
    s_waitcnt vmcnt(0)
    s_branch ploopL_19_rm_3ok
ploopL_19_rp:
    s_sub_u32 s22, s22, 1
    s_cbranch_scc0 ploopL_19_pagain
    s_mov_b32 s22, 0
    s_branch ploopL_19_pgo
.p2align 6
    s_nop 0
    s_nop 0
    s_nop 0
    s_nop 0
    s_nop 0
    s_nop 0
    s_nop 0
    s_nop 0
    s_nop 0
    s_nop 0
    s_nop 0
ploopH_18:
    v_mov_b32 v32, 0
    v_mov_b32 v33, 0
    v_mov_b32 v34, 0
    v_mov_b32 v35, 0
    v_mov_b32 v36, 0
    v_mov_b32 v37, 0
    v_mov_b32 v38, 0
    v_mov_b32 v39, 0
    v_mov_b32 v40, 0
    v_mov_b32 v41, 0
    v_mov_b32 v42, 0
    v_mov_b32 v43, 0
    v_mov_b32 v44, 0
    v_mov_b32 v45, 0
    v_mov_b32 v46, 0
    v_mov_b32 v47, 0
    v_mov_b32 v48, 0
    v_mov_b32 v49, 0
    v_mov_b32 v50, 0
    v_mov_b32 v51, 0
    v_mov_b32 v52, 0
    v_mov_b32 v53, 0
    v_mov_b32 v54, 0
    v_mov_b32 v55, 0
    s_sleep 1
    buffer_load_dwordx4 v[16:19], v1, s[4:7], s23 offen offset:0 sc1
    buffer_load_dwordx4 v[20:23], v1, s[4:7], s23 offen offset:1024 sc1
    buffer_load_dwordx4 v[24:27], v1, s[4:7], s23 offen offset:2048 sc1
    buffer_load_dwordx4 v[28:31], v1, s[4:7], s23 offen offset:3072 sc1
    s_waitcnt vmcnt(3)
    v_cmp_eq_u32 vcc, -1, v16
    s_cbranch_vccnz ploopH_18_rm_0
ploopH_18_rm_0ok:
    v_smfmac_f32_16x16x64_bf16 v[32:35], v[16:19], v[64:71], v8
    v_smfmac_f32_16x16x64_bf16 v[36:39], v[16:19], v[72:79], v8
    s_waitcnt vmcnt(2)
    v_cmp_eq_u32 vcc, -1, v20
    v_smfmac_f32_16x16x64_bf16 v[40:43], v[16:19], v[80:87], v8
    v_smfmac_f32_16x16x64_bf16 v[44:47], v[16:19], v[88:95], v8
    v_smfmac_f32_16x16x64_bf16 v[48:51], v[16:19], v[96:103], v8
    v_smfmac_f32_16x16x64_bf16 v[52:55], v[16:19], v[104:111], v8
    s_cbranch_vccnz ploopH_18_rm_1
ploopH_18_rm_1ok:
    v_smfmac_f32_16x16x64_bf16 v[32:35], v[20:23], v[112:119], v8
    v_smfmac_f32_16x16x64_bf16 v[36:39], v[20:23], v[120:127], v8
    s_waitcnt vmcnt(1)
    v_cmp_eq_u32 vcc, -1, v24
    v_smfmac_f32_16x16x64_bf16 v[40:43], v[20:23], v[128:135], v8
    v_smfmac_f32_16x16x64_bf16 v[44:47], v[20:23], v[136:143], v8
    v_smfmac_f32_16x16x64_bf16 v[48:51], v[20:23], v[144:151], v8
    v_smfmac_f32_16x16x64_bf16 v[52:55], v[20:23], v[152:159], v8
    s_cbranch_vccnz ploopH_18_rm_2
ploopH_18_rm_2ok:
    v_smfmac_f32_16x16x64_bf16 v[32:35], v[24:27], v[160:167], v8
    v_smfmac_f32_16x16x64_bf16 v[36:39], v[24:27], v[168:175], v8
    s_waitcnt vmcnt(0)
    v_cmp_eq_u32 vcc, -1, v28
    v_smfmac_f32_16x16x64_bf16 v[40:43], v[24:27], v[176:183], v8
    v_smfmac_f32_16x16x64_bf16 v[44:47], v[24:27], v[184:191], v8
    v_smfmac_f32_16x16x64_bf16 v[48:51], v[24:27], v[192:199], v8
    v_smfmac_f32_16x16x64_bf16 v[52:55], v[24:27], v[200:207], v8
    s_cbranch_vccnz ploopH_18_rm_3
ploopH_18_rm_3ok:
    v_smfmac_f32_16x16x64_bf16 v[32:35], v[28:31], v[208:215], v8
    ds_write_b32 v63, v59 offset:32
    v_smfmac_f32_16x16x64_bf16 v[36:39], v[28:31], v[216:223], v8
    v_smfmac_f32_16x16x64_bf16 v[40:43], v[28:31], v[224:231], v8
    v_smfmac_f32_16x16x64_bf16 v[44:47], v[28:31], v[232:239], v8
    v_smfmac_f32_16x16x64_bf16 v[48:51], v[28:31], v[240:247], v8
    v_smfmac_f32_16x16x64_bf16 v[52:55], v[28:31], v[248:255], v8
    s_cmp_eq_u32 s3, 3
    s_nop 1
    v_add_f32 v32, v32, v34
    v_add_f32 v33, v33, v35
    ds_write2_b32 v3, v32, v33 offset0:0 offset1:40
    v_add_f32 v36, v36, v38
    v_add_f32 v37, v37, v39
    ds_write2_b32 v3, v36, v37 offset0:16 offset1:56
    v_add_f32 v40, v40, v42
    v_add_f32 v41, v41, v43
    ds_write2_b32 v61, v40, v41 offset0:0 offset1:40
    v_add_f32 v44, v44, v46
    v_add_f32 v45, v45, v47
    ds_write2_b32 v61, v44, v45 offset0:16 offset1:56
    v_add_f32 v48, v48, v50
    v_add_f32 v49, v49, v51
    ds_write2_b32 v62, v48, v49 offset0:0 offset1:40
    v_add_f32 v52, v52, v54
    v_add_f32 v53, v53, v55
    ds_write2_b32 v62, v52, v53 offset0:16 offset1:56
    s_waitcnt lgkmcnt(0)
    s_barrier
    s_cbranch_scc1 ploopH_18_sk1
    ds_read_b128 v[32:35], v4 offset:0
    ds_read_b128 v[36:39], v4 offset:3840
    ds_read_b128 v[40:43], v4 offset:7680
    ds_read_b128 v[44:47], v4 offset:11520
    s_waitcnt lgkmcnt(2)
    v_add_f32 v32, v32, v36
    v_add_f32 v33, v33, v37
    v_add_f32 v34, v34, v38
    v_add_f32 v35, v35, v39
    s_waitcnt lgkmcnt(0)
    v_add_f32 v40, v40, v44
    v_add_f32 v41, v41, v45
    v_add_f32 v42, v42, v46
    v_add_f32 v43, v43, v47
    v_add_f32 v32, v32, v40
    v_add_f32 v33, v33, v41
    v_add_f32 v34, v34, v42
    v_add_f32 v35, v35, v43
    v_cvt_pk_bf16_f32 v56, v32, v33
    v_cvt_pk_bf16_f32 v57, v34, v35
    v_min_u32 v56, -2, v56
    buffer_store_dwordx2 v[56:57], v2, s[4:7], s26 offen
    s_add_u32 s27, s16, 2
    s_and_b32 s27, s27, 3
    s_lshl_b32 s27, s27, 18
    s_add_u32 s27, s27, s38
    buffer_store_dwordx2 v[10:11], v2, s[4:7], s27 offen
ploopH_18_sk1:
    s_setprio 0
    s_add_u32 s25, s16, 3
    s_and_b32 s25, s25, 3
    s_lshl_b32 s25, s25, 16
    s_add_u32 s25, s25, s37
    v_mov_b32 v44, -1
    v_mov_b32 v45, -1
    v_mov_b32 v46, -1
    v_mov_b32 v47, -1
    s_mov_b64 exec, s[56:57]
    buffer_store_dwordx4 v[44:47], v5, s[4:7], s25 offen
    s_mov_b64 exec, -1
    v_mov_b32_dpp v48, v12 row_ror:8 row_mask:0xf bank_mask:0xf
    v_mov_b32_dpp v49, v13 row_ror:8 row_mask:0xf bank_mask:0xf
    v_mov_b32_dpp v50, v14 row_ror:8 row_mask:0xf bank_mask:0xf
    v_mov_b32_dpp v51, v15 row_ror:8 row_mask:0xf bank_mask:0xf
    s_and_b32 s28, s16, 3
    s_lshl_b32 s28, s28, 18
    s_add_u32 s28, s28, s39
    s_add_u32 s24, s16, 1
    s_and_b32 s24, s24, 3
    s_lshl_b32 s24, s24, 16
    s_add_u32 s24, s24, s37
    s_add_u32 s23, s16, 1
    s_and_b32 s23, s23, 3
    s_lshl_b32 s23, s23, 16
    s_add_u32 s23, s23, s36
    s_add_u32 s26, s16, 1
    s_and_b32 s26, s26, 3
    s_lshl_b32 s26, s26, 18
    s_add_u32 s26, s26, s38
    s_cmp_eq_u32 s59, 0
    s_cbranch_scc1 ofl_23
    s_lshl_b32 s17, s3, 10
    v_add_u32 v39, s17, v1
    ds_read_b128 v[40:43], v39 offset:32768
ofl_23:
    s_cmp_eq_u32 s16, 63
    s_cbranch_scc1 ploopH_18_tail
    s_cmp_eq_u32 s30, s54
    s_cbranch_scc1 pnoseg_24
    ds_read_b128 v[16:19], v6 offset:0
    ds_read_b128 v[20:23], v6 offset:256
    ds_read_b128 v[24:27], v6 offset:512
    ds_read_b128 v[28:31], v6 offset:768
    v_xor_b32 v6, 0x4000, v6
    s_waitcnt lgkmcnt(2)
    v_mfma_f32_16x16x32_bf16 v[40:43], v[12:15], v[16:19], 0
    v_mfma_f32_16x16x32_bf16 v[40:43], v[48:51], v[20:23], v[40:43]
    s_waitcnt lgkmcnt(0)
    v_mfma_f32_16x16x32_bf16 v[44:47], v[12:15], v[24:27], 0
    v_mfma_f32_16x16x32_bf16 v[44:47], v[48:51], v[28:31], v[44:47]
    s_nop 7
    v_cvt_pk_bf16_f32 v40, v40, v41
    v_cvt_pk_bf16_f32 v41, v42, v43
    v_cvt_pk_bf16_f32 v42, v44, v45
    v_cvt_pk_bf16_f32 v43, v46, v47
    s_nop 1
    v_permlane16_swap_b32 v40, v42
    v_permlane16_swap_b32 v41, v43
    s_nop 1
    v_min_u32 v40, -2, v40
pnoseg_24:
    s_bitcmp1_b32 s29, 0
    s_cbranch_scc1 gate_25_ok
    s_add_u32 s21, s16, 1
    s_min_u32 s21, s21, 63
    s_cmp_ge_u32 s21, 16
    s_cselect_b32 s19, 12, 8
    s_and_b32 s32, s21, 4
    s_lshr_b32 s21, s21, 3
    s_lshl_b32 s21, s21, 8
    s_add_u32 s32, s32, s21
    s_add_u32 s32, s32, s35
gate_25:
    buffer_load_dword v9, off, s[4:7], s32 sc1
    s_waitcnt vmcnt(0)
    v_readfirstlane_b32 s21, v9
    s_cmp_ge_u32 s21, s19
    s_cbranch_scc1 gate_25_set
    s_sleep 8
    s_sub_u32 s22, s22, 1
    s_cbranch_scc0 gate_25
    s_mov_b32 s22, 0
gate_25_set:
    s_bitset1_b32 s29, 0
gate_25_ok:
    v_readfirstlane_b32 s21, v60
    s_lshr_b32 s29, s29, 1
    s_cmp_ge_u32 s21, s58
    s_cselect_b32 s21, 2, 0
    s_or_b32 s29, s29, s21
    s_cmp_eq_u32 s3, 3
    s_cselect_b32 s20, s21, 0
    s_add_u32 s21, s16, 4
    s_min_u32 s21, s21, 63
    s_cmp_ge_u32 s21, 16
    s_cselect_b32 s58, 12, 8
    s_and_b32 s33, s21, 4
    s_lshr_b32 s21, s21, 3
    s_lshl_b32 s21, s21, 8
    s_add_u32 s33, s33, s21
    s_add_u32 s33, s33, s35
    s_setprio 3
ploopH_18_fs:
    ds_read_b128 v[32:35], v58 offset:0
    s_waitcnt lgkmcnt(0)
    v_min3_i32 v32, v32, v33, v34
    v_min_i32 v32, v32, v35
    s_nop 0
    v_readfirstlane_b32 s18, v32
    s_cmp_ge_i32 s18, s16
    s_cbranch_scc1 ploopH_18_fsok
    s_sleep 1
    s_branch ploopH_18_fs
ploopH_18_fsok:
    s_setprio 1
    s_add_u32 m0, s42, 8192
    s_add_u32 s17, s41, 37748736
    buffer_load_dwordx4 v1, s[4:7], s17 offen offset:0 sc1 lds
    buffer_load_dwordx4 v1, s[4:7], s17 offen offset:1024 sc1 lds
    buffer_load_dwordx4 v1, s[4:7], s17 offen offset:2048 sc1 lds
    buffer_load_dwordx4 v1, s[4:7], s17 offen offset:3072 sc1 lds
    s_add_u32 m0, s42, 12288
    s_add_u32 s17, s41, 37879808
    buffer_load_dwordx4 v1, s[4:7], s17 offen offset:0 sc1 lds
    buffer_load_dwordx4 v1, s[4:7], s17 offen offset:1024 sc1 lds
    buffer_load_dwordx4 v1, s[4:7], s17 offen offset:2048 sc1 lds
    buffer_load_dwordx4 v1, s[4:7], s17 offen offset:3072 sc1 lds
    s_cmp_eq_u32 s20, 0
    s_cbranch_scc1 ploopH_18_nt
    s_mov_b32 exec_hi, 0xffff
    buffer_load_dword v60, v0, s[4:7], s31 offen sc1
    s_mov_b32 exec_hi, -1
ploopH_18_nt:
    s_cmp_eq_u32 s59, 0
    s_cbranch_scc1 ofl_26
    s_lshl_b32 s17, s16, 18
    s_add_u32 s17, s17, s60
    buffer_store_dwordx4 v[40:43], v1, s[4:7], s17 offen sc1
    s_mov_b32 s59, 0
ofl_26:
    s_cmp_eq_u32 s30, s54
    s_cbranch_scc1 pnoseg_27
    buffer_store_dwordx4 v[40:43], v7, s[4:7], s30 offen sc1
    s_add_u32 s30, s30, 65536
pnoseg_27:
    s_barrier
    buffer_load_dword v60, off, s[4:7], s33 sc1
    s_add_u32 s16, s16, 1
    v_mov_b32 v59, s16
    s_add_u32 s41, s41, 262144
    s_add_u32 s31, s31, 262144
    s_mov_b32 s54, 0
    s_setprio 3
    s_sleep 13
ploopH_18_pagain:
    buffer_load_dwordx4 v[16:19], v1, s[4:7], s28 offen offset:0 sc1
    buffer_load_dwordx4 v[20:23], v1, s[4:7], s28 offen offset:1024 sc1
    s_waitcnt vmcnt(1)
    v_mfma_f32_16x16x32_bf16 v[32:35], v[12:15], v[16:19], 0
    s_waitcnt vmcnt(0)
    v_mfma_f32_16x16x32_bf16 v[32:35], v[48:51], v[20:23], v[32:35]
    v_max_u32 v9, v16, v20
    v_cmp_eq_u32 vcc, -1, v9
    s_cbranch_vccnz ploopH_18_rp
ploopH_18_pgo:
    s_nop 4
    v_add_f32_dpp v36, v32, v32 row_ror:8 row_mask:0xf bank_mask:0xf
    v_add_f32_dpp v37, v33, v33 row_ror:8 row_mask:0xf bank_mask:0xf
    v_add_f32_dpp v38, v34, v34 row_ror:8 row_mask:0xf bank_mask:0xf
    v_add_f32_dpp v39, v35, v35 row_ror:8 row_mask:0xf bank_mask:0xf
    v_cvt_pk_bf16_f32 v52, v36, v37
    v_cvt_pk_bf16_f32 v53, v38, v39
    s_nop 0
    v_permlane16_swap_b32 v52, v54
    v_permlane16_swap_b32 v53, v55
    s_mov_b64 exec, s[56:57]
    v_min_u32 v52, -2, v52
    buffer_store_dwordx4 v[52:55], v5, s[4:7], s24 offen
    s_mov_b64 exec, -1
    ds_write_b32 v63, v59 offset:16
    s_branch ploopH_18
ploopH_18_rm_0:
    s_sub_u32 s22, s22, 1
    s_cbranch_scc1 ploopH_18_rm_0_g
    buffer_load_dwordx4 v[16:19], v1, s[4:7], s23 offen offset:0 sc1
    buffer_load_dwordx4 v[20:23], v1, s[4:7], s23 offen offset:1024 sc1
    buffer_load_dwordx4 v[24:27], v1, s[4:7], s23 offen offset:2048 sc1
    buffer_load_dwordx4 v[28:31], v1, s[4:7], s23 offen offset:3072 sc1
    s_waitcnt vmcnt(3)
    v_cmp_eq_u32 vcc, -1, v16
    s_cbranch_vccnz ploopH_18_rm_0
    s_branch ploopH_18_rm_0ok
ploopH_18_rm_0_g:
    s_mov_b32 s22, 0
    s_waitcnt vmcnt(0)
    s_branch ploopH_18_rm_0ok
ploopH_18_rm_1:
    s_sub_u32 s22, s22, 1
    s_cbranch_scc1 ploopH_18_rm_1_g
    buffer_load_dwordx4 v[20:23], v1, s[4:7], s23 offen offset:1024 sc1
    buffer_load_dwordx4 v[24:27], v1, s[4:7], s23 offen offset:2048 sc1
    buffer_load_dwordx4 v[28:31], v1, s[4:7], s23 offen offset:3072 sc1
    s_waitcnt vmcnt(2)
    v_cmp_eq_u32 vcc, -1, v20
    s_cbranch_vccnz ploopH_18_rm_1
    s_branch ploopH_18_rm_1ok
ploopH_18_rm_1_g:
    s_mov_b32 s22, 0
    s_waitcnt vmcnt(0)
    s_branch ploopH_18_rm_1ok
ploopH_18_rm_2:
    s_sub_u32 s22, s22, 1
    s_cbranch_scc1 ploopH_18_rm_2_g
    buffer_load_dwordx4 v[24:27], v1, s[4:7], s23 offen offset:2048 sc1
    buffer_load_dwordx4 v[28:31], v1, s[4:7], s23 offen offset:3072 sc1
    s_waitcnt vmcnt(1)
    v_cmp_eq_u32 vcc, -1, v24
    s_cbranch_vccnz ploopH_18_rm_2
    s_branch ploopH_18_rm_2ok
ploopH_18_rm_2_g:
    s_mov_b32 s22, 0
    s_waitcnt vmcnt(0)
    s_branch ploopH_18_rm_2ok
ploopH_18_rm_3:
    s_sub_u32 s22, s22, 1
    s_cbranch_scc1 ploopH_18_rm_3_g
    buffer_load_dwordx4 v[28:31], v1, s[4:7], s23 offen offset:3072 sc1
    s_waitcnt vmcnt(0)
    v_cmp_eq_u32 vcc, -1, v28
    s_cbranch_vccnz ploopH_18_rm_3
    s_branch ploopH_18_rm_3ok
ploopH_18_rm_3_g:
    s_mov_b32 s22, 0
    s_waitcnt vmcnt(0)
    s_branch ploopH_18_rm_3ok
ploopH_18_rp:
    s_sub_u32 s22, s22, 1
    s_cbranch_scc0 ploopH_18_pagain
    s_mov_b32 s22, 0
    s_branch ploopH_18_pgo
ploopH_18_tail:
    ds_read_b128 v[16:19], v6 offset:0
    ds_read_b128 v[20:23], v6 offset:256
    ds_read_b128 v[24:27], v6 offset:512
    ds_read_b128 v[28:31], v6 offset:768
    v_xor_b32 v6, 0x4000, v6
    s_waitcnt lgkmcnt(2)
    v_mfma_f32_16x16x32_bf16 v[40:43], v[12:15], v[16:19], 0
    v_mfma_f32_16x16x32_bf16 v[40:43], v[48:51], v[20:23], v[40:43]
    s_waitcnt lgkmcnt(0)
    v_mfma_f32_16x16x32_bf16 v[44:47], v[12:15], v[24:27], 0
    v_mfma_f32_16x16x32_bf16 v[44:47], v[48:51], v[28:31], v[44:47]
    s_nop 7
    v_cvt_pk_bf16_f32 v40, v40, v41
    v_cvt_pk_bf16_f32 v41, v42, v43
    v_cvt_pk_bf16_f32 v42, v44, v45
    v_cvt_pk_bf16_f32 v43, v46, v47
    s_nop 1
    v_permlane16_swap_b32 v40, v42
    v_permlane16_swap_b32 v41, v43
    s_nop 1
    v_min_u32 v40, -2, v40
    buffer_store_dwordx4 v[40:43], v7, s[4:7], s30 offen sc1
    s_add_u32 s30, s30, 65536
    s_barrier
    ds_read_b128 v[16:19], v6 offset:0
    ds_read_b128 v[20:23], v6 offset:256
    ds_read_b128 v[24:27], v6 offset:512
    ds_read_b128 v[28:31], v6 offset:768
    v_xor_b32 v6, 0x4000, v6
    s_waitcnt lgkmcnt(2)
    v_mfma_f32_16x16x32_bf16 v[40:43], v[12:15], v[16:19], 0
    v_mfma_f32_16x16x32_bf16 v[40:43], v[48:51], v[20:23], v[40:43]
    s_waitcnt lgkmcnt(0)
    v_mfma_f32_16x16x32_bf16 v[44:47], v[12:15], v[24:27], 0
    v_mfma_f32_16x16x32_bf16 v[44:47], v[48:51], v[28:31], v[44:47]
    s_nop 7
    v_cvt_pk_bf16_f32 v40, v40, v41
    v_cvt_pk_bf16_f32 v41, v42, v43
    v_cvt_pk_bf16_f32 v42, v44, v45
    v_cvt_pk_bf16_f32 v43, v46, v47
    s_nop 1
    v_permlane16_swap_b32 v40, v42
    v_permlane16_swap_b32 v41, v43
    s_nop 1
    v_min_u32 v40, -2, v40
    buffer_store_dwordx4 v[40:43], v7, s[4:7], s30 offen sc1
    s_add_u32 s30, s30, 65536
    s_branch k_end
ch_p_slow:
    v_mov_b32 v32, 0
    v_mov_b32 v33, 0
    v_mov_b32 v34, 0
    v_mov_b32 v35, 0
    v_mov_b32 v36, 0
    v_mov_b32 v37, 0
    v_mov_b32 v38, 0
    v_mov_b32 v39, 0
    v_mov_b32 v40, 0
    v_mov_b32 v41, 0
    v_mov_b32 v42, 0
    v_mov_b32 v43, 0
    v_mov_b32 v44, 0
    v_mov_b32 v45, 0
    v_mov_b32 v46, 0
    v_mov_b32 v47, 0
    v_mov_b32 v48, 0
    v_mov_b32 v49, 0
    v_mov_b32 v50, 0
    v_mov_b32 v51, 0
    v_mov_b32 v52, 0
    v_mov_b32 v53, 0
    v_mov_b32 v54, 0
    v_mov_b32 v55, 0
    v_mov_b32 v59, 0
    s_nop 1
    s_branch ploopL_29_nc
.p2align 6
    s_nop 0
    s_nop 0
    s_nop 0
    s_nop 0
    s_nop 0
    s_nop 0
    s_nop 0
    s_nop 0
    s_nop 0
    s_nop 0
    s_nop 0
ploopL_29:
    v_mov_b32 v32, 0
    v_mov_b32 v33, 0
    v_mov_b32 v34, 0
    v_mov_b32 v35, 0
    v_mov_b32 v36, 0
    v_mov_b32 v37, 0
    v_mov_b32 v38, 0
    v_mov_b32 v39, 0
    v_mov_b32 v40, 0
    v_mov_b32 v41, 0
    v_mov_b32 v42, 0
    v_mov_b32 v43, 0
    v_mov_b32 v44, 0
    v_mov_b32 v45, 0
    v_mov_b32 v46, 0
    v_mov_b32 v47, 0
    v_mov_b32 v48, 0
    v_mov_b32 v49, 0
    v_mov_b32 v50, 0
    v_mov_b32 v51, 0
    v_mov_b32 v52, 0
    v_mov_b32 v53, 0
    v_mov_b32 v54, 0
    v_mov_b32 v55, 0
    s_bitcmp1_b32 s29, 0
    s_cbranch_scc1 gate_30_ok
    s_add_u32 s21, s16, 1
    s_min_u32 s21, s21, 63
    s_cmp_ge_u32 s21, 16
    s_cselect_b32 s19, 12, 8
    s_and_b32 s32, s21, 4
    s_lshr_b32 s21, s21, 3
    s_lshl_b32 s21, s21, 8
    s_add_u32 s32, s32, s21
    s_add_u32 s32, s32, s35
gate_30:
    buffer_load_dword v9, off, s[4:7], s32 sc1
    s_waitcnt vmcnt(0)
    v_readfirstlane_b32 s21, v9
    s_cmp_ge_u32 s21, s19
    s_cbranch_scc1 gate_30_set
    s_sleep 8
    s_sub_u32 s22, s22, 1
    s_cbranch_scc0 gate_30
    s_mov_b32 s22, 0
gate_30_set:
    s_bitset1_b32 s29, 0
gate_30_ok:
    s_sleep 1
    buffer_load_dwordx4 v[16:19], v1, s[4:7], s23 offen offset:0 sc1
    buffer_load_dwordx4 v[20:23], v1, s[4:7], s23 offen offset:1024 sc1
    buffer_load_dwordx4 v[24:27], v1, s[4:7], s23 offen offset:2048 sc1
    buffer_load_dwordx4 v[28:31], v1, s[4:7], s23 offen offset:3072 sc1
    s_waitcnt vmcnt(3)
    v_cmp_eq_u32 vcc, -1, v16
    s_cbranch_vccnz ploopL_29_rm_0
ploopL_29_rm_0ok:
    v_smfmac_f32_16x16x64_bf16 v[32:35], v[16:19], v[64:71], v8
    v_smfmac_f32_16x16x64_bf16 v[36:39], v[16:19], v[72:79], v8
    s_waitcnt vmcnt(2)
    v_cmp_eq_u32 vcc, -1, v20
    v_smfmac_f32_16x16x64_bf16 v[40:43], v[16:19], v[80:87], v8
    v_smfmac_f32_16x16x64_bf16 v[44:47], v[16:19], v[88:95], v8
    v_smfmac_f32_16x16x64_bf16 v[48:51], v[16:19], v[96:103], v8
    v_smfmac_f32_16x16x64_bf16 v[52:55], v[16:19], v[104:111], v8
    s_cbranch_vccnz ploopL_29_rm_1
ploopL_29_rm_1ok:
    v_smfmac_f32_16x16x64_bf16 v[32:35], v[20:23], v[112:119], v8
    v_smfmac_f32_16x16x64_bf16 v[36:39], v[20:23], v[120:127], v8
    s_waitcnt vmcnt(1)
    v_cmp_eq_u32 vcc, -1, v24
    v_smfmac_f32_16x16x64_bf16 v[40:43], v[20:23], v[128:135], v8
    v_smfmac_f32_16x16x64_bf16 v[44:47], v[20:23], v[136:143], v8
    v_smfmac_f32_16x16x64_bf16 v[48:51], v[20:23], v[144:151], v8
    v_smfmac_f32_16x16x64_bf16 v[52:55], v[20:23], v[152:159], v8
    s_cbranch_vccnz ploopL_29_rm_2
ploopL_29_rm_2ok:
    v_smfmac_f32_16x16x64_bf16 v[32:35], v[24:27], v[160:167], v8
    v_smfmac_f32_16x16x64_bf16 v[36:39], v[24:27], v[168:175], v8
    s_waitcnt vmcnt(0)
    v_cmp_eq_u32 vcc, -1, v28
    v_smfmac_f32_16x16x64_bf16 v[40:43], v[24:27], v[176:183], v8
    v_smfmac_f32_16x16x64_bf16 v[44:47], v[24:27], v[184:191], v8
    v_smfmac_f32_16x16x64_bf16 v[48:51], v[24:27], v[192:199], v8
    v_smfmac_f32_16x16x64_bf16 v[52:55], v[24:27], v[200:207], v8
    s_cbranch_vccnz ploopL_29_rm_3
ploopL_29_rm_3ok:
    v_smfmac_f32_16x16x64_bf16 v[32:35], v[28:31], v[208:215], v8
    ds_write_b32 v63, v59 offset:32
    v_smfmac_f32_16x16x64_bf16 v[36:39], v[28:31], v[216:223], v8
    v_smfmac_f32_16x16x64_bf16 v[40:43], v[28:31], v[224:231], v8
    v_smfmac_f32_16x16x64_bf16 v[44:47], v[28:31], v[232:239], v8
    v_smfmac_f32_16x16x64_bf16 v[48:51], v[28:31], v[240:247], v8
    v_smfmac_f32_16x16x64_bf16 v[52:55], v[28:31], v[248:255], v8
    s_branch ploopL_29_mmd
ploopL_29_nc:
    v_smfmac_f32_16x16x64_bf16 v[32:35], v[16:19], v[64:71], v8
    v_smfmac_f32_16x16x64_bf16 v[36:39], v[16:19], v[72:79], v8
    v_smfmac_f32_16x16x64_bf16 v[40:43], v[16:19], v[80:87], v8
    v_smfmac_f32_16x16x64_bf16 v[44:47], v[16:19], v[88:95], v8
    v_smfmac_f32_16x16x64_bf16 v[48:51], v[16:19], v[96:103], v8
    v_smfmac_f32_16x16x64_bf16 v[52:55], v[16:19], v[104:111], v8
    v_smfmac_f32_16x16x64_bf16 v[32:35], v[20:23], v[112:119], v8
    v_smfmac_f32_16x16x64_bf16 v[36:39], v[20:23], v[120:127], v8
    v_smfmac_f32_16x16x64_bf16 v[40:43], v[20:23], v[128:135], v8
    v_smfmac_f32_16x16x64_bf16 v[44:47], v[20:23], v[136:143], v8
    v_smfmac_f32_16x16x64_bf16 v[48:51], v[20:23], v[144:151], v8
    v_smfmac_f32_16x16x64_bf16 v[52:55], v[20:23], v[152:159], v8
    v_smfmac_f32_16x16x64_bf16 v[32:35], v[24:27], v[160:167], v8
    v_smfmac_f32_16x16x64_bf16 v[36:39], v[24:27], v[168:175], v8
    v_smfmac_f32_16x16x64_bf16 v[40:43], v[24:27], v[176:183], v8
    v_smfmac_f32_16x16x64_bf16 v[44:47], v[24:27], v[184:191], v8
    v_smfmac_f32_16x16x64_bf16 v[48:51], v[24:27], v[192:199], v8
    v_smfmac_f32_16x16x64_bf16 v[52:55], v[24:27], v[200:207], v8
    v_smfmac_f32_16x16x64_bf16 v[32:35], v[28:31], v[208:215], v8
    ds_write_b32 v63, v59 offset:32
    v_smfmac_f32_16x16x64_bf16 v[36:39], v[28:31], v[216:223], v8
    v_smfmac_f32_16x16x64_bf16 v[40:43], v[28:31], v[224:231], v8
    v_smfmac_f32_16x16x64_bf16 v[44:47], v[28:31], v[232:239], v8
    v_smfmac_f32_16x16x64_bf16 v[48:51], v[28:31], v[240:247], v8
    v_smfmac_f32_16x16x64_bf16 v[52:55], v[28:31], v[248:255], v8
ploopL_29_mmd:
    s_cmp_eq_u32 s3, 3
    s_nop 1
    v_add_f32 v32, v32, v34
    v_add_f32 v33, v33, v35
    ds_write2_b32 v3, v32, v33 offset0:0 offset1:40
    v_add_f32 v36, v36, v38
    v_add_f32 v37, v37, v39
    ds_write2_b32 v3, v36, v37 offset0:16 offset1:56
    v_add_f32 v40, v40, v42
    v_add_f32 v41, v41, v43
    ds_write2_b32 v61, v40, v41 offset0:0 offset1:40
    v_add_f32 v44, v44, v46
    v_add_f32 v45, v45, v47
    ds_write2_b32 v61, v44, v45 offset0:16 offset1:56
    v_add_f32 v48, v48, v50
    v_add_f32 v49, v49, v51
    ds_write2_b32 v62, v48, v49 offset0:0 offset1:40
    v_add_f32 v52, v52, v54
    v_add_f32 v53, v53, v55
    ds_write2_b32 v62, v52, v53 offset0:16 offset1:56
    s_waitcnt lgkmcnt(0)
    s_barrier
    s_cbranch_scc1 ploopL_29_sk1
    ds_read_b128 v[32:35], v4 offset:0
    ds_read_b128 v[36:39], v4 offset:3840
    ds_read_b128 v[40:43], v4 offset:7680
    ds_read_b128 v[44:47], v4 offset:11520
    s_waitcnt lgkmcnt(2)
    v_add_f32 v32, v32, v36
    v_add_f32 v33, v33, v37
    v_add_f32 v34, v34, v38
    v_add_f32 v35, v35, v39
    s_waitcnt lgkmcnt(0)
    v_add_f32 v40, v40, v44
    v_add_f32 v41, v41, v45
    v_add_f32 v42, v42, v46
    v_add_f32 v43, v43, v47
    v_add_f32 v32, v32, v40
    v_add_f32 v33, v33, v41
    v_add_f32 v34, v34, v42
    v_add_f32 v35, v35, v43
    v_cvt_pk_bf16_f32 v56, v32, v33
    v_cvt_pk_bf16_f32 v57, v34, v35
    v_min_u32 v56, -2, v56
    buffer_store_dwordx2 v[56:57], v2, s[4:7], s26 offen sc1
    s_add_u32 s27, s16, 2
    s_and_b32 s27, s27, 3
    s_lshl_b32 s27, s27, 18
    s_add_u32 s27, s27, s38
    buffer_store_dwordx2 v[10:11], v2, s[4:7], s27 offen sc1
ploopL_29_sk1:
    s_setprio 0
    s_add_u32 s25, s16, 3
    s_and_b32 s25, s25, 3
    s_lshl_b32 s25, s25, 16
    s_add_u32 s25, s25, s37
    v_mov_b32 v44, -1
    v_mov_b32 v45, -1
    v_mov_b32 v46, -1
    v_mov_b32 v47, -1
    s_mov_b64 exec, s[56:57]
    buffer_store_dwordx4 v[44:47], v5, s[4:7], s25 offen sc1
    s_mov_b64 exec, -1
    v_mov_b32_dpp v48, v12 row_ror:8 row_mask:0xf bank_mask:0xf
    v_mov_b32_dpp v49, v13 row_ror:8 row_mask:0xf bank_mask:0xf
    v_mov_b32_dpp v50, v14 row_ror:8 row_mask:0xf bank_mask:0xf
    v_mov_b32_dpp v51, v15 row_ror:8 row_mask:0xf bank_mask:0xf
    s_and_b32 s28, s16, 3
    s_lshl_b32 s28, s28, 18
    s_add_u32 s28, s28, s39
    s_add_u32 s24, s16, 1
    s_and_b32 s24, s24, 3
    s_lshl_b32 s24, s24, 16
    s_add_u32 s24, s24, s37
    s_add_u32 s23, s16, 1
    s_and_b32 s23, s23, 3
    s_lshl_b32 s23, s23, 16
    s_add_u32 s23, s23, s36
    s_add_u32 s26, s16, 1
    s_and_b32 s26, s26, 3
    s_lshl_b32 s26, s26, 18
    s_add_u32 s26, s26, s38
    s_cmp_eq_u32 s59, 0
    s_cbranch_scc1 ofl_31
    s_lshl_b32 s17, s3, 10
    v_add_u32 v39, s17, v1
    ds_read_b128 v[40:43], v39 offset:32768
ofl_31:
    s_cmp_ge_u32 s16, 16
    s_cbranch_scc1 ploopL_29_nx
    v_mov_b32 v40, v2
    v_mov_b32 v42, v56
    v_mov_b32 v43, v57
    s_cmp_lg_u32 s3, 2
    s_cbranch_scc1 ploopL_29_nx
    v_and_b32 v40, 0x60, v1
    v_lshlrev_b32 v40, 2, v40
    v_lshrrev_b32 v41, 3, v1
    v_and_b32 v41, 0x70, v41
    v_or_b32 v40, v40, v41
    v_bfe_u32 v41, v1, 4, 1
    v_lshl_or_b32 v40, v41, 3, v40
    s_lshl_b32 s17, s53, 9
    s_add_u32 s17, s17, 4096
    v_add_u32 v40, s17, v40
    s_mov_b32 vcc_lo, 0x55555555
    s_mov_b32 vcc_hi, 0x55555555
    v_cndmask_b32_dpp v42, v57, v56, vcc quad_perm:[1,0,3,2] row_mask:0xf bank_mask:0xf
    s_not_b64 vcc, vcc
    v_cndmask_b32_dpp v43, v56, v57, vcc quad_perm:[1,0,3,2] row_mask:0xf bank_mask:0xf
ploopL_29_nx:
    v_readfirstlane_b32 s21, v60
    s_lshr_b32 s29, s29, 1
    s_cmp_ge_u32 s21, s58
    s_cselect_b32 s21, 2, 0
    s_or_b32 s29, s29, s21
    s_cmp_eq_u32 s3, 3
    s_cselect_b32 s20, s21, 0
    s_add_u32 s21, s16, 4
    s_min_u32 s21, s21, 63
    s_cmp_ge_u32 s21, 16
    s_cselect_b32 s58, 12, 8
    s_and_b32 s33, s21, 4
    s_lshr_b32 s21, s21, 3
    s_lshl_b32 s21, s21, 8
    s_add_u32 s33, s33, s21
    s_add_u32 s33, s33, s35
    s_setprio 3
ploopL_29_fs:
    ds_read_b128 v[32:35], v58 offset:0
    s_waitcnt lgkmcnt(0)
    v_min3_i32 v32, v32, v33, v34
    v_min_i32 v32, v32, v35
    s_nop 0
    v_readfirstlane_b32 s18, v32
    s_cmp_ge_i32 s18, s16
    s_cbranch_scc1 ploopL_29_fsok
    s_sleep 1
    s_branch ploopL_29_fs
ploopL_29_fsok:
    s_setprio 1
    s_sleep 5
ploopL_29_nofd:
    s_cmp_eq_u32 s20, 0
    s_cbranch_scc1 ploopL_29_nt
    s_cmp_ge_u32 s16, 13
    s_cselect_b32 exec_hi, 0xffff, 0
    buffer_load_dword v60, v0, s[4:7], s31 offen sc1
    s_mov_b32 exec_hi, -1
ploopL_29_nt:
    s_cmp_eq_u32 s59, 0
    s_cbranch_scc1 ofl_32
    s_lshl_b32 s17, s16, 18
    s_add_u32 s17, s17, s60
    buffer_store_dwordx4 v[40:43], v1, s[4:7], s17 offen sc1
    s_mov_b32 s59, 0
ofl_32:
    s_lshr_b32 s17, s34, 3
    s_xor_b32 s17, s17, s16
    s_andn2_b32 s59, 1, s17
    s_cmp_ge_u32 s16, 16
    s_cselect_b32 s59, s59, 0
    s_cbranch_scc1 ploopL_29_nx2
    s_cmp_eq_u32 s3, 3
    s_cbranch_scc1 ploopL_29_nx2
    buffer_store_dwordx2 v[42:43], v40, s[4:7], s55 offen sc1
ploopL_29_nx2:
    s_add_u32 s55, s55, 262144
    s_barrier
    buffer_load_dword v60, off, s[4:7], s33 sc1
    s_add_u32 s16, s16, 1
    v_mov_b32 v59, s16
    s_add_u32 s41, s41, 262144
    s_add_u32 s31, s31, 262144
    s_setprio 3
    s_sleep 13
ploopL_29_pagain:
    buffer_load_dwordx4 v[16:19], v1, s[4:7], s28 offen offset:0 sc1
    buffer_load_dwordx4 v[20:23], v1, s[4:7], s28 offen offset:1024 sc1
    s_waitcnt vmcnt(1)
    v_mfma_f32_16x16x32_bf16 v[32:35], v[12:15], v[16:19], 0
    s_waitcnt vmcnt(0)
    v_mfma_f32_16x16x32_bf16 v[32:35], v[48:51], v[20:23], v[32:35]
    v_max_u32 v9, v16, v20
    v_cmp_eq_u32 vcc, -1, v9
    s_cbranch_vccnz ploopL_29_rp
ploopL_29_pgo:
    s_cmp_lt_u32 s16, 48
    s_nop 3
    v_add_f32_dpp v36, v32, v32 row_ror:8 row_mask:0xf bank_mask:0xf
    v_add_f32_dpp v37, v33, v33 row_ror:8 row_mask:0xf bank_mask:0xf
    v_add_f32_dpp v38, v34, v34 row_ror:8 row_mask:0xf bank_mask:0xf
    v_add_f32_dpp v39, v35, v35 row_ror:8 row_mask:0xf bank_mask:0xf
    v_cvt_pk_bf16_f32 v52, v36, v37
    v_cvt_pk_bf16_f32 v53, v38, v39
    s_nop 0
    v_permlane16_swap_b32 v52, v54
    v_permlane16_swap_b32 v53, v55
    s_mov_b64 exec, s[56:57]
    v_min_u32 v52, -2, v52
    buffer_store_dwordx4 v[52:55], v5, s[4:7], s24 offen sc1
    s_mov_b64 exec, -1
    ds_write_b32 v63, v59 offset:16
    s_cbranch_scc1 ploopL_29
    s_branch ploopH_28
ploopL_29_rm_0:
    s_sub_u32 s22, s22, 1
    s_cbranch_scc1 ploopL_29_rm_0_g
    buffer_load_dwordx4 v[16:19], v1, s[4:7], s23 offen offset:0 sc1
    buffer_load_dwordx4 v[20:23], v1, s[4:7], s23 offen offset:1024 sc1
    buffer_load_dwordx4 v[24:27], v1, s[4:7], s23 offen offset:2048 sc1
    buffer_load_dwordx4 v[28:31], v1, s[4:7], s23 offen offset:3072 sc1
    s_waitcnt vmcnt(3)
    v_cmp_eq_u32 vcc, -1, v16
    s_cbranch_vccnz ploopL_29_rm_0
    s_branch ploopL_29_rm_0ok
ploopL_29_rm_0_g:
    s_mov_b32 s22, 0
    s_waitcnt vmcnt(0)
    s_branch ploopL_29_rm_0ok
ploopL_29_rm_1:
    s_sub_u32 s22, s22, 1
    s_cbranch_scc1 ploopL_29_rm_1_g
    buffer_load_dwordx4 v[20:23], v1, s[4:7], s23 offen offset:1024 sc1
    buffer_load_dwordx4 v[24:27], v1, s[4:7], s23 offen offset:2048 sc1
    buffer_load_dwordx4 v[28:31], v1, s[4:7], s23 offen offset:3072 sc1
    s_waitcnt vmcnt(2)
    v_cmp_eq_u32 vcc, -1, v20
    s_cbranch_vccnz ploopL_29_rm_1
    s_branch ploopL_29_rm_1ok
ploopL_29_rm_1_g:
    s_mov_b32 s22, 0
    s_waitcnt vmcnt(0)
    s_branch ploopL_29_rm_1ok
ploopL_29_rm_2:
    s_sub_u32 s22, s22, 1
    s_cbranch_scc1 ploopL_29_rm_2_g
    buffer_load_dwordx4 v[24:27], v1, s[4:7], s23 offen offset:2048 sc1
    buffer_load_dwordx4 v[28:31], v1, s[4:7], s23 offen offset:3072 sc1
    s_waitcnt vmcnt(1)
    v_cmp_eq_u32 vcc, -1, v24
    s_cbranch_vccnz ploopL_29_rm_2
    s_branch ploopL_29_rm_2ok
ploopL_29_rm_2_g:
    s_mov_b32 s22, 0
    s_waitcnt vmcnt(0)
    s_branch ploopL_29_rm_2ok
ploopL_29_rm_3:
    s_sub_u32 s22, s22, 1
    s_cbranch_scc1 ploopL_29_rm_3_g
    buffer_load_dwordx4 v[28:31], v1, s[4:7], s23 offen offset:3072 sc1
    s_waitcnt vmcnt(0)
    v_cmp_eq_u32 vcc, -1, v28
    s_cbranch_vccnz ploopL_29_rm_3
    s_branch ploopL_29_rm_3ok
ploopL_29_rm_3_g:
    s_mov_b32 s22, 0
    s_waitcnt vmcnt(0)
    s_branch ploopL_29_rm_3ok
ploopL_29_rp:
    s_sub_u32 s22, s22, 1
    s_cbranch_scc0 ploopL_29_pagain
    s_mov_b32 s22, 0
    s_branch ploopL_29_pgo
.p2align 6
    s_nop 0
    s_nop 0
    s_nop 0
    s_nop 0
    s_nop 0
    s_nop 0
    s_nop 0
    s_nop 0
    s_nop 0
    s_nop 0
    s_nop 0
ploopH_28:
    v_mov_b32 v32, 0
    v_mov_b32 v33, 0
    v_mov_b32 v34, 0
    v_mov_b32 v35, 0
    v_mov_b32 v36, 0
    v_mov_b32 v37, 0
    v_mov_b32 v38, 0
    v_mov_b32 v39, 0
    v_mov_b32 v40, 0
    v_mov_b32 v41, 0
    v_mov_b32 v42, 0
    v_mov_b32 v43, 0
    v_mov_b32 v44, 0
    v_mov_b32 v45, 0
    v_mov_b32 v46, 0
    v_mov_b32 v47, 0
    v_mov_b32 v48, 0
    v_mov_b32 v49, 0
    v_mov_b32 v50, 0
    v_mov_b32 v51, 0
    v_mov_b32 v52, 0
    v_mov_b32 v53, 0
    v_mov_b32 v54, 0
    v_mov_b32 v55, 0
    s_sleep 1
    buffer_load_dwordx4 v[16:19], v1, s[4:7], s23 offen offset:0 sc1
    buffer_load_dwordx4 v[20:23], v1, s[4:7], s23 offen offset:1024 sc1
    buffer_load_dwordx4 v[24:27], v1, s[4:7], s23 offen offset:2048 sc1
    buffer_load_dwordx4 v[28:31], v1, s[4:7], s23 offen offset:3072 sc1
    s_waitcnt vmcnt(3)
    v_cmp_eq_u32 vcc, -1, v16
    s_cbranch_vccnz ploopH_28_rm_0
ploopH_28_rm_0ok:
    v_smfmac_f32_16x16x64_bf16 v[32:35], v[16:19], v[64:71], v8
    v_smfmac_f32_16x16x64_bf16 v[36:39], v[16:19], v[72:79], v8
    s_waitcnt vmcnt(2)
    v_cmp_eq_u32 vcc, -1, v20
    v_smfmac_f32_16x16x64_bf16 v[40:43], v[16:19], v[80:87], v8
    v_smfmac_f32_16x16x64_bf16 v[44:47], v[16:19], v[88:95], v8
    v_smfmac_f32_16x16x64_bf16 v[48:51], v[16:19], v[96:103], v8
    v_smfmac_f32_16x16x64_bf16 v[52:55], v[16:19], v[104:111], v8
    s_cbranch_vccnz ploopH_28_rm_1
ploopH_28_rm_1ok:
    v_smfmac_f32_16x16x64_bf16 v[32:35], v[20:23], v[112:119], v8
    v_smfmac_f32_16x16x64_bf16 v[36:39], v[20:23], v[120:127], v8
    s_waitcnt vmcnt(1)
    v_cmp_eq_u32 vcc, -1, v24
    v_smfmac_f32_16x16x64_bf16 v[40:43], v[20:23], v[128:135], v8
    v_smfmac_f32_16x16x64_bf16 v[44:47], v[20:23], v[136:143], v8
    v_smfmac_f32_16x16x64_bf16 v[48:51], v[20:23], v[144:151], v8
    v_smfmac_f32_16x16x64_bf16 v[52:55], v[20:23], v[152:159], v8
    s_cbranch_vccnz ploopH_28_rm_2
ploopH_28_rm_2ok:
    v_smfmac_f32_16x16x64_bf16 v[32:35], v[24:27], v[160:167], v8
    v_smfmac_f32_16x16x64_bf16 v[36:39], v[24:27], v[168:175], v8
    s_waitcnt vmcnt(0)
    v_cmp_eq_u32 vcc, -1, v28
    v_smfmac_f32_16x16x64_bf16 v[40:43], v[24:27], v[176:183], v8
    v_smfmac_f32_16x16x64_bf16 v[44:47], v[24:27], v[184:191], v8
    v_smfmac_f32_16x16x64_bf16 v[48:51], v[24:27], v[192:199], v8
    v_smfmac_f32_16x16x64_bf16 v[52:55], v[24:27], v[200:207], v8
    s_cbranch_vccnz ploopH_28_rm_3
ploopH_28_rm_3ok:
    v_smfmac_f32_16x16x64_bf16 v[32:35], v[28:31], v[208:215], v8
    ds_write_b32 v63, v59 offset:32
    v_smfmac_f32_16x16x64_bf16 v[36:39], v[28:31], v[216:223], v8
    v_smfmac_f32_16x16x64_bf16 v[40:43], v[28:31], v[224:231], v8
    v_smfmac_f32_16x16x64_bf16 v[44:47], v[28:31], v[232:239], v8
    v_smfmac_f32_16x16x64_bf16 v[48:51], v[28:31], v[240:247], v8
    v_smfmac_f32_16x16x64_bf16 v[52:55], v[28:31], v[248:255], v8
    s_cmp_eq_u32 s3, 3
    s_nop 1
    v_add_f32 v32, v32, v34
    v_add_f32 v33, v33, v35
    ds_write2_b32 v3, v32, v33 offset0:0 offset1:40
    v_add_f32 v36, v36, v38
    v_add_f32 v37, v37, v39
    ds_write2_b32 v3, v36, v37 offset0:16 offset1:56
    v_add_f32 v40, v40, v42
    v_add_f32 v41, v41, v43
    ds_write2_b32 v61, v40, v41 offset0:0 offset1:40
    v_add_f32 v44, v44, v46
    v_add_f32 v45, v45, v47
    ds_write2_b32 v61, v44, v45 offset0:16 offset1:56
    v_add_f32 v48, v48, v50
    v_add_f32 v49, v49, v51
    ds_write2_b32 v62, v48, v49 offset0:0 offset1:40
    v_add_f32 v52, v52, v54
    v_add_f32 v53, v53, v55
    ds_write2_b32 v62, v52, v53 offset0:16 offset1:56
    s_waitcnt lgkmcnt(0)
    s_barrier
    s_cbranch_scc1 ploopH_28_sk1
    ds_read_b128 v[32:35], v4 offset:0
    ds_read_b128 v[36:39], v4 offset:3840
    ds_read_b128 v[40:43], v4 offset:7680
    ds_read_b128 v[44:47], v4 offset:11520
    s_waitcnt lgkmcnt(2)
    v_add_f32 v32, v32, v36
    v_add_f32 v33, v33, v37
    v_add_f32 v34, v34, v38
    v_add_f32 v35, v35, v39
    s_waitcnt lgkmcnt(0)
    v_add_f32 v40, v40, v44
    v_add_f32 v41, v41, v45
    v_add_f32 v42, v42, v46
    v_add_f32 v43, v43, v47
    v_add_f32 v32, v32, v40
    v_add_f32 v33, v33, v41
    v_add_f32 v34, v34, v42
    v_add_f32 v35, v35, v43
    v_cvt_pk_bf16_f32 v56, v32, v33
    v_cvt_pk_bf16_f32 v57, v34, v35
    v_min_u32 v56, -2, v56
    buffer_store_dwordx2 v[56:57], v2, s[4:7], s26 offen sc1
    s_add_u32 s27, s16, 2
    s_and_b32 s27, s27, 3
    s_lshl_b32 s27, s27, 18
    s_add_u32 s27, s27, s38
    buffer_store_dwordx2 v[10:11], v2, s[4:7], s27 offen sc1
ploopH_28_sk1:
    s_setprio 0
    s_add_u32 s25, s16, 3
    s_and_b32 s25, s25, 3
    s_lshl_b32 s25, s25, 16
    s_add_u32 s25, s25, s37
    v_mov_b32 v44, -1
    v_mov_b32 v45, -1
    v_mov_b32 v46, -1
    v_mov_b32 v47, -1
    s_mov_b64 exec, s[56:57]
    buffer_store_dwordx4 v[44:47], v5, s[4:7], s25 offen sc1
    s_mov_b64 exec, -1
    v_mov_b32_dpp v48, v12 row_ror:8 row_mask:0xf bank_mask:0xf
    v_mov_b32_dpp v49, v13 row_ror:8 row_mask:0xf bank_mask:0xf
    v_mov_b32_dpp v50, v14 row_ror:8 row_mask:0xf bank_mask:0xf
    v_mov_b32_dpp v51, v15 row_ror:8 row_mask:0xf bank_mask:0xf
    s_and_b32 s28, s16, 3
    s_lshl_b32 s28, s28, 18
    s_add_u32 s28, s28, s39
    s_add_u32 s24, s16, 1
    s_and_b32 s24, s24, 3
    s_lshl_b32 s24, s24, 16
    s_add_u32 s24, s24, s37
    s_add_u32 s23, s16, 1
    s_and_b32 s23, s23, 3
    s_lshl_b32 s23, s23, 16
    s_add_u32 s23, s23, s36
    s_add_u32 s26, s16, 1
    s_and_b32 s26, s26, 3
    s_lshl_b32 s26, s26, 18
    s_add_u32 s26, s26, s38
    s_cmp_eq_u32 s59, 0
    s_cbranch_scc1 ofl_33
    s_lshl_b32 s17, s3, 10
    v_add_u32 v39, s17, v1
    ds_read_b128 v[40:43], v39 offset:32768
ofl_33:
    s_cmp_eq_u32 s16, 63
    s_cbranch_scc1 ploopH_28_tail
    s_cmp_eq_u32 s30, s54
    s_cbranch_scc1 pnoseg_34
    ds_read_b128 v[16:19], v6 offset:0
    ds_read_b128 v[20:23], v6 offset:256
    ds_read_b128 v[24:27], v6 offset:512
    ds_read_b128 v[28:31], v6 offset:768
    v_xor_b32 v6, 0x4000, v6
    s_waitcnt lgkmcnt(2)
    v_mfma_f32_16x16x32_bf16 v[40:43], v[12:15], v[16:19], 0
    v_mfma_f32_16x16x32_bf16 v[40:43], v[48:51], v[20:23], v[40:43]
    s_waitcnt lgkmcnt(0)
    v_mfma_f32_16x16x32_bf16 v[44:47], v[12:15], v[24:27], 0
    v_mfma_f32_16x16x32_bf16 v[44:47], v[48:51], v[28:31], v[44:47]
    s_nop 7
    v_cvt_pk_bf16_f32 v40, v40, v41
    v_cvt_pk_bf16_f32 v41, v42, v43
    v_cvt_pk_bf16_f32 v42, v44, v45
    v_cvt_pk_bf16_f32 v43, v46, v47
    s_nop 1
    v_permlane16_swap_b32 v40, v42
    v_permlane16_swap_b32 v41, v43
    s_nop 1
    v_min_u32 v40, -2, v40
pnoseg_34:
    s_bitcmp1_b32 s29, 0
    s_cbranch_scc1 gate_35_ok
    s_add_u32 s21, s16, 1
    s_min_u32 s21, s21, 63
    s_cmp_ge_u32 s21, 16
    s_cselect_b32 s19, 12, 8
    s_and_b32 s32, s21, 4
    s_lshr_b32 s21, s21, 3
    s_lshl_b32 s21, s21, 8
    s_add_u32 s32, s32, s21
    s_add_u32 s32, s32, s35
gate_35:
    buffer_load_dword v9, off, s[4:7], s32 sc1
    s_waitcnt vmcnt(0)
    v_readfirstlane_b32 s21, v9
    s_cmp_ge_u32 s21, s19
    s_cbranch_scc1 gate_35_set
    s_sleep 8
    s_sub_u32 s22, s22, 1
    s_cbranch_scc0 gate_35
    s_mov_b32 s22, 0
gate_35_set:
    s_bitset1_b32 s29, 0
gate_35_ok:
    v_readfirstlane_b32 s21, v60
    s_lshr_b32 s29, s29, 1
    s_cmp_ge_u32 s21, s58
    s_cselect_b32 s21, 2, 0
    s_or_b32 s29, s29, s21
    s_cmp_eq_u32 s3, 3
    s_cselect_b32 s20, s21, 0
    s_add_u32 s21, s16, 4
    s_min_u32 s21, s21, 63
    s_cmp_ge_u32 s21, 16
    s_cselect_b32 s58, 12, 8
    s_and_b32 s33, s21, 4
    s_lshr_b32 s21, s21, 3
    s_lshl_b32 s21, s21, 8
    s_add_u32 s33, s33, s21
    s_add_u32 s33, s33, s35
    s_setprio 3
ploopH_28_fs:
    ds_read_b128 v[32:35], v58 offset:0
    s_waitcnt lgkmcnt(0)
    v_min3_i32 v32, v32, v33, v34
    v_min_i32 v32, v32, v35
    s_nop 0
    v_readfirstlane_b32 s18, v32
    s_cmp_ge_i32 s18, s16
    s_cbranch_scc1 ploopH_28_fsok
    s_sleep 1
    s_branch ploopH_28_fs
ploopH_28_fsok:
    s_setprio 1
    s_add_u32 m0, s42, 8192
    s_add_u32 s17, s41, 37748736
    buffer_load_dwordx4 v1, s[4:7], s17 offen offset:0 sc1 lds
    buffer_load_dwordx4 v1, s[4:7], s17 offen offset:1024 sc1 lds
    buffer_load_dwordx4 v1, s[4:7], s17 offen offset:2048 sc1 lds
    buffer_load_dwordx4 v1, s[4:7], s17 offen offset:3072 sc1 lds
    s_add_u32 m0, s42, 12288
    s_add_u32 s17, s41, 37879808
    buffer_load_dwordx4 v1, s[4:7], s17 offen offset:0 sc1 lds
    buffer_load_dwordx4 v1, s[4:7], s17 offen offset:1024 sc1 lds
    buffer_load_dwordx4 v1, s[4:7], s17 offen offset:2048 sc1 lds
    buffer_load_dwordx4 v1, s[4:7], s17 offen offset:3072 sc1 lds
    s_cmp_eq_u32 s20, 0
    s_cbranch_scc1 ploopH_28_nt
    s_mov_b32 exec_hi, 0xffff
    buffer_load_dword v60, v0, s[4:7], s31 offen sc1
    s_mov_b32 exec_hi, -1
ploopH_28_nt:
    s_cmp_eq_u32 s59, 0
    s_cbranch_scc1 ofl_36
    s_lshl_b32 s17, s16, 18
    s_add_u32 s17, s17, s60
    buffer_store_dwordx4 v[40:43], v1, s[4:7], s17 offen sc1
    s_mov_b32 s59, 0
ofl_36:
    s_cmp_eq_u32 s30, s54
    s_cbranch_scc1 pnoseg_37
    buffer_store_dwordx4 v[40:43], v7, s[4:7], s30 offen sc1
    s_add_u32 s30, s30, 65536
pnoseg_37:
    s_barrier
    buffer_load_dword v60, off, s[4:7], s33 sc1
    s_add_u32 s16, s16, 1
    v_mov_b32 v59, s16
    s_add_u32 s41, s41, 262144
    s_add_u32 s31, s31, 262144
    s_mov_b32 s54, 0
    s_setprio 3
    s_sleep 13
ploopH_28_pagain:
    buffer_load_dwordx4 v[16:19], v1, s[4:7], s28 offen offset:0 sc1
    buffer_load_dwordx4 v[20:23], v1, s[4:7], s28 offen offset:1024 sc1
    s_waitcnt vmcnt(1)
    v_mfma_f32_16x16x32_bf16 v[32:35], v[12:15], v[16:19], 0
    s_waitcnt vmcnt(0)
    v_mfma_f32_16x16x32_bf16 v[32:35], v[48:51], v[20:23], v[32:35]
    v_max_u32 v9, v16, v20
    v_cmp_eq_u32 vcc, -1, v9
    s_cbranch_vccnz ploopH_28_rp
ploopH_28_pgo:
    s_nop 4
    v_add_f32_dpp v36, v32, v32 row_ror:8 row_mask:0xf bank_mask:0xf
    v_add_f32_dpp v37, v33, v33 row_ror:8 row_mask:0xf bank_mask:0xf
    v_add_f32_dpp v38, v34, v34 row_ror:8 row_mask:0xf bank_mask:0xf
    v_add_f32_dpp v39, v35, v35 row_ror:8 row_mask:0xf bank_mask:0xf
    v_cvt_pk_bf16_f32 v52, v36, v37
    v_cvt_pk_bf16_f32 v53, v38, v39
    s_nop 0
    v_permlane16_swap_b32 v52, v54
    v_permlane16_swap_b32 v53, v55
    s_mov_b64 exec, s[56:57]
    v_min_u32 v52, -2, v52
    buffer_store_dwordx4 v[52:55], v5, s[4:7], s24 offen sc1
    s_mov_b64 exec, -1
    ds_write_b32 v63, v59 offset:16
    s_branch ploopH_28
ploopH_28_rm_0:
    s_sub_u32 s22, s22, 1
    s_cbranch_scc1 ploopH_28_rm_0_g
    buffer_load_dwordx4 v[16:19], v1, s[4:7], s23 offen offset:0 sc1
    buffer_load_dwordx4 v[20:23], v1, s[4:7], s23 offen offset:1024 sc1
    buffer_load_dwordx4 v[24:27], v1, s[4:7], s23 offen offset:2048 sc1
    buffer_load_dwordx4 v[28:31], v1, s[4:7], s23 offen offset:3072 sc1
    s_waitcnt vmcnt(3)
    v_cmp_eq_u32 vcc, -1, v16
    s_cbranch_vccnz ploopH_28_rm_0
    s_branch ploopH_28_rm_0ok
ploopH_28_rm_0_g:
    s_mov_b32 s22, 0
    s_waitcnt vmcnt(0)
    s_branch ploopH_28_rm_0ok
ploopH_28_rm_1:
    s_sub_u32 s22, s22, 1
    s_cbranch_scc1 ploopH_28_rm_1_g
    buffer_load_dwordx4 v[20:23], v1, s[4:7], s23 offen offset:1024 sc1
    buffer_load_dwordx4 v[24:27], v1, s[4:7], s23 offen offset:2048 sc1
    buffer_load_dwordx4 v[28:31], v1, s[4:7], s23 offen offset:3072 sc1
    s_waitcnt vmcnt(2)
    v_cmp_eq_u32 vcc, -1, v20
    s_cbranch_vccnz ploopH_28_rm_1
    s_branch ploopH_28_rm_1ok
ploopH_28_rm_1_g:
    s_mov_b32 s22, 0
    s_waitcnt vmcnt(0)
    s_branch ploopH_28_rm_1ok
ploopH_28_rm_2:
    s_sub_u32 s22, s22, 1
    s_cbranch_scc1 ploopH_28_rm_2_g
    buffer_load_dwordx4 v[24:27], v1, s[4:7], s23 offen offset:2048 sc1
    buffer_load_dwordx4 v[28:31], v1, s[4:7], s23 offen offset:3072 sc1
    s_waitcnt vmcnt(1)
    v_cmp_eq_u32 vcc, -1, v24
    s_cbranch_vccnz ploopH_28_rm_2
    s_branch ploopH_28_rm_2ok
ploopH_28_rm_2_g:
    s_mov_b32 s22, 0
    s_waitcnt vmcnt(0)
    s_branch ploopH_28_rm_2ok
ploopH_28_rm_3:
    s_sub_u32 s22, s22, 1
    s_cbranch_scc1 ploopH_28_rm_3_g
    buffer_load_dwordx4 v[28:31], v1, s[4:7], s23 offen offset:3072 sc1
    s_waitcnt vmcnt(0)
    v_cmp_eq_u32 vcc, -1, v28
    s_cbranch_vccnz ploopH_28_rm_3
    s_branch ploopH_28_rm_3ok
ploopH_28_rm_3_g:
    s_mov_b32 s22, 0
    s_waitcnt vmcnt(0)
    s_branch ploopH_28_rm_3ok
ploopH_28_rp:
    s_sub_u32 s22, s22, 1
    s_cbranch_scc0 ploopH_28_pagain
    s_mov_b32 s22, 0
    s_branch ploopH_28_pgo
ploopH_28_tail:
    ds_read_b128 v[16:19], v6 offset:0
    ds_read_b128 v[20:23], v6 offset:256
    ds_read_b128 v[24:27], v6 offset:512
    ds_read_b128 v[28:31], v6 offset:768
    v_xor_b32 v6, 0x4000, v6
    s_waitcnt lgkmcnt(2)
    v_mfma_f32_16x16x32_bf16 v[40:43], v[12:15], v[16:19], 0
    v_mfma_f32_16x16x32_bf16 v[40:43], v[48:51], v[20:23], v[40:43]
    s_waitcnt lgkmcnt(0)
    v_mfma_f32_16x16x32_bf16 v[44:47], v[12:15], v[24:27], 0
    v_mfma_f32_16x16x32_bf16 v[44:47], v[48:51], v[28:31], v[44:47]
    s_nop 7
    v_cvt_pk_bf16_f32 v40, v40, v41
    v_cvt_pk_bf16_f32 v41, v42, v43
    v_cvt_pk_bf16_f32 v42, v44, v45
    v_cvt_pk_bf16_f32 v43, v46, v47
    s_nop 1
    v_permlane16_swap_b32 v40, v42
    v_permlane16_swap_b32 v41, v43
    s_nop 1
    v_min_u32 v40, -2, v40
    buffer_store_dwordx4 v[40:43], v7, s[4:7], s30 offen sc1
    s_add_u32 s30, s30, 65536
    s_barrier
    ds_read_b128 v[16:19], v6 offset:0
    ds_read_b128 v[20:23], v6 offset:256
    ds_read_b128 v[24:27], v6 offset:512
    ds_read_b128 v[28:31], v6 offset:768
    v_xor_b32 v6, 0x4000, v6
    s_waitcnt lgkmcnt(2)
    v_mfma_f32_16x16x32_bf16 v[40:43], v[12:15], v[16:19], 0
    v_mfma_f32_16x16x32_bf16 v[40:43], v[48:51], v[20:23], v[40:43]
    s_waitcnt lgkmcnt(0)
    v_mfma_f32_16x16x32_bf16 v[44:47], v[12:15], v[24:27], 0
    v_mfma_f32_16x16x32_bf16 v[44:47], v[48:51], v[28:31], v[44:47]
    s_nop 7
    v_cvt_pk_bf16_f32 v40, v40, v41
    v_cvt_pk_bf16_f32 v41, v42, v43
    v_cvt_pk_bf16_f32 v42, v44, v45
    v_cvt_pk_bf16_f32 v43, v46, v47
    s_nop 1
    v_permlane16_swap_b32 v40, v42
    v_permlane16_swap_b32 v41, v43
    s_nop 1
    v_min_u32 v40, -2, v40
    buffer_store_dwordx4 v[40:43], v7, s[4:7], s30 offen sc1
    s_add_u32 s30, s30, 65536
    s_branch k_end
ch_a_pro:
    s_sub_u32 s21, s3, 4
    s_lshl_b32 s15, s14, 2
    s_add_u32 s15, s15, s21
    s_lshl_b32 s38, s15, 13
    s_add_u32 s38, s38, 214958080
    s_min_u32 s20, s21, 2
    s_lshl_b32 s18, s20, 3
    s_add_u32 s18, s18, 16
    s_load_dwordx2 s[8:9], s[0:1], s18
    s_mov_b32 s10, 8388608
    s_mov_b32 s11, 131072
    v_and_b32 v20, 63, v0
    v_lshlrev_b32 v21, 13, v20
    s_lshl_b32 s17, s34, 19
    s_lshl_b32 s18, s14, 10
    s_add_u32 s17, s17, s18
    s_waitcnt lgkmcnt(0)
    buffer_load_dword v26, v21, s[8:11], s17 offen offset:384
    v_and_b32 v20, 63, v0
    v_lshrrev_b32 v21, 4, v20
    v_bfe_u32 v22, v20, 1, 1
    v_xor_b32 v22, 1, v22
    v_lshl_add_u32 v23, v22, 2, v21
    v_bfe_u32 v22, v20, 2, 2
    v_and_b32 v24, 1, v20
    v_lshl_add_u32 v22, v22, 1, v24
    v_lshl_add_u32 v23, v23, 3, v22
    v_and_b32 v22, 7, v20
    v_lshlrev_b32 v23, 4, v23
    s_lshl_b32 s17, s21, 10
    s_add_u32 s17, s17, 16384
    v_add_u32 v160, s17, v23
    v_and_b32 v24, 15, v20
    v_lshlrev_b32 v24, 4, v24
    v_lshl_add_u32 v23, v21, 10, v24
    s_lshl_b32 s17, s21, 8
    s_add_u32 s17, s17, 16384
    v_add_u32 v161, s17, v23
    v_lshl_add_u32 v23, v21, 9, v24
    s_lshl_b32 s17, s21, 12
    s_add_u32 s17, s17, 32768
    v_add_u32 v162, s17, v23
    v_bfe_u32 v23, v20, 3, 1
    v_lshlrev_b32 v23, 10, v23
    v_lshl_add_u32 v23, v22, 4, v23
    v_mov_b32 v1, v23
    s_lshl_b32 s39, s34, 14
    s_lshl_b32 s17, s21, 11
    s_add_u32 s39, s39, s17
    s_lshl_b32 s17, s14, 7
    s_add_u32 s39, s39, s17
    s_add_u32 s39, s39, 209715200
    v_mov_b32 v176, -1
    v_mov_b32 v177, -1
    v_mov_b32 v178, -1
    v_mov_b32 v179, -1
    v_lshlrev_b32 v24, 4, v0
    s_lshl_b32 s17, s52, 13
    s_add_u32 s19, s17, 209711104
    s_add_u32 s17, s17, 214953984
    s_lshl_b32 s18, s52, 12
    s_add_u32 s18, s18, 213905408
    buffer_store_dwordx4 v[176:179], v24, s[4:7], s19 offen sc1
    s_add_u32 s19, s19, 4096
    buffer_store_dwordx4 v[176:179], v24, s[4:7], s19 offen sc1
    buffer_store_dwordx4 v[176:179], v24, s[4:7], s17 offen sc1
    s_add_u32 s17, s17, 4096
    buffer_store_dwordx4 v[176:179], v24, s[4:7], s17 offen sc1
    buffer_store_dwordx4 v[176:179], v24, s[4:7], s18 offen sc1
    s_and_b32 s17, s13, 7
    s_sub_u32 s18, s21, 1
    s_cmp_lt_u32 s18, 2
    s_cselect_b32 s54, s17, 1
    s_lshr_b32 s19, s52, 3
    s_lshl_b32 s19, s19, 8
    s_lshl_b32 s18, s18, 7
    s_add_u32 s19, s19, s18
    s_add_u32 s55, s19, 210763776
    s_cmp_lg_u32 s54, 0
    s_cbranch_scc1 ch_nv0
    v_lshlrev_b32 v24, 13, v20
    s_mov_b64 exec, 0xffff
    buffer_store_dword v176, v24, s[4:7], s55 offen sc1
    s_mov_b64 exec, -1
ch_nv0:
    v_mov_b32 v2, s40
    s_lshl_b32 s17, s12, 2
    s_add_u32 s17, s17, 128
    s_waitcnt vmcnt(0)
    s_barrier
    s_cmp_lg_u32 s3, 4
    s_cbranch_scc1 ch_nox
    s_mov_b64 exec, 1
    buffer_atomic_add v2, off, s[64:67], s17 sc1
    s_mov_b64 exec, -1
ch_nox:
    v_and_b32 v20, 63, v0
    v_lshlrev_b32 v0, 4, v20
    s_lshl_b32 s17, s15, 18
    s_lshl_b32 s18, s34, 7
    s_add_u32 s17, s17, s18
    s_lshl_b32 s19, s21, 13
    s_add_u32 s19, s19, 131072
    s_load_dwordx2 s[8:9], s[0:1], 40
    s_mov_b32 s10, 8388608
    s_mov_b32 s11, 131072
    v_lshrrev_b32 v21, 3, v20
    v_and_b32 v22, 7, v20
    v_lshlrev_b32 v21, 11, v21
    v_lshl_add_u32 v21, v22, 4, v21
    v_lshrrev_b32 v28, 4, v20
    v_and_b32 v29, 1, v28
    v_xor_b32 v29, 0, v29
    v_lshlrev_b32 v29, 2, v29
    v_lshl_add_u32 v29, v28, 3, v29
    v_bfe_u32 v28, v20, 2, 2
    v_add_u32 v29, v29, v28
    v_lshlrev_b32 v29, 7, v29
    v_and_b32 v28, 3, v20
    v_lshl_add_u32 v29, v28, 4, v29
    v_and_b32 v28, 1, v28
    v_xor_b32 v28, 0, v28
    v_lshl_add_u32 v24, v28, 3, v29
    v_add_u32 v24, s19, v24
    v_lshrrev_b32 v28, 4, v20
    v_and_b32 v29, 1, v28
    v_xor_b32 v29, 1, v29
    v_lshlrev_b32 v29, 2, v29
    v_lshl_add_u32 v29, v28, 3, v29
    v_bfe_u32 v28, v20, 2, 2
    v_add_u32 v29, v29, v28
    v_lshlrev_b32 v29, 7, v29
    v_and_b32 v28, 3, v20
    v_lshl_add_u32 v29, v28, 4, v29
    v_and_b32 v28, 1, v28
    v_xor_b32 v28, 0, v28
    v_lshl_add_u32 v25, v28, 3, v29
    v_add_u32 v25, s19, v25
    v_lshrrev_b32 v28, 4, v20
    v_and_b32 v29, 1, v28
    v_xor_b32 v29, 0, v29
    v_lshlrev_b32 v29, 2, v29
    v_lshl_add_u32 v29, v28, 3, v29
    v_bfe_u32 v28, v20, 2, 2
    v_add_u32 v29, v29, v28
    v_lshlrev_b32 v29, 7, v29
    v_and_b32 v28, 3, v20
    v_lshl_add_u32 v29, v28, 4, v29
    v_and_b32 v28, 1, v28
    v_xor_b32 v28, 1, v28
    v_lshl_add_u32 v26, v28, 3, v29
    v_add_u32 v26, s19, v26
    v_lshrrev_b32 v28, 4, v20
    v_and_b32 v29, 1, v28
    v_xor_b32 v29, 1, v29
    v_lshlrev_b32 v29, 2, v29
    v_lshl_add_u32 v29, v28, 3, v29
    v_bfe_u32 v28, v20, 2, 2
    v_add_u32 v29, v29, v28
    v_lshlrev_b32 v29, 7, v29
    v_and_b32 v28, 3, v20
    v_lshl_add_u32 v29, v28, 4, v29
    v_and_b32 v28, 1, v28
    v_xor_b32 v28, 1, v28
    v_lshl_add_u32 v27, v28, 3, v29
    v_add_u32 v27, s19, v27
    s_waitcnt lgkmcnt(0)
    s_add_u32 m0, s19, 0
    s_nop 0
    buffer_load_dwordx4 v21, s[8:11], s17 offen lds
    s_add_u32 s17, s17, 16384
    s_add_u32 m0, s19, 1024
    s_nop 0
    buffer_load_dwordx4 v21, s[8:11], s17 offen lds
    s_add_u32 s17, s17, 16384
    s_add_u32 m0, s19, 2048
    s_nop 0
    buffer_load_dwordx4 v21, s[8:11], s17 offen lds
    s_add_u32 s17, s17, 16384
    s_add_u32 m0, s19, 3072
    s_nop 0
    buffer_load_dwordx4 v21, s[8:11], s17 offen lds
    s_add_u32 s17, s17, 16384
    s_add_u32 m0, s19, 4096
    s_nop 0
    buffer_load_dwordx4 v21, s[8:11], s17 offen lds
    s_add_u32 s17, s17, 16384
    s_add_u32 m0, s19, 5120
    s_nop 0
    buffer_load_dwordx4 v21, s[8:11], s17 offen lds
    s_add_u32 s17, s17, 16384
    s_add_u32 m0, s19, 6144
    s_nop 0
    buffer_load_dwordx4 v21, s[8:11], s17 offen lds
    s_add_u32 s17, s17, 16384
    s_add_u32 m0, s19, 7168
    s_nop 0
    buffer_load_dwordx4 v21, s[8:11], s17 offen lds
    s_add_u32 s17, s17, 16384
    buffer_load_dwordx4 v[96:99], v21, s[8:11], s17 offen
    s_add_u32 s17, s17, 16384
    buffer_load_dwordx4 v[100:103], v21, s[8:11], s17 offen
    s_add_u32 s17, s17, 16384
    buffer_load_dwordx4 v[104:107], v21, s[8:11], s17 offen
    s_add_u32 s17, s17, 16384
    buffer_load_dwordx4 v[108:111], v21, s[8:11], s17 offen
    s_add_u32 s17, s17, 16384
    buffer_load_dwordx4 v[112:115], v21, s[8:11], s17 offen
    s_add_u32 s17, s17, 16384
    buffer_load_dwordx4 v[116:119], v21, s[8:11], s17 offen
    s_add_u32 s17, s17, 16384
    buffer_load_dwordx4 v[120:123], v21, s[8:11], s17 offen
    s_add_u32 s17, s17, 16384
    buffer_load_dwordx4 v[124:127], v21, s[8:11], s17 offen
    s_add_u32 s17, s17, 16384
    s_cmp_lg_u32 s54, 0
    s_cbranch_scc1 ch_nv1
    s_mov_b32 s58, -1
    s_mov_b32 s59, -1
    s_memtime s[60:61]
    s_add_u32 s56, s55, 0
    s_waitcnt lgkmcnt(0)
    s_load_dword s57, s[4:5], s56 glc
    s_waitcnt lgkmcnt(0)
    s_memtime s[62:63]
    s_waitcnt lgkmcnt(0)
    s_sub_u32 s57, s62, s60
    s_min_u32 s58, s58, s57
    s_memtime s[60:61]
    s_add_u32 s56, s55, 8192
    s_waitcnt lgkmcnt(0)
    s_load_dword s57, s[4:5], s56 glc
    s_waitcnt lgkmcnt(0)
    s_memtime s[62:63]
    s_waitcnt lgkmcnt(0)
    s_sub_u32 s57, s62, s60
    s_min_u32 s59, s59, s57
    s_memtime s[60:61]
    s_add_u32 s56, s55, 16384
    s_waitcnt lgkmcnt(0)
    s_load_dword s57, s[4:5], s56 glc
    s_waitcnt lgkmcnt(0)
    s_memtime s[62:63]
    s_waitcnt lgkmcnt(0)
    s_sub_u32 s57, s62, s60
    s_min_u32 s58, s58, s57
    s_memtime s[60:61]
    s_add_u32 s56, s55, 24576
    s_waitcnt lgkmcnt(0)
    s_load_dword s57, s[4:5], s56 glc
    s_waitcnt lgkmcnt(0)
    s_memtime s[62:63]
    s_waitcnt lgkmcnt(0)
    s_sub_u32 s57, s62, s60
    s_min_u32 s59, s59, s57
    s_memtime s[60:61]
    s_add_u32 s56, s55, 32768
    s_waitcnt lgkmcnt(0)
    s_load_dword s57, s[4:5], s56 glc
    s_waitcnt lgkmcnt(0)
    s_memtime s[62:63]
    s_waitcnt lgkmcnt(0)
    s_sub_u32 s57, s62, s60
    s_min_u32 s58, s58, s57
    s_memtime s[60:61]
    s_add_u32 s56, s55, 40960
    s_waitcnt lgkmcnt(0)
    s_load_dword s57, s[4:5], s56 glc
    s_waitcnt lgkmcnt(0)
    s_memtime s[62:63]
    s_waitcnt lgkmcnt(0)
    s_sub_u32 s57, s62, s60
    s_min_u32 s59, s59, s57
    s_memtime s[60:61]
    s_add_u32 s56, s55, 49152
    s_waitcnt lgkmcnt(0)
    s_load_dword s57, s[4:5], s56 glc
    s_waitcnt lgkmcnt(0)
    s_memtime s[62:63]
    s_waitcnt lgkmcnt(0)
    s_sub_u32 s57, s62, s60
    s_min_u32 s58, s58, s57
    s_memtime s[60:61]
    s_add_u32 s56, s55, 57344
    s_waitcnt lgkmcnt(0)
    s_load_dword s57, s[4:5], s56 glc
    s_waitcnt lgkmcnt(0)
    s_memtime s[62:63]
    s_waitcnt lgkmcnt(0)
    s_sub_u32 s57, s62, s60
    s_min_u32 s59, s59, s57
    s_memtime s[60:61]
    s_add_u32 s56, s55, 65536
    s_waitcnt lgkmcnt(0)
    s_load_dword s57, s[4:5], s56 glc
    s_waitcnt lgkmcnt(0)
    s_memtime s[62:63]
    s_waitcnt lgkmcnt(0)
    s_sub_u32 s57, s62, s60
    s_min_u32 s58, s58, s57
    s_memtime s[60:61]
    s_add_u32 s56, s55, 73728
    s_waitcnt lgkmcnt(0)
    s_load_dword s57, s[4:5], s56 glc
    s_waitcnt lgkmcnt(0)
    s_memtime s[62:63]
    s_waitcnt lgkmcnt(0)
    s_sub_u32 s57, s62, s60
    s_min_u32 s59, s59, s57
    s_memtime s[60:61]
    s_add_u32 s56, s55, 81920
    s_waitcnt lgkmcnt(0)
    s_load_dword s57, s[4:5], s56 glc
    s_waitcnt lgkmcnt(0)
    s_memtime s[62:63]
    s_waitcnt lgkmcnt(0)
    s_sub_u32 s57, s62, s60
    s_min_u32 s58, s58, s57
    s_memtime s[60:61]
    s_add_u32 s56, s55, 90112
    s_waitcnt lgkmcnt(0)
    s_load_dword s57, s[4:5], s56 glc
    s_waitcnt lgkmcnt(0)
    s_memtime s[62:63]
    s_waitcnt lgkmcnt(0)
    s_sub_u32 s57, s62, s60
    s_min_u32 s59, s59, s57
    s_memtime s[60:61]
    s_add_u32 s56, s55, 98304
    s_waitcnt lgkmcnt(0)
    s_load_dword s57, s[4:5], s56 glc
    s_waitcnt lgkmcnt(0)
    s_memtime s[62:63]
    s_waitcnt lgkmcnt(0)
    s_sub_u32 s57, s62, s60
    s_min_u32 s58, s58, s57
    s_memtime s[60:61]
    s_add_u32 s56, s55, 106496
    s_waitcnt lgkmcnt(0)
    s_load_dword s57, s[4:5], s56 glc
    s_waitcnt lgkmcnt(0)
    s_memtime s[62:63]
    s_waitcnt lgkmcnt(0)
    s_sub_u32 s57, s62, s60
    s_min_u32 s59, s59, s57
    s_memtime s[60:61]
    s_add_u32 s56, s55, 114688
    s_waitcnt lgkmcnt(0)
    s_load_dword s57, s[4:5], s56 glc
    s_waitcnt lgkmcnt(0)
    s_memtime s[62:63]
    s_waitcnt lgkmcnt(0)
    s_sub_u32 s57, s62, s60
    s_min_u32 s58, s58, s57
    s_memtime s[60:61]
    s_add_u32 s56, s55, 122880
    s_waitcnt lgkmcnt(0)
    s_load_dword s57, s[4:5], s56 glc
    s_waitcnt lgkmcnt(0)
    s_memtime s[62:63]
    s_waitcnt lgkmcnt(0)
    s_sub_u32 s57, s62, s60
    s_min_u32 s59, s59, s57
    s_sub_i32 s57, s58, s59
    s_min_i32 s57, s57, 400
    s_max_i32 s57, s57, -400
    s_add_u32 s57, s57, 16777616
    s_getreg_b32 s56, hwreg(HW_REG_XCC_ID)
    s_and_b32 s56, s56, 0
    v_mov_b32 v2, s57
    s_mov_b64 exec, 1
    buffer_atomic_add v2, off, s[64:67], s56 offset:160 sc1
    s_mov_b64 exec, -1
    s_waitcnt vmcnt(0)
ch_nv1:
    s_lshl_b32 s19, s21, 13
    s_add_u32 s19, s19, 131072
    v_add_u32 v30, s19, v0
    s_waitcnt vmcnt(8)
    ds_read_b64_tr_b16 v[192:193], v24 offset:0
    ds_read_b64_tr_b16 v[194:195], v25 offset:0
    ds_read_b64_tr_b16 v[208:209], v26 offset:0
    ds_read_b64_tr_b16 v[210:211], v27 offset:0
    ds_read_b64_tr_b16 v[224:225], v24 offset:64
    ds_read_b64_tr_b16 v[226:227], v25 offset:64
    ds_read_b64_tr_b16 v[240:241], v26 offset:64
    ds_read_b64_tr_b16 v[242:243], v27 offset:64
    s_waitcnt lgkmcnt(0)
    ds_read_b64_tr_b16 v[196:197], v24 offset:4096
    ds_read_b64_tr_b16 v[198:199], v25 offset:4096
    ds_read_b64_tr_b16 v[212:213], v26 offset:4096
    ds_read_b64_tr_b16 v[214:215], v27 offset:4096
    ds_read_b64_tr_b16 v[228:229], v24 offset:4160
    ds_read_b64_tr_b16 v[230:231], v25 offset:4160
    ds_read_b64_tr_b16 v[244:245], v26 offset:4160
    ds_read_b64_tr_b16 v[246:247], v27 offset:4160
    s_waitcnt lgkmcnt(0)
    s_waitcnt vmcnt(0)
    ds_write_b128 v30, v[96:99] offset:0
    ds_write_b128 v30, v[100:103] offset:1024
    ds_write_b128 v30, v[104:107] offset:2048
    ds_write_b128 v30, v[108:111] offset:3072
    ds_write_b128 v30, v[112:115] offset:4096
    ds_write_b128 v30, v[116:119] offset:5120
    ds_write_b128 v30, v[120:123] offset:6144
    ds_write_b128 v30, v[124:127] offset:7168
    s_waitcnt lgkmcnt(0)
    ds_read_b64_tr_b16 v[200:201], v24 offset:0
    ds_read_b64_tr_b16 v[202:203], v25 offset:0
    ds_read_b64_tr_b16 v[216:217], v26 offset:0
    ds_read_b64_tr_b16 v[218:219], v27 offset:0
    ds_read_b64_tr_b16 v[232:233], v24 offset:64
    ds_read_b64_tr_b16 v[234:235], v25 offset:64
    ds_read_b64_tr_b16 v[248:249], v26 offset:64
    ds_read_b64_tr_b16 v[250:251], v27 offset:64
    s_waitcnt lgkmcnt(0)
    ds_read_b64_tr_b16 v[204:205], v24 offset:4096
    ds_read_b64_tr_b16 v[206:207], v25 offset:4096
    ds_read_b64_tr_b16 v[220:221], v26 offset:4096
    ds_read_b64_tr_b16 v[222:223], v27 offset:4096
    ds_read_b64_tr_b16 v[236:237], v24 offset:4160
    ds_read_b64_tr_b16 v[238:239], v25 offset:4160
    ds_read_b64_tr_b16 v[252:253], v26 offset:4160
    ds_read_b64_tr_b16 v[254:255], v27 offset:4160
    s_waitcnt lgkmcnt(0)
    v_lshrrev_b32 v21, 4, v20
    v_and_b32 v22, 2, v20
    v_cmp_eq_u32 s[56:57], 2, v22
    v_and_b32 v23, 15, v20
    v_lshlrev_b32 v21, 2, v21
    v_mov_b32 v8, 0x44444444
    v_mov_b32 v9, 0xeeeeeeee
    v_cndmask_b32 v166, v8, v9, s[56:57]
    v_mov_b32 v8, 0x3f803f80
    v_mov_b32 v9, 0
    v_mov_b32 v10, 0
    v_mov_b32 v11, 0
    v_mov_b32 v4, 0x3f803f80
    v_mov_b32 v5, 0x3f803f80
    v_mov_b32 v6, 0x3f803f80
    v_mov_b32 v7, 0x3f803f80
    s_mov_b32 s29, 0x3e0293ee
    s_lshl_b32 s27, s13, 2
    s_add_u32 s27, s27, s21
    s_lshl_b32 s28, s12, 7
    s_add_u32 s28, s28, 218112000
    v_add_u32 v163, s42, v0
    s_lshl_b32 s17, s21, 2
    s_add_u32 s17, s17, 15872
    v_mov_b32 v164, s17
    v_mov_b32 v167, 15872
    v_and_b32 v24, 15, v20
    v_and_b32 v25, 1, v24
    v_lshlrev_b32 v25, 4, v25
    v_mov_b32 v184, 0x3f80
    v_lshlrev_b32 v25, v25, v184
    v_lshrrev_b32 v24, 1, v24
    v_cmp_eq_u32 vcc, 0, v24
    s_nop 1
    v_cndmask_b32 v184, 0, v25, vcc
    v_cmp_eq_u32 vcc, 1, v24
    s_nop 1
    v_cndmask_b32 v185, 0, v25, vcc
    v_cmp_eq_u32 vcc, 2, v24
    s_nop 1
    v_cndmask_b32 v186, 0, v25, vcc
    v_cmp_eq_u32 vcc, 3, v24
    s_nop 1
    v_cndmask_b32 v187, 0, v25, vcc
    v_lshrrev_b32 v24, 4, v20
    v_bfe_u32 v25, v20, 2, 2
    v_and_b32 v26, 1, v20
    v_lshl_add_u32 v26, v25, 1, v26
    v_lshlrev_b32 v26, 4, v26
    v_lshl_add_u32 v26, v24, 8, v26
    v_bfe_u32 v27, v20, 1, 1
    v_lshl_add_u32 v26, v27, 2, v26
    s_add_u32 s17, s42, 20480
    v_add_u32 v180, s17, v26
    v_and_b32 v26, 3, v20
    v_lshl_add_u32 v27, v24, 2, v25
    v_lshl_add_u32 v27, v26, 4, v27
    v_lshlrev_b32 v27, 4, v27
    v_add_u32 v181, s42, v27
    v_and_b32 v25, 1, v25
    v_lshl_add_u32 v25, v24, 1, v25
    v_lshl_add_u32 v25, v26, 3, v25
    v_lshlrev_b32 v25, 4, v25
    v_add_u32 v182, s17, v25
    s_bfe_u32 s17, s34, 0x20001
    s_lshr_b32 s30, s34, 3
    s_cmp_eq_u32 s17, s21
    s_cselect_b32 s30, s30, 2
    s_and_b32 s33, s34, 1
    s_lshl_b32 s33, s33, 17
    s_mov_b32 s32, 0
    v_add_u32 v24, 0, v21
    v_cmp_gt_u32 s[44:45], v24, v23
    v_add_u32 v24, 1, v21
    v_cmp_gt_u32 s[46:47], v24, v23
    v_add_u32 v24, 2, v21
    v_cmp_gt_u32 s[48:49], v24, v23
    v_add_u32 v24, 3, v21
    v_cmp_gt_u32 s[50:51], v24, v23
    s_cmp_lg_u32 s3, 4
    s_cbranch_scc1 ch_xcc_skip
    v_lshrrev_b32 v56, 2, v0
    v_add_u32 v56, 128, v56
    v_writelane_b32 v56, 0, 10
    v_mov_b32 v59, 63
    v_mov_b32 v60, 32
    v_writelane_b32 v59, 0, 8
    v_writelane_b32 v60, 0, 8
    v_writelane_b32 v59, 0, 9
    v_writelane_b32 v60, 0, 9
    v_writelane_b32 v59, -1, 10
    s_movk_i32 s17, 128
    v_writelane_b32 v60, s17, 10
    s_mov_b64 exec, 0x70f
ch_xcc:
    buffer_load_dword v57, v56, s[64:67], 0 offen sc1
    s_waitcnt vmcnt(0)
    v_and_b32 v62, v59, v57
    v_cmp_ne_u32 vcc, v62, v60
    v_readlane_b32 s18, v57, 8
    v_readlane_b32 s19, v57, 9
    s_add_u32 s17, s18, s19
    s_lshr_b32 s17, s17, 24
    s_cmp_lg_u32 s17, 32
    s_cbranch_scc1 ch_xcc_w
    s_cbranch_vccz ch_xcc_ok
ch_xcc_w:
    s_sleep 16
    s_sub_u32 s22, s22, 1
    s_cbranch_scc0 ch_xcc
    s_mov_b32 s22, 0
ch_xcc_ok:
    s_getreg_b32 s17, hwreg(HW_REG_XCC_ID)
    s_bitcmp1_b32 s17, 2
    s_cselect_b32 s18, s18, s18
    v_readlane_b32 s17, v57, s12
    s_mov_b64 exec, -1
    s_lshr_b32 s19, s18, 24
    s_mul_i32 s19, s19, 400
    s_and_b32 s18, s18, 0xffffff
    s_cmp_gt_u32 s18, s19
    s_cselect_b32 s18, 8192, 0
    v_mov_b32 v58, 15968
    v_mov_b32 v60, s17
    v_mov_b32 v61, s18
    s_barrier
    ds_write_b64 v58, v[60:61]
    s_waitcnt lgkmcnt(0)
    s_branch ch_xcc_b3
ch_xcc_skip:
    s_barrier
ch_xcc_b3:
    s_barrier
    v_mov_b32 v58, 15968
    ds_read_b64 v[60:61], v58
    v_and_b32 v23, 7, v20
    v_lshlrev_b32 v23, 7, v23
    v_bfe_u32 v24, v20, 3, 1
    v_lshl_add_u32 v23, v24, 17, v23
    v_lshrrev_b32 v24, 4, v20
    v_lshl_add_u32 v23, v24, 24, v23
    s_lshl_b32 s19, s14, 14
    s_lshl_b32 s18, s34, 10
    s_add_u32 s19, s19, s18
    s_and_b32 s18, s21, 1
    s_lshl_b32 s18, s18, 18
    s_add_u32 s19, s19, s18
    s_add_u32 s19, s19, 4456448
    s_waitcnt lgkmcnt(0)
    v_readfirstlane_b32 s17, v61
    s_add_u32 s39, s39, s17
ch_g0:
    buffer_load_dword v57, off, s[4:7], s35 sc1
    s_waitcnt vmcnt(0)
    v_readfirstlane_b32 s17, v57
    s_cmp_ge_u32 s17, 8
    s_cbranch_scc1 ch_g0b
    s_sleep 12
    s_sub_u32 s22, s22, 1
    s_cbranch_scc0 ch_g0
    s_mov_b32 s22, 0
ch_g0b:
    s_add_u32 s23, s41, 37748736
    buffer_load_dwordx4 v[128:131], v0, s[4:7], s23 offen offset:0 sc1
    buffer_load_dwordx4 v[132:135], v0, s[4:7], s23 offen offset:1024 sc1
    buffer_load_dwordx4 v[136:139], v0, s[4:7], s23 offen offset:2048 sc1
    buffer_load_dwordx4 v[140:143], v0, s[4:7], s23 offen offset:3072 sc1
    s_add_u32 s24, s41, 37879808
    buffer_load_dwordx4 v[144:147], v0, s[4:7], s24 offen offset:0 sc1
    buffer_load_dwordx4 v[148:151], v0, s[4:7], s24 offen offset:1024 sc1
    buffer_load_dwordx4 v[152:155], v0, s[4:7], s24 offen offset:2048 sc1
    buffer_load_dwordx4 v[156:159], v0, s[4:7], s24 offen offset:3072 sc1
    s_add_u32 s23, s41, 20971520
    buffer_load_dwordx4 v[96:99], v0, s[4:7], s23 offen offset:0 sc1
    buffer_load_dwordx4 v[100:103], v0, s[4:7], s23 offen offset:1024 sc1
    buffer_load_dwordx4 v[104:107], v0, s[4:7], s23 offen offset:2048 sc1
    buffer_load_dwordx4 v[108:111], v0, s[4:7], s23 offen offset:3072 sc1
    s_add_u32 s24, s41, 21102592
    buffer_load_dwordx4 v[112:115], v0, s[4:7], s24 offen offset:0 sc1
    buffer_load_dwordx4 v[116:119], v0, s[4:7], s24 offen offset:1024 sc1
    buffer_load_dwordx4 v[120:123], v0, s[4:7], s24 offen offset:2048 sc1
    buffer_load_dwordx4 v[124:127], v0, s[4:7], s24 offen offset:3072 sc1
    s_mov_b32 exec_hi, 0xffff
    buffer_load_dword v175, v23, s[4:7], s19 offen sc1
    s_mov_b32 exec_hi, -1
    v_mov_b32 v165, 0
    s_waitcnt vmcnt(1)
    ds_write_b32 v164, v165 offset:16
.p2align 6
aloopL_39:
    s_and_b32 s23, s16, 3
    s_lshl_b32 s23, s23, 18
    s_add_u32 s23, s23, s38
    s_add_u32 s24, s23, 4096
    s_and_b32 s25, s16, 3
    s_lshl_b32 s25, s25, 18
    s_add_u32 s25, s25, s39
    s_add_u32 s26, s16, 2
    s_and_b32 s26, s26, 3
    s_lshl_b32 s26, s26, 18
    s_add_u32 s26, s26, s39
    v_mov_b32 v165, s16
    s_waitcnt vmcnt(8)
    s_and_b32 s31, s16, 1
    s_cmp_lt_u32 s16, 16
    s_cselect_b32 s31, 3, s31
    s_cmp_lg_u32 s31, s30
    s_cbranch_scc1 aloopL_39_nd0
    ds_write_b128 v163, v[128:131] offset:0
    ds_write_b128 v163, v[132:135] offset:1024
    ds_write_b128 v163, v[136:139] offset:2048
    ds_write_b128 v163, v[140:143] offset:3072
    ds_write_b128 v163, v[144:147] offset:4096
    ds_write_b128 v163, v[148:151] offset:5120
    ds_write_b128 v163, v[152:155] offset:6144
    ds_write_b128 v163, v[156:159] offset:7168
aloopL_39_nd0:
    v_mfma_f32_16x16x32_bf16 v[48:51], v[128:131], v[192:195], 0
    v_mfma_f32_16x16x32_bf16 v[52:55], v[128:131], v[208:211], 0
    v_mfma_f32_16x16x32_bf16 v[56:59], v[128:131], v[224:227], 0
    v_mfma_f32_16x16x32_bf16 v[60:63], v[128:131], v[240:243], 0
    v_mfma_f32_16x16x32_bf16 v[64:67], v[144:147], v[192:195], 0
    v_mfma_f32_16x16x32_bf16 v[68:71], v[144:147], v[208:211], 0
    v_mfma_f32_16x16x32_bf16 v[72:75], v[144:147], v[224:227], 0
    v_mfma_f32_16x16x32_bf16 v[76:79], v[144:147], v[240:243], 0
    v_mfma_f32_16x16x32_bf16 v[48:51], v[132:135], v[196:199], v[48:51]
    v_mfma_f32_16x16x32_bf16 v[52:55], v[132:135], v[212:215], v[52:55]
    v_mfma_f32_16x16x32_bf16 v[56:59], v[132:135], v[228:231], v[56:59]
    v_mfma_f32_16x16x32_bf16 v[60:63], v[132:135], v[244:247], v[60:63]
    v_mfma_f32_16x16x32_bf16 v[64:67], v[148:151], v[196:199], v[64:67]
    v_mfma_f32_16x16x32_bf16 v[68:71], v[148:151], v[212:215], v[68:71]
    v_mfma_f32_16x16x32_bf16 v[72:75], v[148:151], v[228:231], v[72:75]
    v_mfma_f32_16x16x32_bf16 v[76:79], v[148:151], v[244:247], v[76:79]
    v_mfma_f32_16x16x32_bf16 v[48:51], v[136:139], v[200:203], v[48:51]
    v_mfma_f32_16x16x32_bf16 v[52:55], v[136:139], v[216:219], v[52:55]
    v_mfma_f32_16x16x32_bf16 v[56:59], v[136:139], v[232:235], v[56:59]
    v_mfma_f32_16x16x32_bf16 v[60:63], v[136:139], v[248:251], v[60:63]
    v_mfma_f32_16x16x32_bf16 v[64:67], v[152:155], v[200:203], v[64:67]
    v_mfma_f32_16x16x32_bf16 v[68:71], v[152:155], v[216:219], v[68:71]
    v_mfma_f32_16x16x32_bf16 v[72:75], v[152:155], v[232:235], v[72:75]
    v_mfma_f32_16x16x32_bf16 v[76:79], v[152:155], v[248:251], v[76:79]
    v_mfma_f32_16x16x32_bf16 v[48:51], v[140:143], v[204:207], v[48:51]
    v_mfma_f32_16x16x32_bf16 v[52:55], v[140:143], v[220:223], v[52:55]
    v_mfma_f32_16x16x32_bf16 v[56:59], v[140:143], v[236:239], v[56:59]
    v_mfma_f32_16x16x32_bf16 v[60:63], v[140:143], v[252:255], v[60:63]
    v_mfma_f32_16x16x32_bf16 v[64:67], v[156:159], v[204:207], v[64:67]
    v_mfma_f32_16x16x32_bf16 v[68:71], v[156:159], v[220:223], v[68:71]
    v_mfma_f32_16x16x32_bf16 v[72:75], v[156:159], v[236:239], v[72:75]
    v_mfma_f32_16x16x32_bf16 v[76:79], v[156:159], v[252:255], v[76:79]
    s_nop 2
    v_cvt_pk_bf16_f32 v80, v48, v49
    v_cvt_pk_bf16_f32 v81, v50, v51
    v_cvt_pk_bf16_f32 v82, v64, v65
    v_cvt_pk_bf16_f32 v83, v66, v67
    v_cvt_pk_bf16_f32 v84, v52, v53
    v_cvt_pk_bf16_f32 v85, v54, v55
    v_cvt_pk_bf16_f32 v86, v68, v69
    v_cvt_pk_bf16_f32 v87, v70, v71
    v_cvt_pk_bf16_f32 v88, v56, v57
    v_cvt_pk_bf16_f32 v89, v58, v59
    v_cvt_pk_bf16_f32 v90, v72, v73
    v_cvt_pk_bf16_f32 v91, v74, v75
    v_cvt_pk_bf16_f32 v92, v60, v61
    v_cvt_pk_bf16_f32 v93, v62, v63
    v_cvt_pk_bf16_f32 v94, v76, v77
    v_cvt_pk_bf16_f32 v95, v78, v79
    s_cmp_eq_u32 s32, 0
    s_cbranch_scc1 aloopL_39_p2a
    s_mov_b32 s32, 0
    ds_read_b64_tr_b16 v[128:129], v181 offset:0
    ds_read_b64_tr_b16 v[130:131], v181 offset:4096
    ds_read_b64_tr_b16 v[64:65], v182 offset:0
    ds_read_b64_tr_b16 v[132:133], v181 offset:8
    ds_read_b64_tr_b16 v[134:135], v181 offset:4104
    ds_read_b64_tr_b16 v[66:67], v182 offset:8
    ds_read_b64_tr_b16 v[136:137], v181 offset:1024
    ds_read_b64_tr_b16 v[138:139], v181 offset:5120
    ds_read_b64_tr_b16 v[68:69], v182 offset:512
    ds_read_b64_tr_b16 v[140:141], v181 offset:1032
    ds_read_b64_tr_b16 v[142:143], v181 offset:5128
    ds_read_b64_tr_b16 v[70:71], v182 offset:520
    ds_read_b64_tr_b16 v[144:145], v181 offset:2048
    ds_read_b64_tr_b16 v[146:147], v181 offset:6144
    ds_read_b64_tr_b16 v[72:73], v182 offset:1024
    ds_read_b64_tr_b16 v[148:149], v181 offset:2056
    ds_read_b64_tr_b16 v[150:151], v181 offset:6152
    ds_read_b64_tr_b16 v[74:75], v182 offset:1032
    ds_read_b64_tr_b16 v[152:153], v181 offset:3072
    ds_read_b64_tr_b16 v[154:155], v181 offset:7168
    ds_read_b64_tr_b16 v[76:77], v182 offset:1536
    ds_read_b64_tr_b16 v[156:157], v181 offset:3080
    ds_read_b64_tr_b16 v[158:159], v181 offset:7176
    ds_read_b64_tr_b16 v[78:79], v182 offset:1544
    v_mov_b32 v188, 0xff61b1e6
    s_cmp_eq_u32 s33, 0
    s_cselect_b64 vcc, s[44:45], 0
    v_cndmask_b32 v12, v12, v188, vcc
    s_cselect_b64 vcc, -1, s[44:45]
    v_cndmask_b32 v16, v16, v188, vcc
    s_cselect_b64 vcc, s[46:47], 0
    v_cndmask_b32 v13, v13, v188, vcc
    s_cselect_b64 vcc, -1, s[46:47]
    v_cndmask_b32 v17, v17, v188, vcc
    s_cselect_b64 vcc, s[48:49], 0
    v_cndmask_b32 v14, v14, v188, vcc
    s_cselect_b64 vcc, -1, s[48:49]
    v_cndmask_b32 v18, v18, v188, vcc
    s_cselect_b64 vcc, s[50:51], 0
    v_cndmask_b32 v15, v15, v188, vcc
    s_cselect_b64 vcc, -1, s[50:51]
    v_cndmask_b32 v19, v19, v188, vcc
    v_max3_f32 v2, v12, v13, v14
    v_max3_f32 v3, v15, v16, v17
    v_max3_f32 v2, v2, v18, v19
    v_max3_f32 v3, v3, v20, v21
    v_max_f32 v2, v2, v3
    v_mov_b32 v3, v2
    s_nop 1
    v_permlane16_swap_b32 v3, v2
    v_max_f32 v2, v2, v3
    v_mov_b32 v3, v2
    s_nop 1
    v_permlane32_swap_b32 v3, v2
    v_max_f32 v2, v2, v3
    v_mul_f32 v2, s29, v2
    v_fma_f32 v12, v12, s29, -v2
    v_fma_f32 v13, v13, s29, -v2
    v_fma_f32 v14, v14, s29, -v2
    v_exp_f32 v12, v12
    v_fma_f32 v15, v15, s29, -v2
    v_exp_f32 v13, v13
    v_fma_f32 v16, v16, s29, -v2
    v_exp_f32 v14, v14
    v_fma_f32 v17, v17, s29, -v2
    v_exp_f32 v15, v15
    v_fma_f32 v18, v18, s29, -v2
    v_exp_f32 v16, v16
    v_fma_f32 v19, v19, s29, -v2
    v_exp_f32 v17, v17
    v_fma_f32 v20, v20, s29, -v2
    v_exp_f32 v18, v18
    v_fma_f32 v21, v21, s29, -v2
    v_exp_f32 v19, v19
    v_exp_f32 v20, v20
    v_exp_f32 v21, v21
    v_cvt_pk_bf16_f32 v12, v12, v13
    v_cvt_pk_bf16_f32 v13, v14, v15
    v_cvt_pk_bf16_f32 v14, v16, v17
    v_cvt_pk_bf16_f32 v15, v18, v19
    v_cvt_pk_bf16_f32 v20, v20, v21
    v_mov_b32 v22, 0
    v_mov_b32 v21, 0
    v_mov_b32 v23, 0
    s_waitcnt lgkmcnt(0)
    s_nop 0
    v_mfma_f32_16x16x32_bf16 v[16:19], v[4:7], v[12:15], 0
    v_mfma_f32_16x16x32_bf16 v[16:19], v[4:7], v[20:23], v[16:19]
    v_mfma_f32_16x16x32_bf16 v[24:27], v[128:131], v[12:15], 0
    v_mfma_f32_16x16x32_bf16 v[24:27], v[64:67], v[20:23], v[24:27]
    v_mfma_f32_16x16x32_bf16 v[28:31], v[132:135], v[12:15], 0
    v_mfma_f32_16x16x32_bf16 v[28:31], v[66:69], v[20:23], v[28:31]
    v_mfma_f32_16x16x32_bf16 v[32:35], v[136:139], v[12:15], 0
    v_mfma_f32_16x16x32_bf16 v[32:35], v[68:71], v[20:23], v[32:35]
    v_mfma_f32_16x16x32_bf16 v[36:39], v[140:143], v[12:15], 0
    v_mfma_f32_16x16x32_bf16 v[36:39], v[70:73], v[20:23], v[36:39]
    v_mfma_f32_16x16x32_bf16 v[48:51], v[144:147], v[12:15], 0
    v_mfma_f32_16x16x32_bf16 v[48:51], v[72:75], v[20:23], v[48:51]
    v_mfma_f32_16x16x32_bf16 v[52:55], v[148:151], v[12:15], 0
    v_mfma_f32_16x16x32_bf16 v[52:55], v[74:77], v[20:23], v[52:55]
    v_mfma_f32_16x16x32_bf16 v[56:59], v[152:155], v[12:15], 0
    v_mfma_f32_16x16x32_bf16 v[56:59], v[76:79], v[20:23], v[56:59]
    v_mfma_f32_16x16x32_bf16 v[60:63], v[156:159], v[12:15], 0
    v_mfma_f32_16x16x32_bf16 v[60:63], v[78:81], v[20:23], v[60:63]
    v_rcp_f32 v3, v16
    s_nop 0
    v_mul_f32 v24, v24, v3
    v_mul_f32 v25, v25, v3
    v_mul_f32 v26, v26, v3
    v_mul_f32 v27, v27, v3
    v_mul_f32 v28, v28, v3
    v_mul_f32 v29, v29, v3
    v_mul_f32 v30, v30, v3
    v_mul_f32 v31, v31, v3
    v_cvt_pk_bf16_f32 v24, v24, v25
    v_cvt_pk_bf16_f32 v25, v26, v27
    v_cvt_pk_bf16_f32 v26, v28, v29
    v_cvt_pk_bf16_f32 v27, v30, v31
    ds_write_b128 v0, v[24:27] offset:32768
    v_mul_f32 v32, v32, v3
    v_mul_f32 v33, v33, v3
    v_mul_f32 v34, v34, v3
    v_mul_f32 v35, v35, v3
    v_mul_f32 v36, v36, v3
    v_mul_f32 v37, v37, v3
    v_mul_f32 v38, v38, v3
    v_mul_f32 v39, v39, v3
    v_cvt_pk_bf16_f32 v32, v32, v33
    v_cvt_pk_bf16_f32 v33, v34, v35
    v_cvt_pk_bf16_f32 v34, v36, v37
    v_cvt_pk_bf16_f32 v35, v38, v39
    ds_write_b128 v0, v[32:35] offset:33792
    v_mul_f32 v48, v48, v3
    v_mul_f32 v49, v49, v3
    v_mul_f32 v50, v50, v3
    v_mul_f32 v51, v51, v3
    v_mul_f32 v52, v52, v3
    v_mul_f32 v53, v53, v3
    v_mul_f32 v54, v54, v3
    v_mul_f32 v55, v55, v3
    v_cvt_pk_bf16_f32 v48, v48, v49
    v_cvt_pk_bf16_f32 v49, v50, v51
    v_cvt_pk_bf16_f32 v50, v52, v53
    v_cvt_pk_bf16_f32 v51, v54, v55
    ds_write_b128 v0, v[48:51] offset:34816
    v_mul_f32 v56, v56, v3
    v_mul_f32 v57, v57, v3
    v_mul_f32 v58, v58, v3
    v_mul_f32 v59, v59, v3
    v_mul_f32 v60, v60, v3
    v_mul_f32 v61, v61, v3
    v_mul_f32 v62, v62, v3
    v_mul_f32 v63, v63, v3
    v_cvt_pk_bf16_f32 v56, v56, v57
    v_cvt_pk_bf16_f32 v57, v58, v59
    v_cvt_pk_bf16_f32 v58, v60, v61
    v_cvt_pk_bf16_f32 v59, v62, v63
    ds_write_b128 v0, v[56:59] offset:35840
aloopL_39_p2a:
    v_mov_b32 v24, 0
    v_mov_b32 v25, 0
    v_mov_b32 v26, 0
    v_mov_b32 v27, 0
    v_mov_b32 v28, 0
    v_mov_b32 v29, 0
    v_mov_b32 v30, 0
    v_mov_b32 v31, 0
    v_mov_b32 v32, 0
    v_mov_b32 v33, 0
    v_mov_b32 v34, 0
    v_mov_b32 v35, 0
    v_mov_b32 v36, 0
    v_mov_b32 v37, 0
    v_mov_b32 v38, 0
    v_mov_b32 v39, 0
    s_setprio 2
    s_cmp_lg_u32 s31, s30
    s_cbranch_scc1 aloopL_39_nd1
    s_add_u32 m0, s42, 16384
    s_add_u32 s17, s41, s33
    s_add_u32 s17, s17, 4194304
    buffer_load_dwordx4 v0, s[4:7], s17 offen offset:0 sc1 lds
    buffer_load_dwordx4 v0, s[4:7], s17 offen offset:1024 sc1 lds
    buffer_load_dwordx4 v0, s[4:7], s17 offen offset:2048 sc1 lds
    buffer_load_dwordx4 v0, s[4:7], s17 offen offset:3072 sc1 lds
aloopL_39_nd1:
    s_add_u32 s41, s41, 262144
    s_barrier
    s_sleep 9
    s_waitcnt lgkmcnt(0)
    buffer_load_dwordx4 v[48:51], v0, s[4:7], s23 offen offset:0 sc1
    buffer_load_dwordx4 v[52:55], v0, s[4:7], s23 offen offset:1024 sc1
    buffer_load_dwordx4 v[56:59], v0, s[4:7], s23 offen offset:2048 sc1
    buffer_load_dwordx4 v[60:63], v0, s[4:7], s23 offen offset:3072 sc1
    s_sleep 2
    buffer_load_dwordx4 v[64:67], v0, s[4:7], s24 offen offset:0 sc1
    buffer_load_dwordx4 v[68:71], v0, s[4:7], s24 offen offset:1024 sc1
    s_waitcnt vmcnt(5)
    v_mfma_f32_16x16x32_bf16 v[12:15], v[96:99], v[48:51], 0
    v_mfma_f32_16x16x32_bf16 v[16:19], v[112:115], v[48:51], 0
    v_max_u32 v3, v48, v50
    v_cmp_eq_u32 vcc, -1, v3
    v_mfma_f32_16x16x32_bf16 v[20:23], v[48:51], v[48:51], 0
    s_cbranch_vccnz aloopL_39_rq_0
    s_waitcnt vmcnt(4)
    v_mfma_f32_16x16x32_bf16 v[12:15], v[100:103], v[52:55], v[12:15]
    v_mfma_f32_16x16x32_bf16 v[16:19], v[116:119], v[52:55], v[16:19]
    v_max_u32 v3, v52, v54
    v_cmp_eq_u32 vcc, -1, v3
    v_mfma_f32_16x16x32_bf16 v[20:23], v[52:55], v[52:55], v[20:23]
    s_cbranch_vccnz aloopL_39_rq_1
    s_waitcnt vmcnt(3)
    v_mfma_f32_16x16x32_bf16 v[12:15], v[104:107], v[56:59], v[12:15]
    v_mfma_f32_16x16x32_bf16 v[16:19], v[120:123], v[56:59], v[16:19]
    v_max_u32 v3, v56, v58
    v_cmp_eq_u32 vcc, -1, v3
    v_mfma_f32_16x16x32_bf16 v[20:23], v[56:59], v[56:59], v[20:23]
    s_cbranch_vccnz aloopL_39_rq_2
    s_waitcnt vmcnt(2)
    v_mfma_f32_16x16x32_bf16 v[12:15], v[108:111], v[60:63], v[12:15]
    v_mfma_f32_16x16x32_bf16 v[16:19], v[124:127], v[60:63], v[16:19]
    v_max_u32 v3, v60, v62
    v_cmp_eq_u32 vcc, -1, v3
    v_mfma_f32_16x16x32_bf16 v[20:23], v[60:63], v[60:63], v[20:23]
    s_cbranch_vccnz aloopL_39_rq_3
aloopL_39_sdone:
    s_nop 1
    ds_write_b32 v164, v165
    s_nop 0
    v_max3_f32 v2, v12, v13, v14
    v_max3_f32 v3, v15, v16, v17
    v_max3_f32 v2, v2, v18, v19
    v_max3_f32 v3, v3, v20, v21
    v_max_f32 v2, v2, v3
    v_mov_b32 v3, v2
    s_nop 1
    v_permlane16_swap_b32 v3, v2
    v_max_f32 v2, v2, v3
    v_mov_b32 v3, v2
    s_waitcnt vmcnt(0)
    v_max3_u32 v188, v64, v66, v68
    v_permlane32_swap_b32 v3, v2
    v_max_f32 v2, v2, v3
    v_max_u32 v188, v188, v70
    v_mul_f32 v2, s29, v2
    v_cmp_eq_u32 vcc, -1, v188
    v_fma_f32 v12, v12, s29, -v2
    v_fma_f32 v13, v13, s29, -v2
    s_cbranch_vccnz aloopL_39_rq_v
aloopL_39_vok:
    v_smfmac_f32_16x16x64_bf16 v[24:27], v[64:67], v[192:199], v166
    v_fma_f32 v14, v14, s29, -v2
    v_exp_f32 v12, v12
    v_smfmac_f32_16x16x64_bf16 v[32:35], v[64:67], v[224:231], v166
    s_add_u32 s17, s41, 37748736
    buffer_load_dwordx4 v[128:131], v0, s[4:7], s17 offen offset:0 sc1
    v_fma_f32 v15, v15, s29, -v2
    v_exp_f32 v13, v13
    v_smfmac_f32_16x16x64_bf16 v[28:31], v[64:67], v[208:215], v166
    buffer_load_dwordx4 v[132:135], v0, s[4:7], s17 offen offset:1024 sc1
    v_fma_f32 v16, v16, s29, -v2
    v_exp_f32 v14, v14
    v_smfmac_f32_16x16x64_bf16 v[36:39], v[64:67], v[240:247], v166
    buffer_load_dwordx4 v[136:139], v0, s[4:7], s17 offen offset:2048 sc1
    v_fma_f32 v17, v17, s29, -v2
    v_exp_f32 v15, v15
    v_smfmac_f32_16x16x64_bf16 v[24:27], v[68:71], v[200:207], v166
    buffer_load_dwordx4 v[140:143], v0, s[4:7], s17 offen offset:3072 sc1
    v_fma_f32 v18, v18, s29, -v2
    v_exp_f32 v16, v16
    v_smfmac_f32_16x16x64_bf16 v[32:35], v[68:71], v[232:239], v166
    s_add_u32 s18, s41, 37879808
    buffer_load_dwordx4 v[144:147], v0, s[4:7], s18 offen offset:0 sc1
    v_fma_f32 v19, v19, s29, -v2
    v_exp_f32 v17, v17
    v_smfmac_f32_16x16x64_bf16 v[28:31], v[68:71], v[216:223], v166
    buffer_load_dwordx4 v[148:151], v0, s[4:7], s18 offen offset:1024 sc1
    v_fma_f32 v20, v20, s29, -v2
    v_exp_f32 v18, v18
    v_smfmac_f32_16x16x64_bf16 v[36:39], v[68:71], v[248:255], v166
    buffer_load_dwordx4 v[152:155], v0, s[4:7], s18 offen offset:2048 sc1
    v_fma_f32 v21, v21, s29, -v2
    v_exp_f32 v19, v19
    buffer_load_dwordx4 v[156:159], v0, s[4:7], s18 offen offset:3072 sc1
    v_exp_f32 v20, v20
    v_exp_f32 v21, v21
    v_cvt_pk_bf16_f32 v12, v12, v13
    v_cvt_pk_bf16_f32 v13, v14, v15
    v_cvt_pk_bf16_f32 v14, v16, v17
    v_cvt_pk_bf16_f32 v15, v18, v19
    v_cvt_pk_bf16_f32 v20, v20, v21
    v_mov_b32 v22, 0
    v_mfma_f32_16x16x32_bf16 v[16:19], v[4:7], v[12:15], 0
    v_mov_b32 v21, v20
    v_mov_b32 v23, 0
    v_cvt_pk_bf16_f32 v40, v24, v25
    v_cvt_pk_bf16_f32 v41, v26, v27
    v_mfma_f32_16x16x32_bf16 v[16:19], v[8:11], v[20:23], v[16:19]
    v_mfma_f32_16x16x32_bf16 v[24:27], v[80:83], v[12:15], 0
    v_cvt_pk_bf16_f32 v44, v32, v33
    v_cvt_pk_bf16_f32 v45, v34, v35
    v_mfma_f32_16x16x32_bf16 v[32:35], v[88:91], v[12:15], 0
    v_cvt_pk_bf16_f32 v42, v28, v29
    v_cvt_pk_bf16_f32 v43, v30, v31
    v_mfma_f32_16x16x32_bf16 v[28:31], v[84:87], v[12:15], 0
    v_cvt_pk_bf16_f32 v46, v36, v37
    v_cvt_pk_bf16_f32 v47, v38, v39
    v_mfma_f32_16x16x32_bf16 v[36:39], v[92:95], v[12:15], 0
aloopL_39_midE:
    s_mov_b64 vcc, s[56:57]
    v_rcp_f32 v3, v16
    v_mfma_f32_16x16x32_bf16 v[24:27], v[40:43], v[20:23], v[24:27]
    v_mfma_f32_16x16x32_bf16 v[32:35], v[44:47], v[20:23], v[32:35]
    v_mfma_f32_16x16x32_bf16 v[28:31], v[42:45], v[20:23], v[28:31]
    v_mfma_f32_16x16x32_bf16 v[36:39], v[46:49], v[20:23], v[36:39]
    v_mov_b32_dpp v3, v3 quad_perm:[2,3,2,3] row_mask:0xf bank_mask:0xf
    s_nop 4
    v_cndmask_b32_dpp v24, v32, v24, vcc quad_perm:[2,3,2,3] row_mask:0xf bank_mask:0xf
    v_cndmask_b32_dpp v25, v33, v25, vcc quad_perm:[2,3,2,3] row_mask:0xf bank_mask:0xf
    v_cndmask_b32_dpp v26, v34, v26, vcc quad_perm:[2,3,2,3] row_mask:0xf bank_mask:0xf
    v_cndmask_b32_dpp v27, v35, v27, vcc quad_perm:[2,3,2,3] row_mask:0xf bank_mask:0xf
    v_cndmask_b32_dpp v28, v36, v28, vcc quad_perm:[2,3,2,3] row_mask:0xf bank_mask:0xf
    v_cndmask_b32_dpp v29, v37, v29, vcc quad_perm:[2,3,2,3] row_mask:0xf bank_mask:0xf
    v_cndmask_b32_dpp v30, v38, v30, vcc quad_perm:[2,3,2,3] row_mask:0xf bank_mask:0xf
    v_cndmask_b32_dpp v31, v39, v31, vcc quad_perm:[2,3,2,3] row_mask:0xf bank_mask:0xf
    v_mul_f32 v24, v24, v3
    v_mul_f32 v25, v25, v3
    v_mul_f32 v26, v26, v3
    v_mul_f32 v27, v27, v3
    v_mul_f32 v28, v28, v3
    v_mul_f32 v29, v29, v3
    v_mul_f32 v30, v30, v3
    v_mul_f32 v31, v31, v3
    v_cvt_pk_bf16_f32 v168, v24, v25
    v_cvt_pk_bf16_f32 v169, v26, v27
    v_cvt_pk_bf16_f32 v170, v28, v29
    v_cvt_pk_bf16_f32 v171, v30, v31
    ds_write_b128 v160, v[168:171]
    s_waitcnt lgkmcnt(0)
    s_barrier
    ds_read_b128 v[172:175], v161
    s_waitcnt lgkmcnt(0)
    v_mfma_f32_16x16x32_bf16 v[24:27], v[184:187], v[172:175], 0
    s_nop 7
    v_cvt_pk_bf16_f32 v168, v24, v25
    v_cvt_pk_bf16_f32 v169, v26, v27
    s_nop 0
    v_permlane16_swap_b32 v168, v170
    v_permlane16_swap_b32 v169, v171
    s_mov_b64 exec, 0xffff
    v_min_u32 v168, -2, v168
    buffer_store_dwordx4 v[168:171], v1, s[4:7], s25 offen sc1
    s_setprio 0
    buffer_store_dwordx4 v[176:179], v1, s[4:7], s26 offen sc1
    s_mov_b64 exec, -1
    s_cmp_lg_u32 s27, 0
    s_cbranch_scc1 pg_40
    s_sub_u32 s21, s16, 1
    s_cbranch_scc1 pg_40
    s_and_b32 s17, s21, 3
    s_cmp_ge_u32 s16, 58
    s_cselect_b32 s17, 0, s17
    s_cmp_lg_u32 s17, 0
    s_cbranch_scc1 pg_40
    v_mov_b32 v3, s21
    s_mov_b64 exec, 1
    buffer_store_dword v3, off, s[4:7], s28 sc1
    s_mov_b64 exec, -1
pg_40:
    s_cmp_lg_u32 s31, s30
    s_cbranch_scc1 aloopL_39_nd2
    ds_read_b128 v[24:27], v163 offset:16384
    ds_read_b128 v[28:31], v163 offset:17408
    ds_read_b128 v[32:35], v163 offset:18432
    ds_read_b128 v[36:39], v163 offset:19456
    ds_write_b32 v180, v64 offset:0
    ds_write_b32 v180, v65 offset:8
    ds_write_b32 v180, v66 offset:128
    ds_write_b32 v180, v67 offset:136
    ds_write_b32 v180, v68 offset:1024
    ds_write_b32 v180, v69 offset:1032
    ds_write_b32 v180, v70 offset:1152
    ds_write_b32 v180, v71 offset:1160
    s_mov_b32 s32, 1
    s_waitcnt lgkmcnt(11)
    v_mfma_f32_16x16x32_bf16 v[12:15], v[96:99], v[24:27], 0
    v_mfma_f32_16x16x32_bf16 v[16:19], v[112:115], v[24:27], 0
    v_mfma_f32_16x16x32_bf16 v[20:23], v[48:51], v[24:27], 0
    s_waitcnt lgkmcnt(10)
    v_mfma_f32_16x16x32_bf16 v[12:15], v[100:103], v[28:31], v[12:15]
    v_mfma_f32_16x16x32_bf16 v[16:19], v[116:119], v[28:31], v[16:19]
    v_mfma_f32_16x16x32_bf16 v[20:23], v[52:55], v[28:31], v[20:23]
    s_waitcnt lgkmcnt(9)
    v_mfma_f32_16x16x32_bf16 v[12:15], v[104:107], v[32:35], v[12:15]
    v_mfma_f32_16x16x32_bf16 v[16:19], v[120:123], v[32:35], v[16:19]
    v_mfma_f32_16x16x32_bf16 v[20:23], v[56:59], v[32:35], v[20:23]
    s_waitcnt lgkmcnt(8)
    v_mfma_f32_16x16x32_bf16 v[12:15], v[108:111], v[36:39], v[12:15]
    v_mfma_f32_16x16x32_bf16 v[16:19], v[124:127], v[36:39], v[16:19]
    v_mfma_f32_16x16x32_bf16 v[20:23], v[60:63], v[36:39], v[20:23]
    s_waitcnt lgkmcnt(0)
    s_nop 3
aloopL_39_nd2:
    s_add_u32 s17, s41, 20971520
    buffer_load_dwordx4 v[96:99], v0, s[4:7], s17 offen offset:0 sc1
    buffer_load_dwordx4 v[100:103], v0, s[4:7], s17 offen offset:1024 sc1
    buffer_load_dwordx4 v[104:107], v0, s[4:7], s17 offen offset:2048 sc1
    buffer_load_dwordx4 v[108:111], v0, s[4:7], s17 offen offset:3072 sc1
    s_add_u32 s18, s41, 21102592
    buffer_load_dwordx4 v[112:115], v0, s[4:7], s18 offen offset:0 sc1
    buffer_load_dwordx4 v[116:119], v0, s[4:7], s18 offen offset:1024 sc1
    buffer_load_dwordx4 v[120:123], v0, s[4:7], s18 offen offset:2048 sc1
    buffer_load_dwordx4 v[124:127], v0, s[4:7], s18 offen offset:3072 sc1
    s_add_u32 s16, s16, 1
    s_cmp_lt_u32 s16, 48
    s_cbranch_scc1 aloopL_39
    s_waitcnt vmcnt(0)
    ds_write_b128 v163, v[128:131] offset:8192
    ds_write_b128 v163, v[132:135] offset:9216
    ds_write_b128 v163, v[136:139] offset:10240
    ds_write_b128 v163, v[140:143] offset:11264
    ds_write_b128 v163, v[144:147] offset:12288
    ds_write_b128 v163, v[148:151] offset:13312
    ds_write_b128 v163, v[152:155] offset:14336
    ds_write_b128 v163, v[156:159] offset:15360
    s_waitcnt lgkmcnt(0)
    s_cmp_eq_u32 s32, 0
    s_cbranch_scc1 aloopL_39_p2b
    s_mov_b32 s32, 0
    ds_read_b64_tr_b16 v[128:129], v181 offset:0
    ds_read_b64_tr_b16 v[130:131], v181 offset:4096
    ds_read_b64_tr_b16 v[64:65], v182 offset:0
    ds_read_b64_tr_b16 v[132:133], v181 offset:8
    ds_read_b64_tr_b16 v[134:135], v181 offset:4104
    ds_read_b64_tr_b16 v[66:67], v182 offset:8
    ds_read_b64_tr_b16 v[136:137], v181 offset:1024
    ds_read_b64_tr_b16 v[138:139], v181 offset:5120
    ds_read_b64_tr_b16 v[68:69], v182 offset:512
    ds_read_b64_tr_b16 v[140:141], v181 offset:1032
    ds_read_b64_tr_b16 v[142:143], v181 offset:5128
    ds_read_b64_tr_b16 v[70:71], v182 offset:520
    ds_read_b64_tr_b16 v[144:145], v181 offset:2048
    ds_read_b64_tr_b16 v[146:147], v181 offset:6144
    ds_read_b64_tr_b16 v[72:73], v182 offset:1024
    ds_read_b64_tr_b16 v[148:149], v181 offset:2056
    ds_read_b64_tr_b16 v[150:151], v181 offset:6152
    ds_read_b64_tr_b16 v[74:75], v182 offset:1032
    ds_read_b64_tr_b16 v[152:153], v181 offset:3072
    ds_read_b64_tr_b16 v[154:155], v181 offset:7168
    ds_read_b64_tr_b16 v[76:77], v182 offset:1536
    ds_read_b64_tr_b16 v[156:157], v181 offset:3080
    ds_read_b64_tr_b16 v[158:159], v181 offset:7176
    ds_read_b64_tr_b16 v[78:79], v182 offset:1544
    v_mov_b32 v188, 0xff61b1e6
    s_cmp_eq_u32 s33, 0
    s_cselect_b64 vcc, s[44:45], 0
    v_cndmask_b32 v12, v12, v188, vcc
    s_cselect_b64 vcc, -1, s[44:45]
    v_cndmask_b32 v16, v16, v188, vcc
    s_cselect_b64 vcc, s[46:47], 0
    v_cndmask_b32 v13, v13, v188, vcc
    s_cselect_b64 vcc, -1, s[46:47]
    v_cndmask_b32 v17, v17, v188, vcc
    s_cselect_b64 vcc, s[48:49], 0
    v_cndmask_b32 v14, v14, v188, vcc
    s_cselect_b64 vcc, -1, s[48:49]
    v_cndmask_b32 v18, v18, v188, vcc
    s_cselect_b64 vcc, s[50:51], 0
    v_cndmask_b32 v15, v15, v188, vcc
    s_cselect_b64 vcc, -1, s[50:51]
    v_cndmask_b32 v19, v19, v188, vcc
    v_max3_f32 v2, v12, v13, v14
    v_max3_f32 v3, v15, v16, v17
    v_max3_f32 v2, v2, v18, v19
    v_max3_f32 v3, v3, v20, v21
    v_max_f32 v2, v2, v3
    v_mov_b32 v3, v2
    s_nop 1
    v_permlane16_swap_b32 v3, v2
    v_max_f32 v2, v2, v3
    v_mov_b32 v3, v2
    s_nop 1
    v_permlane32_swap_b32 v3, v2
    v_max_f32 v2, v2, v3
    v_mul_f32 v2, s29, v2
    v_fma_f32 v12, v12, s29, -v2
    v_fma_f32 v13, v13, s29, -v2
    v_fma_f32 v14, v14, s29, -v2
    v_exp_f32 v12, v12
    v_fma_f32 v15, v15, s29, -v2
    v_exp_f32 v13, v13
    v_fma_f32 v16, v16, s29, -v2
    v_exp_f32 v14, v14
    v_fma_f32 v17, v17, s29, -v2
    v_exp_f32 v15, v15
    v_fma_f32 v18, v18, s29, -v2
    v_exp_f32 v16, v16
    v_fma_f32 v19, v19, s29, -v2
    v_exp_f32 v17, v17
    v_fma_f32 v20, v20, s29, -v2
    v_exp_f32 v18, v18
    v_fma_f32 v21, v21, s29, -v2
    v_exp_f32 v19, v19
    v_exp_f32 v20, v20
    v_exp_f32 v21, v21
    v_cvt_pk_bf16_f32 v12, v12, v13
    v_cvt_pk_bf16_f32 v13, v14, v15
    v_cvt_pk_bf16_f32 v14, v16, v17
    v_cvt_pk_bf16_f32 v15, v18, v19
    v_cvt_pk_bf16_f32 v20, v20, v21
    v_mov_b32 v22, 0
    v_mov_b32 v21, 0
    v_mov_b32 v23, 0
    s_waitcnt lgkmcnt(0)
    s_nop 0
    v_mfma_f32_16x16x32_bf16 v[16:19], v[4:7], v[12:15], 0
    v_mfma_f32_16x16x32_bf16 v[16:19], v[4:7], v[20:23], v[16:19]
    v_mfma_f32_16x16x32_bf16 v[24:27], v[128:131], v[12:15], 0
    v_mfma_f32_16x16x32_bf16 v[24:27], v[64:67], v[20:23], v[24:27]
    v_mfma_f32_16x16x32_bf16 v[28:31], v[132:135], v[12:15], 0
    v_mfma_f32_16x16x32_bf16 v[28:31], v[66:69], v[20:23], v[28:31]
    v_mfma_f32_16x16x32_bf16 v[32:35], v[136:139], v[12:15], 0
    v_mfma_f32_16x16x32_bf16 v[32:35], v[68:71], v[20:23], v[32:35]
    v_mfma_f32_16x16x32_bf16 v[36:39], v[140:143], v[12:15], 0
    v_mfma_f32_16x16x32_bf16 v[36:39], v[70:73], v[20:23], v[36:39]
    v_mfma_f32_16x16x32_bf16 v[48:51], v[144:147], v[12:15], 0
    v_mfma_f32_16x16x32_bf16 v[48:51], v[72:75], v[20:23], v[48:51]
    v_mfma_f32_16x16x32_bf16 v[52:55], v[148:151], v[12:15], 0
    v_mfma_f32_16x16x32_bf16 v[52:55], v[74:77], v[20:23], v[52:55]
    v_mfma_f32_16x16x32_bf16 v[56:59], v[152:155], v[12:15], 0
    v_mfma_f32_16x16x32_bf16 v[56:59], v[76:79], v[20:23], v[56:59]
    v_mfma_f32_16x16x32_bf16 v[60:63], v[156:159], v[12:15], 0
    v_mfma_f32_16x16x32_bf16 v[60:63], v[78:81], v[20:23], v[60:63]
    v_rcp_f32 v3, v16
    s_nop 0
    v_mul_f32 v24, v24, v3
    v_mul_f32 v25, v25, v3
    v_mul_f32 v26, v26, v3
    v_mul_f32 v27, v27, v3
    v_mul_f32 v28, v28, v3
    v_mul_f32 v29, v29, v3
    v_mul_f32 v30, v30, v3
    v_mul_f32 v31, v31, v3
    v_cvt_pk_bf16_f32 v24, v24, v25
    v_cvt_pk_bf16_f32 v25, v26, v27
    v_cvt_pk_bf16_f32 v26, v28, v29
    v_cvt_pk_bf16_f32 v27, v30, v31
    ds_write_b128 v0, v[24:27] offset:32768
    v_mul_f32 v32, v32, v3
    v_mul_f32 v33, v33, v3
    v_mul_f32 v34, v34, v3
    v_mul_f32 v35, v35, v3
    v_mul_f32 v36, v36, v3
    v_mul_f32 v37, v37, v3
    v_mul_f32 v38, v38, v3
    v_mul_f32 v39, v39, v3
    v_cvt_pk_bf16_f32 v32, v32, v33
    v_cvt_pk_bf16_f32 v33, v34, v35
    v_cvt_pk_bf16_f32 v34, v36, v37
    v_cvt_pk_bf16_f32 v35, v38, v39
    ds_write_b128 v0, v[32:35] offset:33792
    v_mul_f32 v48, v48, v3
    v_mul_f32 v49, v49, v3
    v_mul_f32 v50, v50, v3
    v_mul_f32 v51, v51, v3
    v_mul_f32 v52, v52, v3
    v_mul_f32 v53, v53, v3
    v_mul_f32 v54, v54, v3
    v_mul_f32 v55, v55, v3
    v_cvt_pk_bf16_f32 v48, v48, v49
    v_cvt_pk_bf16_f32 v49, v50, v51
    v_cvt_pk_bf16_f32 v50, v52, v53
    v_cvt_pk_bf16_f32 v51, v54, v55
    ds_write_b128 v0, v[48:51] offset:34816
    v_mul_f32 v56, v56, v3
    v_mul_f32 v57, v57, v3
    v_mul_f32 v58, v58, v3
    v_mul_f32 v59, v59, v3
    v_mul_f32 v60, v60, v3
    v_mul_f32 v61, v61, v3
    v_mul_f32 v62, v62, v3
    v_mul_f32 v63, v63, v3
    v_cvt_pk_bf16_f32 v56, v56, v57
    v_cvt_pk_bf16_f32 v57, v58, v59
    v_cvt_pk_bf16_f32 v58, v60, v61
    v_cvt_pk_bf16_f32 v59, v62, v63
    ds_write_b128 v0, v[56:59] offset:35840
aloopL_39_p2b:
    s_waitcnt lgkmcnt(0)
    s_branch aloopH_38
aloopL_39_rq_0:
    s_sub_u32 s22, s22, 1
    s_cbranch_scc1 aloopL_39_rq_0_g
    buffer_load_dwordx4 v[48:51], v0, s[4:7], s23 offen offset:0 sc1
    buffer_load_dwordx4 v[52:55], v0, s[4:7], s23 offen offset:1024 sc1
    buffer_load_dwordx4 v[56:59], v0, s[4:7], s23 offen offset:2048 sc1
    buffer_load_dwordx4 v[60:63], v0, s[4:7], s23 offen offset:3072 sc1
    buffer_load_dwordx4 v[64:67], v0, s[4:7], s24 offen offset:0 sc1
    buffer_load_dwordx4 v[68:71], v0, s[4:7], s24 offen offset:1024 sc1
    s_waitcnt vmcnt(5)
    v_max_u32 v3, v48, v50
    v_cmp_eq_u32 vcc, -1, v3
    s_cbranch_vccnz aloopL_39_rq_0
    s_branch aloopL_39_again
aloopL_39_rq_0_g:
    s_mov_b32 s22, 0
    s_waitcnt vmcnt(0)
    s_branch aloopL_39_nochk
aloopL_39_rq_1:
    s_sub_u32 s22, s22, 1
    s_cbranch_scc1 aloopL_39_rq_1_g
    buffer_load_dwordx4 v[52:55], v0, s[4:7], s23 offen offset:1024 sc1
    buffer_load_dwordx4 v[56:59], v0, s[4:7], s23 offen offset:2048 sc1
    buffer_load_dwordx4 v[60:63], v0, s[4:7], s23 offen offset:3072 sc1
    buffer_load_dwordx4 v[64:67], v0, s[4:7], s24 offen offset:0 sc1
    buffer_load_dwordx4 v[68:71], v0, s[4:7], s24 offen offset:1024 sc1
    s_waitcnt vmcnt(4)
    v_max_u32 v3, v52, v54
    v_cmp_eq_u32 vcc, -1, v3
    s_cbranch_vccnz aloopL_39_rq_1
    s_branch aloopL_39_again
aloopL_39_rq_1_g:
    s_mov_b32 s22, 0
    s_waitcnt vmcnt(0)
    s_branch aloopL_39_nochk
aloopL_39_rq_2:
    s_sub_u32 s22, s22, 1
    s_cbranch_scc1 aloopL_39_rq_2_g
    buffer_load_dwordx4 v[56:59], v0, s[4:7], s23 offen offset:2048 sc1
    buffer_load_dwordx4 v[60:63], v0, s[4:7], s23 offen offset:3072 sc1
    buffer_load_dwordx4 v[64:67], v0, s[4:7], s24 offen offset:0 sc1
    buffer_load_dwordx4 v[68:71], v0, s[4:7], s24 offen offset:1024 sc1
    s_waitcnt vmcnt(3)
    v_max_u32 v3, v56, v58
    v_cmp_eq_u32 vcc, -1, v3
    s_cbranch_vccnz aloopL_39_rq_2
    s_branch aloopL_39_again
aloopL_39_rq_2_g:
    s_mov_b32 s22, 0
    s_waitcnt vmcnt(0)
    s_branch aloopL_39_nochk
aloopL_39_rq_3:
    s_sub_u32 s22, s22, 1
    s_cbranch_scc1 aloopL_39_rq_3_g
    buffer_load_dwordx4 v[60:63], v0, s[4:7], s23 offen offset:3072 sc1
    buffer_load_dwordx4 v[64:67], v0, s[4:7], s24 offen offset:0 sc1
    buffer_load_dwordx4 v[68:71], v0, s[4:7], s24 offen offset:1024 sc1
    s_waitcnt vmcnt(2)
    v_max_u32 v3, v60, v62
    v_cmp_eq_u32 vcc, -1, v3
    s_cbranch_vccnz aloopL_39_rq_3
    s_branch aloopL_39_again
aloopL_39_rq_3_g:
    s_mov_b32 s22, 0
    s_waitcnt vmcnt(0)
    s_branch aloopL_39_nochk
aloopL_39_again:
    s_waitcnt vmcnt(5)
    v_mfma_f32_16x16x32_bf16 v[12:15], v[96:99], v[48:51], 0
    v_mfma_f32_16x16x32_bf16 v[16:19], v[112:115], v[48:51], 0
    v_max_u32 v3, v48, v50
    v_cmp_eq_u32 vcc, -1, v3
    v_mfma_f32_16x16x32_bf16 v[20:23], v[48:51], v[48:51], 0
    s_cbranch_vccnz aloopL_39_rq_0
    s_waitcnt vmcnt(4)
    v_mfma_f32_16x16x32_bf16 v[12:15], v[100:103], v[52:55], v[12:15]
    v_mfma_f32_16x16x32_bf16 v[16:19], v[116:119], v[52:55], v[16:19]
    v_max_u32 v3, v52, v54
    v_cmp_eq_u32 vcc, -1, v3
    v_mfma_f32_16x16x32_bf16 v[20:23], v[52:55], v[52:55], v[20:23]
    s_cbranch_vccnz aloopL_39_rq_1
    s_waitcnt vmcnt(3)
    v_mfma_f32_16x16x32_bf16 v[12:15], v[104:107], v[56:59], v[12:15]
    v_mfma_f32_16x16x32_bf16 v[16:19], v[120:123], v[56:59], v[16:19]
    v_max_u32 v3, v56, v58
    v_cmp_eq_u32 vcc, -1, v3
    v_mfma_f32_16x16x32_bf16 v[20:23], v[56:59], v[56:59], v[20:23]
    s_cbranch_vccnz aloopL_39_rq_2
    s_waitcnt vmcnt(2)
    v_mfma_f32_16x16x32_bf16 v[12:15], v[108:111], v[60:63], v[12:15]
    v_mfma_f32_16x16x32_bf16 v[16:19], v[124:127], v[60:63], v[16:19]
    v_max_u32 v3, v60, v62
    v_cmp_eq_u32 vcc, -1, v3
    v_mfma_f32_16x16x32_bf16 v[20:23], v[60:63], v[60:63], v[20:23]
    s_cbranch_vccnz aloopL_39_rq_3
    s_branch aloopL_39_sdone
aloopL_39_rq_v:
    s_sub_u32 s22, s22, 1
    s_cbranch_scc1 aloopL_39_rq_vg
    buffer_load_dwordx4 v[64:67], v0, s[4:7], s24 offen offset:0 sc1
    buffer_load_dwordx4 v[68:71], v0, s[4:7], s24 offen offset:1024 sc1
    s_waitcnt vmcnt(0)
    v_max3_u32 v188, v64, v66, v68
    v_max_u32 v188, v188, v70
    v_cmp_eq_u32 vcc, -1, v188
    s_cbranch_vccnz aloopL_39_rq_v
    s_branch aloopL_39_vok
aloopL_39_rq_vg:
    s_mov_b32 s22, 0
    s_branch aloopL_39_vok
aloopL_39_nochk:
    v_mfma_f32_16x16x32_bf16 v[12:15], v[96:99], v[48:51], 0
    v_mfma_f32_16x16x32_bf16 v[16:19], v[112:115], v[48:51], 0
    v_mfma_f32_16x16x32_bf16 v[20:23], v[48:51], v[48:51], 0
    v_mfma_f32_16x16x32_bf16 v[12:15], v[100:103], v[52:55], v[12:15]
    v_mfma_f32_16x16x32_bf16 v[16:19], v[116:119], v[52:55], v[16:19]
    v_mfma_f32_16x16x32_bf16 v[20:23], v[52:55], v[52:55], v[20:23]
    v_mfma_f32_16x16x32_bf16 v[12:15], v[104:107], v[56:59], v[12:15]
    v_mfma_f32_16x16x32_bf16 v[16:19], v[120:123], v[56:59], v[16:19]
    v_mfma_f32_16x16x32_bf16 v[20:23], v[56:59], v[56:59], v[20:23]
    v_mfma_f32_16x16x32_bf16 v[12:15], v[108:111], v[60:63], v[12:15]
    v_mfma_f32_16x16x32_bf16 v[16:19], v[124:127], v[60:63], v[16:19]
    v_mfma_f32_16x16x32_bf16 v[20:23], v[60:63], v[60:63], v[20:23]
    s_nop 1
    s_branch aloopL_39_sdone
ct_aH:
.p2align 6
aloopH_38:
    s_and_b32 s23, s16, 3
    s_lshl_b32 s23, s23, 18
    s_add_u32 s23, s23, s38
    s_add_u32 s24, s23, 4096
    s_and_b32 s25, s16, 3
    s_lshl_b32 s25, s25, 18
    s_add_u32 s25, s25, s39
    s_add_u32 s26, s16, 2
    s_and_b32 s26, s26, 3
    s_lshl_b32 s26, s26, 18
    s_add_u32 s26, s26, s39
    v_mov_b32 v165, s16
aloopH_38_wkv:
    ds_read_b32 v188, v164 offset:16
    s_waitcnt lgkmcnt(0)
    v_readfirstlane_b32 s19, v188
    s_cmp_ge_i32 s19, s16
    s_cbranch_scc1 aloopH_38_wkvok
    s_sleep 1
    s_branch aloopH_38_wkv
aloopH_38_wkvok:
    ds_read_b128 v[128:131], v163 offset:8192
    ds_read_b128 v[144:147], v163 offset:12288
    ds_read_b128 v[132:135], v163 offset:9216
    ds_read_b128 v[148:151], v163 offset:13312
    ds_read_b128 v[136:139], v163 offset:10240
    ds_read_b128 v[152:155], v163 offset:14336
    ds_read_b128 v[140:143], v163 offset:11264
    ds_read_b128 v[156:159], v163 offset:15360
    s_waitcnt lgkmcnt(6)
    v_mfma_f32_16x16x32_bf16 v[48:51], v[128:131], v[192:195], 0
    v_mfma_f32_16x16x32_bf16 v[52:55], v[128:131], v[208:211], 0
    v_mfma_f32_16x16x32_bf16 v[56:59], v[128:131], v[224:227], 0
    v_mfma_f32_16x16x32_bf16 v[60:63], v[128:131], v[240:243], 0
    v_mfma_f32_16x16x32_bf16 v[64:67], v[144:147], v[192:195], 0
    v_mfma_f32_16x16x32_bf16 v[68:71], v[144:147], v[208:211], 0
    v_mfma_f32_16x16x32_bf16 v[72:75], v[144:147], v[224:227], 0
    v_mfma_f32_16x16x32_bf16 v[76:79], v[144:147], v[240:243], 0
    s_setprio 2
aloopH_38_wm:
    ds_read_b32 v188, v164 offset:32
    s_waitcnt lgkmcnt(0)
    v_readfirstlane_b32 s19, v188
    s_cmp_ge_i32 s19, s16
    s_cbranch_scc1 aloopH_38_wmok
    s_sleep 1
    s_branch aloopH_38_wm
aloopH_38_wmok:
    s_add_u32 m0, s42, 16384
    s_add_u32 s17, s41, 4194304
    buffer_load_dwordx4 v0, s[4:7], s17 offen offset:0 sc1 lds
    buffer_load_dwordx4 v0, s[4:7], s17 offen offset:1024 sc1 lds
    buffer_load_dwordx4 v0, s[4:7], s17 offen offset:2048 sc1 lds
    buffer_load_dwordx4 v0, s[4:7], s17 offen offset:3072 sc1 lds
    s_add_u32 m0, s42, 20480
    s_add_u32 s17, s41, 4325376
    buffer_load_dwordx4 v0, s[4:7], s17 offen offset:0 sc1 lds
    buffer_load_dwordx4 v0, s[4:7], s17 offen offset:1024 sc1 lds
    buffer_load_dwordx4 v0, s[4:7], s17 offen offset:2048 sc1 lds
    buffer_load_dwordx4 v0, s[4:7], s17 offen offset:3072 sc1 lds
    s_add_u32 s41, s41, 262144
    s_barrier
    s_waitcnt lgkmcnt(4)
    v_mfma_f32_16x16x32_bf16 v[48:51], v[132:135], v[196:199], v[48:51]
    v_mfma_f32_16x16x32_bf16 v[52:55], v[132:135], v[212:215], v[52:55]
    v_mfma_f32_16x16x32_bf16 v[56:59], v[132:135], v[228:231], v[56:59]
    v_mfma_f32_16x16x32_bf16 v[60:63], v[132:135], v[244:247], v[60:63]
    v_mfma_f32_16x16x32_bf16 v[64:67], v[148:151], v[196:199], v[64:67]
    v_mfma_f32_16x16x32_bf16 v[68:71], v[148:151], v[212:215], v[68:71]
    v_mfma_f32_16x16x32_bf16 v[72:75], v[148:151], v[228:231], v[72:75]
    v_mfma_f32_16x16x32_bf16 v[76:79], v[148:151], v[244:247], v[76:79]
    s_waitcnt lgkmcnt(2)
    v_mfma_f32_16x16x32_bf16 v[48:51], v[136:139], v[200:203], v[48:51]
    v_mfma_f32_16x16x32_bf16 v[52:55], v[136:139], v[216:219], v[52:55]
    v_mfma_f32_16x16x32_bf16 v[56:59], v[136:139], v[232:235], v[56:59]
    v_mfma_f32_16x16x32_bf16 v[60:63], v[136:139], v[248:251], v[60:63]
    v_mfma_f32_16x16x32_bf16 v[64:67], v[152:155], v[200:203], v[64:67]
    v_mfma_f32_16x16x32_bf16 v[68:71], v[152:155], v[216:219], v[68:71]
    v_mfma_f32_16x16x32_bf16 v[72:75], v[152:155], v[232:235], v[72:75]
    v_mfma_f32_16x16x32_bf16 v[76:79], v[152:155], v[248:251], v[76:79]
    s_waitcnt lgkmcnt(0)
    v_mfma_f32_16x16x32_bf16 v[48:51], v[140:143], v[204:207], v[48:51]
    v_mfma_f32_16x16x32_bf16 v[52:55], v[140:143], v[220:223], v[52:55]
    v_mfma_f32_16x16x32_bf16 v[56:59], v[140:143], v[236:239], v[56:59]
    v_mfma_f32_16x16x32_bf16 v[60:63], v[140:143], v[252:255], v[60:63]
    v_mfma_f32_16x16x32_bf16 v[64:67], v[156:159], v[204:207], v[64:67]
    v_mfma_f32_16x16x32_bf16 v[68:71], v[156:159], v[220:223], v[68:71]
    v_mfma_f32_16x16x32_bf16 v[72:75], v[156:159], v[236:239], v[72:75]
    v_mfma_f32_16x16x32_bf16 v[76:79], v[156:159], v[252:255], v[76:79]
    s_nop 2
    v_cvt_pk_bf16_f32 v80, v48, v49
    v_cvt_pk_bf16_f32 v81, v50, v51
    v_cvt_pk_bf16_f32 v82, v64, v65
    v_cvt_pk_bf16_f32 v83, v66, v67
    v_cvt_pk_bf16_f32 v84, v52, v53
    v_cvt_pk_bf16_f32 v85, v54, v55
    v_cvt_pk_bf16_f32 v86, v68, v69
    v_cvt_pk_bf16_f32 v87, v70, v71
    v_cvt_pk_bf16_f32 v88, v56, v57
    v_cvt_pk_bf16_f32 v89, v58, v59
    v_cvt_pk_bf16_f32 v90, v72, v73
    v_cvt_pk_bf16_f32 v91, v74, v75
    v_cvt_pk_bf16_f32 v92, v60, v61
    v_cvt_pk_bf16_f32 v93, v62, v63
    v_cvt_pk_bf16_f32 v94, v76, v77
    v_cvt_pk_bf16_f32 v95, v78, v79
    v_mov_b32 v24, 0
    v_mov_b32 v25, 0
    v_mov_b32 v26, 0
    v_mov_b32 v27, 0
    v_mov_b32 v28, 0
    v_mov_b32 v29, 0
    v_mov_b32 v30, 0
    v_mov_b32 v31, 0
    v_mov_b32 v32, 0
    v_mov_b32 v33, 0
    v_mov_b32 v34, 0
    v_mov_b32 v35, 0
    v_mov_b32 v36, 0
    v_mov_b32 v37, 0
    v_mov_b32 v38, 0
    v_mov_b32 v39, 0
    s_waitcnt lgkmcnt(0)
    buffer_load_dwordx4 v[48:51], v0, s[4:7], s23 offen offset:0 sc1
    buffer_load_dwordx4 v[52:55], v0, s[4:7], s23 offen offset:1024 sc1
    buffer_load_dwordx4 v[56:59], v0, s[4:7], s23 offen offset:2048 sc1
    buffer_load_dwordx4 v[60:63], v0, s[4:7], s23 offen offset:3072 sc1
    s_sleep 2
    buffer_load_dwordx4 v[64:67], v0, s[4:7], s24 offen offset:0 sc1
    buffer_load_dwordx4 v[68:71], v0, s[4:7], s24 offen offset:1024 sc1
    s_waitcnt vmcnt(5)
    v_mfma_f32_16x16x32_bf16 v[12:15], v[96:99], v[48:51], 0
    v_mfma_f32_16x16x32_bf16 v[16:19], v[112:115], v[48:51], 0
    v_max_u32 v3, v48, v50
    v_cmp_eq_u32 vcc, -1, v3
    v_mfma_f32_16x16x32_bf16 v[20:23], v[48:51], v[48:51], 0
    s_cbranch_vccnz aloopH_38_rq_0
    s_waitcnt vmcnt(4)
    v_mfma_f32_16x16x32_bf16 v[12:15], v[100:103], v[52:55], v[12:15]
    v_mfma_f32_16x16x32_bf16 v[16:19], v[116:119], v[52:55], v[16:19]
    v_max_u32 v3, v52, v54
    v_cmp_eq_u32 vcc, -1, v3
    v_mfma_f32_16x16x32_bf16 v[20:23], v[52:55], v[52:55], v[20:23]
    s_cbranch_vccnz aloopH_38_rq_1
    s_waitcnt vmcnt(3)
    v_mfma_f32_16x16x32_bf16 v[12:15], v[104:107], v[56:59], v[12:15]
    v_mfma_f32_16x16x32_bf16 v[16:19], v[120:123], v[56:59], v[16:19]
    v_max_u32 v3, v56, v58
    v_cmp_eq_u32 vcc, -1, v3
    v_mfma_f32_16x16x32_bf16 v[20:23], v[56:59], v[56:59], v[20:23]
    s_cbranch_vccnz aloopH_38_rq_2
    s_waitcnt vmcnt(2)
    v_mfma_f32_16x16x32_bf16 v[12:15], v[108:111], v[60:63], v[12:15]
    v_mfma_f32_16x16x32_bf16 v[16:19], v[124:127], v[60:63], v[16:19]
    v_max_u32 v3, v60, v62
    v_cmp_eq_u32 vcc, -1, v3
    v_mfma_f32_16x16x32_bf16 v[20:23], v[60:63], v[60:63], v[20:23]
    s_cbranch_vccnz aloopH_38_rq_3
aloopH_38_sdone:
    s_cmp_eq_u32 s16, 63
    s_cbranch_scc1 aloopH_38_lsk
    ds_write_b32 v164, v165
    s_nop 0
    v_max3_f32 v2, v12, v13, v14
    v_max3_f32 v3, v15, v16, v17
    v_max3_f32 v2, v2, v18, v19
    v_max3_f32 v3, v3, v20, v21
    v_max_f32 v2, v2, v3
    v_mov_b32 v3, v2
    s_nop 1
    v_permlane16_swap_b32 v3, v2
    v_max_f32 v2, v2, v3
    v_mov_b32 v3, v2
    s_waitcnt vmcnt(0)
    v_max3_u32 v188, v64, v66, v68
    v_permlane32_swap_b32 v3, v2
    v_max_f32 v2, v2, v3
    v_max_u32 v188, v188, v70
    v_mul_f32 v2, s29, v2
    v_cmp_eq_u32 vcc, -1, v188
    v_fma_f32 v12, v12, s29, -v2
    v_fma_f32 v13, v13, s29, -v2
    s_cbranch_vccnz aloopH_38_rq_v
aloopH_38_vok:
    v_smfmac_f32_16x16x64_bf16 v[24:27], v[64:67], v[192:199], v166
    v_fma_f32 v14, v14, s29, -v2
    v_exp_f32 v12, v12
    v_smfmac_f32_16x16x64_bf16 v[32:35], v[64:67], v[224:231], v166
    v_fma_f32 v15, v15, s29, -v2
    v_exp_f32 v13, v13
    v_smfmac_f32_16x16x64_bf16 v[28:31], v[64:67], v[208:215], v166
    v_fma_f32 v16, v16, s29, -v2
    v_exp_f32 v14, v14
    v_smfmac_f32_16x16x64_bf16 v[36:39], v[64:67], v[240:247], v166
    v_fma_f32 v17, v17, s29, -v2
    v_exp_f32 v15, v15
    v_smfmac_f32_16x16x64_bf16 v[24:27], v[68:71], v[200:207], v166
    v_fma_f32 v18, v18, s29, -v2
    v_exp_f32 v16, v16
    v_smfmac_f32_16x16x64_bf16 v[32:35], v[68:71], v[232:239], v166
    v_fma_f32 v19, v19, s29, -v2
    v_exp_f32 v17, v17
    v_smfmac_f32_16x16x64_bf16 v[28:31], v[68:71], v[216:223], v166
    v_fma_f32 v20, v20, s29, -v2
    v_exp_f32 v18, v18
    v_smfmac_f32_16x16x64_bf16 v[36:39], v[68:71], v[248:255], v166
    v_fma_f32 v21, v21, s29, -v2
    v_exp_f32 v19, v19
    v_exp_f32 v20, v20
    v_exp_f32 v21, v21
    v_cvt_pk_bf16_f32 v12, v12, v13
    v_cvt_pk_bf16_f32 v13, v14, v15
    v_cvt_pk_bf16_f32 v14, v16, v17
    v_cvt_pk_bf16_f32 v15, v18, v19
    v_cvt_pk_bf16_f32 v20, v20, v21
    v_mov_b32 v22, 0
    v_mfma_f32_16x16x32_bf16 v[16:19], v[4:7], v[12:15], 0
    v_mov_b32 v21, v20
    v_mov_b32 v23, 0
    v_cvt_pk_bf16_f32 v40, v24, v25
    v_cvt_pk_bf16_f32 v41, v26, v27
    v_mfma_f32_16x16x32_bf16 v[16:19], v[8:11], v[20:23], v[16:19]
    v_mfma_f32_16x16x32_bf16 v[24:27], v[80:83], v[12:15], 0
    v_cvt_pk_bf16_f32 v44, v32, v33
    v_cvt_pk_bf16_f32 v45, v34, v35
    v_mfma_f32_16x16x32_bf16 v[32:35], v[88:91], v[12:15], 0
    v_cvt_pk_bf16_f32 v42, v28, v29
    v_cvt_pk_bf16_f32 v43, v30, v31
    v_mfma_f32_16x16x32_bf16 v[28:31], v[84:87], v[12:15], 0
    v_cvt_pk_bf16_f32 v46, v36, v37
    v_cvt_pk_bf16_f32 v47, v38, v39
    v_mfma_f32_16x16x32_bf16 v[36:39], v[92:95], v[12:15], 0
aloopH_38_midE:
    s_mov_b64 vcc, s[56:57]
    v_rcp_f32 v3, v16
    v_mfma_f32_16x16x32_bf16 v[24:27], v[40:43], v[20:23], v[24:27]
    v_mfma_f32_16x16x32_bf16 v[32:35], v[44:47], v[20:23], v[32:35]
    v_mfma_f32_16x16x32_bf16 v[28:31], v[42:45], v[20:23], v[28:31]
    v_mfma_f32_16x16x32_bf16 v[36:39], v[46:49], v[20:23], v[36:39]
    v_mov_b32_dpp v3, v3 quad_perm:[2,3,2,3] row_mask:0xf bank_mask:0xf
    s_nop 4
    v_cndmask_b32_dpp v24, v32, v24, vcc quad_perm:[2,3,2,3] row_mask:0xf bank_mask:0xf
    v_cndmask_b32_dpp v25, v33, v25, vcc quad_perm:[2,3,2,3] row_mask:0xf bank_mask:0xf
    v_cndmask_b32_dpp v26, v34, v26, vcc quad_perm:[2,3,2,3] row_mask:0xf bank_mask:0xf
    v_cndmask_b32_dpp v27, v35, v27, vcc quad_perm:[2,3,2,3] row_mask:0xf bank_mask:0xf
    v_cndmask_b32_dpp v28, v36, v28, vcc quad_perm:[2,3,2,3] row_mask:0xf bank_mask:0xf
    v_cndmask_b32_dpp v29, v37, v29, vcc quad_perm:[2,3,2,3] row_mask:0xf bank_mask:0xf
    v_cndmask_b32_dpp v30, v38, v30, vcc quad_perm:[2,3,2,3] row_mask:0xf bank_mask:0xf
    v_cndmask_b32_dpp v31, v39, v31, vcc quad_perm:[2,3,2,3] row_mask:0xf bank_mask:0xf
    v_mul_f32 v24, v24, v3
    v_mul_f32 v25, v25, v3
    v_mul_f32 v26, v26, v3
    v_mul_f32 v27, v27, v3
    v_mul_f32 v28, v28, v3
    v_mul_f32 v29, v29, v3
    v_mul_f32 v30, v30, v3
    v_mul_f32 v31, v31, v3
    v_cvt_pk_bf16_f32 v168, v24, v25
    v_cvt_pk_bf16_f32 v169, v26, v27
    v_cvt_pk_bf16_f32 v170, v28, v29
    v_cvt_pk_bf16_f32 v171, v30, v31
    ds_write_b128 v160, v[168:171]
    s_waitcnt lgkmcnt(0)
    s_barrier
    ds_read_b128 v[172:175], v161
    s_waitcnt lgkmcnt(0)
    v_mfma_f32_16x16x32_bf16 v[24:27], v[184:187], v[172:175], 0
    s_nop 7
    v_cvt_pk_bf16_f32 v168, v24, v25
    v_cvt_pk_bf16_f32 v169, v26, v27
    s_nop 0
    v_permlane16_swap_b32 v168, v170
    v_permlane16_swap_b32 v169, v171
    s_mov_b64 exec, 0xffff
    v_min_u32 v168, -2, v168
    buffer_store_dwordx4 v[168:171], v1, s[4:7], s25 offen sc1
    s_setprio 0
    buffer_store_dwordx4 v[176:179], v1, s[4:7], s26 offen sc1
    s_mov_b64 exec, -1
    s_cmp_lg_u32 s27, 0
    s_cbranch_scc1 pg_41
    s_sub_u32 s21, s16, 1
    s_cbranch_scc1 pg_41
    s_and_b32 s17, s21, 3
    s_cmp_ge_u32 s16, 58
    s_cselect_b32 s17, 0, s17
    s_cmp_lg_u32 s17, 0
    s_cbranch_scc1 pg_41
    v_mov_b32 v3, s21
    s_mov_b64 exec, 1
    buffer_store_dword v3, off, s[4:7], s28 sc1
    s_mov_b64 exec, -1
pg_41:
aloopH_38_lskb:
    v_mov_b32 v64, 0xff61b1e6
    ds_read_b128 v[128:131], v163 offset:16384
    ds_read_b128 v[132:135], v163 offset:17408
    ds_read_b128 v[136:139], v163 offset:18432
    ds_read_b128 v[140:143], v163 offset:19456
    ds_read_b128 v[144:147], v163 offset:20480
    ds_read_b128 v[148:151], v163 offset:21504
    ds_read_b128 v[152:155], v163 offset:22528
    ds_read_b128 v[156:159], v163 offset:23552
    s_waitcnt lgkmcnt(4)
    v_mfma_f32_16x16x32_bf16 v[12:15], v[96:99], v[128:131], 0
    v_mfma_f32_16x16x32_bf16 v[20:23], v[48:51], v[128:131], 0
    v_mfma_f32_16x16x32_bf16 v[12:15], v[100:103], v[132:135], v[12:15]
    v_mfma_f32_16x16x32_bf16 v[20:23], v[52:55], v[132:135], v[20:23]
    v_mfma_f32_16x16x32_bf16 v[12:15], v[104:107], v[136:139], v[12:15]
    v_mfma_f32_16x16x32_bf16 v[20:23], v[56:59], v[136:139], v[20:23]
    v_mfma_f32_16x16x32_bf16 v[12:15], v[108:111], v[140:143], v[12:15]
    v_mfma_f32_16x16x32_bf16 v[20:23], v[60:63], v[140:143], v[20:23]
    s_waitcnt lgkmcnt(0)
    v_mfma_f32_16x16x32_bf16 v[68:71], v[96:99], v[144:147], 0
    v_mfma_f32_16x16x32_bf16 v[72:75], v[112:115], v[144:147], 0
    v_mfma_f32_16x16x32_bf16 v[76:79], v[48:51], v[144:147], 0
    v_mfma_f32_16x16x32_bf16 v[68:71], v[100:103], v[148:151], v[68:71]
    v_mfma_f32_16x16x32_bf16 v[72:75], v[116:119], v[148:151], v[72:75]
    v_mfma_f32_16x16x32_bf16 v[76:79], v[52:55], v[148:151], v[76:79]
    v_mfma_f32_16x16x32_bf16 v[68:71], v[104:107], v[152:155], v[68:71]
    v_mfma_f32_16x16x32_bf16 v[72:75], v[120:123], v[152:155], v[72:75]
    v_mfma_f32_16x16x32_bf16 v[76:79], v[56:59], v[152:155], v[76:79]
    v_mfma_f32_16x16x32_bf16 v[68:71], v[108:111], v[156:159], v[68:71]
    v_mfma_f32_16x16x32_bf16 v[72:75], v[124:127], v[156:159], v[72:75]
    v_mfma_f32_16x16x32_bf16 v[76:79], v[60:63], v[156:159], v[76:79]
    v_cndmask_b32 v12, v12, v64, s[44:45]
    v_cndmask_b32 v13, v13, v64, s[46:47]
    v_cndmask_b32 v14, v14, v64, s[48:49]
    v_cndmask_b32 v15, v15, v64, s[50:51]
    s_add_u32 s17, s41, 20971520
    buffer_load_dwordx4 v[96:99], v0, s[4:7], s17 offen offset:0 sc1
    v_max3_f32 v2, v12, v13, v14
    buffer_load_dwordx4 v[100:103], v0, s[4:7], s17 offen offset:1024 sc1
    v_max3_f32 v3, v15, v20, v21
    buffer_load_dwordx4 v[104:107], v0, s[4:7], s17 offen offset:2048 sc1
    v_max_f32 v2, v2, v3
    buffer_load_dwordx4 v[108:111], v0, s[4:7], s17 offen offset:3072 sc1
    v_mov_b32 v3, v2
    s_add_u32 s18, s41, 21102592
    buffer_load_dwordx4 v[112:115], v0, s[4:7], s18 offen offset:0 sc1
    s_nop 1
    buffer_load_dwordx4 v[116:119], v0, s[4:7], s18 offen offset:1024 sc1
    v_permlane16_swap_b32 v3, v2
    buffer_load_dwordx4 v[120:123], v0, s[4:7], s18 offen offset:2048 sc1
    v_max_f32 v2, v2, v3
    buffer_load_dwordx4 v[124:127], v0, s[4:7], s18 offen offset:3072 sc1
    v_mov_b32 v3, v2
    s_nop 1
    v_permlane32_swap_b32 v3, v2
    v_max_f32 v2, v2, v3
    v_mul_f32 v2, s29, v2
    v_fma_f32 v12, v12, s29, -v2
    v_fma_f32 v13, v13, s29, -v2
    v_fma_f32 v14, v14, s29, -v2
    v_exp_f32 v12, v12
    v_fma_f32 v15, v15, s29, -v2
    v_exp_f32 v13, v13
    v_fma_f32 v20, v20, s29, -v2
    v_exp_f32 v14, v14
    v_fma_f32 v21, v21, s29, -v2
    v_exp_f32 v15, v15
    v_exp_f32 v20, v20
    v_exp_f32 v21, v21
    v_cvt_pk_bf16_f32 v12, v12, v13
    v_cvt_pk_bf16_f32 v13, v14, v15
    v_mov_b32 v14, 0
    v_mov_b32 v15, 0
    v_cvt_pk_bf16_f32 v20, v20, v21
    v_mov_b32 v22, 0
    v_mov_b32 v21, v20
    v_mov_b32 v23, 0
    s_nop 1
    v_cndmask_b32 v72, v72, v64, s[44:45]
    v_mfma_f32_16x16x32_bf16 v[16:19], v[4:7], v[12:15], 0
    v_cndmask_b32 v73, v73, v64, s[46:47]
    v_cndmask_b32 v74, v74, v64, s[48:49]
    v_mfma_f32_16x16x32_bf16 v[16:19], v[8:11], v[20:23], v[16:19]
    v_cndmask_b32 v75, v75, v64, s[50:51]
    v_max3_f32 v2, v68, v69, v70
    v_mfma_f32_16x16x32_bf16 v[24:27], v[80:83], v[12:15], 0
    v_max3_f32 v3, v71, v72, v73
    v_max3_f32 v2, v2, v74, v75
    v_mfma_f32_16x16x32_bf16 v[24:27], v[40:43], v[20:23], v[24:27]
    v_max3_f32 v3, v3, v76, v77
    v_max_f32 v2, v2, v3
    v_mfma_f32_16x16x32_bf16 v[28:31], v[84:87], v[12:15], 0
    v_mov_b32 v3, v2
    s_nop 1
    v_mfma_f32_16x16x32_bf16 v[28:31], v[42:45], v[20:23], v[28:31]
    v_permlane16_swap_b32 v3, v2
    v_max_f32 v2, v2, v3
    v_mfma_f32_16x16x32_bf16 v[32:35], v[88:91], v[12:15], 0
    v_mov_b32 v3, v2
    s_nop 1
    v_mfma_f32_16x16x32_bf16 v[32:35], v[44:47], v[20:23], v[32:35]
    v_permlane32_swap_b32 v3, v2
    v_max_f32 v2, v2, v3
    v_mfma_f32_16x16x32_bf16 v[36:39], v[92:95], v[12:15], 0
    v_mul_f32 v2, s29, v2
    v_fma_f32 v68, v68, s29, -v2
    v_mfma_f32_16x16x32_bf16 v[36:39], v[46:49], v[20:23], v[36:39]
    v_fma_f32 v69, v69, s29, -v2
    v_fma_f32 v70, v70, s29, -v2
    v_exp_f32 v68, v68
    v_fma_f32 v71, v71, s29, -v2
    v_exp_f32 v69, v69
    v_fma_f32 v72, v72, s29, -v2
    v_exp_f32 v70, v70
    v_fma_f32 v73, v73, s29, -v2
    v_exp_f32 v71, v71
    v_fma_f32 v74, v74, s29, -v2
    v_exp_f32 v72, v72
    v_fma_f32 v75, v75, s29, -v2
    v_exp_f32 v73, v73
    v_fma_f32 v76, v76, s29, -v2
    v_exp_f32 v74, v74
    v_fma_f32 v77, v77, s29, -v2
    v_exp_f32 v75, v75
    v_exp_f32 v76, v76
    v_exp_f32 v77, v77
    v_cvt_pk_bf16_f32 v68, v68, v69
    v_cvt_pk_bf16_f32 v69, v70, v71
    v_cvt_pk_bf16_f32 v70, v72, v73
    v_cvt_pk_bf16_f32 v71, v74, v75
    v_cvt_pk_bf16_f32 v76, v76, v77
    v_mov_b32 v78, 0
    v_mov_b32 v77, v76
    v_mov_b32 v79, 0
    v_rcp_f32 v66, v16
    s_nop 0
    v_mul_f32 v24, v24, v66
    v_mul_f32 v25, v25, v66
    v_mul_f32 v26, v26, v66
    v_mul_f32 v27, v27, v66
    v_cvt_pk_bf16_f32 v168, v24, v25
    v_cvt_pk_bf16_f32 v169, v26, v27
    v_mul_f32 v28, v28, v66
    v_mul_f32 v29, v29, v66
    v_mul_f32 v30, v30, v66
    v_mul_f32 v31, v31, v66
    v_cvt_pk_bf16_f32 v170, v28, v29
    v_cvt_pk_bf16_f32 v171, v30, v31
    v_mul_f32 v32, v32, v66
    v_mul_f32 v33, v33, v66
    v_mul_f32 v34, v34, v66
    v_mul_f32 v35, v35, v66
    v_cvt_pk_bf16_f32 v172, v32, v33
    v_cvt_pk_bf16_f32 v173, v34, v35
    v_mul_f32 v36, v36, v66
    v_mul_f32 v37, v37, v66
    v_mul_f32 v38, v38, v66
    v_mul_f32 v39, v39, v66
    v_cvt_pk_bf16_f32 v174, v36, v37
    v_cvt_pk_bf16_f32 v175, v38, v39
    ds_write_b128 v162, v[168:171] offset:0
    ds_write_b128 v162, v[172:175] offset:2048
    v_mfma_f32_16x16x32_bf16 v[72:75], v[4:7], v[68:71], 0
    v_mfma_f32_16x16x32_bf16 v[72:75], v[8:11], v[76:79], v[72:75]
    v_mfma_f32_16x16x32_bf16 v[24:27], v[80:83], v[68:71], 0
    v_mfma_f32_16x16x32_bf16 v[24:27], v[40:43], v[76:79], v[24:27]
    v_mfma_f32_16x16x32_bf16 v[28:31], v[84:87], v[68:71], 0
    v_mfma_f32_16x16x32_bf16 v[28:31], v[42:45], v[76:79], v[28:31]
    v_mfma_f32_16x16x32_bf16 v[32:35], v[88:91], v[68:71], 0
    v_mfma_f32_16x16x32_bf16 v[32:35], v[44:47], v[76:79], v[32:35]
    v_mfma_f32_16x16x32_bf16 v[36:39], v[92:95], v[68:71], 0
    v_mfma_f32_16x16x32_bf16 v[36:39], v[46:49], v[76:79], v[36:39]
    v_rcp_f32 v3, v72
    s_nop 0
    v_mul_f32 v24, v24, v3
    v_mul_f32 v25, v25, v3
    v_mul_f32 v26, v26, v3
    v_mul_f32 v27, v27, v3
    v_cvt_pk_bf16_f32 v168, v24, v25
    v_cvt_pk_bf16_f32 v169, v26, v27
    v_mul_f32 v28, v28, v3
    v_mul_f32 v29, v29, v3
    v_mul_f32 v30, v30, v3
    v_mul_f32 v31, v31, v3
    v_cvt_pk_bf16_f32 v170, v28, v29
    v_cvt_pk_bf16_f32 v171, v30, v31
    v_mul_f32 v32, v32, v3
    v_mul_f32 v33, v33, v3
    v_mul_f32 v34, v34, v3
    v_mul_f32 v35, v35, v3
    v_cvt_pk_bf16_f32 v172, v32, v33
    v_cvt_pk_bf16_f32 v173, v34, v35
    v_mul_f32 v36, v36, v3
    v_mul_f32 v37, v37, v3
    v_mul_f32 v38, v38, v3
    v_mul_f32 v39, v39, v3
    v_cvt_pk_bf16_f32 v174, v36, v37
    v_cvt_pk_bf16_f32 v175, v38, v39
    ds_write_b128 v162, v[168:171] offset:256
    ds_write_b128 v162, v[172:175] offset:2304
    v_xor_b32 v162, 0x4000, v162
    s_add_u32 s16, s16, 1
    s_cmp_le_u32 s16, 63
    s_cbranch_scc1 aloopH_38
    s_waitcnt lgkmcnt(0)
    s_barrier
    s_waitcnt vmcnt(0)
    s_branch k_end
aloopH_38_rq_0:
    s_sub_u32 s22, s22, 1
    s_cbranch_scc1 aloopH_38_rq_0_g
    buffer_load_dwordx4 v[48:51], v0, s[4:7], s23 offen offset:0 sc1
    buffer_load_dwordx4 v[52:55], v0, s[4:7], s23 offen offset:1024 sc1
    buffer_load_dwordx4 v[56:59], v0, s[4:7], s23 offen offset:2048 sc1
    buffer_load_dwordx4 v[60:63], v0, s[4:7], s23 offen offset:3072 sc1
    buffer_load_dwordx4 v[64:67], v0, s[4:7], s24 offen offset:0 sc1
    buffer_load_dwordx4 v[68:71], v0, s[4:7], s24 offen offset:1024 sc1
    s_waitcnt vmcnt(5)
    v_max_u32 v3, v48, v50
    v_cmp_eq_u32 vcc, -1, v3
    s_cbranch_vccnz aloopH_38_rq_0
    s_branch aloopH_38_again
aloopH_38_rq_0_g:
    s_mov_b32 s22, 0
    s_waitcnt vmcnt(0)
    s_branch aloopH_38_nochk
aloopH_38_rq_1:
    s_sub_u32 s22, s22, 1
    s_cbranch_scc1 aloopH_38_rq_1_g
    buffer_load_dwordx4 v[52:55], v0, s[4:7], s23 offen offset:1024 sc1
    buffer_load_dwordx4 v[56:59], v0, s[4:7], s23 offen offset:2048 sc1
    buffer_load_dwordx4 v[60:63], v0, s[4:7], s23 offen offset:3072 sc1
    buffer_load_dwordx4 v[64:67], v0, s[4:7], s24 offen offset:0 sc1
    buffer_load_dwordx4 v[68:71], v0, s[4:7], s24 offen offset:1024 sc1
    s_waitcnt vmcnt(4)
    v_max_u32 v3, v52, v54
    v_cmp_eq_u32 vcc, -1, v3
    s_cbranch_vccnz aloopH_38_rq_1
    s_branch aloopH_38_again
aloopH_38_rq_1_g:
    s_mov_b32 s22, 0
    s_waitcnt vmcnt(0)
    s_branch aloopH_38_nochk
aloopH_38_rq_2:
    s_sub_u32 s22, s22, 1
    s_cbranch_scc1 aloopH_38_rq_2_g
    buffer_load_dwordx4 v[56:59], v0, s[4:7], s23 offen offset:2048 sc1
    buffer_load_dwordx4 v[60:63], v0, s[4:7], s23 offen offset:3072 sc1
    buffer_load_dwordx4 v[64:67], v0, s[4:7], s24 offen offset:0 sc1
    buffer_load_dwordx4 v[68:71], v0, s[4:7], s24 offen offset:1024 sc1
    s_waitcnt vmcnt(3)
    v_max_u32 v3, v56, v58
    v_cmp_eq_u32 vcc, -1, v3
    s_cbranch_vccnz aloopH_38_rq_2
    s_branch aloopH_38_again
aloopH_38_rq_2_g:
    s_mov_b32 s22, 0
    s_waitcnt vmcnt(0)
    s_branch aloopH_38_nochk
aloopH_38_rq_3:
    s_sub_u32 s22, s22, 1
    s_cbranch_scc1 aloopH_38_rq_3_g
    buffer_load_dwordx4 v[60:63], v0, s[4:7], s23 offen offset:3072 sc1
    buffer_load_dwordx4 v[64:67], v0, s[4:7], s24 offen offset:0 sc1
    buffer_load_dwordx4 v[68:71], v0, s[4:7], s24 offen offset:1024 sc1
    s_waitcnt vmcnt(2)
    v_max_u32 v3, v60, v62
    v_cmp_eq_u32 vcc, -1, v3
    s_cbranch_vccnz aloopH_38_rq_3
    s_branch aloopH_38_again
aloopH_38_rq_3_g:
    s_mov_b32 s22, 0
    s_waitcnt vmcnt(0)
    s_branch aloopH_38_nochk
aloopH_38_again:
    s_waitcnt vmcnt(5)
    v_mfma_f32_16x16x32_bf16 v[12:15], v[96:99], v[48:51], 0
    v_mfma_f32_16x16x32_bf16 v[16:19], v[112:115], v[48:51], 0
    v_max_u32 v3, v48, v50
    v_cmp_eq_u32 vcc, -1, v3
    v_mfma_f32_16x16x32_bf16 v[20:23], v[48:51], v[48:51], 0
    s_cbranch_vccnz aloopH_38_rq_0
    s_waitcnt vmcnt(4)
    v_mfma_f32_16x16x32_bf16 v[12:15], v[100:103], v[52:55], v[12:15]
    v_mfma_f32_16x16x32_bf16 v[16:19], v[116:119], v[52:55], v[16:19]
    v_max_u32 v3, v52, v54
    v_cmp_eq_u32 vcc, -1, v3
    v_mfma_f32_16x16x32_bf16 v[20:23], v[52:55], v[52:55], v[20:23]
    s_cbranch_vccnz aloopH_38_rq_1
    s_waitcnt vmcnt(3)
    v_mfma_f32_16x16x32_bf16 v[12:15], v[104:107], v[56:59], v[12:15]
    v_mfma_f32_16x16x32_bf16 v[16:19], v[120:123], v[56:59], v[16:19]
    v_max_u32 v3, v56, v58
    v_cmp_eq_u32 vcc, -1, v3
    v_mfma_f32_16x16x32_bf16 v[20:23], v[56:59], v[56:59], v[20:23]
    s_cbranch_vccnz aloopH_38_rq_2
    s_waitcnt vmcnt(2)
    v_mfma_f32_16x16x32_bf16 v[12:15], v[108:111], v[60:63], v[12:15]
    v_mfma_f32_16x16x32_bf16 v[16:19], v[124:127], v[60:63], v[16:19]
    v_max_u32 v3, v60, v62
    v_cmp_eq_u32 vcc, -1, v3
    v_mfma_f32_16x16x32_bf16 v[20:23], v[60:63], v[60:63], v[20:23]
    s_cbranch_vccnz aloopH_38_rq_3
    s_branch aloopH_38_sdone
aloopH_38_rq_v:
    s_sub_u32 s22, s22, 1
    s_cbranch_scc1 aloopH_38_rq_vg
    buffer_load_dwordx4 v[64:67], v0, s[4:7], s24 offen offset:0 sc1
    buffer_load_dwordx4 v[68:71], v0, s[4:7], s24 offen offset:1024 sc1
    s_waitcnt vmcnt(0)
    v_max3_u32 v188, v64, v66, v68
    v_max_u32 v188, v188, v70
    v_cmp_eq_u32 vcc, -1, v188
    s_cbranch_vccnz aloopH_38_rq_v
    s_branch aloopH_38_vok
aloopH_38_rq_vg:
    s_mov_b32 s22, 0
    s_branch aloopH_38_vok
aloopH_38_nochk:
    v_mfma_f32_16x16x32_bf16 v[12:15], v[96:99], v[48:51], 0
    v_mfma_f32_16x16x32_bf16 v[16:19], v[112:115], v[48:51], 0
    v_mfma_f32_16x16x32_bf16 v[20:23], v[48:51], v[48:51], 0
    v_mfma_f32_16x16x32_bf16 v[12:15], v[100:103], v[52:55], v[12:15]
    v_mfma_f32_16x16x32_bf16 v[16:19], v[116:119], v[52:55], v[16:19]
    v_mfma_f32_16x16x32_bf16 v[20:23], v[52:55], v[52:55], v[20:23]
    v_mfma_f32_16x16x32_bf16 v[12:15], v[104:107], v[56:59], v[12:15]
    v_mfma_f32_16x16x32_bf16 v[16:19], v[120:123], v[56:59], v[16:19]
    v_mfma_f32_16x16x32_bf16 v[20:23], v[56:59], v[56:59], v[20:23]
    v_mfma_f32_16x16x32_bf16 v[12:15], v[108:111], v[60:63], v[12:15]
    v_mfma_f32_16x16x32_bf16 v[16:19], v[124:127], v[60:63], v[16:19]
    v_mfma_f32_16x16x32_bf16 v[20:23], v[60:63], v[60:63], v[20:23]
    s_nop 1
    s_branch aloopH_38_sdone
aloopH_38_rq_v2:
    s_sub_u32 s22, s22, 1
    s_cbranch_scc1 aloopH_38_rq_v2g
    buffer_load_dwordx4 v[64:67], v0, s[4:7], s24 offen offset:0 sc1
    buffer_load_dwordx4 v[68:71], v0, s[4:7], s24 offen offset:1024 sc1
    s_waitcnt vmcnt(0)
    v_max3_u32 v188, v64, v66, v68
    v_max_u32 v188, v188, v70
    v_cmp_eq_u32 vcc, -1, v188
    s_cbranch_vccnz aloopH_38_rq_v2
    s_branch aloopH_38_lsk3
aloopH_38_rq_v2g:
    s_mov_b32 s22, 0
    s_branch aloopH_38_lsk3
ct_tail:
aloopH_38_lsk:
    s_cmp_lg_u32 s27, 0
    s_cbranch_scc1 aloopH_38_lsk2
    v_mov_b32 v3, 62
    s_mov_b64 exec, 1
    buffer_store_dword v3, off, s[4:7], s28 sc1
    s_mov_b64 exec, -1
aloopH_38_lsk2:
    s_waitcnt vmcnt(0)
    v_max3_u32 v188, v64, v66, v68
    v_max_u32 v188, v188, v70
    v_cmp_eq_u32 vcc, -1, v188
    s_cbranch_vccnz aloopH_38_rq_v2
aloopH_38_lsk3:
    v_smfmac_f32_16x16x64_bf16 v[24:27], v[64:67], v[192:199], v166
    v_smfmac_f32_16x16x64_bf16 v[32:35], v[64:67], v[224:231], v166
    v_smfmac_f32_16x16x64_bf16 v[28:31], v[64:67], v[208:215], v166
    v_smfmac_f32_16x16x64_bf16 v[36:39], v[64:67], v[240:247], v166
    v_smfmac_f32_16x16x64_bf16 v[24:27], v[68:71], v[200:207], v166
    v_smfmac_f32_16x16x64_bf16 v[32:35], v[68:71], v[232:239], v166
    v_smfmac_f32_16x16x64_bf16 v[28:31], v[68:71], v[216:223], v166
    v_smfmac_f32_16x16x64_bf16 v[36:39], v[68:71], v[248:255], v166
    s_nop 7
    s_nop 1
    v_cvt_pk_bf16_f32 v40, v24, v25
    v_cvt_pk_bf16_f32 v41, v26, v27
    v_cvt_pk_bf16_f32 v42, v28, v29
    v_cvt_pk_bf16_f32 v43, v30, v31
    v_cvt_pk_bf16_f32 v44, v32, v33
    v_cvt_pk_bf16_f32 v45, v34, v35
    v_cvt_pk_bf16_f32 v46, v36, v37
    v_cvt_pk_bf16_f32 v47, v38, v39
    s_waitcnt lgkmcnt(0)
    s_branch aloopH_38_lskb
k_end:
k_exit:
    s_endpgm
.section .rodata,"a"
.p2align 6
jobtab:
    .long 4, 24, 24, 8192, 0, 262144, 8388608, 0, 32768, 4, 20971520, 131072, 0, 0, 218104321, 0
    .long 4, 24, 24, 8192, 256, 262400, 8388608, 0, 32768, 4, 20975616, 131072, 0, 0, 218104321, 0
    .long 4, 24, 24, 8192, 512, 262656, 8388608, 0, 32768, 4, 20979712, 131072, 0, 0, 218104321, 0
    .long 4, 24, 24, 8192, 768, 262912, 8388608, 0, 32768, 4, 20983808, 131072, 0, 0, 218104321, 0
    .long 4, 24, 24, 8192, 1024, 263168, 8388608, 0, 32768, 4, 20987904, 131072, 0, 0, 218104337, 0
    .long 4, 24, 24, 8192, 1280, 263424, 8388608, 0, 32768, 4, 20992000, 131072, 0, 0, 218104337, 0
    .long 4, 24, 24, 8192, 1536, 263680, 8388608, 0, 32768, 4, 20996096, 131072, 0, 0, 218104337, 0
    .long 4, 24, 24, 8192, 1792, 263936, 8388608, 0, 32768, 4, 21000192, 131072, 0, 0, 218104337, 0
    .long 4, 32, 32, 8192, 0, 262144, 8388608, 0, 32768, 4, 37748736, 131072, 0, 0, 218104321, 0
    .long 4, 32, 32, 8192, 256, 262400, 8388608, 0, 32768, 4, 37752832, 131072, 0, 0, 218104321, 0
    .long 4, 32, 32, 8192, 512, 262656, 8388608, 0, 32768, 4, 37756928, 131072, 0, 0, 218104321, 0
    .long 4, 32, 32, 8192, 768, 262912, 8388608, 0, 32768, 4, 37761024, 131072, 0, 0, 218104321, 0
    .long 4, 32, 32, 8192, 1024, 263168, 8388608, 0, 32768, 4, 37765120, 131072, 0, 0, 218104337, 0
    .long 4, 32, 32, 8192, 1280, 263424, 8388608, 0, 32768, 4, 37769216, 131072, 0, 0, 218104337, 0
    .long 4, 32, 32, 8192, 1536, 263680, 8388608, 0, 32768, 4, 37773312, 131072, 0, 0, 218104337, 0
    .long 4, 32, 32, 8192, 1792, 263936, 8388608, 0, 32768, 4, 37777408, 131072, 0, 0, 218104337, 0
    .long 4, 24, 24, 8192, 0, 262144, 8388608, 262144, 32768, 4, 22020096, 131072, 0, 0, 218104324, 0
    .long 4, 24, 24, 8192, 256, 262400, 8388608, 262144, 32768, 4, 22024192, 131072, 0, 0, 218104324, 0
    .long 4, 24, 24, 8192, 512, 262656, 8388608, 262144, 32768, 4, 22028288, 131072, 0, 0, 218104324, 0
    .long 4, 24, 24, 8192, 768, 262912, 8388608, 262144, 32768, 4, 22032384, 131072, 0, 0, 218104324, 0
    .long 4, 24, 24, 8192, 1024, 263168, 8388608, 262144, 32768, 4, 22036480, 131072, 0, 0, 218104340, 0
    .long 4, 24, 24, 8192, 1280, 263424, 8388608, 262144, 32768, 4, 22040576, 131072, 0, 0, 218104340, 0
    .long 4, 24, 24, 8192, 1536, 263680, 8388608, 262144, 32768, 4, 22044672, 131072, 0, 0, 218104340, 0
    .long 4, 24, 24, 8192, 1792, 263936, 8388608, 262144, 32768, 4, 22048768, 131072, 0, 0, 218104340, 0
    .long 4, 32, 32, 8192, 0, 262144, 8388608, 262144, 32768, 4, 38797312, 131072, 0, 0, 218104324, 0
    .long 4, 32, 32, 8192, 256, 262400, 8388608, 262144, 32768, 4, 38801408, 131072, 0, 0, 218104324, 0
    .long 4, 32, 32, 8192, 512, 262656, 8388608, 262144, 32768, 4, 38805504, 131072, 0, 0, 218104324, 0
    .long 4, 32, 32, 8192, 768, 262912, 8388608, 262144, 32768, 4, 38809600, 131072, 0, 0, 218104324, 0
    .long 4, 32, 32, 8192, 1024, 263168, 8388608, 262144, 32768, 4, 38813696, 131072, 0, 0, 218104340, 0
    .long 4, 32, 32, 8192, 1280, 263424, 8388608, 262144, 32768, 4, 38817792, 131072, 0, 0, 218104340, 0
    .long 4, 32, 32, 8192, 1536, 263680, 8388608, 262144, 32768, 4, 38821888, 131072, 0, 0, 218104340, 0
    .long 4, 32, 32, 8192, 1792, 263936, 8388608, 262144, 32768, 4, 38825984, 131072, 0, 0, 218104340, 0
    .long 4, 32, 32, 8192, 512, 262656, 8388608, 786432, 32768, 4, 40902656, 131072, 0, 0, 218104580, 0
    .long 4, 32, 32, 8192, 1536, 263680, 8388608, 786432, 32768, 4, 40919040, 131072, 0, 0, 218104596, 0
    .long 4, 32, 32, 8192, 1792, 263936, 8388608, 524288, 32768, 4, 39874560, 131072, 0, 0, 218104593, 0
    .long 4, 24, 24, 8192, 512, 262656, 8388608, 786432, 32768, 4, 24125440, 131072, 0, 0, 218104580, 0
    .long 4, 32, 32, 8192, 512, 262656, 8388608, 524288, 32768, 4, 39854080, 131072, 0, 0, 218104577, 0
    .long 4, 32, 32, 8192, 1792, 263936, 8388608, 786432, 32768, 4, 40923136, 131072, 0, 0, 218104596, 0
    .long 4, 24, 24, 8192, 1536, 263680, 8388608, 786432, 32768, 4, 24141824, 131072, 0, 0, 218104596, 0
    .long 4, 24, 24, 8192, 256, 262400, 8388608, 524288, 32768, 4, 23072768, 131072, 0, 0, 218104577, 0
    .long 4, 24, 24, 8192, 768, 262912, 8388608, 524288, 32768, 4, 23080960, 131072, 0, 0, 218104577, 0
    .long 4, 24, 24, 8192, 1280, 263424, 8388608, 524288, 32768, 4, 23089152, 131072, 0, 0, 218104593, 0
    .long 4, 24, 24, 8192, 768, 262912, 8388608, 786432, 32768, 4, 24129536, 131072, 0, 0, 218104580, 0
    .long 4, 32, 32, 8192, 256, 262400, 8388608, 524288, 32768, 4, 39849984, 131072, 0, 0, 218104577, 0
    .long 4, 32, 32, 8192, 1024, 263168, 8388608, 524288, 32768, 4, 39862272, 131072, 0, 0, 218104593, 0
    .long 4, 24, 24, 8192, 1536, 263680, 8388608, 524288, 32768, 4, 23093248, 131072, 0, 0, 218104593, 0
    .long 4, 32, 32, 8192, 768, 262912, 8388608, 524288, 32768, 4, 39858176, 131072, 0, 0, 218104577, 0
    .long 4, 24, 24, 8192, 0, 262144, 8388608, 524288, 32768, 4, 23068672, 131072, 0, 0, 218104577, 0
    .long 4, 32, 32, 8192, 1024, 263168, 8388608, 786432, 32768, 4, 40910848, 131072, 0, 0, 218104596, 0
    .long 4, 24, 24, 8192, 1792, 263936, 8388608, 786432, 32768, 4, 24145920, 131072, 0, 0, 218104596, 0
    .long 4, 32, 32, 8192, 0, 262144, 8388608, 524288, 32768, 4, 39845888, 131072, 0, 0, 218104577, 0
    .long 4, 24, 24, 8192, 1280, 263424, 8388608, 786432, 32768, 4, 24137728, 131072, 0, 0, 218104596, 0
    .long 4, 32, 32, 8192, 256, 262400, 8388608, 786432, 32768, 4, 40898560, 131072, 0, 0, 218104580, 0
    .long 4, 24, 24, 8192, 1024, 263168, 8388608, 786432, 32768, 4, 24133632, 131072, 0, 0, 218104596, 0
    .long 4, 24, 24, 8192, 512, 262656, 8388608, 524288, 32768, 4, 23076864, 131072, 0, 0, 218104577, 0
    .long 4, 24, 24, 8192, 256, 262400, 8388608, 786432, 32768, 4, 24121344, 131072, 0, 0, 218104580, 0
    .long 4, 32, 32, 8192, 1280, 263424, 8388608, 786432, 32768, 4, 40914944, 131072, 0, 0, 218104596, 0
    .long 4, 24, 24, 8192, 0, 262144, 8388608, 786432, 32768, 4, 24117248, 131072, 0, 0, 218104580, 0
    .long 4, 32, 32, 8192, 1536, 263680, 8388608, 524288, 32768, 4, 39870464, 131072, 0, 0, 218104593, 0
    .long 4, 32, 32, 8192, 768, 262912, 8388608, 786432, 32768, 4, 40906752, 131072, 0, 0, 218104580, 0
    .long 4, 32, 32, 8192, 1280, 263424, 8388608, 524288, 32768, 4, 39866368, 131072, 0, 0, 218104593, 0
    .long 4, 24, 24, 8192, 1024, 263168, 8388608, 524288, 32768, 4, 23085056, 131072, 0, 0, 218104593, 0
    .long 4, 24, 24, 8192, 1792, 263936, 8388608, 524288, 32768, 4, 23097344, 131072, 0, 0, 218104593, 0
    .long 4, 32, 32, 8192, 0, 262144, 8388608, 786432, 32768, 4, 40894464, 131072, 0, 0, 218104580, 0
    .long 1, 16, 16, 8192, 0, 256, 8388608, 1572864, 32768, 8, 10485760, 131072, 0, 0, 218105098, 0
    .long 1, 32, 32, 8192, 512, 768, 8388608, 1048576, 32768, 8, 41951232, 131072, 0, 0, 218104842, 0
    .long 1, 32, 32, 8192, 512, 768, 8388608, 1572864, 32768, 8, 44048384, 131072, 0, 0, 218105098, 0
    .long 1, 24, 24, 8192, 512, 768, 8388608, 1048576, 32768, 8, 25174016, 131072, 0, 0, 218104842, 0
    .long 1, 16, 16, 8192, 1024, 1280, 8388608, 1048576, 32768, 8, 8404992, 131072, 0, 0, 218104858, 0
    .long 1, 16, 16, 8192, 1536, 1792, 8388608, 1048576, 32768, 8, 8413184, 131072, 0, 0, 218104858, 0
    .long 1, 32, 32, 8192, 1536, 1792, 8388608, 1048576, 32768, 8, 41967616, 131072, 0, 0, 218104858, 0
    .long 1, 24, 24, 8192, 1024, 1280, 8388608, 1048576, 32768, 8, 25182208, 131072, 0, 0, 218104858, 0
    .long 1, 24, 24, 8192, 1536, 1792, 8388608, 2097152, 32768, 8, 29384704, 131072, 0, 0, 218105370, 0
    .long 1, 24, 24, 8192, 1536, 1792, 8388608, 1048576, 32768, 8, 25190400, 131072, 0, 0, 218104858, 0
    .long 1, 32, 32, 8192, 1024, 1280, 8388608, 1048576, 32768, 8, 41959424, 131072, 0, 0, 218104858, 0
    .long 1, 24, 24, 8192, 1024, 1280, 8388608, 2097152, 32768, 8, 29376512, 131072, 0, 0, 218105370, 0
    .long 1, 24, 24, 8192, 0, 256, 8388608, 1572864, 32768, 8, 27262976, 131072, 0, 0, 218105098, 0
    .long 1, 32, 32, 8192, 0, 256, 8388608, 1572864, 32768, 8, 44040192, 131072, 0, 0, 218105098, 0
    .long 1, 24, 24, 8192, 1024, 1280, 8388608, 1572864, 32768, 8, 27279360, 131072, 0, 0, 218105114, 0
    .long 1, 16, 16, 8192, 0, 256, 8388608, 1048576, 32768, 8, 8388608, 131072, 0, 0, 218104842, 0
    .long 1, 24, 24, 8192, 512, 768, 8388608, 1572864, 32768, 8, 27271168, 131072, 0, 0, 218105098, 0
    .long 1, 16, 16, 8192, 512, 768, 8388608, 1572864, 32768, 8, 10493952, 131072, 0, 0, 218105098, 0
    .long 1, 32, 32, 8192, 1024, 1280, 8388608, 1572864, 32768, 8, 44056576, 131072, 0, 0, 218105114, 0
    .long 1, 16, 16, 8192, 1024, 1280, 8388608, 1572864, 32768, 8, 10502144, 131072, 0, 0, 218105114, 0
    .long 1, 32, 32, 8192, 1536, 1792, 8388608, 2097152, 32768, 8, 46161920, 131072, 0, 0, 218105370, 0
    .long 1, 24, 24, 8192, 0, 256, 8388608, 1048576, 32768, 8, 25165824, 131072, 0, 0, 218104842, 0
    .long 1, 24, 24, 8192, 0, 256, 8388608, 2097152, 32768, 8, 29360128, 131072, 0, 0, 218105354, 0
    .long 1, 16, 16, 8192, 1536, 1792, 8388608, 1572864, 32768, 8, 10510336, 131072, 0, 0, 218105114, 0
    .long 2, 64, 72, 7168, 768, 768, 7340032, 1572864, 32768, 8, 60043264, 114688, 0, 0, 218104001, 0
    .long 1, 32, 32, 8192, 0, 256, 8388608, 2097152, 32768, 8, 46137344, 131072, 0, 0, 218105354, 0
    .long 1, 32, 32, 8192, 0, 256, 8388608, 1048576, 32768, 8, 41943040, 131072, 0, 0, 218104842, 0
    .long 1, 32, 32, 8192, 512, 768, 8388608, 2097152, 32768, 8, 46145536, 131072, 0, 0, 218105354, 0
    .long 1, 24, 24, 8192, 1536, 1792, 8388608, 1572864, 32768, 8, 27287552, 131072, 0, 0, 218105114, 0
    .long 1, 32, 32, 8192, 1536, 1792, 8388608, 1572864, 32768, 8, 44064768, 131072, 0, 0, 218105114, 0
    .long 1, 16, 16, 8192, 512, 768, 8388608, 1048576, 32768, 8, 8396800, 131072, 0, 0, 218104842, 0
    .long 1, 32, 32, 8192, 1024, 1280, 8388608, 2097152, 32768, 8, 46153728, 131072, 0, 0, 218105370, 0
    .long 1, 16, 16, 8192, 512, 768, 8388608, 0, 32768, 8, 4202496, 131072, 0, 0, 218107914, 0
    .long 2, 64, 72, 7168, 768, 768, 7340032, 2097152, 32768, 8, 61878272, 114688, 0, 0, 218104065, 0
    .long 1, 16, 16, 8192, 1536, 1792, 8388608, 2097152, 32768, 8, 12607488, 131072, 0, 0, 218105370, 0
    .long 1, 16, 16, 8192, 512, 768, 8388608, 524288, 32768, 8, 6299648, 131072, 0, 0, 218108170, 0
    .long 1, 16, 16, 8192, 1536, 1792, 8388608, 3145728, 32768, 8, 16801792, 131072, 0, 0, 218105882, 0
    .long 1, 32, 32, 8192, 1536, 1792, 8388608, 2621440, 32768, 8, 48259072, 131072, 0, 0, 218105626, 0
    .long 1, 16, 16, 8192, 1024, 1280, 8388608, 0, 32768, 8, 4210688, 131072, 0, 0, 218107930, 0
    .long 1, 16, 16, 8192, 0, 256, 8388608, 2097152, 32768, 8, 12582912, 131072, 0, 0, 218105354, 0
    .long 1, 16, 16, 8192, 1536, 1792, 8388608, 0, 32768, 8, 4218880, 131072, 0, 0, 218107930, 0
    .long 1, 16, 16, 8192, 0, 256, 8388608, 524288, 32768, 8, 6291456, 131072, 0, 0, 218108170, 0
    .long 1, 24, 24, 8192, 1024, 1280, 8388608, 3145728, 32768, 8, 33570816, 131072, 0, 0, 218105882, 0
    .long 1, 24, 24, 8192, 512, 768, 8388608, 2621440, 32768, 8, 31465472, 131072, 0, 0, 218105610, 0
    .long 1, 16, 16, 8192, 512, 768, 8388608, 2621440, 32768, 8, 14688256, 131072, 0, 0, 218105610, 0
    .long 1, 16, 16, 8192, 1024, 1280, 8388608, 524288, 32768, 8, 6307840, 131072, 0, 0, 218108186, 0
    .long 2, 64, 72, 7168, 1280, 1280, 7340032, 0, 32768, 8, 54546432, 114688, 0, 0, 218103809, 0
    .long 2, 64, 72, 7168, 768, 768, 7340032, 0, 32768, 8, 54538240, 114688, 0, 0, 218103809, 0
    .long 2, 64, 72, 7168, 1280, 1280, 7340032, 1048576, 32768, 8, 58216448, 114688, 0, 0, 218103937, 0
    .long 1, 16, 16, 8192, 0, 256, 8388608, 0, 32768, 8, 4194304, 131072, 0, 0, 218107914, 0
    .long 1, 16, 16, 8192, 1536, 1792, 8388608, 524288, 32768, 8, 6316032, 131072, 0, 0, 218108186, 0
    .long 1, 24, 24, 8192, 1024, 1280, 8388608, 2621440, 32768, 8, 31473664, 131072, 0, 0, 218105626, 0
    .long 1, 16, 16, 8192, 1536, 1792, 8388608, 2621440, 32768, 8, 14704640, 131072, 0, 0, 218105626, 0
    .long 1, 24, 24, 8192, 512, 768, 8388608, 2097152, 32768, 8, 29368320, 131072, 0, 0, 218105354, 0
    .long 2, 64, 72, 7168, 1280, 1280, 7340032, 2097152, 32768, 8, 61886464, 114688, 0, 0, 218104065, 0
    .long 1, 16, 16, 8192, 512, 768, 8388608, 3145728, 32768, 8, 16785408, 131072, 0, 0, 218105866, 0
    .long 1, 16, 16, 8192, 512, 768, 8388608, 2097152, 32768, 8, 12591104, 131072, 0, 0, 218105354, 0
    .long 2, 64, 72, 7168, 768, 768, 7340032, 3670016, 32768, 8, 67383296, 114688, 0, 0, 218104257, 0
    .long 1, 24, 24, 8192, 512, 768, 8388608, 3145728, 32768, 8, 33562624, 131072, 0, 0, 218105866, 0
    .long 2, 64, 72, 7168, 512, 512, 7340032, 2097152, 32768, 8, 61874176, 114688, 0, 0, 218104065, 0
    .long 1, 16, 16, 8192, 1024, 1280, 8388608, 2097152, 32768, 8, 12599296, 131072, 0, 0, 218105370, 0
    .long 2, 64, 72, 7168, 1280, 1280, 7340032, 2621440, 32768, 8, 63721472, 114688, 0, 0, 218104129, 0
    .long 1, 32, 32, 8192, 1536, 1792, 8388608, 3145728, 32768, 8, 50356224, 131072, 0, 0, 218105882, 0
    .long 1, 24, 24, 8192, 0, 256, 8388608, 2621440, 32768, 8, 31457280, 131072, 0, 0, 218105610, 0
    .long 2, 64, 72, 7168, 0, 0, 7340032, 1048576, 32768, 8, 58195968, 114688, 0, 0, 218103937, 0
    .long 1, 32, 32, 8192, 1024, 1280, 8388608, 3145728, 32768, 8, 50348032, 131072, 0, 0, 218105882, 0
    .long 2, 64, 72, 7168, 768, 768, 7340032, 3145728, 32768, 8, 65548288, 114688, 0, 0, 218104193, 0
    .long 1, 16, 16, 8192, 0, 256, 8388608, 3145728, 32768, 8, 16777216, 131072, 0, 0, 218105866, 0
    .long 2, 64, 72, 7168, 1536, 1536, 7340032, 1048576, 32768, 8, 58220544, 114688, 0, 0, 218103937, 0
    .long 2, 64, 72, 7168, 0, 0, 7340032, 3145728, 32768, 8, 65536000, 114688, 0, 0, 218104193, 0
    .long 2, 64, 72, 7168, 768, 768, 7340032, 2621440, 32768, 8, 63713280, 114688, 0, 0, 218104129, 0
    .long 2, 64, 72, 7168, 256, 256, 7340032, 1048576, 32768, 8, 58200064, 114688, 0, 0, 218103937, 0
    .long 2, 64, 72, 7168, 1024, 1024, 7340032, 3145728, 32768, 8, 65552384, 114688, 0, 0, 218104193, 0
    .long 1, 16, 16, 8192, 1024, 1280, 8388608, 2621440, 32768, 8, 14696448, 131072, 0, 0, 218105626, 0
    .long 1, 32, 32, 8192, 0, 256, 8388608, 2621440, 32768, 8, 48234496, 131072, 0, 0, 218105610, 0
    .long 1, 16, 16, 8192, 0, 256, 8388608, 2621440, 32768, 8, 14680064, 131072, 0, 0, 218105610, 0
    .long 5, 218108160, 0, 0, 0, 0, 0, 8, 0, 0, 0, 0, 218112000, 11, 218106945, 0
    .long 2, 64, 72, 7168, 256, 256, 7340032, 524288, 32768, 8, 56365056, 114688, 0, 0, 218103873, 0
    .long 2, 64, 72, 7168, 1024, 1024, 7340032, 0, 32768, 8, 54542336, 114688, 0, 0, 218103809, 0
    .long 1, 24, 24, 8192, 0, 256, 8388608, 3145728, 32768, 8, 33554432, 131072, 0, 0, 218105866, 0
    .long 2, 64, 72, 7168, 1536, 1536, 7340032, 0, 32768, 8, 54550528, 114688, 0, 0, 218103809, 0
    .long 5, 218107904, 0, 0, 0, 0, 0, 0, 0, 0, 0, 0, 218112000, 3, 218106881, 0
    .long 1, 32, 32, 8192, 512, 768, 8388608, 3145728, 32768, 8, 50339840, 131072, 0, 0, 218105866, 0
    .long 5, 218108176, 0, 0, 4, 0, 0, 8, 0, 0, 0, 0, 218112000, 11, 218106945, 0
    .long 1, 24, 24, 8192, 1536, 1792, 8388608, 2621440, 32768, 8, 31481856, 131072, 0, 0, 218105626, 0
    .long 1, 32, 32, 8192, 1024, 1280, 8388608, 2621440, 32768, 8, 48250880, 131072, 0, 0, 218105626, 0
    .long 2, 64, 72, 7168, 768, 768, 7340032, 1048576, 32768, 8, 58208256, 114688, 0, 0, 218103937, 0
    .long 2, 64, 72, 7168, 768, 768, 7340032, 524288, 32768, 8, 56373248, 114688, 0, 0, 218103873, 0
    .long 2, 64, 72, 7168, 512, 512, 7340032, 524288, 32768, 8, 56369152, 114688, 0, 0, 218103873, 0
    .long 2, 64, 72, 7168, 1024, 1024, 7340032, 1048576, 32768, 8, 58212352, 114688, 0, 0, 218103937, 0
    .long 1, 32, 32, 8192, 512, 768, 8388608, 2621440, 32768, 8, 48242688, 131072, 0, 0, 218105610, 0
    .long 2, 64, 72, 7168, 512, 512, 7340032, 1048576, 32768, 8, 58204160, 114688, 0, 0, 218103937, 0
    .long 1, 16, 16, 8192, 1024, 1280, 8388608, 3670016, 32768, 8, 18890752, 131072, 0, 0, 218106138, 0
    .long 2, 64, 72, 7168, 1024, 1024, 7340032, 524288, 32768, 8, 56377344, 114688, 0, 0, 218103873, 0
    .long 1, 16, 16, 8192, 1024, 1280, 8388608, 3145728, 32768, 8, 16793600, 131072, 0, 0, 218105882, 0
    .long 5, 218107920, 0, 0, 4, 0, 0, 0, 0, 0, 0, 0, 218112000, 3, 218106881, 0
    .long 5, 218107920, 0, 0, 4, 0, 0, 4, 0, 0, 0, 0, 218112000, 7, 218106881, 0
    .long 5, 218108176, 0, 0, 4, 0, 0, 12, 0, 0, 0, 0, 218112000, 15, 218106945, 0
    .long 5, 218108160, 0, 0, 0, 0, 0, 12, 0, 0, 0, 0, 218112000, 15, 218106945, 0
    .long 5, 218107904, 0, 0, 0, 0, 0, 4, 0, 0, 0, 0, 218112000, 7, 218106881, 0
    .long 1, 32, 32, 8192, 0, 256, 8388608, 3145728, 32768, 8, 50331648, 131072, 0, 0, 218105866, 0
    .long 2, 64, 72, 7168, 512, 512, 7340032, 1572864, 32768, 8, 60039168, 114688, 0, 0, 218104001, 0
    .long 2, 64, 72, 7168, 0, 0, 7340032, 1572864, 32768, 8, 60030976, 114688, 0, 0, 218104001, 0
    .long 2, 64, 72, 7168, 256, 256, 7340032, 0, 32768, 8, 54530048, 114688, 0, 0, 218103809, 0
    .long 1, 24, 24, 8192, 1536, 1792, 8388608, 3145728, 32768, 8, 33579008, 131072, 0, 0, 218105882, 0
    .long 2, 64, 72, 7168, 1536, 1536, 7340032, 3145728, 32768, 8, 65560576, 114688, 0, 0, 218104193, 0
    .long 2, 64, 72, 7168, 0, 0, 7340032, 2621440, 32768, 8, 63700992, 114688, 0, 0, 218104129, 0
    .long 2, 64, 72, 7168, 512, 512, 7340032, 0, 32768, 8, 54534144, 114688, 0, 0, 218103809, 0
    .long 2, 64, 72, 7168, 1024, 1024, 7340032, 2097152, 32768, 8, 61882368, 114688, 0, 0, 218104065, 0
    .long 2, 64, 72, 7168, 1536, 1536, 7340032, 524288, 32768, 8, 56385536, 114688, 0, 0, 218103873, 0
    .long 2, 64, 72, 7168, 256, 256, 7340032, 2097152, 32768, 8, 61870080, 114688, 0, 0, 218104065, 0
    .long 2, 64, 72, 7168, 1536, 1536, 7340032, 1572864, 32768, 8, 60055552, 114688, 0, 0, 218104001, 0
    .long 2, 64, 72, 7168, 0, 0, 7340032, 0, 32768, 8, 54525952, 114688, 0, 0, 218103809, 0
    .long 2, 64, 72, 7168, 1024, 1024, 7340032, 3670016, 32768, 8, 67387392, 114688, 0, 0, 218104257, 0
    .long 2, 64, 72, 7168, 0, 0, 7340032, 524288, 32768, 8, 56360960, 114688, 0, 0, 218103873, 0
    .long 2, 64, 72, 7168, 1280, 1280, 7340032, 524288, 32768, 8, 56381440, 114688, 0, 0, 218103873, 0
    .long 2, 64, 72, 7168, 1536, 1536, 7340032, 2097152, 32768, 8, 61890560, 114688, 0, 0, 218104065, 0
    .long 1, 24, 24, 8192, 1536, 1792, 8388608, 3670016, 32768, 8, 35676160, 131072, 0, 0, 218106138, 0
    .long 2, 64, 72, 7168, 512, 512, 7340032, 2621440, 32768, 8, 63709184, 114688, 0, 0, 218104129, 0
    .long 2, 64, 72, 7168, 1024, 1024, 7340032, 1572864, 32768, 8, 60047360, 114688, 0, 0, 218104001, 0
    .long 2, 64, 72, 7168, 0, 0, 7340032, 2097152, 32768, 8, 61865984, 114688, 0, 0, 218104065, 0
    .long 2, 64, 72, 7168, 1280, 1280, 7340032, 3145728, 32768, 8, 65556480, 114688, 0, 0, 218104193, 0
    .long 2, 64, 72, 7168, 256, 256, 7340032, 1572864, 32768, 8, 60035072, 114688, 0, 0, 218104001, 0
    .long 2, 64, 72, 7168, 256, 256, 7340032, 2621440, 32768, 8, 63705088, 114688, 0, 0, 218104129, 0
    .long 1, 24, 24, 8192, 0, 256, 8388608, 3670016, 32768, 8, 35651584, 131072, 0, 0, 218106122, 0
    .long 2, 64, 72, 7168, 1536, 1536, 7340032, 2621440, 32768, 8, 63725568, 114688, 0, 0, 218104129, 0
    .long 2, 64, 72, 7168, 1024, 1024, 7340032, 2621440, 32768, 8, 63717376, 114688, 0, 0, 218104129, 0
    .long 2, 64, 72, 7168, 1280, 1280, 7340032, 3670016, 32768, 8, 67391488, 114688, 0, 0, 218104257, 0
    .long 2, 64, 72, 7168, 1280, 1280, 7340032, 1572864, 32768, 8, 60051456, 114688, 0, 0, 218104001, 0
    .long 1, 40, 40, 2048, 512, 768, 8388608, 180355072, 131072, 16, 76554240, 32768, 218112000, 25, 218106504, 0
    .long 1, 80, 80, 2048, 0, 256, 7340032, 58195968, 114688, 14, 118489088, 32768, 218103936, 14, 218106498, 0
    .long 1, 24, 24, 8192, 1024, 1280, 8388608, 3670016, 32768, 8, 35667968, 131072, 0, 0, 218106138, 0
    .long 1, 40, 40, 2048, 0, 256, 8388608, 180355072, 131072, 16, 76546048, 32768, 218112000, 25, 218106504, 0
    .long 1, 40, 40, 2048, 0, 256, 8388608, 178257920, 131072, 16, 76021760, 32768, 218106944, 8, 218106440, 0
    .long 2, 64, 72, 7168, 512, 512, 7340032, 3145728, 32768, 8, 65544192, 114688, 0, 0, 218104193, 0
    .long 1, 40, 40, 2048, 512, 768, 8388608, 178257920, 131072, 16, 76029952, 32768, 218106944, 8, 218106440, 0
    .long 1, 80, 80, 2048, 512, 768, 7340032, 58195968, 114688, 14, 118497280, 32768, 218103936, 14, 218106498, 0
    .long 2, 64, 72, 7168, 256, 256, 7340032, 3145728, 32768, 8, 65540096, 114688, 0, 0, 218104193, 0
    .long 1, 32, 32, 8192, 512, 768, 8388608, 3670016, 32768, 8, 52436992, 131072, 0, 0, 218106122, 0
    .long 1, 16, 16, 8192, 512, 768, 8388608, 3670016, 32768, 8, 18882560, 131072, 0, 0, 218106122, 0
    .long 1, 40, 40, 2048, 512, 768, 8388608, 176160768, 131072, 16, 75505664, 32768, 218106880, 8, 218106376, 0
    .long 1, 40, 40, 2048, 0, 256, 8388608, 176160768, 131072, 16, 75497472, 32768, 218106880, 8, 218106376, 0
    .long 1, 32, 32, 8192, 0, 256, 8388608, 3670016, 32768, 8, 52428800, 131072, 0, 0, 218106122, 0
    .long 1, 24, 24, 8192, 512, 768, 8388608, 3670016, 32768, 8, 35659776, 131072, 0, 0, 218106122, 0
    .long 1, 16, 16, 8192, 0, 256, 8388608, 3670016, 32768, 8, 18874368, 131072, 0, 0, 218106122, 0
    .long 1, 32, 32, 8192, 1024, 1280, 8388608, 3670016, 32768, 8, 52445184, 131072, 0, 0, 218106138, 0
    .long 1, 32, 32, 8192, 1536, 1792, 8388608, 3670016, 32768, 8, 52453376, 131072, 0, 0, 218106138, 0
    .long 2, 64, 72, 7168, 512, 512, 7340032, 3670016, 32768, 8, 67379200, 114688, 0, 0, 218104257, 0
    .long 2, 64, 72, 7168, 0, 0, 7340032, 3670016, 32768, 8, 67371008, 114688, 0, 0, 218104257, 0
    .long 1, 16, 16, 8192, 1536, 1792, 8388608, 3670016, 32768, 8, 18898944, 131072, 0, 0, 218106138, 0
    .long 2, 64, 72, 7168, 1536, 1536, 7340032, 3670016, 32768, 8, 67395584, 114688, 0, 0, 218104257, 0
    .long 1, 80, 80, 2048, 512, 768, 7340032, 56360960, 114688, 14, 117972992, 32768, 218103872, 14, 218106434, 0
    .long 1, 80, 80, 2048, 0, 256, 7340032, 54525952, 114688, 14, 117440512, 32768, 218103808, 14, 218106370, 0
    .long 1, 80, 80, 2048, 0, 256, 7340032, 61865984, 114688, 14, 119537664, 32768, 218104064, 14, 218106626, 0
    .long 1, 80, 80, 2048, 0, 256, 7340032, 56360960, 114688, 14, 117964800, 32768, 218103872, 14, 218106434, 0
    .long 2, 64, 72, 7168, 256, 256, 7340032, 3670016, 32768, 8, 67375104, 114688, 0, 0, 218104257, 0
    .long 1, 40, 40, 2048, 0, 256, 8388608, 182452224, 131072, 16, 77070336, 32768, 218112000, 33, 218106568, 0
    .long 1, 40, 40, 2048, 512, 768, 8388608, 182452224, 131072, 16, 77078528, 32768, 218112000, 33, 218106568, 0
    .long 1, 80, 80, 2048, 512, 768, 7340032, 61865984, 114688, 14, 119545856, 32768, 218104064, 14, 218106626, 0
    .long 1, 80, 80, 2048, 512, 768, 7340032, 54525952, 114688, 14, 117448704, 32768, 218103808, 14, 218106370, 0
    .long 1, 80, 80, 2048, 512, 768, 7340032, 60030976, 114688, 14, 119021568, 32768, 218104000, 14, 218106562, 0
    .long 1, 80, 80, 2048, 0, 256, 7340032, 60030976, 114688, 14, 119013376, 32768, 218104000, 14, 218106562, 0
    .long 1, 40, 40, 2048, 512, 768, 8388608, 184549376, 131072, 8, 77602816, 32768, 218112000, 40, 218106628, 0
    .long 1, 40, 40, 2048, 0, 256, 8388608, 184549376, 131072, 8, 77594624, 32768, 218112000, 40, 218106628, 0
    .long 1, 40, 40, 2048, 1536, 1792, 8388608, 184549376, 131072, 8, 77619200, 32768, 218112000, 40, 218106628, 0
    .long 1, 40, 40, 2048, 1024, 1280, 8388608, 184549376, 131072, 8, 77611008, 32768, 218112000, 40, 218106628, 0
    .long 1, 80, 80, 2048, 1536, 1792, 7340032, 63700992, 114688, 7, 120086528, 32768, 218104128, 7, 218106689, 0
    .long 1, 80, 80, 2048, 1024, 1280, 7340032, 63700992, 114688, 7, 120078336, 32768, 218104128, 7, 218106689, 0
    .long 1, 80, 80, 2048, 0, 256, 7340032, 63700992, 114688, 7, 120061952, 32768, 218104128, 7, 218106689, 0
    .long 1, 80, 80, 2048, 512, 768, 7340032, 63700992, 114688, 7, 120070144, 32768, 218104128, 7, 218106689, 0
    .long 1, 80, 80, 2048, 512, 768, 7340032, 65536000, 114688, 7, 120594432, 32768, 218104192, 7, 218106753, 0
    .long 1, 80, 80, 2048, 0, 256, 7340032, 65536000, 114688, 7, 120586240, 32768, 218104192, 7, 218106753, 0
    .long 1, 80, 80, 2048, 1536, 1792, 7340032, 65536000, 114688, 7, 120610816, 32768, 218104192, 7, 218106753, 0
    .long 1, 40, 40, 2048, 512, 768, 8388608, 186646528, 131072, 8, 78127104, 32768, 218112000, 48, 218106692, 0
    .long 1, 80, 80, 2048, 1024, 1280, 7340032, 65536000, 114688, 7, 120602624, 32768, 218104192, 7, 218106753, 0
    .long 1, 40, 40, 2048, 1024, 1280, 8388608, 186646528, 131072, 8, 78135296, 32768, 218112000, 48, 218106692, 0
    .long 1, 40, 40, 2048, 1536, 1792, 8388608, 186646528, 131072, 8, 78143488, 32768, 218112000, 48, 218106692, 0
    .long 1, 40, 40, 2048, 0, 256, 8388608, 186646528, 131072, 8, 78118912, 32768, 218112000, 48, 218106692, 0
    .long 1, 80, 80, 2048, 1536, 1792, 7340032, 67371008, 114688, 7, 121135104, 32768, 218104256, 7, 218106817, 0
    .long 1, 80, 80, 2048, 512, 768, 7340032, 67371008, 114688, 7, 121118720, 32768, 218104256, 7, 218106817, 0
    .long 1, 80, 80, 2048, 1024, 1280, 7340032, 67371008, 114688, 7, 121126912, 32768, 218104256, 7, 218106817, 0
    .long 1, 80, 80, 2048, 0, 256, 7340032, 67371008, 114688, 7, 121110528, 32768, 218104256, 7, 218106817, 0
    .long 6, 1, 0, 2, 0, 16, 0, 23, 0, 0, 0, 0, 0, 0, 0, 0
    .long 6, 1, 0, 2, 0, 16, 0, 17, 0, 0, 0, 0, 0, 0, 0, 0
    .long 6, 1, 0, 2, 0, 16, 0, 20, 0, 0, 0, 0, 0, 0, 0, 0
    .long 6, 1, 0, 2, 0, 16, 0, 10, 0, 0, 0, 0, 0, 0, 0, 0
    .long 6, 1, 0, 2, 0, 16, 0, 6, 0, 0, 0, 0, 0, 0, 0, 0
    .long 6, 1, 0, 2, 0, 16, 0, 13, 0, 0, 0, 0, 0, 0, 0, 0
    .long 6, 1, 0, 1, 0, 16, 0, 38, 0, 0, 0, 0, 0, 0, 0, 0
    .long 6, 1, 0, 2, 0, 16, 0, 18, 0, 0, 0, 0, 0, 0, 0, 0
    .long 6, 1, 0, 2, 0, 16, 0, 9, 0, 0, 0, 0, 0, 0, 0, 0
    .long 6, 1, 0, 2, 0, 16, 0, 2, 0, 0, 0, 0, 0, 0, 0, 0
    .long 6, 1, 0, 2, 0, 16, 0, 5, 0, 0, 0, 0, 0, 0, 0, 0
    .long 6, 1, 0, 1, 0, 16, 0, 34, 0, 0, 0, 0, 0, 0, 0, 0
    .long 6, 1, 0, 2, 0, 16, 0, 7, 0, 0, 0, 0, 0, 0, 0, 0
    .long 6, 1, 0, 2, 0, 16, 0, 1, 0, 0, 0, 0, 0, 0, 0, 0
    .long 6, 1, 0, 2, 0, 16, 0, 12, 0, 0, 0, 0, 0, 0, 0, 0
    .long 6, 1, 0, 2, 0, 16, 0, 14, 0, 0, 0, 0, 0, 0, 0, 0
    .long 6, 1, 0, 2, 0, 16, 0, 0, 0, 0, 0, 0, 0, 0, 0, 0
    .long 6, 1, 0, 2, 0, 16, 0, 3, 0, 0, 0, 0, 0, 0, 0, 0
    .long 6, 1, 0, 2, 0, 16, 0, 22, 0, 0, 0, 0, 0, 0, 0, 0
    .long 6, 1, 0, 2, 0, 16, 0, 21, 0, 0, 0, 0, 0, 0, 0, 0
    .long 6, 1, 0, 2, 0, 16, 0, 8, 0, 0, 0, 0, 0, 0, 0, 0
    .long 6, 1, 0, 2, 0, 16, 0, 15, 0, 0, 0, 0, 0, 0, 0, 0
    .long 6, 1, 0, 2, 0, 16, 0, 19, 0, 0, 0, 0, 0, 0, 0, 0
    .long 6, 1, 0, 2, 0, 16, 0, 11, 0, 0, 0, 0, 0, 0, 0, 0
    .long 6, 1, 0, 2, 0, 16, 0, 16, 0, 0, 0, 0, 0, 0, 0, 0
    .long 6, 1, 0, 2, 0, 16, 0, 4, 0, 0, 0, 0, 0, 0, 0, 0
    .long 6, 0, 0, 0, 0, 0, 0, 54, 0, 0, 0, 0, 0, 0, 0, 0
    .long 6, 0, 0, 0, 0, 0, 0, 51, 0, 0, 0, 0, 0, 0, 0, 0
    .long 6, 0, 0, 0, 0, 0, 0, 48, 0, 0, 0, 0, 0, 0, 0, 0
    .long 6, 0, 0, 0, 0, 0, 0, 49, 0, 0, 0, 0, 0, 0, 0, 0
    .long 6, 0, 0, 0, 0, 0, 0, 50, 0, 0, 0, 0, 0, 0, 0, 0
    .long 6, 0, 0, 0, 0, 0, 0, 52, 0, 0, 0, 0, 0, 0, 0, 0
    .long 6, 0, 0, 0, 0, 0, 0, 53, 0, 0, 0, 0, 0, 0, 0, 0
    .long 6, 0, 0, 0, 0, 0, 0, 55, 0, 0, 0, 0, 0, 0, 0, 0
    .long 6, 1, 0, 1, 0, 16, 0, 32, 0, 0, 0, 0, 0, 0, 0, 0
    .long 6, 1, 0, 1, 0, 16, 0, 33, 0, 0, 0, 0, 0, 0, 0, 0
    .long 6, 1, 0, 1, 0, 16, 0, 35, 0, 0, 0, 0, 0, 0, 0, 0
    .long 6, 1, 0, 1, 0, 16, 0, 36, 0, 0, 0, 0, 0, 0, 0, 0
    .long 6, 1, 0, 1, 0, 16, 0, 37, 0, 0, 0, 0, 0, 0, 0, 0
    .long 6, 1, 0, 1, 0, 16, 0, 39, 0, 0, 0, 0, 0, 0, 0, 0
    .long 6, 1, 0, 2, 0, 16, 0, 24, 0, 0, 0, 0, 0, 0, 0, 0
    .long 6, 1, 0, 2, 0, 16, 0, 26, 0, 0, 0, 0, 0, 0, 0, 0
    .long 6, 1, 0, 2, 0, 16, 0, 27, 0, 0, 0, 0, 0, 0, 0, 0
    .long 6, 1, 0, 2, 0, 16, 0, 28, 0, 0, 0, 0, 0, 0, 0, 0
    .long 6, 1, 0, 2, 0, 16, 0, 29, 0, 0, 0, 0, 0, 0, 0, 0
    .long 6, 1, 0, 2, 0, 16, 0, 30, 0, 0, 0, 0, 0, 0, 0, 0
    .long 6, 1, 0, 2, 0, 16, 0, 31, 0, 0, 0, 0, 0, 0, 0, 0
    .long 6, 1, 0, 2, 0, 16, 0, 25, 0, 0, 0, 0, 0, 0, 0, 0
    .long 6, 0, 0, 1, 0, 16, 0, 40, 0, 0, 0, 0, 0, 0, 0, 0
    .long 6, 0, 0, 1, 0, 16, 0, 41, 0, 0, 0, 0, 0, 0, 0, 0
    .long 6, 0, 0, 1, 0, 16, 0, 42, 0, 0, 0, 0, 0, 0, 0, 0
    .long 6, 0, 0, 1, 0, 16, 0, 43, 0, 0, 0, 0, 0, 0, 0, 0
    .long 6, 0, 0, 1, 0, 16, 0, 44, 0, 0, 0, 0, 0, 0, 0, 0
    .long 6, 0, 0, 1, 0, 16, 0, 47, 0, 0, 0, 0, 0, 0, 0, 0
    .long 6, 0, 0, 1, 0, 16, 0, 46, 0, 0, 0, 0, 0, 0, 0, 0
    .long 6, 0, 0, 1, 0, 16, 0, 45, 0, 0, 0, 0, 0, 0, 0, 0
    .long 6, 0, 0, 0, 0, 0, 0, 56, 0, 0, 0, 0, 0, 0, 0, 0
    .long 6, 0, 0, 0, 0, 0, 0, 57, 0, 0, 0, 0, 0, 0, 0, 0
    .long 6, 0, 0, 0, 0, 0, 0, 58, 0, 0, 0, 0, 0, 0, 0, 0
    .long 6, 0, 0, 0, 0, 0, 0, 59, 0, 0, 0, 0, 0, 0, 0, 0
    .long 6, 0, 0, 0, 0, 0, 0, 60, 0, 0, 0, 0, 0, 0, 0, 0
    .long 7, 0, 0, 0, 0, 0, 0, 61, 0, 0, 0, 0, 0, 0, 0, 0
    .long 7, 0, 0, 0, 1, 0, 0, 61, 0, 0, 0, 0, 0, 0, 0, 0
    .long 7, 0, 0, 0, 2, 0, 0, 61, 0, 0, 0, 0, 0, 0, 0, 0
    .long 7, 0, 0, 0, 3, 0, 0, 61, 0, 0, 0, 0, 0, 0, 0, 0
    .long 7, 0, 0, 0, 0, 0, 0, 62, 0, 0, 0, 0, 0, 0, 0, 0
    .long 7, 0, 0, 0, 1, 0, 0, 62, 0, 0, 0, 0, 0, 0, 0, 0
    .long 7, 0, 0, 0, 2, 0, 0, 62, 0, 0, 0, 0, 0, 0, 0, 0
    .long 7, 0, 0, 0, 3, 0, 0, 62, 0, 0, 0, 0, 0, 0, 0, 0
    .long 7, 0, 0, 0, 0, 0, 0, 63, 0, 0, 0, 0, 0, 0, 0, 0
    .long 7, 0, 0, 0, 1, 0, 0, 63, 0, 0, 0, 0, 0, 0, 0, 0
    .long 7, 0, 0, 0, 2, 0, 0, 63, 0, 0, 0, 0, 0, 0, 0, 0
    .long 7, 0, 0, 0, 3, 0, 0, 63, 0, 0, 0, 0, 0, 0, 0, 0
    .long 0, 0, 0, 0, 0, 0, 0, 0, 0, 0, 0, 0, 0, 0, 0, 0
    .long 4, 24, 24, 8192, 2048, 264192, 8388608, 0, 32768, 4, 21004288, 131072, 0, 0, 218104353, 0
    .long 4, 24, 24, 8192, 2304, 264448, 8388608, 0, 32768, 4, 21008384, 131072, 0, 0, 218104353, 0
    .long 4, 24, 24, 8192, 2560, 264704, 8388608, 0, 32768, 4, 21012480, 131072, 0, 0, 218104353, 0
    .long 4, 24, 24, 8192, 2816, 264960, 8388608, 0, 32768, 4, 21016576, 131072, 0, 0, 218104353, 0
    .long 4, 24, 24, 8192, 3072, 265216, 8388608, 0, 32768, 4, 21020672, 131072, 0, 0, 218104369, 0
    .long 4, 24, 24, 8192, 3328, 265472, 8388608, 0, 32768, 4, 21024768, 131072, 0, 0, 218104369, 0
    .long 4, 24, 24, 8192, 3584, 265728, 8388608, 0, 32768, 4, 21028864, 131072, 0, 0, 218104369, 0
    .long 4, 24, 24, 8192, 3840, 265984, 8388608, 0, 32768, 4, 21032960, 131072, 0, 0, 218104369, 0
    .long 4, 32, 32, 8192, 2048, 264192, 8388608, 0, 32768, 4, 37781504, 131072, 0, 0, 218104353, 0
    .long 4, 32, 32, 8192, 2304, 264448, 8388608, 0, 32768, 4, 37785600, 131072, 0, 0, 218104353, 0
    .long 4, 32, 32, 8192, 2560, 264704, 8388608, 0, 32768, 4, 37789696, 131072, 0, 0, 218104353, 0
    .long 4, 32, 32, 8192, 2816, 264960, 8388608, 0, 32768, 4, 37793792, 131072, 0, 0, 218104353, 0
    .long 4, 32, 32, 8192, 3072, 265216, 8388608, 0, 32768, 4, 37797888, 131072, 0, 0, 218104369, 0
    .long 4, 32, 32, 8192, 3328, 265472, 8388608, 0, 32768, 4, 37801984, 131072, 0, 0, 218104369, 0
    .long 4, 32, 32, 8192, 3584, 265728, 8388608, 0, 32768, 4, 37806080, 131072, 0, 0, 218104369, 0
    .long 4, 32, 32, 8192, 3840, 265984, 8388608, 0, 32768, 4, 37810176, 131072, 0, 0, 218104369, 0
    .long 4, 24, 24, 8192, 2048, 264192, 8388608, 262144, 32768, 4, 22052864, 131072, 0, 0, 218104356, 0
    .long 4, 24, 24, 8192, 2304, 264448, 8388608, 262144, 32768, 4, 22056960, 131072, 0, 0, 218104356, 0
    .long 4, 24, 24, 8192, 2560, 264704, 8388608, 262144, 32768, 4, 22061056, 131072, 0, 0, 218104356, 0
    .long 4, 24, 24, 8192, 2816, 264960, 8388608, 262144, 32768, 4, 22065152, 131072, 0, 0, 218104356, 0
    .long 4, 24, 24, 8192, 3072, 265216, 8388608, 262144, 32768, 4, 22069248, 131072, 0, 0, 218104372, 0
    .long 4, 24, 24, 8192, 3328, 265472, 8388608, 262144, 32768, 4, 22073344, 131072, 0, 0, 218104372, 0
    .long 4, 24, 24, 8192, 3584, 265728, 8388608, 262144, 32768, 4, 22077440, 131072, 0, 0, 218104372, 0
    .long 4, 24, 24, 8192, 3840, 265984, 8388608, 262144, 32768, 4, 22081536, 131072, 0, 0, 218104372, 0
    .long 4, 32, 32, 8192, 2048, 264192, 8388608, 262144, 32768, 4, 38830080, 131072, 0, 0, 218104356, 0
    .long 4, 32, 32, 8192, 2304, 264448, 8388608, 262144, 32768, 4, 38834176, 131072, 0, 0, 218104356, 0
    .long 4, 32, 32, 8192, 2560, 264704, 8388608, 262144, 32768, 4, 38838272, 131072, 0, 0, 218104356, 0
    .long 4, 32, 32, 8192, 2816, 264960, 8388608, 262144, 32768, 4, 38842368, 131072, 0, 0, 218104356, 0
    .long 4, 32, 32, 8192, 3072, 265216, 8388608, 262144, 32768, 4, 38846464, 131072, 0, 0, 218104372, 0
    .long 4, 32, 32, 8192, 3328, 265472, 8388608, 262144, 32768, 4, 38850560, 131072, 0, 0, 218104372, 0
    .long 4, 32, 32, 8192, 3584, 265728, 8388608, 262144, 32768, 4, 38854656, 131072, 0, 0, 218104372, 0
    .long 4, 32, 32, 8192, 3840, 265984, 8388608, 262144, 32768, 4, 38858752, 131072, 0, 0, 218104372, 0
    .long 4, 32, 32, 8192, 2560, 264704, 8388608, 786432, 32768, 4, 40935424, 131072, 0, 0, 218104612, 0
    .long 4, 32, 32, 8192, 3584, 265728, 8388608, 786432, 32768, 4, 40951808, 131072, 0, 0, 218104628, 0
    .long 4, 32, 32, 8192, 3840, 265984, 8388608, 524288, 32768, 4, 39907328, 131072, 0, 0, 218104625, 0
    .long 4, 24, 24, 8192, 2560, 264704, 8388608, 786432, 32768, 4, 24158208, 131072, 0, 0, 218104612, 0
    .long 4, 32, 32, 8192, 2560, 264704, 8388608, 524288, 32768, 4, 39886848, 131072, 0, 0, 218104609, 0
    .long 4, 32, 32, 8192, 3840, 265984, 8388608, 786432, 32768, 4, 40955904, 131072, 0, 0, 218104628, 0
    .long 4, 24, 24, 8192, 3584, 265728, 8388608, 786432, 32768, 4, 24174592, 131072, 0, 0, 218104628, 0
    .long 4, 24, 24, 8192, 2304, 264448, 8388608, 524288, 32768, 4, 23105536, 131072, 0, 0, 218104609, 0
    .long 4, 24, 24, 8192, 2816, 264960, 8388608, 524288, 32768, 4, 23113728, 131072, 0, 0, 218104609, 0
    .long 4, 24, 24, 8192, 3328, 265472, 8388608, 524288, 32768, 4, 23121920, 131072, 0, 0, 218104625, 0
    .long 4, 24, 24, 8192, 2816, 264960, 8388608, 786432, 32768, 4, 24162304, 131072, 0, 0, 218104612, 0
    .long 4, 32, 32, 8192, 2304, 264448, 8388608, 524288, 32768, 4, 39882752, 131072, 0, 0, 218104609, 0
    .long 4, 32, 32, 8192, 3072, 265216, 8388608, 524288, 32768, 4, 39895040, 131072, 0, 0, 218104625, 0
    .long 4, 24, 24, 8192, 3584, 265728, 8388608, 524288, 32768, 4, 23126016, 131072, 0, 0, 218104625, 0
    .long 4, 32, 32, 8192, 2816, 264960, 8388608, 524288, 32768, 4, 39890944, 131072, 0, 0, 218104609, 0
    .long 4, 24, 24, 8192, 2048, 264192, 8388608, 524288, 32768, 4, 23101440, 131072, 0, 0, 218104609, 0
    .long 4, 32, 32, 8192, 3072, 265216, 8388608, 786432, 32768, 4, 40943616, 131072, 0, 0, 218104628, 0
    .long 4, 24, 24, 8192, 3840, 265984, 8388608, 786432, 32768, 4, 24178688, 131072, 0, 0, 218104628, 0
    .long 4, 32, 32, 8192, 2048, 264192, 8388608, 524288, 32768, 4, 39878656, 131072, 0, 0, 218104609, 0
    .long 4, 24, 24, 8192, 3328, 265472, 8388608, 786432, 32768, 4, 24170496, 131072, 0, 0, 218104628, 0
    .long 4, 32, 32, 8192, 2304, 264448, 8388608, 786432, 32768, 4, 40931328, 131072, 0, 0, 218104612, 0
    .long 4, 24, 24, 8192, 3072, 265216, 8388608, 786432, 32768, 4, 24166400, 131072, 0, 0, 218104628, 0
    .long 4, 24, 24, 8192, 2560, 264704, 8388608, 524288, 32768, 4, 23109632, 131072, 0, 0, 218104609, 0
    .long 4, 24, 24, 8192, 2304, 264448, 8388608, 786432, 32768, 4, 24154112, 131072, 0, 0, 218104612, 0
    .long 4, 32, 32, 8192, 3328, 265472, 8388608, 786432, 32768, 4, 40947712, 131072, 0, 0, 218104628, 0
    .long 4, 24, 24, 8192, 2048, 264192, 8388608, 786432, 32768, 4, 24150016, 131072, 0, 0, 218104612, 0
    .long 4, 32, 32, 8192, 3584, 265728, 8388608, 524288, 32768, 4, 39903232, 131072, 0, 0, 218104625, 0
    .long 4, 32, 32, 8192, 2816, 264960, 8388608, 786432, 32768, 4, 40939520, 131072, 0, 0, 218104612, 0
    .long 4, 32, 32, 8192, 3328, 265472, 8388608, 524288, 32768, 4, 39899136, 131072, 0, 0, 218104625, 0
    .long 4, 24, 24, 8192, 3072, 265216, 8388608, 524288, 32768, 4, 23117824, 131072, 0, 0, 218104625, 0
    .long 4, 24, 24, 8192, 3840, 265984, 8388608, 524288, 32768, 4, 23130112, 131072, 0, 0, 218104625, 0
    .long 4, 32, 32, 8192, 2048, 264192, 8388608, 786432, 32768, 4, 40927232, 131072, 0, 0, 218104612, 0
    .long 1, 16, 16, 8192, 2048, 2304, 8388608, 1572864, 32768, 8, 10518528, 131072, 0, 0, 218105130, 0
    .long 1, 32, 32, 8192, 2560, 2816, 8388608, 1048576, 32768, 8, 41984000, 131072, 0, 0, 218104874, 0
    .long 1, 32, 32, 8192, 2560, 2816, 8388608, 1572864, 32768, 8, 44081152, 131072, 0, 0, 218105130, 0
    .long 1, 24, 24, 8192, 2560, 2816, 8388608, 1048576, 32768, 8, 25206784, 131072, 0, 0, 218104874, 0
    .long 1, 16, 16, 8192, 3072, 3328, 8388608, 1048576, 32768, 8, 8437760, 131072, 0, 0, 218104890, 0
    .long 1, 16, 16, 8192, 3584, 3840, 8388608, 1048576, 32768, 8, 8445952, 131072, 0, 0, 218104890, 0
    .long 1, 32, 32, 8192, 3584, 3840, 8388608, 1048576, 32768, 8, 42000384, 131072, 0, 0, 218104890, 0
    .long 1, 24, 24, 8192, 3072, 3328, 8388608, 1048576, 32768, 8, 25214976, 131072, 0, 0, 218104890, 0
    .long 1, 24, 24, 8192, 3584, 3840, 8388608, 2097152, 32768, 8, 29417472, 131072, 0, 0, 218105402, 0
    .long 1, 24, 24, 8192, 3584, 3840, 8388608, 1048576, 32768, 8, 25223168, 131072, 0, 0, 218104890, 0
    .long 1, 32, 32, 8192, 3072, 3328, 8388608, 1048576, 32768, 8, 41992192, 131072, 0, 0, 218104890, 0
    .long 1, 24, 24, 8192, 3072, 3328, 8388608, 2097152, 32768, 8, 29409280, 131072, 0, 0, 218105402, 0
    .long 1, 24, 24, 8192, 2048, 2304, 8388608, 1572864, 32768, 8, 27295744, 131072, 0, 0, 218105130, 0
    .long 1, 32, 32, 8192, 2048, 2304, 8388608, 1572864, 32768, 8, 44072960, 131072, 0, 0, 218105130, 0
    .long 1, 24, 24, 8192, 3072, 3328, 8388608, 1572864, 32768, 8, 27312128, 131072, 0, 0, 218105146, 0
    .long 1, 16, 16, 8192, 2048, 2304, 8388608, 1048576, 32768, 8, 8421376, 131072, 0, 0, 218104874, 0
    .long 1, 24, 24, 8192, 2560, 2816, 8388608, 1572864, 32768, 8, 27303936, 131072, 0, 0, 218105130, 0
    .long 1, 16, 16, 8192, 2560, 2816, 8388608, 1572864, 32768, 8, 10526720, 131072, 0, 0, 218105130, 0
    .long 1, 32, 32, 8192, 3072, 3328, 8388608, 1572864, 32768, 8, 44089344, 131072, 0, 0, 218105146, 0
    .long 1, 16, 16, 8192, 3072, 3328, 8388608, 1572864, 32768, 8, 10534912, 131072, 0, 0, 218105146, 0
    .long 1, 32, 32, 8192, 3584, 3840, 8388608, 2097152, 32768, 8, 46194688, 131072, 0, 0, 218105402, 0
    .long 1, 24, 24, 8192, 2048, 2304, 8388608, 1048576, 32768, 8, 25198592, 131072, 0, 0, 218104874, 0
    .long 1, 24, 24, 8192, 2048, 2304, 8388608, 2097152, 32768, 8, 29392896, 131072, 0, 0, 218105386, 0
    .long 1, 16, 16, 8192, 3584, 3840, 8388608, 1572864, 32768, 8, 10543104, 131072, 0, 0, 218105146, 0
    .long 2, 64, 72, 7168, 2560, 2560, 7340032, 1572864, 32768, 8, 60071936, 114688, 0, 0, 218104001, 0
    .long 1, 32, 32, 8192, 2048, 2304, 8388608, 2097152, 32768, 8, 46170112, 131072, 0, 0, 218105386, 0
    .long 1, 32, 32, 8192, 2048, 2304, 8388608, 1048576, 32768, 8, 41975808, 131072, 0, 0, 218104874, 0
    .long 1, 32, 32, 8192, 2560, 2816, 8388608, 2097152, 32768, 8, 46178304, 131072, 0, 0, 218105386, 0
    .long 1, 24, 24, 8192, 3584, 3840, 8388608, 1572864, 32768, 8, 27320320, 131072, 0, 0, 218105146, 0
    .long 1, 32, 32, 8192, 3584, 3840, 8388608, 1572864, 32768, 8, 44097536, 131072, 0, 0, 218105146, 0
    .long 1, 16, 16, 8192, 2560, 2816, 8388608, 1048576, 32768, 8, 8429568, 131072, 0, 0, 218104874, 0
    .long 1, 32, 32, 8192, 3072, 3328, 8388608, 2097152, 32768, 8, 46186496, 131072, 0, 0, 218105402, 0
    .long 1, 16, 16, 8192, 2560, 2816, 8388608, 0, 32768, 8, 4235264, 131072, 0, 0, 218107946, 0
    .long 2, 64, 72, 7168, 2560, 2560, 7340032, 2097152, 32768, 8, 61906944, 114688, 0, 0, 218104065, 0
    .long 1, 16, 16, 8192, 3584, 3840, 8388608, 2097152, 32768, 8, 12640256, 131072, 0, 0, 218105402, 0
    .long 1, 16, 16, 8192, 2560, 2816, 8388608, 524288, 32768, 8, 6332416, 131072, 0, 0, 218108202, 0
    .long 1, 16, 16, 8192, 3584, 3840, 8388608, 3145728, 32768, 8, 16834560, 131072, 0, 0, 218105914, 0
    .long 1, 32, 32, 8192, 3584, 3840, 8388608, 2621440, 32768, 8, 48291840, 131072, 0, 0, 218105658, 0
    .long 1, 16, 16, 8192, 3072, 3328, 8388608, 0, 32768, 8, 4243456, 131072, 0, 0, 218107962, 0
    .long 1, 16, 16, 8192, 2048, 2304, 8388608, 2097152, 32768, 8, 12615680, 131072, 0, 0, 218105386, 0
    .long 1, 16, 16, 8192, 3584, 3840, 8388608, 0, 32768, 8, 4251648, 131072, 0, 0, 218107962, 0
    .long 1, 16, 16, 8192, 2048, 2304, 8388608, 524288, 32768, 8, 6324224, 131072, 0, 0, 218108202, 0
    .long 1, 24, 24, 8192, 3072, 3328, 8388608, 3145728, 32768, 8, 33603584, 131072, 0, 0, 218105914, 0
    .long 1, 24, 24, 8192, 2560, 2816, 8388608, 2621440, 32768, 8, 31498240, 131072, 0, 0, 218105642, 0
    .long 1, 16, 16, 8192, 2560, 2816, 8388608, 2621440, 32768, 8, 14721024, 131072, 0, 0, 218105642, 0
    .long 1, 16, 16, 8192, 3072, 3328, 8388608, 524288, 32768, 8, 6340608, 131072, 0, 0, 218108218, 0
    .long 2, 64, 72, 7168, 3072, 3072, 7340032, 0, 32768, 8, 54575104, 114688, 0, 0, 218103809, 0
    .long 2, 64, 72, 7168, 2560, 2560, 7340032, 0, 32768, 8, 54566912, 114688, 0, 0, 218103809, 0
    .long 2, 64, 72, 7168, 3072, 3072, 7340032, 1048576, 32768, 8, 58245120, 114688, 0, 0, 218103937, 0
    .long 1, 16, 16, 8192, 2048, 2304, 8388608, 0, 32768, 8, 4227072, 131072, 0, 0, 218107946, 0
    .long 1, 16, 16, 8192, 3584, 3840, 8388608, 524288, 32768, 8, 6348800, 131072, 0, 0, 218108218, 0
    .long 1, 24, 24, 8192, 3072, 3328, 8388608, 2621440, 32768, 8, 31506432, 131072, 0, 0, 218105658, 0
    .long 1, 16, 16, 8192, 3584, 3840, 8388608, 2621440, 32768, 8, 14737408, 131072, 0, 0, 218105658, 0
    .long 1, 24, 24, 8192, 2560, 2816, 8388608, 2097152, 32768, 8, 29401088, 131072, 0, 0, 218105386, 0
    .long 2, 64, 72, 7168, 3072, 3072, 7340032, 2097152, 32768, 8, 61915136, 114688, 0, 0, 218104065, 0
    .long 1, 16, 16, 8192, 2560, 2816, 8388608, 3145728, 32768, 8, 16818176, 131072, 0, 0, 218105898, 0
    .long 1, 16, 16, 8192, 2560, 2816, 8388608, 2097152, 32768, 8, 12623872, 131072, 0, 0, 218105386, 0
    .long 2, 64, 72, 7168, 2560, 2560, 7340032, 3670016, 32768, 8, 67411968, 114688, 0, 0, 218104260, 0
    .long 1, 24, 24, 8192, 2560, 2816, 8388608, 3145728, 32768, 8, 33595392, 131072, 0, 0, 218105898, 0
    .long 2, 64, 72, 7168, 2304, 2304, 7340032, 2097152, 32768, 8, 61902848, 114688, 0, 0, 218104065, 0
    .long 1, 16, 16, 8192, 3072, 3328, 8388608, 2097152, 32768, 8, 12632064, 131072, 0, 0, 218105402, 0
    .long 2, 64, 72, 7168, 3072, 3072, 7340032, 2621440, 32768, 8, 63750144, 114688, 0, 0, 218104132, 0
    .long 1, 32, 32, 8192, 3584, 3840, 8388608, 3145728, 32768, 8, 50388992, 131072, 0, 0, 218105914, 0
    .long 1, 24, 24, 8192, 2048, 2304, 8388608, 2621440, 32768, 8, 31490048, 131072, 0, 0, 218105642, 0
    .long 2, 64, 72, 7168, 1792, 1792, 7340032, 1048576, 32768, 8, 58224640, 114688, 0, 0, 218103937, 0
    .long 1, 32, 32, 8192, 3072, 3328, 8388608, 3145728, 32768, 8, 50380800, 131072, 0, 0, 218105914, 0
    .long 2, 64, 72, 7168, 2560, 2560, 7340032, 3145728, 32768, 8, 65576960, 114688, 0, 0, 218104196, 0
    .long 1, 16, 16, 8192, 2048, 2304, 8388608, 3145728, 32768, 8, 16809984, 131072, 0, 0, 218105898, 0
    .long 2, 64, 72, 7168, 3328, 3328, 7340032, 1048576, 32768, 8, 58249216, 114688, 0, 0, 218103937, 0
    .long 2, 64, 72, 7168, 1792, 1792, 7340032, 3145728, 32768, 8, 65564672, 114688, 0, 0, 218104196, 0
    .long 2, 64, 72, 7168, 2560, 2560, 7340032, 2621440, 32768, 8, 63741952, 114688, 0, 0, 218104132, 0
    .long 2, 64, 72, 7168, 2048, 2048, 7340032, 1048576, 32768, 8, 58228736, 114688, 0, 0, 218103937, 0
    .long 2, 64, 72, 7168, 2816, 2816, 7340032, 3145728, 32768, 8, 65581056, 114688, 0, 0, 218104196, 0
    .long 1, 16, 16, 8192, 3072, 3328, 8388608, 2621440, 32768, 8, 14729216, 131072, 0, 0, 218105658, 0
    .long 1, 32, 32, 8192, 2048, 2304, 8388608, 2621440, 32768, 8, 48267264, 131072, 0, 0, 218105642, 0
    .long 1, 16, 16, 8192, 2048, 2304, 8388608, 2621440, 32768, 8, 14712832, 131072, 0, 0, 218105642, 0
    .long 5, 218108192, 0, 0, 8, 0, 0, 8, 0, 0, 0, 0, 218112128, 11, 218106945, 0
    .long 2, 64, 72, 7168, 2048, 2048, 7340032, 524288, 32768, 8, 56393728, 114688, 0, 0, 218103873, 0
    .long 2, 64, 72, 7168, 2816, 2816, 7340032, 0, 32768, 8, 54571008, 114688, 0, 0, 218103809, 0
    .long 1, 24, 24, 8192, 2048, 2304, 8388608, 3145728, 32768, 8, 33587200, 131072, 0, 0, 218105898, 0
    .long 2, 64, 72, 7168, 3328, 3328, 7340032, 0, 32768, 8, 54579200, 114688, 0, 0, 218103809, 0
    .long 5, 218107936, 0, 0, 8, 0, 0, 0, 0, 0, 0, 0, 218112128, 3, 218106881, 0
    .long 1, 32, 32, 8192, 2560, 2816, 8388608, 3145728, 32768, 8, 50372608, 131072, 0, 0, 218105898, 0
    .long 5, 218108208, 0, 0, 12, 0, 0, 8, 0, 0, 0, 0, 218112128, 11, 218106945, 0
    .long 1, 24, 24, 8192, 3584, 3840, 8388608, 2621440, 32768, 8, 31514624, 131072, 0, 0, 218105658, 0
    .long 1, 32, 32, 8192, 3072, 3328, 8388608, 2621440, 32768, 8, 48283648, 131072, 0, 0, 218105658, 0
    .long 2, 64, 72, 7168, 2560, 2560, 7340032, 1048576, 32768, 8, 58236928, 114688, 0, 0, 218103937, 0
    .long 2, 64, 72, 7168, 2560, 2560, 7340032, 524288, 32768, 8, 56401920, 114688, 0, 0, 218103873, 0
    .long 2, 64, 72, 7168, 2304, 2304, 7340032, 524288, 32768, 8, 56397824, 114688, 0, 0, 218103873, 0
    .long 2, 64, 72, 7168, 2816, 2816, 7340032, 1048576, 32768, 8, 58241024, 114688, 0, 0, 218103937, 0
    .long 1, 32, 32, 8192, 2560, 2816, 8388608, 2621440, 32768, 8, 48275456, 131072, 0, 0, 218105642, 0
    .long 2, 64, 72, 7168, 2304, 2304, 7340032, 1048576, 32768, 8, 58232832, 114688, 0, 0, 218103937, 0
    .long 1, 16, 16, 8192, 3072, 3328, 8388608, 3670016, 32768, 8, 18923520, 131072, 0, 0, 218106170, 0
    .long 2, 64, 72, 7168, 2816, 2816, 7340032, 524288, 32768, 8, 56406016, 114688, 0, 0, 218103873, 0
    .long 1, 16, 16, 8192, 3072, 3328, 8388608, 3145728, 32768, 8, 16826368, 131072, 0, 0, 218105914, 0
    .long 5, 218107952, 0, 0, 12, 0, 0, 0, 0, 0, 0, 0, 218112128, 3, 218106881, 0
    .long 5, 218107952, 0, 0, 12, 0, 0, 4, 0, 0, 0, 0, 218112128, 7, 218106881, 0
    .long 5, 218108208, 0, 0, 12, 0, 0, 12, 0, 0, 0, 0, 218112128, 15, 218106945, 0
    .long 5, 218108192, 0, 0, 8, 0, 0, 12, 0, 0, 0, 0, 218112128, 15, 218106945, 0
    .long 5, 218107936, 0, 0, 8, 0, 0, 4, 0, 0, 0, 0, 218112128, 7, 218106881, 0
    .long 1, 32, 32, 8192, 2048, 2304, 8388608, 3145728, 32768, 8, 50364416, 131072, 0, 0, 218105898, 0
    .long 2, 64, 72, 7168, 2304, 2304, 7340032, 1572864, 32768, 8, 60067840, 114688, 0, 0, 218104001, 0
    .long 2, 64, 72, 7168, 1792, 1792, 7340032, 1572864, 32768, 8, 60059648, 114688, 0, 0, 218104001, 0
    .long 2, 64, 72, 7168, 2048, 2048, 7340032, 0, 32768, 8, 54558720, 114688, 0, 0, 218103809, 0
    .long 1, 24, 24, 8192, 3584, 3840, 8388608, 3145728, 32768, 8, 33611776, 131072, 0, 0, 218105914, 0
    .long 2, 64, 72, 7168, 3328, 3328, 7340032, 3145728, 32768, 8, 65589248, 114688, 0, 0, 218104196, 0
    .long 2, 64, 72, 7168, 1792, 1792, 7340032, 2621440, 32768, 8, 63729664, 114688, 0, 0, 218104132, 0
    .long 2, 64, 72, 7168, 2304, 2304, 7340032, 0, 32768, 8, 54562816, 114688, 0, 0, 218103809, 0
    .long 2, 64, 72, 7168, 2816, 2816, 7340032, 2097152, 32768, 8, 61911040, 114688, 0, 0, 218104065, 0
    .long 2, 64, 72, 7168, 3328, 3328, 7340032, 524288, 32768, 8, 56414208, 114688, 0, 0, 218103873, 0
    .long 2, 64, 72, 7168, 2048, 2048, 7340032, 2097152, 32768, 8, 61898752, 114688, 0, 0, 218104065, 0
    .long 2, 64, 72, 7168, 3328, 3328, 7340032, 1572864, 32768, 8, 60084224, 114688, 0, 0, 218104001, 0
    .long 2, 64, 72, 7168, 1792, 1792, 7340032, 0, 32768, 8, 54554624, 114688, 0, 0, 218103809, 0
    .long 2, 64, 72, 7168, 2816, 2816, 7340032, 3670016, 32768, 8, 67416064, 114688, 0, 0, 218104260, 0
    .long 2, 64, 72, 7168, 1792, 1792, 7340032, 524288, 32768, 8, 56389632, 114688, 0, 0, 218103873, 0
    .long 2, 64, 72, 7168, 3072, 3072, 7340032, 524288, 32768, 8, 56410112, 114688, 0, 0, 218103873, 0
    .long 2, 64, 72, 7168, 3328, 3328, 7340032, 2097152, 32768, 8, 61919232, 114688, 0, 0, 218104065, 0
    .long 1, 24, 24, 8192, 3584, 3840, 8388608, 3670016, 32768, 8, 35708928, 131072, 0, 0, 218106170, 0
    .long 2, 64, 72, 7168, 2304, 2304, 7340032, 2621440, 32768, 8, 63737856, 114688, 0, 0, 218104132, 0
    .long 2, 64, 72, 7168, 2816, 2816, 7340032, 1572864, 32768, 8, 60076032, 114688, 0, 0, 218104001, 0
    .long 2, 64, 72, 7168, 1792, 1792, 7340032, 2097152, 32768, 8, 61894656, 114688, 0, 0, 218104065, 0
    .long 2, 64, 72, 7168, 3072, 3072, 7340032, 3145728, 32768, 8, 65585152, 114688, 0, 0, 218104196, 0
    .long 2, 64, 72, 7168, 2048, 2048, 7340032, 1572864, 32768, 8, 60063744, 114688, 0, 0, 218104001, 0
    .long 2, 64, 72, 7168, 2048, 2048, 7340032, 2621440, 32768, 8, 63733760, 114688, 0, 0, 218104132, 0
    .long 1, 24, 24, 8192, 2048, 2304, 8388608, 3670016, 32768, 8, 35684352, 131072, 0, 0, 218106154, 0
    .long 2, 64, 72, 7168, 3328, 3328, 7340032, 2621440, 32768, 8, 63754240, 114688, 0, 0, 218104132, 0
    .long 2, 64, 72, 7168, 2816, 2816, 7340032, 2621440, 32768, 8, 63746048, 114688, 0, 0, 218104132, 0
    .long 2, 64, 72, 7168, 3072, 3072, 7340032, 3670016, 32768, 8, 67420160, 114688, 0, 0, 218104260, 0
    .long 2, 64, 72, 7168, 3072, 3072, 7340032, 1572864, 32768, 8, 60080128, 114688, 0, 0, 218104001, 0
    .long 1, 40, 40, 2048, 1536, 1792, 8388608, 180355072, 131072, 16, 76570624, 32768, 218112128, 25, 218106504, 0
    .long 1, 80, 80, 2048, 1024, 1280, 7340032, 58195968, 114688, 14, 118505472, 32768, 218103936, 14, 218106498, 0
    .long 1, 24, 24, 8192, 3072, 3328, 8388608, 3670016, 32768, 8, 35700736, 131072, 0, 0, 218106170, 0
    .long 1, 40, 40, 2048, 1024, 1280, 8388608, 180355072, 131072, 16, 76562432, 32768, 218112128, 25, 218106504, 0
    .long 1, 40, 40, 2048, 1024, 1280, 8388608, 178257920, 131072, 16, 76038144, 32768, 218106944, 8, 218106440, 0
    .long 2, 64, 72, 7168, 2304, 2304, 7340032, 3145728, 32768, 8, 65572864, 114688, 0, 0, 218104196, 0
    .long 1, 40, 40, 2048, 1536, 1792, 8388608, 178257920, 131072, 16, 76046336, 32768, 218106944, 8, 218106440, 0
    .long 1, 80, 80, 2048, 1536, 1792, 7340032, 58195968, 114688, 14, 118513664, 32768, 218103936, 14, 218106498, 0
    .long 2, 64, 72, 7168, 2048, 2048, 7340032, 3145728, 32768, 8, 65568768, 114688, 0, 0, 218104196, 0
    .long 1, 32, 32, 8192, 2560, 2816, 8388608, 3670016, 32768, 8, 52469760, 131072, 0, 0, 218106154, 0
    .long 1, 16, 16, 8192, 2560, 2816, 8388608, 3670016, 32768, 8, 18915328, 131072, 0, 0, 218106154, 0
    .long 1, 40, 40, 2048, 1536, 1792, 8388608, 176160768, 131072, 16, 75522048, 32768, 218106880, 8, 218106376, 0
    .long 1, 40, 40, 2048, 1024, 1280, 8388608, 176160768, 131072, 16, 75513856, 32768, 218106880, 8, 218106376, 0
    .long 1, 32, 32, 8192, 2048, 2304, 8388608, 3670016, 32768, 8, 52461568, 131072, 0, 0, 218106154, 0
    .long 1, 24, 24, 8192, 2560, 2816, 8388608, 3670016, 32768, 8, 35692544, 131072, 0, 0, 218106154, 0
    .long 1, 16, 16, 8192, 2048, 2304, 8388608, 3670016, 32768, 8, 18907136, 131072, 0, 0, 218106154, 0
    .long 1, 32, 32, 8192, 3072, 3328, 8388608, 3670016, 32768, 8, 52477952, 131072, 0, 0, 218106170, 0
    .long 1, 32, 32, 8192, 3584, 3840, 8388608, 3670016, 32768, 8, 52486144, 131072, 0, 0, 218106170, 0
    .long 2, 64, 72, 7168, 2304, 2304, 7340032, 3670016, 32768, 8, 67407872, 114688, 0, 0, 218104260, 0
    .long 2, 64, 72, 7168, 1792, 1792, 7340032, 3670016, 32768, 8, 67399680, 114688, 0, 0, 218104260, 0
    .long 1, 16, 16, 8192, 3584, 3840, 8388608, 3670016, 32768, 8, 18931712, 131072, 0, 0, 218106170, 0
    .long 2, 64, 72, 7168, 3328, 3328, 7340032, 3670016, 32768, 8, 67424256, 114688, 0, 0, 218104260, 0
    .long 1, 80, 80, 2048, 1536, 1792, 7340032, 56360960, 114688, 14, 117989376, 32768, 218103872, 14, 218106434, 0
    .long 1, 80, 80, 2048, 1024, 1280, 7340032, 54525952, 114688, 14, 117456896, 32768, 218103808, 14, 218106370, 0
    .long 1, 80, 80, 2048, 1024, 1280, 7340032, 61865984, 114688, 14, 119554048, 32768, 218104064, 14, 218106626, 0
    .long 1, 80, 80, 2048, 1024, 1280, 7340032, 56360960, 114688, 14, 117981184, 32768, 218103872, 14, 218106434, 0
    .long 2, 64, 72, 7168, 2048, 2048, 7340032, 3670016, 32768, 8, 67403776, 114688, 0, 0, 218104260, 0
    .long 1, 40, 40, 2048, 1024, 1280, 8388608, 182452224, 131072, 16, 77086720, 32768, 218112128, 33, 218106568, 0
    .long 1, 40, 40, 2048, 1536, 1792, 8388608, 182452224, 131072, 16, 77094912, 32768, 218112128, 33, 218106568, 0
    .long 1, 80, 80, 2048, 1536, 1792, 7340032, 61865984, 114688, 14, 119562240, 32768, 218104064, 14, 218106626, 0
    .long 1, 80, 80, 2048, 1536, 1792, 7340032, 54525952, 114688, 14, 117465088, 32768, 218103808, 14, 218106370, 0
    .long 1, 80, 80, 2048, 1536, 1792, 7340032, 60030976, 114688, 14, 119037952, 32768, 218104000, 14, 218106562, 0
    .long 1, 80, 80, 2048, 1024, 1280, 7340032, 60030976, 114688, 14, 119029760, 32768, 218104000, 14, 218106562, 0
    .long 1, 40, 40, 2048, 2097664, 2097920, 8388608, 184582144, 131072, 8, 81797120, 32768, 218112128, 40, 218106628, 0
    .long 1, 40, 40, 2048, 2097152, 2097408, 8388608, 184582144, 131072, 8, 81788928, 32768, 218112128, 40, 218106628, 0
    .long 1, 40, 40, 2048, 2098688, 2098944, 8388608, 184582144, 131072, 8, 81813504, 32768, 218112128, 40, 218106628, 0
    .long 1, 40, 40, 2048, 2098176, 2098432, 8388608, 184582144, 131072, 8, 81805312, 32768, 218112128, 40, 218106628, 0
    .long 1, 80, 80, 2048, 1836544, 1836800, 7340032, 63729664, 114688, 7, 124280832, 32768, 218104132, 7, 218106689, 0
    .long 1, 80, 80, 2048, 1836032, 1836288, 7340032, 63729664, 114688, 7, 124272640, 32768, 218104132, 7, 218106689, 0
    .long 1, 80, 80, 2048, 1835008, 1835264, 7340032, 63729664, 114688, 7, 124256256, 32768, 218104132, 7, 218106689, 0
    .long 1, 80, 80, 2048, 1835520, 1835776, 7340032, 63729664, 114688, 7, 124264448, 32768, 218104132, 7, 218106689, 0
    .long 1, 80, 80, 2048, 1835520, 1835776, 7340032, 65564672, 114688, 7, 124788736, 32768, 218104196, 7, 218106753, 0
    .long 1, 80, 80, 2048, 1835008, 1835264, 7340032, 65564672, 114688, 7, 124780544, 32768, 218104196, 7, 218106753, 0
    .long 1, 80, 80, 2048, 1836544, 1836800, 7340032, 65564672, 114688, 7, 124805120, 32768, 218104196, 7, 218106753, 0
    .long 1, 40, 40, 2048, 2097664, 2097920, 8388608, 186679296, 131072, 8, 82321408, 32768, 218112128, 48, 218106692, 0
    .long 1, 80, 80, 2048, 1836032, 1836288, 7340032, 65564672, 114688, 7, 124796928, 32768, 218104196, 7, 218106753, 0
    .long 1, 40, 40, 2048, 2098176, 2098432, 8388608, 186679296, 131072, 8, 82329600, 32768, 218112128, 48, 218106692, 0
    .long 1, 40, 40, 2048, 2098688, 2098944, 8388608, 186679296, 131072, 8, 82337792, 32768, 218112128, 48, 218106692, 0
    .long 1, 40, 40, 2048, 2097152, 2097408, 8388608, 186679296, 131072, 8, 82313216, 32768, 218112128, 48, 218106692, 0
    .long 1, 80, 80, 2048, 1836544, 1836800, 7340032, 67399680, 114688, 7, 125329408, 32768, 218104260, 7, 218106817, 0
    .long 1, 80, 80, 2048, 1835520, 1835776, 7340032, 67399680, 114688, 7, 125313024, 32768, 218104260, 7, 218106817, 0
    .long 1, 80, 80, 2048, 1836032, 1836288, 7340032, 67399680, 114688, 7, 125321216, 32768, 218104260, 7, 218106817, 0
    .long 1, 80, 80, 2048, 1835008, 1835264, 7340032, 67399680, 114688, 7, 125304832, 32768, 218104260, 7, 218106817, 0
    .long 6, 1, 0, 2, 1, 16, 0, 23, 0, 0, 0, 0, 0, 0, 0, 0
    .long 6, 1, 0, 2, 1, 16, 0, 17, 0, 0, 0, 0, 0, 0, 0, 0
    .long 6, 1, 0, 2, 1, 16, 0, 20, 0, 0, 0, 0, 0, 0, 0, 0
    .long 6, 1, 0, 2, 1, 16, 0, 10, 0, 0, 0, 0, 0, 0, 0, 0
    .long 6, 1, 0, 2, 1, 16, 0, 6, 0, 0, 0, 0, 0, 0, 0, 0
    .long 6, 1, 0, 2, 1, 16, 0, 13, 0, 0, 0, 0, 0, 0, 0, 0
    .long 6, 1, 0, 1, 1, 16, 0, 38, 0, 0, 0, 0, 0, 0, 0, 0
    .long 6, 1, 0, 2, 1, 16, 0, 18, 0, 0, 0, 0, 0, 0, 0, 0
    .long 6, 1, 0, 2, 1, 16, 0, 9, 0, 0, 0, 0, 0, 0, 0, 0
    .long 6, 1, 0, 2, 1, 16, 0, 2, 0, 0, 0, 0, 0, 0, 0, 0
    .long 6, 1, 0, 2, 1, 16, 0, 5, 0, 0, 0, 0, 0, 0, 0, 0
    .long 6, 1, 0, 1, 1, 16, 0, 34, 0, 0, 0, 0, 0, 0, 0, 0
    .long 6, 1, 0, 2, 1, 16, 0, 7, 0, 0, 0, 0, 0, 0, 0, 0
    .long 6, 1, 0, 2, 1, 16, 0, 1, 0, 0, 0, 0, 0, 0, 0, 0
    .long 6, 1, 0, 2, 1, 16, 0, 12, 0, 0, 0, 0, 0, 0, 0, 0
    .long 6, 1, 0, 2, 1, 16, 0, 14, 0, 0, 0, 0, 0, 0, 0, 0
    .long 6, 1, 0, 2, 1, 16, 0, 0, 0, 0, 0, 0, 0, 0, 0, 0
    .long 6, 1, 0, 2, 1, 16, 0, 3, 0, 0, 0, 0, 0, 0, 0, 0
    .long 6, 1, 0, 2, 1, 16, 0, 22, 0, 0, 0, 0, 0, 0, 0, 0
    .long 6, 1, 0, 2, 1, 16, 0, 21, 0, 0, 0, 0, 0, 0, 0, 0
    .long 6, 1, 0, 2, 1, 16, 0, 8, 0, 0, 0, 0, 0, 0, 0, 0
    .long 6, 1, 0, 2, 1, 16, 0, 15, 0, 0, 0, 0, 0, 0, 0, 0
    .long 6, 1, 0, 2, 1, 16, 0, 19, 0, 0, 0, 0, 0, 0, 0, 0
    .long 6, 1, 0, 2, 1, 16, 0, 11, 0, 0, 0, 0, 0, 0, 0, 0
    .long 6, 1, 0, 2, 1, 16, 0, 16, 0, 0, 0, 0, 0, 0, 0, 0
    .long 6, 1, 0, 2, 1, 16, 0, 4, 0, 0, 0, 0, 0, 0, 0, 0
    .long 6, 0, 0, 0, 1, 0, 0, 54, 0, 0, 0, 0, 0, 0, 0, 0
    .long 6, 0, 0, 0, 1, 0, 0, 51, 0, 0, 0, 0, 0, 0, 0, 0
    .long 6, 0, 0, 0, 1, 0, 0, 48, 0, 0, 0, 0, 0, 0, 0, 0
    .long 6, 0, 0, 0, 1, 0, 0, 49, 0, 0, 0, 0, 0, 0, 0, 0
    .long 6, 0, 0, 0, 1, 0, 0, 50, 0, 0, 0, 0, 0, 0, 0, 0
    .long 6, 0, 0, 0, 1, 0, 0, 52, 0, 0, 0, 0, 0, 0, 0, 0
    .long 6, 0, 0, 0, 1, 0, 0, 53, 0, 0, 0, 0, 0, 0, 0, 0
    .long 6, 0, 0, 0, 1, 0, 0, 55, 0, 0, 0, 0, 0, 0, 0, 0
    .long 6, 1, 0, 1, 1, 16, 0, 32, 0, 0, 0, 0, 0, 0, 0, 0
    .long 6, 1, 0, 1, 1, 16, 0, 33, 0, 0, 0, 0, 0, 0, 0, 0
    .long 6, 1, 0, 1, 1, 16, 0, 35, 0, 0, 0, 0, 0, 0, 0, 0
    .long 6, 1, 0, 1, 1, 16, 0, 36, 0, 0, 0, 0, 0, 0, 0, 0
    .long 6, 1, 0, 1, 1, 16, 0, 37, 0, 0, 0, 0, 0, 0, 0, 0
    .long 6, 1, 0, 1, 1, 16, 0, 39, 0, 0, 0, 0, 0, 0, 0, 0
    .long 6, 1, 0, 2, 1, 16, 0, 24, 0, 0, 0, 0, 0, 0, 0, 0
    .long 6, 1, 0, 2, 1, 16, 0, 26, 0, 0, 0, 0, 0, 0, 0, 0
    .long 6, 1, 0, 2, 1, 16, 0, 27, 0, 0, 0, 0, 0, 0, 0, 0
    .long 6, 1, 0, 2, 1, 16, 0, 28, 0, 0, 0, 0, 0, 0, 0, 0
    .long 6, 1, 0, 2, 1, 16, 0, 29, 0, 0, 0, 0, 0, 0, 0, 0
    .long 6, 1, 0, 2, 1, 16, 0, 30, 0, 0, 0, 0, 0, 0, 0, 0
    .long 6, 1, 0, 2, 1, 16, 0, 31, 0, 0, 0, 0, 0, 0, 0, 0
    .long 6, 1, 0, 2, 1, 16, 0, 25, 0, 0, 0, 0, 0, 0, 0, 0
    .long 6, 0, 0, 1, 1, 16, 0, 40, 0, 0, 0, 0, 0, 0, 0, 0
    .long 6, 0, 0, 1, 1, 16, 0, 41, 0, 0, 0, 0, 0, 0, 0, 0
    .long 6, 0, 0, 1, 1, 16, 0, 42, 0, 0, 0, 0, 0, 0, 0, 0
    .long 6, 0, 0, 1, 1, 16, 0, 43, 0, 0, 0, 0, 0, 0, 0, 0
    .long 6, 0, 0, 1, 1, 16, 0, 44, 0, 0, 0, 0, 0, 0, 0, 0
    .long 6, 0, 0, 1, 1, 16, 0, 47, 0, 0, 0, 0, 0, 0, 0, 0
    .long 6, 0, 0, 1, 1, 16, 0, 46, 0, 0, 0, 0, 0, 0, 0, 0
    .long 6, 0, 0, 1, 1, 16, 0, 45, 0, 0, 0, 0, 0, 0, 0, 0
    .long 6, 0, 0, 0, 1, 0, 0, 56, 0, 0, 0, 0, 0, 0, 0, 0
    .long 6, 0, 0, 0, 1, 0, 0, 57, 0, 0, 0, 0, 0, 0, 0, 0
    .long 6, 0, 0, 0, 1, 0, 0, 58, 0, 0, 0, 0, 0, 0, 0, 0
    .long 6, 0, 0, 0, 1, 0, 0, 59, 0, 0, 0, 0, 0, 0, 0, 0
    .long 6, 0, 0, 0, 1, 0, 0, 60, 0, 0, 0, 0, 0, 0, 0, 0
    .long 7, 0, 0, 0, 4, 0, 0, 61, 0, 0, 0, 0, 0, 0, 0, 0
    .long 7, 0, 0, 0, 5, 0, 0, 61, 0, 0, 0, 0, 0, 0, 0, 0
    .long 7, 0, 0, 0, 6, 0, 0, 61, 0, 0, 0, 0, 0, 0, 0, 0
    .long 7, 0, 0, 0, 7, 0, 0, 61, 0, 0, 0, 0, 0, 0, 0, 0
    .long 7, 0, 0, 0, 4, 0, 0, 62, 0, 0, 0, 0, 0, 0, 0, 0
    .long 7, 0, 0, 0, 5, 0, 0, 62, 0, 0, 0, 0, 0, 0, 0, 0
    .long 7, 0, 0, 0, 6, 0, 0, 62, 0, 0, 0, 0, 0, 0, 0, 0
    .long 7, 0, 0, 0, 7, 0, 0, 62, 0, 0, 0, 0, 0, 0, 0, 0
    .long 7, 0, 0, 0, 4, 0, 0, 63, 0, 0, 0, 0, 0, 0, 0, 0
    .long 7, 0, 0, 0, 5, 0, 0, 63, 0, 0, 0, 0, 0, 0, 0, 0
    .long 7, 0, 0, 0, 6, 0, 0, 63, 0, 0, 0, 0, 0, 0, 0, 0
    .long 7, 0, 0, 0, 7, 0, 0, 63, 0, 0, 0, 0, 0, 0, 0, 0
    .long 0, 0, 0, 0, 0, 0, 0, 0, 0, 0, 0, 0, 0, 0, 0, 0
    .long 4, 24, 24, 8192, 4096, 266240, 8388608, 0, 32768, 4, 21037056, 131072, 0, 0, 218104385, 0
    .long 4, 24, 24, 8192, 4352, 266496, 8388608, 0, 32768, 4, 21041152, 131072, 0, 0, 218104385, 0
    .long 4, 24, 24, 8192, 4608, 266752, 8388608, 0, 32768, 4, 21045248, 131072, 0, 0, 218104385, 0
    .long 4, 24, 24, 8192, 4864, 267008, 8388608, 0, 32768, 4, 21049344, 131072, 0, 0, 218104385, 0
    .long 4, 24, 24, 8192, 5120, 267264, 8388608, 0, 32768, 4, 21053440, 131072, 0, 0, 218104401, 0
    .long 4, 24, 24, 8192, 5376, 267520, 8388608, 0, 32768, 4, 21057536, 131072, 0, 0, 218104401, 0
    .long 4, 24, 24, 8192, 5632, 267776, 8388608, 0, 32768, 4, 21061632, 131072, 0, 0, 218104401, 0
    .long 4, 24, 24, 8192, 5888, 268032, 8388608, 0, 32768, 4, 21065728, 131072, 0, 0, 218104401, 0
    .long 4, 32, 32, 8192, 4096, 266240, 8388608, 0, 32768, 4, 37814272, 131072, 0, 0, 218104385, 0
    .long 4, 32, 32, 8192, 4352, 266496, 8388608, 0, 32768, 4, 37818368, 131072, 0, 0, 218104385, 0
    .long 4, 32, 32, 8192, 4608, 266752, 8388608, 0, 32768, 4, 37822464, 131072, 0, 0, 218104385, 0
    .long 4, 32, 32, 8192, 4864, 267008, 8388608, 0, 32768, 4, 37826560, 131072, 0, 0, 218104385, 0
    .long 4, 32, 32, 8192, 5120, 267264, 8388608, 0, 32768, 4, 37830656, 131072, 0, 0, 218104401, 0
    .long 4, 32, 32, 8192, 5376, 267520, 8388608, 0, 32768, 4, 37834752, 131072, 0, 0, 218104401, 0
    .long 4, 32, 32, 8192, 5632, 267776, 8388608, 0, 32768, 4, 37838848, 131072, 0, 0, 218104401, 0
    .long 4, 32, 32, 8192, 5888, 268032, 8388608, 0, 32768, 4, 37842944, 131072, 0, 0, 218104401, 0
    .long 4, 24, 24, 8192, 4096, 266240, 8388608, 262144, 32768, 4, 22085632, 131072, 0, 0, 218104388, 0
    .long 4, 24, 24, 8192, 4352, 266496, 8388608, 262144, 32768, 4, 22089728, 131072, 0, 0, 218104388, 0
    .long 4, 24, 24, 8192, 4608, 266752, 8388608, 262144, 32768, 4, 22093824, 131072, 0, 0, 218104388, 0
    .long 4, 24, 24, 8192, 4864, 267008, 8388608, 262144, 32768, 4, 22097920, 131072, 0, 0, 218104388, 0
    .long 4, 24, 24, 8192, 5120, 267264, 8388608, 262144, 32768, 4, 22102016, 131072, 0, 0, 218104404, 0
    .long 4, 24, 24, 8192, 5376, 267520, 8388608, 262144, 32768, 4, 22106112, 131072, 0, 0, 218104404, 0
    .long 4, 24, 24, 8192, 5632, 267776, 8388608, 262144, 32768, 4, 22110208, 131072, 0, 0, 218104404, 0
    .long 4, 24, 24, 8192, 5888, 268032, 8388608, 262144, 32768, 4, 22114304, 131072, 0, 0, 218104404, 0
    .long 4, 32, 32, 8192, 4096, 266240, 8388608, 262144, 32768, 4, 38862848, 131072, 0, 0, 218104388, 0
    .long 4, 32, 32, 8192, 4352, 266496, 8388608, 262144, 32768, 4, 38866944, 131072, 0, 0, 218104388, 0
    .long 4, 32, 32, 8192, 4608, 266752, 8388608, 262144, 32768, 4, 38871040, 131072, 0, 0, 218104388, 0
    .long 4, 32, 32, 8192, 4864, 267008, 8388608, 262144, 32768, 4, 38875136, 131072, 0, 0, 218104388, 0
    .long 4, 32, 32, 8192, 5120, 267264, 8388608, 262144, 32768, 4, 38879232, 131072, 0, 0, 218104404, 0
    .long 4, 32, 32, 8192, 5376, 267520, 8388608, 262144, 32768, 4, 38883328, 131072, 0, 0, 218104404, 0
    .long 4, 32, 32, 8192, 5632, 267776, 8388608, 262144, 32768, 4, 38887424, 131072, 0, 0, 218104404, 0
    .long 4, 32, 32, 8192, 5888, 268032, 8388608, 262144, 32768, 4, 38891520, 131072, 0, 0, 218104404, 0
    .long 4, 32, 32, 8192, 4608, 266752, 8388608, 786432, 32768, 4, 40968192, 131072, 0, 0, 218104644, 0
    .long 4, 32, 32, 8192, 5632, 267776, 8388608, 786432, 32768, 4, 40984576, 131072, 0, 0, 218104660, 0
    .long 4, 32, 32, 8192, 5888, 268032, 8388608, 524288, 32768, 4, 39940096, 131072, 0, 0, 218104657, 0
    .long 4, 24, 24, 8192, 4608, 266752, 8388608, 786432, 32768, 4, 24190976, 131072, 0, 0, 218104644, 0
    .long 4, 32, 32, 8192, 4608, 266752, 8388608, 524288, 32768, 4, 39919616, 131072, 0, 0, 218104641, 0
    .long 4, 32, 32, 8192, 5888, 268032, 8388608, 786432, 32768, 4, 40988672, 131072, 0, 0, 218104660, 0
    .long 4, 24, 24, 8192, 5632, 267776, 8388608, 786432, 32768, 4, 24207360, 131072, 0, 0, 218104660, 0
    .long 4, 24, 24, 8192, 4352, 266496, 8388608, 524288, 32768, 4, 23138304, 131072, 0, 0, 218104641, 0
    .long 4, 24, 24, 8192, 4864, 267008, 8388608, 524288, 32768, 4, 23146496, 131072, 0, 0, 218104641, 0
    .long 4, 24, 24, 8192, 5376, 267520, 8388608, 524288, 32768, 4, 23154688, 131072, 0, 0, 218104657, 0
    .long 4, 24, 24, 8192, 4864, 267008, 8388608, 786432, 32768, 4, 24195072, 131072, 0, 0, 218104644, 0
    .long 4, 32, 32, 8192, 4352, 266496, 8388608, 524288, 32768, 4, 39915520, 131072, 0, 0, 218104641, 0
    .long 4, 32, 32, 8192, 5120, 267264, 8388608, 524288, 32768, 4, 39927808, 131072, 0, 0, 218104657, 0
    .long 4, 24, 24, 8192, 5632, 267776, 8388608, 524288, 32768, 4, 23158784, 131072, 0, 0, 218104657, 0
    .long 4, 32, 32, 8192, 4864, 267008, 8388608, 524288, 32768, 4, 39923712, 131072, 0, 0, 218104641, 0
    .long 4, 24, 24, 8192, 4096, 266240, 8388608, 524288, 32768, 4, 23134208, 131072, 0, 0, 218104641, 0
    .long 4, 32, 32, 8192, 5120, 267264, 8388608, 786432, 32768, 4, 40976384, 131072, 0, 0, 218104660, 0
    .long 4, 24, 24, 8192, 5888, 268032, 8388608, 786432, 32768, 4, 24211456, 131072, 0, 0, 218104660, 0
    .long 4, 32, 32, 8192, 4096, 266240, 8388608, 524288, 32768, 4, 39911424, 131072, 0, 0, 218104641, 0
    .long 4, 24, 24, 8192, 5376, 267520, 8388608, 786432, 32768, 4, 24203264, 131072, 0, 0, 218104660, 0
    .long 4, 32, 32, 8192, 4352, 266496, 8388608, 786432, 32768, 4, 40964096, 131072, 0, 0, 218104644, 0
    .long 4, 24, 24, 8192, 5120, 267264, 8388608, 786432, 32768, 4, 24199168, 131072, 0, 0, 218104660, 0
    .long 4, 24, 24, 8192, 4608, 266752, 8388608, 524288, 32768, 4, 23142400, 131072, 0, 0, 218104641, 0
    .long 4, 24, 24, 8192, 4352, 266496, 8388608, 786432, 32768, 4, 24186880, 131072, 0, 0, 218104644, 0
    .long 4, 32, 32, 8192, 5376, 267520, 8388608, 786432, 32768, 4, 40980480, 131072, 0, 0, 218104660, 0
    .long 4, 24, 24, 8192, 4096, 266240, 8388608, 786432, 32768, 4, 24182784, 131072, 0, 0, 218104644, 0
    .long 4, 32, 32, 8192, 5632, 267776, 8388608, 524288, 32768, 4, 39936000, 131072, 0, 0, 218104657, 0
    .long 4, 32, 32, 8192, 4864, 267008, 8388608, 786432, 32768, 4, 40972288, 131072, 0, 0, 218104644, 0
    .long 4, 32, 32, 8192, 5376, 267520, 8388608, 524288, 32768, 4, 39931904, 131072, 0, 0, 218104657, 0
    .long 4, 24, 24, 8192, 5120, 267264, 8388608, 524288, 32768, 4, 23150592, 131072, 0, 0, 218104657, 0
    .long 4, 24, 24, 8192, 5888, 268032, 8388608, 524288, 32768, 4, 23162880, 131072, 0, 0, 218104657, 0
    .long 4, 32, 32, 8192, 4096, 266240, 8388608, 786432, 32768, 4, 40960000, 131072, 0, 0, 218104644, 0
    .long 1, 16, 16, 8192, 4096, 4352, 8388608, 1572864, 32768, 8, 10551296, 131072, 0, 0, 218105162, 0
    .long 1, 32, 32, 8192, 4608, 4864, 8388608, 1048576, 32768, 8, 42016768, 131072, 0, 0, 218104906, 0
    .long 1, 32, 32, 8192, 4608, 4864, 8388608, 1572864, 32768, 8, 44113920, 131072, 0, 0, 218105162, 0
    .long 1, 24, 24, 8192, 4608, 4864, 8388608, 1048576, 32768, 8, 25239552, 131072, 0, 0, 218104906, 0
    .long 1, 16, 16, 8192, 5120, 5376, 8388608, 1048576, 32768, 8, 8470528, 131072, 0, 0, 218104922, 0
    .long 1, 16, 16, 8192, 5632, 5888, 8388608, 1048576, 32768, 8, 8478720, 131072, 0, 0, 218104922, 0
    .long 1, 32, 32, 8192, 5632, 5888, 8388608, 1048576, 32768, 8, 42033152, 131072, 0, 0, 218104922, 0
    .long 1, 24, 24, 8192, 5120, 5376, 8388608, 1048576, 32768, 8, 25247744, 131072, 0, 0, 218104922, 0
    .long 1, 24, 24, 8192, 5632, 5888, 8388608, 2097152, 32768, 8, 29450240, 131072, 0, 0, 218105434, 0
    .long 1, 24, 24, 8192, 5632, 5888, 8388608, 1048576, 32768, 8, 25255936, 131072, 0, 0, 218104922, 0
    .long 1, 32, 32, 8192, 5120, 5376, 8388608, 1048576, 32768, 8, 42024960, 131072, 0, 0, 218104922, 0
    .long 1, 24, 24, 8192, 5120, 5376, 8388608, 2097152, 32768, 8, 29442048, 131072, 0, 0, 218105434, 0
    .long 1, 24, 24, 8192, 4096, 4352, 8388608, 1572864, 32768, 8, 27328512, 131072, 0, 0, 218105162, 0
    .long 1, 32, 32, 8192, 4096, 4352, 8388608, 1572864, 32768, 8, 44105728, 131072, 0, 0, 218105162, 0
    .long 1, 24, 24, 8192, 5120, 5376, 8388608, 1572864, 32768, 8, 27344896, 131072, 0, 0, 218105178, 0
    .long 1, 16, 16, 8192, 4096, 4352, 8388608, 1048576, 32768, 8, 8454144, 131072, 0, 0, 218104906, 0
    .long 1, 24, 24, 8192, 4608, 4864, 8388608, 1572864, 32768, 8, 27336704, 131072, 0, 0, 218105162, 0
    .long 1, 16, 16, 8192, 4608, 4864, 8388608, 1572864, 32768, 8, 10559488, 131072, 0, 0, 218105162, 0
    .long 1, 32, 32, 8192, 5120, 5376, 8388608, 1572864, 32768, 8, 44122112, 131072, 0, 0, 218105178, 0
    .long 1, 16, 16, 8192, 5120, 5376, 8388608, 1572864, 32768, 8, 10567680, 131072, 0, 0, 218105178, 0
    .long 1, 32, 32, 8192, 5632, 5888, 8388608, 2097152, 32768, 8, 46227456, 131072, 0, 0, 218105434, 0
    .long 1, 24, 24, 8192, 4096, 4352, 8388608, 1048576, 32768, 8, 25231360, 131072, 0, 0, 218104906, 0
    .long 1, 24, 24, 8192, 4096, 4352, 8388608, 2097152, 32768, 8, 29425664, 131072, 0, 0, 218105418, 0
    .long 1, 16, 16, 8192, 5632, 5888, 8388608, 1572864, 32768, 8, 10575872, 131072, 0, 0, 218105178, 0
    .long 2, 64, 72, 7168, 4352, 4352, 7340032, 1572864, 32768, 8, 60100608, 114688, 0, 0, 218104017, 0
    .long 1, 32, 32, 8192, 4096, 4352, 8388608, 2097152, 32768, 8, 46202880, 131072, 0, 0, 218105418, 0
    .long 1, 32, 32, 8192, 4096, 4352, 8388608, 1048576, 32768, 8, 42008576, 131072, 0, 0, 218104906, 0
    .long 1, 32, 32, 8192, 4608, 4864, 8388608, 2097152, 32768, 8, 46211072, 131072, 0, 0, 218105418, 0
    .long 1, 24, 24, 8192, 5632, 5888, 8388608, 1572864, 32768, 8, 27353088, 131072, 0, 0, 218105178, 0
    .long 1, 32, 32, 8192, 5632, 5888, 8388608, 1572864, 32768, 8, 44130304, 131072, 0, 0, 218105178, 0
    .long 1, 16, 16, 8192, 4608, 4864, 8388608, 1048576, 32768, 8, 8462336, 131072, 0, 0, 218104906, 0
    .long 1, 32, 32, 8192, 5120, 5376, 8388608, 2097152, 32768, 8, 46219264, 131072, 0, 0, 218105434, 0
    .long 1, 16, 16, 8192, 4608, 4864, 8388608, 0, 32768, 8, 4268032, 131072, 0, 0, 218107978, 0
    .long 2, 64, 72, 7168, 4352, 4352, 7340032, 2097152, 32768, 8, 61935616, 114688, 0, 0, 218104081, 0
    .long 1, 16, 16, 8192, 5632, 5888, 8388608, 2097152, 32768, 8, 12673024, 131072, 0, 0, 218105434, 0
    .long 1, 16, 16, 8192, 4608, 4864, 8388608, 524288, 32768, 8, 6365184, 131072, 0, 0, 218108234, 0
    .long 1, 16, 16, 8192, 5632, 5888, 8388608, 3145728, 32768, 8, 16867328, 131072, 0, 0, 218105946, 0
    .long 1, 32, 32, 8192, 5632, 5888, 8388608, 2621440, 32768, 8, 48324608, 131072, 0, 0, 218105690, 0
    .long 1, 16, 16, 8192, 5120, 5376, 8388608, 0, 32768, 8, 4276224, 131072, 0, 0, 218107994, 0
    .long 1, 16, 16, 8192, 4096, 4352, 8388608, 2097152, 32768, 8, 12648448, 131072, 0, 0, 218105418, 0
    .long 1, 16, 16, 8192, 5632, 5888, 8388608, 0, 32768, 8, 4284416, 131072, 0, 0, 218107994, 0
    .long 1, 16, 16, 8192, 4096, 4352, 8388608, 524288, 32768, 8, 6356992, 131072, 0, 0, 218108234, 0
    .long 1, 24, 24, 8192, 5120, 5376, 8388608, 3145728, 32768, 8, 33636352, 131072, 0, 0, 218105946, 0
    .long 1, 24, 24, 8192, 4608, 4864, 8388608, 2621440, 32768, 8, 31531008, 131072, 0, 0, 218105674, 0
    .long 1, 16, 16, 8192, 4608, 4864, 8388608, 2621440, 32768, 8, 14753792, 131072, 0, 0, 218105674, 0
    .long 1, 16, 16, 8192, 5120, 5376, 8388608, 524288, 32768, 8, 6373376, 131072, 0, 0, 218108250, 0
    .long 2, 64, 72, 7168, 4864, 4864, 7340032, 0, 32768, 8, 54603776, 114688, 0, 0, 218103825, 0
    .long 2, 64, 72, 7168, 4352, 4352, 7340032, 0, 32768, 8, 54595584, 114688, 0, 0, 218103825, 0
    .long 2, 64, 72, 7168, 4864, 4864, 7340032, 1048576, 32768, 8, 58273792, 114688, 0, 0, 218103953, 0
    .long 1, 16, 16, 8192, 4096, 4352, 8388608, 0, 32768, 8, 4259840, 131072, 0, 0, 218107978, 0
    .long 1, 16, 16, 8192, 5632, 5888, 8388608, 524288, 32768, 8, 6381568, 131072, 0, 0, 218108250, 0
    .long 1, 24, 24, 8192, 5120, 5376, 8388608, 2621440, 32768, 8, 31539200, 131072, 0, 0, 218105690, 0
    .long 1, 16, 16, 8192, 5632, 5888, 8388608, 2621440, 32768, 8, 14770176, 131072, 0, 0, 218105690, 0
    .long 1, 24, 24, 8192, 4608, 4864, 8388608, 2097152, 32768, 8, 29433856, 131072, 0, 0, 218105418, 0
    .long 2, 64, 72, 7168, 4864, 4864, 7340032, 2097152, 32768, 8, 61943808, 114688, 0, 0, 218104081, 0
    .long 1, 16, 16, 8192, 4608, 4864, 8388608, 3145728, 32768, 8, 16850944, 131072, 0, 0, 218105930, 0
    .long 1, 16, 16, 8192, 4608, 4864, 8388608, 2097152, 32768, 8, 12656640, 131072, 0, 0, 218105418, 0
    .long 2, 64, 72, 7168, 4352, 4352, 7340032, 3670016, 32768, 8, 67440640, 114688, 0, 0, 218104273, 0
    .long 1, 24, 24, 8192, 4608, 4864, 8388608, 3145728, 32768, 8, 33628160, 131072, 0, 0, 218105930, 0
    .long 2, 64, 72, 7168, 4096, 4096, 7340032, 2097152, 32768, 8, 61931520, 114688, 0, 0, 218104081, 0
    .long 1, 16, 16, 8192, 5120, 5376, 8388608, 2097152, 32768, 8, 12664832, 131072, 0, 0, 218105434, 0
    .long 2, 64, 72, 7168, 4864, 4864, 7340032, 2621440, 32768, 8, 63778816, 114688, 0, 0, 218104145, 0
    .long 1, 32, 32, 8192, 5632, 5888, 8388608, 3145728, 32768, 8, 50421760, 131072, 0, 0, 218105946, 0
    .long 1, 24, 24, 8192, 4096, 4352, 8388608, 2621440, 32768, 8, 31522816, 131072, 0, 0, 218105674, 0
    .long 2, 64, 72, 7168, 3584, 3584, 7340032, 1048576, 32768, 8, 58253312, 114688, 0, 0, 218103953, 0
    .long 1, 32, 32, 8192, 5120, 5376, 8388608, 3145728, 32768, 8, 50413568, 131072, 0, 0, 218105946, 0
    .long 2, 64, 72, 7168, 4352, 4352, 7340032, 3145728, 32768, 8, 65605632, 114688, 0, 0, 218104209, 0
    .long 1, 16, 16, 8192, 4096, 4352, 8388608, 3145728, 32768, 8, 16842752, 131072, 0, 0, 218105930, 0
    .long 2, 64, 72, 7168, 5120, 5120, 7340032, 1048576, 32768, 8, 58277888, 114688, 0, 0, 218103953, 0
    .long 2, 64, 72, 7168, 3584, 3584, 7340032, 3145728, 32768, 8, 65593344, 114688, 0, 0, 218104209, 0
    .long 2, 64, 72, 7168, 4352, 4352, 7340032, 2621440, 32768, 8, 63770624, 114688, 0, 0, 218104145, 0
    .long 2, 64, 72, 7168, 3840, 3840, 7340032, 1048576, 32768, 8, 58257408, 114688, 0, 0, 218103953, 0
    .long 2, 64, 72, 7168, 4608, 4608, 7340032, 3145728, 32768, 8, 65609728, 114688, 0, 0, 218104209, 0
    .long 1, 16, 16, 8192, 5120, 5376, 8388608, 2621440, 32768, 8, 14761984, 131072, 0, 0, 218105690, 0
    .long 1, 32, 32, 8192, 4096, 4352, 8388608, 2621440, 32768, 8, 48300032, 131072, 0, 0, 218105674, 0
    .long 1, 16, 16, 8192, 4096, 4352, 8388608, 2621440, 32768, 8, 14745600, 131072, 0, 0, 218105674, 0
    .long 5, 218108224, 0, 0, 16, 0, 0, 8, 0, 0, 0, 0, 218112256, 11, 218106961, 0
    .long 2, 64, 72, 7168, 3840, 3840, 7340032, 524288, 32768, 8, 56422400, 114688, 0, 0, 218103889, 0
    .long 2, 64, 72, 7168, 4608, 4608, 7340032, 0, 32768, 8, 54599680, 114688, 0, 0, 218103825, 0
    .long 1, 24, 24, 8192, 4096, 4352, 8388608, 3145728, 32768, 8, 33619968, 131072, 0, 0, 218105930, 0
    .long 2, 64, 72, 7168, 5120, 5120, 7340032, 0, 32768, 8, 54607872, 114688, 0, 0, 218103825, 0
    .long 5, 218107968, 0, 0, 16, 0, 0, 0, 0, 0, 0, 0, 218112256, 3, 218106897, 0
    .long 1, 32, 32, 8192, 4608, 4864, 8388608, 3145728, 32768, 8, 50405376, 131072, 0, 0, 218105930, 0
    .long 5, 218108240, 0, 0, 20, 0, 0, 8, 0, 0, 0, 0, 218112256, 11, 218106961, 0
    .long 1, 24, 24, 8192, 5632, 5888, 8388608, 2621440, 32768, 8, 31547392, 131072, 0, 0, 218105690, 0
    .long 1, 32, 32, 8192, 5120, 5376, 8388608, 2621440, 32768, 8, 48316416, 131072, 0, 0, 218105690, 0
    .long 2, 64, 72, 7168, 4352, 4352, 7340032, 1048576, 32768, 8, 58265600, 114688, 0, 0, 218103953, 0
    .long 2, 64, 72, 7168, 4352, 4352, 7340032, 524288, 32768, 8, 56430592, 114688, 0, 0, 218103889, 0
    .long 2, 64, 72, 7168, 4096, 4096, 7340032, 524288, 32768, 8, 56426496, 114688, 0, 0, 218103889, 0
    .long 2, 64, 72, 7168, 4608, 4608, 7340032, 1048576, 32768, 8, 58269696, 114688, 0, 0, 218103953, 0
    .long 1, 32, 32, 8192, 4608, 4864, 8388608, 2621440, 32768, 8, 48308224, 131072, 0, 0, 218105674, 0
    .long 2, 64, 72, 7168, 4096, 4096, 7340032, 1048576, 32768, 8, 58261504, 114688, 0, 0, 218103953, 0
    .long 1, 16, 16, 8192, 5120, 5376, 8388608, 3670016, 32768, 8, 18956288, 131072, 0, 0, 218106202, 0
    .long 2, 64, 72, 7168, 4608, 4608, 7340032, 524288, 32768, 8, 56434688, 114688, 0, 0, 218103889, 0
    .long 1, 16, 16, 8192, 5120, 5376, 8388608, 3145728, 32768, 8, 16859136, 131072, 0, 0, 218105946, 0
    .long 5, 218107984, 0, 0, 20, 0, 0, 0, 0, 0, 0, 0, 218112256, 3, 218106897, 0
    .long 5, 218107984, 0, 0, 20, 0, 0, 4, 0, 0, 0, 0, 218112256, 7, 218106897, 0
    .long 5, 218108240, 0, 0, 20, 0, 0, 12, 0, 0, 0, 0, 218112256, 15, 218106961, 0
    .long 5, 218108224, 0, 0, 16, 0, 0, 12, 0, 0, 0, 0, 218112256, 15, 218106961, 0
    .long 5, 218107968, 0, 0, 16, 0, 0, 4, 0, 0, 0, 0, 218112256, 7, 218106897, 0
    .long 1, 32, 32, 8192, 4096, 4352, 8388608, 3145728, 32768, 8, 50397184, 131072, 0, 0, 218105930, 0
    .long 2, 64, 72, 7168, 4096, 4096, 7340032, 1572864, 32768, 8, 60096512, 114688, 0, 0, 218104017, 0
    .long 2, 64, 72, 7168, 3584, 3584, 7340032, 1572864, 32768, 8, 60088320, 114688, 0, 0, 218104017, 0
    .long 2, 64, 72, 7168, 3840, 3840, 7340032, 0, 32768, 8, 54587392, 114688, 0, 0, 218103825, 0
    .long 1, 24, 24, 8192, 5632, 5888, 8388608, 3145728, 32768, 8, 33644544, 131072, 0, 0, 218105946, 0
    .long 2, 64, 72, 7168, 5120, 5120, 7340032, 3145728, 32768, 8, 65617920, 114688, 0, 0, 218104209, 0
    .long 2, 64, 72, 7168, 3584, 3584, 7340032, 2621440, 32768, 8, 63758336, 114688, 0, 0, 218104145, 0
    .long 2, 64, 72, 7168, 4096, 4096, 7340032, 0, 32768, 8, 54591488, 114688, 0, 0, 218103825, 0
    .long 2, 64, 72, 7168, 4608, 4608, 7340032, 2097152, 32768, 8, 61939712, 114688, 0, 0, 218104081, 0
    .long 2, 64, 72, 7168, 5120, 5120, 7340032, 524288, 32768, 8, 56442880, 114688, 0, 0, 218103889, 0
    .long 2, 64, 72, 7168, 3840, 3840, 7340032, 2097152, 32768, 8, 61927424, 114688, 0, 0, 218104081, 0
    .long 2, 64, 72, 7168, 5120, 5120, 7340032, 1572864, 32768, 8, 60112896, 114688, 0, 0, 218104017, 0
    .long 2, 64, 72, 7168, 3584, 3584, 7340032, 0, 32768, 8, 54583296, 114688, 0, 0, 218103825, 0
    .long 2, 64, 72, 7168, 4608, 4608, 7340032, 3670016, 32768, 8, 67444736, 114688, 0, 0, 218104273, 0
    .long 2, 64, 72, 7168, 3584, 3584, 7340032, 524288, 32768, 8, 56418304, 114688, 0, 0, 218103889, 0
    .long 2, 64, 72, 7168, 4864, 4864, 7340032, 524288, 32768, 8, 56438784, 114688, 0, 0, 218103889, 0
    .long 2, 64, 72, 7168, 5120, 5120, 7340032, 2097152, 32768, 8, 61947904, 114688, 0, 0, 218104081, 0
    .long 1, 24, 24, 8192, 5632, 5888, 8388608, 3670016, 32768, 8, 35741696, 131072, 0, 0, 218106202, 0
    .long 2, 64, 72, 7168, 4096, 4096, 7340032, 2621440, 32768, 8, 63766528, 114688, 0, 0, 218104145, 0
    .long 2, 64, 72, 7168, 4608, 4608, 7340032, 1572864, 32768, 8, 60104704, 114688, 0, 0, 218104017, 0
    .long 2, 64, 72, 7168, 3584, 3584, 7340032, 2097152, 32768, 8, 61923328, 114688, 0, 0, 218104081, 0
    .long 2, 64, 72, 7168, 4864, 4864, 7340032, 3145728, 32768, 8, 65613824, 114688, 0, 0, 218104209, 0
    .long 2, 64, 72, 7168, 3840, 3840, 7340032, 1572864, 32768, 8, 60092416, 114688, 0, 0, 218104017, 0
    .long 2, 64, 72, 7168, 3840, 3840, 7340032, 2621440, 32768, 8, 63762432, 114688, 0, 0, 218104145, 0
    .long 1, 24, 24, 8192, 4096, 4352, 8388608, 3670016, 32768, 8, 35717120, 131072, 0, 0, 218106186, 0
    .long 2, 64, 72, 7168, 5120, 5120, 7340032, 2621440, 32768, 8, 63782912, 114688, 0, 0, 218104145, 0
    .long 2, 64, 72, 7168, 4608, 4608, 7340032, 2621440, 32768, 8, 63774720, 114688, 0, 0, 218104145, 0
    .long 2, 64, 72, 7168, 4864, 4864, 7340032, 3670016, 32768, 8, 67448832, 114688, 0, 0, 218104273, 0
    .long 2, 64, 72, 7168, 4864, 4864, 7340032, 1572864, 32768, 8, 60108800, 114688, 0, 0, 218104017, 0
    .long 1, 40, 40, 2048, 4194816, 4195072, 8388608, 180420608, 131072, 16, 80748544, 32768, 218112256, 25, 218106504, 0
    .long 1, 80, 80, 2048, 3670016, 3670272, 7340032, 58253312, 114688, 14, 122683392, 32768, 218103952, 14, 218106498, 0
    .long 1, 24, 24, 8192, 5120, 5376, 8388608, 3670016, 32768, 8, 35733504, 131072, 0, 0, 218106202, 0
    .long 1, 40, 40, 2048, 4194304, 4194560, 8388608, 180420608, 131072, 16, 80740352, 32768, 218112256, 25, 218106504, 0
    .long 1, 40, 40, 2048, 4194304, 4194560, 8388608, 178323456, 131072, 16, 80216064, 32768, 218106960, 8, 218106440, 0
    .long 2, 64, 72, 7168, 4096, 4096, 7340032, 3145728, 32768, 8, 65601536, 114688, 0, 0, 218104209, 0
    .long 1, 40, 40, 2048, 4194816, 4195072, 8388608, 178323456, 131072, 16, 80224256, 32768, 218106960, 8, 218106440, 0
    .long 1, 80, 80, 2048, 3670528, 3670784, 7340032, 58253312, 114688, 14, 122691584, 32768, 218103952, 14, 218106498, 0
    .long 2, 64, 72, 7168, 3840, 3840, 7340032, 3145728, 32768, 8, 65597440, 114688, 0, 0, 218104209, 0
    .long 1, 32, 32, 8192, 4608, 4864, 8388608, 3670016, 32768, 8, 52502528, 131072, 0, 0, 218106186, 0
    .long 1, 16, 16, 8192, 4608, 4864, 8388608, 3670016, 32768, 8, 18948096, 131072, 0, 0, 218106186, 0
    .long 1, 40, 40, 2048, 4194816, 4195072, 8388608, 176226304, 131072, 16, 79699968, 32768, 218106896, 8, 218106376, 0
    .long 1, 40, 40, 2048, 4194304, 4194560, 8388608, 176226304, 131072, 16, 79691776, 32768, 218106896, 8, 218106376, 0
    .long 1, 32, 32, 8192, 4096, 4352, 8388608, 3670016, 32768, 8, 52494336, 131072, 0, 0, 218106186, 0
    .long 1, 24, 24, 8192, 4608, 4864, 8388608, 3670016, 32768, 8, 35725312, 131072, 0, 0, 218106186, 0
    .long 1, 16, 16, 8192, 4096, 4352, 8388608, 3670016, 32768, 8, 18939904, 131072, 0, 0, 218106186, 0
    .long 1, 32, 32, 8192, 5120, 5376, 8388608, 3670016, 32768, 8, 52510720, 131072, 0, 0, 218106202, 0
    .long 1, 32, 32, 8192, 5632, 5888, 8388608, 3670016, 32768, 8, 52518912, 131072, 0, 0, 218106202, 0
    .long 2, 64, 72, 7168, 4096, 4096, 7340032, 3670016, 32768, 8, 67436544, 114688, 0, 0, 218104273, 0
    .long 2, 64, 72, 7168, 3584, 3584, 7340032, 3670016, 32768, 8, 67428352, 114688, 0, 0, 218104273, 0
    .long 1, 16, 16, 8192, 5632, 5888, 8388608, 3670016, 32768, 8, 18964480, 131072, 0, 0, 218106202, 0
    .long 2, 64, 72, 7168, 5120, 5120, 7340032, 3670016, 32768, 8, 67452928, 114688, 0, 0, 218104273, 0
    .long 1, 80, 80, 2048, 3670528, 3670784, 7340032, 56418304, 114688, 14, 122167296, 32768, 218103888, 14, 218106434, 0
    .long 1, 80, 80, 2048, 3670016, 3670272, 7340032, 54583296, 114688, 14, 121634816, 32768, 218103824, 14, 218106370, 0
    .long 1, 80, 80, 2048, 3670016, 3670272, 7340032, 61923328, 114688, 14, 123731968, 32768, 218104080, 14, 218106626, 0
    .long 1, 80, 80, 2048, 3670016, 3670272, 7340032, 56418304, 114688, 14, 122159104, 32768, 218103888, 14, 218106434, 0
    .long 2, 64, 72, 7168, 3840, 3840, 7340032, 3670016, 32768, 8, 67432448, 114688, 0, 0, 218104273, 0
    .long 1, 40, 40, 2048, 4194304, 4194560, 8388608, 182517760, 131072, 16, 81264640, 32768, 218112256, 33, 218106568, 0
    .long 1, 40, 40, 2048, 4194816, 4195072, 8388608, 182517760, 131072, 16, 81272832, 32768, 218112256, 33, 218106568, 0
    .long 1, 80, 80, 2048, 3670528, 3670784, 7340032, 61923328, 114688, 14, 123740160, 32768, 218104080, 14, 218106626, 0
    .long 1, 80, 80, 2048, 3670528, 3670784, 7340032, 54583296, 114688, 14, 121643008, 32768, 218103824, 14, 218106370, 0
    .long 1, 80, 80, 2048, 3670528, 3670784, 7340032, 60088320, 114688, 14, 123215872, 32768, 218104016, 14, 218106562, 0
    .long 1, 80, 80, 2048, 3670016, 3670272, 7340032, 60088320, 114688, 14, 123207680, 32768, 218104016, 14, 218106562, 0
    .long 1, 40, 40, 2048, 4194816, 4195072, 8388608, 184614912, 131072, 8, 85991424, 32768, 218112256, 40, 218106628, 0
    .long 1, 40, 40, 2048, 4194304, 4194560, 8388608, 184614912, 131072, 8, 85983232, 32768, 218112256, 40, 218106628, 0
    .long 1, 40, 40, 2048, 4195840, 4196096, 8388608, 184614912, 131072, 8, 86007808, 32768, 218112256, 40, 218106628, 0
    .long 1, 40, 40, 2048, 4195328, 4195584, 8388608, 184614912, 131072, 8, 85999616, 32768, 218112256, 40, 218106628, 0
    .long 1, 80, 80, 2048, 3671552, 3671808, 7340032, 63758336, 114688, 7, 128475136, 32768, 218104144, 7, 218106689, 0
    .long 1, 80, 80, 2048, 3671040, 3671296, 7340032, 63758336, 114688, 7, 128466944, 32768, 218104144, 7, 218106689, 0
    .long 1, 80, 80, 2048, 3670016, 3670272, 7340032, 63758336, 114688, 7, 128450560, 32768, 218104144, 7, 218106689, 0
    .long 1, 80, 80, 2048, 3670528, 3670784, 7340032, 63758336, 114688, 7, 128458752, 32768, 218104144, 7, 218106689, 0
    .long 1, 80, 80, 2048, 3670528, 3670784, 7340032, 65593344, 114688, 7, 128983040, 32768, 218104208, 7, 218106753, 0
    .long 1, 80, 80, 2048, 3670016, 3670272, 7340032, 65593344, 114688, 7, 128974848, 32768, 218104208, 7, 218106753, 0
    .long 1, 80, 80, 2048, 3671552, 3671808, 7340032, 65593344, 114688, 7, 128999424, 32768, 218104208, 7, 218106753, 0
    .long 1, 40, 40, 2048, 4194816, 4195072, 8388608, 186712064, 131072, 8, 86515712, 32768, 218112256, 48, 218106692, 0
    .long 1, 80, 80, 2048, 3671040, 3671296, 7340032, 65593344, 114688, 7, 128991232, 32768, 218104208, 7, 218106753, 0
    .long 1, 40, 40, 2048, 4195328, 4195584, 8388608, 186712064, 131072, 8, 86523904, 32768, 218112256, 48, 218106692, 0
    .long 1, 40, 40, 2048, 4195840, 4196096, 8388608, 186712064, 131072, 8, 86532096, 32768, 218112256, 48, 218106692, 0
    .long 1, 40, 40, 2048, 4194304, 4194560, 8388608, 186712064, 131072, 8, 86507520, 32768, 218112256, 48, 218106692, 0
    .long 1, 80, 80, 2048, 3671552, 3671808, 7340032, 67428352, 114688, 7, 129523712, 32768, 218104272, 7, 218106817, 0
    .long 1, 80, 80, 2048, 3670528, 3670784, 7340032, 67428352, 114688, 7, 129507328, 32768, 218104272, 7, 218106817, 0
    .long 1, 80, 80, 2048, 3671040, 3671296, 7340032, 67428352, 114688, 7, 129515520, 32768, 218104272, 7, 218106817, 0
    .long 1, 80, 80, 2048, 3670016, 3670272, 7340032, 67428352, 114688, 7, 129499136, 32768, 218104272, 7, 218106817, 0
    .long 6, 1, 0, 2, 2, 16, 0, 23, 0, 0, 0, 0, 0, 0, 0, 0
    .long 6, 1, 0, 2, 2, 16, 0, 17, 0, 0, 0, 0, 0, 0, 0, 0
    .long 6, 1, 0, 2, 2, 16, 0, 20, 0, 0, 0, 0, 0, 0, 0, 0
    .long 6, 1, 0, 2, 2, 16, 0, 10, 0, 0, 0, 0, 0, 0, 0, 0
    .long 6, 1, 0, 2, 2, 16, 0, 6, 0, 0, 0, 0, 0, 0, 0, 0
    .long 6, 1, 0, 2, 2, 16, 0, 13, 0, 0, 0, 0, 0, 0, 0, 0
    .long 6, 1, 0, 1, 2, 16, 0, 38, 0, 0, 0, 0, 0, 0, 0, 0
    .long 6, 1, 0, 2, 2, 16, 0, 18, 0, 0, 0, 0, 0, 0, 0, 0
    .long 6, 1, 0, 2, 2, 16, 0, 9, 0, 0, 0, 0, 0, 0, 0, 0
    .long 6, 1, 0, 2, 2, 16, 0, 2, 0, 0, 0, 0, 0, 0, 0, 0
    .long 6, 1, 0, 2, 2, 16, 0, 5, 0, 0, 0, 0, 0, 0, 0, 0
    .long 6, 1, 0, 1, 2, 16, 0, 34, 0, 0, 0, 0, 0, 0, 0, 0
    .long 6, 1, 0, 2, 2, 16, 0, 7, 0, 0, 0, 0, 0, 0, 0, 0
    .long 6, 1, 0, 2, 2, 16, 0, 1, 0, 0, 0, 0, 0, 0, 0, 0
    .long 6, 1, 0, 2, 2, 16, 0, 12, 0, 0, 0, 0, 0, 0, 0, 0
    .long 6, 1, 0, 2, 2, 16, 0, 14, 0, 0, 0, 0, 0, 0, 0, 0
    .long 6, 1, 0, 2, 2, 16, 0, 0, 0, 0, 0, 0, 0, 0, 0, 0
    .long 6, 1, 0, 2, 2, 16, 0, 3, 0, 0, 0, 0, 0, 0, 0, 0
    .long 6, 1, 0, 2, 2, 16, 0, 22, 0, 0, 0, 0, 0, 0, 0, 0
    .long 6, 1, 0, 2, 2, 16, 0, 21, 0, 0, 0, 0, 0, 0, 0, 0
    .long 6, 1, 0, 2, 2, 16, 0, 8, 0, 0, 0, 0, 0, 0, 0, 0
    .long 6, 1, 0, 2, 2, 16, 0, 15, 0, 0, 0, 0, 0, 0, 0, 0
    .long 6, 1, 0, 2, 2, 16, 0, 19, 0, 0, 0, 0, 0, 0, 0, 0
    .long 6, 1, 0, 2, 2, 16, 0, 11, 0, 0, 0, 0, 0, 0, 0, 0
    .long 6, 1, 0, 2, 2, 16, 0, 16, 0, 0, 0, 0, 0, 0, 0, 0
    .long 6, 1, 0, 2, 2, 16, 0, 4, 0, 0, 0, 0, 0, 0, 0, 0
    .long 6, 0, 0, 0, 2, 0, 0, 54, 0, 0, 0, 0, 0, 0, 0, 0
    .long 6, 0, 0, 0, 2, 0, 0, 51, 0, 0, 0, 0, 0, 0, 0, 0
    .long 6, 0, 0, 0, 2, 0, 0, 48, 0, 0, 0, 0, 0, 0, 0, 0
    .long 6, 0, 0, 0, 2, 0, 0, 49, 0, 0, 0, 0, 0, 0, 0, 0
    .long 6, 0, 0, 0, 2, 0, 0, 50, 0, 0, 0, 0, 0, 0, 0, 0
    .long 6, 0, 0, 0, 2, 0, 0, 52, 0, 0, 0, 0, 0, 0, 0, 0
    .long 6, 0, 0, 0, 2, 0, 0, 53, 0, 0, 0, 0, 0, 0, 0, 0
    .long 6, 0, 0, 0, 2, 0, 0, 55, 0, 0, 0, 0, 0, 0, 0, 0
    .long 6, 1, 0, 1, 2, 16, 0, 32, 0, 0, 0, 0, 0, 0, 0, 0
    .long 6, 1, 0, 1, 2, 16, 0, 33, 0, 0, 0, 0, 0, 0, 0, 0
    .long 6, 1, 0, 1, 2, 16, 0, 35, 0, 0, 0, 0, 0, 0, 0, 0
    .long 6, 1, 0, 1, 2, 16, 0, 36, 0, 0, 0, 0, 0, 0, 0, 0
    .long 6, 1, 0, 1, 2, 16, 0, 37, 0, 0, 0, 0, 0, 0, 0, 0
    .long 6, 1, 0, 1, 2, 16, 0, 39, 0, 0, 0, 0, 0, 0, 0, 0
    .long 6, 1, 0, 2, 2, 16, 0, 24, 0, 0, 0, 0, 0, 0, 0, 0
    .long 6, 1, 0, 2, 2, 16, 0, 26, 0, 0, 0, 0, 0, 0, 0, 0
    .long 6, 1, 0, 2, 2, 16, 0, 27, 0, 0, 0, 0, 0, 0, 0, 0
    .long 6, 1, 0, 2, 2, 16, 0, 28, 0, 0, 0, 0, 0, 0, 0, 0
    .long 6, 1, 0, 2, 2, 16, 0, 29, 0, 0, 0, 0, 0, 0, 0, 0
    .long 6, 1, 0, 2, 2, 16, 0, 30, 0, 0, 0, 0, 0, 0, 0, 0
    .long 6, 1, 0, 2, 2, 16, 0, 31, 0, 0, 0, 0, 0, 0, 0, 0
    .long 6, 1, 0, 2, 2, 16, 0, 25, 0, 0, 0, 0, 0, 0, 0, 0
    .long 6, 0, 0, 1, 2, 16, 0, 40, 0, 0, 0, 0, 0, 0, 0, 0
    .long 6, 0, 0, 1, 2, 16, 0, 41, 0, 0, 0, 0, 0, 0, 0, 0
    .long 6, 0, 0, 1, 2, 16, 0, 42, 0, 0, 0, 0, 0, 0, 0, 0
    .long 6, 0, 0, 1, 2, 16, 0, 43, 0, 0, 0, 0, 0, 0, 0, 0
    .long 6, 0, 0, 1, 2, 16, 0, 44, 0, 0, 0, 0, 0, 0, 0, 0
    .long 6, 0, 0, 1, 2, 16, 0, 47, 0, 0, 0, 0, 0, 0, 0, 0
    .long 6, 0, 0, 1, 2, 16, 0, 46, 0, 0, 0, 0, 0, 0, 0, 0
    .long 6, 0, 0, 1, 2, 16, 0, 45, 0, 0, 0, 0, 0, 0, 0, 0
    .long 6, 0, 0, 0, 2, 0, 0, 56, 0, 0, 0, 0, 0, 0, 0, 0
    .long 6, 0, 0, 0, 2, 0, 0, 57, 0, 0, 0, 0, 0, 0, 0, 0
    .long 6, 0, 0, 0, 2, 0, 0, 58, 0, 0, 0, 0, 0, 0, 0, 0
    .long 6, 0, 0, 0, 2, 0, 0, 59, 0, 0, 0, 0, 0, 0, 0, 0
    .long 6, 0, 0, 0, 2, 0, 0, 60, 0, 0, 0, 0, 0, 0, 0, 0
    .long 7, 0, 0, 0, 8, 0, 0, 61, 0, 0, 0, 0, 0, 0, 0, 0
    .long 7, 0, 0, 0, 9, 0, 0, 61, 0, 0, 0, 0, 0, 0, 0, 0
    .long 7, 0, 0, 0, 10, 0, 0, 61, 0, 0, 0, 0, 0, 0, 0, 0
    .long 7, 0, 0, 0, 11, 0, 0, 61, 0, 0, 0, 0, 0, 0, 0, 0
    .long 7, 0, 0, 0, 8, 0, 0, 62, 0, 0, 0, 0, 0, 0, 0, 0
    .long 7, 0, 0, 0, 9, 0, 0, 62, 0, 0, 0, 0, 0, 0, 0, 0
    .long 7, 0, 0, 0, 10, 0, 0, 62, 0, 0, 0, 0, 0, 0, 0, 0
    .long 7, 0, 0, 0, 11, 0, 0, 62, 0, 0, 0, 0, 0, 0, 0, 0
    .long 7, 0, 0, 0, 8, 0, 0, 63, 0, 0, 0, 0, 0, 0, 0, 0
    .long 7, 0, 0, 0, 9, 0, 0, 63, 0, 0, 0, 0, 0, 0, 0, 0
    .long 7, 0, 0, 0, 10, 0, 0, 63, 0, 0, 0, 0, 0, 0, 0, 0
    .long 7, 0, 0, 0, 11, 0, 0, 63, 0, 0, 0, 0, 0, 0, 0, 0
    .long 0, 0, 0, 0, 0, 0, 0, 0, 0, 0, 0, 0, 0, 0, 0, 0
    .long 4, 24, 24, 8192, 6144, 268288, 8388608, 0, 32768, 4, 21069824, 131072, 0, 0, 218104417, 0
    .long 4, 24, 24, 8192, 6400, 268544, 8388608, 0, 32768, 4, 21073920, 131072, 0, 0, 218104417, 0
    .long 4, 24, 24, 8192, 6656, 268800, 8388608, 0, 32768, 4, 21078016, 131072, 0, 0, 218104417, 0
    .long 4, 24, 24, 8192, 6912, 269056, 8388608, 0, 32768, 4, 21082112, 131072, 0, 0, 218104417, 0
    .long 4, 24, 24, 8192, 7168, 269312, 8388608, 0, 32768, 4, 21086208, 131072, 0, 0, 218104433, 0
    .long 4, 24, 24, 8192, 7424, 269568, 8388608, 0, 32768, 4, 21090304, 131072, 0, 0, 218104433, 0
    .long 4, 24, 24, 8192, 7680, 269824, 8388608, 0, 32768, 4, 21094400, 131072, 0, 0, 218104433, 0
    .long 4, 24, 24, 8192, 7936, 270080, 8388608, 0, 32768, 4, 21098496, 131072, 0, 0, 218104433, 0
    .long 4, 32, 32, 8192, 6144, 268288, 8388608, 0, 32768, 4, 37847040, 131072, 0, 0, 218104417, 0
    .long 4, 32, 32, 8192, 6400, 268544, 8388608, 0, 32768, 4, 37851136, 131072, 0, 0, 218104417, 0
    .long 4, 32, 32, 8192, 6656, 268800, 8388608, 0, 32768, 4, 37855232, 131072, 0, 0, 218104417, 0
    .long 4, 32, 32, 8192, 6912, 269056, 8388608, 0, 32768, 4, 37859328, 131072, 0, 0, 218104417, 0
    .long 4, 32, 32, 8192, 7168, 269312, 8388608, 0, 32768, 4, 37863424, 131072, 0, 0, 218104433, 0
    .long 4, 32, 32, 8192, 7424, 269568, 8388608, 0, 32768, 4, 37867520, 131072, 0, 0, 218104433, 0
    .long 4, 32, 32, 8192, 7680, 269824, 8388608, 0, 32768, 4, 37871616, 131072, 0, 0, 218104433, 0
    .long 4, 32, 32, 8192, 7936, 270080, 8388608, 0, 32768, 4, 37875712, 131072, 0, 0, 218104433, 0
    .long 4, 24, 24, 8192, 6144, 268288, 8388608, 262144, 32768, 4, 22118400, 131072, 0, 0, 218104420, 0
    .long 4, 24, 24, 8192, 6400, 268544, 8388608, 262144, 32768, 4, 22122496, 131072, 0, 0, 218104420, 0
    .long 4, 24, 24, 8192, 6656, 268800, 8388608, 262144, 32768, 4, 22126592, 131072, 0, 0, 218104420, 0
    .long 4, 24, 24, 8192, 6912, 269056, 8388608, 262144, 32768, 4, 22130688, 131072, 0, 0, 218104420, 0
    .long 4, 24, 24, 8192, 7168, 269312, 8388608, 262144, 32768, 4, 22134784, 131072, 0, 0, 218104436, 0
    .long 4, 24, 24, 8192, 7424, 269568, 8388608, 262144, 32768, 4, 22138880, 131072, 0, 0, 218104436, 0
    .long 4, 24, 24, 8192, 7680, 269824, 8388608, 262144, 32768, 4, 22142976, 131072, 0, 0, 218104436, 0
    .long 4, 24, 24, 8192, 7936, 270080, 8388608, 262144, 32768, 4, 22147072, 131072, 0, 0, 218104436, 0
    .long 4, 32, 32, 8192, 6144, 268288, 8388608, 262144, 32768, 4, 38895616, 131072, 0, 0, 218104420, 0
    .long 4, 32, 32, 8192, 6400, 268544, 8388608, 262144, 32768, 4, 38899712, 131072, 0, 0, 218104420, 0
    .long 4, 32, 32, 8192, 6656, 268800, 8388608, 262144, 32768, 4, 38903808, 131072, 0, 0, 218104420, 0
    .long 4, 32, 32, 8192, 6912, 269056, 8388608, 262144, 32768, 4, 38907904, 131072, 0, 0, 218104420, 0
    .long 4, 32, 32, 8192, 7168, 269312, 8388608, 262144, 32768, 4, 38912000, 131072, 0, 0, 218104436, 0
    .long 4, 32, 32, 8192, 7424, 269568, 8388608, 262144, 32768, 4, 38916096, 131072, 0, 0, 218104436, 0
    .long 4, 32, 32, 8192, 7680, 269824, 8388608, 262144, 32768, 4, 38920192, 131072, 0, 0, 218104436, 0
    .long 4, 32, 32, 8192, 7936, 270080, 8388608, 262144, 32768, 4, 38924288, 131072, 0, 0, 218104436, 0
    .long 4, 32, 32, 8192, 6656, 268800, 8388608, 786432, 32768, 4, 41000960, 131072, 0, 0, 218104676, 0
    .long 4, 32, 32, 8192, 7680, 269824, 8388608, 786432, 32768, 4, 41017344, 131072, 0, 0, 218104692, 0
    .long 4, 32, 32, 8192, 7936, 270080, 8388608, 524288, 32768, 4, 39972864, 131072, 0, 0, 218104689, 0
    .long 4, 24, 24, 8192, 6656, 268800, 8388608, 786432, 32768, 4, 24223744, 131072, 0, 0, 218104676, 0
    .long 4, 32, 32, 8192, 6656, 268800, 8388608, 524288, 32768, 4, 39952384, 131072, 0, 0, 218104673, 0
    .long 4, 32, 32, 8192, 7936, 270080, 8388608, 786432, 32768, 4, 41021440, 131072, 0, 0, 218104692, 0
    .long 4, 24, 24, 8192, 7680, 269824, 8388608, 786432, 32768, 4, 24240128, 131072, 0, 0, 218104692, 0
    .long 4, 24, 24, 8192, 6400, 268544, 8388608, 524288, 32768, 4, 23171072, 131072, 0, 0, 218104673, 0
    .long 4, 24, 24, 8192, 6912, 269056, 8388608, 524288, 32768, 4, 23179264, 131072, 0, 0, 218104673, 0
    .long 4, 24, 24, 8192, 7424, 269568, 8388608, 524288, 32768, 4, 23187456, 131072, 0, 0, 218104689, 0
    .long 4, 24, 24, 8192, 6912, 269056, 8388608, 786432, 32768, 4, 24227840, 131072, 0, 0, 218104676, 0
    .long 4, 32, 32, 8192, 6400, 268544, 8388608, 524288, 32768, 4, 39948288, 131072, 0, 0, 218104673, 0
    .long 4, 32, 32, 8192, 7168, 269312, 8388608, 524288, 32768, 4, 39960576, 131072, 0, 0, 218104689, 0
    .long 4, 24, 24, 8192, 7680, 269824, 8388608, 524288, 32768, 4, 23191552, 131072, 0, 0, 218104689, 0
    .long 4, 32, 32, 8192, 6912, 269056, 8388608, 524288, 32768, 4, 39956480, 131072, 0, 0, 218104673, 0
    .long 4, 24, 24, 8192, 6144, 268288, 8388608, 524288, 32768, 4, 23166976, 131072, 0, 0, 218104673, 0
    .long 4, 32, 32, 8192, 7168, 269312, 8388608, 786432, 32768, 4, 41009152, 131072, 0, 0, 218104692, 0
    .long 4, 24, 24, 8192, 7936, 270080, 8388608, 786432, 32768, 4, 24244224, 131072, 0, 0, 218104692, 0
    .long 4, 32, 32, 8192, 6144, 268288, 8388608, 524288, 32768, 4, 39944192, 131072, 0, 0, 218104673, 0
    .long 4, 24, 24, 8192, 7424, 269568, 8388608, 786432, 32768, 4, 24236032, 131072, 0, 0, 218104692, 0
    .long 4, 32, 32, 8192, 6400, 268544, 8388608, 786432, 32768, 4, 40996864, 131072, 0, 0, 218104676, 0
    .long 4, 24, 24, 8192, 7168, 269312, 8388608, 786432, 32768, 4, 24231936, 131072, 0, 0, 218104692, 0
    .long 4, 24, 24, 8192, 6656, 268800, 8388608, 524288, 32768, 4, 23175168, 131072, 0, 0, 218104673, 0
    .long 4, 24, 24, 8192, 6400, 268544, 8388608, 786432, 32768, 4, 24219648, 131072, 0, 0, 218104676, 0
    .long 4, 32, 32, 8192, 7424, 269568, 8388608, 786432, 32768, 4, 41013248, 131072, 0, 0, 218104692, 0
    .long 4, 24, 24, 8192, 6144, 268288, 8388608, 786432, 32768, 4, 24215552, 131072, 0, 0, 218104676, 0
    .long 4, 32, 32, 8192, 7680, 269824, 8388608, 524288, 32768, 4, 39968768, 131072, 0, 0, 218104689, 0
    .long 4, 32, 32, 8192, 6912, 269056, 8388608, 786432, 32768, 4, 41005056, 131072, 0, 0, 218104676, 0
    .long 4, 32, 32, 8192, 7424, 269568, 8388608, 524288, 32768, 4, 39964672, 131072, 0, 0, 218104689, 0
    .long 4, 24, 24, 8192, 7168, 269312, 8388608, 524288, 32768, 4, 23183360, 131072, 0, 0, 218104689, 0
    .long 4, 24, 24, 8192, 7936, 270080, 8388608, 524288, 32768, 4, 23195648, 131072, 0, 0, 218104689, 0
    .long 4, 32, 32, 8192, 6144, 268288, 8388608, 786432, 32768, 4, 40992768, 131072, 0, 0, 218104676, 0
    .long 1, 16, 16, 8192, 6144, 6400, 8388608, 1572864, 32768, 8, 10584064, 131072, 0, 0, 218105194, 0
    .long 1, 32, 32, 8192, 6656, 6912, 8388608, 1048576, 32768, 8, 42049536, 131072, 0, 0, 218104938, 0
    .long 1, 32, 32, 8192, 6656, 6912, 8388608, 1572864, 32768, 8, 44146688, 131072, 0, 0, 218105194, 0
    .long 1, 24, 24, 8192, 6656, 6912, 8388608, 1048576, 32768, 8, 25272320, 131072, 0, 0, 218104938, 0
    .long 1, 16, 16, 8192, 7168, 7424, 8388608, 1048576, 32768, 8, 8503296, 131072, 0, 0, 218104954, 0
    .long 1, 16, 16, 8192, 7680, 7936, 8388608, 1048576, 32768, 8, 8511488, 131072, 0, 0, 218104954, 0
    .long 1, 32, 32, 8192, 7680, 7936, 8388608, 1048576, 32768, 8, 42065920, 131072, 0, 0, 218104954, 0
    .long 1, 24, 24, 8192, 7168, 7424, 8388608, 1048576, 32768, 8, 25280512, 131072, 0, 0, 218104954, 0
    .long 1, 24, 24, 8192, 7680, 7936, 8388608, 2097152, 32768, 8, 29483008, 131072, 0, 0, 218105466, 0
    .long 1, 24, 24, 8192, 7680, 7936, 8388608, 1048576, 32768, 8, 25288704, 131072, 0, 0, 218104954, 0
    .long 1, 32, 32, 8192, 7168, 7424, 8388608, 1048576, 32768, 8, 42057728, 131072, 0, 0, 218104954, 0
    .long 1, 24, 24, 8192, 7168, 7424, 8388608, 2097152, 32768, 8, 29474816, 131072, 0, 0, 218105466, 0
    .long 1, 24, 24, 8192, 6144, 6400, 8388608, 1572864, 32768, 8, 27361280, 131072, 0, 0, 218105194, 0
    .long 1, 32, 32, 8192, 6144, 6400, 8388608, 1572864, 32768, 8, 44138496, 131072, 0, 0, 218105194, 0
    .long 1, 24, 24, 8192, 7168, 7424, 8388608, 1572864, 32768, 8, 27377664, 131072, 0, 0, 218105210, 0
    .long 1, 16, 16, 8192, 6144, 6400, 8388608, 1048576, 32768, 8, 8486912, 131072, 0, 0, 218104938, 0
    .long 1, 24, 24, 8192, 6656, 6912, 8388608, 1572864, 32768, 8, 27369472, 131072, 0, 0, 218105194, 0
    .long 1, 16, 16, 8192, 6656, 6912, 8388608, 1572864, 32768, 8, 10592256, 131072, 0, 0, 218105194, 0
    .long 1, 32, 32, 8192, 7168, 7424, 8388608, 1572864, 32768, 8, 44154880, 131072, 0, 0, 218105210, 0
    .long 1, 16, 16, 8192, 7168, 7424, 8388608, 1572864, 32768, 8, 10600448, 131072, 0, 0, 218105210, 0
    .long 1, 32, 32, 8192, 7680, 7936, 8388608, 2097152, 32768, 8, 46260224, 131072, 0, 0, 218105466, 0
    .long 1, 24, 24, 8192, 6144, 6400, 8388608, 1048576, 32768, 8, 25264128, 131072, 0, 0, 218104938, 0
    .long 1, 24, 24, 8192, 6144, 6400, 8388608, 2097152, 32768, 8, 29458432, 131072, 0, 0, 218105450, 0
    .long 1, 16, 16, 8192, 7680, 7936, 8388608, 1572864, 32768, 8, 10608640, 131072, 0, 0, 218105210, 0
    .long 2, 64, 72, 7168, 6144, 6144, 7340032, 1572864, 32768, 8, 60129280, 114688, 0, 0, 218104017, 0
    .long 1, 32, 32, 8192, 6144, 6400, 8388608, 2097152, 32768, 8, 46235648, 131072, 0, 0, 218105450, 0
    .long 1, 32, 32, 8192, 6144, 6400, 8388608, 1048576, 32768, 8, 42041344, 131072, 0, 0, 218104938, 0
    .long 1, 32, 32, 8192, 6656, 6912, 8388608, 2097152, 32768, 8, 46243840, 131072, 0, 0, 218105450, 0
    .long 1, 24, 24, 8192, 7680, 7936, 8388608, 1572864, 32768, 8, 27385856, 131072, 0, 0, 218105210, 0
    .long 1, 32, 32, 8192, 7680, 7936, 8388608, 1572864, 32768, 8, 44163072, 131072, 0, 0, 218105210, 0
    .long 1, 16, 16, 8192, 6656, 6912, 8388608, 1048576, 32768, 8, 8495104, 131072, 0, 0, 218104938, 0
    .long 1, 32, 32, 8192, 7168, 7424, 8388608, 2097152, 32768, 8, 46252032, 131072, 0, 0, 218105466, 0
    .long 1, 16, 16, 8192, 6656, 6912, 8388608, 0, 32768, 8, 4300800, 131072, 0, 0, 218108010, 0
    .long 2, 64, 72, 7168, 6144, 6144, 7340032, 2097152, 32768, 8, 61964288, 114688, 0, 0, 218104081, 0
    .long 1, 16, 16, 8192, 7680, 7936, 8388608, 2097152, 32768, 8, 12705792, 131072, 0, 0, 218105466, 0
    .long 1, 16, 16, 8192, 6656, 6912, 8388608, 524288, 32768, 8, 6397952, 131072, 0, 0, 218108266, 0
    .long 1, 16, 16, 8192, 7680, 7936, 8388608, 3145728, 32768, 8, 16900096, 131072, 0, 0, 218105978, 0
    .long 1, 32, 32, 8192, 7680, 7936, 8388608, 2621440, 32768, 8, 48357376, 131072, 0, 0, 218105722, 0
    .long 1, 16, 16, 8192, 7168, 7424, 8388608, 0, 32768, 8, 4308992, 131072, 0, 0, 218108026, 0
    .long 1, 16, 16, 8192, 6144, 6400, 8388608, 2097152, 32768, 8, 12681216, 131072, 0, 0, 218105450, 0
    .long 1, 16, 16, 8192, 7680, 7936, 8388608, 0, 32768, 8, 4317184, 131072, 0, 0, 218108026, 0
    .long 1, 16, 16, 8192, 6144, 6400, 8388608, 524288, 32768, 8, 6389760, 131072, 0, 0, 218108266, 0
    .long 1, 24, 24, 8192, 7168, 7424, 8388608, 3145728, 32768, 8, 33669120, 131072, 0, 0, 218105978, 0
    .long 1, 24, 24, 8192, 6656, 6912, 8388608, 2621440, 32768, 8, 31563776, 131072, 0, 0, 218105706, 0
    .long 1, 16, 16, 8192, 6656, 6912, 8388608, 2621440, 32768, 8, 14786560, 131072, 0, 0, 218105706, 0
    .long 1, 16, 16, 8192, 7168, 7424, 8388608, 524288, 32768, 8, 6406144, 131072, 0, 0, 218108282, 0
    .long 2, 64, 72, 7168, 6656, 6656, 7340032, 0, 32768, 8, 54632448, 114688, 0, 0, 218103825, 0
    .long 2, 64, 72, 7168, 6144, 6144, 7340032, 0, 32768, 8, 54624256, 114688, 0, 0, 218103825, 0
    .long 2, 64, 72, 7168, 6656, 6656, 7340032, 1048576, 32768, 8, 58302464, 114688, 0, 0, 218103953, 0
    .long 1, 16, 16, 8192, 6144, 6400, 8388608, 0, 32768, 8, 4292608, 131072, 0, 0, 218108010, 0
    .long 1, 16, 16, 8192, 7680, 7936, 8388608, 524288, 32768, 8, 6414336, 131072, 0, 0, 218108282, 0
    .long 1, 24, 24, 8192, 7168, 7424, 8388608, 2621440, 32768, 8, 31571968, 131072, 0, 0, 218105722, 0
    .long 1, 16, 16, 8192, 7680, 7936, 8388608, 2621440, 32768, 8, 14802944, 131072, 0, 0, 218105722, 0
    .long 1, 24, 24, 8192, 6656, 6912, 8388608, 2097152, 32768, 8, 29466624, 131072, 0, 0, 218105450, 0
    .long 2, 64, 72, 7168, 6656, 6656, 7340032, 2097152, 32768, 8, 61972480, 114688, 0, 0, 218104081, 0
    .long 1, 16, 16, 8192, 6656, 6912, 8388608, 3145728, 32768, 8, 16883712, 131072, 0, 0, 218105962, 0
    .long 1, 16, 16, 8192, 6656, 6912, 8388608, 2097152, 32768, 8, 12689408, 131072, 0, 0, 218105450, 0
    .long 2, 64, 72, 7168, 6144, 6144, 7340032, 3670016, 32768, 8, 67469312, 114688, 0, 0, 218104276, 0
    .long 1, 24, 24, 8192, 6656, 6912, 8388608, 3145728, 32768, 8, 33660928, 131072, 0, 0, 218105962, 0
    .long 2, 64, 72, 7168, 5888, 5888, 7340032, 2097152, 32768, 8, 61960192, 114688, 0, 0, 218104081, 0
    .long 1, 16, 16, 8192, 7168, 7424, 8388608, 2097152, 32768, 8, 12697600, 131072, 0, 0, 218105466, 0
    .long 2, 64, 72, 7168, 6656, 6656, 7340032, 2621440, 32768, 8, 63807488, 114688, 0, 0, 218104148, 0
    .long 1, 32, 32, 8192, 7680, 7936, 8388608, 3145728, 32768, 8, 50454528, 131072, 0, 0, 218105978, 0
    .long 1, 24, 24, 8192, 6144, 6400, 8388608, 2621440, 32768, 8, 31555584, 131072, 0, 0, 218105706, 0
    .long 2, 64, 72, 7168, 5376, 5376, 7340032, 1048576, 32768, 8, 58281984, 114688, 0, 0, 218103953, 0
    .long 1, 32, 32, 8192, 7168, 7424, 8388608, 3145728, 32768, 8, 50446336, 131072, 0, 0, 218105978, 0
    .long 2, 64, 72, 7168, 6144, 6144, 7340032, 3145728, 32768, 8, 65634304, 114688, 0, 0, 218104212, 0
    .long 1, 16, 16, 8192, 6144, 6400, 8388608, 3145728, 32768, 8, 16875520, 131072, 0, 0, 218105962, 0
    .long 2, 64, 72, 7168, 6912, 6912, 7340032, 1048576, 32768, 8, 58306560, 114688, 0, 0, 218103953, 0
    .long 2, 64, 72, 7168, 5376, 5376, 7340032, 3145728, 32768, 8, 65622016, 114688, 0, 0, 218104212, 0
    .long 2, 64, 72, 7168, 6144, 6144, 7340032, 2621440, 32768, 8, 63799296, 114688, 0, 0, 218104148, 0
    .long 2, 64, 72, 7168, 5632, 5632, 7340032, 1048576, 32768, 8, 58286080, 114688, 0, 0, 218103953, 0
    .long 2, 64, 72, 7168, 6400, 6400, 7340032, 3145728, 32768, 8, 65638400, 114688, 0, 0, 218104212, 0
    .long 1, 16, 16, 8192, 7168, 7424, 8388608, 2621440, 32768, 8, 14794752, 131072, 0, 0, 218105722, 0
    .long 1, 32, 32, 8192, 6144, 6400, 8388608, 2621440, 32768, 8, 48332800, 131072, 0, 0, 218105706, 0
    .long 1, 16, 16, 8192, 6144, 6400, 8388608, 2621440, 32768, 8, 14778368, 131072, 0, 0, 218105706, 0
    .long 5, 218108256, 0, 0, 24, 0, 0, 8, 0, 0, 0, 0, 218112384, 11, 218106961, 0
    .long 2, 64, 72, 7168, 5632, 5632, 7340032, 524288, 32768, 8, 56451072, 114688, 0, 0, 218103889, 0
    .long 2, 64, 72, 7168, 6400, 6400, 7340032, 0, 32768, 8, 54628352, 114688, 0, 0, 218103825, 0
    .long 1, 24, 24, 8192, 6144, 6400, 8388608, 3145728, 32768, 8, 33652736, 131072, 0, 0, 218105962, 0
    .long 2, 64, 72, 7168, 6912, 6912, 7340032, 0, 32768, 8, 54636544, 114688, 0, 0, 218103825, 0
    .long 5, 218108000, 0, 0, 24, 0, 0, 0, 0, 0, 0, 0, 218112384, 3, 218106897, 0
    .long 1, 32, 32, 8192, 6656, 6912, 8388608, 3145728, 32768, 8, 50438144, 131072, 0, 0, 218105962, 0
    .long 5, 218108272, 0, 0, 28, 0, 0, 8, 0, 0, 0, 0, 218112384, 11, 218106961, 0
    .long 1, 24, 24, 8192, 7680, 7936, 8388608, 2621440, 32768, 8, 31580160, 131072, 0, 0, 218105722, 0
    .long 1, 32, 32, 8192, 7168, 7424, 8388608, 2621440, 32768, 8, 48349184, 131072, 0, 0, 218105722, 0
    .long 2, 64, 72, 7168, 6144, 6144, 7340032, 1048576, 32768, 8, 58294272, 114688, 0, 0, 218103953, 0
    .long 2, 64, 72, 7168, 6144, 6144, 7340032, 524288, 32768, 8, 56459264, 114688, 0, 0, 218103889, 0
    .long 2, 64, 72, 7168, 5888, 5888, 7340032, 524288, 32768, 8, 56455168, 114688, 0, 0, 218103889, 0
    .long 2, 64, 72, 7168, 6400, 6400, 7340032, 1048576, 32768, 8, 58298368, 114688, 0, 0, 218103953, 0
    .long 1, 32, 32, 8192, 6656, 6912, 8388608, 2621440, 32768, 8, 48340992, 131072, 0, 0, 218105706, 0
    .long 2, 64, 72, 7168, 5888, 5888, 7340032, 1048576, 32768, 8, 58290176, 114688, 0, 0, 218103953, 0
    .long 1, 16, 16, 8192, 7168, 7424, 8388608, 3670016, 32768, 8, 18989056, 131072, 0, 0, 218106234, 0
    .long 2, 64, 72, 7168, 6400, 6400, 7340032, 524288, 32768, 8, 56463360, 114688, 0, 0, 218103889, 0
    .long 1, 16, 16, 8192, 7168, 7424, 8388608, 3145728, 32768, 8, 16891904, 131072, 0, 0, 218105978, 0
    .long 5, 218108016, 0, 0, 28, 0, 0, 0, 0, 0, 0, 0, 218112384, 3, 218106897, 0
    .long 5, 218108016, 0, 0, 28, 0, 0, 4, 0, 0, 0, 0, 218112384, 7, 218106897, 0
    .long 5, 218108272, 0, 0, 28, 0, 0, 12, 0, 0, 0, 0, 218112384, 15, 218106961, 0
    .long 5, 218108256, 0, 0, 24, 0, 0, 12, 0, 0, 0, 0, 218112384, 15, 218106961, 0
    .long 5, 218108000, 0, 0, 24, 0, 0, 4, 0, 0, 0, 0, 218112384, 7, 218106897, 0
    .long 1, 32, 32, 8192, 6144, 6400, 8388608, 3145728, 32768, 8, 50429952, 131072, 0, 0, 218105962, 0
    .long 2, 64, 72, 7168, 5888, 5888, 7340032, 1572864, 32768, 8, 60125184, 114688, 0, 0, 218104017, 0
    .long 2, 64, 72, 7168, 5376, 5376, 7340032, 1572864, 32768, 8, 60116992, 114688, 0, 0, 218104017, 0
    .long 2, 64, 72, 7168, 5632, 5632, 7340032, 0, 32768, 8, 54616064, 114688, 0, 0, 218103825, 0
    .long 1, 24, 24, 8192, 7680, 7936, 8388608, 3145728, 32768, 8, 33677312, 131072, 0, 0, 218105978, 0
    .long 2, 64, 72, 7168, 6912, 6912, 7340032, 3145728, 32768, 8, 65646592, 114688, 0, 0, 218104212, 0
    .long 2, 64, 72, 7168, 5376, 5376, 7340032, 2621440, 32768, 8, 63787008, 114688, 0, 0, 218104148, 0
    .long 2, 64, 72, 7168, 5888, 5888, 7340032, 0, 32768, 8, 54620160, 114688, 0, 0, 218103825, 0
    .long 2, 64, 72, 7168, 6400, 6400, 7340032, 2097152, 32768, 8, 61968384, 114688, 0, 0, 218104081, 0
    .long 2, 64, 72, 7168, 6912, 6912, 7340032, 524288, 32768, 8, 56471552, 114688, 0, 0, 218103889, 0
    .long 2, 64, 72, 7168, 5632, 5632, 7340032, 2097152, 32768, 8, 61956096, 114688, 0, 0, 218104081, 0
    .long 2, 64, 72, 7168, 6912, 6912, 7340032, 1572864, 32768, 8, 60141568, 114688, 0, 0, 218104017, 0
    .long 2, 64, 72, 7168, 5376, 5376, 7340032, 0, 32768, 8, 54611968, 114688, 0, 0, 218103825, 0
    .long 2, 64, 72, 7168, 6400, 6400, 7340032, 3670016, 32768, 8, 67473408, 114688, 0, 0, 218104276, 0
    .long 2, 64, 72, 7168, 5376, 5376, 7340032, 524288, 32768, 8, 56446976, 114688, 0, 0, 218103889, 0
    .long 2, 64, 72, 7168, 6656, 6656, 7340032, 524288, 32768, 8, 56467456, 114688, 0, 0, 218103889, 0
    .long 2, 64, 72, 7168, 6912, 6912, 7340032, 2097152, 32768, 8, 61976576, 114688, 0, 0, 218104081, 0
    .long 1, 24, 24, 8192, 7680, 7936, 8388608, 3670016, 32768, 8, 35774464, 131072, 0, 0, 218106234, 0
    .long 2, 64, 72, 7168, 5888, 5888, 7340032, 2621440, 32768, 8, 63795200, 114688, 0, 0, 218104148, 0
    .long 2, 64, 72, 7168, 6400, 6400, 7340032, 1572864, 32768, 8, 60133376, 114688, 0, 0, 218104017, 0
    .long 2, 64, 72, 7168, 5376, 5376, 7340032, 2097152, 32768, 8, 61952000, 114688, 0, 0, 218104081, 0
    .long 2, 64, 72, 7168, 6656, 6656, 7340032, 3145728, 32768, 8, 65642496, 114688, 0, 0, 218104212, 0
    .long 2, 64, 72, 7168, 5632, 5632, 7340032, 1572864, 32768, 8, 60121088, 114688, 0, 0, 218104017, 0
    .long 2, 64, 72, 7168, 5632, 5632, 7340032, 2621440, 32768, 8, 63791104, 114688, 0, 0, 218104148, 0
    .long 1, 24, 24, 8192, 6144, 6400, 8388608, 3670016, 32768, 8, 35749888, 131072, 0, 0, 218106218, 0
    .long 2, 64, 72, 7168, 6912, 6912, 7340032, 2621440, 32768, 8, 63811584, 114688, 0, 0, 218104148, 0
    .long 2, 64, 72, 7168, 6400, 6400, 7340032, 2621440, 32768, 8, 63803392, 114688, 0, 0, 218104148, 0
    .long 2, 64, 72, 7168, 6656, 6656, 7340032, 3670016, 32768, 8, 67477504, 114688, 0, 0, 218104276, 0
    .long 2, 64, 72, 7168, 6656, 6656, 7340032, 1572864, 32768, 8, 60137472, 114688, 0, 0, 218104017, 0
    .long 1, 40, 40, 2048, 4195840, 4196096, 8388608, 180420608, 131072, 16, 80764928, 32768, 218112384, 25, 218106504, 0
    .long 1, 80, 80, 2048, 3671040, 3671296, 7340032, 58253312, 114688, 14, 122699776, 32768, 218103952, 14, 218106498, 0
    .long 1, 24, 24, 8192, 7168, 7424, 8388608, 3670016, 32768, 8, 35766272, 131072, 0, 0, 218106234, 0
    .long 1, 40, 40, 2048, 4195328, 4195584, 8388608, 180420608, 131072, 16, 80756736, 32768, 218112384, 25, 218106504, 0
    .long 1, 40, 40, 2048, 4195328, 4195584, 8388608, 178323456, 131072, 16, 80232448, 32768, 218106960, 8, 218106440, 0
    .long 2, 64, 72, 7168, 5888, 5888, 7340032, 3145728, 32768, 8, 65630208, 114688, 0, 0, 218104212, 0
    .long 1, 40, 40, 2048, 4195840, 4196096, 8388608, 178323456, 131072, 16, 80240640, 32768, 218106960, 8, 218106440, 0
    .long 1, 80, 80, 2048, 3671552, 3671808, 7340032, 58253312, 114688, 14, 122707968, 32768, 218103952, 14, 218106498, 0
    .long 2, 64, 72, 7168, 5632, 5632, 7340032, 3145728, 32768, 8, 65626112, 114688, 0, 0, 218104212, 0
    .long 1, 32, 32, 8192, 6656, 6912, 8388608, 3670016, 32768, 8, 52535296, 131072, 0, 0, 218106218, 0
    .long 1, 16, 16, 8192, 6656, 6912, 8388608, 3670016, 32768, 8, 18980864, 131072, 0, 0, 218106218, 0
    .long 1, 40, 40, 2048, 4195840, 4196096, 8388608, 176226304, 131072, 16, 79716352, 32768, 218106896, 8, 218106376, 0
    .long 1, 40, 40, 2048, 4195328, 4195584, 8388608, 176226304, 131072, 16, 79708160, 32768, 218106896, 8, 218106376, 0
    .long 1, 32, 32, 8192, 6144, 6400, 8388608, 3670016, 32768, 8, 52527104, 131072, 0, 0, 218106218, 0
    .long 1, 24, 24, 8192, 6656, 6912, 8388608, 3670016, 32768, 8, 35758080, 131072, 0, 0, 218106218, 0
    .long 1, 16, 16, 8192, 6144, 6400, 8388608, 3670016, 32768, 8, 18972672, 131072, 0, 0, 218106218, 0
    .long 1, 32, 32, 8192, 7168, 7424, 8388608, 3670016, 32768, 8, 52543488, 131072, 0, 0, 218106234, 0
    .long 1, 32, 32, 8192, 7680, 7936, 8388608, 3670016, 32768, 8, 52551680, 131072, 0, 0, 218106234, 0
    .long 2, 64, 72, 7168, 5888, 5888, 7340032, 3670016, 32768, 8, 67465216, 114688, 0, 0, 218104276, 0
    .long 2, 64, 72, 7168, 5376, 5376, 7340032, 3670016, 32768, 8, 67457024, 114688, 0, 0, 218104276, 0
    .long 1, 16, 16, 8192, 7680, 7936, 8388608, 3670016, 32768, 8, 18997248, 131072, 0, 0, 218106234, 0
    .long 2, 64, 72, 7168, 6912, 6912, 7340032, 3670016, 32768, 8, 67481600, 114688, 0, 0, 218104276, 0
    .long 1, 80, 80, 2048, 3671552, 3671808, 7340032, 56418304, 114688, 14, 122183680, 32768, 218103888, 14, 218106434, 0
    .long 1, 80, 80, 2048, 3671040, 3671296, 7340032, 54583296, 114688, 14, 121651200, 32768, 218103824, 14, 218106370, 0
    .long 1, 80, 80, 2048, 3671040, 3671296, 7340032, 61923328, 114688, 14, 123748352, 32768, 218104080, 14, 218106626, 0
    .long 1, 80, 80, 2048, 3671040, 3671296, 7340032, 56418304, 114688, 14, 122175488, 32768, 218103888, 14, 218106434, 0
    .long 2, 64, 72, 7168, 5632, 5632, 7340032, 3670016, 32768, 8, 67461120, 114688, 0, 0, 218104276, 0
    .long 1, 40, 40, 2048, 4195328, 4195584, 8388608, 182517760, 131072, 16, 81281024, 32768, 218112384, 33, 218106568, 0
    .long 1, 40, 40, 2048, 4195840, 4196096, 8388608, 182517760, 131072, 16, 81289216, 32768, 218112384, 33, 218106568, 0
    .long 1, 80, 80, 2048, 3671552, 3671808, 7340032, 61923328, 114688, 14, 123756544, 32768, 218104080, 14, 218106626, 0
    .long 1, 80, 80, 2048, 3671552, 3671808, 7340032, 54583296, 114688, 14, 121659392, 32768, 218103824, 14, 218106370, 0
    .long 1, 80, 80, 2048, 3671552, 3671808, 7340032, 60088320, 114688, 14, 123232256, 32768, 218104016, 14, 218106562, 0
    .long 1, 80, 80, 2048, 3671040, 3671296, 7340032, 60088320, 114688, 14, 123224064, 32768, 218104016, 14, 218106562, 0
    .long 1, 40, 40, 2048, 6291968, 6292224, 8388608, 184647680, 131072, 8, 90185728, 32768, 218112384, 40, 218106628, 0
    .long 1, 40, 40, 2048, 6291456, 6291712, 8388608, 184647680, 131072, 8, 90177536, 32768, 218112384, 40, 218106628, 0
    .long 1, 40, 40, 2048, 6292992, 6293248, 8388608, 184647680, 131072, 8, 90202112, 32768, 218112384, 40, 218106628, 0
    .long 1, 40, 40, 2048, 6292480, 6292736, 8388608, 184647680, 131072, 8, 90193920, 32768, 218112384, 40, 218106628, 0
    .long 1, 80, 80, 2048, 5506560, 5506816, 7340032, 63787008, 114688, 7, 132669440, 32768, 218104148, 7, 218106689, 0
    .long 1, 80, 80, 2048, 5506048, 5506304, 7340032, 63787008, 114688, 7, 132661248, 32768, 218104148, 7, 218106689, 0
    .long 1, 80, 80, 2048, 5505024, 5505280, 7340032, 63787008, 114688, 7, 132644864, 32768, 218104148, 7, 218106689, 0
    .long 1, 80, 80, 2048, 5505536, 5505792, 7340032, 63787008, 114688, 7, 132653056, 32768, 218104148, 7, 218106689, 0
    .long 1, 80, 80, 2048, 5505536, 5505792, 7340032, 65622016, 114688, 7, 133177344, 32768, 218104212, 7, 218106753, 0
    .long 1, 80, 80, 2048, 5505024, 5505280, 7340032, 65622016, 114688, 7, 133169152, 32768, 218104212, 7, 218106753, 0
    .long 1, 80, 80, 2048, 5506560, 5506816, 7340032, 65622016, 114688, 7, 133193728, 32768, 218104212, 7, 218106753, 0
    .long 1, 40, 40, 2048, 6291968, 6292224, 8388608, 186744832, 131072, 8, 90710016, 32768, 218112384, 48, 218106692, 0
    .long 1, 80, 80, 2048, 5506048, 5506304, 7340032, 65622016, 114688, 7, 133185536, 32768, 218104212, 7, 218106753, 0
    .long 1, 40, 40, 2048, 6292480, 6292736, 8388608, 186744832, 131072, 8, 90718208, 32768, 218112384, 48, 218106692, 0
    .long 1, 40, 40, 2048, 6292992, 6293248, 8388608, 186744832, 131072, 8, 90726400, 32768, 218112384, 48, 218106692, 0
    .long 1, 40, 40, 2048, 6291456, 6291712, 8388608, 186744832, 131072, 8, 90701824, 32768, 218112384, 48, 218106692, 0
    .long 1, 80, 80, 2048, 5506560, 5506816, 7340032, 67457024, 114688, 7, 133718016, 32768, 218104276, 7, 218106817, 0
    .long 1, 80, 80, 2048, 5505536, 5505792, 7340032, 67457024, 114688, 7, 133701632, 32768, 218104276, 7, 218106817, 0
    .long 1, 80, 80, 2048, 5506048, 5506304, 7340032, 67457024, 114688, 7, 133709824, 32768, 218104276, 7, 218106817, 0
    .long 1, 80, 80, 2048, 5505024, 5505280, 7340032, 67457024, 114688, 7, 133693440, 32768, 218104276, 7, 218106817, 0
    .long 6, 1, 0, 2, 3, 16, 0, 23, 0, 0, 0, 0, 0, 0, 0, 0
    .long 6, 1, 0, 2, 3, 16, 0, 17, 0, 0, 0, 0, 0, 0, 0, 0
    .long 6, 1, 0, 2, 3, 16, 0, 20, 0, 0, 0, 0, 0, 0, 0, 0
    .long 6, 1, 0, 2, 3, 16, 0, 10, 0, 0, 0, 0, 0, 0, 0, 0
    .long 6, 1, 0, 2, 3, 16, 0, 6, 0, 0, 0, 0, 0, 0, 0, 0
    .long 6, 1, 0, 2, 3, 16, 0, 13, 0, 0, 0, 0, 0, 0, 0, 0
    .long 6, 1, 0, 1, 3, 16, 0, 38, 0, 0, 0, 0, 0, 0, 0, 0
    .long 6, 1, 0, 2, 3, 16, 0, 18, 0, 0, 0, 0, 0, 0, 0, 0
    .long 6, 1, 0, 2, 3, 16, 0, 9, 0, 0, 0, 0, 0, 0, 0, 0
    .long 6, 1, 0, 2, 3, 16, 0, 2, 0, 0, 0, 0, 0, 0, 0, 0
    .long 6, 1, 0, 2, 3, 16, 0, 5, 0, 0, 0, 0, 0, 0, 0, 0
    .long 6, 1, 0, 1, 3, 16, 0, 34, 0, 0, 0, 0, 0, 0, 0, 0
    .long 6, 1, 0, 2, 3, 16, 0, 7, 0, 0, 0, 0, 0, 0, 0, 0
    .long 6, 1, 0, 2, 3, 16, 0, 1, 0, 0, 0, 0, 0, 0, 0, 0
    .long 6, 1, 0, 2, 3, 16, 0, 12, 0, 0, 0, 0, 0, 0, 0, 0
    .long 6, 1, 0, 2, 3, 16, 0, 14, 0, 0, 0, 0, 0, 0, 0, 0
    .long 6, 1, 0, 2, 3, 16, 0, 0, 0, 0, 0, 0, 0, 0, 0, 0
    .long 6, 1, 0, 2, 3, 16, 0, 3, 0, 0, 0, 0, 0, 0, 0, 0
    .long 6, 1, 0, 2, 3, 16, 0, 22, 0, 0, 0, 0, 0, 0, 0, 0
    .long 6, 1, 0, 2, 3, 16, 0, 21, 0, 0, 0, 0, 0, 0, 0, 0
    .long 6, 1, 0, 2, 3, 16, 0, 8, 0, 0, 0, 0, 0, 0, 0, 0
    .long 6, 1, 0, 2, 3, 16, 0, 15, 0, 0, 0, 0, 0, 0, 0, 0
    .long 6, 1, 0, 2, 3, 16, 0, 19, 0, 0, 0, 0, 0, 0, 0, 0
    .long 6, 1, 0, 2, 3, 16, 0, 11, 0, 0, 0, 0, 0, 0, 0, 0
    .long 6, 1, 0, 2, 3, 16, 0, 16, 0, 0, 0, 0, 0, 0, 0, 0
    .long 6, 1, 0, 2, 3, 16, 0, 4, 0, 0, 0, 0, 0, 0, 0, 0
    .long 6, 0, 0, 0, 3, 0, 0, 54, 0, 0, 0, 0, 0, 0, 0, 0
    .long 6, 0, 0, 0, 3, 0, 0, 51, 0, 0, 0, 0, 0, 0, 0, 0
    .long 6, 0, 0, 0, 3, 0, 0, 48, 0, 0, 0, 0, 0, 0, 0, 0
    .long 6, 0, 0, 0, 3, 0, 0, 49, 0, 0, 0, 0, 0, 0, 0, 0
    .long 6, 0, 0, 0, 3, 0, 0, 50, 0, 0, 0, 0, 0, 0, 0, 0
    .long 6, 0, 0, 0, 3, 0, 0, 52, 0, 0, 0, 0, 0, 0, 0, 0
    .long 6, 0, 0, 0, 3, 0, 0, 53, 0, 0, 0, 0, 0, 0, 0, 0
    .long 6, 0, 0, 0, 3, 0, 0, 55, 0, 0, 0, 0, 0, 0, 0, 0
    .long 6, 1, 0, 1, 3, 16, 0, 32, 0, 0, 0, 0, 0, 0, 0, 0
    .long 6, 1, 0, 1, 3, 16, 0, 33, 0, 0, 0, 0, 0, 0, 0, 0
    .long 6, 1, 0, 1, 3, 16, 0, 35, 0, 0, 0, 0, 0, 0, 0, 0
    .long 6, 1, 0, 1, 3, 16, 0, 36, 0, 0, 0, 0, 0, 0, 0, 0
    .long 6, 1, 0, 1, 3, 16, 0, 37, 0, 0, 0, 0, 0, 0, 0, 0
    .long 6, 1, 0, 1, 3, 16, 0, 39, 0, 0, 0, 0, 0, 0, 0, 0
    .long 6, 1, 0, 2, 3, 16, 0, 24, 0, 0, 0, 0, 0, 0, 0, 0
    .long 6, 1, 0, 2, 3, 16, 0, 26, 0, 0, 0, 0, 0, 0, 0, 0
    .long 6, 1, 0, 2, 3, 16, 0, 27, 0, 0, 0, 0, 0, 0, 0, 0
    .long 6, 1, 0, 2, 3, 16, 0, 28, 0, 0, 0, 0, 0, 0, 0, 0
    .long 6, 1, 0, 2, 3, 16, 0, 29, 0, 0, 0, 0, 0, 0, 0, 0
    .long 6, 1, 0, 2, 3, 16, 0, 30, 0, 0, 0, 0, 0, 0, 0, 0
    .long 6, 1, 0, 2, 3, 16, 0, 31, 0, 0, 0, 0, 0, 0, 0, 0
    .long 6, 1, 0, 2, 3, 16, 0, 25, 0, 0, 0, 0, 0, 0, 0, 0
    .long 6, 0, 0, 1, 3, 16, 0, 40, 0, 0, 0, 0, 0, 0, 0, 0
    .long 6, 0, 0, 1, 3, 16, 0, 41, 0, 0, 0, 0, 0, 0, 0, 0
    .long 6, 0, 0, 1, 3, 16, 0, 42, 0, 0, 0, 0, 0, 0, 0, 0
    .long 6, 0, 0, 1, 3, 16, 0, 43, 0, 0, 0, 0, 0, 0, 0, 0
    .long 6, 0, 0, 1, 3, 16, 0, 44, 0, 0, 0, 0, 0, 0, 0, 0
    .long 6, 0, 0, 1, 3, 16, 0, 47, 0, 0, 0, 0, 0, 0, 0, 0
    .long 6, 0, 0, 1, 3, 16, 0, 46, 0, 0, 0, 0, 0, 0, 0, 0
    .long 6, 0, 0, 1, 3, 16, 0, 45, 0, 0, 0, 0, 0, 0, 0, 0
    .long 6, 0, 0, 0, 3, 0, 0, 56, 0, 0, 0, 0, 0, 0, 0, 0
    .long 6, 0, 0, 0, 3, 0, 0, 57, 0, 0, 0, 0, 0, 0, 0, 0
    .long 6, 0, 0, 0, 3, 0, 0, 58, 0, 0, 0, 0, 0, 0, 0, 0
    .long 6, 0, 0, 0, 3, 0, 0, 59, 0, 0, 0, 0, 0, 0, 0, 0
    .long 6, 0, 0, 0, 3, 0, 0, 60, 0, 0, 0, 0, 0, 0, 0, 0
    .long 7, 0, 0, 0, 12, 0, 0, 61, 0, 0, 0, 0, 0, 0, 0, 0
    .long 7, 0, 0, 0, 13, 0, 0, 61, 0, 0, 0, 0, 0, 0, 0, 0
    .long 7, 0, 0, 0, 14, 0, 0, 61, 0, 0, 0, 0, 0, 0, 0, 0
    .long 7, 0, 0, 0, 15, 0, 0, 61, 0, 0, 0, 0, 0, 0, 0, 0
    .long 7, 0, 0, 0, 12, 0, 0, 62, 0, 0, 0, 0, 0, 0, 0, 0
    .long 7, 0, 0, 0, 13, 0, 0, 62, 0, 0, 0, 0, 0, 0, 0, 0
    .long 7, 0, 0, 0, 14, 0, 0, 62, 0, 0, 0, 0, 0, 0, 0, 0
    .long 7, 0, 0, 0, 15, 0, 0, 62, 0, 0, 0, 0, 0, 0, 0, 0
    .long 7, 0, 0, 0, 12, 0, 0, 63, 0, 0, 0, 0, 0, 0, 0, 0
    .long 7, 0, 0, 0, 13, 0, 0, 63, 0, 0, 0, 0, 0, 0, 0, 0
    .long 7, 0, 0, 0, 14, 0, 0, 63, 0, 0, 0, 0, 0, 0, 0, 0
    .long 7, 0, 0, 0, 15, 0, 0, 63, 0, 0, 0, 0, 0, 0, 0, 0
    .long 0, 0, 0, 0, 0, 0, 0, 0, 0, 0, 0, 0, 0, 0, 0, 0
.p2align 6
.amdhsa_kernel recurrent_scan__memory_aug_recurrent_mem_tr__glu_gated_glu__prompt_kernel
  .amdhsa_next_free_vgpr 256
  .amdhsa_next_free_sgpr 102
  .amdhsa_accum_offset 256
  .amdhsa_group_segment_fixed_size 0
  .amdhsa_kernarg_size 112
  .amdhsa_user_sgpr_count 2
  .amdhsa_user_sgpr_kernarg_segment_ptr 1
  .amdhsa_system_sgpr_workgroup_id_x 1
  .amdhsa_float_denorm_mode_32 3
.end_amdhsa_kernel
```

```asm
; @launch grid=(256,1,1) block=(512,1,1) lds=163840
.amdgcn_target "amdgcn-amd-amdhsa--gfx950"
.text
.globl recurrent_scan__memory_aug_recurrent_mem_tr__glu_gated_glu__prompt_kernel
.p2align 8
.type recurrent_scan__memory_aug_recurrent_mem_tr__glu_gated_glu__prompt_kernel,@function
recurrent_scan__memory_aug_recurrent_mem_tr__glu_gated_glu__prompt_kernel:
    s_cmp_ge_u32 s2, 256
    s_cbranch_scc1 k_exit
    s_mov_b32 s99, s2
    s_load_dwordx2 s[4:5], s[0:1], 104
    s_load_dwordx2 s[64:65], s[0:1], 96
    v_lshrrev_b32 v2, 6, v0
    s_mov_b32 s6, 268435456
    s_mov_b32 s7, 131072
    s_mov_b32 s66, 256
    s_mov_b32 s67, 131072
    v_readfirstlane_b32 s3, v2
    s_lshr_b32 s13, s2, 3
    s_and_b32 s12, s2, 3
    s_waitcnt lgkmcnt(0)
    s_bitcmp0_b32 s2, 2
    s_cbranch_scc1 chain_map
    s_lshl_b32 s63, s13, 2
    s_add_u32 s63, s63, s12
    s_cmp_ge_u32 s3, 4
    s_cbranch_scc1 ln_touch
    s_load_dwordx2 s[8:9], s[0:1], 0
    v_and_b32 v1, 63, v0
    s_mov_b32 s10, 4194304
    s_mov_b32 s11, 131072
    v_and_b32 v3, 15, v1
    v_lshrrev_b32 v4, 4, v1
    v_lshlrev_b32 v5, 11, v3
    v_lshl_add_u32 v5, v4, 4, v5
    s_lshl_b32 s12, s63, 15
    s_lshl_b32 s13, s3, 9
    s_add_u32 s12, s12, s13
    s_waitcnt lgkmcnt(0)
    buffer_load_dwordx4 v[16:19], v5, s[8:11], s12 offen offset:0
    buffer_load_dwordx4 v[20:23], v5, s[8:11], s12 offen offset:64
    buffer_load_dwordx4 v[24:27], v5, s[8:11], s12 offen offset:128
    buffer_load_dwordx4 v[28:31], v5, s[8:11], s12 offen offset:192
    buffer_load_dwordx4 v[32:35], v5, s[8:11], s12 offen offset:256
    buffer_load_dwordx4 v[36:39], v5, s[8:11], s12 offen offset:320
    buffer_load_dwordx4 v[40:43], v5, s[8:11], s12 offen offset:384
    buffer_load_dwordx4 v[44:47], v5, s[8:11], s12 offen offset:448
    v_mov_b32 v14, 0
    s_lshl_b32 s13, s63, 7
    s_add_u32 s13, s13, 218103808
    v_lshlrev_b32 v13, 2, v0
    v_cmp_gt_u32 vcc, 32, v0
    s_and_saveexec_b64 s[22:23], vcc
    s_cbranch_execz ln_nz
    buffer_store_dword v14, v13, s[4:7], s13 offen sc1
ln_nz:
    s_mov_b64 exec, -1
    v_lshlrev_b32 v6, 4, v3
    s_lshl_b32 s14, s3, 2
    v_add_u32 v7, s14, v6
    v_lshlrev_b32 v8, 4, v1
    s_lshl_b32 s15, s63, 15
    s_lshl_b32 s16, s3, 13
    s_add_u32 s15, s15, s16
    s_add_u32 s16, s15, 4096
    v_and_b32 v9, 1, v4
    v_cmp_eq_u32 s[20:21], 1, v9
    s_waitcnt vmcnt(1)
    v_lshlrev_b32 v48, 16, v16
    v_and_b32 v49, 0xffff0000, v16
    v_lshlrev_b32 v50, 16, v17
    v_and_b32 v51, 0xffff0000, v17
    v_lshlrev_b32 v52, 16, v18
    v_and_b32 v53, 0xffff0000, v18
    v_lshlrev_b32 v54, 16, v19
    v_and_b32 v55, 0xffff0000, v19
    v_lshlrev_b32 v56, 16, v20
    v_and_b32 v57, 0xffff0000, v20
    v_lshlrev_b32 v58, 16, v21
    v_and_b32 v59, 0xffff0000, v21
    v_lshlrev_b32 v60, 16, v22
    v_and_b32 v61, 0xffff0000, v22
    v_lshlrev_b32 v62, 16, v23
    v_and_b32 v63, 0xffff0000, v23
    v_lshlrev_b32 v64, 16, v24
    v_and_b32 v65, 0xffff0000, v24
    v_lshlrev_b32 v66, 16, v25
    v_and_b32 v67, 0xffff0000, v25
    v_lshlrev_b32 v68, 16, v26
    v_and_b32 v69, 0xffff0000, v26
    v_lshlrev_b32 v70, 16, v27
    v_and_b32 v71, 0xffff0000, v27
    v_lshlrev_b32 v72, 16, v28
    v_and_b32 v73, 0xffff0000, v28
    v_lshlrev_b32 v74, 16, v29
    v_and_b32 v75, 0xffff0000, v29
    v_lshlrev_b32 v76, 16, v30
    v_and_b32 v77, 0xffff0000, v30
    v_lshlrev_b32 v78, 16, v31
    v_and_b32 v79, 0xffff0000, v31
    v_lshlrev_b32 v80, 16, v32
    v_and_b32 v81, 0xffff0000, v32
    v_lshlrev_b32 v82, 16, v33
    v_and_b32 v83, 0xffff0000, v33
    v_lshlrev_b32 v84, 16, v34
    v_and_b32 v85, 0xffff0000, v34
    v_lshlrev_b32 v86, 16, v35
    v_and_b32 v87, 0xffff0000, v35
    v_lshlrev_b32 v88, 16, v36
    v_and_b32 v89, 0xffff0000, v36
    v_lshlrev_b32 v90, 16, v37
    v_and_b32 v91, 0xffff0000, v37
    v_lshlrev_b32 v92, 16, v38
    v_and_b32 v93, 0xffff0000, v38
    v_lshlrev_b32 v94, 16, v39
    v_and_b32 v95, 0xffff0000, v39
    v_lshlrev_b32 v96, 16, v40
    v_and_b32 v97, 0xffff0000, v40
    v_lshlrev_b32 v98, 16, v41
    v_and_b32 v99, 0xffff0000, v41
    v_lshlrev_b32 v100, 16, v42
    v_and_b32 v101, 0xffff0000, v42
    v_lshlrev_b32 v102, 16, v43
    v_and_b32 v103, 0xffff0000, v43
    v_lshlrev_b32 v104, 16, v44
    v_and_b32 v105, 0xffff0000, v44
    v_lshlrev_b32 v106, 16, v45
    v_and_b32 v107, 0xffff0000, v45
    v_lshlrev_b32 v108, 16, v46
    v_and_b32 v109, 0xffff0000, v46
    v_lshlrev_b32 v110, 16, v47
    v_and_b32 v111, 0xffff0000, v47
    v_add_f32 v112, v48, v80
    v_add_f32 v113, v49, v81
    v_add_f32 v114, v50, v82
    v_add_f32 v115, v51, v83
    v_add_f32 v116, v52, v84
    v_add_f32 v117, v53, v85
    v_add_f32 v118, v54, v86
    v_add_f32 v119, v55, v87
    v_add_f32 v120, v56, v88
    v_add_f32 v121, v57, v89
    v_add_f32 v122, v58, v90
    v_add_f32 v123, v59, v91
    v_add_f32 v124, v60, v92
    v_add_f32 v125, v61, v93
    v_add_f32 v126, v62, v94
    v_add_f32 v127, v63, v95
    v_add_f32 v128, v64, v96
    v_add_f32 v129, v65, v97
    v_add_f32 v130, v66, v98
    v_add_f32 v131, v67, v99
    v_add_f32 v132, v68, v100
    v_add_f32 v133, v69, v101
    v_add_f32 v134, v70, v102
    v_add_f32 v135, v71, v103
    v_add_f32 v136, v72, v104
    v_add_f32 v137, v73, v105
    v_add_f32 v138, v74, v106
    v_add_f32 v139, v75, v107
    v_add_f32 v140, v76, v108
    v_add_f32 v141, v77, v109
    v_add_f32 v142, v78, v110
    v_add_f32 v143, v79, v111
    v_add_f32 v112, v112, v128
    v_add_f32 v113, v113, v129
    v_add_f32 v114, v114, v130
    v_add_f32 v115, v115, v131
    v_add_f32 v116, v116, v132
    v_add_f32 v117, v117, v133
    v_add_f32 v118, v118, v134
    v_add_f32 v119, v119, v135
    v_add_f32 v120, v120, v136
    v_add_f32 v121, v121, v137
    v_add_f32 v122, v122, v138
    v_add_f32 v123, v123, v139
    v_add_f32 v124, v124, v140
    v_add_f32 v125, v125, v141
    v_add_f32 v126, v126, v142
    v_add_f32 v127, v127, v143
    v_add_f32 v112, v112, v120
    v_add_f32 v113, v113, v121
    v_add_f32 v114, v114, v122
    v_add_f32 v115, v115, v123
    v_add_f32 v116, v116, v124
    v_add_f32 v117, v117, v125
    v_add_f32 v118, v118, v126
    v_add_f32 v119, v119, v127
    v_add_f32 v112, v112, v116
    v_add_f32 v113, v113, v117
    v_add_f32 v114, v114, v118
    v_add_f32 v115, v115, v119
    v_add_f32 v112, v112, v114
    v_add_f32 v113, v113, v115
    v_add_f32 v112, v112, v113
    v_mov_b32 v113, v112
    s_nop 1
    v_permlane16_swap_b32 v113, v112
    v_add_f32 v112, v112, v113
    v_mov_b32 v113, v112
    s_nop 1
    v_permlane32_swap_b32 v113, v112
    v_add_f32 v112, v112, v113
    ds_write_b32 v7, v112
    s_waitcnt lgkmcnt(0)
    s_barrier
    ds_read_b128 v[112:115], v6
    s_waitcnt lgkmcnt(0)
    v_add_f32 v112, v112, v114
    v_add_f32 v113, v113, v115
    v_add_f32 v112, v112, v113
    v_mul_f32 v10, 0x3a800000, v112
    v_sub_f32 v176, v48, v10
    v_sub_f32 v177, v49, v10
    v_sub_f32 v178, v50, v10
    v_sub_f32 v179, v51, v10
    v_sub_f32 v180, v52, v10
    v_sub_f32 v181, v53, v10
    v_sub_f32 v182, v54, v10
    v_sub_f32 v183, v55, v10
    v_sub_f32 v184, v56, v10
    v_sub_f32 v185, v57, v10
    v_sub_f32 v186, v58, v10
    v_sub_f32 v187, v59, v10
    v_sub_f32 v188, v60, v10
    v_sub_f32 v189, v61, v10
    v_sub_f32 v190, v62, v10
    v_sub_f32 v191, v63, v10
    v_sub_f32 v192, v64, v10
    v_sub_f32 v193, v65, v10
    v_sub_f32 v194, v66, v10
    v_sub_f32 v195, v67, v10
    v_sub_f32 v196, v68, v10
    v_sub_f32 v197, v69, v10
    v_sub_f32 v198, v70, v10
    v_sub_f32 v199, v71, v10
    v_sub_f32 v200, v72, v10
    v_sub_f32 v201, v73, v10
    v_sub_f32 v202, v74, v10
    v_sub_f32 v203, v75, v10
    v_sub_f32 v204, v76, v10
    v_sub_f32 v205, v77, v10
    v_sub_f32 v206, v78, v10
    v_sub_f32 v207, v79, v10
    v_sub_f32 v208, v80, v10
    v_sub_f32 v209, v81, v10
    v_sub_f32 v210, v82, v10
    v_sub_f32 v211, v83, v10
    v_sub_f32 v212, v84, v10
    v_sub_f32 v213, v85, v10
    v_sub_f32 v214, v86, v10
    v_sub_f32 v215, v87, v10
    v_sub_f32 v216, v88, v10
    v_sub_f32 v217, v89, v10
    v_sub_f32 v218, v90, v10
    v_sub_f32 v219, v91, v10
    v_sub_f32 v220, v92, v10
    v_sub_f32 v221, v93, v10
    v_sub_f32 v222, v94, v10
    v_sub_f32 v223, v95, v10
    v_sub_f32 v224, v96, v10
    v_sub_f32 v225, v97, v10
    v_sub_f32 v226, v98, v10
    v_sub_f32 v227, v99, v10
    v_sub_f32 v228, v100, v10
    v_sub_f32 v229, v101, v10
    v_sub_f32 v230, v102, v10
    v_sub_f32 v231, v103, v10
    v_sub_f32 v232, v104, v10
    v_sub_f32 v233, v105, v10
    v_sub_f32 v234, v106, v10
    v_sub_f32 v235, v107, v10
    v_sub_f32 v236, v108, v10
    v_sub_f32 v237, v109, v10
    v_sub_f32 v238, v110, v10
    v_sub_f32 v239, v111, v10
    v_mul_f32 v112, v176, v176
    v_fmac_f32 v112, v208, v208
    v_mul_f32 v113, v177, v177
    v_fmac_f32 v113, v209, v209
    v_mul_f32 v114, v178, v178
    v_fmac_f32 v114, v210, v210
    v_mul_f32 v115, v179, v179
    v_fmac_f32 v115, v211, v211
    v_mul_f32 v116, v180, v180
    v_fmac_f32 v116, v212, v212
    v_mul_f32 v117, v181, v181
    v_fmac_f32 v117, v213, v213
    v_mul_f32 v118, v182, v182
    v_fmac_f32 v118, v214, v214
    v_mul_f32 v119, v183, v183
    v_fmac_f32 v119, v215, v215
    v_mul_f32 v120, v184, v184
    v_fmac_f32 v120, v216, v216
    v_mul_f32 v121, v185, v185
    v_fmac_f32 v121, v217, v217
    v_mul_f32 v122, v186, v186
    v_fmac_f32 v122, v218, v218
    v_mul_f32 v123, v187, v187
    v_fmac_f32 v123, v219, v219
    v_mul_f32 v124, v188, v188
    v_fmac_f32 v124, v220, v220
    v_mul_f32 v125, v189, v189
    v_fmac_f32 v125, v221, v221
    v_mul_f32 v126, v190, v190
    v_fmac_f32 v126, v222, v222
    v_mul_f32 v127, v191, v191
    v_fmac_f32 v127, v223, v223
    v_mul_f32 v128, v192, v192
    v_fmac_f32 v128, v224, v224
    v_mul_f32 v129, v193, v193
    v_fmac_f32 v129, v225, v225
    v_mul_f32 v130, v194, v194
    v_fmac_f32 v130, v226, v226
    v_mul_f32 v131, v195, v195
    v_fmac_f32 v131, v227, v227
    v_mul_f32 v132, v196, v196
    v_fmac_f32 v132, v228, v228
    v_mul_f32 v133, v197, v197
    v_fmac_f32 v133, v229, v229
    v_mul_f32 v134, v198, v198
    v_fmac_f32 v134, v230, v230
    v_mul_f32 v135, v199, v199
    v_fmac_f32 v135, v231, v231
    v_mul_f32 v136, v200, v200
    v_fmac_f32 v136, v232, v232
    v_mul_f32 v137, v201, v201
    v_fmac_f32 v137, v233, v233
    v_mul_f32 v138, v202, v202
    v_fmac_f32 v138, v234, v234
    v_mul_f32 v139, v203, v203
    v_fmac_f32 v139, v235, v235
    v_mul_f32 v140, v204, v204
    v_fmac_f32 v140, v236, v236
    v_mul_f32 v141, v205, v205
    v_fmac_f32 v141, v237, v237
    v_mul_f32 v142, v206, v206
    v_fmac_f32 v142, v238, v238
    v_mul_f32 v143, v207, v207
    v_fmac_f32 v143, v239, v239
    v_add_f32 v112, v112, v128
    v_add_f32 v113, v113, v129
    v_add_f32 v114, v114, v130
    v_add_f32 v115, v115, v131
    v_add_f32 v116, v116, v132
    v_add_f32 v117, v117, v133
    v_add_f32 v118, v118, v134
    v_add_f32 v119, v119, v135
    v_add_f32 v120, v120, v136
    v_add_f32 v121, v121, v137
    v_add_f32 v122, v122, v138
    v_add_f32 v123, v123, v139
    v_add_f32 v124, v124, v140
    v_add_f32 v125, v125, v141
    v_add_f32 v126, v126, v142
    v_add_f32 v127, v127, v143
    v_add_f32 v112, v112, v120
    v_add_f32 v113, v113, v121
    v_add_f32 v114, v114, v122
    v_add_f32 v115, v115, v123
    v_add_f32 v116, v116, v124
    v_add_f32 v117, v117, v125
    v_add_f32 v118, v118, v126
    v_add_f32 v119, v119, v127
    v_add_f32 v112, v112, v116
    v_add_f32 v113, v113, v117
    v_add_f32 v114, v114, v118
    v_add_f32 v115, v115, v119
    v_add_f32 v112, v112, v114
    v_add_f32 v113, v113, v115
    v_add_f32 v112, v112, v113
    v_mov_b32 v113, v112
    s_nop 1
    v_permlane16_swap_b32 v113, v112
    v_add_f32 v112, v112, v113
    v_mov_b32 v113, v112
    s_nop 1
    v_permlane32_swap_b32 v113, v112
    v_add_f32 v112, v112, v113
    ds_write_b32 v7, v112 offset:512
    s_waitcnt lgkmcnt(0)
    s_barrier
    ds_read_b128 v[112:115], v6 offset:512
    s_waitcnt lgkmcnt(0)
    v_add_f32 v112, v112, v114
    v_add_f32 v113, v113, v115
    v_add_f32 v112, v112, v113
    v_mul_f32 v11, 0x3a800000, v112
    v_cvt_pk_bf16_f32 v10, v10, v10
    v_lshlrev_b32 v10, 16, v10
    v_cvt_pk_bf16_f32 v11, v11, v11
    v_lshlrev_b32 v11, 16, v11
    v_add_f32 v11, 0x3727c5ac, v11
    v_cvt_pk_bf16_f32 v11, v11, v11
    v_lshlrev_b32 v11, 16, v11
    v_sqrt_f32 v11, v11
    s_nop 0
    v_cvt_pk_bf16_f32 v11, v11, v11
    v_lshlrev_b32 v11, 16, v11
    v_rcp_f32 v11, v11
    s_nop 0
    v_sub_f32 v48, v48, v10
    v_sub_f32 v49, v49, v10
    v_cvt_pk_bf16_f32 v16, v48, v49
    v_lshlrev_b32 v48, 16, v16
    v_and_b32 v49, 0xffff0000, v16
    v_mul_f32 v48, v48, v11
    v_mul_f32 v49, v49, v11
    v_cvt_pk_bf16_f32 v16, v48, v49
    v_sub_f32 v50, v50, v10
    v_sub_f32 v51, v51, v10
    v_cvt_pk_bf16_f32 v17, v50, v51
    v_lshlrev_b32 v50, 16, v17
    v_and_b32 v51, 0xffff0000, v17
    v_mul_f32 v50, v50, v11
    v_mul_f32 v51, v51, v11
    v_cvt_pk_bf16_f32 v17, v50, v51
    v_sub_f32 v52, v52, v10
    v_sub_f32 v53, v53, v10
    v_cvt_pk_bf16_f32 v18, v52, v53
    v_lshlrev_b32 v52, 16, v18
    v_and_b32 v53, 0xffff0000, v18
    v_mul_f32 v52, v52, v11
    v_mul_f32 v53, v53, v11
    v_cvt_pk_bf16_f32 v18, v52, v53
    v_sub_f32 v54, v54, v10
    v_sub_f32 v55, v55, v10
    v_cvt_pk_bf16_f32 v19, v54, v55
    v_lshlrev_b32 v54, 16, v19
    v_and_b32 v55, 0xffff0000, v19
    v_mul_f32 v54, v54, v11
    v_mul_f32 v55, v55, v11
    v_cvt_pk_bf16_f32 v19, v54, v55
    v_cndmask_b32 v112, v16, v18, s[20:21]
    v_cndmask_b32 v113, v17, v19, s[20:21]
    v_cndmask_b32 v114, v18, v16, s[20:21]
    v_cndmask_b32 v115, v19, v17, s[20:21]
    buffer_store_dwordx4 v[112:115], v8, s[4:7], s15 offen offset:0 sc1
    v_sub_f32 v56, v56, v10
    v_sub_f32 v57, v57, v10
    v_cvt_pk_bf16_f32 v20, v56, v57
    v_lshlrev_b32 v56, 16, v20
    v_and_b32 v57, 0xffff0000, v20
    v_mul_f32 v56, v56, v11
    v_mul_f32 v57, v57, v11
    v_cvt_pk_bf16_f32 v20, v56, v57
    v_sub_f32 v58, v58, v10
    v_sub_f32 v59, v59, v10
    v_cvt_pk_bf16_f32 v21, v58, v59
    v_lshlrev_b32 v58, 16, v21
    v_and_b32 v59, 0xffff0000, v21
    v_mul_f32 v58, v58, v11
    v_mul_f32 v59, v59, v11
    v_cvt_pk_bf16_f32 v21, v58, v59
    v_sub_f32 v60, v60, v10
    v_sub_f32 v61, v61, v10
    v_cvt_pk_bf16_f32 v22, v60, v61
    v_lshlrev_b32 v60, 16, v22
    v_and_b32 v61, 0xffff0000, v22
    v_mul_f32 v60, v60, v11
    v_mul_f32 v61, v61, v11
    v_cvt_pk_bf16_f32 v22, v60, v61
    v_sub_f32 v62, v62, v10
    v_sub_f32 v63, v63, v10
    v_cvt_pk_bf16_f32 v23, v62, v63
    v_lshlrev_b32 v62, 16, v23
    v_and_b32 v63, 0xffff0000, v23
    v_mul_f32 v62, v62, v11
    v_mul_f32 v63, v63, v11
    v_cvt_pk_bf16_f32 v23, v62, v63
    v_cndmask_b32 v116, v20, v22, s[20:21]
    v_cndmask_b32 v117, v21, v23, s[20:21]
    v_cndmask_b32 v118, v22, v20, s[20:21]
    v_cndmask_b32 v119, v23, v21, s[20:21]
    buffer_store_dwordx4 v[116:119], v8, s[4:7], s15 offen offset:1024 sc1
    v_sub_f32 v64, v64, v10
    v_sub_f32 v65, v65, v10
    v_cvt_pk_bf16_f32 v24, v64, v65
    v_lshlrev_b32 v64, 16, v24
    v_and_b32 v65, 0xffff0000, v24
    v_mul_f32 v64, v64, v11
    v_mul_f32 v65, v65, v11
    v_cvt_pk_bf16_f32 v24, v64, v65
    v_sub_f32 v66, v66, v10
    v_sub_f32 v67, v67, v10
    v_cvt_pk_bf16_f32 v25, v66, v67
    v_lshlrev_b32 v66, 16, v25
    v_and_b32 v67, 0xffff0000, v25
    v_mul_f32 v66, v66, v11
    v_mul_f32 v67, v67, v11
    v_cvt_pk_bf16_f32 v25, v66, v67
    v_sub_f32 v68, v68, v10
    v_sub_f32 v69, v69, v10
    v_cvt_pk_bf16_f32 v26, v68, v69
    v_lshlrev_b32 v68, 16, v26
    v_and_b32 v69, 0xffff0000, v26
    v_mul_f32 v68, v68, v11
    v_mul_f32 v69, v69, v11
    v_cvt_pk_bf16_f32 v26, v68, v69
    v_sub_f32 v70, v70, v10
    v_sub_f32 v71, v71, v10
    v_cvt_pk_bf16_f32 v27, v70, v71
    v_lshlrev_b32 v70, 16, v27
    v_and_b32 v71, 0xffff0000, v27
    v_mul_f32 v70, v70, v11
    v_mul_f32 v71, v71, v11
    v_cvt_pk_bf16_f32 v27, v70, v71
    v_cndmask_b32 v120, v24, v26, s[20:21]
    v_cndmask_b32 v121, v25, v27, s[20:21]
    v_cndmask_b32 v122, v26, v24, s[20:21]
    v_cndmask_b32 v123, v27, v25, s[20:21]
    buffer_store_dwordx4 v[120:123], v8, s[4:7], s15 offen offset:2048 sc1
    v_sub_f32 v72, v72, v10
    v_sub_f32 v73, v73, v10
    v_cvt_pk_bf16_f32 v28, v72, v73
    v_lshlrev_b32 v72, 16, v28
    v_and_b32 v73, 0xffff0000, v28
    v_mul_f32 v72, v72, v11
    v_mul_f32 v73, v73, v11
    v_cvt_pk_bf16_f32 v28, v72, v73
    v_sub_f32 v74, v74, v10
    v_sub_f32 v75, v75, v10
    v_cvt_pk_bf16_f32 v29, v74, v75
    v_lshlrev_b32 v74, 16, v29
    v_and_b32 v75, 0xffff0000, v29
    v_mul_f32 v74, v74, v11
    v_mul_f32 v75, v75, v11
    v_cvt_pk_bf16_f32 v29, v74, v75
    v_sub_f32 v76, v76, v10
    v_sub_f32 v77, v77, v10
    v_cvt_pk_bf16_f32 v30, v76, v77
    v_lshlrev_b32 v76, 16, v30
    v_and_b32 v77, 0xffff0000, v30
    v_mul_f32 v76, v76, v11
    v_mul_f32 v77, v77, v11
    v_cvt_pk_bf16_f32 v30, v76, v77
    v_sub_f32 v78, v78, v10
    v_sub_f32 v79, v79, v10
    v_cvt_pk_bf16_f32 v31, v78, v79
    v_lshlrev_b32 v78, 16, v31
    v_and_b32 v79, 0xffff0000, v31
    v_mul_f32 v78, v78, v11
    v_mul_f32 v79, v79, v11
    v_cvt_pk_bf16_f32 v31, v78, v79
    v_cndmask_b32 v124, v28, v30, s[20:21]
    v_cndmask_b32 v125, v29, v31, s[20:21]
    v_cndmask_b32 v126, v30, v28, s[20:21]
    v_cndmask_b32 v127, v31, v29, s[20:21]
    buffer_store_dwordx4 v[124:127], v8, s[4:7], s15 offen offset:3072 sc1
    v_sub_f32 v80, v80, v10
    v_sub_f32 v81, v81, v10
    v_cvt_pk_bf16_f32 v32, v80, v81
    v_lshlrev_b32 v80, 16, v32
    v_and_b32 v81, 0xffff0000, v32
    v_mul_f32 v80, v80, v11
    v_mul_f32 v81, v81, v11
    v_cvt_pk_bf16_f32 v32, v80, v81
    v_sub_f32 v82, v82, v10
    v_sub_f32 v83, v83, v10
    v_cvt_pk_bf16_f32 v33, v82, v83
    v_lshlrev_b32 v82, 16, v33
    v_and_b32 v83, 0xffff0000, v33
    v_mul_f32 v82, v82, v11
    v_mul_f32 v83, v83, v11
    v_cvt_pk_bf16_f32 v33, v82, v83
    v_sub_f32 v84, v84, v10
    v_sub_f32 v85, v85, v10
    v_cvt_pk_bf16_f32 v34, v84, v85
    v_lshlrev_b32 v84, 16, v34
    v_and_b32 v85, 0xffff0000, v34
    v_mul_f32 v84, v84, v11
    v_mul_f32 v85, v85, v11
    v_cvt_pk_bf16_f32 v34, v84, v85
    v_sub_f32 v86, v86, v10
    v_sub_f32 v87, v87, v10
    v_cvt_pk_bf16_f32 v35, v86, v87
    v_lshlrev_b32 v86, 16, v35
    v_and_b32 v87, 0xffff0000, v35
    v_mul_f32 v86, v86, v11
    v_mul_f32 v87, v87, v11
    v_cvt_pk_bf16_f32 v35, v86, v87
    v_cndmask_b32 v128, v32, v34, s[20:21]
    v_cndmask_b32 v129, v33, v35, s[20:21]
    v_cndmask_b32 v130, v34, v32, s[20:21]
    v_cndmask_b32 v131, v35, v33, s[20:21]
    buffer_store_dwordx4 v[128:131], v8, s[4:7], s16 offen offset:0 sc1
    v_sub_f32 v88, v88, v10
    v_sub_f32 v89, v89, v10
    v_cvt_pk_bf16_f32 v36, v88, v89
    v_lshlrev_b32 v88, 16, v36
    v_and_b32 v89, 0xffff0000, v36
    v_mul_f32 v88, v88, v11
    v_mul_f32 v89, v89, v11
    v_cvt_pk_bf16_f32 v36, v88, v89
    v_sub_f32 v90, v90, v10
    v_sub_f32 v91, v91, v10
    v_cvt_pk_bf16_f32 v37, v90, v91
    v_lshlrev_b32 v90, 16, v37
    v_and_b32 v91, 0xffff0000, v37
    v_mul_f32 v90, v90, v11
    v_mul_f32 v91, v91, v11
    v_cvt_pk_bf16_f32 v37, v90, v91
    v_sub_f32 v92, v92, v10
    v_sub_f32 v93, v93, v10
    v_cvt_pk_bf16_f32 v38, v92, v93
    v_lshlrev_b32 v92, 16, v38
    v_and_b32 v93, 0xffff0000, v38
    v_mul_f32 v92, v92, v11
    v_mul_f32 v93, v93, v11
    v_cvt_pk_bf16_f32 v38, v92, v93
    v_sub_f32 v94, v94, v10
    v_sub_f32 v95, v95, v10
    v_cvt_pk_bf16_f32 v39, v94, v95
    v_lshlrev_b32 v94, 16, v39
    v_and_b32 v95, 0xffff0000, v39
    v_mul_f32 v94, v94, v11
    v_mul_f32 v95, v95, v11
    v_cvt_pk_bf16_f32 v39, v94, v95
    v_cndmask_b32 v132, v36, v38, s[20:21]
    v_cndmask_b32 v133, v37, v39, s[20:21]
    v_cndmask_b32 v134, v38, v36, s[20:21]
    v_cndmask_b32 v135, v39, v37, s[20:21]
    buffer_store_dwordx4 v[132:135], v8, s[4:7], s16 offen offset:1024 sc1
    v_sub_f32 v96, v96, v10
    v_sub_f32 v97, v97, v10
    v_cvt_pk_bf16_f32 v40, v96, v97
    v_lshlrev_b32 v96, 16, v40
    v_and_b32 v97, 0xffff0000, v40
    v_mul_f32 v96, v96, v11
    v_mul_f32 v97, v97, v11
    v_cvt_pk_bf16_f32 v40, v96, v97
    v_sub_f32 v98, v98, v10
    v_sub_f32 v99, v99, v10
    v_cvt_pk_bf16_f32 v41, v98, v99
    v_lshlrev_b32 v98, 16, v41
    v_and_b32 v99, 0xffff0000, v41
    v_mul_f32 v98, v98, v11
    v_mul_f32 v99, v99, v11
    v_cvt_pk_bf16_f32 v41, v98, v99
    v_sub_f32 v100, v100, v10
    v_sub_f32 v101, v101, v10
    v_cvt_pk_bf16_f32 v42, v100, v101
    v_lshlrev_b32 v100, 16, v42
    v_and_b32 v101, 0xffff0000, v42
    v_mul_f32 v100, v100, v11
    v_mul_f32 v101, v101, v11
    v_cvt_pk_bf16_f32 v42, v100, v101
    v_sub_f32 v102, v102, v10
    v_sub_f32 v103, v103, v10
    v_cvt_pk_bf16_f32 v43, v102, v103
    v_lshlrev_b32 v102, 16, v43
    v_and_b32 v103, 0xffff0000, v43
    v_mul_f32 v102, v102, v11
    v_mul_f32 v103, v103, v11
    v_cvt_pk_bf16_f32 v43, v102, v103
    v_cndmask_b32 v136, v40, v42, s[20:21]
    v_cndmask_b32 v137, v41, v43, s[20:21]
    v_cndmask_b32 v138, v42, v40, s[20:21]
    v_cndmask_b32 v139, v43, v41, s[20:21]
    buffer_store_dwordx4 v[136:139], v8, s[4:7], s16 offen offset:2048 sc1
    v_sub_f32 v104, v104, v10
    v_sub_f32 v105, v105, v10
    v_cvt_pk_bf16_f32 v44, v104, v105
    v_lshlrev_b32 v104, 16, v44
    v_and_b32 v105, 0xffff0000, v44
    v_mul_f32 v104, v104, v11
    v_mul_f32 v105, v105, v11
    v_cvt_pk_bf16_f32 v44, v104, v105
    v_sub_f32 v106, v106, v10
    v_sub_f32 v107, v107, v10
    v_cvt_pk_bf16_f32 v45, v106, v107
    v_lshlrev_b32 v106, 16, v45
    v_and_b32 v107, 0xffff0000, v45
    v_mul_f32 v106, v106, v11
    v_mul_f32 v107, v107, v11
    v_cvt_pk_bf16_f32 v45, v106, v107
    v_sub_f32 v108, v108, v10
    v_sub_f32 v109, v109, v10
    v_cvt_pk_bf16_f32 v46, v108, v109
    v_lshlrev_b32 v108, 16, v46
    v_and_b32 v109, 0xffff0000, v46
    v_mul_f32 v108, v108, v11
    v_mul_f32 v109, v109, v11
    v_cvt_pk_bf16_f32 v46, v108, v109
    v_sub_f32 v110, v110, v10
    v_sub_f32 v111, v111, v10
    v_cvt_pk_bf16_f32 v47, v110, v111
    v_lshlrev_b32 v110, 16, v47
    v_and_b32 v111, 0xffff0000, v47
    v_mul_f32 v110, v110, v11
    v_mul_f32 v111, v111, v11
    v_cvt_pk_bf16_f32 v47, v110, v111
    v_cndmask_b32 v140, v44, v46, s[20:21]
    v_cndmask_b32 v141, v45, v47, s[20:21]
    v_cndmask_b32 v142, v46, v44, s[20:21]
    v_cndmask_b32 v143, v47, v45, s[20:21]
    buffer_store_dwordx4 v[140:143], v8, s[4:7], s16 offen offset:3072 sc1
    s_waitcnt vmcnt(0)
    s_barrier
    s_cmp_lg_u32 s3, 0
    s_cbranch_scc1 ln_sig
    v_mov_b32 v2, 1
    s_mov_b64 exec, 1
    s_cmp_ge_u32 s63, 8
    s_cbranch_scc1 ln_sb
    buffer_atomic_add v2, off, s[64:67], 0 offset:192 sc1
ln_sb:
    buffer_atomic_add v2, off, s[64:67], 0 offset:0 sc1
    s_mov_b64 exec, -1
    s_branch ln_sig
ln_touch:
    s_getpc_b64 s[24:25]
    s_add_u32 s24, s24, jobtab@rel32@lo+4
    s_addc_u32 s25, s25, jobtab@rel32@hi+12
    s_and_b32 s30, s63, 3
    s_mul_i32 s30, s30, 320
    s_lshr_b32 s31, s63, 2
    s_add_u32 s30, s30, s31
    s_lshl_b32 s30, s30, 6
    s_add_u32 s24, s24, s30
    s_addc_u32 s25, s25, 0
    s_load_dwordx16 s[32:47], s[24:25], 0
    s_mov_b32 s11, 131072
    v_and_b32 v20, 63, v0
    s_waitcnt lgkmcnt(0)
    s_load_dwordx2 s[8:9], s[0:1], s33
    s_mov_b32 s10, s38
    s_lshl_b32 s30, s35, 4
    v_mul_lo_u32 v21, s30, v20
    v_and_b32 v22, 15, v20
    v_mul_lo_u32 v22, s43, v22
    s_waitcnt lgkmcnt(0)
    s_cmp_eq_u32 s3, 4
    s_cbranch_scc0 tlb_1_1
    buffer_load_dword v23, v21, s[8:11], s36 offen
    s_branch tlb_1
tlb_1_1:
    s_cmp_eq_u32 s3, 5
    s_cbranch_scc0 tlb_1
    buffer_load_dword v23, v22, s[4:7], s42 offen
    buffer_load_dword v23, off, s[4:7], s46
tlb_1:
    s_barrier
    s_barrier
    s_barrier
ln_sig:
    s_mov_b32 s29, s63
    v_and_b32 v20, 63, v0
    v_lshlrev_b32 v1, 4, v20
    v_add_u32 v19, 0x1000, v1
    v_lshrrev_b32 v4, 4, v20
    v_mov_b32 v17, 0
    v_mov_b32 v18, 1
    s_lshr_b32 s26, s3, 2
    s_and_b32 s27, s3, 3
    s_lshl_b32 s21, s3, 11
    s_lshl_b32 s22, s3, 10
    s_add_u32 s22, s22, 16384
    s_mov_b32 s11, 131072
    s_mov_b32 s15, 131072
    s_mov_b32 s28, 0
    v_and_b32 v21, 15, v20
    v_lshlrev_b32 v22, 2, v4
    v_xor_b32 v21, v21, v22
    s_lshr_b32 s30, s3, 1
    s_and_b32 s30, s30, 1
    v_xor_b32 v21, s30, v21
    v_lshlrev_b32 v3, 4, v21
    s_lshl_b32 s30, s26, 13
    v_add_u32 v5, s30, v1
    v_add_u32 v6, 0x10000, v5
    v_bfe_u32 v21, v20, 2, 2
    v_and_b32 v22, 3, v20
    v_and_b32 v23, 1, v4
    v_xor_b32 v24, s27, v21
    v_xor_b32 v25, v22, v23
    v_lshl_add_u32 v24, v24, 2, v25
    v_lshlrev_b32 v24, 4, v24
    v_lshl_add_u32 v25, v4, 3, v21
    v_lshl_add_u32 v24, v25, 8, v24
    v_and_b32 v22, 1, v22
    v_xor_b32 v25, 0, v23
    v_lshl_add_u32 v8, v25, 10, v24
    v_xor_b32 v25, 0, v22
    v_lshl_add_u32 v8, v25, 3, v8
    v_add_u32 v12, 0x10000, v8
    v_xor_b32 v25, 1, v23
    v_lshl_add_u32 v9, v25, 10, v24
    v_xor_b32 v25, 0, v22
    v_lshl_add_u32 v9, v25, 3, v9
    v_add_u32 v13, 0x10000, v9
    v_xor_b32 v25, 0, v23
    v_lshl_add_u32 v10, v25, 10, v24
    v_xor_b32 v25, 1, v22
    v_lshl_add_u32 v10, v25, 3, v10
    v_add_u32 v14, 0x10000, v10
    v_xor_b32 v25, 1, v23
    v_lshl_add_u32 v11, v25, 10, v24
    v_xor_b32 v25, 1, v22
    v_lshl_add_u32 v11, v25, 3, v11
    v_add_u32 v15, 0x10000, v11
    s_lshl_b32 s30, s3, 2
    s_add_u32 s30, s30, 131072
    v_mov_b32 v7, s30
    s_cmp_ge_u32 s3, 4
    s_cbranch_scc0 w_np
    s_setprio 1
w_np:
    s_getpc_b64 s[24:25]
    s_add_u32 s24, s24, jobtab@rel32@lo+4
    s_addc_u32 s25, s25, jobtab@rel32@hi+12
    s_and_b32 s31, s29, 3
    s_mul_i32 s30, s31, 20480
    s_add_u32 s24, s24, s30
    s_addc_u32 s25, s25, 0
    s_lshl_b32 s71, s31, 2
    s_add_u32 s71, s71, 64
    s_lshr_b32 s59, s29, 2
    s_lshl_b32 s30, s59, 6
    s_load_dwordx16 s[32:47], s[24:25], s30
    s_waitcnt lgkmcnt(0)
    s_cmp_lg_u32 s32, 4
    s_cbranch_scc1 w_nopre
    s_load_dwordx2 s[8:9], s[0:1], s33
    s_load_dwordx2 s[12:13], s[0:1], s34
    s_mov_b32 s10, s38
    s_mov_b32 s14, s38
    s_cmp_eq_u32 s32, 4
    s_cselect_b32 s31, 0, 1
    s_lshl_b32 s30, s3, s31
    s_mul_i32 s30, s30, s40
    s_add_u32 s16, s39, s30
    s_cmp_eq_u32 s32, 4
    s_cselect_b32 s30, 1024, s40
    s_cselect_b32 s31, 6, 5
    s_lshl_b32 s62, 32, s31
    s_add_u32 s17, s16, s30
    s_lshl_b32 s30, s3, 2
    s_mul_i32 s30, s30, s35
    s_add_u32 s18, s36, s30
    s_add_u32 s19, s37, s30
    s_lshl_b32 s20, s35, s31
    v_mul_u32_u24 v2, s35, v4
    v_add_u32 v2, v2, v3
    s_waitcnt lgkmcnt(0)
    s_add_u32 m0, s22, 0
    s_nop 0
    buffer_load_dwordx4 v2, s[8:11], s18 offen lds
    s_add_u32 s18, s18, s20
    s_add_u32 m0, s22, 8192
    s_nop 0
    buffer_load_dwordx4 v2, s[12:15], s19 offen lds
    s_add_u32 s19, s19, s20
    s_add_u32 m0, s22, 32768
    s_nop 0
    buffer_load_dwordx4 v2, s[8:11], s18 offen lds
    s_add_u32 s18, s18, s20
    s_add_u32 m0, s22, 40960
    s_nop 0
    buffer_load_dwordx4 v2, s[12:15], s19 offen lds
    s_add_u32 s19, s19, s20
    s_add_u32 m0, s22, 65536
    s_nop 0
    buffer_load_dwordx4 v2, s[8:11], s18 offen lds
    s_add_u32 s18, s18, s20
    s_add_u32 m0, s22, 73728
    s_nop 0
    buffer_load_dwordx4 v2, s[12:15], s19 offen lds
    s_add_u32 s19, s19, s20
    s_add_u32 m0, s22, 98304
    s_nop 0
    buffer_load_dwordx4 v2, s[8:11], s18 offen lds
    s_add_u32 s18, s18, s20
    s_add_u32 m0, s22, 106496
    s_nop 0
    buffer_load_dwordx4 v2, s[12:15], s19 offen lds
    s_add_u32 s19, s19, s20
    s_cmp_eq_u32 s32, 4
    s_cselect_b32 s70, 1, 0
    s_cmp_eq_u32 s39, 0
    s_cselect_b32 s70, s70, 0
    s_cmp_lg_u32 s3, 0
    s_cbranch_scc1 lnwp_ok
    s_cmp_eq_u32 s70, 0
    s_cbranch_scc1 lnwp_full
    s_mov_b32 s69, 65536
lnwap:
    buffer_load_dword v20, off, s[64:67], 0 offset:192 sc1
    s_waitcnt vmcnt(0)
    v_readfirstlane_b32 s68, v20
    s_cmp_ge_u32 s68, 8
    s_cbranch_scc1 lnwap_ok
    s_sleep 8
    s_sub_u32 s69, s69, 1
    s_cbranch_scc0 lnwap
lnwap_ok:
    s_branch lnwp_ok
lnwp_full:
    s_mov_b32 s69, 65536
lnwp:
    buffer_load_dword v20, off, s[64:67], 0 offset:0 sc1
    s_waitcnt vmcnt(0)
    v_readfirstlane_b32 s68, v20
    s_cmp_ge_u32 s68, 128
    s_cbranch_scc1 lnwp_ok
    s_sleep 8
    s_sub_u32 s69, s69, 1
    s_cbranch_scc0 lnwp
lnwp_ok:
    s_barrier
    s_add_u32 m0, s21, 0
    s_nop 0
    buffer_load_dwordx4 v1, s[4:7], s16 offen sc1 lds
    s_add_u32 s16, s16, s62
    s_add_u32 m0, s21, 1024
    s_nop 0
    buffer_load_dwordx4 v1, s[4:7], s17 offen sc1 lds
    s_add_u32 s17, s17, s62
    s_add_u32 m0, s21, 32768
    s_nop 0
    buffer_load_dwordx4 v1, s[4:7], s16 offen sc1 lds
    s_add_u32 s16, s16, s62
    s_add_u32 m0, s21, 33792
    s_nop 0
    buffer_load_dwordx4 v1, s[4:7], s17 offen sc1 lds
    s_add_u32 s17, s17, s62
    s_add_u32 m0, s21, 65536
    s_nop 0
    buffer_load_dwordx4 v1, s[4:7], s16 offen sc1 lds
    s_add_u32 s16, s16, s62
    s_add_u32 m0, s21, 66560
    s_nop 0
    buffer_load_dwordx4 v1, s[4:7], s17 offen sc1 lds
    s_add_u32 s17, s17, s62
    s_add_u32 m0, s21, 98304
    s_nop 0
    buffer_load_dwordx4 v1, s[4:7], s16 offen sc1 lds
    s_add_u32 s16, s16, s62
    s_add_u32 m0, s21, 99328
    s_nop 0
    buffer_load_dwordx4 v1, s[4:7], s17 offen sc1 lds
    s_add_u32 s17, s17, s62
    s_branch w_adopt
w_nopre:
    s_cmp_eq_u32 s32, 4
    s_cselect_b32 s70, 1, 0
    s_cmp_eq_u32 s39, 0
    s_cselect_b32 s70, s70, 0
    s_cmp_lg_u32 s3, 0
    s_cbranch_scc1 lnw_ok
    s_cmp_eq_u32 s70, 0
    s_cbranch_scc1 lnw_full
    s_mov_b32 s69, 65536
lnwa:
    buffer_load_dword v20, off, s[64:67], 0 offset:192 sc1
    s_waitcnt vmcnt(0)
    v_readfirstlane_b32 s68, v20
    s_cmp_ge_u32 s68, 8
    s_cbranch_scc1 lnwa_ok
    s_sleep 8
    s_sub_u32 s69, s69, 1
    s_cbranch_scc0 lnwa
lnwa_ok:
    s_branch lnw_ok
lnw_full:
    s_mov_b32 s69, 65536
lnw:
    buffer_load_dword v20, off, s[64:67], 0 offset:0 sc1
    s_waitcnt vmcnt(0)
    v_readfirstlane_b32 s68, v20
    s_cmp_ge_u32 s68, 128
    s_cbranch_scc1 lnw_ok
    s_sleep 8
    s_sub_u32 s69, s69, 1
    s_cbranch_scc0 lnw
lnw_ok:
    s_barrier
w_cold:
    s_cmp_eq_u32 s32, 0
    s_cbranch_scc1 k_end
    s_cmp_ge_u32 s32, 6
    s_cbranch_scc1 w_fin
    s_cmp_lg_u32 s3, 0
    s_cbranch_scc1 w_depok
    s_cmp_eq_u32 s45, 0
    s_cbranch_scc1 w_depok
    s_mov_b32 s31, 0x40000
w_waitdep:
    buffer_load_dword v16, v17, s[4:7], s44 offen sc1
    s_waitcnt vmcnt(0)
    v_readfirstlane_b32 s30, v16
    s_cmp_ge_u32 s30, s45
    s_cbranch_scc1 w_depok
    s_sleep 16
    s_sub_u32 s31, s31, 1
    s_cbranch_scc0 w_waitdep
w_depok:
    s_cmp_eq_u32 s32, 5
    s_cbranch_scc1 w_att
    s_load_dwordx2 s[8:9], s[0:1], s33
    s_load_dwordx2 s[12:13], s[0:1], s34
    s_mov_b32 s10, s38
    s_mov_b32 s14, s38
    s_cmp_eq_u32 s32, 4
    s_cselect_b32 s31, 0, 1
    s_lshl_b32 s30, s3, s31
    s_mul_i32 s30, s30, s40
    s_add_u32 s16, s39, s30
    s_cmp_eq_u32 s32, 4
    s_cselect_b32 s30, 1024, s40
    s_cselect_b32 s31, 6, 5
    s_lshl_b32 s62, 32, s31
    s_add_u32 s17, s16, s30
    s_lshl_b32 s30, s3, 2
    s_mul_i32 s30, s30, s35
    s_add_u32 s18, s36, s30
    s_add_u32 s19, s37, s30
    s_lshl_b32 s20, s35, s31
    v_mul_u32_u24 v2, s35, v4
    v_add_u32 v2, v2, v3
    s_waitcnt lgkmcnt(0)
    s_barrier
    s_add_u32 m0, s21, 0
    s_nop 0
    buffer_load_dwordx4 v1, s[4:7], s16 offen sc1 lds
    s_add_u32 s16, s16, s62
    s_add_u32 m0, s21, 1024
    s_nop 0
    buffer_load_dwordx4 v1, s[4:7], s17 offen sc1 lds
    s_add_u32 s17, s17, s62
    s_add_u32 m0, s22, 0
    s_nop 0
    buffer_load_dwordx4 v2, s[8:11], s18 offen lds
    s_add_u32 s18, s18, s20
    s_add_u32 m0, s22, 8192
    s_nop 0
    buffer_load_dwordx4 v2, s[12:15], s19 offen lds
    s_add_u32 s19, s19, s20
    s_add_u32 m0, s21, 32768
    s_nop 0
    buffer_load_dwordx4 v1, s[4:7], s16 offen sc1 lds
    s_add_u32 s16, s16, s62
    s_add_u32 m0, s21, 33792
    s_nop 0
    buffer_load_dwordx4 v1, s[4:7], s17 offen sc1 lds
    s_add_u32 s17, s17, s62
    s_add_u32 m0, s22, 32768
    s_nop 0
    buffer_load_dwordx4 v2, s[8:11], s18 offen lds
    s_add_u32 s18, s18, s20
    s_add_u32 m0, s22, 40960
    s_nop 0
    buffer_load_dwordx4 v2, s[12:15], s19 offen lds
    s_add_u32 s19, s19, s20
    s_add_u32 m0, s21, 65536
    s_nop 0
    buffer_load_dwordx4 v1, s[4:7], s16 offen sc1 lds
    s_add_u32 s16, s16, s62
    s_add_u32 m0, s21, 66560
    s_nop 0
    buffer_load_dwordx4 v1, s[4:7], s17 offen sc1 lds
    s_add_u32 s17, s17, s62
    s_add_u32 m0, s22, 65536
    s_nop 0
    buffer_load_dwordx4 v2, s[8:11], s18 offen lds
    s_add_u32 s18, s18, s20
    s_add_u32 m0, s22, 73728
    s_nop 0
    buffer_load_dwordx4 v2, s[12:15], s19 offen lds
    s_add_u32 s19, s19, s20
    s_add_u32 m0, s21, 98304
    s_nop 0
    buffer_load_dwordx4 v1, s[4:7], s16 offen sc1 lds
    s_add_u32 s16, s16, s62
    s_add_u32 m0, s21, 99328
    s_nop 0
    buffer_load_dwordx4 v1, s[4:7], s17 offen sc1 lds
    s_add_u32 s17, s17, s62
    s_add_u32 m0, s22, 98304
    s_nop 0
    buffer_load_dwordx4 v2, s[8:11], s18 offen lds
    s_add_u32 s18, s18, s20
    s_add_u32 m0, s22, 106496
    s_nop 0
    buffer_load_dwordx4 v2, s[12:15], s19 offen lds
    s_add_u32 s19, s19, s20
w_adopt:
    s_mov_b32 s48, s32
    s_cmp_eq_u32 s32, 4
    s_cselect_b32 s30, 2, 3
    s_lshl_b32 s30, s26, s30
    s_mul_i32 s30, s30, s43
    s_add_u32 s49, s42, s30
    s_mov_b32 s50, s43
    s_mov_b32 s51, s46
    s_mov_b32 s23, s41
    s_mov_b32 s53, s41
    s_waitcnt vmcnt(0)
    s_barrier
    ds_read_b64_tr_b16 v[64:65], v8 offset:16384
    ds_read_b64_tr_b16 v[66:67], v9 offset:16384
    ds_read_b64_tr_b16 v[68:69], v10 offset:16384
    ds_read_b64_tr_b16 v[70:71], v11 offset:16384
    ds_read_b64_tr_b16 v[72:73], v8 offset:24576
    ds_read_b64_tr_b16 v[74:75], v9 offset:24576
    ds_read_b64_tr_b16 v[76:77], v10 offset:24576
    ds_read_b64_tr_b16 v[78:79], v11 offset:24576
    ds_read_b128 v[32:35], v5 offset:0
    ds_read_b128 v[36:39], v5 offset:1024
    ds_read_b128 v[40:43], v5 offset:2048
    ds_read_b128 v[44:47], v5 offset:3072
    ds_read_b128 v[48:51], v5 offset:4096
    ds_read_b128 v[52:55], v5 offset:5120
    ds_read_b128 v[56:59], v5 offset:6144
    ds_read_b128 v[60:63], v5 offset:7168
    s_waitcnt lgkmcnt(0)
    s_cmp_eq_u32 s48, 4
    s_cbranch_scc1 w_firstH
    s_branch w_first16
w_first4:
    s_waitcnt vmcnt(12)
    s_barrier
    v_mfma_f32_16x16x32_bf16 v[128:131], v[64:67], v[32:35], 0
    s_add_u32 m0, s21, 0
    s_nop 0
    buffer_load_dwordx4 v1, s[4:7], s16 offen sc1 lds
    s_add_u32 s16, s16, s62
    v_mfma_f32_16x16x32_bf16 v[132:135], v[68:71], v[32:35], 0
    ds_read_b64_tr_b16 v[112:113], v8 offset:49152
    v_mfma_f32_16x16x32_bf16 v[136:139], v[72:75], v[32:35], 0
    ds_read_b64_tr_b16 v[114:115], v9 offset:49152
    v_mfma_f32_16x16x32_bf16 v[140:143], v[76:79], v[32:35], 0
    ds_read_b64_tr_b16 v[116:117], v10 offset:49152
    v_mfma_f32_16x16x32_bf16 v[144:147], v[64:67], v[36:39], 0
    s_add_u32 m0, s21, 1024
    s_nop 0
    buffer_load_dwordx4 v1, s[4:7], s17 offen sc1 lds
    s_add_u32 s17, s17, s62
    v_mfma_f32_16x16x32_bf16 v[148:151], v[68:71], v[36:39], 0
    ds_read_b64_tr_b16 v[118:119], v11 offset:49152
    v_mfma_f32_16x16x32_bf16 v[152:155], v[72:75], v[36:39], 0
    ds_read_b64_tr_b16 v[120:121], v8 offset:57344
    v_mfma_f32_16x16x32_bf16 v[156:159], v[76:79], v[36:39], 0
    ds_read_b64_tr_b16 v[122:123], v9 offset:57344
    v_mfma_f32_16x16x32_bf16 v[160:163], v[64:67], v[40:43], 0
    s_add_u32 m0, s22, 0
    s_nop 0
    buffer_load_dwordx4 v2, s[8:11], s18 offen lds
    s_add_u32 s18, s18, s20
    v_mfma_f32_16x16x32_bf16 v[164:167], v[68:71], v[40:43], 0
    ds_read_b64_tr_b16 v[124:125], v10 offset:57344
    v_mfma_f32_16x16x32_bf16 v[168:171], v[72:75], v[40:43], 0
    ds_read_b64_tr_b16 v[126:127], v11 offset:57344
    v_mfma_f32_16x16x32_bf16 v[172:175], v[76:79], v[40:43], 0
    ds_read_b128 v[80:83], v5 offset:32768
    v_mfma_f32_16x16x32_bf16 v[176:179], v[64:67], v[44:47], 0
    s_add_u32 m0, s22, 8192
    s_nop 0
    buffer_load_dwordx4 v2, s[12:15], s19 offen lds
    s_add_u32 s19, s19, s20
    v_mfma_f32_16x16x32_bf16 v[180:183], v[68:71], v[44:47], 0
    ds_read_b128 v[84:87], v5 offset:33792
    v_mfma_f32_16x16x32_bf16 v[184:187], v[72:75], v[44:47], 0
    ds_read_b128 v[88:91], v5 offset:34816
    v_mfma_f32_16x16x32_bf16 v[188:191], v[76:79], v[44:47], 0
    ds_read_b128 v[92:95], v5 offset:35840
    v_mfma_f32_16x16x32_bf16 v[192:195], v[64:67], v[48:51], 0
    ds_read_b128 v[96:99], v5 offset:36864
    v_mfma_f32_16x16x32_bf16 v[196:199], v[68:71], v[48:51], 0
    ds_read_b128 v[100:103], v5 offset:37888
    v_mfma_f32_16x16x32_bf16 v[200:203], v[72:75], v[48:51], 0
    ds_read_b128 v[104:107], v5 offset:38912
    v_mfma_f32_16x16x32_bf16 v[204:207], v[76:79], v[48:51], 0
    ds_read_b128 v[108:111], v5 offset:39936
    v_mfma_f32_16x16x32_bf16 v[208:211], v[64:67], v[52:55], 0
    v_mfma_f32_16x16x32_bf16 v[212:215], v[68:71], v[52:55], 0
    v_mfma_f32_16x16x32_bf16 v[216:219], v[72:75], v[52:55], 0
    v_mfma_f32_16x16x32_bf16 v[220:223], v[76:79], v[52:55], 0
    v_mfma_f32_16x16x32_bf16 v[224:227], v[64:67], v[56:59], 0
    v_mfma_f32_16x16x32_bf16 v[228:231], v[68:71], v[56:59], 0
    v_mfma_f32_16x16x32_bf16 v[232:235], v[72:75], v[56:59], 0
    v_mfma_f32_16x16x32_bf16 v[236:239], v[76:79], v[56:59], 0
    v_mfma_f32_16x16x32_bf16 v[240:243], v[64:67], v[60:63], 0
    v_mfma_f32_16x16x32_bf16 v[244:247], v[68:71], v[60:63], 0
    v_mfma_f32_16x16x32_bf16 v[248:251], v[72:75], v[60:63], 0
    v_mfma_f32_16x16x32_bf16 v[252:255], v[76:79], v[60:63], 0
    s_waitcnt lgkmcnt(0)
w_first4_q1:
    s_waitcnt vmcnt(12)
    s_barrier
    v_mfma_f32_16x16x32_bf16 v[128:131], v[112:115], v[80:83], v[128:131]
    s_add_u32 m0, s21, 32768
    s_nop 0
    buffer_load_dwordx4 v1, s[4:7], s16 offen sc1 lds
    s_add_u32 s16, s16, s62
    v_mfma_f32_16x16x32_bf16 v[132:135], v[116:119], v[80:83], v[132:135]
    ds_read_b64_tr_b16 v[64:65], v12 offset:16384
    v_mfma_f32_16x16x32_bf16 v[136:139], v[120:123], v[80:83], v[136:139]
    ds_read_b64_tr_b16 v[66:67], v13 offset:16384
    v_mfma_f32_16x16x32_bf16 v[140:143], v[124:127], v[80:83], v[140:143]
    ds_read_b64_tr_b16 v[68:69], v14 offset:16384
    v_mfma_f32_16x16x32_bf16 v[144:147], v[112:115], v[84:87], v[144:147]
    s_add_u32 m0, s21, 33792
    s_nop 0
    buffer_load_dwordx4 v1, s[4:7], s17 offen sc1 lds
    s_add_u32 s17, s17, s62
    v_mfma_f32_16x16x32_bf16 v[148:151], v[116:119], v[84:87], v[148:151]
    ds_read_b64_tr_b16 v[70:71], v15 offset:16384
    v_mfma_f32_16x16x32_bf16 v[152:155], v[120:123], v[84:87], v[152:155]
    ds_read_b64_tr_b16 v[72:73], v12 offset:24576
    v_mfma_f32_16x16x32_bf16 v[156:159], v[124:127], v[84:87], v[156:159]
    ds_read_b64_tr_b16 v[74:75], v13 offset:24576
    v_mfma_f32_16x16x32_bf16 v[160:163], v[112:115], v[88:91], v[160:163]
    s_add_u32 m0, s22, 32768
    s_nop 0
    buffer_load_dwordx4 v2, s[8:11], s18 offen lds
    s_add_u32 s18, s18, s20
    v_mfma_f32_16x16x32_bf16 v[164:167], v[116:119], v[88:91], v[164:167]
    ds_read_b64_tr_b16 v[76:77], v14 offset:24576
    v_mfma_f32_16x16x32_bf16 v[168:171], v[120:123], v[88:91], v[168:171]
    ds_read_b64_tr_b16 v[78:79], v15 offset:24576
    v_mfma_f32_16x16x32_bf16 v[172:175], v[124:127], v[88:91], v[172:175]
    ds_read_b128 v[32:35], v6 offset:0
    v_mfma_f32_16x16x32_bf16 v[176:179], v[112:115], v[92:95], v[176:179]
    s_add_u32 m0, s22, 40960
    s_nop 0
    buffer_load_dwordx4 v2, s[12:15], s19 offen lds
    s_add_u32 s19, s19, s20
    v_mfma_f32_16x16x32_bf16 v[180:183], v[116:119], v[92:95], v[180:183]
    ds_read_b128 v[36:39], v6 offset:1024
    v_mfma_f32_16x16x32_bf16 v[184:187], v[120:123], v[92:95], v[184:187]
    ds_read_b128 v[40:43], v6 offset:2048
    v_mfma_f32_16x16x32_bf16 v[188:191], v[124:127], v[92:95], v[188:191]
    ds_read_b128 v[44:47], v6 offset:3072
    v_mfma_f32_16x16x32_bf16 v[192:195], v[112:115], v[96:99], v[192:195]
    ds_read_b128 v[48:51], v6 offset:4096
    v_mfma_f32_16x16x32_bf16 v[196:199], v[116:119], v[96:99], v[196:199]
    ds_read_b128 v[52:55], v6 offset:5120
    v_mfma_f32_16x16x32_bf16 v[200:203], v[120:123], v[96:99], v[200:203]
    ds_read_b128 v[56:59], v6 offset:6144
    v_mfma_f32_16x16x32_bf16 v[204:207], v[124:127], v[96:99], v[204:207]
    ds_read_b128 v[60:63], v6 offset:7168
    v_mfma_f32_16x16x32_bf16 v[208:211], v[112:115], v[100:103], v[208:211]
    v_mfma_f32_16x16x32_bf16 v[212:215], v[116:119], v[100:103], v[212:215]
    v_mfma_f32_16x16x32_bf16 v[216:219], v[120:123], v[100:103], v[216:219]
    v_mfma_f32_16x16x32_bf16 v[220:223], v[124:127], v[100:103], v[220:223]
    v_mfma_f32_16x16x32_bf16 v[224:227], v[112:115], v[104:107], v[224:227]
    v_mfma_f32_16x16x32_bf16 v[228:231], v[116:119], v[104:107], v[228:231]
    v_mfma_f32_16x16x32_bf16 v[232:235], v[120:123], v[104:107], v[232:235]
    v_mfma_f32_16x16x32_bf16 v[236:239], v[124:127], v[104:107], v[236:239]
    v_mfma_f32_16x16x32_bf16 v[240:243], v[112:115], v[108:111], v[240:243]
    v_mfma_f32_16x16x32_bf16 v[244:247], v[116:119], v[108:111], v[244:247]
    v_mfma_f32_16x16x32_bf16 v[248:251], v[120:123], v[108:111], v[248:251]
    v_mfma_f32_16x16x32_bf16 v[252:255], v[124:127], v[108:111], v[252:255]
    s_waitcnt lgkmcnt(0)
    s_waitcnt vmcnt(12)
    s_barrier
    v_mfma_f32_16x16x32_bf16 v[128:131], v[64:67], v[32:35], v[128:131]
    s_add_u32 m0, s21, 65536
    s_nop 0
    buffer_load_dwordx4 v1, s[4:7], s16 offen sc1 lds
    s_add_u32 s16, s16, s62
    v_mfma_f32_16x16x32_bf16 v[132:135], v[68:71], v[32:35], v[132:135]
    ds_read_b64_tr_b16 v[112:113], v12 offset:49152
    v_mfma_f32_16x16x32_bf16 v[136:139], v[72:75], v[32:35], v[136:139]
    ds_read_b64_tr_b16 v[114:115], v13 offset:49152
    v_mfma_f32_16x16x32_bf16 v[140:143], v[76:79], v[32:35], v[140:143]
    ds_read_b64_tr_b16 v[116:117], v14 offset:49152
    v_mfma_f32_16x16x32_bf16 v[144:147], v[64:67], v[36:39], v[144:147]
    s_add_u32 m0, s21, 66560
    s_nop 0
    buffer_load_dwordx4 v1, s[4:7], s17 offen sc1 lds
    s_add_u32 s17, s17, s62
    v_mfma_f32_16x16x32_bf16 v[148:151], v[68:71], v[36:39], v[148:151]
    ds_read_b64_tr_b16 v[118:119], v15 offset:49152
    v_mfma_f32_16x16x32_bf16 v[152:155], v[72:75], v[36:39], v[152:155]
    ds_read_b64_tr_b16 v[120:121], v12 offset:57344
    v_mfma_f32_16x16x32_bf16 v[156:159], v[76:79], v[36:39], v[156:159]
    ds_read_b64_tr_b16 v[122:123], v13 offset:57344
    v_mfma_f32_16x16x32_bf16 v[160:163], v[64:67], v[40:43], v[160:163]
    s_add_u32 m0, s22, 65536
    s_nop 0
    buffer_load_dwordx4 v2, s[8:11], s18 offen lds
    s_add_u32 s18, s18, s20
    v_mfma_f32_16x16x32_bf16 v[164:167], v[68:71], v[40:43], v[164:167]
    ds_read_b64_tr_b16 v[124:125], v14 offset:57344
    v_mfma_f32_16x16x32_bf16 v[168:171], v[72:75], v[40:43], v[168:171]
    ds_read_b64_tr_b16 v[126:127], v15 offset:57344
    v_mfma_f32_16x16x32_bf16 v[172:175], v[76:79], v[40:43], v[172:175]
    ds_read_b128 v[80:83], v6 offset:32768
    v_mfma_f32_16x16x32_bf16 v[176:179], v[64:67], v[44:47], v[176:179]
    s_add_u32 m0, s22, 73728
    s_nop 0
    buffer_load_dwordx4 v2, s[12:15], s19 offen lds
    s_add_u32 s19, s19, s20
    v_mfma_f32_16x16x32_bf16 v[180:183], v[68:71], v[44:47], v[180:183]
    ds_read_b128 v[84:87], v6 offset:33792
    v_mfma_f32_16x16x32_bf16 v[184:187], v[72:75], v[44:47], v[184:187]
    ds_read_b128 v[88:91], v6 offset:34816
    v_mfma_f32_16x16x32_bf16 v[188:191], v[76:79], v[44:47], v[188:191]
    ds_read_b128 v[92:95], v6 offset:35840
    v_mfma_f32_16x16x32_bf16 v[192:195], v[64:67], v[48:51], v[192:195]
    ds_read_b128 v[96:99], v6 offset:36864
    v_mfma_f32_16x16x32_bf16 v[196:199], v[68:71], v[48:51], v[196:199]
    ds_read_b128 v[100:103], v6 offset:37888
    v_mfma_f32_16x16x32_bf16 v[200:203], v[72:75], v[48:51], v[200:203]
    ds_read_b128 v[104:107], v6 offset:38912
    v_mfma_f32_16x16x32_bf16 v[204:207], v[76:79], v[48:51], v[204:207]
    ds_read_b128 v[108:111], v6 offset:39936
    v_mfma_f32_16x16x32_bf16 v[208:211], v[64:67], v[52:55], v[208:211]
    v_mfma_f32_16x16x32_bf16 v[212:215], v[68:71], v[52:55], v[212:215]
    v_mfma_f32_16x16x32_bf16 v[216:219], v[72:75], v[52:55], v[216:219]
    v_mfma_f32_16x16x32_bf16 v[220:223], v[76:79], v[52:55], v[220:223]
    v_mfma_f32_16x16x32_bf16 v[224:227], v[64:67], v[56:59], v[224:227]
    v_mfma_f32_16x16x32_bf16 v[228:231], v[68:71], v[56:59], v[228:231]
    v_mfma_f32_16x16x32_bf16 v[232:235], v[72:75], v[56:59], v[232:235]
    v_mfma_f32_16x16x32_bf16 v[236:239], v[76:79], v[56:59], v[236:239]
    v_mfma_f32_16x16x32_bf16 v[240:243], v[64:67], v[60:63], v[240:243]
    v_mfma_f32_16x16x32_bf16 v[244:247], v[68:71], v[60:63], v[244:247]
    v_mfma_f32_16x16x32_bf16 v[248:251], v[72:75], v[60:63], v[248:251]
    v_mfma_f32_16x16x32_bf16 v[252:255], v[76:79], v[60:63], v[252:255]
    s_waitcnt lgkmcnt(0)
    s_waitcnt vmcnt(8)
    s_barrier
    s_cmp_eq_u32 s28, 0
    s_cbranch_scc1 sig_2
    s_cmp_lg_u32 s3, 0
    s_cbranch_scc1 sig_2
    s_and_b32 s57, s28, 3
    v_mov_b32 v24, s57
    s_bfe_u32 s57, s28, 0x20002
    v_mov_b32 v25, s57
    s_andn2_b32 s28, s28, 15
    s_mov_b64 exec, 1
    buffer_atomic_add_x2 v[24:25], v17, s[4:7], s28 offen sc1
    s_mov_b64 exec, -1
sig_2:
    s_mov_b32 s28, 0
    v_mfma_f32_16x16x32_bf16 v[128:131], v[112:115], v[80:83], v[128:131]
    s_add_u32 m0, s21, 98304
    s_nop 0
    buffer_load_dwordx4 v1, s[4:7], s16 offen sc1 lds
    s_add_u32 s16, s16, s62
    v_mfma_f32_16x16x32_bf16 v[132:135], v[116:119], v[80:83], v[132:135]
    ds_read_b64_tr_b16 v[64:65], v8 offset:16384
    v_mfma_f32_16x16x32_bf16 v[136:139], v[120:123], v[80:83], v[136:139]
    ds_read_b64_tr_b16 v[66:67], v9 offset:16384
    v_mfma_f32_16x16x32_bf16 v[140:143], v[124:127], v[80:83], v[140:143]
    ds_read_b64_tr_b16 v[68:69], v10 offset:16384
    v_mfma_f32_16x16x32_bf16 v[144:147], v[112:115], v[84:87], v[144:147]
    s_add_u32 m0, s21, 99328
    s_nop 0
    buffer_load_dwordx4 v1, s[4:7], s17 offen sc1 lds
    s_add_u32 s17, s17, s62
    v_mfma_f32_16x16x32_bf16 v[148:151], v[116:119], v[84:87], v[148:151]
    ds_read_b64_tr_b16 v[70:71], v11 offset:16384
    v_mfma_f32_16x16x32_bf16 v[152:155], v[120:123], v[84:87], v[152:155]
    ds_read_b64_tr_b16 v[72:73], v8 offset:24576
    v_mfma_f32_16x16x32_bf16 v[156:159], v[124:127], v[84:87], v[156:159]
    ds_read_b64_tr_b16 v[74:75], v9 offset:24576
    v_mfma_f32_16x16x32_bf16 v[160:163], v[112:115], v[88:91], v[160:163]
    s_add_u32 m0, s22, 98304
    s_nop 0
    buffer_load_dwordx4 v2, s[8:11], s18 offen lds
    s_add_u32 s18, s18, s20
    v_mfma_f32_16x16x32_bf16 v[164:167], v[116:119], v[88:91], v[164:167]
    ds_read_b64_tr_b16 v[76:77], v10 offset:24576
    v_mfma_f32_16x16x32_bf16 v[168:171], v[120:123], v[88:91], v[168:171]
    ds_read_b64_tr_b16 v[78:79], v11 offset:24576
    v_mfma_f32_16x16x32_bf16 v[172:175], v[124:127], v[88:91], v[172:175]
    ds_read_b128 v[32:35], v5 offset:0
    v_mfma_f32_16x16x32_bf16 v[176:179], v[112:115], v[92:95], v[176:179]
    s_add_u32 m0, s22, 106496
    s_nop 0
    buffer_load_dwordx4 v2, s[12:15], s19 offen lds
    s_add_u32 s19, s19, s20
    v_mfma_f32_16x16x32_bf16 v[180:183], v[116:119], v[92:95], v[180:183]
    ds_read_b128 v[36:39], v5 offset:1024
    v_mfma_f32_16x16x32_bf16 v[184:187], v[120:123], v[92:95], v[184:187]
    ds_read_b128 v[40:43], v5 offset:2048
    v_mfma_f32_16x16x32_bf16 v[188:191], v[124:127], v[92:95], v[188:191]
    ds_read_b128 v[44:47], v5 offset:3072
    v_mfma_f32_16x16x32_bf16 v[192:195], v[112:115], v[96:99], v[192:195]
    ds_read_b128 v[48:51], v5 offset:4096
    v_mfma_f32_16x16x32_bf16 v[196:199], v[116:119], v[96:99], v[196:199]
    ds_read_b128 v[52:55], v5 offset:5120
    v_mfma_f32_16x16x32_bf16 v[200:203], v[120:123], v[96:99], v[200:203]
    ds_read_b128 v[56:59], v5 offset:6144
    v_mfma_f32_16x16x32_bf16 v[204:207], v[124:127], v[96:99], v[204:207]
    ds_read_b128 v[60:63], v5 offset:7168
    v_mfma_f32_16x16x32_bf16 v[208:211], v[112:115], v[100:103], v[208:211]
    v_mfma_f32_16x16x32_bf16 v[212:215], v[116:119], v[100:103], v[212:215]
    v_mfma_f32_16x16x32_bf16 v[216:219], v[120:123], v[100:103], v[216:219]
    v_mfma_f32_16x16x32_bf16 v[220:223], v[124:127], v[100:103], v[220:223]
    v_mfma_f32_16x16x32_bf16 v[224:227], v[112:115], v[104:107], v[224:227]
    v_mfma_f32_16x16x32_bf16 v[228:231], v[116:119], v[104:107], v[228:231]
    v_mfma_f32_16x16x32_bf16 v[232:235], v[120:123], v[104:107], v[232:235]
    v_mfma_f32_16x16x32_bf16 v[236:239], v[124:127], v[104:107], v[236:239]
    v_mfma_f32_16x16x32_bf16 v[240:243], v[112:115], v[108:111], v[240:243]
    v_mfma_f32_16x16x32_bf16 v[244:247], v[116:119], v[108:111], v[244:247]
    v_mfma_f32_16x16x32_bf16 v[248:251], v[120:123], v[108:111], v[248:251]
    v_mfma_f32_16x16x32_bf16 v[252:255], v[124:127], v[108:111], v[252:255]
    s_waitcnt lgkmcnt(0)
    s_branch w_loop_chk
w_first8:
    s_waitcnt vmcnt(16)
    s_barrier
    v_mfma_f32_16x16x32_bf16 v[128:131], v[64:67], v[32:35], 0
    s_add_u32 m0, s21, 0
    s_nop 0
    buffer_load_dwordx4 v1, s[4:7], s16 offen sc1 lds
    s_add_u32 s16, s16, s62
    v_mfma_f32_16x16x32_bf16 v[132:135], v[68:71], v[32:35], 0
    ds_read_b64_tr_b16 v[112:113], v8 offset:49152
    v_mfma_f32_16x16x32_bf16 v[136:139], v[72:75], v[32:35], 0
    ds_read_b64_tr_b16 v[114:115], v9 offset:49152
    v_mfma_f32_16x16x32_bf16 v[140:143], v[76:79], v[32:35], 0
    ds_read_b64_tr_b16 v[116:117], v10 offset:49152
    v_mfma_f32_16x16x32_bf16 v[144:147], v[64:67], v[36:39], 0
    s_add_u32 m0, s21, 1024
    s_nop 0
    buffer_load_dwordx4 v1, s[4:7], s17 offen sc1 lds
    s_add_u32 s17, s17, s62
    v_mfma_f32_16x16x32_bf16 v[148:151], v[68:71], v[36:39], 0
    ds_read_b64_tr_b16 v[118:119], v11 offset:49152
    v_mfma_f32_16x16x32_bf16 v[152:155], v[72:75], v[36:39], 0
    ds_read_b64_tr_b16 v[120:121], v8 offset:57344
    v_mfma_f32_16x16x32_bf16 v[156:159], v[76:79], v[36:39], 0
    ds_read_b64_tr_b16 v[122:123], v9 offset:57344
    v_mfma_f32_16x16x32_bf16 v[160:163], v[64:67], v[40:43], 0
    s_add_u32 m0, s22, 0
    s_nop 0
    buffer_load_dwordx4 v2, s[8:11], s18 offen lds
    s_add_u32 s18, s18, s20
    v_mfma_f32_16x16x32_bf16 v[164:167], v[68:71], v[40:43], 0
    ds_read_b64_tr_b16 v[124:125], v10 offset:57344
    v_mfma_f32_16x16x32_bf16 v[168:171], v[72:75], v[40:43], 0
    ds_read_b64_tr_b16 v[126:127], v11 offset:57344
    v_mfma_f32_16x16x32_bf16 v[172:175], v[76:79], v[40:43], 0
    ds_read_b128 v[80:83], v5 offset:32768
    v_mfma_f32_16x16x32_bf16 v[176:179], v[64:67], v[44:47], 0
    s_add_u32 m0, s22, 8192
    s_nop 0
    buffer_load_dwordx4 v2, s[12:15], s19 offen lds
    s_add_u32 s19, s19, s20
    v_mfma_f32_16x16x32_bf16 v[180:183], v[68:71], v[44:47], 0
    ds_read_b128 v[84:87], v5 offset:33792
    v_mfma_f32_16x16x32_bf16 v[184:187], v[72:75], v[44:47], 0
    ds_read_b128 v[88:91], v5 offset:34816
    v_mfma_f32_16x16x32_bf16 v[188:191], v[76:79], v[44:47], 0
    ds_read_b128 v[92:95], v5 offset:35840
    v_mfma_f32_16x16x32_bf16 v[192:195], v[64:67], v[48:51], 0
    ds_read_b128 v[96:99], v5 offset:36864
    v_mfma_f32_16x16x32_bf16 v[196:199], v[68:71], v[48:51], 0
    ds_read_b128 v[100:103], v5 offset:37888
    v_mfma_f32_16x16x32_bf16 v[200:203], v[72:75], v[48:51], 0
    ds_read_b128 v[104:107], v5 offset:38912
    v_mfma_f32_16x16x32_bf16 v[204:207], v[76:79], v[48:51], 0
    ds_read_b128 v[108:111], v5 offset:39936
    v_mfma_f32_16x16x32_bf16 v[208:211], v[64:67], v[52:55], 0
    v_mfma_f32_16x16x32_bf16 v[212:215], v[68:71], v[52:55], 0
    v_mfma_f32_16x16x32_bf16 v[216:219], v[72:75], v[52:55], 0
    v_mfma_f32_16x16x32_bf16 v[220:223], v[76:79], v[52:55], 0
    v_mfma_f32_16x16x32_bf16 v[224:227], v[64:67], v[56:59], 0
    v_mfma_f32_16x16x32_bf16 v[228:231], v[68:71], v[56:59], 0
    v_mfma_f32_16x16x32_bf16 v[232:235], v[72:75], v[56:59], 0
    v_mfma_f32_16x16x32_bf16 v[236:239], v[76:79], v[56:59], 0
    v_mfma_f32_16x16x32_bf16 v[240:243], v[64:67], v[60:63], 0
    v_mfma_f32_16x16x32_bf16 v[244:247], v[68:71], v[60:63], 0
    v_mfma_f32_16x16x32_bf16 v[248:251], v[72:75], v[60:63], 0
    v_mfma_f32_16x16x32_bf16 v[252:255], v[76:79], v[60:63], 0
    s_waitcnt lgkmcnt(0)
w_first8_q1:
    s_waitcnt vmcnt(16)
    s_barrier
    v_mfma_f32_16x16x32_bf16 v[128:131], v[112:115], v[80:83], v[128:131]
    s_add_u32 m0, s21, 32768
    s_nop 0
    buffer_load_dwordx4 v1, s[4:7], s16 offen sc1 lds
    s_add_u32 s16, s16, s62
    v_mfma_f32_16x16x32_bf16 v[132:135], v[116:119], v[80:83], v[132:135]
    ds_read_b64_tr_b16 v[64:65], v12 offset:16384
    v_mfma_f32_16x16x32_bf16 v[136:139], v[120:123], v[80:83], v[136:139]
    ds_read_b64_tr_b16 v[66:67], v13 offset:16384
    v_mfma_f32_16x16x32_bf16 v[140:143], v[124:127], v[80:83], v[140:143]
    ds_read_b64_tr_b16 v[68:69], v14 offset:16384
    v_mfma_f32_16x16x32_bf16 v[144:147], v[112:115], v[84:87], v[144:147]
    s_add_u32 m0, s21, 33792
    s_nop 0
    buffer_load_dwordx4 v1, s[4:7], s17 offen sc1 lds
    s_add_u32 s17, s17, s62
    v_mfma_f32_16x16x32_bf16 v[148:151], v[116:119], v[84:87], v[148:151]
    ds_read_b64_tr_b16 v[70:71], v15 offset:16384
    v_mfma_f32_16x16x32_bf16 v[152:155], v[120:123], v[84:87], v[152:155]
    ds_read_b64_tr_b16 v[72:73], v12 offset:24576
    v_mfma_f32_16x16x32_bf16 v[156:159], v[124:127], v[84:87], v[156:159]
    ds_read_b64_tr_b16 v[74:75], v13 offset:24576
    v_mfma_f32_16x16x32_bf16 v[160:163], v[112:115], v[88:91], v[160:163]
    s_add_u32 m0, s22, 32768
    s_nop 0
    buffer_load_dwordx4 v2, s[8:11], s18 offen lds
    s_add_u32 s18, s18, s20
    v_mfma_f32_16x16x32_bf16 v[164:167], v[116:119], v[88:91], v[164:167]
    ds_read_b64_tr_b16 v[76:77], v14 offset:24576
    v_mfma_f32_16x16x32_bf16 v[168:171], v[120:123], v[88:91], v[168:171]
    ds_read_b64_tr_b16 v[78:79], v15 offset:24576
    v_mfma_f32_16x16x32_bf16 v[172:175], v[124:127], v[88:91], v[172:175]
    ds_read_b128 v[32:35], v6 offset:0
    v_mfma_f32_16x16x32_bf16 v[176:179], v[112:115], v[92:95], v[176:179]
    s_add_u32 m0, s22, 40960
    s_nop 0
    buffer_load_dwordx4 v2, s[12:15], s19 offen lds
    s_add_u32 s19, s19, s20
    v_mfma_f32_16x16x32_bf16 v[180:183], v[116:119], v[92:95], v[180:183]
    ds_read_b128 v[36:39], v6 offset:1024
    v_mfma_f32_16x16x32_bf16 v[184:187], v[120:123], v[92:95], v[184:187]
    ds_read_b128 v[40:43], v6 offset:2048
    v_mfma_f32_16x16x32_bf16 v[188:191], v[124:127], v[92:95], v[188:191]
    ds_read_b128 v[44:47], v6 offset:3072
    v_mfma_f32_16x16x32_bf16 v[192:195], v[112:115], v[96:99], v[192:195]
    ds_read_b128 v[48:51], v6 offset:4096
    v_mfma_f32_16x16x32_bf16 v[196:199], v[116:119], v[96:99], v[196:199]
    ds_read_b128 v[52:55], v6 offset:5120
    v_mfma_f32_16x16x32_bf16 v[200:203], v[120:123], v[96:99], v[200:203]
    ds_read_b128 v[56:59], v6 offset:6144
    v_mfma_f32_16x16x32_bf16 v[204:207], v[124:127], v[96:99], v[204:207]
    ds_read_b128 v[60:63], v6 offset:7168
    v_mfma_f32_16x16x32_bf16 v[208:211], v[112:115], v[100:103], v[208:211]
    v_mfma_f32_16x16x32_bf16 v[212:215], v[116:119], v[100:103], v[212:215]
    v_mfma_f32_16x16x32_bf16 v[216:219], v[120:123], v[100:103], v[216:219]
    v_mfma_f32_16x16x32_bf16 v[220:223], v[124:127], v[100:103], v[220:223]
    v_mfma_f32_16x16x32_bf16 v[224:227], v[112:115], v[104:107], v[224:227]
    v_mfma_f32_16x16x32_bf16 v[228:231], v[116:119], v[104:107], v[228:231]
    v_mfma_f32_16x16x32_bf16 v[232:235], v[120:123], v[104:107], v[232:235]
    v_mfma_f32_16x16x32_bf16 v[236:239], v[124:127], v[104:107], v[236:239]
    v_mfma_f32_16x16x32_bf16 v[240:243], v[112:115], v[108:111], v[240:243]
    v_mfma_f32_16x16x32_bf16 v[244:247], v[116:119], v[108:111], v[244:247]
    v_mfma_f32_16x16x32_bf16 v[248:251], v[120:123], v[108:111], v[248:251]
    v_mfma_f32_16x16x32_bf16 v[252:255], v[124:127], v[108:111], v[252:255]
    s_waitcnt lgkmcnt(0)
    s_waitcnt vmcnt(16)
    s_barrier
    v_mfma_f32_16x16x32_bf16 v[128:131], v[64:67], v[32:35], v[128:131]
    s_add_u32 m0, s21, 65536
    s_nop 0
    buffer_load_dwordx4 v1, s[4:7], s16 offen sc1 lds
    s_add_u32 s16, s16, s62
    v_mfma_f32_16x16x32_bf16 v[132:135], v[68:71], v[32:35], v[132:135]
    ds_read_b64_tr_b16 v[112:113], v12 offset:49152
    v_mfma_f32_16x16x32_bf16 v[136:139], v[72:75], v[32:35], v[136:139]
    ds_read_b64_tr_b16 v[114:115], v13 offset:49152
    v_mfma_f32_16x16x32_bf16 v[140:143], v[76:79], v[32:35], v[140:143]
    ds_read_b64_tr_b16 v[116:117], v14 offset:49152
    v_mfma_f32_16x16x32_bf16 v[144:147], v[64:67], v[36:39], v[144:147]
    s_add_u32 m0, s21, 66560
    s_nop 0
    buffer_load_dwordx4 v1, s[4:7], s17 offen sc1 lds
    s_add_u32 s17, s17, s62
    v_mfma_f32_16x16x32_bf16 v[148:151], v[68:71], v[36:39], v[148:151]
    ds_read_b64_tr_b16 v[118:119], v15 offset:49152
    v_mfma_f32_16x16x32_bf16 v[152:155], v[72:75], v[36:39], v[152:155]
    ds_read_b64_tr_b16 v[120:121], v12 offset:57344
    v_mfma_f32_16x16x32_bf16 v[156:159], v[76:79], v[36:39], v[156:159]
    ds_read_b64_tr_b16 v[122:123], v13 offset:57344
    v_mfma_f32_16x16x32_bf16 v[160:163], v[64:67], v[40:43], v[160:163]
    s_add_u32 m0, s22, 65536
    s_nop 0
    buffer_load_dwordx4 v2, s[8:11], s18 offen lds
    s_add_u32 s18, s18, s20
    v_mfma_f32_16x16x32_bf16 v[164:167], v[68:71], v[40:43], v[164:167]
    ds_read_b64_tr_b16 v[124:125], v14 offset:57344
    v_mfma_f32_16x16x32_bf16 v[168:171], v[72:75], v[40:43], v[168:171]
    ds_read_b64_tr_b16 v[126:127], v15 offset:57344
    v_mfma_f32_16x16x32_bf16 v[172:175], v[76:79], v[40:43], v[172:175]
    ds_read_b128 v[80:83], v6 offset:32768
    v_mfma_f32_16x16x32_bf16 v[176:179], v[64:67], v[44:47], v[176:179]
    s_add_u32 m0, s22, 73728
    s_nop 0
    buffer_load_dwordx4 v2, s[12:15], s19 offen lds
    s_add_u32 s19, s19, s20
    v_mfma_f32_16x16x32_bf16 v[180:183], v[68:71], v[44:47], v[180:183]
    ds_read_b128 v[84:87], v6 offset:33792
    v_mfma_f32_16x16x32_bf16 v[184:187], v[72:75], v[44:47], v[184:187]
    ds_read_b128 v[88:91], v6 offset:34816
    v_mfma_f32_16x16x32_bf16 v[188:191], v[76:79], v[44:47], v[188:191]
    ds_read_b128 v[92:95], v6 offset:35840
    v_mfma_f32_16x16x32_bf16 v[192:195], v[64:67], v[48:51], v[192:195]
    ds_read_b128 v[96:99], v6 offset:36864
    v_mfma_f32_16x16x32_bf16 v[196:199], v[68:71], v[48:51], v[196:199]
    ds_read_b128 v[100:103], v6 offset:37888
    v_mfma_f32_16x16x32_bf16 v[200:203], v[72:75], v[48:51], v[200:203]
    ds_read_b128 v[104:107], v6 offset:38912
    v_mfma_f32_16x16x32_bf16 v[204:207], v[76:79], v[48:51], v[204:207]
    ds_read_b128 v[108:111], v6 offset:39936
    v_mfma_f32_16x16x32_bf16 v[208:211], v[64:67], v[52:55], v[208:211]
    v_mfma_f32_16x16x32_bf16 v[212:215], v[68:71], v[52:55], v[212:215]
    v_mfma_f32_16x16x32_bf16 v[216:219], v[72:75], v[52:55], v[216:219]
    v_mfma_f32_16x16x32_bf16 v[220:223], v[76:79], v[52:55], v[220:223]
    v_mfma_f32_16x16x32_bf16 v[224:227], v[64:67], v[56:59], v[224:227]
    v_mfma_f32_16x16x32_bf16 v[228:231], v[68:71], v[56:59], v[228:231]
    v_mfma_f32_16x16x32_bf16 v[232:235], v[72:75], v[56:59], v[232:235]
    v_mfma_f32_16x16x32_bf16 v[236:239], v[76:79], v[56:59], v[236:239]
    v_mfma_f32_16x16x32_bf16 v[240:243], v[64:67], v[60:63], v[240:243]
    v_mfma_f32_16x16x32_bf16 v[244:247], v[68:71], v[60:63], v[244:247]
    v_mfma_f32_16x16x32_bf16 v[248:251], v[72:75], v[60:63], v[248:251]
    v_mfma_f32_16x16x32_bf16 v[252:255], v[76:79], v[60:63], v[252:255]
    s_waitcnt lgkmcnt(0)
    s_waitcnt vmcnt(8)
    s_barrier
    s_cmp_eq_u32 s28, 0
    s_cbranch_scc1 sig_3
    s_cmp_lg_u32 s3, 0
    s_cbranch_scc1 sig_3
    s_and_b32 s57, s28, 3
    v_mov_b32 v24, s57
    s_bfe_u32 s57, s28, 0x20002
    v_mov_b32 v25, s57
    s_andn2_b32 s28, s28, 15
    s_mov_b64 exec, 1
    buffer_atomic_add_x2 v[24:25], v17, s[4:7], s28 offen sc1
    s_mov_b64 exec, -1
sig_3:
    s_mov_b32 s28, 0
    v_mfma_f32_16x16x32_bf16 v[128:131], v[112:115], v[80:83], v[128:131]
    s_add_u32 m0, s21, 98304
    s_nop 0
    buffer_load_dwordx4 v1, s[4:7], s16 offen sc1 lds
    s_add_u32 s16, s16, s62
    v_mfma_f32_16x16x32_bf16 v[132:135], v[116:119], v[80:83], v[132:135]
    ds_read_b64_tr_b16 v[64:65], v8 offset:16384
    v_mfma_f32_16x16x32_bf16 v[136:139], v[120:123], v[80:83], v[136:139]
    ds_read_b64_tr_b16 v[66:67], v9 offset:16384
    v_mfma_f32_16x16x32_bf16 v[140:143], v[124:127], v[80:83], v[140:143]
    ds_read_b64_tr_b16 v[68:69], v10 offset:16384
    v_mfma_f32_16x16x32_bf16 v[144:147], v[112:115], v[84:87], v[144:147]
    s_add_u32 m0, s21, 99328
    s_nop 0
    buffer_load_dwordx4 v1, s[4:7], s17 offen sc1 lds
    s_add_u32 s17, s17, s62
    v_mfma_f32_16x16x32_bf16 v[148:151], v[116:119], v[84:87], v[148:151]
    ds_read_b64_tr_b16 v[70:71], v11 offset:16384
    v_mfma_f32_16x16x32_bf16 v[152:155], v[120:123], v[84:87], v[152:155]
    ds_read_b64_tr_b16 v[72:73], v8 offset:24576
    v_mfma_f32_16x16x32_bf16 v[156:159], v[124:127], v[84:87], v[156:159]
    ds_read_b64_tr_b16 v[74:75], v9 offset:24576
    v_mfma_f32_16x16x32_bf16 v[160:163], v[112:115], v[88:91], v[160:163]
    s_add_u32 m0, s22, 98304
    s_nop 0
    buffer_load_dwordx4 v2, s[8:11], s18 offen lds
    s_add_u32 s18, s18, s20
    v_mfma_f32_16x16x32_bf16 v[164:167], v[116:119], v[88:91], v[164:167]
    ds_read_b64_tr_b16 v[76:77], v10 offset:24576
    v_mfma_f32_16x16x32_bf16 v[168:171], v[120:123], v[88:91], v[168:171]
    ds_read_b64_tr_b16 v[78:79], v11 offset:24576
    v_mfma_f32_16x16x32_bf16 v[172:175], v[124:127], v[88:91], v[172:175]
    ds_read_b128 v[32:35], v5 offset:0
    v_mfma_f32_16x16x32_bf16 v[176:179], v[112:115], v[92:95], v[176:179]
    s_add_u32 m0, s22, 106496
    s_nop 0
    buffer_load_dwordx4 v2, s[12:15], s19 offen lds
    s_add_u32 s19, s19, s20
    v_mfma_f32_16x16x32_bf16 v[180:183], v[116:119], v[92:95], v[180:183]
    ds_read_b128 v[36:39], v5 offset:1024
    v_mfma_f32_16x16x32_bf16 v[184:187], v[120:123], v[92:95], v[184:187]
    ds_read_b128 v[40:43], v5 offset:2048
    v_mfma_f32_16x16x32_bf16 v[188:191], v[124:127], v[92:95], v[188:191]
    ds_read_b128 v[44:47], v5 offset:3072
    v_mfma_f32_16x16x32_bf16 v[192:195], v[112:115], v[96:99], v[192:195]
    ds_read_b128 v[48:51], v5 offset:4096
    v_mfma_f32_16x16x32_bf16 v[196:199], v[116:119], v[96:99], v[196:199]
    ds_read_b128 v[52:55], v5 offset:5120
    v_mfma_f32_16x16x32_bf16 v[200:203], v[120:123], v[96:99], v[200:203]
    ds_read_b128 v[56:59], v5 offset:6144
    v_mfma_f32_16x16x32_bf16 v[204:207], v[124:127], v[96:99], v[204:207]
    ds_read_b128 v[60:63], v5 offset:7168
    v_mfma_f32_16x16x32_bf16 v[208:211], v[112:115], v[100:103], v[208:211]
    v_mfma_f32_16x16x32_bf16 v[212:215], v[116:119], v[100:103], v[212:215]
    v_mfma_f32_16x16x32_bf16 v[216:219], v[120:123], v[100:103], v[216:219]
    v_mfma_f32_16x16x32_bf16 v[220:223], v[124:127], v[100:103], v[220:223]
    v_mfma_f32_16x16x32_bf16 v[224:227], v[112:115], v[104:107], v[224:227]
    v_mfma_f32_16x16x32_bf16 v[228:231], v[116:119], v[104:107], v[228:231]
    v_mfma_f32_16x16x32_bf16 v[232:235], v[120:123], v[104:107], v[232:235]
    v_mfma_f32_16x16x32_bf16 v[236:239], v[124:127], v[104:107], v[236:239]
    v_mfma_f32_16x16x32_bf16 v[240:243], v[112:115], v[108:111], v[240:243]
    v_mfma_f32_16x16x32_bf16 v[244:247], v[116:119], v[108:111], v[244:247]
    v_mfma_f32_16x16x32_bf16 v[248:251], v[120:123], v[108:111], v[248:251]
    v_mfma_f32_16x16x32_bf16 v[252:255], v[124:127], v[108:111], v[252:255]
    s_waitcnt lgkmcnt(0)
    s_branch w_loop_chk
w_first16:
    s_waitcnt vmcnt(24)
    s_barrier
    v_mfma_f32_16x16x32_bf16 v[128:131], v[64:67], v[32:35], 0
    s_add_u32 m0, s21, 0
    s_nop 0
    buffer_load_dwordx4 v1, s[4:7], s16 offen sc1 lds
    s_add_u32 s16, s16, s62
    v_mfma_f32_16x16x32_bf16 v[132:135], v[68:71], v[32:35], 0
    ds_read_b64_tr_b16 v[112:113], v8 offset:49152
    v_mfma_f32_16x16x32_bf16 v[136:139], v[72:75], v[32:35], 0
    ds_read_b64_tr_b16 v[114:115], v9 offset:49152
    v_mfma_f32_16x16x32_bf16 v[140:143], v[76:79], v[32:35], 0
    ds_read_b64_tr_b16 v[116:117], v10 offset:49152
    v_mfma_f32_16x16x32_bf16 v[144:147], v[64:67], v[36:39], 0
    s_add_u32 m0, s21, 1024
    s_nop 0
    buffer_load_dwordx4 v1, s[4:7], s17 offen sc1 lds
    s_add_u32 s17, s17, s62
    v_mfma_f32_16x16x32_bf16 v[148:151], v[68:71], v[36:39], 0
    ds_read_b64_tr_b16 v[118:119], v11 offset:49152
    v_mfma_f32_16x16x32_bf16 v[152:155], v[72:75], v[36:39], 0
    ds_read_b64_tr_b16 v[120:121], v8 offset:57344
    v_mfma_f32_16x16x32_bf16 v[156:159], v[76:79], v[36:39], 0
    ds_read_b64_tr_b16 v[122:123], v9 offset:57344
    v_mfma_f32_16x16x32_bf16 v[160:163], v[64:67], v[40:43], 0
    s_add_u32 m0, s22, 0
    s_nop 0
    buffer_load_dwordx4 v2, s[8:11], s18 offen lds
    s_add_u32 s18, s18, s20
    v_mfma_f32_16x16x32_bf16 v[164:167], v[68:71], v[40:43], 0
    ds_read_b64_tr_b16 v[124:125], v10 offset:57344
    v_mfma_f32_16x16x32_bf16 v[168:171], v[72:75], v[40:43], 0
    ds_read_b64_tr_b16 v[126:127], v11 offset:57344
    v_mfma_f32_16x16x32_bf16 v[172:175], v[76:79], v[40:43], 0
    ds_read_b128 v[80:83], v5 offset:32768
    v_mfma_f32_16x16x32_bf16 v[176:179], v[64:67], v[44:47], 0
    s_add_u32 m0, s22, 8192
    s_nop 0
    buffer_load_dwordx4 v2, s[12:15], s19 offen lds
    s_add_u32 s19, s19, s20
    v_mfma_f32_16x16x32_bf16 v[180:183], v[68:71], v[44:47], 0
    ds_read_b128 v[84:87], v5 offset:33792
    v_mfma_f32_16x16x32_bf16 v[184:187], v[72:75], v[44:47], 0
    ds_read_b128 v[88:91], v5 offset:34816
    v_mfma_f32_16x16x32_bf16 v[188:191], v[76:79], v[44:47], 0
    ds_read_b128 v[92:95], v5 offset:35840
    v_mfma_f32_16x16x32_bf16 v[192:195], v[64:67], v[48:51], 0
    ds_read_b128 v[96:99], v5 offset:36864
    v_mfma_f32_16x16x32_bf16 v[196:199], v[68:71], v[48:51], 0
    ds_read_b128 v[100:103], v5 offset:37888
    v_mfma_f32_16x16x32_bf16 v[200:203], v[72:75], v[48:51], 0
    ds_read_b128 v[104:107], v5 offset:38912
    v_mfma_f32_16x16x32_bf16 v[204:207], v[76:79], v[48:51], 0
    ds_read_b128 v[108:111], v5 offset:39936
    v_mfma_f32_16x16x32_bf16 v[208:211], v[64:67], v[52:55], 0
    v_mfma_f32_16x16x32_bf16 v[212:215], v[68:71], v[52:55], 0
    v_mfma_f32_16x16x32_bf16 v[216:219], v[72:75], v[52:55], 0
    v_mfma_f32_16x16x32_bf16 v[220:223], v[76:79], v[52:55], 0
    v_mfma_f32_16x16x32_bf16 v[224:227], v[64:67], v[56:59], 0
    v_mfma_f32_16x16x32_bf16 v[228:231], v[68:71], v[56:59], 0
    v_mfma_f32_16x16x32_bf16 v[232:235], v[72:75], v[56:59], 0
    v_mfma_f32_16x16x32_bf16 v[236:239], v[76:79], v[56:59], 0
    v_mfma_f32_16x16x32_bf16 v[240:243], v[64:67], v[60:63], 0
    v_mfma_f32_16x16x32_bf16 v[244:247], v[68:71], v[60:63], 0
    v_mfma_f32_16x16x32_bf16 v[248:251], v[72:75], v[60:63], 0
    v_mfma_f32_16x16x32_bf16 v[252:255], v[76:79], v[60:63], 0
    s_waitcnt lgkmcnt(0)
w_first16_q1:
    s_waitcnt vmcnt(24)
    s_barrier
    v_mfma_f32_16x16x32_bf16 v[128:131], v[112:115], v[80:83], v[128:131]
    s_add_u32 m0, s21, 32768
    s_nop 0
    buffer_load_dwordx4 v1, s[4:7], s16 offen sc1 lds
    s_add_u32 s16, s16, s62
    v_mfma_f32_16x16x32_bf16 v[132:135], v[116:119], v[80:83], v[132:135]
    ds_read_b64_tr_b16 v[64:65], v12 offset:16384
    v_mfma_f32_16x16x32_bf16 v[136:139], v[120:123], v[80:83], v[136:139]
    ds_read_b64_tr_b16 v[66:67], v13 offset:16384
    v_mfma_f32_16x16x32_bf16 v[140:143], v[124:127], v[80:83], v[140:143]
    ds_read_b64_tr_b16 v[68:69], v14 offset:16384
    v_mfma_f32_16x16x32_bf16 v[144:147], v[112:115], v[84:87], v[144:147]
    s_add_u32 m0, s21, 33792
    s_nop 0
    buffer_load_dwordx4 v1, s[4:7], s17 offen sc1 lds
    s_add_u32 s17, s17, s62
    v_mfma_f32_16x16x32_bf16 v[148:151], v[116:119], v[84:87], v[148:151]
    ds_read_b64_tr_b16 v[70:71], v15 offset:16384
    v_mfma_f32_16x16x32_bf16 v[152:155], v[120:123], v[84:87], v[152:155]
    ds_read_b64_tr_b16 v[72:73], v12 offset:24576
    v_mfma_f32_16x16x32_bf16 v[156:159], v[124:127], v[84:87], v[156:159]
    ds_read_b64_tr_b16 v[74:75], v13 offset:24576
    v_mfma_f32_16x16x32_bf16 v[160:163], v[112:115], v[88:91], v[160:163]
    s_add_u32 m0, s22, 32768
    s_nop 0
    buffer_load_dwordx4 v2, s[8:11], s18 offen lds
    s_add_u32 s18, s18, s20
    v_mfma_f32_16x16x32_bf16 v[164:167], v[116:119], v[88:91], v[164:167]
    ds_read_b64_tr_b16 v[76:77], v14 offset:24576
    v_mfma_f32_16x16x32_bf16 v[168:171], v[120:123], v[88:91], v[168:171]
    ds_read_b64_tr_b16 v[78:79], v15 offset:24576
    v_mfma_f32_16x16x32_bf16 v[172:175], v[124:127], v[88:91], v[172:175]
    ds_read_b128 v[32:35], v6 offset:0
    v_mfma_f32_16x16x32_bf16 v[176:179], v[112:115], v[92:95], v[176:179]
    s_add_u32 m0, s22, 40960
    s_nop 0
    buffer_load_dwordx4 v2, s[12:15], s19 offen lds
    s_add_u32 s19, s19, s20
    v_mfma_f32_16x16x32_bf16 v[180:183], v[116:119], v[92:95], v[180:183]
    ds_read_b128 v[36:39], v6 offset:1024
    v_mfma_f32_16x16x32_bf16 v[184:187], v[120:123], v[92:95], v[184:187]
    ds_read_b128 v[40:43], v6 offset:2048
    v_mfma_f32_16x16x32_bf16 v[188:191], v[124:127], v[92:95], v[188:191]
    ds_read_b128 v[44:47], v6 offset:3072
    v_mfma_f32_16x16x32_bf16 v[192:195], v[112:115], v[96:99], v[192:195]
    ds_read_b128 v[48:51], v6 offset:4096
    v_mfma_f32_16x16x32_bf16 v[196:199], v[116:119], v[96:99], v[196:199]
    ds_read_b128 v[52:55], v6 offset:5120
    v_mfma_f32_16x16x32_bf16 v[200:203], v[120:123], v[96:99], v[200:203]
    ds_read_b128 v[56:59], v6 offset:6144
    v_mfma_f32_16x16x32_bf16 v[204:207], v[124:127], v[96:99], v[204:207]
    ds_read_b128 v[60:63], v6 offset:7168
    v_mfma_f32_16x16x32_bf16 v[208:211], v[112:115], v[100:103], v[208:211]
    v_mfma_f32_16x16x32_bf16 v[212:215], v[116:119], v[100:103], v[212:215]
    v_mfma_f32_16x16x32_bf16 v[216:219], v[120:123], v[100:103], v[216:219]
    v_mfma_f32_16x16x32_bf16 v[220:223], v[124:127], v[100:103], v[220:223]
    v_mfma_f32_16x16x32_bf16 v[224:227], v[112:115], v[104:107], v[224:227]
    v_mfma_f32_16x16x32_bf16 v[228:231], v[116:119], v[104:107], v[228:231]
    v_mfma_f32_16x16x32_bf16 v[232:235], v[120:123], v[104:107], v[232:235]
    v_mfma_f32_16x16x32_bf16 v[236:239], v[124:127], v[104:107], v[236:239]
    v_mfma_f32_16x16x32_bf16 v[240:243], v[112:115], v[108:111], v[240:243]
    v_mfma_f32_16x16x32_bf16 v[244:247], v[116:119], v[108:111], v[244:247]
    v_mfma_f32_16x16x32_bf16 v[248:251], v[120:123], v[108:111], v[248:251]
    v_mfma_f32_16x16x32_bf16 v[252:255], v[124:127], v[108:111], v[252:255]
    s_waitcnt lgkmcnt(0)
    s_waitcnt vmcnt(24)
    s_barrier
    v_mfma_f32_16x16x32_bf16 v[128:131], v[64:67], v[32:35], v[128:131]
    s_add_u32 m0, s21, 65536
    s_nop 0
    buffer_load_dwordx4 v1, s[4:7], s16 offen sc1 lds
    s_add_u32 s16, s16, s62
    v_mfma_f32_16x16x32_bf16 v[132:135], v[68:71], v[32:35], v[132:135]
    ds_read_b64_tr_b16 v[112:113], v12 offset:49152
    v_mfma_f32_16x16x32_bf16 v[136:139], v[72:75], v[32:35], v[136:139]
    ds_read_b64_tr_b16 v[114:115], v13 offset:49152
    v_mfma_f32_16x16x32_bf16 v[140:143], v[76:79], v[32:35], v[140:143]
    ds_read_b64_tr_b16 v[116:117], v14 offset:49152
    v_mfma_f32_16x16x32_bf16 v[144:147], v[64:67], v[36:39], v[144:147]
    s_add_u32 m0, s21, 66560
    s_nop 0
    buffer_load_dwordx4 v1, s[4:7], s17 offen sc1 lds
    s_add_u32 s17, s17, s62
    v_mfma_f32_16x16x32_bf16 v[148:151], v[68:71], v[36:39], v[148:151]
    ds_read_b64_tr_b16 v[118:119], v15 offset:49152
    v_mfma_f32_16x16x32_bf16 v[152:155], v[72:75], v[36:39], v[152:155]
    ds_read_b64_tr_b16 v[120:121], v12 offset:57344
    v_mfma_f32_16x16x32_bf16 v[156:159], v[76:79], v[36:39], v[156:159]
    ds_read_b64_tr_b16 v[122:123], v13 offset:57344
    v_mfma_f32_16x16x32_bf16 v[160:163], v[64:67], v[40:43], v[160:163]
    s_add_u32 m0, s22, 65536
    s_nop 0
    buffer_load_dwordx4 v2, s[8:11], s18 offen lds
    s_add_u32 s18, s18, s20
    v_mfma_f32_16x16x32_bf16 v[164:167], v[68:71], v[40:43], v[164:167]
    ds_read_b64_tr_b16 v[124:125], v14 offset:57344
    v_mfma_f32_16x16x32_bf16 v[168:171], v[72:75], v[40:43], v[168:171]
    ds_read_b64_tr_b16 v[126:127], v15 offset:57344
    v_mfma_f32_16x16x32_bf16 v[172:175], v[76:79], v[40:43], v[172:175]
    ds_read_b128 v[80:83], v6 offset:32768
    v_mfma_f32_16x16x32_bf16 v[176:179], v[64:67], v[44:47], v[176:179]
    s_add_u32 m0, s22, 73728
    s_nop 0
    buffer_load_dwordx4 v2, s[12:15], s19 offen lds
    s_add_u32 s19, s19, s20
    v_mfma_f32_16x16x32_bf16 v[180:183], v[68:71], v[44:47], v[180:183]
    ds_read_b128 v[84:87], v6 offset:33792
    v_mfma_f32_16x16x32_bf16 v[184:187], v[72:75], v[44:47], v[184:187]
    ds_read_b128 v[88:91], v6 offset:34816
    v_mfma_f32_16x16x32_bf16 v[188:191], v[76:79], v[44:47], v[188:191]
    ds_read_b128 v[92:95], v6 offset:35840
    v_mfma_f32_16x16x32_bf16 v[192:195], v[64:67], v[48:51], v[192:195]
    ds_read_b128 v[96:99], v6 offset:36864
    v_mfma_f32_16x16x32_bf16 v[196:199], v[68:71], v[48:51], v[196:199]
    ds_read_b128 v[100:103], v6 offset:37888
    v_mfma_f32_16x16x32_bf16 v[200:203], v[72:75], v[48:51], v[200:203]
    ds_read_b128 v[104:107], v6 offset:38912
    v_mfma_f32_16x16x32_bf16 v[204:207], v[76:79], v[48:51], v[204:207]
    ds_read_b128 v[108:111], v6 offset:39936
    v_mfma_f32_16x16x32_bf16 v[208:211], v[64:67], v[52:55], v[208:211]
    v_mfma_f32_16x16x32_bf16 v[212:215], v[68:71], v[52:55], v[212:215]
    v_mfma_f32_16x16x32_bf16 v[216:219], v[72:75], v[52:55], v[216:219]
    v_mfma_f32_16x16x32_bf16 v[220:223], v[76:79], v[52:55], v[220:223]
    v_mfma_f32_16x16x32_bf16 v[224:227], v[64:67], v[56:59], v[224:227]
    v_mfma_f32_16x16x32_bf16 v[228:231], v[68:71], v[56:59], v[228:231]
    v_mfma_f32_16x16x32_bf16 v[232:235], v[72:75], v[56:59], v[232:235]
    v_mfma_f32_16x16x32_bf16 v[236:239], v[76:79], v[56:59], v[236:239]
    v_mfma_f32_16x16x32_bf16 v[240:243], v[64:67], v[60:63], v[240:243]
    v_mfma_f32_16x16x32_bf16 v[244:247], v[68:71], v[60:63], v[244:247]
    v_mfma_f32_16x16x32_bf16 v[248:251], v[72:75], v[60:63], v[248:251]
    v_mfma_f32_16x16x32_bf16 v[252:255], v[76:79], v[60:63], v[252:255]
    s_waitcnt lgkmcnt(0)
    s_waitcnt vmcnt(8)
    s_barrier
    s_cmp_eq_u32 s28, 0
    s_cbranch_scc1 sig_4
    s_cmp_lg_u32 s3, 0
    s_cbranch_scc1 sig_4
    s_and_b32 s57, s28, 3
    v_mov_b32 v24, s57
    s_bfe_u32 s57, s28, 0x20002
    v_mov_b32 v25, s57
    s_andn2_b32 s28, s28, 15
    s_mov_b64 exec, 1
    buffer_atomic_add_x2 v[24:25], v17, s[4:7], s28 offen sc1
    s_mov_b64 exec, -1
sig_4:
    s_mov_b32 s28, 0
    v_mfma_f32_16x16x32_bf16 v[128:131], v[112:115], v[80:83], v[128:131]
    s_add_u32 m0, s21, 98304
    s_nop 0
    buffer_load_dwordx4 v1, s[4:7], s16 offen sc1 lds
    s_add_u32 s16, s16, s62
    v_mfma_f32_16x16x32_bf16 v[132:135], v[116:119], v[80:83], v[132:135]
    ds_read_b64_tr_b16 v[64:65], v8 offset:16384
    v_mfma_f32_16x16x32_bf16 v[136:139], v[120:123], v[80:83], v[136:139]
    ds_read_b64_tr_b16 v[66:67], v9 offset:16384
    v_mfma_f32_16x16x32_bf16 v[140:143], v[124:127], v[80:83], v[140:143]
    ds_read_b64_tr_b16 v[68:69], v10 offset:16384
    v_mfma_f32_16x16x32_bf16 v[144:147], v[112:115], v[84:87], v[144:147]
    s_add_u32 m0, s21, 99328
    s_nop 0
    buffer_load_dwordx4 v1, s[4:7], s17 offen sc1 lds
    s_add_u32 s17, s17, s62
    v_mfma_f32_16x16x32_bf16 v[148:151], v[116:119], v[84:87], v[148:151]
    ds_read_b64_tr_b16 v[70:71], v11 offset:16384
    v_mfma_f32_16x16x32_bf16 v[152:155], v[120:123], v[84:87], v[152:155]
    ds_read_b64_tr_b16 v[72:73], v8 offset:24576
    v_mfma_f32_16x16x32_bf16 v[156:159], v[124:127], v[84:87], v[156:159]
    ds_read_b64_tr_b16 v[74:75], v9 offset:24576
    v_mfma_f32_16x16x32_bf16 v[160:163], v[112:115], v[88:91], v[160:163]
    s_add_u32 m0, s22, 98304
    s_nop 0
    buffer_load_dwordx4 v2, s[8:11], s18 offen lds
    s_add_u32 s18, s18, s20
    v_mfma_f32_16x16x32_bf16 v[164:167], v[116:119], v[88:91], v[164:167]
    ds_read_b64_tr_b16 v[76:77], v10 offset:24576
    v_mfma_f32_16x16x32_bf16 v[168:171], v[120:123], v[88:91], v[168:171]
    ds_read_b64_tr_b16 v[78:79], v11 offset:24576
    v_mfma_f32_16x16x32_bf16 v[172:175], v[124:127], v[88:91], v[172:175]
    ds_read_b128 v[32:35], v5 offset:0
    v_mfma_f32_16x16x32_bf16 v[176:179], v[112:115], v[92:95], v[176:179]
    s_add_u32 m0, s22, 106496
    s_nop 0
    buffer_load_dwordx4 v2, s[12:15], s19 offen lds
    s_add_u32 s19, s19, s20
    v_mfma_f32_16x16x32_bf16 v[180:183], v[116:119], v[92:95], v[180:183]
    ds_read_b128 v[36:39], v5 offset:1024
    v_mfma_f32_16x16x32_bf16 v[184:187], v[120:123], v[92:95], v[184:187]
    ds_read_b128 v[40:43], v5 offset:2048
    v_mfma_f32_16x16x32_bf16 v[188:191], v[124:127], v[92:95], v[188:191]
    ds_read_b128 v[44:47], v5 offset:3072
    v_mfma_f32_16x16x32_bf16 v[192:195], v[112:115], v[96:99], v[192:195]
    ds_read_b128 v[48:51], v5 offset:4096
    v_mfma_f32_16x16x32_bf16 v[196:199], v[116:119], v[96:99], v[196:199]
    ds_read_b128 v[52:55], v5 offset:5120
    v_mfma_f32_16x16x32_bf16 v[200:203], v[120:123], v[96:99], v[200:203]
    ds_read_b128 v[56:59], v5 offset:6144
    v_mfma_f32_16x16x32_bf16 v[204:207], v[124:127], v[96:99], v[204:207]
    ds_read_b128 v[60:63], v5 offset:7168
    v_mfma_f32_16x16x32_bf16 v[208:211], v[112:115], v[100:103], v[208:211]
    v_mfma_f32_16x16x32_bf16 v[212:215], v[116:119], v[100:103], v[212:215]
    v_mfma_f32_16x16x32_bf16 v[216:219], v[120:123], v[100:103], v[216:219]
    v_mfma_f32_16x16x32_bf16 v[220:223], v[124:127], v[100:103], v[220:223]
    v_mfma_f32_16x16x32_bf16 v[224:227], v[112:115], v[104:107], v[224:227]
    v_mfma_f32_16x16x32_bf16 v[228:231], v[116:119], v[104:107], v[228:231]
    v_mfma_f32_16x16x32_bf16 v[232:235], v[120:123], v[104:107], v[232:235]
    v_mfma_f32_16x16x32_bf16 v[236:239], v[124:127], v[104:107], v[236:239]
    v_mfma_f32_16x16x32_bf16 v[240:243], v[112:115], v[108:111], v[240:243]
    v_mfma_f32_16x16x32_bf16 v[244:247], v[116:119], v[108:111], v[244:247]
    v_mfma_f32_16x16x32_bf16 v[248:251], v[120:123], v[108:111], v[248:251]
    v_mfma_f32_16x16x32_bf16 v[252:255], v[124:127], v[108:111], v[252:255]
    s_waitcnt lgkmcnt(0)
w_loop_chk:
    s_sub_u32 s23, s23, 1
w_loop:
    s_cmp_gt_u32 s23, 3
    s_cbranch_scc1 w_body
    s_cmp_lg_u32 s23, 3
    s_cbranch_scc1 w_l2
    s_cmp_lg_u32 s3, 0
    s_cbranch_scc1 clm_5
    v_mov_b32 v26, 1
    s_mov_b64 exec, 1
    buffer_atomic_add v26, off, s[64:67], s71 sc0 sc1
    s_mov_b64 exec, -1
clm_5:
    s_branch w_body
w_l2:
    s_cmp_lg_u32 s23, 2
    s_cbranch_scc1 w_l1
    s_cmp_lg_u32 s3, 0
    s_cbranch_scc1 pub_6
    v_mov_b32 v20, 131136
    s_mov_b64 exec, 1
    ds_write_b32 v20, v26
    s_mov_b64 exec, -1
    s_waitcnt lgkmcnt(0)
pub_6:
    s_branch w_body
w_l1:
    s_waitcnt vmcnt(8)
    v_readfirstlane_b32 s30, v16
    s_cmp_ge_u32 s30, s45
    s_cselect_b32 s30, 0, 1
    s_or_b32 s30, s30, s70
    s_cmp_eq_u32 s32, 4
    s_cselect_b32 s30, 1, s30
    s_sub_u32 s57, s32, 1
    s_cmp_ge_u32 s57, 4
    s_cselect_b32 s30, 1, s30
    v_mov_b32 v20, s30
    ds_write_b32 v7, v20
    s_cbranch_scc1 w_body
    s_load_dwordx2 s[8:9], s[0:1], s33
    s_load_dwordx2 s[12:13], s[0:1], s34
    s_mov_b32 s10, s38
    s_mov_b32 s14, s38
    s_cmp_eq_u32 s32, 4
    s_cselect_b32 s31, 0, 1
    s_lshl_b32 s30, s3, s31
    s_mul_i32 s30, s30, s40
    s_add_u32 s16, s39, s30
    s_cmp_eq_u32 s32, 4
    s_cselect_b32 s30, 1024, s40
    s_cselect_b32 s31, 6, 5
    s_lshl_b32 s62, 32, s31
    s_add_u32 s17, s16, s30
    s_lshl_b32 s30, s3, 2
    s_mul_i32 s30, s30, s35
    s_add_u32 s18, s36, s30
    s_add_u32 s19, s37, s30
    s_lshl_b32 s20, s35, s31
    v_mul_u32_u24 v2, s35, v4
    v_add_u32 v2, v2, v3
    s_waitcnt lgkmcnt(0)
w_body:
    s_waitcnt vmcnt(8)
    s_barrier
    s_cmp_lg_u32 s23, 2
    s_cbranch_scc1 w_nf
    v_mov_b32 v20, 131136
    ds_read_b32 v20, v20
    s_waitcnt lgkmcnt(0)
    v_readfirstlane_b32 s59, v20
    s_add_u32 s59, s59, 32
    s_min_u32 s59, s59, 319
    s_lshl_b32 s57, s59, 6
    s_load_dwordx16 s[32:47], s[24:25], s57
w_nf:
    v_mfma_f32_16x16x32_bf16 v[128:131], v[64:67], v[32:35], v[128:131]
    s_add_u32 m0, s21, 0
    s_nop 0
    buffer_load_dwordx4 v1, s[4:7], s16 offen sc1 lds
    s_add_u32 s16, s16, s62
    v_mfma_f32_16x16x32_bf16 v[132:135], v[68:71], v[32:35], v[132:135]
    ds_read_b64_tr_b16 v[112:113], v8 offset:49152
    v_mfma_f32_16x16x32_bf16 v[136:139], v[72:75], v[32:35], v[136:139]
    ds_read_b64_tr_b16 v[114:115], v9 offset:49152
    v_mfma_f32_16x16x32_bf16 v[140:143], v[76:79], v[32:35], v[140:143]
    ds_read_b64_tr_b16 v[116:117], v10 offset:49152
    v_mfma_f32_16x16x32_bf16 v[144:147], v[64:67], v[36:39], v[144:147]
    s_add_u32 m0, s21, 1024
    s_nop 0
    buffer_load_dwordx4 v1, s[4:7], s17 offen sc1 lds
    s_add_u32 s17, s17, s62
    v_mfma_f32_16x16x32_bf16 v[148:151], v[68:71], v[36:39], v[148:151]
    ds_read_b64_tr_b16 v[118:119], v11 offset:49152
    v_mfma_f32_16x16x32_bf16 v[152:155], v[72:75], v[36:39], v[152:155]
    ds_read_b64_tr_b16 v[120:121], v8 offset:57344
    v_mfma_f32_16x16x32_bf16 v[156:159], v[76:79], v[36:39], v[156:159]
    ds_read_b64_tr_b16 v[122:123], v9 offset:57344
    v_mfma_f32_16x16x32_bf16 v[160:163], v[64:67], v[40:43], v[160:163]
    s_add_u32 m0, s22, 0
    s_nop 0
    buffer_load_dwordx4 v2, s[8:11], s18 offen lds
    s_add_u32 s18, s18, s20
    v_mfma_f32_16x16x32_bf16 v[164:167], v[68:71], v[40:43], v[164:167]
    ds_read_b64_tr_b16 v[124:125], v10 offset:57344
    v_mfma_f32_16x16x32_bf16 v[168:171], v[72:75], v[40:43], v[168:171]
    ds_read_b64_tr_b16 v[126:127], v11 offset:57344
    v_mfma_f32_16x16x32_bf16 v[172:175], v[76:79], v[40:43], v[172:175]
    ds_read_b128 v[80:83], v5 offset:32768
    v_mfma_f32_16x16x32_bf16 v[176:179], v[64:67], v[44:47], v[176:179]
    s_add_u32 m0, s22, 8192
    s_nop 0
    buffer_load_dwordx4 v2, s[12:15], s19 offen lds
    s_add_u32 s19, s19, s20
    v_mfma_f32_16x16x32_bf16 v[180:183], v[68:71], v[44:47], v[180:183]
    ds_read_b128 v[84:87], v5 offset:33792
    v_mfma_f32_16x16x32_bf16 v[184:187], v[72:75], v[44:47], v[184:187]
    ds_read_b128 v[88:91], v5 offset:34816
    v_mfma_f32_16x16x32_bf16 v[188:191], v[76:79], v[44:47], v[188:191]
    ds_read_b128 v[92:95], v5 offset:35840
    v_mfma_f32_16x16x32_bf16 v[192:195], v[64:67], v[48:51], v[192:195]
    ds_read_b128 v[96:99], v5 offset:36864
    v_mfma_f32_16x16x32_bf16 v[196:199], v[68:71], v[48:51], v[196:199]
    ds_read_b128 v[100:103], v5 offset:37888
    v_mfma_f32_16x16x32_bf16 v[200:203], v[72:75], v[48:51], v[200:203]
    ds_read_b128 v[104:107], v5 offset:38912
    v_mfma_f32_16x16x32_bf16 v[204:207], v[76:79], v[48:51], v[204:207]
    ds_read_b128 v[108:111], v5 offset:39936
    v_mfma_f32_16x16x32_bf16 v[208:211], v[64:67], v[52:55], v[208:211]
    v_mfma_f32_16x16x32_bf16 v[212:215], v[68:71], v[52:55], v[212:215]
    v_mfma_f32_16x16x32_bf16 v[216:219], v[72:75], v[52:55], v[216:219]
    v_mfma_f32_16x16x32_bf16 v[220:223], v[76:79], v[52:55], v[220:223]
    v_mfma_f32_16x16x32_bf16 v[224:227], v[64:67], v[56:59], v[224:227]
    v_mfma_f32_16x16x32_bf16 v[228:231], v[68:71], v[56:59], v[228:231]
    v_mfma_f32_16x16x32_bf16 v[232:235], v[72:75], v[56:59], v[232:235]
    v_mfma_f32_16x16x32_bf16 v[236:239], v[76:79], v[56:59], v[236:239]
    v_mfma_f32_16x16x32_bf16 v[240:243], v[64:67], v[60:63], v[240:243]
    v_mfma_f32_16x16x32_bf16 v[244:247], v[68:71], v[60:63], v[244:247]
    v_mfma_f32_16x16x32_bf16 v[248:251], v[72:75], v[60:63], v[248:251]
    v_mfma_f32_16x16x32_bf16 v[252:255], v[76:79], v[60:63], v[252:255]
    s_waitcnt lgkmcnt(0)
    s_waitcnt vmcnt(8)
    s_barrier
    buffer_load_dword v16, v17, s[4:7], s44 offen sc1
    v_mfma_f32_16x16x32_bf16 v[128:131], v[112:115], v[80:83], v[128:131]
    s_add_u32 m0, s21, 32768
    s_nop 0
    buffer_load_dwordx4 v1, s[4:7], s16 offen sc1 lds
    s_add_u32 s16, s16, s62
    v_mfma_f32_16x16x32_bf16 v[132:135], v[116:119], v[80:83], v[132:135]
    ds_read_b64_tr_b16 v[64:65], v12 offset:16384
    v_mfma_f32_16x16x32_bf16 v[136:139], v[120:123], v[80:83], v[136:139]
    ds_read_b64_tr_b16 v[66:67], v13 offset:16384
    v_mfma_f32_16x16x32_bf16 v[140:143], v[124:127], v[80:83], v[140:143]
    ds_read_b64_tr_b16 v[68:69], v14 offset:16384
    v_mfma_f32_16x16x32_bf16 v[144:147], v[112:115], v[84:87], v[144:147]
    s_add_u32 m0, s21, 33792
    s_nop 0
    buffer_load_dwordx4 v1, s[4:7], s17 offen sc1 lds
    s_add_u32 s17, s17, s62
    v_mfma_f32_16x16x32_bf16 v[148:151], v[116:119], v[84:87], v[148:151]
    ds_read_b64_tr_b16 v[70:71], v15 offset:16384
    v_mfma_f32_16x16x32_bf16 v[152:155], v[120:123], v[84:87], v[152:155]
    ds_read_b64_tr_b16 v[72:73], v12 offset:24576
    v_mfma_f32_16x16x32_bf16 v[156:159], v[124:127], v[84:87], v[156:159]
    ds_read_b64_tr_b16 v[74:75], v13 offset:24576
    v_mfma_f32_16x16x32_bf16 v[160:163], v[112:115], v[88:91], v[160:163]
    s_add_u32 m0, s22, 32768
    s_nop 0
    buffer_load_dwordx4 v2, s[8:11], s18 offen lds
    s_add_u32 s18, s18, s20
    v_mfma_f32_16x16x32_bf16 v[164:167], v[116:119], v[88:91], v[164:167]
    ds_read_b64_tr_b16 v[76:77], v14 offset:24576
    v_mfma_f32_16x16x32_bf16 v[168:171], v[120:123], v[88:91], v[168:171]
    ds_read_b64_tr_b16 v[78:79], v15 offset:24576
    v_mfma_f32_16x16x32_bf16 v[172:175], v[124:127], v[88:91], v[172:175]
    ds_read_b128 v[32:35], v6 offset:0
    v_mfma_f32_16x16x32_bf16 v[176:179], v[112:115], v[92:95], v[176:179]
    s_add_u32 m0, s22, 40960
    s_nop 0
    buffer_load_dwordx4 v2, s[12:15], s19 offen lds
    s_add_u32 s19, s19, s20
    v_mfma_f32_16x16x32_bf16 v[180:183], v[116:119], v[92:95], v[180:183]
    ds_read_b128 v[36:39], v6 offset:1024
    v_mfma_f32_16x16x32_bf16 v[184:187], v[120:123], v[92:95], v[184:187]
    ds_read_b128 v[40:43], v6 offset:2048
    v_mfma_f32_16x16x32_bf16 v[188:191], v[124:127], v[92:95], v[188:191]
    ds_read_b128 v[44:47], v6 offset:3072
    v_mfma_f32_16x16x32_bf16 v[192:195], v[112:115], v[96:99], v[192:195]
    ds_read_b128 v[48:51], v6 offset:4096
    v_mfma_f32_16x16x32_bf16 v[196:199], v[116:119], v[96:99], v[196:199]
    ds_read_b128 v[52:55], v6 offset:5120
    v_mfma_f32_16x16x32_bf16 v[200:203], v[120:123], v[96:99], v[200:203]
    ds_read_b128 v[56:59], v6 offset:6144
    v_mfma_f32_16x16x32_bf16 v[204:207], v[124:127], v[96:99], v[204:207]
    ds_read_b128 v[60:63], v6 offset:7168
    v_mfma_f32_16x16x32_bf16 v[208:211], v[112:115], v[100:103], v[208:211]
    v_mfma_f32_16x16x32_bf16 v[212:215], v[116:119], v[100:103], v[212:215]
    v_mfma_f32_16x16x32_bf16 v[216:219], v[120:123], v[100:103], v[216:219]
    v_mfma_f32_16x16x32_bf16 v[220:223], v[124:127], v[100:103], v[220:223]
    v_mfma_f32_16x16x32_bf16 v[224:227], v[112:115], v[104:107], v[224:227]
    v_mfma_f32_16x16x32_bf16 v[228:231], v[116:119], v[104:107], v[228:231]
    v_mfma_f32_16x16x32_bf16 v[232:235], v[120:123], v[104:107], v[232:235]
    v_mfma_f32_16x16x32_bf16 v[236:239], v[124:127], v[104:107], v[236:239]
    v_mfma_f32_16x16x32_bf16 v[240:243], v[112:115], v[108:111], v[240:243]
    v_mfma_f32_16x16x32_bf16 v[244:247], v[116:119], v[108:111], v[244:247]
    v_mfma_f32_16x16x32_bf16 v[248:251], v[120:123], v[108:111], v[248:251]
    v_mfma_f32_16x16x32_bf16 v[252:255], v[124:127], v[108:111], v[252:255]
    s_waitcnt lgkmcnt(0)
    s_waitcnt vmcnt(8)
    s_barrier
    v_mfma_f32_16x16x32_bf16 v[128:131], v[64:67], v[32:35], v[128:131]
    s_add_u32 m0, s21, 65536
    s_nop 0
    buffer_load_dwordx4 v1, s[4:7], s16 offen sc1 lds
    s_add_u32 s16, s16, s62
    v_mfma_f32_16x16x32_bf16 v[132:135], v[68:71], v[32:35], v[132:135]
    ds_read_b64_tr_b16 v[112:113], v12 offset:49152
    v_mfma_f32_16x16x32_bf16 v[136:139], v[72:75], v[32:35], v[136:139]
    ds_read_b64_tr_b16 v[114:115], v13 offset:49152
    v_mfma_f32_16x16x32_bf16 v[140:143], v[76:79], v[32:35], v[140:143]
    ds_read_b64_tr_b16 v[116:117], v14 offset:49152
    v_mfma_f32_16x16x32_bf16 v[144:147], v[64:67], v[36:39], v[144:147]
    s_add_u32 m0, s21, 66560
    s_nop 0
    buffer_load_dwordx4 v1, s[4:7], s17 offen sc1 lds
    s_add_u32 s17, s17, s62
    v_mfma_f32_16x16x32_bf16 v[148:151], v[68:71], v[36:39], v[148:151]
    ds_read_b64_tr_b16 v[118:119], v15 offset:49152
    v_mfma_f32_16x16x32_bf16 v[152:155], v[72:75], v[36:39], v[152:155]
    ds_read_b64_tr_b16 v[120:121], v12 offset:57344
    v_mfma_f32_16x16x32_bf16 v[156:159], v[76:79], v[36:39], v[156:159]
    ds_read_b64_tr_b16 v[122:123], v13 offset:57344
    v_mfma_f32_16x16x32_bf16 v[160:163], v[64:67], v[40:43], v[160:163]
    s_add_u32 m0, s22, 65536
    s_nop 0
    buffer_load_dwordx4 v2, s[8:11], s18 offen lds
    s_add_u32 s18, s18, s20
    v_mfma_f32_16x16x32_bf16 v[164:167], v[68:71], v[40:43], v[164:167]
    ds_read_b64_tr_b16 v[124:125], v14 offset:57344
    v_mfma_f32_16x16x32_bf16 v[168:171], v[72:75], v[40:43], v[168:171]
    ds_read_b64_tr_b16 v[126:127], v15 offset:57344
    v_mfma_f32_16x16x32_bf16 v[172:175], v[76:79], v[40:43], v[172:175]
    ds_read_b128 v[80:83], v6 offset:32768
    v_mfma_f32_16x16x32_bf16 v[176:179], v[64:67], v[44:47], v[176:179]
    s_add_u32 m0, s22, 73728
    s_nop 0
    buffer_load_dwordx4 v2, s[12:15], s19 offen lds
    s_add_u32 s19, s19, s20
    v_mfma_f32_16x16x32_bf16 v[180:183], v[68:71], v[44:47], v[180:183]
    ds_read_b128 v[84:87], v6 offset:33792
    v_mfma_f32_16x16x32_bf16 v[184:187], v[72:75], v[44:47], v[184:187]
    ds_read_b128 v[88:91], v6 offset:34816
    v_mfma_f32_16x16x32_bf16 v[188:191], v[76:79], v[44:47], v[188:191]
    ds_read_b128 v[92:95], v6 offset:35840
    v_mfma_f32_16x16x32_bf16 v[192:195], v[64:67], v[48:51], v[192:195]
    ds_read_b128 v[96:99], v6 offset:36864
    v_mfma_f32_16x16x32_bf16 v[196:199], v[68:71], v[48:51], v[196:199]
    ds_read_b128 v[100:103], v6 offset:37888
    v_mfma_f32_16x16x32_bf16 v[200:203], v[72:75], v[48:51], v[200:203]
    ds_read_b128 v[104:107], v6 offset:38912
    v_mfma_f32_16x16x32_bf16 v[204:207], v[76:79], v[48:51], v[204:207]
    ds_read_b128 v[108:111], v6 offset:39936
    v_mfma_f32_16x16x32_bf16 v[208:211], v[64:67], v[52:55], v[208:211]
    v_mfma_f32_16x16x32_bf16 v[212:215], v[68:71], v[52:55], v[212:215]
    v_mfma_f32_16x16x32_bf16 v[216:219], v[72:75], v[52:55], v[216:219]
    v_mfma_f32_16x16x32_bf16 v[220:223], v[76:79], v[52:55], v[220:223]
    v_mfma_f32_16x16x32_bf16 v[224:227], v[64:67], v[56:59], v[224:227]
    v_mfma_f32_16x16x32_bf16 v[228:231], v[68:71], v[56:59], v[228:231]
    v_mfma_f32_16x16x32_bf16 v[232:235], v[72:75], v[56:59], v[232:235]
    v_mfma_f32_16x16x32_bf16 v[236:239], v[76:79], v[56:59], v[236:239]
    v_mfma_f32_16x16x32_bf16 v[240:243], v[64:67], v[60:63], v[240:243]
    v_mfma_f32_16x16x32_bf16 v[244:247], v[68:71], v[60:63], v[244:247]
    v_mfma_f32_16x16x32_bf16 v[248:251], v[72:75], v[60:63], v[248:251]
    v_mfma_f32_16x16x32_bf16 v[252:255], v[76:79], v[60:63], v[252:255]
    s_waitcnt lgkmcnt(0)
    s_waitcnt vmcnt(8)
    s_barrier
    v_mfma_f32_16x16x32_bf16 v[128:131], v[112:115], v[80:83], v[128:131]
    s_add_u32 m0, s21, 98304
    s_nop 0
    buffer_load_dwordx4 v1, s[4:7], s16 offen sc1 lds
    s_add_u32 s16, s16, s62
    v_mfma_f32_16x16x32_bf16 v[132:135], v[116:119], v[80:83], v[132:135]
    ds_read_b64_tr_b16 v[64:65], v8 offset:16384
    v_mfma_f32_16x16x32_bf16 v[136:139], v[120:123], v[80:83], v[136:139]
    ds_read_b64_tr_b16 v[66:67], v9 offset:16384
    v_mfma_f32_16x16x32_bf16 v[140:143], v[124:127], v[80:83], v[140:143]
    ds_read_b64_tr_b16 v[68:69], v10 offset:16384
    v_mfma_f32_16x16x32_bf16 v[144:147], v[112:115], v[84:87], v[144:147]
    s_add_u32 m0, s21, 99328
    s_nop 0
    buffer_load_dwordx4 v1, s[4:7], s17 offen sc1 lds
    s_add_u32 s17, s17, s62
    v_mfma_f32_16x16x32_bf16 v[148:151], v[116:119], v[84:87], v[148:151]
    ds_read_b64_tr_b16 v[70:71], v11 offset:16384
    v_mfma_f32_16x16x32_bf16 v[152:155], v[120:123], v[84:87], v[152:155]
    ds_read_b64_tr_b16 v[72:73], v8 offset:24576
    v_mfma_f32_16x16x32_bf16 v[156:159], v[124:127], v[84:87], v[156:159]
    ds_read_b64_tr_b16 v[74:75], v9 offset:24576
    v_mfma_f32_16x16x32_bf16 v[160:163], v[112:115], v[88:91], v[160:163]
    s_add_u32 m0, s22, 98304
    s_nop 0
    buffer_load_dwordx4 v2, s[8:11], s18 offen lds
    s_add_u32 s18, s18, s20
    v_mfma_f32_16x16x32_bf16 v[164:167], v[116:119], v[88:91], v[164:167]
    ds_read_b64_tr_b16 v[76:77], v10 offset:24576
    v_mfma_f32_16x16x32_bf16 v[168:171], v[120:123], v[88:91], v[168:171]
    ds_read_b64_tr_b16 v[78:79], v11 offset:24576
    v_mfma_f32_16x16x32_bf16 v[172:175], v[124:127], v[88:91], v[172:175]
    ds_read_b128 v[32:35], v5 offset:0
    v_mfma_f32_16x16x32_bf16 v[176:179], v[112:115], v[92:95], v[176:179]
    s_add_u32 m0, s22, 106496
    s_nop 0
    buffer_load_dwordx4 v2, s[12:15], s19 offen lds
    s_add_u32 s19, s19, s20
    v_mfma_f32_16x16x32_bf16 v[180:183], v[116:119], v[92:95], v[180:183]
    ds_read_b128 v[36:39], v5 offset:1024
    v_mfma_f32_16x16x32_bf16 v[184:187], v[120:123], v[92:95], v[184:187]
    ds_read_b128 v[40:43], v5 offset:2048
    v_mfma_f32_16x16x32_bf16 v[188:191], v[124:127], v[92:95], v[188:191]
    ds_read_b128 v[44:47], v5 offset:3072
    v_mfma_f32_16x16x32_bf16 v[192:195], v[112:115], v[96:99], v[192:195]
    ds_read_b128 v[48:51], v5 offset:4096
    v_mfma_f32_16x16x32_bf16 v[196:199], v[116:119], v[96:99], v[196:199]
    ds_read_b128 v[52:55], v5 offset:5120
    v_mfma_f32_16x16x32_bf16 v[200:203], v[120:123], v[96:99], v[200:203]
    ds_read_b128 v[56:59], v5 offset:6144
    v_mfma_f32_16x16x32_bf16 v[204:207], v[124:127], v[96:99], v[204:207]
    ds_read_b128 v[60:63], v5 offset:7168
    v_mfma_f32_16x16x32_bf16 v[208:211], v[112:115], v[100:103], v[208:211]
    v_mfma_f32_16x16x32_bf16 v[212:215], v[116:119], v[100:103], v[212:215]
    v_mfma_f32_16x16x32_bf16 v[216:219], v[120:123], v[100:103], v[216:219]
    v_mfma_f32_16x16x32_bf16 v[220:223], v[124:127], v[100:103], v[220:223]
    v_mfma_f32_16x16x32_bf16 v[224:227], v[112:115], v[104:107], v[224:227]
    v_mfma_f32_16x16x32_bf16 v[228:231], v[116:119], v[104:107], v[228:231]
    v_mfma_f32_16x16x32_bf16 v[232:235], v[120:123], v[104:107], v[232:235]
    v_mfma_f32_16x16x32_bf16 v[236:239], v[124:127], v[104:107], v[236:239]
    v_mfma_f32_16x16x32_bf16 v[240:243], v[112:115], v[108:111], v[240:243]
    v_mfma_f32_16x16x32_bf16 v[244:247], v[116:119], v[108:111], v[244:247]
    v_mfma_f32_16x16x32_bf16 v[248:251], v[120:123], v[108:111], v[248:251]
    v_mfma_f32_16x16x32_bf16 v[252:255], v[124:127], v[108:111], v[252:255]
    s_waitcnt lgkmcnt(0)
    s_sub_u32 s23, s23, 1
    s_cmp_lg_u32 s23, 0
    s_cbranch_scc1 w_loop
    v_mov_b32 v20, 131072
    ds_read_b128 v[24:27], v20
    ds_read_b128 v[28:31], v20 offset:16
    s_cmp_eq_u32 s48, 2
    s_cbranch_scc1 w_epi_glu
    s_lshl_b32 s30, s27, 10
    s_add_u32 s30, s30, s49
    s_nop 7
    v_cvt_pk_bf16_f32 v80, v128, v129
    v_cvt_pk_bf16_f32 v81, v130, v131
    v_cvt_pk_bf16_f32 v82, v132, v133
    v_cvt_pk_bf16_f32 v83, v134, v135
    buffer_store_dwordx4 v[80:83], v1, s[4:7], s30 offen sc1
    v_cvt_pk_bf16_f32 v84, v136, v137
    v_cvt_pk_bf16_f32 v85, v138, v139
    v_cvt_pk_bf16_f32 v86, v140, v141
    v_cvt_pk_bf16_f32 v87, v142, v143
    buffer_store_dwordx4 v[84:87], v19, s[4:7], s30 offen sc1
    s_add_u32 s30, s30, s50
    v_cvt_pk_bf16_f32 v88, v144, v145
    v_cvt_pk_bf16_f32 v89, v146, v147
    v_cvt_pk_bf16_f32 v90, v148, v149
    v_cvt_pk_bf16_f32 v91, v150, v151
    buffer_store_dwordx4 v[88:91], v1, s[4:7], s30 offen sc1
    v_cvt_pk_bf16_f32 v92, v152, v153
    v_cvt_pk_bf16_f32 v93, v154, v155
    v_cvt_pk_bf16_f32 v94, v156, v157
    v_cvt_pk_bf16_f32 v95, v158, v159
    buffer_store_dwordx4 v[92:95], v19, s[4:7], s30 offen sc1
    s_add_u32 s30, s30, s50
    v_cvt_pk_bf16_f32 v80, v160, v161
    v_cvt_pk_bf16_f32 v81, v162, v163
    v_cvt_pk_bf16_f32 v82, v164, v165
    v_cvt_pk_bf16_f32 v83, v166, v167
    buffer_store_dwordx4 v[80:83], v1, s[4:7], s30 offen sc1
    v_cvt_pk_bf16_f32 v84, v168, v169
    v_cvt_pk_bf16_f32 v85, v170, v171
    v_cvt_pk_bf16_f32 v86, v172, v173
    v_cvt_pk_bf16_f32 v87, v174, v175
    buffer_store_dwordx4 v[84:87], v19, s[4:7], s30 offen sc1
    s_add_u32 s30, s30, s50
    v_cvt_pk_bf16_f32 v88, v176, v177
    v_cvt_pk_bf16_f32 v89, v178, v179
    v_cvt_pk_bf16_f32 v90, v180, v181
    v_cvt_pk_bf16_f32 v91, v182, v183
    buffer_store_dwordx4 v[88:91], v1, s[4:7], s30 offen sc1
    v_cvt_pk_bf16_f32 v92, v184, v185
    v_cvt_pk_bf16_f32 v93, v186, v187
    v_cvt_pk_bf16_f32 v94, v188, v189
    v_cvt_pk_bf16_f32 v95, v190, v191
    buffer_store_dwordx4 v[92:95], v19, s[4:7], s30 offen sc1
    s_add_u32 s30, s30, s50
    v_cvt_pk_bf16_f32 v80, v192, v193
    v_cvt_pk_bf16_f32 v81, v194, v195
    v_cvt_pk_bf16_f32 v82, v196, v197
    v_cvt_pk_bf16_f32 v83, v198, v199
    buffer_store_dwordx4 v[80:83], v1, s[4:7], s30 offen sc1
    v_cvt_pk_bf16_f32 v84, v200, v201
    v_cvt_pk_bf16_f32 v85, v202, v203
    v_cvt_pk_bf16_f32 v86, v204, v205
    v_cvt_pk_bf16_f32 v87, v206, v207
    buffer_store_dwordx4 v[84:87], v19, s[4:7], s30 offen sc1
    s_add_u32 s30, s30, s50
    v_cvt_pk_bf16_f32 v88, v208, v209
    v_cvt_pk_bf16_f32 v89, v210, v211
    v_cvt_pk_bf16_f32 v90, v212, v213
    v_cvt_pk_bf16_f32 v91, v214, v215
    buffer_store_dwordx4 v[88:91], v1, s[4:7], s30 offen sc1
    v_cvt_pk_bf16_f32 v92, v216, v217
    v_cvt_pk_bf16_f32 v93, v218, v219
    v_cvt_pk_bf16_f32 v94, v220, v221
    v_cvt_pk_bf16_f32 v95, v222, v223
    buffer_store_dwordx4 v[92:95], v19, s[4:7], s30 offen sc1
    s_add_u32 s30, s30, s50
    v_cvt_pk_bf16_f32 v80, v224, v225
    v_cvt_pk_bf16_f32 v81, v226, v227
    v_cvt_pk_bf16_f32 v82, v228, v229
    v_cvt_pk_bf16_f32 v83, v230, v231
    buffer_store_dwordx4 v[80:83], v1, s[4:7], s30 offen sc1
    v_cvt_pk_bf16_f32 v84, v232, v233
    v_cvt_pk_bf16_f32 v85, v234, v235
    v_cvt_pk_bf16_f32 v86, v236, v237
    v_cvt_pk_bf16_f32 v87, v238, v239
    buffer_store_dwordx4 v[84:87], v19, s[4:7], s30 offen sc1
    s_add_u32 s30, s30, s50
    v_cvt_pk_bf16_f32 v88, v240, v241
    v_cvt_pk_bf16_f32 v89, v242, v243
    v_cvt_pk_bf16_f32 v90, v244, v245
    v_cvt_pk_bf16_f32 v91, v246, v247
    buffer_store_dwordx4 v[88:91], v1, s[4:7], s30 offen sc1
    v_cvt_pk_bf16_f32 v92, v248, v249
    v_cvt_pk_bf16_f32 v93, v250, v251
    v_cvt_pk_bf16_f32 v94, v252, v253
    v_cvt_pk_bf16_f32 v95, v254, v255
    buffer_store_dwordx4 v[92:95], v19, s[4:7], s30 offen sc1
    s_waitcnt lgkmcnt(0)
    v_or3_b32 v24, v24, v25, v26
    v_or3_b32 v28, v28, v29, v30
    v_or3_b32 v24, v24, v27, v31
    v_or_b32 v24, v24, v28
    s_mov_b32 s28, s51
    v_readfirstlane_b32 s30, v24
    s_cmp_lg_u32 s30, 0
    s_cbranch_scc1 w_drain
    s_mov_b32 s48, s32
    s_cmp_eq_u32 s32, 4
    s_cselect_b32 s30, 2, 3
    s_lshl_b32 s30, s26, s30
    s_mul_i32 s30, s30, s43
    s_add_u32 s49, s42, s30
    s_mov_b32 s50, s43
    s_mov_b32 s51, s46
    s_mov_b32 s23, s41
    s_mov_b32 s53, s41
    s_branch w_first16
w_epi_glu:
    s_lshl_b32 s30, s27, 10
    s_add_u32 s30, s30, s49
    s_mov_b32 s54, 0xbfb8aa3b
    s_nop 7
    v_cvt_pk_bf16_f32 v80, v128, v129
    v_cvt_pk_bf16_f32 v81, v130, v131
    v_cvt_pk_bf16_f32 v82, v132, v133
    v_cvt_pk_bf16_f32 v83, v134, v135
    v_lshlrev_b32 v96, 16, v80
    v_and_b32 v97, 0xffff0000, v80
    v_lshlrev_b32 v98, 16, v81
    v_and_b32 v99, 0xffff0000, v81
    v_lshlrev_b32 v100, 16, v82
    v_and_b32 v101, 0xffff0000, v82
    v_lshlrev_b32 v102, 16, v83
    v_and_b32 v103, 0xffff0000, v83
    v_mul_f32 v96, s54, v96
    v_mul_f32 v97, s54, v97
    v_mul_f32 v98, s54, v98
    v_mul_f32 v99, s54, v99
    v_mul_f32 v100, s54, v100
    v_mul_f32 v101, s54, v101
    v_mul_f32 v102, s54, v102
    v_mul_f32 v103, s54, v103
    v_exp_f32 v96, v96
    v_exp_f32 v97, v97
    v_exp_f32 v98, v98
    v_exp_f32 v99, v99
    v_exp_f32 v100, v100
    v_exp_f32 v101, v101
    v_exp_f32 v102, v102
    v_exp_f32 v103, v103
    v_add_f32 v96, 1.0, v96
    v_add_f32 v97, 1.0, v97
    v_add_f32 v98, 1.0, v98
    v_add_f32 v99, 1.0, v99
    v_add_f32 v100, 1.0, v100
    v_add_f32 v101, 1.0, v101
    v_add_f32 v102, 1.0, v102
    v_add_f32 v103, 1.0, v103
    v_rcp_f32 v96, v96
    v_rcp_f32 v97, v97
    v_rcp_f32 v98, v98
    v_rcp_f32 v99, v99
    v_rcp_f32 v100, v100
    v_rcp_f32 v101, v101
    v_rcp_f32 v102, v102
    v_rcp_f32 v103, v103
    v_mul_f32 v96, v96, v136
    v_mul_f32 v97, v97, v137
    v_mul_f32 v98, v98, v138
    v_mul_f32 v99, v99, v139
    v_mul_f32 v100, v100, v140
    v_mul_f32 v101, v101, v141
    v_mul_f32 v102, v102, v142
    v_mul_f32 v103, v103, v143
    v_cvt_pk_bf16_f32 v80, v96, v97
    v_cvt_pk_bf16_f32 v81, v98, v99
    v_cvt_pk_bf16_f32 v82, v100, v101
    v_cvt_pk_bf16_f32 v83, v102, v103
    buffer_store_dwordx4 v[80:83], v1, s[4:7], s30 offen sc1
    s_add_u32 s30, s30, s50
    v_cvt_pk_bf16_f32 v84, v144, v145
    v_cvt_pk_bf16_f32 v85, v146, v147
    v_cvt_pk_bf16_f32 v86, v148, v149
    v_cvt_pk_bf16_f32 v87, v150, v151
    v_lshlrev_b32 v104, 16, v84
    v_and_b32 v105, 0xffff0000, v84
    v_lshlrev_b32 v106, 16, v85
    v_and_b32 v107, 0xffff0000, v85
    v_lshlrev_b32 v108, 16, v86
    v_and_b32 v109, 0xffff0000, v86
    v_lshlrev_b32 v110, 16, v87
    v_and_b32 v111, 0xffff0000, v87
    v_mul_f32 v104, s54, v104
    v_mul_f32 v105, s54, v105
    v_mul_f32 v106, s54, v106
    v_mul_f32 v107, s54, v107
    v_mul_f32 v108, s54, v108
    v_mul_f32 v109, s54, v109
    v_mul_f32 v110, s54, v110
    v_mul_f32 v111, s54, v111
    v_exp_f32 v104, v104
    v_exp_f32 v105, v105
    v_exp_f32 v106, v106
    v_exp_f32 v107, v107
    v_exp_f32 v108, v108
    v_exp_f32 v109, v109
    v_exp_f32 v110, v110
    v_exp_f32 v111, v111
    v_add_f32 v104, 1.0, v104
    v_add_f32 v105, 1.0, v105
    v_add_f32 v106, 1.0, v106
    v_add_f32 v107, 1.0, v107
    v_add_f32 v108, 1.0, v108
    v_add_f32 v109, 1.0, v109
    v_add_f32 v110, 1.0, v110
    v_add_f32 v111, 1.0, v111
    v_rcp_f32 v104, v104
    v_rcp_f32 v105, v105
    v_rcp_f32 v106, v106
    v_rcp_f32 v107, v107
    v_rcp_f32 v108, v108
    v_rcp_f32 v109, v109
    v_rcp_f32 v110, v110
    v_rcp_f32 v111, v111
    v_mul_f32 v104, v104, v152
    v_mul_f32 v105, v105, v153
    v_mul_f32 v106, v106, v154
    v_mul_f32 v107, v107, v155
    v_mul_f32 v108, v108, v156
    v_mul_f32 v109, v109, v157
    v_mul_f32 v110, v110, v158
    v_mul_f32 v111, v111, v159
    v_cvt_pk_bf16_f32 v84, v104, v105
    v_cvt_pk_bf16_f32 v85, v106, v107
    v_cvt_pk_bf16_f32 v86, v108, v109
    v_cvt_pk_bf16_f32 v87, v110, v111
    buffer_store_dwordx4 v[84:87], v1, s[4:7], s30 offen sc1
    s_add_u32 s30, s30, s50
    v_cvt_pk_bf16_f32 v88, v160, v161
    v_cvt_pk_bf16_f32 v89, v162, v163
    v_cvt_pk_bf16_f32 v90, v164, v165
    v_cvt_pk_bf16_f32 v91, v166, v167
    v_lshlrev_b32 v96, 16, v88
    v_and_b32 v97, 0xffff0000, v88
    v_lshlrev_b32 v98, 16, v89
    v_and_b32 v99, 0xffff0000, v89
    v_lshlrev_b32 v100, 16, v90
    v_and_b32 v101, 0xffff0000, v90
    v_lshlrev_b32 v102, 16, v91
    v_and_b32 v103, 0xffff0000, v91
    v_mul_f32 v96, s54, v96
    v_mul_f32 v97, s54, v97
    v_mul_f32 v98, s54, v98
    v_mul_f32 v99, s54, v99
    v_mul_f32 v100, s54, v100
    v_mul_f32 v101, s54, v101
    v_mul_f32 v102, s54, v102
    v_mul_f32 v103, s54, v103
    v_exp_f32 v96, v96
    v_exp_f32 v97, v97
    v_exp_f32 v98, v98
    v_exp_f32 v99, v99
    v_exp_f32 v100, v100
    v_exp_f32 v101, v101
    v_exp_f32 v102, v102
    v_exp_f32 v103, v103
    v_add_f32 v96, 1.0, v96
    v_add_f32 v97, 1.0, v97
    v_add_f32 v98, 1.0, v98
    v_add_f32 v99, 1.0, v99
    v_add_f32 v100, 1.0, v100
    v_add_f32 v101, 1.0, v101
    v_add_f32 v102, 1.0, v102
    v_add_f32 v103, 1.0, v103
    v_rcp_f32 v96, v96
    v_rcp_f32 v97, v97
    v_rcp_f32 v98, v98
    v_rcp_f32 v99, v99
    v_rcp_f32 v100, v100
    v_rcp_f32 v101, v101
    v_rcp_f32 v102, v102
    v_rcp_f32 v103, v103
    v_mul_f32 v96, v96, v168
    v_mul_f32 v97, v97, v169
    v_mul_f32 v98, v98, v170
    v_mul_f32 v99, v99, v171
    v_mul_f32 v100, v100, v172
    v_mul_f32 v101, v101, v173
    v_mul_f32 v102, v102, v174
    v_mul_f32 v103, v103, v175
    v_cvt_pk_bf16_f32 v88, v96, v97
    v_cvt_pk_bf16_f32 v89, v98, v99
    v_cvt_pk_bf16_f32 v90, v100, v101
    v_cvt_pk_bf16_f32 v91, v102, v103
    buffer_store_dwordx4 v[88:91], v1, s[4:7], s30 offen sc1
    s_add_u32 s30, s30, s50
    v_cvt_pk_bf16_f32 v92, v176, v177
    v_cvt_pk_bf16_f32 v93, v178, v179
    v_cvt_pk_bf16_f32 v94, v180, v181
    v_cvt_pk_bf16_f32 v95, v182, v183
    v_lshlrev_b32 v104, 16, v92
    v_and_b32 v105, 0xffff0000, v92
    v_lshlrev_b32 v106, 16, v93
    v_and_b32 v107, 0xffff0000, v93
    v_lshlrev_b32 v108, 16, v94
    v_and_b32 v109, 0xffff0000, v94
    v_lshlrev_b32 v110, 16, v95
    v_and_b32 v111, 0xffff0000, v95
    v_mul_f32 v104, s54, v104
    v_mul_f32 v105, s54, v105
    v_mul_f32 v106, s54, v106
    v_mul_f32 v107, s54, v107
    v_mul_f32 v108, s54, v108
    v_mul_f32 v109, s54, v109
    v_mul_f32 v110, s54, v110
    v_mul_f32 v111, s54, v111
    v_exp_f32 v104, v104
    v_exp_f32 v105, v105
    v_exp_f32 v106, v106
    v_exp_f32 v107, v107
    v_exp_f32 v108, v108
    v_exp_f32 v109, v109
    v_exp_f32 v110, v110
    v_exp_f32 v111, v111
    v_add_f32 v104, 1.0, v104
    v_add_f32 v105, 1.0, v105
    v_add_f32 v106, 1.0, v106
    v_add_f32 v107, 1.0, v107
    v_add_f32 v108, 1.0, v108
    v_add_f32 v109, 1.0, v109
    v_add_f32 v110, 1.0, v110
    v_add_f32 v111, 1.0, v111
    v_rcp_f32 v104, v104
    v_rcp_f32 v105, v105
    v_rcp_f32 v106, v106
    v_rcp_f32 v107, v107
    v_rcp_f32 v108, v108
    v_rcp_f32 v109, v109
    v_rcp_f32 v110, v110
    v_rcp_f32 v111, v111
    v_mul_f32 v104, v104, v184
    v_mul_f32 v105, v105, v185
    v_mul_f32 v106, v106, v186
    v_mul_f32 v107, v107, v187
    v_mul_f32 v108, v108, v188
    v_mul_f32 v109, v109, v189
    v_mul_f32 v110, v110, v190
    v_mul_f32 v111, v111, v191
    v_cvt_pk_bf16_f32 v92, v104, v105
    v_cvt_pk_bf16_f32 v93, v106, v107
    v_cvt_pk_bf16_f32 v94, v108, v109
    v_cvt_pk_bf16_f32 v95, v110, v111
    buffer_store_dwordx4 v[92:95], v1, s[4:7], s30 offen sc1
    s_add_u32 s30, s30, s50
    v_cvt_pk_bf16_f32 v80, v192, v193
    v_cvt_pk_bf16_f32 v81, v194, v195
    v_cvt_pk_bf16_f32 v82, v196, v197
    v_cvt_pk_bf16_f32 v83, v198, v199
    v_lshlrev_b32 v96, 16, v80
    v_and_b32 v97, 0xffff0000, v80
    v_lshlrev_b32 v98, 16, v81
    v_and_b32 v99, 0xffff0000, v81
    v_lshlrev_b32 v100, 16, v82
    v_and_b32 v101, 0xffff0000, v82
    v_lshlrev_b32 v102, 16, v83
    v_and_b32 v103, 0xffff0000, v83
    v_mul_f32 v96, s54, v96
    v_mul_f32 v97, s54, v97
    v_mul_f32 v98, s54, v98
    v_mul_f32 v99, s54, v99
    v_mul_f32 v100, s54, v100
    v_mul_f32 v101, s54, v101
    v_mul_f32 v102, s54, v102
    v_mul_f32 v103, s54, v103
    v_exp_f32 v96, v96
    v_exp_f32 v97, v97
    v_exp_f32 v98, v98
    v_exp_f32 v99, v99
    v_exp_f32 v100, v100
    v_exp_f32 v101, v101
    v_exp_f32 v102, v102
    v_exp_f32 v103, v103
    v_add_f32 v96, 1.0, v96
    v_add_f32 v97, 1.0, v97
    v_add_f32 v98, 1.0, v98
    v_add_f32 v99, 1.0, v99
    v_add_f32 v100, 1.0, v100
    v_add_f32 v101, 1.0, v101
    v_add_f32 v102, 1.0, v102
    v_add_f32 v103, 1.0, v103
    v_rcp_f32 v96, v96
    v_rcp_f32 v97, v97
    v_rcp_f32 v98, v98
    v_rcp_f32 v99, v99
    v_rcp_f32 v100, v100
    v_rcp_f32 v101, v101
    v_rcp_f32 v102, v102
    v_rcp_f32 v103, v103
    v_mul_f32 v96, v96, v200
    v_mul_f32 v97, v97, v201
    v_mul_f32 v98, v98, v202
    v_mul_f32 v99, v99, v203
    v_mul_f32 v100, v100, v204
    v_mul_f32 v101, v101, v205
    v_mul_f32 v102, v102, v206
    v_mul_f32 v103, v103, v207
    v_cvt_pk_bf16_f32 v80, v96, v97
    v_cvt_pk_bf16_f32 v81, v98, v99
    v_cvt_pk_bf16_f32 v82, v100, v101
    v_cvt_pk_bf16_f32 v83, v102, v103
    buffer_store_dwordx4 v[80:83], v1, s[4:7], s30 offen sc1
    s_add_u32 s30, s30, s50
    v_cvt_pk_bf16_f32 v84, v208, v209
    v_cvt_pk_bf16_f32 v85, v210, v211
    v_cvt_pk_bf16_f32 v86, v212, v213
    v_cvt_pk_bf16_f32 v87, v214, v215
    v_lshlrev_b32 v104, 16, v84
    v_and_b32 v105, 0xffff0000, v84
    v_lshlrev_b32 v106, 16, v85
    v_and_b32 v107, 0xffff0000, v85
    v_lshlrev_b32 v108, 16, v86
    v_and_b32 v109, 0xffff0000, v86
    v_lshlrev_b32 v110, 16, v87
    v_and_b32 v111, 0xffff0000, v87
    v_mul_f32 v104, s54, v104
    v_mul_f32 v105, s54, v105
    v_mul_f32 v106, s54, v106
    v_mul_f32 v107, s54, v107
    v_mul_f32 v108, s54, v108
    v_mul_f32 v109, s54, v109
    v_mul_f32 v110, s54, v110
    v_mul_f32 v111, s54, v111
    v_exp_f32 v104, v104
    v_exp_f32 v105, v105
    v_exp_f32 v106, v106
    v_exp_f32 v107, v107
    v_exp_f32 v108, v108
    v_exp_f32 v109, v109
    v_exp_f32 v110, v110
    v_exp_f32 v111, v111
    v_add_f32 v104, 1.0, v104
    v_add_f32 v105, 1.0, v105
    v_add_f32 v106, 1.0, v106
    v_add_f32 v107, 1.0, v107
    v_add_f32 v108, 1.0, v108
    v_add_f32 v109, 1.0, v109
    v_add_f32 v110, 1.0, v110
    v_add_f32 v111, 1.0, v111
    v_rcp_f32 v104, v104
    v_rcp_f32 v105, v105
    v_rcp_f32 v106, v106
    v_rcp_f32 v107, v107
    v_rcp_f32 v108, v108
    v_rcp_f32 v109, v109
    v_rcp_f32 v110, v110
    v_rcp_f32 v111, v111
    v_mul_f32 v104, v104, v216
    v_mul_f32 v105, v105, v217
    v_mul_f32 v106, v106, v218
    v_mul_f32 v107, v107, v219
    v_mul_f32 v108, v108, v220
    v_mul_f32 v109, v109, v221
    v_mul_f32 v110, v110, v222
    v_mul_f32 v111, v111, v223
    v_cvt_pk_bf16_f32 v84, v104, v105
    v_cvt_pk_bf16_f32 v85, v106, v107
    v_cvt_pk_bf16_f32 v86, v108, v109
    v_cvt_pk_bf16_f32 v87, v110, v111
    buffer_store_dwordx4 v[84:87], v1, s[4:7], s30 offen sc1
    s_add_u32 s30, s30, s50
    v_cvt_pk_bf16_f32 v88, v224, v225
    v_cvt_pk_bf16_f32 v89, v226, v227
    v_cvt_pk_bf16_f32 v90, v228, v229
    v_cvt_pk_bf16_f32 v91, v230, v231
    v_lshlrev_b32 v96, 16, v88
    v_and_b32 v97, 0xffff0000, v88
    v_lshlrev_b32 v98, 16, v89
    v_and_b32 v99, 0xffff0000, v89
    v_lshlrev_b32 v100, 16, v90
    v_and_b32 v101, 0xffff0000, v90
    v_lshlrev_b32 v102, 16, v91
    v_and_b32 v103, 0xffff0000, v91
    v_mul_f32 v96, s54, v96
    v_mul_f32 v97, s54, v97
    v_mul_f32 v98, s54, v98
    v_mul_f32 v99, s54, v99
    v_mul_f32 v100, s54, v100
    v_mul_f32 v101, s54, v101
    v_mul_f32 v102, s54, v102
    v_mul_f32 v103, s54, v103
    v_exp_f32 v96, v96
    v_exp_f32 v97, v97
    v_exp_f32 v98, v98
    v_exp_f32 v99, v99
    v_exp_f32 v100, v100
    v_exp_f32 v101, v101
    v_exp_f32 v102, v102
    v_exp_f32 v103, v103
    v_add_f32 v96, 1.0, v96
    v_add_f32 v97, 1.0, v97
    v_add_f32 v98, 1.0, v98
    v_add_f32 v99, 1.0, v99
    v_add_f32 v100, 1.0, v100
    v_add_f32 v101, 1.0, v101
    v_add_f32 v102, 1.0, v102
    v_add_f32 v103, 1.0, v103
    v_rcp_f32 v96, v96
    v_rcp_f32 v97, v97
    v_rcp_f32 v98, v98
    v_rcp_f32 v99, v99
    v_rcp_f32 v100, v100
    v_rcp_f32 v101, v101
    v_rcp_f32 v102, v102
    v_rcp_f32 v103, v103
    v_mul_f32 v96, v96, v232
    v_mul_f32 v97, v97, v233
    v_mul_f32 v98, v98, v234
    v_mul_f32 v99, v99, v235
    v_mul_f32 v100, v100, v236
    v_mul_f32 v101, v101, v237
    v_mul_f32 v102, v102, v238
    v_mul_f32 v103, v103, v239
    v_cvt_pk_bf16_f32 v88, v96, v97
    v_cvt_pk_bf16_f32 v89, v98, v99
    v_cvt_pk_bf16_f32 v90, v100, v101
    v_cvt_pk_bf16_f32 v91, v102, v103
    buffer_store_dwordx4 v[88:91], v1, s[4:7], s30 offen sc1
    s_add_u32 s30, s30, s50
    v_cvt_pk_bf16_f32 v92, v240, v241
    v_cvt_pk_bf16_f32 v93, v242, v243
    v_cvt_pk_bf16_f32 v94, v244, v245
    v_cvt_pk_bf16_f32 v95, v246, v247
    v_lshlrev_b32 v104, 16, v92
    v_and_b32 v105, 0xffff0000, v92
    v_lshlrev_b32 v106, 16, v93
    v_and_b32 v107, 0xffff0000, v93
    v_lshlrev_b32 v108, 16, v94
    v_and_b32 v109, 0xffff0000, v94
    v_lshlrev_b32 v110, 16, v95
    v_and_b32 v111, 0xffff0000, v95
    v_mul_f32 v104, s54, v104
    v_mul_f32 v105, s54, v105
    v_mul_f32 v106, s54, v106
    v_mul_f32 v107, s54, v107
    v_mul_f32 v108, s54, v108
    v_mul_f32 v109, s54, v109
    v_mul_f32 v110, s54, v110
    v_mul_f32 v111, s54, v111
    v_exp_f32 v104, v104
    v_exp_f32 v105, v105
    v_exp_f32 v106, v106
    v_exp_f32 v107, v107
    v_exp_f32 v108, v108
    v_exp_f32 v109, v109
    v_exp_f32 v110, v110
    v_exp_f32 v111, v111
    v_add_f32 v104, 1.0, v104
    v_add_f32 v105, 1.0, v105
    v_add_f32 v106, 1.0, v106
    v_add_f32 v107, 1.0, v107
    v_add_f32 v108, 1.0, v108
    v_add_f32 v109, 1.0, v109
    v_add_f32 v110, 1.0, v110
    v_add_f32 v111, 1.0, v111
    v_rcp_f32 v104, v104
    v_rcp_f32 v105, v105
    v_rcp_f32 v106, v106
    v_rcp_f32 v107, v107
    v_rcp_f32 v108, v108
    v_rcp_f32 v109, v109
    v_rcp_f32 v110, v110
    v_rcp_f32 v111, v111
    v_mul_f32 v104, v104, v248
    v_mul_f32 v105, v105, v249
    v_mul_f32 v106, v106, v250
    v_mul_f32 v107, v107, v251
    v_mul_f32 v108, v108, v252
    v_mul_f32 v109, v109, v253
    v_mul_f32 v110, v110, v254
    v_mul_f32 v111, v111, v255
    v_cvt_pk_bf16_f32 v92, v104, v105
    v_cvt_pk_bf16_f32 v93, v106, v107
    v_cvt_pk_bf16_f32 v94, v108, v109
    v_cvt_pk_bf16_f32 v95, v110, v111
    buffer_store_dwordx4 v[92:95], v1, s[4:7], s30 offen sc1
    s_waitcnt lgkmcnt(0)
    v_or3_b32 v24, v24, v25, v26
    v_or3_b32 v28, v28, v29, v30
    v_or3_b32 v24, v24, v27, v31
    v_or_b32 v24, v24, v28
    s_mov_b32 s28, s51
    v_readfirstlane_b32 s30, v24
    s_cmp_lg_u32 s30, 0
    s_cbranch_scc1 w_drain
    s_mov_b32 s48, s32
    s_cmp_eq_u32 s32, 4
    s_cselect_b32 s30, 2, 3
    s_lshl_b32 s30, s26, s30
    s_mul_i32 s30, s30, s43
    s_add_u32 s49, s42, s30
    s_mov_b32 s50, s43
    s_mov_b32 s51, s46
    s_mov_b32 s23, s41
    s_mov_b32 s53, s41
    s_branch w_first8
w_firstH:
    s_waitcnt vmcnt(8)
    s_barrier
    s_add_u32 m0, s21, 0
    s_nop 0
    buffer_load_dwordx4 v1, s[4:7], s16 offen sc1 lds
    s_add_u32 s16, s16, s62
    s_add_u32 m0, s21, 1024
    s_nop 0
    buffer_load_dwordx4 v1, s[4:7], s17 offen sc1 lds
    s_add_u32 s17, s17, s62
    s_add_u32 m0, s22, 0
    s_nop 0
    buffer_load_dwordx4 v2, s[8:11], s18 offen lds
    s_add_u32 s18, s18, s20
    s_add_u32 m0, s22, 8192
    s_nop 0
    buffer_load_dwordx4 v2, s[12:15], s19 offen lds
    s_add_u32 s19, s19, s20
    v_mfma_f32_16x16x32_bf16 v[128:131], v[64:67], v[32:35], 0
    ds_read_b64_tr_b16 v[112:113], v8 offset:49152
    v_mfma_f32_16x16x32_bf16 v[132:135], v[68:71], v[32:35], 0
    ds_read_b64_tr_b16 v[114:115], v9 offset:49152
    v_mfma_f32_16x16x32_bf16 v[144:147], v[64:67], v[40:43], 0
    ds_read_b64_tr_b16 v[116:117], v10 offset:49152
    v_mfma_f32_16x16x32_bf16 v[148:151], v[68:71], v[40:43], 0
    ds_read_b64_tr_b16 v[118:119], v11 offset:49152
    v_mfma_f32_16x16x32_bf16 v[160:163], v[64:67], v[48:51], 0
    ds_read_b64_tr_b16 v[120:121], v8 offset:57344
    v_mfma_f32_16x16x32_bf16 v[164:167], v[68:71], v[48:51], 0
    ds_read_b64_tr_b16 v[122:123], v9 offset:57344
    v_mfma_f32_16x16x32_bf16 v[176:179], v[64:67], v[56:59], 0
    ds_read_b64_tr_b16 v[124:125], v10 offset:57344
    v_mfma_f32_16x16x32_bf16 v[180:183], v[68:71], v[56:59], 0
    ds_read_b64_tr_b16 v[126:127], v11 offset:57344
    v_mfma_f32_16x16x32_bf16 v[128:131], v[72:75], v[36:39], v[128:131]
    ds_read_b128 v[80:83], v5 offset:32768
    v_mfma_f32_16x16x32_bf16 v[132:135], v[76:79], v[36:39], v[132:135]
    ds_read_b128 v[84:87], v5 offset:33792
    v_mfma_f32_16x16x32_bf16 v[144:147], v[72:75], v[44:47], v[144:147]
    ds_read_b128 v[88:91], v5 offset:34816
    v_mfma_f32_16x16x32_bf16 v[148:151], v[76:79], v[44:47], v[148:151]
    ds_read_b128 v[92:95], v5 offset:35840
    v_mfma_f32_16x16x32_bf16 v[160:163], v[72:75], v[52:55], v[160:163]
    ds_read_b128 v[96:99], v5 offset:36864
    v_mfma_f32_16x16x32_bf16 v[164:167], v[76:79], v[52:55], v[164:167]
    ds_read_b128 v[100:103], v5 offset:37888
    v_mfma_f32_16x16x32_bf16 v[176:179], v[72:75], v[60:63], v[176:179]
    ds_read_b128 v[104:107], v5 offset:38912
    v_mfma_f32_16x16x32_bf16 v[180:183], v[76:79], v[60:63], v[180:183]
    ds_read_b128 v[108:111], v5 offset:39936
    s_waitcnt lgkmcnt(0)
    s_waitcnt vmcnt(8)
    s_barrier
    s_add_u32 m0, s21, 32768
    s_nop 0
    buffer_load_dwordx4 v1, s[4:7], s16 offen sc1 lds
    s_add_u32 s16, s16, s62
    s_add_u32 m0, s21, 33792
    s_nop 0
    buffer_load_dwordx4 v1, s[4:7], s17 offen sc1 lds
    s_add_u32 s17, s17, s62
    s_add_u32 m0, s22, 32768
    s_nop 0
    buffer_load_dwordx4 v2, s[8:11], s18 offen lds
    s_add_u32 s18, s18, s20
    s_add_u32 m0, s22, 40960
    s_nop 0
    buffer_load_dwordx4 v2, s[12:15], s19 offen lds
    s_add_u32 s19, s19, s20
    v_mfma_f32_16x16x32_bf16 v[128:131], v[112:115], v[80:83], v[128:131]
    ds_read_b64_tr_b16 v[64:65], v12 offset:16384
    v_mfma_f32_16x16x32_bf16 v[132:135], v[116:119], v[80:83], v[132:135]
    ds_read_b64_tr_b16 v[66:67], v13 offset:16384
    v_mfma_f32_16x16x32_bf16 v[144:147], v[112:115], v[88:91], v[144:147]
    ds_read_b64_tr_b16 v[68:69], v14 offset:16384
    v_mfma_f32_16x16x32_bf16 v[148:151], v[116:119], v[88:91], v[148:151]
    ds_read_b64_tr_b16 v[70:71], v15 offset:16384
    v_mfma_f32_16x16x32_bf16 v[160:163], v[112:115], v[96:99], v[160:163]
    ds_read_b64_tr_b16 v[72:73], v12 offset:24576
    v_mfma_f32_16x16x32_bf16 v[164:167], v[116:119], v[96:99], v[164:167]
    ds_read_b64_tr_b16 v[74:75], v13 offset:24576
    v_mfma_f32_16x16x32_bf16 v[176:179], v[112:115], v[104:107], v[176:179]
    ds_read_b64_tr_b16 v[76:77], v14 offset:24576
    v_mfma_f32_16x16x32_bf16 v[180:183], v[116:119], v[104:107], v[180:183]
    ds_read_b64_tr_b16 v[78:79], v15 offset:24576
    v_mfma_f32_16x16x32_bf16 v[128:131], v[120:123], v[84:87], v[128:131]
    ds_read_b128 v[32:35], v6 offset:0
    v_mfma_f32_16x16x32_bf16 v[132:135], v[124:127], v[84:87], v[132:135]
    ds_read_b128 v[36:39], v6 offset:1024
    v_mfma_f32_16x16x32_bf16 v[144:147], v[120:123], v[92:95], v[144:147]
    ds_read_b128 v[40:43], v6 offset:2048
    v_mfma_f32_16x16x32_bf16 v[148:151], v[124:127], v[92:95], v[148:151]
    ds_read_b128 v[44:47], v6 offset:3072
    v_mfma_f32_16x16x32_bf16 v[160:163], v[120:123], v[100:103], v[160:163]
    ds_read_b128 v[48:51], v6 offset:4096
    v_mfma_f32_16x16x32_bf16 v[164:167], v[124:127], v[100:103], v[164:167]
    ds_read_b128 v[52:55], v6 offset:5120
    v_mfma_f32_16x16x32_bf16 v[176:179], v[120:123], v[108:111], v[176:179]
    ds_read_b128 v[56:59], v6 offset:6144
    v_mfma_f32_16x16x32_bf16 v[180:183], v[124:127], v[108:111], v[180:183]
    ds_read_b128 v[60:63], v6 offset:7168
    s_waitcnt lgkmcnt(0)
    s_waitcnt vmcnt(8)
    s_barrier
    s_add_u32 m0, s21, 65536
    s_nop 0
    buffer_load_dwordx4 v1, s[4:7], s16 offen sc1 lds
    s_add_u32 s16, s16, s62
    s_add_u32 m0, s21, 66560
    s_nop 0
    buffer_load_dwordx4 v1, s[4:7], s17 offen sc1 lds
    s_add_u32 s17, s17, s62
    s_add_u32 m0, s22, 65536
    s_nop 0
    buffer_load_dwordx4 v2, s[8:11], s18 offen lds
    s_add_u32 s18, s18, s20
    s_add_u32 m0, s22, 73728
    s_nop 0
    buffer_load_dwordx4 v2, s[12:15], s19 offen lds
    s_add_u32 s19, s19, s20
    v_mfma_f32_16x16x32_bf16 v[128:131], v[64:67], v[32:35], v[128:131]
    ds_read_b64_tr_b16 v[112:113], v12 offset:49152
    v_mfma_f32_16x16x32_bf16 v[132:135], v[68:71], v[32:35], v[132:135]
    ds_read_b64_tr_b16 v[114:115], v13 offset:49152
    v_mfma_f32_16x16x32_bf16 v[144:147], v[64:67], v[40:43], v[144:147]
    ds_read_b64_tr_b16 v[116:117], v14 offset:49152
    v_mfma_f32_16x16x32_bf16 v[148:151], v[68:71], v[40:43], v[148:151]
    ds_read_b64_tr_b16 v[118:119], v15 offset:49152
    v_mfma_f32_16x16x32_bf16 v[160:163], v[64:67], v[48:51], v[160:163]
    ds_read_b64_tr_b16 v[120:121], v12 offset:57344
    v_mfma_f32_16x16x32_bf16 v[164:167], v[68:71], v[48:51], v[164:167]
    ds_read_b64_tr_b16 v[122:123], v13 offset:57344
    v_mfma_f32_16x16x32_bf16 v[176:179], v[64:67], v[56:59], v[176:179]
    ds_read_b64_tr_b16 v[124:125], v14 offset:57344
    v_mfma_f32_16x16x32_bf16 v[180:183], v[68:71], v[56:59], v[180:183]
    ds_read_b64_tr_b16 v[126:127], v15 offset:57344
    v_mfma_f32_16x16x32_bf16 v[128:131], v[72:75], v[36:39], v[128:131]
    ds_read_b128 v[80:83], v6 offset:32768
    v_mfma_f32_16x16x32_bf16 v[132:135], v[76:79], v[36:39], v[132:135]
    ds_read_b128 v[84:87], v6 offset:33792
    v_mfma_f32_16x16x32_bf16 v[144:147], v[72:75], v[44:47], v[144:147]
    ds_read_b128 v[88:91], v6 offset:34816
    v_mfma_f32_16x16x32_bf16 v[148:151], v[76:79], v[44:47], v[148:151]
    ds_read_b128 v[92:95], v6 offset:35840
    v_mfma_f32_16x16x32_bf16 v[160:163], v[72:75], v[52:55], v[160:163]
    ds_read_b128 v[96:99], v6 offset:36864
    v_mfma_f32_16x16x32_bf16 v[164:167], v[76:79], v[52:55], v[164:167]
    ds_read_b128 v[100:103], v6 offset:37888
    v_mfma_f32_16x16x32_bf16 v[176:179], v[72:75], v[60:63], v[176:179]
    ds_read_b128 v[104:107], v6 offset:38912
    v_mfma_f32_16x16x32_bf16 v[180:183], v[76:79], v[60:63], v[180:183]
    ds_read_b128 v[108:111], v6 offset:39936
    s_waitcnt lgkmcnt(0)
    s_waitcnt vmcnt(8)
    s_barrier
    s_add_u32 m0, s21, 98304
    s_nop 0
    buffer_load_dwordx4 v1, s[4:7], s16 offen sc1 lds
    s_add_u32 s16, s16, s62
    s_add_u32 m0, s21, 99328
    s_nop 0
    buffer_load_dwordx4 v1, s[4:7], s17 offen sc1 lds
    s_add_u32 s17, s17, s62
    s_add_u32 m0, s22, 98304
    s_nop 0
    buffer_load_dwordx4 v2, s[8:11], s18 offen lds
    s_add_u32 s18, s18, s20
    s_add_u32 m0, s22, 106496
    s_nop 0
    buffer_load_dwordx4 v2, s[12:15], s19 offen lds
    s_add_u32 s19, s19, s20
    v_mfma_f32_16x16x32_bf16 v[128:131], v[112:115], v[80:83], v[128:131]
    ds_read_b64_tr_b16 v[64:65], v8 offset:16384
    v_mfma_f32_16x16x32_bf16 v[132:135], v[116:119], v[80:83], v[132:135]
    ds_read_b64_tr_b16 v[66:67], v9 offset:16384
    v_mfma_f32_16x16x32_bf16 v[144:147], v[112:115], v[88:91], v[144:147]
    ds_read_b64_tr_b16 v[68:69], v10 offset:16384
    v_mfma_f32_16x16x32_bf16 v[148:151], v[116:119], v[88:91], v[148:151]
    ds_read_b64_tr_b16 v[70:71], v11 offset:16384
    v_mfma_f32_16x16x32_bf16 v[160:163], v[112:115], v[96:99], v[160:163]
    ds_read_b64_tr_b16 v[72:73], v8 offset:24576
    v_mfma_f32_16x16x32_bf16 v[164:167], v[116:119], v[96:99], v[164:167]
    ds_read_b64_tr_b16 v[74:75], v9 offset:24576
    v_mfma_f32_16x16x32_bf16 v[176:179], v[112:115], v[104:107], v[176:179]
    ds_read_b64_tr_b16 v[76:77], v10 offset:24576
    v_mfma_f32_16x16x32_bf16 v[180:183], v[116:119], v[104:107], v[180:183]
    ds_read_b64_tr_b16 v[78:79], v11 offset:24576
    v_mfma_f32_16x16x32_bf16 v[128:131], v[120:123], v[84:87], v[128:131]
    ds_read_b128 v[32:35], v5 offset:0
    v_mfma_f32_16x16x32_bf16 v[132:135], v[124:127], v[84:87], v[132:135]
    ds_read_b128 v[36:39], v5 offset:1024
    v_mfma_f32_16x16x32_bf16 v[144:147], v[120:123], v[92:95], v[144:147]
    ds_read_b128 v[40:43], v5 offset:2048
    v_mfma_f32_16x16x32_bf16 v[148:151], v[124:127], v[92:95], v[148:151]
    ds_read_b128 v[44:47], v5 offset:3072
    v_mfma_f32_16x16x32_bf16 v[160:163], v[120:123], v[100:103], v[160:163]
    ds_read_b128 v[48:51], v5 offset:4096
    v_mfma_f32_16x16x32_bf16 v[164:167], v[124:127], v[100:103], v[164:167]
    ds_read_b128 v[52:55], v5 offset:5120
    v_mfma_f32_16x16x32_bf16 v[176:179], v[120:123], v[108:111], v[176:179]
    ds_read_b128 v[56:59], v5 offset:6144
    v_mfma_f32_16x16x32_bf16 v[180:183], v[124:127], v[108:111], v[180:183]
    ds_read_b128 v[60:63], v5 offset:7168
    s_waitcnt lgkmcnt(0)
w_loop_chkH:
    s_sub_u32 s23, s23, 1
w_loopH:
    s_cmp_gt_u32 s23, 3
    s_cbranch_scc1 w_bodyH
    s_cmp_lg_u32 s23, 3
    s_cbranch_scc1 w_l2H
    s_cmp_lg_u32 s3, 0
    s_cbranch_scc1 clm_7
    v_mov_b32 v26, 1
    s_mov_b64 exec, 1
    buffer_atomic_add v26, off, s[64:67], s71 sc0 sc1
    s_mov_b64 exec, -1
clm_7:
    s_branch w_bodyH
w_l2H:
    s_cmp_lg_u32 s23, 2
    s_cbranch_scc1 w_l1H
    s_cmp_lg_u32 s3, 0
    s_cbranch_scc1 pub_8
    v_mov_b32 v20, 131136
    s_mov_b64 exec, 1
    ds_write_b32 v20, v26
    s_mov_b64 exec, -1
    s_waitcnt lgkmcnt(0)
pub_8:
    s_branch w_bodyH
w_l1H:
    s_waitcnt vmcnt(8)
    buffer_load_dword v22, off, s[64:67], 0 sc1
    v_readfirstlane_b32 s30, v16
    s_cmp_ge_u32 s30, s45
    s_cselect_b32 s30, 0, 1
    s_or_b32 s30, s30, s70
    s_cmp_eq_u32 s32, 4
    s_cselect_b32 s30, 1, s30
    s_sub_u32 s57, s32, 1
    s_cmp_ge_u32 s57, 4
    s_cselect_b32 s30, 1, s30
    v_mov_b32 v20, s30
    ds_write_b32 v7, v20
    s_cbranch_scc1 w_bodyH
    s_load_dwordx2 s[8:9], s[0:1], s33
    s_load_dwordx2 s[12:13], s[0:1], s34
    s_mov_b32 s10, s38
    s_mov_b32 s14, s38
    s_cmp_eq_u32 s32, 4
    s_cselect_b32 s31, 0, 1
    s_lshl_b32 s30, s3, s31
    s_mul_i32 s30, s30, s40
    s_add_u32 s16, s39, s30
    s_cmp_eq_u32 s32, 4
    s_cselect_b32 s30, 1024, s40
    s_cselect_b32 s31, 6, 5
    s_lshl_b32 s62, 32, s31
    s_add_u32 s17, s16, s30
    s_lshl_b32 s30, s3, 2
    s_mul_i32 s30, s30, s35
    s_add_u32 s18, s36, s30
    s_add_u32 s19, s37, s30
    s_lshl_b32 s20, s35, s31
    v_mul_u32_u24 v2, s35, v4
    v_add_u32 v2, v2, v3
    s_waitcnt lgkmcnt(0)
w_bodyH:
    s_waitcnt vmcnt(8)
    s_barrier
    s_cmp_lg_u32 s23, 2
    s_cbranch_scc1 w_nfH
    v_mov_b32 v20, 131136
    ds_read_b32 v20, v20
    s_waitcnt lgkmcnt(0)
    v_readfirstlane_b32 s59, v20
    s_add_u32 s59, s59, 32
    s_min_u32 s59, s59, 319
    s_lshl_b32 s57, s59, 6
    s_load_dwordx16 s[32:47], s[24:25], s57
w_nfH:
    s_add_u32 m0, s21, 0
    s_nop 0
    buffer_load_dwordx4 v1, s[4:7], s16 offen sc1 lds
    s_add_u32 s16, s16, s62
    s_add_u32 m0, s21, 1024
    s_nop 0
    buffer_load_dwordx4 v1, s[4:7], s17 offen sc1 lds
    s_add_u32 s17, s17, s62
    s_add_u32 m0, s22, 0
    s_nop 0
    buffer_load_dwordx4 v2, s[8:11], s18 offen lds
    s_add_u32 s18, s18, s20
    s_add_u32 m0, s22, 8192
    s_nop 0
    buffer_load_dwordx4 v2, s[12:15], s19 offen lds
    s_add_u32 s19, s19, s20
    v_mfma_f32_16x16x32_bf16 v[128:131], v[64:67], v[32:35], v[128:131]
    ds_read_b64_tr_b16 v[112:113], v8 offset:49152
    v_mfma_f32_16x16x32_bf16 v[132:135], v[68:71], v[32:35], v[132:135]
    ds_read_b64_tr_b16 v[114:115], v9 offset:49152
    v_mfma_f32_16x16x32_bf16 v[144:147], v[64:67], v[40:43], v[144:147]
    ds_read_b64_tr_b16 v[116:117], v10 offset:49152
    v_mfma_f32_16x16x32_bf16 v[148:151], v[68:71], v[40:43], v[148:151]
    ds_read_b64_tr_b16 v[118:119], v11 offset:49152
    v_mfma_f32_16x16x32_bf16 v[160:163], v[64:67], v[48:51], v[160:163]
    ds_read_b64_tr_b16 v[120:121], v8 offset:57344
    v_mfma_f32_16x16x32_bf16 v[164:167], v[68:71], v[48:51], v[164:167]
    ds_read_b64_tr_b16 v[122:123], v9 offset:57344
    v_mfma_f32_16x16x32_bf16 v[176:179], v[64:67], v[56:59], v[176:179]
    ds_read_b64_tr_b16 v[124:125], v10 offset:57344
    v_mfma_f32_16x16x32_bf16 v[180:183], v[68:71], v[56:59], v[180:183]
    ds_read_b64_tr_b16 v[126:127], v11 offset:57344
    v_mfma_f32_16x16x32_bf16 v[128:131], v[72:75], v[36:39], v[128:131]
    ds_read_b128 v[80:83], v5 offset:32768
    v_mfma_f32_16x16x32_bf16 v[132:135], v[76:79], v[36:39], v[132:135]
    ds_read_b128 v[84:87], v5 offset:33792
    v_mfma_f32_16x16x32_bf16 v[144:147], v[72:75], v[44:47], v[144:147]
    ds_read_b128 v[88:91], v5 offset:34816
    v_mfma_f32_16x16x32_bf16 v[148:151], v[76:79], v[44:47], v[148:151]
    ds_read_b128 v[92:95], v5 offset:35840
    v_mfma_f32_16x16x32_bf16 v[160:163], v[72:75], v[52:55], v[160:163]
    ds_read_b128 v[96:99], v5 offset:36864
    v_mfma_f32_16x16x32_bf16 v[164:167], v[76:79], v[52:55], v[164:167]
    ds_read_b128 v[100:103], v5 offset:37888
    v_mfma_f32_16x16x32_bf16 v[176:179], v[72:75], v[60:63], v[176:179]
    ds_read_b128 v[104:107], v5 offset:38912
    v_mfma_f32_16x16x32_bf16 v[180:183], v[76:79], v[60:63], v[180:183]
    ds_read_b128 v[108:111], v5 offset:39936
    s_waitcnt lgkmcnt(0)
    s_waitcnt vmcnt(8)
    s_barrier
    buffer_load_dword v16, v17, s[4:7], s44 offen sc1
    s_add_u32 m0, s21, 32768
    s_nop 0
    buffer_load_dwordx4 v1, s[4:7], s16 offen sc1 lds
    s_add_u32 s16, s16, s62
    s_add_u32 m0, s21, 33792
    s_nop 0
    buffer_load_dwordx4 v1, s[4:7], s17 offen sc1 lds
    s_add_u32 s17, s17, s62
    s_add_u32 m0, s22, 32768
    s_nop 0
    buffer_load_dwordx4 v2, s[8:11], s18 offen lds
    s_add_u32 s18, s18, s20
    s_add_u32 m0, s22, 40960
    s_nop 0
    buffer_load_dwordx4 v2, s[12:15], s19 offen lds
    s_add_u32 s19, s19, s20
    v_mfma_f32_16x16x32_bf16 v[128:131], v[112:115], v[80:83], v[128:131]
    ds_read_b64_tr_b16 v[64:65], v12 offset:16384
    v_mfma_f32_16x16x32_bf16 v[132:135], v[116:119], v[80:83], v[132:135]
    ds_read_b64_tr_b16 v[66:67], v13 offset:16384
    v_mfma_f32_16x16x32_bf16 v[144:147], v[112:115], v[88:91], v[144:147]
    ds_read_b64_tr_b16 v[68:69], v14 offset:16384
    v_mfma_f32_16x16x32_bf16 v[148:151], v[116:119], v[88:91], v[148:151]
    ds_read_b64_tr_b16 v[70:71], v15 offset:16384
    v_mfma_f32_16x16x32_bf16 v[160:163], v[112:115], v[96:99], v[160:163]
    ds_read_b64_tr_b16 v[72:73], v12 offset:24576
    v_mfma_f32_16x16x32_bf16 v[164:167], v[116:119], v[96:99], v[164:167]
    ds_read_b64_tr_b16 v[74:75], v13 offset:24576
    v_mfma_f32_16x16x32_bf16 v[176:179], v[112:115], v[104:107], v[176:179]
    ds_read_b64_tr_b16 v[76:77], v14 offset:24576
    v_mfma_f32_16x16x32_bf16 v[180:183], v[116:119], v[104:107], v[180:183]
    ds_read_b64_tr_b16 v[78:79], v15 offset:24576
    v_mfma_f32_16x16x32_bf16 v[128:131], v[120:123], v[84:87], v[128:131]
    ds_read_b128 v[32:35], v6 offset:0
    v_mfma_f32_16x16x32_bf16 v[132:135], v[124:127], v[84:87], v[132:135]
    ds_read_b128 v[36:39], v6 offset:1024
    v_mfma_f32_16x16x32_bf16 v[144:147], v[120:123], v[92:95], v[144:147]
    ds_read_b128 v[40:43], v6 offset:2048
    v_mfma_f32_16x16x32_bf16 v[148:151], v[124:127], v[92:95], v[148:151]
    ds_read_b128 v[44:47], v6 offset:3072
    v_mfma_f32_16x16x32_bf16 v[160:163], v[120:123], v[100:103], v[160:163]
    ds_read_b128 v[48:51], v6 offset:4096
    v_mfma_f32_16x16x32_bf16 v[164:167], v[124:127], v[100:103], v[164:167]
    ds_read_b128 v[52:55], v6 offset:5120
    v_mfma_f32_16x16x32_bf16 v[176:179], v[120:123], v[108:111], v[176:179]
    ds_read_b128 v[56:59], v6 offset:6144
    v_mfma_f32_16x16x32_bf16 v[180:183], v[124:127], v[108:111], v[180:183]
    ds_read_b128 v[60:63], v6 offset:7168
    s_waitcnt lgkmcnt(0)
    s_waitcnt vmcnt(8)
    s_barrier
    s_add_u32 m0, s21, 65536
    s_nop 0
    buffer_load_dwordx4 v1, s[4:7], s16 offen sc1 lds
    s_add_u32 s16, s16, s62
    s_add_u32 m0, s21, 66560
    s_nop 0
    buffer_load_dwordx4 v1, s[4:7], s17 offen sc1 lds
    s_add_u32 s17, s17, s62
    s_add_u32 m0, s22, 65536
    s_nop 0
    buffer_load_dwordx4 v2, s[8:11], s18 offen lds
    s_add_u32 s18, s18, s20
    s_add_u32 m0, s22, 73728
    s_nop 0
    buffer_load_dwordx4 v2, s[12:15], s19 offen lds
    s_add_u32 s19, s19, s20
    v_mfma_f32_16x16x32_bf16 v[128:131], v[64:67], v[32:35], v[128:131]
    ds_read_b64_tr_b16 v[112:113], v12 offset:49152
    v_mfma_f32_16x16x32_bf16 v[132:135], v[68:71], v[32:35], v[132:135]
    ds_read_b64_tr_b16 v[114:115], v13 offset:49152
    v_mfma_f32_16x16x32_bf16 v[144:147], v[64:67], v[40:43], v[144:147]
    ds_read_b64_tr_b16 v[116:117], v14 offset:49152
    v_mfma_f32_16x16x32_bf16 v[148:151], v[68:71], v[40:43], v[148:151]
    ds_read_b64_tr_b16 v[118:119], v15 offset:49152
    v_mfma_f32_16x16x32_bf16 v[160:163], v[64:67], v[48:51], v[160:163]
    ds_read_b64_tr_b16 v[120:121], v12 offset:57344
    v_mfma_f32_16x16x32_bf16 v[164:167], v[68:71], v[48:51], v[164:167]
    ds_read_b64_tr_b16 v[122:123], v13 offset:57344
    v_mfma_f32_16x16x32_bf16 v[176:179], v[64:67], v[56:59], v[176:179]
    ds_read_b64_tr_b16 v[124:125], v14 offset:57344
    v_mfma_f32_16x16x32_bf16 v[180:183], v[68:71], v[56:59], v[180:183]
    ds_read_b64_tr_b16 v[126:127], v15 offset:57344
    v_mfma_f32_16x16x32_bf16 v[128:131], v[72:75], v[36:39], v[128:131]
    ds_read_b128 v[80:83], v6 offset:32768
    v_mfma_f32_16x16x32_bf16 v[132:135], v[76:79], v[36:39], v[132:135]
    ds_read_b128 v[84:87], v6 offset:33792
    v_mfma_f32_16x16x32_bf16 v[144:147], v[72:75], v[44:47], v[144:147]
    ds_read_b128 v[88:91], v6 offset:34816
    v_mfma_f32_16x16x32_bf16 v[148:151], v[76:79], v[44:47], v[148:151]
    ds_read_b128 v[92:95], v6 offset:35840
    v_mfma_f32_16x16x32_bf16 v[160:163], v[72:75], v[52:55], v[160:163]
    ds_read_b128 v[96:99], v6 offset:36864
    v_mfma_f32_16x16x32_bf16 v[164:167], v[76:79], v[52:55], v[164:167]
    ds_read_b128 v[100:103], v6 offset:37888
    v_mfma_f32_16x16x32_bf16 v[176:179], v[72:75], v[60:63], v[176:179]
    ds_read_b128 v[104:107], v6 offset:38912
    v_mfma_f32_16x16x32_bf16 v[180:183], v[76:79], v[60:63], v[180:183]
    ds_read_b128 v[108:111], v6 offset:39936
    s_waitcnt lgkmcnt(0)
    s_waitcnt vmcnt(8)
    s_barrier
    s_add_u32 m0, s21, 98304
    s_nop 0
    buffer_load_dwordx4 v1, s[4:7], s16 offen sc1 lds
    s_add_u32 s16, s16, s62
    s_add_u32 m0, s21, 99328
    s_nop 0
    buffer_load_dwordx4 v1, s[4:7], s17 offen sc1 lds
    s_add_u32 s17, s17, s62
    s_add_u32 m0, s22, 98304
    s_nop 0
    buffer_load_dwordx4 v2, s[8:11], s18 offen lds
    s_add_u32 s18, s18, s20
    s_add_u32 m0, s22, 106496
    s_nop 0
    buffer_load_dwordx4 v2, s[12:15], s19 offen lds
    s_add_u32 s19, s19, s20
    v_mfma_f32_16x16x32_bf16 v[128:131], v[112:115], v[80:83], v[128:131]
    ds_read_b64_tr_b16 v[64:65], v8 offset:16384
    v_mfma_f32_16x16x32_bf16 v[132:135], v[116:119], v[80:83], v[132:135]
    ds_read_b64_tr_b16 v[66:67], v9 offset:16384
    v_mfma_f32_16x16x32_bf16 v[144:147], v[112:115], v[88:91], v[144:147]
    ds_read_b64_tr_b16 v[68:69], v10 offset:16384
    v_mfma_f32_16x16x32_bf16 v[148:151], v[116:119], v[88:91], v[148:151]
    ds_read_b64_tr_b16 v[70:71], v11 offset:16384
    v_mfma_f32_16x16x32_bf16 v[160:163], v[112:115], v[96:99], v[160:163]
    ds_read_b64_tr_b16 v[72:73], v8 offset:24576
    v_mfma_f32_16x16x32_bf16 v[164:167], v[116:119], v[96:99], v[164:167]
    ds_read_b64_tr_b16 v[74:75], v9 offset:24576
    v_mfma_f32_16x16x32_bf16 v[176:179], v[112:115], v[104:107], v[176:179]
    ds_read_b64_tr_b16 v[76:77], v10 offset:24576
    v_mfma_f32_16x16x32_bf16 v[180:183], v[116:119], v[104:107], v[180:183]
    ds_read_b64_tr_b16 v[78:79], v11 offset:24576
    v_mfma_f32_16x16x32_bf16 v[128:131], v[120:123], v[84:87], v[128:131]
    ds_read_b128 v[32:35], v5 offset:0
    v_mfma_f32_16x16x32_bf16 v[132:135], v[124:127], v[84:87], v[132:135]
    ds_read_b128 v[36:39], v5 offset:1024
    v_mfma_f32_16x16x32_bf16 v[144:147], v[120:123], v[92:95], v[144:147]
    ds_read_b128 v[40:43], v5 offset:2048
    v_mfma_f32_16x16x32_bf16 v[148:151], v[124:127], v[92:95], v[148:151]
    ds_read_b128 v[44:47], v5 offset:3072
    v_mfma_f32_16x16x32_bf16 v[160:163], v[120:123], v[100:103], v[160:163]
    ds_read_b128 v[48:51], v5 offset:4096
    v_mfma_f32_16x16x32_bf16 v[164:167], v[124:127], v[100:103], v[164:167]
    ds_read_b128 v[52:55], v5 offset:5120
    v_mfma_f32_16x16x32_bf16 v[176:179], v[120:123], v[108:111], v[176:179]
    ds_read_b128 v[56:59], v5 offset:6144
    v_mfma_f32_16x16x32_bf16 v[180:183], v[124:127], v[108:111], v[180:183]
    ds_read_b128 v[60:63], v5 offset:7168
    s_waitcnt lgkmcnt(0)
    s_sub_u32 s23, s23, 1
    s_cmp_lg_u32 s23, 0
    s_cbranch_scc1 w_loopH
    v_mov_b32 v20, 131072
    ds_read_b128 v[24:27], v20
    ds_read_b128 v[28:31], v20 offset:16
    s_lshl_b32 s30, s27, 10
    s_add_u32 s30, s30, s49
    s_nop 7
    v_cvt_pk_bf16_f32 v80, v128, v129
    v_cvt_pk_bf16_f32 v81, v130, v131
    v_cvt_pk_bf16_f32 v82, v132, v133
    v_cvt_pk_bf16_f32 v83, v134, v135
    buffer_store_dwordx4 v[80:83], v1, s[4:7], s30 offen sc1
    s_add_u32 s30, s30, s50
    v_cvt_pk_bf16_f32 v84, v144, v145
    v_cvt_pk_bf16_f32 v85, v146, v147
    v_cvt_pk_bf16_f32 v86, v148, v149
    v_cvt_pk_bf16_f32 v87, v150, v151
    buffer_store_dwordx4 v[84:87], v1, s[4:7], s30 offen sc1
    s_add_u32 s30, s30, s50
    v_cvt_pk_bf16_f32 v88, v160, v161
    v_cvt_pk_bf16_f32 v89, v162, v163
    v_cvt_pk_bf16_f32 v90, v164, v165
    v_cvt_pk_bf16_f32 v91, v166, v167
    buffer_store_dwordx4 v[88:91], v1, s[4:7], s30 offen sc1
    s_add_u32 s30, s30, s50
    v_cvt_pk_bf16_f32 v92, v176, v177
    v_cvt_pk_bf16_f32 v93, v178, v179
    v_cvt_pk_bf16_f32 v94, v180, v181
    v_cvt_pk_bf16_f32 v95, v182, v183
    buffer_store_dwordx4 v[92:95], v1, s[4:7], s30 offen sc1
    s_add_u32 s30, s30, s50
    s_waitcnt lgkmcnt(0)
    v_or3_b32 v24, v24, v25, v26
    v_or3_b32 v28, v28, v29, v30
    v_or3_b32 v24, v24, v27, v31
    v_or_b32 v24, v24, v28
    s_mov_b32 s28, s51
    v_readfirstlane_b32 s30, v24
    s_cmp_lg_u32 s30, 0
    s_cbranch_scc1 w_drain
    s_mov_b32 s48, s32
    s_cmp_eq_u32 s32, 4
    s_cselect_b32 s30, 2, 3
    s_lshl_b32 s30, s26, s30
    s_mul_i32 s30, s30, s43
    s_add_u32 s49, s42, s30
    s_mov_b32 s50, s43
    s_mov_b32 s51, s46
    s_mov_b32 s23, s41
    s_mov_b32 s53, s41
    s_branch w_first4
w_drain:
    s_waitcnt vmcnt(0)
    s_barrier
    s_cmp_eq_u32 s70, 0
    s_cbranch_scc1 drw_ok
    s_mov_b32 s70, 0
    s_cmp_lg_u32 s3, 0
    s_cbranch_scc1 drw_ok
    v_readfirstlane_b32 s68, v22
    s_cmp_ge_u32 s68, 128
    s_cbranch_scc1 drw_ok
    s_mov_b32 s69, 65536
drw:
    buffer_load_dword v20, off, s[64:67], 0 offset:0 sc1
    s_waitcnt vmcnt(0)
    v_readfirstlane_b32 s68, v20
    s_cmp_ge_u32 s68, 128
    s_cbranch_scc1 drw_ok
    s_sleep 8
    s_sub_u32 s69, s69, 1
    s_cbranch_scc0 drw
drw_ok:
    s_cmp_eq_u32 s28, 0
    s_cbranch_scc1 sig_9
    s_cmp_lg_u32 s3, 0
    s_cbranch_scc1 sig_9
    s_and_b32 s57, s28, 3
    v_mov_b32 v24, s57
    s_bfe_u32 s57, s28, 0x20002
    v_mov_b32 v25, s57
    s_andn2_b32 s28, s28, 15
    s_mov_b64 exec, 1
    buffer_atomic_add_x2 v[24:25], v17, s[4:7], s28 offen sc1
    s_mov_b64 exec, -1
sig_9:
    s_mov_b32 s28, 0
    s_cmp_ge_u32 s53, 4
    s_cbranch_scc1 w_cold
    s_cmp_lg_u32 s3, 0
    s_cbranch_scc1 clm_10
    v_mov_b32 v26, 1
    s_mov_b64 exec, 1
    buffer_atomic_add v26, off, s[64:67], s71 sc0 sc1
    s_mov_b64 exec, -1
clm_10:
    s_waitcnt vmcnt(0)
    s_cmp_lg_u32 s3, 0
    s_cbranch_scc1 pub_11
    v_mov_b32 v20, 131136
    s_mov_b64 exec, 1
    ds_write_b32 v20, v26
    s_mov_b64 exec, -1
    s_waitcnt lgkmcnt(0)
pub_11:
    s_barrier
    v_mov_b32 v20, 131136
    ds_read_b32 v20, v20
    s_waitcnt lgkmcnt(0)
    v_readfirstlane_b32 s59, v20
    s_add_u32 s59, s59, 32
    s_min_u32 s59, s59, 319
    s_lshl_b32 s57, s59, 6
    s_load_dwordx16 s[32:47], s[24:25], s57
    s_waitcnt lgkmcnt(0)
    s_barrier
    s_branch w_cold
w_att:
    s_cmp_lg_u32 s3, 0
    s_cbranch_scc1 w_att_go
    s_mov_b32 s31, 0x40000
w_att_w:
    buffer_load_dwordx2 v[20:21], off, s[4:7], s33 sc1
    s_waitcnt vmcnt(0)
    v_add_u32 v20, v20, v21
    s_nop 0
    v_readfirstlane_b32 s30, v20
    s_cmp_ge_u32 s30, 8
    s_cbranch_scc1 w_att_go
    s_sleep 16
    s_sub_u32 s31, s31, 1
    s_cbranch_scc0 w_att_w
w_att_go:
    s_cmp_lg_u32 s3, 0
    s_cbranch_scc1 clm_12
    v_mov_b32 v250, 1
    s_mov_b64 exec, 1
    buffer_atomic_add v250, off, s[64:67], s71 sc0 sc1
    s_mov_b64 exec, -1
clm_12:
    s_barrier
    v_lshrrev_b32 v20, 4, v1
    v_lshrrev_b32 v21, 4, v20
    v_and_b32 v22, 15, v20
    v_lshlrev_b32 v23, 2, v21
    v_add_u32 v24, 0, v23
    v_cmp_gt_u32 s[72:73], v24, v22
    v_add_u32 v24, 1, v23
    v_cmp_gt_u32 s[74:75], v24, v22
    v_add_u32 v24, 2, v23
    v_cmp_gt_u32 s[76:77], v24, v22
    v_add_u32 v24, 3, v23
    v_cmp_gt_u32 s[78:79], v24, v22
    s_mul_i32 s83, s3, 10240
    v_and_b32 v22, 3, v20
    v_bfe_u32 v24, v20, 2, 2
    v_add_u32 v23, v23, v24
    v_lshl_add_u32 v23, v22, 4, v23
    v_lshlrev_b32 v23, 4, v23
    v_add_u32 v25, s83, v23
    v_and_b32 v24, 1, v24
    v_lshl_add_u32 v24, v21, 1, v24
    v_lshl_add_u32 v24, v22, 3, v24
    v_lshlrev_b32 v24, 4, v24
    v_add_u32 v26, s83, v24
    v_mov_b32 v22, 0xff61b1e6
    v_mov_b32 v136, 0
    v_mov_b32 v137, 0
    v_mov_b32 v220, 0
    v_mov_b32 v221, 0
    s_mov_b32 s80, 0x3e0293ee
    s_lshr_b32 s85, s3, 2
    s_add_u32 s85, s85, s39
    s_lshl_b32 s81, s85, 18
    s_and_b32 s85, s3, 3
    s_add_u32 s85, s85, s36
    s_lshl_b32 s82, s85, 13
    s_add_u32 s82, s82, s81
    s_add_u32 s82, s82, 192937984
    s_lshl_b32 s85, s85, 12
    s_add_u32 s81, s81, s85
    v_mov_b32 v28, 0x3f803f80
    v_mov_b32 v29, 0x3f803f80
    v_mov_b32 v30, 0x3f803f80
    v_mov_b32 v31, 0x3f803f80
    s_add_u32 s86, s82, 0
    buffer_load_dwordx4 v[120:123], v1, s[4:7], s86 offen offset:0 sc1
    buffer_load_dwordx4 v[124:127], v1, s[4:7], s86 offen offset:1024 sc1
    buffer_load_dwordx4 v[128:131], v1, s[4:7], s86 offen offset:2048 sc1
    buffer_load_dwordx4 v[132:135], v1, s[4:7], s86 offen offset:3072 sc1
    s_add_u32 s85, s81, 4194304
    buffer_load_dwordx4 v[56:59], v1, s[4:7], s85 offen offset:0 sc1
    buffer_load_dwordx4 v[60:63], v1, s[4:7], s85 offen offset:1024 sc1
    buffer_load_dwordx4 v[64:67], v1, s[4:7], s85 offen offset:2048 sc1
    buffer_load_dwordx4 v[68:71], v1, s[4:7], s85 offen offset:3072 sc1
    s_add_u32 s85, s81, 4325376
    buffer_load_dwordx4 v[72:75], v1, s[4:7], s85 offen offset:0 sc1
    buffer_load_dwordx4 v[76:79], v1, s[4:7], s85 offen offset:1024 sc1
    buffer_load_dwordx4 v[80:83], v1, s[4:7], s85 offen offset:2048 sc1
    buffer_load_dwordx4 v[84:87], v1, s[4:7], s85 offen offset:3072 sc1
    s_add_u32 s85, s81, 20971520
    buffer_load_dwordx4 v[88:91], v1, s[4:7], s85 offen offset:0 sc1
    buffer_load_dwordx4 v[92:95], v1, s[4:7], s85 offen offset:1024 sc1
    buffer_load_dwordx4 v[96:99], v1, s[4:7], s85 offen offset:2048 sc1
    buffer_load_dwordx4 v[100:103], v1, s[4:7], s85 offen offset:3072 sc1
    s_add_u32 s85, s81, 21102592
    buffer_load_dwordx4 v[104:107], v1, s[4:7], s85 offen offset:0 sc1
    buffer_load_dwordx4 v[108:111], v1, s[4:7], s85 offen offset:1024 sc1
    buffer_load_dwordx4 v[112:115], v1, s[4:7], s85 offen offset:2048 sc1
    buffer_load_dwordx4 v[116:119], v1, s[4:7], s85 offen offset:3072 sc1
    s_add_u32 m0, s83, 0
    s_add_u32 s85, s81, 37748736
    buffer_load_dwordx4 v1, s[4:7], s85 offen offset:0 sc1 lds
    buffer_load_dwordx4 v1, s[4:7], s85 offen offset:1024 sc1 lds
    buffer_load_dwordx4 v1, s[4:7], s85 offen offset:2048 sc1 lds
    buffer_load_dwordx4 v1, s[4:7], s85 offen offset:3072 sc1 lds
    s_add_u32 m0, s83, 4096
    s_add_u32 s85, s81, 37879808
    buffer_load_dwordx4 v1, s[4:7], s85 offen offset:0 sc1 lds
    buffer_load_dwordx4 v1, s[4:7], s85 offen offset:1024 sc1 lds
    buffer_load_dwordx4 v1, s[4:7], s85 offen offset:2048 sc1 lds
    buffer_load_dwordx4 v1, s[4:7], s85 offen offset:3072 sc1 lds
    s_add_u32 m0, s83, 8192
    s_add_u32 s85, s82, 4096
    buffer_load_dwordx4 v1, s[4:7], s85 offen offset:0 sc1 lds
    buffer_load_dwordx4 v1, s[4:7], s85 offen offset:1024 sc1 lds
    s_add_u32 s86, s82, 524288
    buffer_load_dwordx4 v[204:207], v1, s[4:7], s86 offen offset:0 sc1
    buffer_load_dwordx4 v[208:211], v1, s[4:7], s86 offen offset:1024 sc1
    buffer_load_dwordx4 v[212:215], v1, s[4:7], s86 offen offset:2048 sc1
    buffer_load_dwordx4 v[216:219], v1, s[4:7], s86 offen offset:3072 sc1
    s_add_u32 s85, s81, 4718592
    buffer_load_dwordx4 v[140:143], v1, s[4:7], s85 offen offset:0 sc1
    buffer_load_dwordx4 v[144:147], v1, s[4:7], s85 offen offset:1024 sc1
    buffer_load_dwordx4 v[148:151], v1, s[4:7], s85 offen offset:2048 sc1
    buffer_load_dwordx4 v[152:155], v1, s[4:7], s85 offen offset:3072 sc1
    s_add_u32 s85, s81, 4849664
    buffer_load_dwordx4 v[156:159], v1, s[4:7], s85 offen offset:0 sc1
    buffer_load_dwordx4 v[160:163], v1, s[4:7], s85 offen offset:1024 sc1
    buffer_load_dwordx4 v[164:167], v1, s[4:7], s85 offen offset:2048 sc1
    buffer_load_dwordx4 v[168:171], v1, s[4:7], s85 offen offset:3072 sc1
    s_add_u32 s85, s81, 21495808
    buffer_load_dwordx4 v[172:175], v1, s[4:7], s85 offen offset:0 sc1
    buffer_load_dwordx4 v[176:179], v1, s[4:7], s85 offen offset:1024 sc1
    buffer_load_dwordx4 v[180:183], v1, s[4:7], s85 offen offset:2048 sc1
    buffer_load_dwordx4 v[184:187], v1, s[4:7], s85 offen offset:3072 sc1
    s_add_u32 s85, s81, 21626880
    buffer_load_dwordx4 v[188:191], v1, s[4:7], s85 offen offset:0 sc1
    buffer_load_dwordx4 v[192:195], v1, s[4:7], s85 offen offset:1024 sc1
    buffer_load_dwordx4 v[196:199], v1, s[4:7], s85 offen offset:2048 sc1
    buffer_load_dwordx4 v[200:203], v1, s[4:7], s85 offen offset:3072 sc1
    s_add_u32 m0, s83, 81920
    s_add_u32 s85, s81, 38273024
    buffer_load_dwordx4 v1, s[4:7], s85 offen offset:0 sc1 lds
    buffer_load_dwordx4 v1, s[4:7], s85 offen offset:1024 sc1 lds
    buffer_load_dwordx4 v1, s[4:7], s85 offen offset:2048 sc1 lds
    buffer_load_dwordx4 v1, s[4:7], s85 offen offset:3072 sc1 lds
    s_add_u32 m0, s83, 86016
    s_add_u32 s85, s81, 38404096
    buffer_load_dwordx4 v1, s[4:7], s85 offen offset:0 sc1 lds
    buffer_load_dwordx4 v1, s[4:7], s85 offen offset:1024 sc1 lds
    buffer_load_dwordx4 v1, s[4:7], s85 offen offset:2048 sc1 lds
    buffer_load_dwordx4 v1, s[4:7], s85 offen offset:3072 sc1 lds
    s_add_u32 m0, s83, 90112
    s_add_u32 s85, s82, 528384
    buffer_load_dwordx4 v1, s[4:7], s85 offen offset:0 sc1 lds
    buffer_load_dwordx4 v1, s[4:7], s85 offen offset:1024 sc1 lds
    s_waitcnt vmcnt(40)
    v_mfma_f32_16x16x32_bf16 v[32:35], v[88:91], v[56:59], 0
    v_mfma_f32_16x16x32_bf16 v[40:43], v[120:123], v[56:59], 0
    v_mfma_f32_16x16x32_bf16 v[32:35], v[92:95], v[60:63], v[32:35]
    v_mfma_f32_16x16x32_bf16 v[40:43], v[124:127], v[60:63], v[40:43]
    v_mfma_f32_16x16x32_bf16 v[32:35], v[96:99], v[64:67], v[32:35]
    v_mfma_f32_16x16x32_bf16 v[40:43], v[128:131], v[64:67], v[40:43]
    v_mfma_f32_16x16x32_bf16 v[32:35], v[100:103], v[68:71], v[32:35]
    v_mfma_f32_16x16x32_bf16 v[40:43], v[132:135], v[68:71], v[40:43]
    v_mfma_f32_16x16x32_bf16 v[44:47], v[88:91], v[72:75], 0
    v_mfma_f32_16x16x32_bf16 v[48:51], v[104:107], v[72:75], 0
    v_mfma_f32_16x16x32_bf16 v[52:55], v[120:123], v[72:75], 0
    v_mfma_f32_16x16x32_bf16 v[44:47], v[92:95], v[76:79], v[44:47]
    v_mfma_f32_16x16x32_bf16 v[48:51], v[108:111], v[76:79], v[48:51]
    v_mfma_f32_16x16x32_bf16 v[52:55], v[124:127], v[76:79], v[52:55]
    v_mfma_f32_16x16x32_bf16 v[44:47], v[96:99], v[80:83], v[44:47]
    v_mfma_f32_16x16x32_bf16 v[48:51], v[112:115], v[80:83], v[48:51]
    v_mfma_f32_16x16x32_bf16 v[52:55], v[128:131], v[80:83], v[52:55]
    v_mfma_f32_16x16x32_bf16 v[44:47], v[100:103], v[84:87], v[44:47]
    v_mfma_f32_16x16x32_bf16 v[48:51], v[116:119], v[84:87], v[48:51]
    v_mfma_f32_16x16x32_bf16 v[52:55], v[132:135], v[84:87], v[52:55]
    v_cndmask_b32 v32, v32, v22, s[72:73]
    v_cndmask_b32 v33, v33, v22, s[74:75]
    v_cndmask_b32 v34, v34, v22, s[76:77]
    v_cndmask_b32 v35, v35, v22, s[78:79]
    v_max3_f32 v20, v32, v33, v34
    v_max3_f32 v21, v35, v40, v41
    v_max_f32 v20, v20, v21
    v_mov_b32 v21, v20
    s_nop 1
    v_permlane16_swap_b32 v21, v20
    v_max_f32 v20, v20, v21
    v_mov_b32 v21, v20
    s_nop 1
    v_permlane32_swap_b32 v21, v20
    v_max_f32 v20, v20, v21
    v_mul_f32 v20, s80, v20
    v_fma_f32 v32, v32, s80, -v20
    v_fma_f32 v33, v33, s80, -v20
    v_fma_f32 v34, v34, s80, -v20
    v_fma_f32 v35, v35, s80, -v20
    v_fma_f32 v40, v40, s80, -v20
    v_fma_f32 v41, v41, s80, -v20
    v_exp_f32 v32, v32
    v_exp_f32 v33, v33
    v_exp_f32 v34, v34
    v_exp_f32 v35, v35
    v_exp_f32 v40, v40
    v_exp_f32 v41, v41
    s_nop 0
    v_cvt_pk_bf16_f32 v32, v32, v33
    v_cvt_pk_bf16_f32 v33, v34, v35
    v_mov_b32 v34, 0
    v_mov_b32 v35, 0
    v_cvt_pk_bf16_f32 v40, v40, v41
    v_mov_b32 v41, 0
    v_mov_b32 v42, 0
    v_mov_b32 v43, 0
    s_nop 1
    s_waitcnt vmcnt(30)
    ds_read_b64_tr_b16 v[56:57], v25 offset:0
    ds_read_b64_tr_b16 v[58:59], v25 offset:4096
    ds_read_b64_tr_b16 v[120:121], v26 offset:8192
    ds_read_b64_tr_b16 v[60:61], v25 offset:8
    ds_read_b64_tr_b16 v[62:63], v25 offset:4104
    ds_read_b64_tr_b16 v[122:123], v26 offset:8200
    ds_read_b64_tr_b16 v[64:65], v25 offset:1024
    ds_read_b64_tr_b16 v[66:67], v25 offset:5120
    ds_read_b64_tr_b16 v[124:125], v26 offset:8704
    ds_read_b64_tr_b16 v[68:69], v25 offset:1032
    ds_read_b64_tr_b16 v[70:71], v25 offset:5128
    ds_read_b64_tr_b16 v[126:127], v26 offset:8712
    ds_read_b64_tr_b16 v[72:73], v25 offset:2048
    ds_read_b64_tr_b16 v[74:75], v25 offset:6144
    ds_read_b64_tr_b16 v[128:129], v26 offset:9216
    ds_read_b64_tr_b16 v[76:77], v25 offset:2056
    ds_read_b64_tr_b16 v[78:79], v25 offset:6152
    ds_read_b64_tr_b16 v[130:131], v26 offset:9224
    ds_read_b64_tr_b16 v[80:81], v25 offset:3072
    ds_read_b64_tr_b16 v[82:83], v25 offset:7168
    ds_read_b64_tr_b16 v[132:133], v26 offset:9728
    ds_read_b64_tr_b16 v[84:85], v25 offset:3080
    ds_read_b64_tr_b16 v[86:87], v25 offset:7176
    ds_read_b64_tr_b16 v[134:135], v26 offset:9736
    v_cndmask_b32 v48, v48, v22, s[72:73]
    v_cndmask_b32 v49, v49, v22, s[74:75]
    v_cndmask_b32 v50, v50, v22, s[76:77]
    v_cndmask_b32 v51, v51, v22, s[78:79]
    v_max3_f32 v20, v44, v45, v46
    v_max3_f32 v21, v47, v48, v49
    v_max3_f32 v20, v20, v50, v51
    v_max3_f32 v21, v21, v52, v53
    v_max_f32 v20, v20, v21
    v_mov_b32 v21, v20
    s_nop 1
    v_permlane16_swap_b32 v21, v20
    v_max_f32 v20, v20, v21
    v_mov_b32 v21, v20
    s_nop 1
    v_permlane32_swap_b32 v21, v20
    v_max_f32 v20, v20, v21
    v_mul_f32 v20, s80, v20
    v_fma_f32 v44, v44, s80, -v20
    v_fma_f32 v45, v45, s80, -v20
    v_fma_f32 v46, v46, s80, -v20
    v_fma_f32 v47, v47, s80, -v20
    v_fma_f32 v48, v48, s80, -v20
    v_fma_f32 v49, v49, s80, -v20
    v_fma_f32 v50, v50, s80, -v20
    v_fma_f32 v51, v51, s80, -v20
    v_fma_f32 v52, v52, s80, -v20
    v_fma_f32 v53, v53, s80, -v20
    v_exp_f32 v44, v44
    v_exp_f32 v45, v45
    v_exp_f32 v46, v46
    v_exp_f32 v47, v47
    v_exp_f32 v48, v48
    v_exp_f32 v49, v49
    v_exp_f32 v50, v50
    v_exp_f32 v51, v51
    v_exp_f32 v52, v52
    v_exp_f32 v53, v53
    s_nop 0
    v_cvt_pk_bf16_f32 v44, v44, v45
    v_cvt_pk_bf16_f32 v45, v46, v47
    v_cvt_pk_bf16_f32 v46, v48, v49
    v_cvt_pk_bf16_f32 v47, v50, v51
    v_cvt_pk_bf16_f32 v52, v52, v53
    v_mov_b32 v53, 0
    v_mov_b32 v54, 0
    v_mov_b32 v55, 0
    s_nop 1
    s_waitcnt lgkmcnt(0)
    v_mfma_f32_16x16x32_bf16 v[36:39], v[28:31], v[32:35], 0
    v_mfma_f32_16x16x32_bf16 v[36:39], v[28:31], v[40:43], v[36:39]
    v_mfma_f32_16x16x32_bf16 v[88:91], v[56:59], v[32:35], 0
    v_mfma_f32_16x16x32_bf16 v[88:91], v[120:123], v[40:43], v[88:91]
    v_mfma_f32_16x16x32_bf16 v[92:95], v[60:63], v[32:35], 0
    v_mfma_f32_16x16x32_bf16 v[92:95], v[122:125], v[40:43], v[92:95]
    v_mfma_f32_16x16x32_bf16 v[96:99], v[64:67], v[32:35], 0
    v_mfma_f32_16x16x32_bf16 v[96:99], v[124:127], v[40:43], v[96:99]
    v_mfma_f32_16x16x32_bf16 v[100:103], v[68:71], v[32:35], 0
    v_mfma_f32_16x16x32_bf16 v[100:103], v[126:129], v[40:43], v[100:103]
    v_mfma_f32_16x16x32_bf16 v[104:107], v[72:75], v[32:35], 0
    v_mfma_f32_16x16x32_bf16 v[104:107], v[128:131], v[40:43], v[104:107]
    v_mfma_f32_16x16x32_bf16 v[108:111], v[76:79], v[32:35], 0
    v_mfma_f32_16x16x32_bf16 v[108:111], v[130:133], v[40:43], v[108:111]
    v_mfma_f32_16x16x32_bf16 v[112:115], v[80:83], v[32:35], 0
    v_mfma_f32_16x16x32_bf16 v[112:115], v[132:135], v[40:43], v[112:115]
    v_mfma_f32_16x16x32_bf16 v[116:119], v[84:87], v[32:35], 0
    v_mfma_f32_16x16x32_bf16 v[116:119], v[134:137], v[40:43], v[116:119]
    v_rcp_f32 v23, v36
    s_add_u32 s85, s81, 176160768
    v_mul_f32 v88, v88, v23
    v_mul_f32 v89, v89, v23
    v_mul_f32 v90, v90, v23
    v_mul_f32 v91, v91, v23
    v_mul_f32 v92, v92, v23
    v_mul_f32 v93, v93, v23
    v_mul_f32 v94, v94, v23
    v_mul_f32 v95, v95, v23
    v_cvt_pk_bf16_f32 v224, v88, v89
    v_cvt_pk_bf16_f32 v225, v90, v91
    v_cvt_pk_bf16_f32 v226, v92, v93
    v_cvt_pk_bf16_f32 v227, v94, v95
    buffer_store_dwordx4 v[224:227], v1, s[4:7], s85 offen offset:0 sc1
    v_mul_f32 v96, v96, v23
    v_mul_f32 v97, v97, v23
    v_mul_f32 v98, v98, v23
    v_mul_f32 v99, v99, v23
    v_mul_f32 v100, v100, v23
    v_mul_f32 v101, v101, v23
    v_mul_f32 v102, v102, v23
    v_mul_f32 v103, v103, v23
    v_cvt_pk_bf16_f32 v228, v96, v97
    v_cvt_pk_bf16_f32 v229, v98, v99
    v_cvt_pk_bf16_f32 v230, v100, v101
    v_cvt_pk_bf16_f32 v231, v102, v103
    buffer_store_dwordx4 v[228:231], v1, s[4:7], s85 offen offset:1024 sc1
    v_mul_f32 v104, v104, v23
    v_mul_f32 v105, v105, v23
    v_mul_f32 v106, v106, v23
    v_mul_f32 v107, v107, v23
    v_mul_f32 v108, v108, v23
    v_mul_f32 v109, v109, v23
    v_mul_f32 v110, v110, v23
    v_mul_f32 v111, v111, v23
    v_cvt_pk_bf16_f32 v232, v104, v105
    v_cvt_pk_bf16_f32 v233, v106, v107
    v_cvt_pk_bf16_f32 v234, v108, v109
    v_cvt_pk_bf16_f32 v235, v110, v111
    buffer_store_dwordx4 v[232:235], v1, s[4:7], s85 offen offset:2048 sc1
    v_mul_f32 v112, v112, v23
    v_mul_f32 v113, v113, v23
    v_mul_f32 v114, v114, v23
    v_mul_f32 v115, v115, v23
    v_mul_f32 v116, v116, v23
    v_mul_f32 v117, v117, v23
    v_mul_f32 v118, v118, v23
    v_mul_f32 v119, v119, v23
    v_cvt_pk_bf16_f32 v236, v112, v113
    v_cvt_pk_bf16_f32 v237, v114, v115
    v_cvt_pk_bf16_f32 v238, v116, v117
    v_cvt_pk_bf16_f32 v239, v118, v119
    buffer_store_dwordx4 v[236:239], v1, s[4:7], s85 offen offset:3072 sc1
    v_mfma_f32_16x16x32_bf16 v[48:51], v[28:31], v[44:47], 0
    v_mfma_f32_16x16x32_bf16 v[48:51], v[28:31], v[52:55], v[48:51]
    v_mfma_f32_16x16x32_bf16 v[88:91], v[56:59], v[44:47], 0
    v_mfma_f32_16x16x32_bf16 v[88:91], v[120:123], v[52:55], v[88:91]
    v_mfma_f32_16x16x32_bf16 v[92:95], v[60:63], v[44:47], 0
    v_mfma_f32_16x16x32_bf16 v[92:95], v[122:125], v[52:55], v[92:95]
    v_mfma_f32_16x16x32_bf16 v[96:99], v[64:67], v[44:47], 0
    v_mfma_f32_16x16x32_bf16 v[96:99], v[124:127], v[52:55], v[96:99]
    v_mfma_f32_16x16x32_bf16 v[100:103], v[68:71], v[44:47], 0
    v_mfma_f32_16x16x32_bf16 v[100:103], v[126:129], v[52:55], v[100:103]
    v_mfma_f32_16x16x32_bf16 v[104:107], v[72:75], v[44:47], 0
    v_mfma_f32_16x16x32_bf16 v[104:107], v[128:131], v[52:55], v[104:107]
    v_mfma_f32_16x16x32_bf16 v[108:111], v[76:79], v[44:47], 0
    v_mfma_f32_16x16x32_bf16 v[108:111], v[130:133], v[52:55], v[108:111]
    v_mfma_f32_16x16x32_bf16 v[112:115], v[80:83], v[44:47], 0
    v_mfma_f32_16x16x32_bf16 v[112:115], v[132:135], v[52:55], v[112:115]
    v_mfma_f32_16x16x32_bf16 v[116:119], v[84:87], v[44:47], 0
    v_mfma_f32_16x16x32_bf16 v[116:119], v[134:137], v[52:55], v[116:119]
    v_rcp_f32 v23, v48
    s_add_u32 s85, s81, 176291840
    v_mul_f32 v88, v88, v23
    v_mul_f32 v89, v89, v23
    v_mul_f32 v90, v90, v23
    v_mul_f32 v91, v91, v23
    v_mul_f32 v92, v92, v23
    v_mul_f32 v93, v93, v23
    v_mul_f32 v94, v94, v23
    v_mul_f32 v95, v95, v23
    v_cvt_pk_bf16_f32 v224, v88, v89
    v_cvt_pk_bf16_f32 v225, v90, v91
    v_cvt_pk_bf16_f32 v226, v92, v93
    v_cvt_pk_bf16_f32 v227, v94, v95
    buffer_store_dwordx4 v[224:227], v1, s[4:7], s85 offen offset:0 sc1
    v_mul_f32 v96, v96, v23
    v_mul_f32 v97, v97, v23
    v_mul_f32 v98, v98, v23
    v_mul_f32 v99, v99, v23
    v_mul_f32 v100, v100, v23
    v_mul_f32 v101, v101, v23
    v_mul_f32 v102, v102, v23
    v_mul_f32 v103, v103, v23
    v_cvt_pk_bf16_f32 v228, v96, v97
    v_cvt_pk_bf16_f32 v229, v98, v99
    v_cvt_pk_bf16_f32 v230, v100, v101
    v_cvt_pk_bf16_f32 v231, v102, v103
    buffer_store_dwordx4 v[228:231], v1, s[4:7], s85 offen offset:1024 sc1
    v_mul_f32 v104, v104, v23
    v_mul_f32 v105, v105, v23
    v_mul_f32 v106, v106, v23
    v_mul_f32 v107, v107, v23
    v_mul_f32 v108, v108, v23
    v_mul_f32 v109, v109, v23
    v_mul_f32 v110, v110, v23
    v_mul_f32 v111, v111, v23
    v_cvt_pk_bf16_f32 v232, v104, v105
    v_cvt_pk_bf16_f32 v233, v106, v107
    v_cvt_pk_bf16_f32 v234, v108, v109
    v_cvt_pk_bf16_f32 v235, v110, v111
    buffer_store_dwordx4 v[232:235], v1, s[4:7], s85 offen offset:2048 sc1
    v_mul_f32 v112, v112, v23
    v_mul_f32 v113, v113, v23
    v_mul_f32 v114, v114, v23
    v_mul_f32 v115, v115, v23
    v_mul_f32 v116, v116, v23
    v_mul_f32 v117, v117, v23
    v_mul_f32 v118, v118, v23
    v_mul_f32 v119, v119, v23
    v_cvt_pk_bf16_f32 v236, v112, v113
    v_cvt_pk_bf16_f32 v237, v114, v115
    v_cvt_pk_bf16_f32 v238, v116, v117
    v_cvt_pk_bf16_f32 v239, v118, v119
    buffer_store_dwordx4 v[236:239], v1, s[4:7], s85 offen offset:3072 sc1
    s_waitcnt vmcnt(18)
    v_mfma_f32_16x16x32_bf16 v[32:35], v[172:175], v[140:143], 0
    v_mfma_f32_16x16x32_bf16 v[40:43], v[204:207], v[140:143], 0
    v_mfma_f32_16x16x32_bf16 v[32:35], v[176:179], v[144:147], v[32:35]
    v_mfma_f32_16x16x32_bf16 v[40:43], v[208:211], v[144:147], v[40:43]
    v_mfma_f32_16x16x32_bf16 v[32:35], v[180:183], v[148:151], v[32:35]
    v_mfma_f32_16x16x32_bf16 v[40:43], v[212:215], v[148:151], v[40:43]
    v_mfma_f32_16x16x32_bf16 v[32:35], v[184:187], v[152:155], v[32:35]
    v_mfma_f32_16x16x32_bf16 v[40:43], v[216:219], v[152:155], v[40:43]
    v_mfma_f32_16x16x32_bf16 v[44:47], v[172:175], v[156:159], 0
    v_mfma_f32_16x16x32_bf16 v[48:51], v[188:191], v[156:159], 0
    v_mfma_f32_16x16x32_bf16 v[52:55], v[204:207], v[156:159], 0
    v_mfma_f32_16x16x32_bf16 v[44:47], v[176:179], v[160:163], v[44:47]
    v_mfma_f32_16x16x32_bf16 v[48:51], v[192:195], v[160:163], v[48:51]
    v_mfma_f32_16x16x32_bf16 v[52:55], v[208:211], v[160:163], v[52:55]
    v_mfma_f32_16x16x32_bf16 v[44:47], v[180:183], v[164:167], v[44:47]
    v_mfma_f32_16x16x32_bf16 v[48:51], v[196:199], v[164:167], v[48:51]
    v_mfma_f32_16x16x32_bf16 v[52:55], v[212:215], v[164:167], v[52:55]
    v_mfma_f32_16x16x32_bf16 v[44:47], v[184:187], v[168:171], v[44:47]
    v_mfma_f32_16x16x32_bf16 v[48:51], v[200:203], v[168:171], v[48:51]
    v_mfma_f32_16x16x32_bf16 v[52:55], v[216:219], v[168:171], v[52:55]
    v_cndmask_b32 v32, v32, v22, s[72:73]
    v_cndmask_b32 v33, v33, v22, s[74:75]
    v_cndmask_b32 v34, v34, v22, s[76:77]
    v_cndmask_b32 v35, v35, v22, s[78:79]
    v_max3_f32 v20, v32, v33, v34
    v_max3_f32 v21, v35, v40, v41
    v_max_f32 v20, v20, v21
    v_mov_b32 v21, v20
    s_nop 1
    v_permlane16_swap_b32 v21, v20
    v_max_f32 v20, v20, v21
    v_mov_b32 v21, v20
    s_nop 1
    v_permlane32_swap_b32 v21, v20
    v_max_f32 v20, v20, v21
    v_mul_f32 v20, s80, v20
    v_fma_f32 v32, v32, s80, -v20
    v_fma_f32 v33, v33, s80, -v20
    v_fma_f32 v34, v34, s80, -v20
    v_fma_f32 v35, v35, s80, -v20
    v_fma_f32 v40, v40, s80, -v20
    v_fma_f32 v41, v41, s80, -v20
    v_exp_f32 v32, v32
    v_exp_f32 v33, v33
    v_exp_f32 v34, v34
    v_exp_f32 v35, v35
    v_exp_f32 v40, v40
    v_exp_f32 v41, v41
    s_nop 0
    v_cvt_pk_bf16_f32 v32, v32, v33
    v_cvt_pk_bf16_f32 v33, v34, v35
    v_mov_b32 v34, 0
    v_mov_b32 v35, 0
    v_cvt_pk_bf16_f32 v40, v40, v41
    v_mov_b32 v41, 0
    v_mov_b32 v42, 0
    v_mov_b32 v43, 0
    s_nop 1
    s_waitcnt vmcnt(8)
    v_add_u32 v25, 81920, v25
    v_add_u32 v26, 81920, v26
    ds_read_b64_tr_b16 v[140:141], v25 offset:0
    ds_read_b64_tr_b16 v[142:143], v25 offset:4096
    ds_read_b64_tr_b16 v[204:205], v26 offset:8192
    ds_read_b64_tr_b16 v[144:145], v25 offset:8
    ds_read_b64_tr_b16 v[146:147], v25 offset:4104
    ds_read_b64_tr_b16 v[206:207], v26 offset:8200
    ds_read_b64_tr_b16 v[148:149], v25 offset:1024
    ds_read_b64_tr_b16 v[150:151], v25 offset:5120
    ds_read_b64_tr_b16 v[208:209], v26 offset:8704
    ds_read_b64_tr_b16 v[152:153], v25 offset:1032
    ds_read_b64_tr_b16 v[154:155], v25 offset:5128
    ds_read_b64_tr_b16 v[210:211], v26 offset:8712
    ds_read_b64_tr_b16 v[156:157], v25 offset:2048
    ds_read_b64_tr_b16 v[158:159], v25 offset:6144
    ds_read_b64_tr_b16 v[212:213], v26 offset:9216
    ds_read_b64_tr_b16 v[160:161], v25 offset:2056
    ds_read_b64_tr_b16 v[162:163], v25 offset:6152
    ds_read_b64_tr_b16 v[214:215], v26 offset:9224
    ds_read_b64_tr_b16 v[164:165], v25 offset:3072
    ds_read_b64_tr_b16 v[166:167], v25 offset:7168
    ds_read_b64_tr_b16 v[216:217], v26 offset:9728
    ds_read_b64_tr_b16 v[168:169], v25 offset:3080
    ds_read_b64_tr_b16 v[170:171], v25 offset:7176
    ds_read_b64_tr_b16 v[218:219], v26 offset:9736
    v_cndmask_b32 v48, v48, v22, s[72:73]
    v_cndmask_b32 v49, v49, v22, s[74:75]
    v_cndmask_b32 v50, v50, v22, s[76:77]
    v_cndmask_b32 v51, v51, v22, s[78:79]
    v_max3_f32 v20, v44, v45, v46
    v_max3_f32 v21, v47, v48, v49
    v_max3_f32 v20, v20, v50, v51
    v_max3_f32 v21, v21, v52, v53
    v_max_f32 v20, v20, v21
    v_mov_b32 v21, v20
    s_nop 1
    v_permlane16_swap_b32 v21, v20
    v_max_f32 v20, v20, v21
    v_mov_b32 v21, v20
    s_nop 1
    v_permlane32_swap_b32 v21, v20
    v_max_f32 v20, v20, v21
    v_mul_f32 v20, s80, v20
    v_fma_f32 v44, v44, s80, -v20
    v_fma_f32 v45, v45, s80, -v20
    v_fma_f32 v46, v46, s80, -v20
    v_fma_f32 v47, v47, s80, -v20
    v_fma_f32 v48, v48, s80, -v20
    v_fma_f32 v49, v49, s80, -v20
    v_fma_f32 v50, v50, s80, -v20
    v_fma_f32 v51, v51, s80, -v20
    v_fma_f32 v52, v52, s80, -v20
    v_fma_f32 v53, v53, s80, -v20
    v_exp_f32 v44, v44
    v_exp_f32 v45, v45
    v_exp_f32 v46, v46
    v_exp_f32 v47, v47
    v_exp_f32 v48, v48
    v_exp_f32 v49, v49
    v_exp_f32 v50, v50
    v_exp_f32 v51, v51
    v_exp_f32 v52, v52
    v_exp_f32 v53, v53
    s_nop 0
    v_cvt_pk_bf16_f32 v44, v44, v45
    v_cvt_pk_bf16_f32 v45, v46, v47
    v_cvt_pk_bf16_f32 v46, v48, v49
    v_cvt_pk_bf16_f32 v47, v50, v51
    v_cvt_pk_bf16_f32 v52, v52, v53
    v_mov_b32 v53, 0
    v_mov_b32 v54, 0
    v_mov_b32 v55, 0
    s_nop 1
    s_waitcnt lgkmcnt(0)
    v_mfma_f32_16x16x32_bf16 v[36:39], v[28:31], v[32:35], 0
    v_mfma_f32_16x16x32_bf16 v[36:39], v[28:31], v[40:43], v[36:39]
    v_mfma_f32_16x16x32_bf16 v[172:175], v[140:143], v[32:35], 0
    v_mfma_f32_16x16x32_bf16 v[172:175], v[204:207], v[40:43], v[172:175]
    v_mfma_f32_16x16x32_bf16 v[176:179], v[144:147], v[32:35], 0
    v_mfma_f32_16x16x32_bf16 v[176:179], v[206:209], v[40:43], v[176:179]
    v_mfma_f32_16x16x32_bf16 v[180:183], v[148:151], v[32:35], 0
    v_mfma_f32_16x16x32_bf16 v[180:183], v[208:211], v[40:43], v[180:183]
    v_mfma_f32_16x16x32_bf16 v[184:187], v[152:155], v[32:35], 0
    v_mfma_f32_16x16x32_bf16 v[184:187], v[210:213], v[40:43], v[184:187]
    v_mfma_f32_16x16x32_bf16 v[188:191], v[156:159], v[32:35], 0
    v_mfma_f32_16x16x32_bf16 v[188:191], v[212:215], v[40:43], v[188:191]
    v_mfma_f32_16x16x32_bf16 v[192:195], v[160:163], v[32:35], 0
    v_mfma_f32_16x16x32_bf16 v[192:195], v[214:217], v[40:43], v[192:195]
    v_mfma_f32_16x16x32_bf16 v[196:199], v[164:167], v[32:35], 0
    v_mfma_f32_16x16x32_bf16 v[196:199], v[216:219], v[40:43], v[196:199]
    v_mfma_f32_16x16x32_bf16 v[200:203], v[168:171], v[32:35], 0
    v_mfma_f32_16x16x32_bf16 v[200:203], v[218:221], v[40:43], v[200:203]
    v_rcp_f32 v23, v36
    s_add_u32 s85, s81, 176685056
    v_mul_f32 v172, v172, v23
    v_mul_f32 v173, v173, v23
    v_mul_f32 v174, v174, v23
    v_mul_f32 v175, v175, v23
    v_mul_f32 v176, v176, v23
    v_mul_f32 v177, v177, v23
    v_mul_f32 v178, v178, v23
    v_mul_f32 v179, v179, v23
    v_cvt_pk_bf16_f32 v224, v172, v173
    v_cvt_pk_bf16_f32 v225, v174, v175
    v_cvt_pk_bf16_f32 v226, v176, v177
    v_cvt_pk_bf16_f32 v227, v178, v179
    buffer_store_dwordx4 v[224:227], v1, s[4:7], s85 offen offset:0 sc1
    v_mul_f32 v180, v180, v23
    v_mul_f32 v181, v181, v23
    v_mul_f32 v182, v182, v23
    v_mul_f32 v183, v183, v23
    v_mul_f32 v184, v184, v23
    v_mul_f32 v185, v185, v23
    v_mul_f32 v186, v186, v23
    v_mul_f32 v187, v187, v23
    v_cvt_pk_bf16_f32 v228, v180, v181
    v_cvt_pk_bf16_f32 v229, v182, v183
    v_cvt_pk_bf16_f32 v230, v184, v185
    v_cvt_pk_bf16_f32 v231, v186, v187
    buffer_store_dwordx4 v[228:231], v1, s[4:7], s85 offen offset:1024 sc1
    v_mul_f32 v188, v188, v23
    v_mul_f32 v189, v189, v23
    v_mul_f32 v190, v190, v23
    v_mul_f32 v191, v191, v23
    v_mul_f32 v192, v192, v23
    v_mul_f32 v193, v193, v23
    v_mul_f32 v194, v194, v23
    v_mul_f32 v195, v195, v23
    v_cvt_pk_bf16_f32 v232, v188, v189
    v_cvt_pk_bf16_f32 v233, v190, v191
    v_cvt_pk_bf16_f32 v234, v192, v193
    v_cvt_pk_bf16_f32 v235, v194, v195
    buffer_store_dwordx4 v[232:235], v1, s[4:7], s85 offen offset:2048 sc1
    v_mul_f32 v196, v196, v23
    v_mul_f32 v197, v197, v23
    v_mul_f32 v198, v198, v23
    v_mul_f32 v199, v199, v23
    v_mul_f32 v200, v200, v23
    v_mul_f32 v201, v201, v23
    v_mul_f32 v202, v202, v23
    v_mul_f32 v203, v203, v23
    v_cvt_pk_bf16_f32 v236, v196, v197
    v_cvt_pk_bf16_f32 v237, v198, v199
    v_cvt_pk_bf16_f32 v238, v200, v201
    v_cvt_pk_bf16_f32 v239, v202, v203
    buffer_store_dwordx4 v[236:239], v1, s[4:7], s85 offen offset:3072 sc1
    v_mfma_f32_16x16x32_bf16 v[48:51], v[28:31], v[44:47], 0
    v_mfma_f32_16x16x32_bf16 v[48:51], v[28:31], v[52:55], v[48:51]
    v_mfma_f32_16x16x32_bf16 v[172:175], v[140:143], v[44:47], 0
    v_mfma_f32_16x16x32_bf16 v[172:175], v[204:207], v[52:55], v[172:175]
    v_mfma_f32_16x16x32_bf16 v[176:179], v[144:147], v[44:47], 0
    v_mfma_f32_16x16x32_bf16 v[176:179], v[206:209], v[52:55], v[176:179]
    v_mfma_f32_16x16x32_bf16 v[180:183], v[148:151], v[44:47], 0
    v_mfma_f32_16x16x32_bf16 v[180:183], v[208:211], v[52:55], v[180:183]
    v_mfma_f32_16x16x32_bf16 v[184:187], v[152:155], v[44:47], 0
    v_mfma_f32_16x16x32_bf16 v[184:187], v[210:213], v[52:55], v[184:187]
    v_mfma_f32_16x16x32_bf16 v[188:191], v[156:159], v[44:47], 0
    v_mfma_f32_16x16x32_bf16 v[188:191], v[212:215], v[52:55], v[188:191]
    v_mfma_f32_16x16x32_bf16 v[192:195], v[160:163], v[44:47], 0
    v_mfma_f32_16x16x32_bf16 v[192:195], v[214:217], v[52:55], v[192:195]
    v_mfma_f32_16x16x32_bf16 v[196:199], v[164:167], v[44:47], 0
    v_mfma_f32_16x16x32_bf16 v[196:199], v[216:219], v[52:55], v[196:199]
    v_mfma_f32_16x16x32_bf16 v[200:203], v[168:171], v[44:47], 0
    v_mfma_f32_16x16x32_bf16 v[200:203], v[218:221], v[52:55], v[200:203]
    v_rcp_f32 v23, v48
    s_add_u32 s85, s81, 176816128
    v_mul_f32 v172, v172, v23
    v_mul_f32 v173, v173, v23
    v_mul_f32 v174, v174, v23
    v_mul_f32 v175, v175, v23
    v_mul_f32 v176, v176, v23
    v_mul_f32 v177, v177, v23
    v_mul_f32 v178, v178, v23
    v_mul_f32 v179, v179, v23
    v_cvt_pk_bf16_f32 v224, v172, v173
    v_cvt_pk_bf16_f32 v225, v174, v175
    v_cvt_pk_bf16_f32 v226, v176, v177
    v_cvt_pk_bf16_f32 v227, v178, v179
    buffer_store_dwordx4 v[224:227], v1, s[4:7], s85 offen offset:0 sc1
    v_mul_f32 v180, v180, v23
    v_mul_f32 v181, v181, v23
    v_mul_f32 v182, v182, v23
    v_mul_f32 v183, v183, v23
    v_mul_f32 v184, v184, v23
    v_mul_f32 v185, v185, v23
    v_mul_f32 v186, v186, v23
    v_mul_f32 v187, v187, v23
    v_cvt_pk_bf16_f32 v228, v180, v181
    v_cvt_pk_bf16_f32 v229, v182, v183
    v_cvt_pk_bf16_f32 v230, v184, v185
    v_cvt_pk_bf16_f32 v231, v186, v187
    buffer_store_dwordx4 v[228:231], v1, s[4:7], s85 offen offset:1024 sc1
    v_mul_f32 v188, v188, v23
    v_mul_f32 v189, v189, v23
    v_mul_f32 v190, v190, v23
    v_mul_f32 v191, v191, v23
    v_mul_f32 v192, v192, v23
    v_mul_f32 v193, v193, v23
    v_mul_f32 v194, v194, v23
    v_mul_f32 v195, v195, v23
    v_cvt_pk_bf16_f32 v232, v188, v189
    v_cvt_pk_bf16_f32 v233, v190, v191
    v_cvt_pk_bf16_f32 v234, v192, v193
    v_cvt_pk_bf16_f32 v235, v194, v195
    buffer_store_dwordx4 v[232:235], v1, s[4:7], s85 offen offset:2048 sc1
    v_mul_f32 v196, v196, v23
    v_mul_f32 v197, v197, v23
    v_mul_f32 v198, v198, v23
    v_mul_f32 v199, v199, v23
    v_mul_f32 v200, v200, v23
    v_mul_f32 v201, v201, v23
    v_mul_f32 v202, v202, v23
    v_mul_f32 v203, v203, v23
    v_cvt_pk_bf16_f32 v236, v196, v197
    v_cvt_pk_bf16_f32 v237, v198, v199
    v_cvt_pk_bf16_f32 v238, v200, v201
    v_cvt_pk_bf16_f32 v239, v202, v203
    buffer_store_dwordx4 v[236:239], v1, s[4:7], s85 offen offset:3072 sc1
    s_mov_b32 s28, s46
    s_waitcnt vmcnt(0)
    s_barrier
    s_cmp_eq_u32 s28, 0
    s_cbranch_scc1 sig_13
    s_cmp_lg_u32 s3, 0
    s_cbranch_scc1 sig_13
    s_and_b32 s57, s28, 3
    v_mov_b32 v24, s57
    s_bfe_u32 s57, s28, 0x20002
    v_mov_b32 v25, s57
    s_andn2_b32 s28, s28, 15
    s_mov_b64 exec, 1
    buffer_atomic_add_x2 v[24:25], v17, s[4:7], s28 offen sc1
    s_mov_b64 exec, -1
sig_13:
    s_mov_b32 s28, 0
    s_cmp_lg_u32 s3, 0
    s_cbranch_scc1 pub_14
    v_mov_b32 v20, 131136
    s_mov_b64 exec, 1
    ds_write_b32 v20, v250
    s_mov_b64 exec, -1
    s_waitcnt lgkmcnt(0)
pub_14:
    s_barrier
    v_mov_b32 v20, 131136
    ds_read_b32 v20, v20
    s_waitcnt lgkmcnt(0)
    v_readfirstlane_b32 s59, v20
    s_add_u32 s59, s59, 32
    s_min_u32 s59, s59, 319
    s_lshl_b32 s57, s59, 6
    s_load_dwordx16 s[32:47], s[24:25], s57
    s_waitcnt lgkmcnt(0)
    s_branch w_cold
w_fin:
    s_load_dwordx2 s[8:9], s[0:1], 0
    s_load_dwordx2 s[12:13], s[0:1], 88
    v_mbcnt_lo_u32_b32 v1, -1, 0
    v_mbcnt_hi_u32_b32 v1, -1, v1
    s_mov_b32 s10, 4194304
    s_mov_b32 s11, 131072
    s_mov_b32 s14, 4194304
    s_mov_b32 s15, 131072
    s_mov_b32 s89, 0xbfb8aa3b
    v_lshlrev_b32 v3, 4, v1
    v_and_b32 v4, 15, v1
    v_lshrrev_b32 v5, 4, v1
    v_lshlrev_b32 v4, 11, v4
    v_lshl_add_u32 v4, v5, 4, v4
    v_and_b32 v5, 1, v5
    v_cmp_eq_u32 s[76:77], 1, v5
    v_and_b32 v6, 3, v1
    v_lshlrev_b32 v6, 7, v6
    s_mov_b32 s80, s39
    s_lshl_b32 s81, s36, 2
    s_and_b32 s82, s3, 3
    s_add_u32 s81, s81, s82
    s_lshr_b32 s82, s3, 2
    s_mov_b32 s84, 65536
    s_mov_b32 s85, 218112000
    s_waitcnt lgkmcnt(0)
    s_cmp_eq_u32 s32, 7
    s_cbranch_scc1 fin_tail
fin_job:
    s_lshl_b32 s72, s80, 1
    s_add_u32 s72, s72, s82
    s_lshl_b32 s74, s72, 15
    s_lshl_b32 s73, s81, 11
    s_add_u32 s73, s73, s74
    s_lshl_b32 s75, s81, 7
    s_add_u32 s74, s74, s75
    s_add_u32 s78, s73, 117440512
    s_add_u32 s79, s73, 75497472
    s_lshr_b32 s83, s80, 3
    s_lshl_b32 s83, s83, 6
    s_add_u32 s83, s83, 218106368
    s_add_u32 s87, s80, 1
    buffer_load_dwordx4 v[88:91], v4, s[8:11], s74 offen offset:0
    buffer_load_dwordx4 v[92:95], v4, s[8:11], s74 offen offset:64
    s_cmp_lg_u32 s3, 0
    s_cbranch_scc1 fin_ws_ok
fin_wd:
    buffer_load_dwordx2 v[8:9], off, s[4:7], s83 sc1
    s_waitcnt vmcnt(0)
    v_readfirstlane_b32 s86, v8
    v_readfirstlane_b32 s88, v9
    s_cmp_ge_u32 s88, s37
    s_cselect_b32 s86, s86, 0
    s_cmp_ge_u32 s86, 16
    s_cbranch_scc1 fin_wd2
    s_sleep 64
    s_sub_u32 s84, s84, 1
    s_cbranch_scc0 fin_wd
    s_mov_b32 s84, 0
fin_wd2:
    s_cmp_lg_u32 s37, 0
    s_cbranch_scc1 fin_ws_ok
fin_ws:
    buffer_load_dword v7, v6, s[4:7], s85 offen sc1
    s_waitcnt vmcnt(0)
    v_cmp_gt_u32 vcc, s87, v7
    s_cbranch_vccz fin_ws_ok
    s_sleep 12
    s_sub_u32 s86, s87, 2
    v_cmp_gt_i32 vcc, s86, v7
    s_cbranch_vccz fin_ws_f
    s_sleep 64
    s_sub_u32 s86, s87, 6
    v_cmp_gt_i32 vcc, s86, v7
    s_cbranch_vccz fin_ws_f
    s_sleep 127
    s_sleep 127
fin_ws_f:
    s_sub_u32 s84, s84, 1
    s_cbranch_scc0 fin_ws
    s_mov_b32 s84, 0
fin_ws_ok:
    s_cmp_lg_u32 s3, 0
    s_cbranch_scc1 clm_15
    v_mov_b32 v250, 1
    s_mov_b64 exec, 1
    buffer_atomic_add v250, off, s[64:67], s71 sc0 sc1
    s_mov_b64 exec, -1
clm_15:
    s_barrier
    buffer_load_dwordx4 v[136:139], v3, s[4:7], s78 offen offset:0 sc1
    buffer_load_dwordx4 v[140:143], v3, s[4:7], s78 offen offset:1024 sc1
    s_add_u32 s78, s78, 4194304
    buffer_load_dwordx4 v[144:147], v3, s[4:7], s78 offen offset:0 sc1
    buffer_load_dwordx4 v[148:151], v3, s[4:7], s78 offen offset:1024 sc1
    s_add_u32 s78, s78, 4194304
    s_cmp_lg_u32 s33, 0
    s_cbranch_scc1 fin_g2
    buffer_load_dwordx4 v[152:155], v3, s[4:7], s78 offen offset:0 sc1
    buffer_load_dwordx4 v[156:159], v3, s[4:7], s78 offen offset:1024 sc1
    s_add_u32 s78, s78, 4194304
    buffer_load_dwordx4 v[160:163], v3, s[4:7], s78 offen offset:0 sc1
    buffer_load_dwordx4 v[164:167], v3, s[4:7], s78 offen offset:1024 sc1
    s_add_u32 s78, s78, 4194304
    s_branch fin_g4
fin_g2:
    v_mov_b32 v152, 0
    v_mov_b32 v153, 0
    v_mov_b32 v154, 0
    v_mov_b32 v155, 0
    v_mov_b32 v156, 0
    v_mov_b32 v157, 0
    v_mov_b32 v158, 0
    v_mov_b32 v159, 0
    v_mov_b32 v160, 0
    v_mov_b32 v161, 0
    v_mov_b32 v162, 0
    v_mov_b32 v163, 0
    v_mov_b32 v164, 0
    v_mov_b32 v165, 0
    v_mov_b32 v166, 0
    v_mov_b32 v167, 0
fin_g4:
    buffer_load_dwordx4 v[16:19], v3, s[4:7], s79 offen offset:0 sc1
    buffer_load_dwordx4 v[48:51], v3, s[4:7], s79 offen offset:1024 sc1
    s_add_u32 s79, s79, 4194304
    buffer_load_dwordx4 v[20:23], v3, s[4:7], s79 offen offset:0 sc1
    buffer_load_dwordx4 v[52:55], v3, s[4:7], s79 offen offset:1024 sc1
    s_add_u32 s79, s79, 4194304
    s_cmp_ge_u32 s35, 2
    s_cbranch_scc1 fin_2p
    buffer_load_dwordx4 v[24:27], v3, s[4:7], s79 offen offset:0 sc1
    buffer_load_dwordx4 v[56:59], v3, s[4:7], s79 offen offset:1024 sc1
    s_add_u32 s79, s79, 4194304
    buffer_load_dwordx4 v[28:31], v3, s[4:7], s79 offen offset:0 sc1
    buffer_load_dwordx4 v[60:63], v3, s[4:7], s79 offen offset:1024 sc1
    s_add_u32 s79, s79, 4194304
    s_cmp_ge_u32 s35, 1
    s_cbranch_scc1 fin_4p
    buffer_load_dwordx4 v[32:35], v3, s[4:7], s79 offen offset:0 sc1
    buffer_load_dwordx4 v[64:67], v3, s[4:7], s79 offen offset:1024 sc1
    s_add_u32 s79, s79, 4194304
    buffer_load_dwordx4 v[36:39], v3, s[4:7], s79 offen offset:0 sc1
    buffer_load_dwordx4 v[68:71], v3, s[4:7], s79 offen offset:1024 sc1
    s_add_u32 s79, s79, 4194304
    buffer_load_dwordx4 v[40:43], v3, s[4:7], s79 offen offset:0 sc1
    buffer_load_dwordx4 v[72:75], v3, s[4:7], s79 offen offset:1024 sc1
    s_add_u32 s79, s79, 4194304
    buffer_load_dwordx4 v[44:47], v3, s[4:7], s79 offen offset:0 sc1
    buffer_load_dwordx4 v[76:79], v3, s[4:7], s79 offen offset:1024 sc1
    s_add_u32 s79, s79, 4194304
    s_waitcnt vmcnt(16)
    s_branch fin_8p
fin_2p:
    v_mov_b32 v24, 0
    v_mov_b32 v25, 0
    v_mov_b32 v26, 0
    v_mov_b32 v27, 0
    v_mov_b32 v28, 0
    v_mov_b32 v29, 0
    v_mov_b32 v30, 0
    v_mov_b32 v31, 0
    v_mov_b32 v32, 0
    v_mov_b32 v33, 0
    v_mov_b32 v34, 0
    v_mov_b32 v35, 0
    v_mov_b32 v36, 0
    v_mov_b32 v37, 0
    v_mov_b32 v38, 0
    v_mov_b32 v39, 0
    v_mov_b32 v40, 0
    v_mov_b32 v41, 0
    v_mov_b32 v42, 0
    v_mov_b32 v43, 0
    v_mov_b32 v44, 0
    v_mov_b32 v45, 0
    v_mov_b32 v46, 0
    v_mov_b32 v47, 0
    v_mov_b32 v56, 0
    v_mov_b32 v57, 0
    v_mov_b32 v58, 0
    v_mov_b32 v59, 0
    v_mov_b32 v60, 0
    v_mov_b32 v61, 0
    v_mov_b32 v62, 0
    v_mov_b32 v63, 0
    v_mov_b32 v64, 0
    v_mov_b32 v65, 0
    v_mov_b32 v66, 0
    v_mov_b32 v67, 0
    v_mov_b32 v68, 0
    v_mov_b32 v69, 0
    v_mov_b32 v70, 0
    v_mov_b32 v71, 0
    v_mov_b32 v72, 0
    v_mov_b32 v73, 0
    v_mov_b32 v74, 0
    v_mov_b32 v75, 0
    v_mov_b32 v76, 0
    v_mov_b32 v77, 0
    v_mov_b32 v78, 0
    v_mov_b32 v79, 0
    s_waitcnt vmcnt(4)
    s_branch fin_8p
fin_4p:
    v_mov_b32 v32, 0
    v_mov_b32 v33, 0
    v_mov_b32 v34, 0
    v_mov_b32 v35, 0
    v_mov_b32 v36, 0
    v_mov_b32 v37, 0
    v_mov_b32 v38, 0
    v_mov_b32 v39, 0
    v_mov_b32 v40, 0
    v_mov_b32 v41, 0
    v_mov_b32 v42, 0
    v_mov_b32 v43, 0
    v_mov_b32 v44, 0
    v_mov_b32 v45, 0
    v_mov_b32 v46, 0
    v_mov_b32 v47, 0
    v_mov_b32 v64, 0
    v_mov_b32 v65, 0
    v_mov_b32 v66, 0
    v_mov_b32 v67, 0
    v_mov_b32 v68, 0
    v_mov_b32 v69, 0
    v_mov_b32 v70, 0
    v_mov_b32 v71, 0
    v_mov_b32 v72, 0
    v_mov_b32 v73, 0
    v_mov_b32 v74, 0
    v_mov_b32 v75, 0
    v_mov_b32 v76, 0
    v_mov_b32 v77, 0
    v_mov_b32 v78, 0
    v_mov_b32 v79, 0
    s_waitcnt vmcnt(8)
fin_8p:
    v_lshlrev_b32 v120, 16, v136
    v_and_b32 v121, 0xffff0000, v136
    v_lshlrev_b32 v136, 16, v144
    v_and_b32 v144, 0xffff0000, v144
    v_add_f32 v120, v120, v136
    v_add_f32 v121, v121, v144
    v_lshlrev_b32 v136, 16, v152
    v_and_b32 v152, 0xffff0000, v152
    v_add_f32 v120, v120, v136
    v_add_f32 v121, v121, v152
    v_lshlrev_b32 v136, 16, v160
    v_and_b32 v160, 0xffff0000, v160
    v_add_f32 v120, v120, v136
    v_add_f32 v121, v121, v160
    v_cvt_pk_bf16_f32 v136, v120, v121
    v_lshlrev_b32 v120, 16, v136
    v_and_b32 v121, 0xffff0000, v136
    v_mul_f32 v136, s89, v120
    v_mul_f32 v144, s89, v121
    v_lshlrev_b32 v122, 16, v137
    v_and_b32 v123, 0xffff0000, v137
    v_lshlrev_b32 v137, 16, v145
    v_and_b32 v145, 0xffff0000, v145
    v_add_f32 v122, v122, v137
    v_add_f32 v123, v123, v145
    v_lshlrev_b32 v137, 16, v153
    v_and_b32 v153, 0xffff0000, v153
    v_add_f32 v122, v122, v137
    v_add_f32 v123, v123, v153
    v_lshlrev_b32 v137, 16, v161
    v_and_b32 v161, 0xffff0000, v161
    v_add_f32 v122, v122, v137
    v_add_f32 v123, v123, v161
    v_cvt_pk_bf16_f32 v137, v122, v123
    v_lshlrev_b32 v122, 16, v137
    v_and_b32 v123, 0xffff0000, v137
    v_mul_f32 v137, s89, v122
    v_mul_f32 v145, s89, v123
    v_lshlrev_b32 v124, 16, v138
    v_and_b32 v125, 0xffff0000, v138
    v_lshlrev_b32 v138, 16, v146
    v_and_b32 v146, 0xffff0000, v146
    v_add_f32 v124, v124, v138
    v_add_f32 v125, v125, v146
    v_lshlrev_b32 v138, 16, v154
    v_and_b32 v154, 0xffff0000, v154
    v_add_f32 v124, v124, v138
    v_add_f32 v125, v125, v154
    v_lshlrev_b32 v138, 16, v162
    v_and_b32 v162, 0xffff0000, v162
    v_add_f32 v124, v124, v138
    v_add_f32 v125, v125, v162
    v_cvt_pk_bf16_f32 v138, v124, v125
    v_lshlrev_b32 v124, 16, v138
    v_and_b32 v125, 0xffff0000, v138
    v_mul_f32 v138, s89, v124
    v_mul_f32 v146, s89, v125
    v_lshlrev_b32 v126, 16, v139
    v_and_b32 v127, 0xffff0000, v139
    v_lshlrev_b32 v139, 16, v147
    v_and_b32 v147, 0xffff0000, v147
    v_add_f32 v126, v126, v139
    v_add_f32 v127, v127, v147
    v_lshlrev_b32 v139, 16, v155
    v_and_b32 v155, 0xffff0000, v155
    v_add_f32 v126, v126, v139
    v_add_f32 v127, v127, v155
    v_lshlrev_b32 v139, 16, v163
    v_and_b32 v163, 0xffff0000, v163
    v_add_f32 v126, v126, v139
    v_add_f32 v127, v127, v163
    v_cvt_pk_bf16_f32 v139, v126, v127
    v_lshlrev_b32 v126, 16, v139
    v_and_b32 v127, 0xffff0000, v139
    v_mul_f32 v139, s89, v126
    v_mul_f32 v147, s89, v127
    v_exp_f32 v136, v136
    v_exp_f32 v144, v144
    v_exp_f32 v137, v137
    v_exp_f32 v145, v145
    v_exp_f32 v138, v138
    v_exp_f32 v146, v146
    v_exp_f32 v139, v139
    v_exp_f32 v147, v147
    s_nop 0
    v_add_f32 v136, 1.0, v136
    v_add_f32 v144, 1.0, v144
    v_add_f32 v137, 1.0, v137
    v_add_f32 v145, 1.0, v145
    v_add_f32 v138, 1.0, v138
    v_add_f32 v146, 1.0, v146
    v_add_f32 v139, 1.0, v139
    v_add_f32 v147, 1.0, v147
    v_rcp_f32 v136, v136
    v_rcp_f32 v144, v144
    v_rcp_f32 v137, v137
    v_rcp_f32 v145, v145
    v_rcp_f32 v138, v138
    v_rcp_f32 v146, v146
    v_rcp_f32 v139, v139
    v_rcp_f32 v147, v147
    s_nop 0
    v_mul_f32 v120, v120, v136
    v_mul_f32 v121, v121, v144
    v_cvt_pk_bf16_f32 v136, v120, v121
    v_mul_f32 v122, v122, v137
    v_mul_f32 v123, v123, v145
    v_cvt_pk_bf16_f32 v137, v122, v123
    v_mul_f32 v124, v124, v138
    v_mul_f32 v125, v125, v146
    v_cvt_pk_bf16_f32 v138, v124, v125
    v_mul_f32 v126, v126, v139
    v_mul_f32 v127, v127, v147
    v_cvt_pk_bf16_f32 v139, v126, v127
    v_lshlrev_b32 v120, 16, v140
    v_and_b32 v121, 0xffff0000, v140
    v_lshlrev_b32 v140, 16, v148
    v_and_b32 v148, 0xffff0000, v148
    v_add_f32 v120, v120, v140
    v_add_f32 v121, v121, v148
    v_lshlrev_b32 v140, 16, v156
    v_and_b32 v156, 0xffff0000, v156
    v_add_f32 v120, v120, v140
    v_add_f32 v121, v121, v156
    v_lshlrev_b32 v140, 16, v164
    v_and_b32 v164, 0xffff0000, v164
    v_add_f32 v120, v120, v140
    v_add_f32 v121, v121, v164
    v_cvt_pk_bf16_f32 v140, v120, v121
    v_lshlrev_b32 v120, 16, v140
    v_and_b32 v121, 0xffff0000, v140
    v_mul_f32 v140, s89, v120
    v_mul_f32 v148, s89, v121
    v_lshlrev_b32 v122, 16, v141
    v_and_b32 v123, 0xffff0000, v141
    v_lshlrev_b32 v141, 16, v149
    v_and_b32 v149, 0xffff0000, v149
    v_add_f32 v122, v122, v141
    v_add_f32 v123, v123, v149
    v_lshlrev_b32 v141, 16, v157
    v_and_b32 v157, 0xffff0000, v157
    v_add_f32 v122, v122, v141
    v_add_f32 v123, v123, v157
    v_lshlrev_b32 v141, 16, v165
    v_and_b32 v165, 0xffff0000, v165
    v_add_f32 v122, v122, v141
    v_add_f32 v123, v123, v165
    v_cvt_pk_bf16_f32 v141, v122, v123
    v_lshlrev_b32 v122, 16, v141
    v_and_b32 v123, 0xffff0000, v141
    v_mul_f32 v141, s89, v122
    v_mul_f32 v149, s89, v123
    v_lshlrev_b32 v124, 16, v142
    v_and_b32 v125, 0xffff0000, v142
    v_lshlrev_b32 v142, 16, v150
    v_and_b32 v150, 0xffff0000, v150
    v_add_f32 v124, v124, v142
    v_add_f32 v125, v125, v150
    v_lshlrev_b32 v142, 16, v158
    v_and_b32 v158, 0xffff0000, v158
    v_add_f32 v124, v124, v142
    v_add_f32 v125, v125, v158
    v_lshlrev_b32 v142, 16, v166
    v_and_b32 v166, 0xffff0000, v166
    v_add_f32 v124, v124, v142
    v_add_f32 v125, v125, v166
    v_cvt_pk_bf16_f32 v142, v124, v125
    v_lshlrev_b32 v124, 16, v142
    v_and_b32 v125, 0xffff0000, v142
    v_mul_f32 v142, s89, v124
    v_mul_f32 v150, s89, v125
    v_lshlrev_b32 v126, 16, v143
    v_and_b32 v127, 0xffff0000, v143
    v_lshlrev_b32 v143, 16, v151
    v_and_b32 v151, 0xffff0000, v151
    v_add_f32 v126, v126, v143
    v_add_f32 v127, v127, v151
    v_lshlrev_b32 v143, 16, v159
    v_and_b32 v159, 0xffff0000, v159
    v_add_f32 v126, v126, v143
    v_add_f32 v127, v127, v159
    v_lshlrev_b32 v143, 16, v167
    v_and_b32 v167, 0xffff0000, v167
    v_add_f32 v126, v126, v143
    v_add_f32 v127, v127, v167
    v_cvt_pk_bf16_f32 v143, v126, v127
    v_lshlrev_b32 v126, 16, v143
    v_and_b32 v127, 0xffff0000, v143
    v_mul_f32 v143, s89, v126
    v_mul_f32 v151, s89, v127
    v_exp_f32 v140, v140
    v_exp_f32 v148, v148
    v_exp_f32 v141, v141
    v_exp_f32 v149, v149
    v_exp_f32 v142, v142
    v_exp_f32 v150, v150
    v_exp_f32 v143, v143
    v_exp_f32 v151, v151
    s_nop 0
    v_add_f32 v140, 1.0, v140
    v_add_f32 v148, 1.0, v148
    v_add_f32 v141, 1.0, v141
    v_add_f32 v149, 1.0, v149
    v_add_f32 v142, 1.0, v142
    v_add_f32 v150, 1.0, v150
    v_add_f32 v143, 1.0, v143
    v_add_f32 v151, 1.0, v151
    v_rcp_f32 v140, v140
    v_rcp_f32 v148, v148
    v_rcp_f32 v141, v141
    v_rcp_f32 v149, v149
    v_rcp_f32 v142, v142
    v_rcp_f32 v150, v150
    v_rcp_f32 v143, v143
    v_rcp_f32 v151, v151
    s_nop 0
    v_mul_f32 v120, v120, v140
    v_mul_f32 v121, v121, v148
    v_cvt_pk_bf16_f32 v140, v120, v121
    v_mul_f32 v122, v122, v141
    v_mul_f32 v123, v123, v149
    v_cvt_pk_bf16_f32 v141, v122, v123
    v_mul_f32 v124, v124, v142
    v_mul_f32 v125, v125, v150
    v_cvt_pk_bf16_f32 v142, v124, v125
    v_mul_f32 v126, v126, v143
    v_mul_f32 v127, v127, v151
    v_cvt_pk_bf16_f32 v143, v126, v127
    s_waitcnt vmcnt(0)
    v_lshlrev_b32 v96, 16, v16
    v_and_b32 v97, 0xffff0000, v16
    v_lshlrev_b32 v98, 16, v17
    v_and_b32 v99, 0xffff0000, v17
    v_lshlrev_b32 v100, 16, v18
    v_and_b32 v101, 0xffff0000, v18
    v_lshlrev_b32 v102, 16, v19
    v_and_b32 v103, 0xffff0000, v19
    v_lshlrev_b32 v120, 16, v20
    v_and_b32 v121, 0xffff0000, v20
    v_lshlrev_b32 v122, 16, v21
    v_and_b32 v123, 0xffff0000, v21
    v_lshlrev_b32 v124, 16, v22
    v_and_b32 v125, 0xffff0000, v22
    v_lshlrev_b32 v126, 16, v23
    v_and_b32 v127, 0xffff0000, v23
    v_add_f32 v96, v96, v120
    v_add_f32 v97, v97, v121
    v_add_f32 v98, v98, v122
    v_add_f32 v99, v99, v123
    v_add_f32 v100, v100, v124
    v_add_f32 v101, v101, v125
    v_add_f32 v102, v102, v126
    v_add_f32 v103, v103, v127
    v_lshlrev_b32 v120, 16, v24
    v_and_b32 v121, 0xffff0000, v24
    v_lshlrev_b32 v122, 16, v25
    v_and_b32 v123, 0xffff0000, v25
    v_lshlrev_b32 v124, 16, v26
    v_and_b32 v125, 0xffff0000, v26
    v_lshlrev_b32 v126, 16, v27
    v_and_b32 v127, 0xffff0000, v27
    v_add_f32 v96, v96, v120
    v_add_f32 v97, v97, v121
    v_add_f32 v98, v98, v122
    v_add_f32 v99, v99, v123
    v_add_f32 v100, v100, v124
    v_add_f32 v101, v101, v125
    v_add_f32 v102, v102, v126
    v_add_f32 v103, v103, v127
    v_lshlrev_b32 v120, 16, v28
    v_and_b32 v121, 0xffff0000, v28
    v_lshlrev_b32 v122, 16, v29
    v_and_b32 v123, 0xffff0000, v29
    v_lshlrev_b32 v124, 16, v30
    v_and_b32 v125, 0xffff0000, v30
    v_lshlrev_b32 v126, 16, v31
    v_and_b32 v127, 0xffff0000, v31
    v_add_f32 v96, v96, v120
    v_add_f32 v97, v97, v121
    v_add_f32 v98, v98, v122
    v_add_f32 v99, v99, v123
    v_add_f32 v100, v100, v124
    v_add_f32 v101, v101, v125
    v_add_f32 v102, v102, v126
    v_add_f32 v103, v103, v127
    v_lshlrev_b32 v120, 16, v32
    v_and_b32 v121, 0xffff0000, v32
    v_lshlrev_b32 v122, 16, v33
    v_and_b32 v123, 0xffff0000, v33
    v_lshlrev_b32 v124, 16, v34
    v_and_b32 v125, 0xffff0000, v34
    v_lshlrev_b32 v126, 16, v35
    v_and_b32 v127, 0xffff0000, v35
    v_add_f32 v96, v96, v120
    v_add_f32 v97, v97, v121
    v_add_f32 v98, v98, v122
    v_add_f32 v99, v99, v123
    v_add_f32 v100, v100, v124
    v_add_f32 v101, v101, v125
    v_add_f32 v102, v102, v126
    v_add_f32 v103, v103, v127
    v_lshlrev_b32 v120, 16, v36
    v_and_b32 v121, 0xffff0000, v36
    v_lshlrev_b32 v122, 16, v37
    v_and_b32 v123, 0xffff0000, v37
    v_lshlrev_b32 v124, 16, v38
    v_and_b32 v125, 0xffff0000, v38
    v_lshlrev_b32 v126, 16, v39
    v_and_b32 v127, 0xffff0000, v39
    v_add_f32 v96, v96, v120
    v_add_f32 v97, v97, v121
    v_add_f32 v98, v98, v122
    v_add_f32 v99, v99, v123
    v_add_f32 v100, v100, v124
    v_add_f32 v101, v101, v125
    v_add_f32 v102, v102, v126
    v_add_f32 v103, v103, v127
    v_lshlrev_b32 v120, 16, v40
    v_and_b32 v121, 0xffff0000, v40
    v_lshlrev_b32 v122, 16, v41
    v_and_b32 v123, 0xffff0000, v41
    v_lshlrev_b32 v124, 16, v42
    v_and_b32 v125, 0xffff0000, v42
    v_lshlrev_b32 v126, 16, v43
    v_and_b32 v127, 0xffff0000, v43
    v_add_f32 v96, v96, v120
    v_add_f32 v97, v97, v121
    v_add_f32 v98, v98, v122
    v_add_f32 v99, v99, v123
    v_add_f32 v100, v100, v124
    v_add_f32 v101, v101, v125
    v_add_f32 v102, v102, v126
    v_add_f32 v103, v103, v127
    v_lshlrev_b32 v120, 16, v44
    v_and_b32 v121, 0xffff0000, v44
    v_lshlrev_b32 v122, 16, v45
    v_and_b32 v123, 0xffff0000, v45
    v_lshlrev_b32 v124, 16, v46
    v_and_b32 v125, 0xffff0000, v46
    v_lshlrev_b32 v126, 16, v47
    v_and_b32 v127, 0xffff0000, v47
    v_add_f32 v96, v96, v120
    v_add_f32 v97, v97, v121
    v_add_f32 v98, v98, v122
    v_add_f32 v99, v99, v123
    v_add_f32 v100, v100, v124
    v_add_f32 v101, v101, v125
    v_add_f32 v102, v102, v126
    v_add_f32 v103, v103, v127
    v_cndmask_b32 v108, v88, v90, s[76:77]
    v_cndmask_b32 v109, v89, v91, s[76:77]
    v_cndmask_b32 v110, v90, v88, s[76:77]
    v_cndmask_b32 v111, v91, v89, s[76:77]
    v_cvt_pk_bf16_f32 v104, v96, v97
    v_lshlrev_b32 v96, 16, v104
    v_and_b32 v97, 0xffff0000, v104
    v_lshlrev_b32 v104, 16, v136
    v_and_b32 v105, 0xffff0000, v136
    v_mul_f32 v96, v96, v104
    v_mul_f32 v97, v97, v105
    v_cvt_pk_bf16_f32 v104, v96, v97
    v_lshlrev_b32 v96, 16, v104
    v_and_b32 v97, 0xffff0000, v104
    v_lshlrev_b32 v104, 16, v108
    v_and_b32 v105, 0xffff0000, v108
    v_add_f32 v96, v96, v104
    v_add_f32 v97, v97, v105
    v_cvt_pk_bf16_f32 v112, v96, v97
    v_cvt_pk_bf16_f32 v104, v98, v99
    v_lshlrev_b32 v98, 16, v104
    v_and_b32 v99, 0xffff0000, v104
    v_lshlrev_b32 v104, 16, v137
    v_and_b32 v105, 0xffff0000, v137
    v_mul_f32 v98, v98, v104
    v_mul_f32 v99, v99, v105
    v_cvt_pk_bf16_f32 v104, v98, v99
    v_lshlrev_b32 v98, 16, v104
    v_and_b32 v99, 0xffff0000, v104
    v_lshlrev_b32 v104, 16, v109
    v_and_b32 v105, 0xffff0000, v109
    v_add_f32 v98, v98, v104
    v_add_f32 v99, v99, v105
    v_cvt_pk_bf16_f32 v113, v98, v99
    v_cvt_pk_bf16_f32 v104, v100, v101
    v_lshlrev_b32 v100, 16, v104
    v_and_b32 v101, 0xffff0000, v104
    v_lshlrev_b32 v104, 16, v138
    v_and_b32 v105, 0xffff0000, v138
    v_mul_f32 v100, v100, v104
    v_mul_f32 v101, v101, v105
    v_cvt_pk_bf16_f32 v104, v100, v101
    v_lshlrev_b32 v100, 16, v104
    v_and_b32 v101, 0xffff0000, v104
    v_lshlrev_b32 v104, 16, v110
    v_and_b32 v105, 0xffff0000, v110
    v_add_f32 v100, v100, v104
    v_add_f32 v101, v101, v105
    v_cvt_pk_bf16_f32 v114, v100, v101
    v_cvt_pk_bf16_f32 v104, v102, v103
    v_lshlrev_b32 v102, 16, v104
    v_and_b32 v103, 0xffff0000, v104
    v_lshlrev_b32 v104, 16, v139
    v_and_b32 v105, 0xffff0000, v139
    v_mul_f32 v102, v102, v104
    v_mul_f32 v103, v103, v105
    v_cvt_pk_bf16_f32 v104, v102, v103
    v_lshlrev_b32 v102, 16, v104
    v_and_b32 v103, 0xffff0000, v104
    v_lshlrev_b32 v104, 16, v111
    v_and_b32 v105, 0xffff0000, v111
    v_add_f32 v102, v102, v104
    v_add_f32 v103, v103, v105
    v_cvt_pk_bf16_f32 v115, v102, v103
    v_cndmask_b32 v128, v112, v114, s[76:77]
    v_cndmask_b32 v129, v113, v115, s[76:77]
    v_cndmask_b32 v130, v114, v112, s[76:77]
    v_cndmask_b32 v131, v115, v113, s[76:77]
    buffer_store_dwordx4 v[128:131], v4, s[12:15], s74 offen offset:0
    v_lshlrev_b32 v96, 16, v48
    v_and_b32 v97, 0xffff0000, v48
    v_lshlrev_b32 v98, 16, v49
    v_and_b32 v99, 0xffff0000, v49
    v_lshlrev_b32 v100, 16, v50
    v_and_b32 v101, 0xffff0000, v50
    v_lshlrev_b32 v102, 16, v51
    v_and_b32 v103, 0xffff0000, v51
    v_lshlrev_b32 v120, 16, v52
    v_and_b32 v121, 0xffff0000, v52
    v_lshlrev_b32 v122, 16, v53
    v_and_b32 v123, 0xffff0000, v53
    v_lshlrev_b32 v124, 16, v54
    v_and_b32 v125, 0xffff0000, v54
    v_lshlrev_b32 v126, 16, v55
    v_and_b32 v127, 0xffff0000, v55
    v_add_f32 v96, v96, v120
    v_add_f32 v97, v97, v121
    v_add_f32 v98, v98, v122
    v_add_f32 v99, v99, v123
    v_add_f32 v100, v100, v124
    v_add_f32 v101, v101, v125
    v_add_f32 v102, v102, v126
    v_add_f32 v103, v103, v127
    v_lshlrev_b32 v120, 16, v56
    v_and_b32 v121, 0xffff0000, v56
    v_lshlrev_b32 v122, 16, v57
    v_and_b32 v123, 0xffff0000, v57
    v_lshlrev_b32 v124, 16, v58
    v_and_b32 v125, 0xffff0000, v58
    v_lshlrev_b32 v126, 16, v59
    v_and_b32 v127, 0xffff0000, v59
    v_add_f32 v96, v96, v120
    v_add_f32 v97, v97, v121
    v_add_f32 v98, v98, v122
    v_add_f32 v99, v99, v123
    v_add_f32 v100, v100, v124
    v_add_f32 v101, v101, v125
    v_add_f32 v102, v102, v126
    v_add_f32 v103, v103, v127
    v_lshlrev_b32 v120, 16, v60
    v_and_b32 v121, 0xffff0000, v60
    v_lshlrev_b32 v122, 16, v61
    v_and_b32 v123, 0xffff0000, v61
    v_lshlrev_b32 v124, 16, v62
    v_and_b32 v125, 0xffff0000, v62
    v_lshlrev_b32 v126, 16, v63
    v_and_b32 v127, 0xffff0000, v63
    v_add_f32 v96, v96, v120
    v_add_f32 v97, v97, v121
    v_add_f32 v98, v98, v122
    v_add_f32 v99, v99, v123
    v_add_f32 v100, v100, v124
    v_add_f32 v101, v101, v125
    v_add_f32 v102, v102, v126
    v_add_f32 v103, v103, v127
    v_lshlrev_b32 v120, 16, v64
    v_and_b32 v121, 0xffff0000, v64
    v_lshlrev_b32 v122, 16, v65
    v_and_b32 v123, 0xffff0000, v65
    v_lshlrev_b32 v124, 16, v66
    v_and_b32 v125, 0xffff0000, v66
    v_lshlrev_b32 v126, 16, v67
    v_and_b32 v127, 0xffff0000, v67
    v_add_f32 v96, v96, v120
    v_add_f32 v97, v97, v121
    v_add_f32 v98, v98, v122
    v_add_f32 v99, v99, v123
    v_add_f32 v100, v100, v124
    v_add_f32 v101, v101, v125
    v_add_f32 v102, v102, v126
    v_add_f32 v103, v103, v127
    v_lshlrev_b32 v120, 16, v68
    v_and_b32 v121, 0xffff0000, v68
    v_lshlrev_b32 v122, 16, v69
    v_and_b32 v123, 0xffff0000, v69
    v_lshlrev_b32 v124, 16, v70
    v_and_b32 v125, 0xffff0000, v70
    v_lshlrev_b32 v126, 16, v71
    v_and_b32 v127, 0xffff0000, v71
    v_add_f32 v96, v96, v120
    v_add_f32 v97, v97, v121
    v_add_f32 v98, v98, v122
    v_add_f32 v99, v99, v123
    v_add_f32 v100, v100, v124
    v_add_f32 v101, v101, v125
    v_add_f32 v102, v102, v126
    v_add_f32 v103, v103, v127
    v_lshlrev_b32 v120, 16, v72
    v_and_b32 v121, 0xffff0000, v72
    v_lshlrev_b32 v122, 16, v73
    v_and_b32 v123, 0xffff0000, v73
    v_lshlrev_b32 v124, 16, v74
    v_and_b32 v125, 0xffff0000, v74
    v_lshlrev_b32 v126, 16, v75
    v_and_b32 v127, 0xffff0000, v75
    v_add_f32 v96, v96, v120
    v_add_f32 v97, v97, v121
    v_add_f32 v98, v98, v122
    v_add_f32 v99, v99, v123
    v_add_f32 v100, v100, v124
    v_add_f32 v101, v101, v125
    v_add_f32 v102, v102, v126
    v_add_f32 v103, v103, v127
    v_lshlrev_b32 v120, 16, v76
    v_and_b32 v121, 0xffff0000, v76
    v_lshlrev_b32 v122, 16, v77
    v_and_b32 v123, 0xffff0000, v77
    v_lshlrev_b32 v124, 16, v78
    v_and_b32 v125, 0xffff0000, v78
    v_lshlrev_b32 v126, 16, v79
    v_and_b32 v127, 0xffff0000, v79
    v_add_f32 v96, v96, v120
    v_add_f32 v97, v97, v121
    v_add_f32 v98, v98, v122
    v_add_f32 v99, v99, v123
    v_add_f32 v100, v100, v124
    v_add_f32 v101, v101, v125
    v_add_f32 v102, v102, v126
    v_add_f32 v103, v103, v127
    v_cndmask_b32 v108, v92, v94, s[76:77]
    v_cndmask_b32 v109, v93, v95, s[76:77]
    v_cndmask_b32 v110, v94, v92, s[76:77]
    v_cndmask_b32 v111, v95, v93, s[76:77]
    v_cvt_pk_bf16_f32 v104, v96, v97
    v_lshlrev_b32 v96, 16, v104
    v_and_b32 v97, 0xffff0000, v104
    v_lshlrev_b32 v104, 16, v140
    v_and_b32 v105, 0xffff0000, v140
    v_mul_f32 v96, v96, v104
    v_mul_f32 v97, v97, v105
    v_cvt_pk_bf16_f32 v104, v96, v97
    v_lshlrev_b32 v96, 16, v104
    v_and_b32 v97, 0xffff0000, v104
    v_lshlrev_b32 v104, 16, v108
    v_and_b32 v105, 0xffff0000, v108
    v_add_f32 v96, v96, v104
    v_add_f32 v97, v97, v105
    v_cvt_pk_bf16_f32 v112, v96, v97
    v_cvt_pk_bf16_f32 v104, v98, v99
    v_lshlrev_b32 v98, 16, v104
    v_and_b32 v99, 0xffff0000, v104
    v_lshlrev_b32 v104, 16, v141
    v_and_b32 v105, 0xffff0000, v141
    v_mul_f32 v98, v98, v104
    v_mul_f32 v99, v99, v105
    v_cvt_pk_bf16_f32 v104, v98, v99
    v_lshlrev_b32 v98, 16, v104
    v_and_b32 v99, 0xffff0000, v104
    v_lshlrev_b32 v104, 16, v109
    v_and_b32 v105, 0xffff0000, v109
    v_add_f32 v98, v98, v104
    v_add_f32 v99, v99, v105
    v_cvt_pk_bf16_f32 v113, v98, v99
    v_cvt_pk_bf16_f32 v104, v100, v101
    v_lshlrev_b32 v100, 16, v104
    v_and_b32 v101, 0xffff0000, v104
    v_lshlrev_b32 v104, 16, v142
    v_and_b32 v105, 0xffff0000, v142
    v_mul_f32 v100, v100, v104
    v_mul_f32 v101, v101, v105
    v_cvt_pk_bf16_f32 v104, v100, v101
    v_lshlrev_b32 v100, 16, v104
    v_and_b32 v101, 0xffff0000, v104
    v_lshlrev_b32 v104, 16, v110
    v_and_b32 v105, 0xffff0000, v110
    v_add_f32 v100, v100, v104
    v_add_f32 v101, v101, v105
    v_cvt_pk_bf16_f32 v114, v100, v101
    v_cvt_pk_bf16_f32 v104, v102, v103
    v_lshlrev_b32 v102, 16, v104
    v_and_b32 v103, 0xffff0000, v104
    v_lshlrev_b32 v104, 16, v143
    v_and_b32 v105, 0xffff0000, v143
    v_mul_f32 v102, v102, v104
    v_mul_f32 v103, v103, v105
    v_cvt_pk_bf16_f32 v104, v102, v103
    v_lshlrev_b32 v102, 16, v104
    v_and_b32 v103, 0xffff0000, v104
    v_lshlrev_b32 v104, 16, v111
    v_and_b32 v105, 0xffff0000, v111
    v_add_f32 v102, v102, v104
    v_add_f32 v103, v103, v105
    v_cvt_pk_bf16_f32 v115, v102, v103
    v_cndmask_b32 v132, v112, v114, s[76:77]
    v_cndmask_b32 v133, v113, v115, s[76:77]
    v_cndmask_b32 v134, v114, v112, s[76:77]
    v_cndmask_b32 v135, v115, v113, s[76:77]
    buffer_store_dwordx4 v[132:135], v4, s[12:15], s74 offen offset:64
    s_branch w_fin_done
fin_tail:
    s_mov_b32 s81, s36
    s_lshl_b32 s81, s81, 2
    s_and_b32 s82, s3, 3
    s_add_u32 s81, s81, s82
    s_lshr_b32 s82, s81, 5
    s_and_b32 s81, s81, 31
    s_lshl_b32 s72, s80, 1
    s_add_u32 s72, s72, s82
    s_lshl_b32 s74, s72, 15
    s_lshl_b32 s73, s81, 10
    s_add_u32 s73, s73, s74
    s_lshl_b32 s75, s81, 6
    s_add_u32 s74, s74, s75
    s_add_u32 s78, s73, 117440512
    s_add_u32 s79, s73, 75497472
    s_mov_b32 s83, 218106816
    s_mov_b32 s84, 65536
    s_min_u32 s87, s80, 62
    v_and_b32 v8, 7, v1
    v_lshlrev_b32 v8, 22, v8
    s_cmp_lg_u32 s3, 0
    s_cbranch_scc1 ft_ok
ft_wd:
    buffer_load_dword v7, off, s[4:7], s83 sc1
    s_waitcnt vmcnt(0)
    v_readfirstlane_b32 s86, v7
    s_cmp_ge_u32 s86, 16
    s_cbranch_scc1 ft_wdok
    s_sleep 32
    s_sub_u32 s84, s84, 1
    s_cbranch_scc0 ft_wd
    s_mov_b32 s84, 0
ft_wdok:
ft_ok:
    s_barrier
    s_cmp_ge_u32 s3, 4
    s_cbranch_scc1 w_fin_done
    buffer_load_dwordx4 v[88:91], v4, s[8:11], s74 offen
    buffer_load_dwordx4 v[136:139], v3, s[4:7], s78 offen sc1
    s_add_u32 s78, s78, 4194304
    buffer_load_dwordx4 v[144:147], v3, s[4:7], s78 offen sc1
    s_add_u32 s78, s78, 4194304
    buffer_load_dwordx4 v[152:155], v3, s[4:7], s78 offen sc1
    s_add_u32 s78, s78, 4194304
    buffer_load_dwordx4 v[160:163], v3, s[4:7], s78 offen sc1
    s_add_u32 s78, s78, 4194304
    s_waitcnt vmcnt(0)
    v_lshlrev_b32 v120, 16, v136
    v_and_b32 v121, 0xffff0000, v136
    v_lshlrev_b32 v136, 16, v144
    v_and_b32 v144, 0xffff0000, v144
    v_add_f32 v120, v120, v136
    v_add_f32 v121, v121, v144
    v_lshlrev_b32 v136, 16, v152
    v_and_b32 v152, 0xffff0000, v152
    v_add_f32 v120, v120, v136
    v_add_f32 v121, v121, v152
    v_lshlrev_b32 v136, 16, v160
    v_and_b32 v160, 0xffff0000, v160
    v_add_f32 v120, v120, v136
    v_add_f32 v121, v121, v160
    v_cvt_pk_bf16_f32 v136, v120, v121
    v_lshlrev_b32 v120, 16, v136
    v_and_b32 v121, 0xffff0000, v136
    v_mul_f32 v136, s89, v120
    v_mul_f32 v144, s89, v121
    v_lshlrev_b32 v122, 16, v137
    v_and_b32 v123, 0xffff0000, v137
    v_lshlrev_b32 v137, 16, v145
    v_and_b32 v145, 0xffff0000, v145
    v_add_f32 v122, v122, v137
    v_add_f32 v123, v123, v145
    v_lshlrev_b32 v137, 16, v153
    v_and_b32 v153, 0xffff0000, v153
    v_add_f32 v122, v122, v137
    v_add_f32 v123, v123, v153
    v_lshlrev_b32 v137, 16, v161
    v_and_b32 v161, 0xffff0000, v161
    v_add_f32 v122, v122, v137
    v_add_f32 v123, v123, v161
    v_cvt_pk_bf16_f32 v137, v122, v123
    v_lshlrev_b32 v122, 16, v137
    v_and_b32 v123, 0xffff0000, v137
    v_mul_f32 v137, s89, v122
    v_mul_f32 v145, s89, v123
    v_lshlrev_b32 v124, 16, v138
    v_and_b32 v125, 0xffff0000, v138
    v_lshlrev_b32 v138, 16, v146
    v_and_b32 v146, 0xffff0000, v146
    v_add_f32 v124, v124, v138
    v_add_f32 v125, v125, v146
    v_lshlrev_b32 v138, 16, v154
    v_and_b32 v154, 0xffff0000, v154
    v_add_f32 v124, v124, v138
    v_add_f32 v125, v125, v154
    v_lshlrev_b32 v138, 16, v162
    v_and_b32 v162, 0xffff0000, v162
    v_add_f32 v124, v124, v138
    v_add_f32 v125, v125, v162
    v_cvt_pk_bf16_f32 v138, v124, v125
    v_lshlrev_b32 v124, 16, v138
    v_and_b32 v125, 0xffff0000, v138
    v_mul_f32 v138, s89, v124
    v_mul_f32 v146, s89, v125
    v_lshlrev_b32 v126, 16, v139
    v_and_b32 v127, 0xffff0000, v139
    v_lshlrev_b32 v139, 16, v147
    v_and_b32 v147, 0xffff0000, v147
    v_add_f32 v126, v126, v139
    v_add_f32 v127, v127, v147
    v_lshlrev_b32 v139, 16, v155
    v_and_b32 v155, 0xffff0000, v155
    v_add_f32 v126, v126, v139
    v_add_f32 v127, v127, v155
    v_lshlrev_b32 v139, 16, v163
    v_and_b32 v163, 0xffff0000, v163
    v_add_f32 v126, v126, v139
    v_add_f32 v127, v127, v163
    v_cvt_pk_bf16_f32 v139, v126, v127
    v_lshlrev_b32 v126, 16, v139
    v_and_b32 v127, 0xffff0000, v139
    v_mul_f32 v139, s89, v126
    v_mul_f32 v147, s89, v127
    v_exp_f32 v136, v136
    v_exp_f32 v144, v144
    v_exp_f32 v137, v137
    v_exp_f32 v145, v145
    v_exp_f32 v138, v138
    v_exp_f32 v146, v146
    v_exp_f32 v139, v139
    v_exp_f32 v147, v147
    s_nop 0
    v_add_f32 v136, 1.0, v136
    v_add_f32 v144, 1.0, v144
    v_add_f32 v137, 1.0, v137
    v_add_f32 v145, 1.0, v145
    v_add_f32 v138, 1.0, v138
    v_add_f32 v146, 1.0, v146
    v_add_f32 v139, 1.0, v139
    v_add_f32 v147, 1.0, v147
    v_rcp_f32 v136, v136
    v_rcp_f32 v144, v144
    v_rcp_f32 v137, v137
    v_rcp_f32 v145, v145
    v_rcp_f32 v138, v138
    v_rcp_f32 v146, v146
    v_rcp_f32 v139, v139
    v_rcp_f32 v147, v147
    s_nop 0
    v_mul_f32 v120, v120, v136
    v_mul_f32 v121, v121, v144
    v_cvt_pk_bf16_f32 v136, v120, v121
    v_mul_f32 v122, v122, v137
    v_mul_f32 v123, v123, v145
    v_cvt_pk_bf16_f32 v137, v122, v123
    v_mul_f32 v124, v124, v138
    v_mul_f32 v125, v125, v146
    v_cvt_pk_bf16_f32 v138, v124, v125
    v_mul_f32 v126, v126, v139
    v_mul_f32 v127, v127, v147
    v_cvt_pk_bf16_f32 v139, v126, v127
ft_ws:
    buffer_load_dword v7, v6, s[4:7], s85 offen sc1
    s_waitcnt vmcnt(0)
    v_cmp_gt_u32 vcc, s87, v7
    s_cbranch_vccz ft_p
    s_sleep 12
    v_cmp_gt_u32 vcc, 59, v7
    s_cbranch_vccz ft_wsf
    s_sleep 64
    v_cmp_gt_u32 vcc, 56, v7
    s_cbranch_vccz ft_wsf
    s_sleep 127
    s_sleep 127
ft_wsf:
    s_sub_u32 s84, s84, 1
    s_cbranch_scc0 ft_ws
    s_mov_b32 s84, 0
ft_p:
    buffer_load_dword v7, v8, s[4:7], s79 offen offset:1008 sc1
    s_waitcnt vmcnt(0)
    v_cmp_eq_u32 vcc, -1, v7
    s_cbranch_vccz ft_l0
    s_sleep 4
    s_sub_u32 s84, s84, 1
    s_cbranch_scc0 ft_p
    s_mov_b32 s84, 0
ft_l0:
    s_cmp_lg_u32 s3, 0
    s_cbranch_scc1 clm_16
    v_mov_b32 v250, 1
    s_mov_b64 exec, 1
    buffer_atomic_add v250, off, s[64:67], s71 sc0 sc1
    s_mov_b64 exec, -1
clm_16:
ft_l:
    s_mov_b32 s86, s79
    buffer_load_dwordx4 v[16:19], v3, s[4:7], s86 offen sc1
    s_add_u32 s86, s86, 4194304
    buffer_load_dwordx4 v[20:23], v3, s[4:7], s86 offen sc1
    s_add_u32 s86, s86, 4194304
    buffer_load_dwordx4 v[24:27], v3, s[4:7], s86 offen sc1
    s_add_u32 s86, s86, 4194304
    buffer_load_dwordx4 v[28:31], v3, s[4:7], s86 offen sc1
    s_add_u32 s86, s86, 4194304
    buffer_load_dwordx4 v[32:35], v3, s[4:7], s86 offen sc1
    s_add_u32 s86, s86, 4194304
    buffer_load_dwordx4 v[36:39], v3, s[4:7], s86 offen sc1
    s_add_u32 s86, s86, 4194304
    buffer_load_dwordx4 v[40:43], v3, s[4:7], s86 offen sc1
    s_add_u32 s86, s86, 4194304
    buffer_load_dwordx4 v[44:47], v3, s[4:7], s86 offen sc1
    s_waitcnt vmcnt(0)
    v_max3_u32 v7, v16, v20, v24
    v_max3_u32 v7, v7, v28, v32
    v_max3_u32 v7, v7, v36, v40
    v_max_u32 v7, v7, v44
    v_cmp_eq_u32 vcc, -1, v7
    s_cbranch_vccz ft_go
    s_sub_u32 s84, s84, 1
    s_cbranch_scc0 ft_l
ft_go:
    v_lshlrev_b32 v96, 16, v16
    v_and_b32 v97, 0xffff0000, v16
    v_lshlrev_b32 v98, 16, v17
    v_and_b32 v99, 0xffff0000, v17
    v_lshlrev_b32 v100, 16, v18
    v_and_b32 v101, 0xffff0000, v18
    v_lshlrev_b32 v102, 16, v19
    v_and_b32 v103, 0xffff0000, v19
    v_lshlrev_b32 v120, 16, v20
    v_and_b32 v121, 0xffff0000, v20
    v_lshlrev_b32 v122, 16, v21
    v_and_b32 v123, 0xffff0000, v21
    v_lshlrev_b32 v124, 16, v22
    v_and_b32 v125, 0xffff0000, v22
    v_lshlrev_b32 v126, 16, v23
    v_and_b32 v127, 0xffff0000, v23
    v_add_f32 v96, v96, v120
    v_add_f32 v97, v97, v121
    v_add_f32 v98, v98, v122
    v_add_f32 v99, v99, v123
    v_add_f32 v100, v100, v124
    v_add_f32 v101, v101, v125
    v_add_f32 v102, v102, v126
    v_add_f32 v103, v103, v127
    v_lshlrev_b32 v120, 16, v24
    v_and_b32 v121, 0xffff0000, v24
    v_lshlrev_b32 v122, 16, v25
    v_and_b32 v123, 0xffff0000, v25
    v_lshlrev_b32 v124, 16, v26
    v_and_b32 v125, 0xffff0000, v26
    v_lshlrev_b32 v126, 16, v27
    v_and_b32 v127, 0xffff0000, v27
    v_add_f32 v96, v96, v120
    v_add_f32 v97, v97, v121
    v_add_f32 v98, v98, v122
    v_add_f32 v99, v99, v123
    v_add_f32 v100, v100, v124
    v_add_f32 v101, v101, v125
    v_add_f32 v102, v102, v126
    v_add_f32 v103, v103, v127
    v_lshlrev_b32 v120, 16, v28
    v_and_b32 v121, 0xffff0000, v28
    v_lshlrev_b32 v122, 16, v29
    v_and_b32 v123, 0xffff0000, v29
    v_lshlrev_b32 v124, 16, v30
    v_and_b32 v125, 0xffff0000, v30
    v_lshlrev_b32 v126, 16, v31
    v_and_b32 v127, 0xffff0000, v31
    v_add_f32 v96, v96, v120
    v_add_f32 v97, v97, v121
    v_add_f32 v98, v98, v122
    v_add_f32 v99, v99, v123
    v_add_f32 v100, v100, v124
    v_add_f32 v101, v101, v125
    v_add_f32 v102, v102, v126
    v_add_f32 v103, v103, v127
    v_lshlrev_b32 v120, 16, v32
    v_and_b32 v121, 0xffff0000, v32
    v_lshlrev_b32 v122, 16, v33
    v_and_b32 v123, 0xffff0000, v33
    v_lshlrev_b32 v124, 16, v34
    v_and_b32 v125, 0xffff0000, v34
    v_lshlrev_b32 v126, 16, v35
    v_and_b32 v127, 0xffff0000, v35
    v_add_f32 v96, v96, v120
    v_add_f32 v97, v97, v121
    v_add_f32 v98, v98, v122
    v_add_f32 v99, v99, v123
    v_add_f32 v100, v100, v124
    v_add_f32 v101, v101, v125
    v_add_f32 v102, v102, v126
    v_add_f32 v103, v103, v127
    v_lshlrev_b32 v120, 16, v36
    v_and_b32 v121, 0xffff0000, v36
    v_lshlrev_b32 v122, 16, v37
    v_and_b32 v123, 0xffff0000, v37
    v_lshlrev_b32 v124, 16, v38
    v_and_b32 v125, 0xffff0000, v38
    v_lshlrev_b32 v126, 16, v39
    v_and_b32 v127, 0xffff0000, v39
    v_add_f32 v96, v96, v120
    v_add_f32 v97, v97, v121
    v_add_f32 v98, v98, v122
    v_add_f32 v99, v99, v123
    v_add_f32 v100, v100, v124
    v_add_f32 v101, v101, v125
    v_add_f32 v102, v102, v126
    v_add_f32 v103, v103, v127
    v_lshlrev_b32 v120, 16, v40
    v_and_b32 v121, 0xffff0000, v40
    v_lshlrev_b32 v122, 16, v41
    v_and_b32 v123, 0xffff0000, v41
    v_lshlrev_b32 v124, 16, v42
    v_and_b32 v125, 0xffff0000, v42
    v_lshlrev_b32 v126, 16, v43
    v_and_b32 v127, 0xffff0000, v43
    v_add_f32 v96, v96, v120
    v_add_f32 v97, v97, v121
    v_add_f32 v98, v98, v122
    v_add_f32 v99, v99, v123
    v_add_f32 v100, v100, v124
    v_add_f32 v101, v101, v125
    v_add_f32 v102, v102, v126
    v_add_f32 v103, v103, v127
    v_lshlrev_b32 v120, 16, v44
    v_and_b32 v121, 0xffff0000, v44
    v_lshlrev_b32 v122, 16, v45
    v_and_b32 v123, 0xffff0000, v45
    v_lshlrev_b32 v124, 16, v46
    v_and_b32 v125, 0xffff0000, v46
    v_lshlrev_b32 v126, 16, v47
    v_and_b32 v127, 0xffff0000, v47
    v_add_f32 v96, v96, v120
    v_add_f32 v97, v97, v121
    v_add_f32 v98, v98, v122
    v_add_f32 v99, v99, v123
    v_add_f32 v100, v100, v124
    v_add_f32 v101, v101, v125
    v_add_f32 v102, v102, v126
    v_add_f32 v103, v103, v127
    v_cndmask_b32 v108, v88, v90, s[76:77]
    v_cndmask_b32 v109, v89, v91, s[76:77]
    v_cndmask_b32 v110, v90, v88, s[76:77]
    v_cndmask_b32 v111, v91, v89, s[76:77]
    v_cvt_pk_bf16_f32 v104, v96, v97
    v_lshlrev_b32 v96, 16, v104
    v_and_b32 v97, 0xffff0000, v104
    v_lshlrev_b32 v104, 16, v136
    v_and_b32 v105, 0xffff0000, v136
    v_mul_f32 v96, v96, v104
    v_mul_f32 v97, v97, v105
    v_cvt_pk_bf16_f32 v104, v96, v97
    v_lshlrev_b32 v96, 16, v104
    v_and_b32 v97, 0xffff0000, v104
    v_lshlrev_b32 v104, 16, v108
    v_and_b32 v105, 0xffff0000, v108
    v_add_f32 v96, v96, v104
    v_add_f32 v97, v97, v105
    v_cvt_pk_bf16_f32 v112, v96, v97
    v_cvt_pk_bf16_f32 v104, v98, v99
    v_lshlrev_b32 v98, 16, v104
    v_and_b32 v99, 0xffff0000, v104
    v_lshlrev_b32 v104, 16, v137
    v_and_b32 v105, 0xffff0000, v137
    v_mul_f32 v98, v98, v104
    v_mul_f32 v99, v99, v105
    v_cvt_pk_bf16_f32 v104, v98, v99
    v_lshlrev_b32 v98, 16, v104
    v_and_b32 v99, 0xffff0000, v104
    v_lshlrev_b32 v104, 16, v109
    v_and_b32 v105, 0xffff0000, v109
    v_add_f32 v98, v98, v104
    v_add_f32 v99, v99, v105
    v_cvt_pk_bf16_f32 v113, v98, v99
    v_cvt_pk_bf16_f32 v104, v100, v101
    v_lshlrev_b32 v100, 16, v104
    v_and_b32 v101, 0xffff0000, v104
    v_lshlrev_b32 v104, 16, v138
    v_and_b32 v105, 0xffff0000, v138
    v_mul_f32 v100, v100, v104
    v_mul_f32 v101, v101, v105
    v_cvt_pk_bf16_f32 v104, v100, v101
    v_lshlrev_b32 v100, 16, v104
    v_and_b32 v101, 0xffff0000, v104
    v_lshlrev_b32 v104, 16, v110
    v_and_b32 v105, 0xffff0000, v110
    v_add_f32 v100, v100, v104
    v_add_f32 v101, v101, v105
    v_cvt_pk_bf16_f32 v114, v100, v101
    v_cvt_pk_bf16_f32 v104, v102, v103
    v_lshlrev_b32 v102, 16, v104
    v_and_b32 v103, 0xffff0000, v104
    v_lshlrev_b32 v104, 16, v139
    v_and_b32 v105, 0xffff0000, v139
    v_mul_f32 v102, v102, v104
    v_mul_f32 v103, v103, v105
    v_cvt_pk_bf16_f32 v104, v102, v103
    v_lshlrev_b32 v102, 16, v104
    v_and_b32 v103, 0xffff0000, v104
    v_lshlrev_b32 v104, 16, v111
    v_and_b32 v105, 0xffff0000, v111
    v_add_f32 v102, v102, v104
    v_add_f32 v103, v103, v105
    v_cvt_pk_bf16_f32 v115, v102, v103
    v_cndmask_b32 v128, v112, v114, s[76:77]
    v_cndmask_b32 v129, v113, v115, s[76:77]
    v_cndmask_b32 v130, v114, v112, s[76:77]
    v_cndmask_b32 v131, v115, v113, s[76:77]
    buffer_store_dwordx4 v[128:131], v4, s[12:15], s74 offen offset:0
    s_branch w_fin_done
w_fin_done:
    s_cmp_lg_u32 s3, 0
    s_cbranch_scc1 pub_17
    v_mov_b32 v20, 131136
    s_mov_b64 exec, 1
    ds_write_b32 v20, v250
    s_mov_b64 exec, -1
    s_waitcnt lgkmcnt(0)
pub_17:
    s_barrier
    v_mov_b32 v20, 131136
    ds_read_b32 v20, v20
    s_waitcnt lgkmcnt(0)
    v_readfirstlane_b32 s59, v20
    s_add_u32 s59, s59, 32
    s_min_u32 s59, s59, 319
    s_lshl_b32 s57, s59, 6
    s_load_dwordx16 s[32:47], s[24:25], s57
    s_waitcnt lgkmcnt(0)
    s_barrier
    s_sub_u32 s57, s32, 1
    s_cmp_ge_u32 s57, 5
    s_cbranch_scc1 w_cold
    v_and_b32 v20, 63, v0
    v_lshlrev_b32 v1, 4, v20
    v_add_u32 v19, 0x1000, v1
    v_lshrrev_b32 v4, 4, v20
    v_mov_b32 v17, 0
    v_mov_b32 v18, 1
    s_lshr_b32 s26, s3, 2
    s_and_b32 s27, s3, 3
    s_lshl_b32 s21, s3, 11
    s_lshl_b32 s22, s3, 10
    s_add_u32 s22, s22, 16384
    s_mov_b32 s11, 131072
    s_mov_b32 s15, 131072
    s_mov_b32 s28, 0
    v_and_b32 v21, 15, v20
    v_lshlrev_b32 v22, 2, v4
    v_xor_b32 v21, v21, v22
    s_lshr_b32 s30, s3, 1
    s_and_b32 s30, s30, 1
    v_xor_b32 v21, s30, v21
    v_lshlrev_b32 v3, 4, v21
    s_lshl_b32 s30, s26, 13
    v_add_u32 v5, s30, v1
    v_add_u32 v6, 0x10000, v5
    v_bfe_u32 v21, v20, 2, 2
    v_and_b32 v22, 3, v20
    v_and_b32 v23, 1, v4
    v_xor_b32 v24, s27, v21
    v_xor_b32 v25, v22, v23
    v_lshl_add_u32 v24, v24, 2, v25
    v_lshlrev_b32 v24, 4, v24
    v_lshl_add_u32 v25, v4, 3, v21
    v_lshl_add_u32 v24, v25, 8, v24
    v_and_b32 v22, 1, v22
    v_xor_b32 v25, 0, v23
    v_lshl_add_u32 v8, v25, 10, v24
    v_xor_b32 v25, 0, v22
    v_lshl_add_u32 v8, v25, 3, v8
    v_add_u32 v12, 0x10000, v8
    v_xor_b32 v25, 1, v23
    v_lshl_add_u32 v9, v25, 10, v24
    v_xor_b32 v25, 0, v22
    v_lshl_add_u32 v9, v25, 3, v9
    v_add_u32 v13, 0x10000, v9
    v_xor_b32 v25, 0, v23
    v_lshl_add_u32 v10, v25, 10, v24
    v_xor_b32 v25, 1, v22
    v_lshl_add_u32 v10, v25, 3, v10
    v_add_u32 v14, 0x10000, v10
    v_xor_b32 v25, 1, v23
    v_lshl_add_u32 v11, v25, 10, v24
    v_xor_b32 v25, 1, v22
    v_lshl_add_u32 v11, v25, 3, v11
    v_add_u32 v15, 0x10000, v11
    s_lshl_b32 s30, s3, 2
    s_add_u32 s30, s30, 131072
    v_mov_b32 v7, s30
    s_branch w_cold
chain_map:
    s_lshl_b32 s52, s12, 5
    s_add_u32 s52, s52, s13
    s_lshr_b32 s15, s52, 2
    s_lshr_b32 s14, s52, 4
    s_and_b32 s34, s13, 15
    s_and_b32 s53, s13, 3
    s_mov_b32 s16, 0
    s_mov_b32 s22, 131072
    s_mov_b32 s100, 131072
    s_getreg_b32 s40, hwreg(HW_REG_XCC_ID)
    s_and_b32 s40, s40, 15
    s_mul_i32 s19, s40, s40
    s_lshl_b32 s19, s19, 18
    s_lshl_b32 s40, s40, 8
    s_add_u32 s40, s40, s19
    s_add_u32 s40, s40, 1
    s_lshl_b32 s35, s14, 4
    s_add_u32 s35, s35, 218104320
    s_and_b32 s21, s3, 3
    s_mul_i32 s42, s21, 24576
    s_add_u32 s42, s42, 65536
    s_lshl_b32 s41, s14, 2
    s_add_u32 s41, s41, s21
    s_lshl_b32 s41, s41, 12
    s_add_u32 s101, s42, 8192
    s_bfe_u32 s17, s34, 0x20001
    s_cmp_eq_u32 s17, s21
    s_cselect_b32 s68, 20480, s42
    s_xor_b32 s68, s68, s101
    s_lshl_b32 s43, s21, 13
    s_add_u32 s43, s43, 138412032
    s_lshl_b32 s69, s21, 24
    s_lshl_b32 s17, s52, 10
    s_add_u32 s69, s69, s17
    s_add_u32 s69, s69, 20971520
    s_cmp_ge_u32 s3, 4
    s_cbranch_scc1 ch_a_pro
    s_add_u32 s41, s41, 262144
    s_lshl_b32 s38, s15, 13
    s_add_u32 s38, s38, 214958080
    s_lshl_b32 s17, s13, 1
    s_and_b32 s18, s3, 1
    s_add_u32 s17, s17, s18
    s_lshl_b32 s17, s17, 1
    s_cmp_lt_u32 s3, 2
    s_cselect_b32 s56, 0xff, 0
    s_mov_b32 s57, s56
    s_lshr_b32 s18, s17, 1
    s_and_b32 s19, s17, 1
    s_lshl_b32 s20, s12, 14
    s_add_u32 s20, s20, 213909504
    s_lshl_b32 s36, s3, 12
    s_add_u32 s36, s36, s20
    s_lshl_b32 s37, s18, 8
    s_add_u32 s37, s37, s20
    s_lshl_b32 s20, s19, 5
    s_add_u32 s37, s37, s20
    s_lshr_b32 s39, s17, 3
    s_lshl_b32 s39, s39, 14
    s_and_b32 s20, s17, 7
    s_lshl_b32 s20, s20, 10
    s_add_u32 s39, s39, s20
    s_add_u32 s39, s39, 209715200
    s_lshl_b32 s30, s14, 22
    s_lshl_b32 s20, s34, 11
    s_add_u32 s30, s30, s20
    s_lshl_b32 s20, s3, 9
    s_add_u32 s30, s30, s20
    s_add_u32 s30, s30, 78643200
    s_lshl_b32 s55, s15, 13
    s_add_u32 s55, s55, 192937984
    s_mov_b32 s26, s38
    s_mov_b32 s54, s30
    s_mov_b32 s29, 2
    s_mov_b32 s58, 0
    s_mov_b32 s59, 0
    s_bfe_u32 s17, s34, 0x20001
    s_lshl_b32 s60, s14, 2
    s_add_u32 s60, s60, s17
    s_lshl_b32 s60, s60, 2
    s_add_u32 s60, s60, s3
    s_lshl_b32 s60, s60, 10
    s_and_b32 s17, s34, 1
    s_lshl_b32 s17, s17, 17
    s_add_u32 s60, s60, s17
    s_add_u32 s60, s60, 175898624
    s_mov_b32 s31, 786432
    v_and_b32 v20, 63, v0
    v_lshlrev_b32 v1, 4, v20
    v_mov_b32 v10, -1
    v_mov_b32 v11, -1
    v_lshrrev_b32 v21, 2, v20
    v_and_b32 v22, 3, v20
    v_lshlrev_b32 v21, 13, v21
    v_lshl_add_u32 v21, v22, 4, v21
    s_lshl_b32 s17, s3, 21
    s_lshl_b32 s18, s52, 6
    s_add_u32 s17, s17, s18
    s_lshl_b32 s19, s3, 15
    s_mov_b32 s10, 8388608
    s_mov_b32 s11, 131072
    v_lshrrev_b32 v24, 5, v20
    v_bfe_u32 v25, v20, 3, 1
    v_lshl_add_u32 v24, v24, 1, v25
    v_bfe_u32 v26, v20, 4, 1
    v_xor_b32 v26, v26, v25
    v_lshl_add_u32 v24, v24, 1, v26
    v_bfe_u32 v25, v20, 2, 1
    v_lshl_add_u32 v24, v24, 2, v25
    v_lshlrev_b32 v24, 6, v24
    v_lshl_add_u32 v24, v22, 3, v24
    v_add_u32 v24, s19, v24
    s_and_b32 s70, s13, 0
    s_lshl_b32 s72, s70, 20
    s_lshl_b32 s73, s70, 21
    s_lshl_b32 s70, s70, 13
    s_sub_u32 s71, s19, s70
    s_add_u32 s70, s19, s70
    s_load_dwordx2 s[8:9], s[0:1], 16
    s_add_u32 s20, s17, s72
    s_waitcnt lgkmcnt(0)
    s_add_u32 m0, s70, 0
    s_nop 0
    buffer_load_dwordx4 v21, s[8:11], s20 offen lds
    s_add_u32 s20, s20, 131072
    s_add_u32 m0, s70, 1024
    s_nop 0
    buffer_load_dwordx4 v21, s[8:11], s20 offen lds
    s_add_u32 s20, s20, 131072
    s_add_u32 m0, s70, 2048
    s_nop 0
    buffer_load_dwordx4 v21, s[8:11], s20 offen lds
    s_add_u32 s20, s20, 131072
    s_add_u32 m0, s70, 3072
    s_nop 0
    buffer_load_dwordx4 v21, s[8:11], s20 offen lds
    s_add_u32 s20, s20, 131072
    s_add_u32 m0, s70, 4096
    s_nop 0
    buffer_load_dwordx4 v21, s[8:11], s20 offen lds
    s_add_u32 s20, s20, 131072
    s_add_u32 m0, s70, 5120
    s_nop 0
    buffer_load_dwordx4 v21, s[8:11], s20 offen lds
    s_add_u32 s20, s20, 131072
    s_add_u32 m0, s70, 6144
    s_nop 0
    buffer_load_dwordx4 v21, s[8:11], s20 offen lds
    s_add_u32 s20, s20, 131072
    s_add_u32 m0, s70, 7168
    s_nop 0
    buffer_load_dwordx4 v21, s[8:11], s20 offen lds
    s_add_u32 s20, s20, 131072
    s_sub_u32 s20, s20, s73
    s_add_u32 m0, s71, 8192
    s_nop 0
    buffer_load_dwordx4 v21, s[8:11], s20 offen lds
    s_add_u32 s20, s20, 131072
    s_add_u32 m0, s71, 9216
    s_nop 0
    buffer_load_dwordx4 v21, s[8:11], s20 offen lds
    s_add_u32 s20, s20, 131072
    s_add_u32 m0, s71, 10240
    s_nop 0
    buffer_load_dwordx4 v21, s[8:11], s20 offen lds
    s_add_u32 s20, s20, 131072
    s_add_u32 m0, s71, 11264
    s_nop 0
    buffer_load_dwordx4 v21, s[8:11], s20 offen lds
    s_add_u32 s20, s20, 131072
    s_add_u32 m0, s71, 12288
    s_nop 0
    buffer_load_dwordx4 v21, s[8:11], s20 offen lds
    s_add_u32 s20, s20, 131072
    s_add_u32 m0, s71, 13312
    s_nop 0
    buffer_load_dwordx4 v21, s[8:11], s20 offen lds
    s_add_u32 s20, s20, 131072
    s_add_u32 m0, s71, 14336
    s_nop 0
    buffer_load_dwordx4 v21, s[8:11], s20 offen lds
    s_add_u32 s20, s20, 131072
    s_add_u32 m0, s71, 15360
    s_nop 0
    buffer_load_dwordx4 v21, s[8:11], s20 offen lds
    s_add_u32 s20, s20, 131072
    s_load_dwordx2 s[8:9], s[0:1], 24
    s_add_u32 s20, s17, s72
    s_waitcnt lgkmcnt(0)
    s_add_u32 m0, s70, 16384
    s_nop 0
    buffer_load_dwordx4 v21, s[8:11], s20 offen lds
    s_add_u32 s20, s20, 131072
    s_add_u32 m0, s70, 17408
    s_nop 0
    buffer_load_dwordx4 v21, s[8:11], s20 offen lds
    s_add_u32 s20, s20, 131072
    s_add_u32 m0, s70, 18432
    s_nop 0
    buffer_load_dwordx4 v21, s[8:11], s20 offen lds
    s_add_u32 s20, s20, 131072
    s_add_u32 m0, s70, 19456
    s_nop 0
    buffer_load_dwordx4 v21, s[8:11], s20 offen lds
    s_add_u32 s20, s20, 131072
    s_add_u32 m0, s70, 20480
    s_nop 0
    buffer_load_dwordx4 v21, s[8:11], s20 offen lds
    s_add_u32 s20, s20, 131072
    s_add_u32 m0, s70, 21504
    s_nop 0
    buffer_load_dwordx4 v21, s[8:11], s20 offen lds
    s_add_u32 s20, s20, 131072
    s_add_u32 m0, s70, 22528
    s_nop 0
    buffer_load_dwordx4 v21, s[8:11], s20 offen lds
    s_add_u32 s20, s20, 131072
    s_add_u32 m0, s70, 23552
    s_nop 0
    buffer_load_dwordx4 v21, s[8:11], s20 offen lds
    s_add_u32 s20, s20, 131072
    s_sub_u32 s20, s20, s73
    s_add_u32 m0, s71, 24576
    s_nop 0
    buffer_load_dwordx4 v21, s[8:11], s20 offen lds
    s_add_u32 s20, s20, 131072
    s_add_u32 m0, s71, 25600
    s_nop 0
    buffer_load_dwordx4 v21, s[8:11], s20 offen lds
    s_add_u32 s20, s20, 131072
    s_add_u32 m0, s71, 26624
    s_nop 0
    buffer_load_dwordx4 v21, s[8:11], s20 offen lds
    s_add_u32 s20, s20, 131072
    s_add_u32 m0, s71, 27648
    s_nop 0
    buffer_load_dwordx4 v21, s[8:11], s20 offen lds
    s_add_u32 s20, s20, 131072
    s_add_u32 m0, s71, 28672
    s_nop 0
    buffer_load_dwordx4 v21, s[8:11], s20 offen lds
    s_add_u32 s20, s20, 131072
    s_add_u32 m0, s71, 29696
    s_nop 0
    buffer_load_dwordx4 v21, s[8:11], s20 offen lds
    s_add_u32 s20, s20, 131072
    s_add_u32 m0, s71, 30720
    s_nop 0
    buffer_load_dwordx4 v21, s[8:11], s20 offen lds
    s_add_u32 s20, s20, 131072
    s_add_u32 m0, s71, 31744
    s_nop 0
    buffer_load_dwordx4 v21, s[8:11], s20 offen lds
    s_add_u32 s20, s20, 131072
    s_load_dwordx2 s[8:9], s[0:1], 32
    s_add_u32 s20, s17, s72
    s_waitcnt lgkmcnt(0)
    buffer_load_dwordx4 v[96:99], v21, s[8:11], s20 offen
    s_add_u32 s20, s20, 131072
    buffer_load_dwordx4 v[100:103], v21, s[8:11], s20 offen
    s_add_u32 s20, s20, 131072
    buffer_load_dwordx4 v[104:107], v21, s[8:11], s20 offen
    s_add_u32 s20, s20, 131072
    buffer_load_dwordx4 v[108:111], v21, s[8:11], s20 offen
    s_add_u32 s20, s20, 131072
    buffer_load_dwordx4 v[144:147], v21, s[8:11], s20 offen
    s_add_u32 s20, s20, 131072
    buffer_load_dwordx4 v[148:151], v21, s[8:11], s20 offen
    s_add_u32 s20, s20, 131072
    buffer_load_dwordx4 v[152:155], v21, s[8:11], s20 offen
    s_add_u32 s20, s20, 131072
    buffer_load_dwordx4 v[156:159], v21, s[8:11], s20 offen
    s_add_u32 s20, s20, 131072
    s_sub_u32 s20, s20, s73
    buffer_load_dwordx4 v[192:195], v21, s[8:11], s20 offen
    s_add_u32 s20, s20, 131072
    buffer_load_dwordx4 v[196:199], v21, s[8:11], s20 offen
    s_add_u32 s20, s20, 131072
    buffer_load_dwordx4 v[200:203], v21, s[8:11], s20 offen
    s_add_u32 s20, s20, 131072
    buffer_load_dwordx4 v[204:207], v21, s[8:11], s20 offen
    s_add_u32 s20, s20, 131072
    buffer_load_dwordx4 v[240:243], v21, s[8:11], s20 offen
    s_add_u32 s20, s20, 131072
    buffer_load_dwordx4 v[244:247], v21, s[8:11], s20 offen
    s_add_u32 s20, s20, 131072
    buffer_load_dwordx4 v[248:251], v21, s[8:11], s20 offen
    s_add_u32 s20, s20, 131072
    buffer_load_dwordx4 v[252:255], v21, s[8:11], s20 offen
    s_add_u32 s20, s20, 131072
    s_load_dwordx2 s[8:9], s[0:1], 8
    s_mov_b32 s10, 16384
    v_bfe_u32 v57, v20, 2, 2
    v_and_b32 v58, 1, v20
    v_lshl_add_u32 v57, v57, 1, v58
    v_lshlrev_b32 v57, 11, v57
    v_lshrrev_b32 v58, 4, v20
    v_lshl_add_u32 v57, v58, 5, v57
    v_bfe_u32 v58, v20, 1, 1
    v_lshl_add_u32 v57, v58, 4, v57
    v_lshl_add_u32 v59, v58, 3, v57
    v_xor_b32 v60, 8, v59
    s_lshl_b32 s20, s3, 9
    s_waitcnt lgkmcnt(0)
    buffer_load_dwordx2 v[32:33], v59, s[8:11], s20 offen offset:0
    buffer_load_dwordx2 v[34:35], v60, s[8:11], s20 offen offset:0
    buffer_load_dwordx2 v[36:37], v59, s[8:11], s20 offen offset:128
    buffer_load_dwordx2 v[38:39], v60, s[8:11], s20 offen offset:128
    buffer_load_dwordx2 v[40:41], v59, s[8:11], s20 offen offset:256
    buffer_load_dwordx2 v[42:43], v60, s[8:11], s20 offen offset:256
    buffer_load_dwordx2 v[44:45], v59, s[8:11], s20 offen offset:384
    buffer_load_dwordx2 v[46:47], v60, s[8:11], s20 offen offset:384
    s_barrier
    v_add_u32 v56, s70, v1
    v_add_u32 v26, s71, v1
    s_waitcnt vmcnt(40)
    ds_read_b64_tr_b16 v[64:65], v24 offset:0
    ds_read_b64_tr_b16 v[66:67], v24 offset:128
    ds_read_b64_tr_b16 v[68:69], v24 offset:2048
    ds_read_b64_tr_b16 v[70:71], v24 offset:2176
    ds_read_b64_tr_b16 v[72:73], v24 offset:32
    ds_read_b64_tr_b16 v[74:75], v24 offset:160
    ds_read_b64_tr_b16 v[76:77], v24 offset:2080
    ds_read_b64_tr_b16 v[78:79], v24 offset:2208
    s_waitcnt lgkmcnt(0)
    ds_read_b64_tr_b16 v[112:113], v24 offset:4096
    ds_read_b64_tr_b16 v[114:115], v24 offset:4224
    ds_read_b64_tr_b16 v[116:117], v24 offset:6144
    ds_read_b64_tr_b16 v[118:119], v24 offset:6272
    ds_read_b64_tr_b16 v[120:121], v24 offset:4128
    ds_read_b64_tr_b16 v[122:123], v24 offset:4256
    ds_read_b64_tr_b16 v[124:125], v24 offset:6176
    ds_read_b64_tr_b16 v[126:127], v24 offset:6304
    s_waitcnt lgkmcnt(0)
    ds_read_b64_tr_b16 v[160:161], v24 offset:8192
    ds_read_b64_tr_b16 v[162:163], v24 offset:8320
    ds_read_b64_tr_b16 v[164:165], v24 offset:10240
    ds_read_b64_tr_b16 v[166:167], v24 offset:10368
    ds_read_b64_tr_b16 v[168:169], v24 offset:8224
    ds_read_b64_tr_b16 v[170:171], v24 offset:8352
    ds_read_b64_tr_b16 v[172:173], v24 offset:10272
    ds_read_b64_tr_b16 v[174:175], v24 offset:10400
    s_waitcnt lgkmcnt(0)
    ds_read_b64_tr_b16 v[208:209], v24 offset:12288
    ds_read_b64_tr_b16 v[210:211], v24 offset:12416
    ds_read_b64_tr_b16 v[212:213], v24 offset:14336
    ds_read_b64_tr_b16 v[214:215], v24 offset:14464
    ds_read_b64_tr_b16 v[216:217], v24 offset:12320
    ds_read_b64_tr_b16 v[218:219], v24 offset:12448
    ds_read_b64_tr_b16 v[220:221], v24 offset:14368
    ds_read_b64_tr_b16 v[222:223], v24 offset:14496
    s_waitcnt lgkmcnt(0)
    s_waitcnt vmcnt(24)
    ds_read_b64_tr_b16 v[80:81], v24 offset:16384
    ds_read_b64_tr_b16 v[82:83], v24 offset:16512
    ds_read_b64_tr_b16 v[84:85], v24 offset:18432
    ds_read_b64_tr_b16 v[86:87], v24 offset:18560
    ds_read_b64_tr_b16 v[88:89], v24 offset:16416
    ds_read_b64_tr_b16 v[90:91], v24 offset:16544
    ds_read_b64_tr_b16 v[92:93], v24 offset:18464
    ds_read_b64_tr_b16 v[94:95], v24 offset:18592
    s_waitcnt lgkmcnt(0)
    ds_read_b64_tr_b16 v[128:129], v24 offset:20480
    ds_read_b64_tr_b16 v[130:131], v24 offset:20608
    ds_read_b64_tr_b16 v[132:133], v24 offset:22528
    ds_read_b64_tr_b16 v[134:135], v24 offset:22656
    ds_read_b64_tr_b16 v[136:137], v24 offset:20512
    ds_read_b64_tr_b16 v[138:139], v24 offset:20640
    ds_read_b64_tr_b16 v[140:141], v24 offset:22560
    ds_read_b64_tr_b16 v[142:143], v24 offset:22688
    s_waitcnt lgkmcnt(0)
    ds_read_b64_tr_b16 v[176:177], v24 offset:24576
    ds_read_b64_tr_b16 v[178:179], v24 offset:24704
    ds_read_b64_tr_b16 v[180:181], v24 offset:26624
    ds_read_b64_tr_b16 v[182:183], v24 offset:26752
    ds_read_b64_tr_b16 v[184:185], v24 offset:24608
    ds_read_b64_tr_b16 v[186:187], v24 offset:24736
    ds_read_b64_tr_b16 v[188:189], v24 offset:26656
    ds_read_b64_tr_b16 v[190:191], v24 offset:26784
    s_waitcnt lgkmcnt(0)
    ds_read_b64_tr_b16 v[224:225], v24 offset:28672
    ds_read_b64_tr_b16 v[226:227], v24 offset:28800
    ds_read_b64_tr_b16 v[228:229], v24 offset:30720
    ds_read_b64_tr_b16 v[230:231], v24 offset:30848
    ds_read_b64_tr_b16 v[232:233], v24 offset:28704
    ds_read_b64_tr_b16 v[234:235], v24 offset:28832
    ds_read_b64_tr_b16 v[236:237], v24 offset:30752
    ds_read_b64_tr_b16 v[238:239], v24 offset:30880
    s_waitcnt lgkmcnt(0)
    s_waitcnt vmcnt(8)
    ds_write_b128 v56, v[96:99] offset:0
    ds_write_b128 v56, v[100:103] offset:1024
    ds_write_b128 v56, v[104:107] offset:2048
    ds_write_b128 v56, v[108:111] offset:3072
    ds_write_b128 v56, v[144:147] offset:4096
    ds_write_b128 v56, v[148:151] offset:5120
    ds_write_b128 v56, v[152:155] offset:6144
    ds_write_b128 v56, v[156:159] offset:7168
    ds_write_b128 v26, v[192:195] offset:8192
    ds_write_b128 v26, v[196:199] offset:9216
    ds_write_b128 v26, v[200:203] offset:10240
    ds_write_b128 v26, v[204:207] offset:11264
    ds_write_b128 v26, v[240:243] offset:12288
    ds_write_b128 v26, v[244:247] offset:13312
    ds_write_b128 v26, v[248:251] offset:14336
    ds_write_b128 v26, v[252:255] offset:15360
    s_waitcnt lgkmcnt(0)
    ds_read_b64_tr_b16 v[96:97], v24 offset:0
    ds_read_b64_tr_b16 v[98:99], v24 offset:128
    ds_read_b64_tr_b16 v[100:101], v24 offset:2048
    ds_read_b64_tr_b16 v[102:103], v24 offset:2176
    ds_read_b64_tr_b16 v[104:105], v24 offset:32
    ds_read_b64_tr_b16 v[106:107], v24 offset:160
    ds_read_b64_tr_b16 v[108:109], v24 offset:2080
    ds_read_b64_tr_b16 v[110:111], v24 offset:2208
    s_waitcnt lgkmcnt(0)
    ds_read_b64_tr_b16 v[144:145], v24 offset:4096
    ds_read_b64_tr_b16 v[146:147], v24 offset:4224
    ds_read_b64_tr_b16 v[148:149], v24 offset:6144
    ds_read_b64_tr_b16 v[150:151], v24 offset:6272
    ds_read_b64_tr_b16 v[152:153], v24 offset:4128
    ds_read_b64_tr_b16 v[154:155], v24 offset:4256
    ds_read_b64_tr_b16 v[156:157], v24 offset:6176
    ds_read_b64_tr_b16 v[158:159], v24 offset:6304
    s_waitcnt lgkmcnt(0)
    ds_read_b64_tr_b16 v[192:193], v24 offset:8192
    ds_read_b64_tr_b16 v[194:195], v24 offset:8320
    ds_read_b64_tr_b16 v[196:197], v24 offset:10240
    ds_read_b64_tr_b16 v[198:199], v24 offset:10368
    ds_read_b64_tr_b16 v[200:201], v24 offset:8224
    ds_read_b64_tr_b16 v[202:203], v24 offset:8352
    ds_read_b64_tr_b16 v[204:205], v24 offset:10272
    ds_read_b64_tr_b16 v[206:207], v24 offset:10400
    s_waitcnt lgkmcnt(0)
    ds_read_b64_tr_b16 v[240:241], v24 offset:12288
    ds_read_b64_tr_b16 v[242:243], v24 offset:12416
    ds_read_b64_tr_b16 v[244:245], v24 offset:14336
    ds_read_b64_tr_b16 v[246:247], v24 offset:14464
    ds_read_b64_tr_b16 v[248:249], v24 offset:12320
    ds_read_b64_tr_b16 v[250:251], v24 offset:12448
    ds_read_b64_tr_b16 v[252:253], v24 offset:14368
    ds_read_b64_tr_b16 v[254:255], v24 offset:14496
    s_waitcnt lgkmcnt(0)
    v_mov_b32 v21, 0x44444444
    v_mov_b32 v22, 0xeeeeeeee
    v_and_b32 v23, 2, v20
    v_cmp_eq_u32 vcc, 0, v23
    s_nop 1
    v_cndmask_b32 v8, v22, v21, vcc
    v_bfe_u32 v21, v20, 2, 3
    v_lshrrev_b32 v22, 5, v20
    v_mul_u32_u24 v23, 160, v21
    v_mul_u32_u24 v24, 1280, v22
    v_add_u32 v23, v23, v24
    v_and_b32 v24, 3, v20
    v_lshl_add_u32 v27, v24, 4, v23
    v_lshrrev_b32 v23, 1, v21
    v_and_b32 v21, 1, v21
    v_lshl_add_u32 v21, v23, 2, v21
    v_xor_b32 v22, 1, v22
    v_lshl_add_u32 v21, v22, 1, v21
    v_bfe_u32 v22, v20, 1, 1
    v_lshl_add_u32 v21, v22, 4, v21
    v_xor_b32 v22, v20, v22
    v_and_b32 v22, 1, v22
    v_lshlrev_b32 v21, 4, v21
    v_lshl_add_u32 v25, v22, 3, v21
    v_lshrrev_b32 v21, 3, v20
    v_mul_u32_u24 v23, 160, v21
    v_and_b32 v24, 7, v20
    v_lshl_add_u32 v28, v24, 4, v23
    v_lshrrev_b32 v23, 1, v21
    v_and_b32 v21, 1, v21
    v_lshl_add_u32 v21, v23, 2, v21
    v_and_b32 v22, 1, v20
    v_lshl_add_u32 v21, v22, 1, v21
    v_bfe_u32 v22, v20, 2, 1
    v_lshl_add_u32 v21, v22, 4, v21
    v_bfe_u32 v22, v20, 1, 1
    v_lshlrev_b32 v21, 4, v21
    v_lshl_add_u32 v26, v22, 3, v21
    s_lshl_b32 s17, s53, 10
    s_lshl_b32 s18, s3, 9
    s_add_u32 s17, s17, s18
    s_lshl_b32 s18, s3, 6
    s_lshl_b32 s19, s53, 9
    s_add_u32 s19, s19, 4096
    s_cmp_ge_u32 s3, 2
    s_cselect_b32 s17, s19, s17
    s_cselect_b32 s18, 2560, s18
    s_cselect_b64 vcc, -1, 0
    v_cndmask_b32 v22, v25, v26, vcc
    v_cndmask_b32 v23, v27, v28, vcc
    v_add_u32 v2, s17, v22
    v_add_u32 v4, s18, v23
    v_lshrrev_b32 v21, 4, v20
    v_and_b32 v22, 15, v20
    v_mul_u32_u24 v23, 320, v21
    v_lshl_add_u32 v23, v22, 2, v23
    s_mul_i32 s17, s3, 3840
    v_add_u32 v3, s17, v23
    v_add_u32 v61, 1280, v3
    v_bfe_u32 v24, v20, 3, 1
    v_bfe_u32 v25, v20, 2, 1
    v_xor_b32 v25, v25, v24
    v_bfe_u32 v26, v20, 1, 1
    v_lshl_add_u32 v25, v26, 1, v25
    v_lshl_add_u32 v25, v24, 2, v25
    v_and_b32 v26, 1, v20
    v_lshl_add_u32 v25, v25, 1, v26
    v_sub_u32 v25, v25, v22
    v_lshl_add_u32 v25, v25, 2, v3
    v_add_u32 v62, 2560, v25
    v_lshlrev_b32 v23, 4, v22
    v_lshl_add_u32 v6, v21, 12, v23
    s_lshl_b32 s17, s3, 10
    s_add_u32 s17, s17, 32768
    v_add_u32 v6, s17, v6
    v_lshrrev_b32 v24, 1, v21
    v_lshl_add_u32 v23, v24, 15, v23
    v_and_b32 v24, 1, v21
    v_lshl_add_u32 v7, v24, 8, v23
    v_mov_b32 v58, 15872
    v_bfe_u32 v23, v20, 1, 2
    v_lshlrev_b32 v23, 6, v23
    v_and_b32 v25, 1, v20
    v_lshl_add_u32 v23, v25, 4, v23
    v_lshrrev_b32 v24, 5, v20
    v_lshl_add_u32 v5, v24, 5, v23
    v_and_b32 v23, 7, v20
    v_lshlrev_b32 v23, 7, v23
    v_bfe_u32 v24, v20, 3, 1
    v_lshl_add_u32 v23, v24, 17, v23
    v_lshrrev_b32 v24, 4, v20
    v_add_u32 v24, 1, v24
    v_cmp_le_u32 vcc, 3, v24
    s_nop 1
    v_cndmask_b32 v24, v24, 0, vcc
    v_lshl_add_u32 v23, v24, 24, v23
    s_lshl_b32 s17, s14, 14
    s_lshl_b32 s18, s34, 10
    s_add_u32 s17, s17, s18
    s_add_u32 s17, s17, 4194304
    v_add_u32 v0, s17, v23
    s_lshl_b32 s17, s3, 2
    s_add_u32 s17, s17, 15872
    v_mov_b32 v63, s17
    v_and_b32 v21, 15, v20
    v_and_b32 v22, 1, v21
    v_lshlrev_b32 v22, 4, v22
    v_mov_b32 v12, 0x3f80
    v_lshlrev_b32 v22, v22, v12
    v_lshrrev_b32 v21, 1, v21
    v_cmp_eq_u32 vcc, 0, v21
    s_nop 1
    v_cndmask_b32 v12, 0, v22, vcc
    v_cmp_eq_u32 vcc, 1, v21
    s_nop 1
    v_cndmask_b32 v13, 0, v22, vcc
    v_cmp_eq_u32 vcc, 2, v21
    s_nop 1
    v_cndmask_b32 v14, 0, v22, vcc
    v_cmp_eq_u32 vcc, 3, v21
    s_nop 1
    v_cndmask_b32 v15, 0, v22, vcc
    s_waitcnt vmcnt(0)
    v_mov_b32 v16, v32
    v_mov_b32 v17, v33
    v_mov_b32 v18, v34
    v_mov_b32 v19, v35
    v_mov_b32 v20, v36
    v_mov_b32 v21, v37
    v_mov_b32 v22, v38
    v_mov_b32 v23, v39
    v_mov_b32 v24, v40
    v_mov_b32 v25, v41
    v_mov_b32 v26, v42
    v_mov_b32 v27, v43
    v_mov_b32 v28, v44
    v_mov_b32 v29, v45
    v_mov_b32 v30, v46
    v_mov_b32 v31, v47
    v_mov_b32 v52, -1
    v_mov_b32 v53, -1
    v_mov_b32 v54, -1
    v_mov_b32 v55, -1
    s_add_u32 s17, s30, 851968
    buffer_store_dwordx4 v[52:55], v7, s[4:7], s17 offen sc1
    s_add_u32 s17, s30, 917504
    buffer_store_dwordx4 v[52:55], v7, s[4:7], s17 offen sc1
    s_add_u32 s17, s30, 983040
    buffer_store_dwordx4 v[52:55], v7, s[4:7], s17 offen sc1
    s_lshl_b32 s40, s40, 5
    s_barrier
    ds_write_b32 v63, v10
    ds_write_b32 v63, v10 offset:16
    ds_write_b32 v63, v10 offset:32
    ds_write_b32 v63, v10 offset:48
    v_mov_b32 v60, 12
    v_mov_b32 v56, 15968
    s_waitcnt lgkmcnt(0)
    s_barrier
    ds_read_b64 v[32:33], v56
    s_waitcnt lgkmcnt(0)
    v_cmp_ne_u32 vcc, s40, v32
    s_setprio 3
    v_readfirstlane_b32 s17, v33
    s_add_u32 s39, s39, s17
    s_cbranch_vccnz ch_p_slow
    v_mov_b32 v32, 0
    v_mov_b32 v33, 0
    v_mov_b32 v34, 0
    v_mov_b32 v35, 0
    v_mov_b32 v36, 0
    v_mov_b32 v37, 0
    v_mov_b32 v38, 0
    v_mov_b32 v39, 0
    v_mov_b32 v40, 0
    v_mov_b32 v41, 0
    v_mov_b32 v42, 0
    v_mov_b32 v43, 0
    v_mov_b32 v44, 0
    v_mov_b32 v45, 0
    v_mov_b32 v46, 0
    v_mov_b32 v47, 0
    v_mov_b32 v48, 0
    v_mov_b32 v49, 0
    v_mov_b32 v50, 0
    v_mov_b32 v51, 0
    v_mov_b32 v52, 0
    v_mov_b32 v53, 0
    v_mov_b32 v54, 0
    v_mov_b32 v55, 0
    v_mov_b32 v59, 0
    s_nop 1
    s_branch ploopL_19_nc
.p2align 6
    s_nop 0
    s_nop 0
    s_nop 0
    s_nop 0
    s_nop 0
    s_nop 0
    s_nop 0
    s_nop 0
    s_nop 0
    s_nop 0
    s_nop 0
ploopL_19:
    v_mov_b32 v32, 0
    v_mov_b32 v33, 0
    v_mov_b32 v34, 0
    v_mov_b32 v35, 0
    v_mov_b32 v36, 0
    v_mov_b32 v37, 0
    v_mov_b32 v38, 0
    v_mov_b32 v39, 0
    v_mov_b32 v40, 0
    v_mov_b32 v41, 0
    v_mov_b32 v42, 0
    v_mov_b32 v43, 0
    v_mov_b32 v44, 0
    v_mov_b32 v45, 0
    v_mov_b32 v46, 0
    v_mov_b32 v47, 0
    v_mov_b32 v48, 0
    v_mov_b32 v49, 0
    v_mov_b32 v50, 0
    v_mov_b32 v51, 0
    v_mov_b32 v52, 0
    v_mov_b32 v53, 0
    v_mov_b32 v54, 0
    v_mov_b32 v55, 0
    s_bitcmp1_b32 s29, 0
    s_cbranch_scc1 gate_20_ok
    s_add_u32 s21, s16, 1
    s_min_u32 s21, s21, 63
    s_cmp_ge_u32 s21, 16
    s_cselect_b32 s19, 12, 8
    s_and_b32 s32, s21, 4
    s_lshr_b32 s21, s21, 3
    s_lshl_b32 s21, s21, 8
    s_add_u32 s32, s32, s21
    s_add_u32 s32, s32, s35
gate_20:
    buffer_load_dword v9, off, s[4:7], s32 sc1
    s_waitcnt vmcnt(0)
    v_readfirstlane_b32 s21, v9
    s_cmp_ge_u32 s21, s19
    s_cbranch_scc1 gate_20_set
    s_sleep 8
    s_sub_u32 s22, s22, 1
    s_cbranch_scc0 gate_20
    s_mov_b32 s22, 0
gate_20_set:
    s_bitset1_b32 s29, 0
gate_20_ok:
    s_sleep 1
    buffer_load_dwordx4 v[16:19], v1, s[4:7], s23 offen offset:0 sc1
    buffer_load_dwordx4 v[20:23], v1, s[4:7], s23 offen offset:1024 sc1
    buffer_load_dwordx4 v[24:27], v1, s[4:7], s23 offen offset:2048 sc1
    buffer_load_dwordx4 v[28:31], v1, s[4:7], s23 offen offset:3072 sc1
    s_waitcnt vmcnt(3)
    v_cmp_eq_u32 vcc, -1, v16
    s_cbranch_vccnz ploopL_19_rm_0
ploopL_19_rm_0ok:
    v_smfmac_f32_16x16x64_bf16 v[32:35], v[16:19], v[64:71], v8
    v_smfmac_f32_16x16x64_bf16 v[36:39], v[16:19], v[72:79], v8
    s_waitcnt vmcnt(2)
    v_cmp_eq_u32 vcc, -1, v20
    v_smfmac_f32_16x16x64_bf16 v[40:43], v[16:19], v[80:87], v8
    v_smfmac_f32_16x16x64_bf16 v[44:47], v[16:19], v[88:95], v8
    v_smfmac_f32_16x16x64_bf16 v[48:51], v[16:19], v[96:103], v8
    v_smfmac_f32_16x16x64_bf16 v[52:55], v[16:19], v[104:111], v8
    s_cbranch_vccnz ploopL_19_rm_1
ploopL_19_rm_1ok:
    v_smfmac_f32_16x16x64_bf16 v[32:35], v[20:23], v[112:119], v8
    v_smfmac_f32_16x16x64_bf16 v[36:39], v[20:23], v[120:127], v8
    s_waitcnt vmcnt(1)
    v_cmp_eq_u32 vcc, -1, v24
    v_smfmac_f32_16x16x64_bf16 v[40:43], v[20:23], v[128:135], v8
    v_smfmac_f32_16x16x64_bf16 v[44:47], v[20:23], v[136:143], v8
    v_smfmac_f32_16x16x64_bf16 v[48:51], v[20:23], v[144:151], v8
    v_smfmac_f32_16x16x64_bf16 v[52:55], v[20:23], v[152:159], v8
    s_cbranch_vccnz ploopL_19_rm_2
ploopL_19_rm_2ok:
    v_smfmac_f32_16x16x64_bf16 v[32:35], v[24:27], v[160:167], v8
    v_smfmac_f32_16x16x64_bf16 v[36:39], v[24:27], v[168:175], v8
    s_waitcnt vmcnt(0)
    v_cmp_eq_u32 vcc, -1, v28
    v_smfmac_f32_16x16x64_bf16 v[40:43], v[24:27], v[176:183], v8
    v_smfmac_f32_16x16x64_bf16 v[44:47], v[24:27], v[184:191], v8
    v_smfmac_f32_16x16x64_bf16 v[48:51], v[24:27], v[192:199], v8
    v_smfmac_f32_16x16x64_bf16 v[52:55], v[24:27], v[200:207], v8
    s_cbranch_vccnz ploopL_19_rm_3
ploopL_19_rm_3ok:
    v_smfmac_f32_16x16x64_bf16 v[32:35], v[28:31], v[208:215], v8
    ds_write_b32 v63, v59 offset:32
    v_smfmac_f32_16x16x64_bf16 v[36:39], v[28:31], v[216:223], v8
    v_smfmac_f32_16x16x64_bf16 v[40:43], v[28:31], v[224:231], v8
    v_smfmac_f32_16x16x64_bf16 v[44:47], v[28:31], v[232:239], v8
    v_smfmac_f32_16x16x64_bf16 v[48:51], v[28:31], v[240:247], v8
    v_smfmac_f32_16x16x64_bf16 v[52:55], v[28:31], v[248:255], v8
    s_branch ploopL_19_mmd
ploopL_19_nc:
    v_smfmac_f32_16x16x64_bf16 v[32:35], v[16:19], v[64:71], v8
    v_smfmac_f32_16x16x64_bf16 v[36:39], v[16:19], v[72:79], v8
    v_smfmac_f32_16x16x64_bf16 v[40:43], v[16:19], v[80:87], v8
    v_smfmac_f32_16x16x64_bf16 v[44:47], v[16:19], v[88:95], v8
    v_smfmac_f32_16x16x64_bf16 v[48:51], v[16:19], v[96:103], v8
    v_smfmac_f32_16x16x64_bf16 v[52:55], v[16:19], v[104:111], v8
    v_smfmac_f32_16x16x64_bf16 v[32:35], v[20:23], v[112:119], v8
    v_smfmac_f32_16x16x64_bf16 v[36:39], v[20:23], v[120:127], v8
    v_smfmac_f32_16x16x64_bf16 v[40:43], v[20:23], v[128:135], v8
    v_smfmac_f32_16x16x64_bf16 v[44:47], v[20:23], v[136:143], v8
    v_smfmac_f32_16x16x64_bf16 v[48:51], v[20:23], v[144:151], v8
    v_smfmac_f32_16x16x64_bf16 v[52:55], v[20:23], v[152:159], v8
    v_smfmac_f32_16x16x64_bf16 v[32:35], v[24:27], v[160:167], v8
    v_smfmac_f32_16x16x64_bf16 v[36:39], v[24:27], v[168:175], v8
    v_smfmac_f32_16x16x64_bf16 v[40:43], v[24:27], v[176:183], v8
    v_smfmac_f32_16x16x64_bf16 v[44:47], v[24:27], v[184:191], v8
    v_smfmac_f32_16x16x64_bf16 v[48:51], v[24:27], v[192:199], v8
    v_smfmac_f32_16x16x64_bf16 v[52:55], v[24:27], v[200:207], v8
    v_smfmac_f32_16x16x64_bf16 v[32:35], v[28:31], v[208:215], v8
    ds_write_b32 v63, v59 offset:32
    v_smfmac_f32_16x16x64_bf16 v[36:39], v[28:31], v[216:223], v8
    v_smfmac_f32_16x16x64_bf16 v[40:43], v[28:31], v[224:231], v8
    v_smfmac_f32_16x16x64_bf16 v[44:47], v[28:31], v[232:239], v8
    v_smfmac_f32_16x16x64_bf16 v[48:51], v[28:31], v[240:247], v8
    v_smfmac_f32_16x16x64_bf16 v[52:55], v[28:31], v[248:255], v8
ploopL_19_mmd:
    s_cmp_eq_u32 s3, 3
    s_nop 1
    v_add_f32 v32, v32, v34
    v_add_f32 v33, v33, v35
    ds_write2_b32 v3, v32, v33 offset0:0 offset1:40
    v_add_f32 v36, v36, v38
    v_add_f32 v37, v37, v39
    ds_write2_b32 v3, v36, v37 offset0:16 offset1:56
    v_add_f32 v40, v40, v42
    v_add_f32 v41, v41, v43
    ds_write2_b32 v61, v40, v41 offset0:0 offset1:40
    v_add_f32 v44, v44, v46
    v_add_f32 v45, v45, v47
    ds_write2_b32 v61, v44, v45 offset0:16 offset1:56
    v_add_f32 v48, v48, v50
    v_add_f32 v49, v49, v51
    ds_write2_b32 v62, v48, v49 offset0:0 offset1:40
    v_add_f32 v52, v52, v54
    v_add_f32 v53, v53, v55
    ds_write2_b32 v62, v52, v53 offset0:16 offset1:56
    s_waitcnt lgkmcnt(0)
    s_barrier
    s_cbranch_scc1 ploopL_19_sk1
    ds_read_b128 v[32:35], v4 offset:0
    ds_read_b128 v[36:39], v4 offset:3840
    ds_read_b128 v[40:43], v4 offset:7680
    ds_read_b128 v[44:47], v4 offset:11520
    s_waitcnt lgkmcnt(2)
    v_add_f32 v32, v32, v36
    v_add_f32 v33, v33, v37
    v_add_f32 v34, v34, v38
    v_add_f32 v35, v35, v39
    s_waitcnt lgkmcnt(0)
    v_add_f32 v40, v40, v44
    v_add_f32 v41, v41, v45
    v_add_f32 v42, v42, v46
    v_add_f32 v43, v43, v47
    v_add_f32 v32, v32, v40
    v_add_f32 v33, v33, v41
    v_add_f32 v34, v34, v42
    v_add_f32 v35, v35, v43
    v_cvt_pk_bf16_f32 v56, v32, v33
    v_cvt_pk_bf16_f32 v57, v34, v35
    v_min_u32 v56, -2, v56
    buffer_store_dwordx2 v[56:57], v2, s[4:7], s26 offen
    s_add_u32 s27, s16, 2
    s_and_b32 s27, s27, 3
    s_lshl_b32 s27, s27, 18
    s_add_u32 s27, s27, s38
    buffer_store_dwordx2 v[10:11], v2, s[4:7], s27 offen
ploopL_19_sk1:
    s_setprio 0
    s_add_u32 s25, s16, 3
    s_and_b32 s25, s25, 3
    s_lshl_b32 s25, s25, 16
    s_add_u32 s25, s25, s37
    v_mov_b32 v44, -1
    v_mov_b32 v45, -1
    v_mov_b32 v46, -1
    v_mov_b32 v47, -1
    s_mov_b64 exec, s[56:57]
    buffer_store_dwordx4 v[44:47], v5, s[4:7], s25 offen
    s_mov_b64 exec, -1
    v_mov_b32_dpp v48, v12 row_ror:8 row_mask:0xf bank_mask:0xf
    v_mov_b32_dpp v49, v13 row_ror:8 row_mask:0xf bank_mask:0xf
    v_mov_b32_dpp v50, v14 row_ror:8 row_mask:0xf bank_mask:0xf
    v_mov_b32_dpp v51, v15 row_ror:8 row_mask:0xf bank_mask:0xf
    s_and_b32 s28, s16, 3
    s_lshl_b32 s28, s28, 18
    s_add_u32 s28, s28, s39
    s_add_u32 s24, s16, 1
    s_and_b32 s24, s24, 3
    s_lshl_b32 s24, s24, 16
    s_add_u32 s24, s24, s37
    s_add_u32 s23, s16, 1
    s_and_b32 s23, s23, 3
    s_lshl_b32 s23, s23, 16
    s_add_u32 s23, s23, s36
    s_add_u32 s26, s16, 1
    s_and_b32 s26, s26, 3
    s_lshl_b32 s26, s26, 18
    s_add_u32 s26, s26, s38
    s_cmp_eq_u32 s59, 0
    s_cbranch_scc1 ofl_21
    s_lshl_b32 s17, s3, 10
    v_add_u32 v39, s17, v1
    ds_read_b128 v[40:43], v39 offset:32768
ofl_21:
    s_cmp_ge_u32 s16, 16
    s_cbranch_scc1 ploopL_19_nx
    v_mov_b32 v40, v2
    v_mov_b32 v42, v56
    v_mov_b32 v43, v57
    s_cmp_lg_u32 s3, 2
    s_cbranch_scc1 ploopL_19_nx
    v_and_b32 v40, 0x60, v1
    v_lshlrev_b32 v40, 2, v40
    v_lshrrev_b32 v41, 3, v1
    v_and_b32 v41, 0x70, v41
    v_or_b32 v40, v40, v41
    v_bfe_u32 v41, v1, 4, 1
    v_lshl_or_b32 v40, v41, 3, v40
    s_lshl_b32 s17, s53, 9
    s_add_u32 s17, s17, 4096
    v_add_u32 v40, s17, v40
    s_mov_b32 vcc_lo, 0x55555555
    s_mov_b32 vcc_hi, 0x55555555
    v_cndmask_b32_dpp v42, v57, v56, vcc quad_perm:[1,0,3,2] row_mask:0xf bank_mask:0xf
    s_not_b64 vcc, vcc
    v_cndmask_b32_dpp v43, v56, v57, vcc quad_perm:[1,0,3,2] row_mask:0xf bank_mask:0xf
ploopL_19_nx:
    v_readfirstlane_b32 s21, v60
    s_lshr_b32 s29, s29, 1
    s_cmp_ge_u32 s21, s58
    s_cselect_b32 s21, 2, 0
    s_or_b32 s29, s29, s21
    s_cmp_eq_u32 s3, 3
    s_cselect_b32 s20, s21, 0
    s_add_u32 s21, s16, 4
    s_min_u32 s21, s21, 63
    s_cmp_ge_u32 s21, 16
    s_cselect_b32 s58, 12, 8
    s_and_b32 s33, s21, 4
    s_lshr_b32 s21, s21, 3
    s_lshl_b32 s21, s21, 8
    s_add_u32 s33, s33, s21
    s_add_u32 s33, s33, s35
    s_setprio 3
ploopL_19_fs:
    ds_read_b128 v[32:35], v58 offset:0
    s_waitcnt lgkmcnt(0)
    v_min3_i32 v32, v32, v33, v34
    v_min_i32 v32, v32, v35
    s_nop 0
    v_readfirstlane_b32 s18, v32
    s_cmp_ge_i32 s18, s16
    s_cbranch_scc1 ploopL_19_fsok
    s_sleep 1
    s_branch ploopL_19_fs
ploopL_19_fsok:
    s_setprio 1
    s_sleep 4
ploopL_19_nofd:
    s_cmp_eq_u32 s20, 0
    s_cbranch_scc1 ploopL_19_nt
    s_cmp_ge_u32 s16, 13
    s_cselect_b32 exec_hi, 0xffff, 0
    buffer_load_dword v60, v0, s[4:7], s31 offen sc1
    s_mov_b32 exec_hi, -1
ploopL_19_nt:
    s_cmp_eq_u32 s59, 0
    s_cbranch_scc1 ofl_22
    s_lshl_b32 s17, s16, 18
    s_add_u32 s17, s17, s60
    buffer_store_dwordx4 v[40:43], v1, s[4:7], s17 offen sc1
    s_mov_b32 s59, 0
ofl_22:
    s_lshr_b32 s17, s34, 3
    s_xor_b32 s17, s17, s16
    s_andn2_b32 s59, 1, s17
    s_cmp_ge_u32 s16, 16
    s_cselect_b32 s59, s59, 0
    s_cbranch_scc1 ploopL_19_nx2
    s_cmp_eq_u32 s3, 3
    s_cbranch_scc1 ploopL_19_nx2
    buffer_store_dwordx2 v[42:43], v40, s[4:7], s55 offen sc1
ploopL_19_nx2:
    s_add_u32 s55, s55, 262144
    s_or_b32 s17, s13, s3
    s_cmp_lg_u32 s17, 0
    s_cbranch_scc1 ploopL_19_npg
    s_sub_u32 s21, s16, 1
    s_cbranch_scc1 ploopL_19_npg
    s_and_b32 s17, s21, 3
    s_cmp_ge_u32 s16, 58
    s_cselect_b32 s17, 0, s17
    s_cmp_lg_u32 s17, 0
    s_cbranch_scc1 ploopL_19_npg
    s_lshl_b32 s17, s12, 7
    s_add_u32 s17, s17, 218112000
    v_mov_b32 v9, s21
    s_mov_b64 exec, 1
    buffer_store_dword v9, off, s[4:7], s17 sc1
    s_mov_b64 exec, -1
ploopL_19_npg:
    s_barrier
    buffer_load_dword v60, off, s[4:7], s33 sc1
    s_add_u32 s16, s16, 1
    v_mov_b32 v59, s16
    s_add_u32 s41, s41, 262144
    s_add_u32 s31, s31, 262144
    s_setprio 3
    s_sleep 13
ploopL_19_pagain:
    buffer_load_dwordx4 v[16:19], v1, s[4:7], s28 offen offset:0 sc1
    buffer_load_dwordx4 v[20:23], v1, s[4:7], s28 offen offset:1024 sc1
    s_waitcnt vmcnt(1)
    v_mfma_f32_16x16x32_bf16 v[32:35], v[12:15], v[16:19], 0
    s_waitcnt vmcnt(0)
    v_mfma_f32_16x16x32_bf16 v[32:35], v[48:51], v[20:23], v[32:35]
    v_max_u32 v9, v16, v20
    v_cmp_eq_u32 vcc, -1, v9
    s_cbranch_vccnz ploopL_19_rp
ploopL_19_pgo:
    s_cmp_lt_u32 s16, 48
    s_nop 3
    v_add_f32_dpp v36, v32, v32 row_ror:8 row_mask:0xf bank_mask:0xf
    v_add_f32_dpp v37, v33, v33 row_ror:8 row_mask:0xf bank_mask:0xf
    v_add_f32_dpp v38, v34, v34 row_ror:8 row_mask:0xf bank_mask:0xf
    v_add_f32_dpp v39, v35, v35 row_ror:8 row_mask:0xf bank_mask:0xf
    v_cvt_pk_bf16_f32 v52, v36, v37
    v_cvt_pk_bf16_f32 v53, v38, v39
    s_nop 0
    v_permlane16_swap_b32 v52, v54
    v_permlane16_swap_b32 v53, v55
    s_mov_b64 exec, s[56:57]
    v_min_u32 v52, -2, v52
    buffer_store_dwordx4 v[52:55], v5, s[4:7], s24 offen
    s_mov_b64 exec, -1
    ds_write_b32 v63, v59 offset:16
    s_cbranch_scc1 ploopL_19
    s_branch ploopH_18
ploopL_19_rm_0:
    s_sub_u32 s22, s22, 1
    s_cbranch_scc1 ploopL_19_rm_0_g
    buffer_load_dwordx4 v[16:19], v1, s[4:7], s23 offen offset:0 sc1
    buffer_load_dwordx4 v[20:23], v1, s[4:7], s23 offen offset:1024 sc1
    buffer_load_dwordx4 v[24:27], v1, s[4:7], s23 offen offset:2048 sc1
    buffer_load_dwordx4 v[28:31], v1, s[4:7], s23 offen offset:3072 sc1
    s_waitcnt vmcnt(3)
    v_cmp_eq_u32 vcc, -1, v16
    s_cbranch_vccnz ploopL_19_rm_0
    s_branch ploopL_19_rm_0ok
ploopL_19_rm_0_g:
    s_mov_b32 s22, 0
    s_waitcnt vmcnt(0)
    s_branch ploopL_19_rm_0ok
ploopL_19_rm_1:
    s_sub_u32 s22, s22, 1
    s_cbranch_scc1 ploopL_19_rm_1_g
    buffer_load_dwordx4 v[20:23], v1, s[4:7], s23 offen offset:1024 sc1
    buffer_load_dwordx4 v[24:27], v1, s[4:7], s23 offen offset:2048 sc1
    buffer_load_dwordx4 v[28:31], v1, s[4:7], s23 offen offset:3072 sc1
    s_waitcnt vmcnt(2)
    v_cmp_eq_u32 vcc, -1, v20
    s_cbranch_vccnz ploopL_19_rm_1
    s_branch ploopL_19_rm_1ok
ploopL_19_rm_1_g:
    s_mov_b32 s22, 0
    s_waitcnt vmcnt(0)
    s_branch ploopL_19_rm_1ok
ploopL_19_rm_2:
    s_sub_u32 s22, s22, 1
    s_cbranch_scc1 ploopL_19_rm_2_g
    buffer_load_dwordx4 v[24:27], v1, s[4:7], s23 offen offset:2048 sc1
    buffer_load_dwordx4 v[28:31], v1, s[4:7], s23 offen offset:3072 sc1
    s_waitcnt vmcnt(1)
    v_cmp_eq_u32 vcc, -1, v24
    s_cbranch_vccnz ploopL_19_rm_2
    s_branch ploopL_19_rm_2ok
ploopL_19_rm_2_g:
    s_mov_b32 s22, 0
    s_waitcnt vmcnt(0)
    s_branch ploopL_19_rm_2ok
ploopL_19_rm_3:
    s_sub_u32 s22, s22, 1
    s_cbranch_scc1 ploopL_19_rm_3_g
    buffer_load_dwordx4 v[28:31], v1, s[4:7], s23 offen offset:3072 sc1
    s_waitcnt vmcnt(0)
    v_cmp_eq_u32 vcc, -1, v28
    s_cbranch_vccnz ploopL_19_rm_3
    s_branch ploopL_19_rm_3ok
ploopL_19_rm_3_g:
    s_mov_b32 s22, 0
    s_waitcnt vmcnt(0)
    s_branch ploopL_19_rm_3ok
ploopL_19_rp:
    s_sub_u32 s22, s22, 1
    s_cbranch_scc0 ploopL_19_pagain
    s_mov_b32 s22, 0
    s_branch ploopL_19_pgo
.p2align 6
    s_nop 0
    s_nop 0
    s_nop 0
    s_nop 0
    s_nop 0
    s_nop 0
    s_nop 0
    s_nop 0
    s_nop 0
    s_nop 0
    s_nop 0
ploopH_18:
    v_mov_b32 v32, 0
    v_mov_b32 v33, 0
    v_mov_b32 v34, 0
    v_mov_b32 v35, 0
    v_mov_b32 v36, 0
    v_mov_b32 v37, 0
    v_mov_b32 v38, 0
    v_mov_b32 v39, 0
    v_mov_b32 v40, 0
    v_mov_b32 v41, 0
    v_mov_b32 v42, 0
    v_mov_b32 v43, 0
    v_mov_b32 v44, 0
    v_mov_b32 v45, 0
    v_mov_b32 v46, 0
    v_mov_b32 v47, 0
    v_mov_b32 v48, 0
    v_mov_b32 v49, 0
    v_mov_b32 v50, 0
    v_mov_b32 v51, 0
    v_mov_b32 v52, 0
    v_mov_b32 v53, 0
    v_mov_b32 v54, 0
    v_mov_b32 v55, 0
    s_sleep 1
    buffer_load_dwordx4 v[16:19], v1, s[4:7], s23 offen offset:0 sc1
    buffer_load_dwordx4 v[20:23], v1, s[4:7], s23 offen offset:1024 sc1
    buffer_load_dwordx4 v[24:27], v1, s[4:7], s23 offen offset:2048 sc1
    buffer_load_dwordx4 v[28:31], v1, s[4:7], s23 offen offset:3072 sc1
    s_waitcnt vmcnt(3)
    v_cmp_eq_u32 vcc, -1, v16
    s_cbranch_vccnz ploopH_18_rm_0
ploopH_18_rm_0ok:
    v_smfmac_f32_16x16x64_bf16 v[32:35], v[16:19], v[64:71], v8
    v_smfmac_f32_16x16x64_bf16 v[36:39], v[16:19], v[72:79], v8
    s_waitcnt vmcnt(2)
    v_cmp_eq_u32 vcc, -1, v20
    v_smfmac_f32_16x16x64_bf16 v[40:43], v[16:19], v[80:87], v8
    v_smfmac_f32_16x16x64_bf16 v[44:47], v[16:19], v[88:95], v8
    v_smfmac_f32_16x16x64_bf16 v[48:51], v[16:19], v[96:103], v8
    v_smfmac_f32_16x16x64_bf16 v[52:55], v[16:19], v[104:111], v8
    s_cbranch_vccnz ploopH_18_rm_1
ploopH_18_rm_1ok:
    v_smfmac_f32_16x16x64_bf16 v[32:35], v[20:23], v[112:119], v8
    v_smfmac_f32_16x16x64_bf16 v[36:39], v[20:23], v[120:127], v8
    s_waitcnt vmcnt(1)
    v_cmp_eq_u32 vcc, -1, v24
    v_smfmac_f32_16x16x64_bf16 v[40:43], v[20:23], v[128:135], v8
    v_smfmac_f32_16x16x64_bf16 v[44:47], v[20:23], v[136:143], v8
    v_smfmac_f32_16x16x64_bf16 v[48:51], v[20:23], v[144:151], v8
    v_smfmac_f32_16x16x64_bf16 v[52:55], v[20:23], v[152:159], v8
    s_cbranch_vccnz ploopH_18_rm_2
ploopH_18_rm_2ok:
    v_smfmac_f32_16x16x64_bf16 v[32:35], v[24:27], v[160:167], v8
    v_smfmac_f32_16x16x64_bf16 v[36:39], v[24:27], v[168:175], v8
    s_waitcnt vmcnt(0)
    v_cmp_eq_u32 vcc, -1, v28
    v_smfmac_f32_16x16x64_bf16 v[40:43], v[24:27], v[176:183], v8
    v_smfmac_f32_16x16x64_bf16 v[44:47], v[24:27], v[184:191], v8
    v_smfmac_f32_16x16x64_bf16 v[48:51], v[24:27], v[192:199], v8
    v_smfmac_f32_16x16x64_bf16 v[52:55], v[24:27], v[200:207], v8
    s_cbranch_vccnz ploopH_18_rm_3
ploopH_18_rm_3ok:
    v_smfmac_f32_16x16x64_bf16 v[32:35], v[28:31], v[208:215], v8
    ds_write_b32 v63, v59 offset:32
    v_smfmac_f32_16x16x64_bf16 v[36:39], v[28:31], v[216:223], v8
    v_smfmac_f32_16x16x64_bf16 v[40:43], v[28:31], v[224:231], v8
    v_smfmac_f32_16x16x64_bf16 v[44:47], v[28:31], v[232:239], v8
    v_smfmac_f32_16x16x64_bf16 v[48:51], v[28:31], v[240:247], v8
    v_smfmac_f32_16x16x64_bf16 v[52:55], v[28:31], v[248:255], v8
    s_cmp_eq_u32 s3, 3
    s_nop 1
    v_add_f32 v32, v32, v34
    v_add_f32 v33, v33, v35
    ds_write2_b32 v3, v32, v33 offset0:0 offset1:40
    v_add_f32 v36, v36, v38
    v_add_f32 v37, v37, v39
    ds_write2_b32 v3, v36, v37 offset0:16 offset1:56
    v_add_f32 v40, v40, v42
    v_add_f32 v41, v41, v43
    ds_write2_b32 v61, v40, v41 offset0:0 offset1:40
    v_add_f32 v44, v44, v46
    v_add_f32 v45, v45, v47
    ds_write2_b32 v61, v44, v45 offset0:16 offset1:56
    v_add_f32 v48, v48, v50
    v_add_f32 v49, v49, v51
    ds_write2_b32 v62, v48, v49 offset0:0 offset1:40
    v_add_f32 v52, v52, v54
    v_add_f32 v53, v53, v55
    ds_write2_b32 v62, v52, v53 offset0:16 offset1:56
    s_waitcnt lgkmcnt(0)
    s_barrier
    s_cbranch_scc1 ploopH_18_sk1
    ds_read_b128 v[32:35], v4 offset:0
    ds_read_b128 v[36:39], v4 offset:3840
    ds_read_b128 v[40:43], v4 offset:7680
    ds_read_b128 v[44:47], v4 offset:11520
    s_waitcnt lgkmcnt(2)
    v_add_f32 v32, v32, v36
    v_add_f32 v33, v33, v37
    v_add_f32 v34, v34, v38
    v_add_f32 v35, v35, v39
    s_waitcnt lgkmcnt(0)
    v_add_f32 v40, v40, v44
    v_add_f32 v41, v41, v45
    v_add_f32 v42, v42, v46
    v_add_f32 v43, v43, v47
    v_add_f32 v32, v32, v40
    v_add_f32 v33, v33, v41
    v_add_f32 v34, v34, v42
    v_add_f32 v35, v35, v43
    v_cvt_pk_bf16_f32 v56, v32, v33
    v_cvt_pk_bf16_f32 v57, v34, v35
    v_min_u32 v56, -2, v56
    buffer_store_dwordx2 v[56:57], v2, s[4:7], s26 offen
    s_add_u32 s27, s16, 2
    s_and_b32 s27, s27, 3
    s_lshl_b32 s27, s27, 18
    s_add_u32 s27, s27, s38
    buffer_store_dwordx2 v[10:11], v2, s[4:7], s27 offen
ploopH_18_sk1:
    s_setprio 0
    s_add_u32 s25, s16, 3
    s_and_b32 s25, s25, 3
    s_lshl_b32 s25, s25, 16
    s_add_u32 s25, s25, s37
    v_mov_b32 v44, -1
    v_mov_b32 v45, -1
    v_mov_b32 v46, -1
    v_mov_b32 v47, -1
    s_mov_b64 exec, s[56:57]
    buffer_store_dwordx4 v[44:47], v5, s[4:7], s25 offen
    s_mov_b64 exec, -1
    v_mov_b32_dpp v48, v12 row_ror:8 row_mask:0xf bank_mask:0xf
    v_mov_b32_dpp v49, v13 row_ror:8 row_mask:0xf bank_mask:0xf
    v_mov_b32_dpp v50, v14 row_ror:8 row_mask:0xf bank_mask:0xf
    v_mov_b32_dpp v51, v15 row_ror:8 row_mask:0xf bank_mask:0xf
    s_and_b32 s28, s16, 3
    s_lshl_b32 s28, s28, 18
    s_add_u32 s28, s28, s39
    s_add_u32 s24, s16, 1
    s_and_b32 s24, s24, 3
    s_lshl_b32 s24, s24, 16
    s_add_u32 s24, s24, s37
    s_add_u32 s23, s16, 1
    s_and_b32 s23, s23, 3
    s_lshl_b32 s23, s23, 16
    s_add_u32 s23, s23, s36
    s_add_u32 s26, s16, 1
    s_and_b32 s26, s26, 3
    s_lshl_b32 s26, s26, 18
    s_add_u32 s26, s26, s38
    s_cmp_eq_u32 s59, 0
    s_cbranch_scc1 ofl_23
    s_lshl_b32 s17, s3, 10
    v_add_u32 v39, s17, v1
    ds_read_b128 v[40:43], v39 offset:32768
ofl_23:
    s_cmp_eq_u32 s16, 63
    s_cbranch_scc1 ploopH_18_tail
    s_cmp_eq_u32 s30, s54
    s_cbranch_scc1 pnoseg_24
    ds_read_b128 v[16:19], v6 offset:0
    ds_read_b128 v[20:23], v6 offset:256
    ds_read_b128 v[24:27], v6 offset:512
    ds_read_b128 v[28:31], v6 offset:768
    v_xor_b32 v6, 0x4000, v6
    s_waitcnt lgkmcnt(2)
    v_mfma_f32_16x16x32_bf16 v[40:43], v[12:15], v[16:19], 0
    v_mfma_f32_16x16x32_bf16 v[40:43], v[48:51], v[20:23], v[40:43]
    s_waitcnt lgkmcnt(0)
    v_mfma_f32_16x16x32_bf16 v[44:47], v[12:15], v[24:27], 0
    v_mfma_f32_16x16x32_bf16 v[44:47], v[48:51], v[28:31], v[44:47]
    s_nop 7
    v_cvt_pk_bf16_f32 v40, v40, v41
    v_cvt_pk_bf16_f32 v41, v42, v43
    v_cvt_pk_bf16_f32 v42, v44, v45
    v_cvt_pk_bf16_f32 v43, v46, v47
    s_nop 1
    v_permlane16_swap_b32 v40, v42
    v_permlane16_swap_b32 v41, v43
    s_nop 1
    v_min_u32 v40, -2, v40
pnoseg_24:
    s_bitcmp1_b32 s29, 0
    s_cbranch_scc1 gate_25_ok
    s_add_u32 s21, s16, 1
    s_min_u32 s21, s21, 63
    s_cmp_ge_u32 s21, 16
    s_cselect_b32 s19, 12, 8
    s_and_b32 s32, s21, 4
    s_lshr_b32 s21, s21, 3
    s_lshl_b32 s21, s21, 8
    s_add_u32 s32, s32, s21
    s_add_u32 s32, s32, s35
gate_25:
    buffer_load_dword v9, off, s[4:7], s32 sc1
    s_waitcnt vmcnt(0)
    v_readfirstlane_b32 s21, v9
    s_cmp_ge_u32 s21, s19
    s_cbranch_scc1 gate_25_set
    s_sleep 8
    s_sub_u32 s22, s22, 1
    s_cbranch_scc0 gate_25
    s_mov_b32 s22, 0
gate_25_set:
    s_bitset1_b32 s29, 0
gate_25_ok:
    v_readfirstlane_b32 s21, v60
    s_lshr_b32 s29, s29, 1
    s_cmp_ge_u32 s21, s58
    s_cselect_b32 s21, 2, 0
    s_or_b32 s29, s29, s21
    s_cmp_eq_u32 s3, 3
    s_cselect_b32 s20, s21, 0
    s_add_u32 s21, s16, 4
    s_min_u32 s21, s21, 63
    s_cmp_ge_u32 s21, 16
    s_cselect_b32 s58, 12, 8
    s_and_b32 s33, s21, 4
    s_lshr_b32 s21, s21, 3
    s_lshl_b32 s21, s21, 8
    s_add_u32 s33, s33, s21
    s_add_u32 s33, s33, s35
    s_setprio 3
ploopH_18_fs:
    ds_read_b128 v[32:35], v58 offset:0
    s_waitcnt lgkmcnt(0)
    v_min3_i32 v32, v32, v33, v34
    v_min_i32 v32, v32, v35
    s_nop 0
    v_readfirstlane_b32 s18, v32
    s_cmp_ge_i32 s18, s16
    s_cbranch_scc1 ploopH_18_fsok
    s_sleep 1
    s_branch ploopH_18_fs
ploopH_18_fsok:
    s_setprio 1
    s_add_u32 m0, s42, 8192
    s_add_u32 s17, s41, 37748736
    buffer_load_dwordx4 v1, s[4:7], s17 offen offset:0 sc1 lds
    buffer_load_dwordx4 v1, s[4:7], s17 offen offset:1024 sc1 lds
    buffer_load_dwordx4 v1, s[4:7], s17 offen offset:2048 sc1 lds
    buffer_load_dwordx4 v1, s[4:7], s17 offen offset:3072 sc1 lds
    s_add_u32 m0, s42, 12288
    s_add_u32 s17, s41, 37879808
    buffer_load_dwordx4 v1, s[4:7], s17 offen offset:0 sc1 lds
    buffer_load_dwordx4 v1, s[4:7], s17 offen offset:1024 sc1 lds
    buffer_load_dwordx4 v1, s[4:7], s17 offen offset:2048 sc1 lds
    buffer_load_dwordx4 v1, s[4:7], s17 offen offset:3072 sc1 lds
    s_cmp_eq_u32 s20, 0
    s_cbranch_scc1 ploopH_18_nt
    s_mov_b32 exec_hi, 0xffff
    buffer_load_dword v60, v0, s[4:7], s31 offen sc1
    s_mov_b32 exec_hi, -1
ploopH_18_nt:
    s_cmp_eq_u32 s59, 0
    s_cbranch_scc1 ofl_26
    s_lshl_b32 s17, s16, 18
    s_add_u32 s17, s17, s60
    buffer_store_dwordx4 v[40:43], v1, s[4:7], s17 offen sc1
    s_mov_b32 s59, 0
ofl_26:
    s_cmp_eq_u32 s30, s54
    s_cbranch_scc1 pnoseg_27
    buffer_store_dwordx4 v[40:43], v7, s[4:7], s30 offen sc1
    s_add_u32 s30, s30, 65536
pnoseg_27:
    s_or_b32 s17, s13, s3
    s_cmp_lg_u32 s17, 0
    s_cbranch_scc1 ploopH_18_npg
    s_sub_u32 s21, s16, 1
    s_cbranch_scc1 ploopH_18_npg
    s_and_b32 s17, s21, 3
    s_cmp_ge_u32 s16, 58
    s_cselect_b32 s17, 0, s17
    s_cmp_lg_u32 s17, 0
    s_cbranch_scc1 ploopH_18_npg
    s_lshl_b32 s17, s12, 7
    s_add_u32 s17, s17, 218112000
    v_mov_b32 v9, s21
    s_mov_b64 exec, 1
    buffer_store_dword v9, off, s[4:7], s17 sc1
    s_mov_b64 exec, -1
ploopH_18_npg:
    s_barrier
    buffer_load_dword v60, off, s[4:7], s33 sc1
    s_add_u32 s16, s16, 1
    v_mov_b32 v59, s16
    s_add_u32 s41, s41, 262144
    s_add_u32 s31, s31, 262144
    s_mov_b32 s54, 0
    s_setprio 3
    s_sleep 13
ploopH_18_pagain:
    buffer_load_dwordx4 v[16:19], v1, s[4:7], s28 offen offset:0 sc1
    buffer_load_dwordx4 v[20:23], v1, s[4:7], s28 offen offset:1024 sc1
    s_waitcnt vmcnt(1)
    v_mfma_f32_16x16x32_bf16 v[32:35], v[12:15], v[16:19], 0
    s_waitcnt vmcnt(0)
    v_mfma_f32_16x16x32_bf16 v[32:35], v[48:51], v[20:23], v[32:35]
    v_max_u32 v9, v16, v20
    v_cmp_eq_u32 vcc, -1, v9
    s_cbranch_vccnz ploopH_18_rp
ploopH_18_pgo:
    s_nop 4
    v_add_f32_dpp v36, v32, v32 row_ror:8 row_mask:0xf bank_mask:0xf
    v_add_f32_dpp v37, v33, v33 row_ror:8 row_mask:0xf bank_mask:0xf
    v_add_f32_dpp v38, v34, v34 row_ror:8 row_mask:0xf bank_mask:0xf
    v_add_f32_dpp v39, v35, v35 row_ror:8 row_mask:0xf bank_mask:0xf
    v_cvt_pk_bf16_f32 v52, v36, v37
    v_cvt_pk_bf16_f32 v53, v38, v39
    s_nop 0
    v_permlane16_swap_b32 v52, v54
    v_permlane16_swap_b32 v53, v55
    s_mov_b64 exec, s[56:57]
    v_min_u32 v52, -2, v52
    buffer_store_dwordx4 v[52:55], v5, s[4:7], s24 offen
    s_mov_b64 exec, -1
    ds_write_b32 v63, v59 offset:16
    s_branch ploopH_18
ploopH_18_rm_0:
    s_sub_u32 s22, s22, 1
    s_cbranch_scc1 ploopH_18_rm_0_g
    buffer_load_dwordx4 v[16:19], v1, s[4:7], s23 offen offset:0 sc1
    buffer_load_dwordx4 v[20:23], v1, s[4:7], s23 offen offset:1024 sc1
    buffer_load_dwordx4 v[24:27], v1, s[4:7], s23 offen offset:2048 sc1
    buffer_load_dwordx4 v[28:31], v1, s[4:7], s23 offen offset:3072 sc1
    s_waitcnt vmcnt(3)
    v_cmp_eq_u32 vcc, -1, v16
    s_cbranch_vccnz ploopH_18_rm_0
    s_branch ploopH_18_rm_0ok
ploopH_18_rm_0_g:
    s_mov_b32 s22, 0
    s_waitcnt vmcnt(0)
    s_branch ploopH_18_rm_0ok
ploopH_18_rm_1:
    s_sub_u32 s22, s22, 1
    s_cbranch_scc1 ploopH_18_rm_1_g
    buffer_load_dwordx4 v[20:23], v1, s[4:7], s23 offen offset:1024 sc1
    buffer_load_dwordx4 v[24:27], v1, s[4:7], s23 offen offset:2048 sc1
    buffer_load_dwordx4 v[28:31], v1, s[4:7], s23 offen offset:3072 sc1
    s_waitcnt vmcnt(2)
    v_cmp_eq_u32 vcc, -1, v20
    s_cbranch_vccnz ploopH_18_rm_1
    s_branch ploopH_18_rm_1ok
ploopH_18_rm_1_g:
    s_mov_b32 s22, 0
    s_waitcnt vmcnt(0)
    s_branch ploopH_18_rm_1ok
ploopH_18_rm_2:
    s_sub_u32 s22, s22, 1
    s_cbranch_scc1 ploopH_18_rm_2_g
    buffer_load_dwordx4 v[24:27], v1, s[4:7], s23 offen offset:2048 sc1
    buffer_load_dwordx4 v[28:31], v1, s[4:7], s23 offen offset:3072 sc1
    s_waitcnt vmcnt(1)
    v_cmp_eq_u32 vcc, -1, v24
    s_cbranch_vccnz ploopH_18_rm_2
    s_branch ploopH_18_rm_2ok
ploopH_18_rm_2_g:
    s_mov_b32 s22, 0
    s_waitcnt vmcnt(0)
    s_branch ploopH_18_rm_2ok
ploopH_18_rm_3:
    s_sub_u32 s22, s22, 1
    s_cbranch_scc1 ploopH_18_rm_3_g
    buffer_load_dwordx4 v[28:31], v1, s[4:7], s23 offen offset:3072 sc1
    s_waitcnt vmcnt(0)
    v_cmp_eq_u32 vcc, -1, v28
    s_cbranch_vccnz ploopH_18_rm_3
    s_branch ploopH_18_rm_3ok
ploopH_18_rm_3_g:
    s_mov_b32 s22, 0
    s_waitcnt vmcnt(0)
    s_branch ploopH_18_rm_3ok
ploopH_18_rp:
    s_sub_u32 s22, s22, 1
    s_cbranch_scc0 ploopH_18_pagain
    s_mov_b32 s22, 0
    s_branch ploopH_18_pgo
ploopH_18_tail:
    ds_read_b128 v[16:19], v6 offset:0
    ds_read_b128 v[20:23], v6 offset:256
    ds_read_b128 v[24:27], v6 offset:512
    ds_read_b128 v[28:31], v6 offset:768
    v_xor_b32 v6, 0x4000, v6
    s_waitcnt lgkmcnt(2)
    v_mfma_f32_16x16x32_bf16 v[40:43], v[12:15], v[16:19], 0
    v_mfma_f32_16x16x32_bf16 v[40:43], v[48:51], v[20:23], v[40:43]
    s_waitcnt lgkmcnt(0)
    v_mfma_f32_16x16x32_bf16 v[44:47], v[12:15], v[24:27], 0
    v_mfma_f32_16x16x32_bf16 v[44:47], v[48:51], v[28:31], v[44:47]
    s_nop 7
    v_cvt_pk_bf16_f32 v40, v40, v41
    v_cvt_pk_bf16_f32 v41, v42, v43
    v_cvt_pk_bf16_f32 v42, v44, v45
    v_cvt_pk_bf16_f32 v43, v46, v47
    s_nop 1
    v_permlane16_swap_b32 v40, v42
    v_permlane16_swap_b32 v41, v43
    s_nop 1
    v_min_u32 v40, -2, v40
    buffer_store_dwordx4 v[40:43], v7, s[4:7], s30 offen sc1
    s_add_u32 s30, s30, 65536
    s_barrier
    ds_read_b128 v[16:19], v6 offset:0
    ds_read_b128 v[20:23], v6 offset:256
    ds_read_b128 v[24:27], v6 offset:512
    ds_read_b128 v[28:31], v6 offset:768
    v_xor_b32 v6, 0x4000, v6
    s_waitcnt lgkmcnt(2)
    v_mfma_f32_16x16x32_bf16 v[40:43], v[12:15], v[16:19], 0
    v_mfma_f32_16x16x32_bf16 v[40:43], v[48:51], v[20:23], v[40:43]
    s_waitcnt lgkmcnt(0)
    v_mfma_f32_16x16x32_bf16 v[44:47], v[12:15], v[24:27], 0
    v_mfma_f32_16x16x32_bf16 v[44:47], v[48:51], v[28:31], v[44:47]
    s_nop 7
    v_cvt_pk_bf16_f32 v40, v40, v41
    v_cvt_pk_bf16_f32 v41, v42, v43
    v_cvt_pk_bf16_f32 v42, v44, v45
    v_cvt_pk_bf16_f32 v43, v46, v47
    s_nop 1
    v_permlane16_swap_b32 v40, v42
    v_permlane16_swap_b32 v41, v43
    s_nop 1
    v_min_u32 v40, -2, v40
    buffer_store_dwordx4 v[40:43], v7, s[4:7], s30 offen sc1
    s_add_u32 s30, s30, 65536
    s_branch k_end
ch_p_slow:
    v_mov_b32 v32, 0
    v_mov_b32 v33, 0
    v_mov_b32 v34, 0
    v_mov_b32 v35, 0
    v_mov_b32 v36, 0
    v_mov_b32 v37, 0
    v_mov_b32 v38, 0
    v_mov_b32 v39, 0
    v_mov_b32 v40, 0
    v_mov_b32 v41, 0
    v_mov_b32 v42, 0
    v_mov_b32 v43, 0
    v_mov_b32 v44, 0
    v_mov_b32 v45, 0
    v_mov_b32 v46, 0
    v_mov_b32 v47, 0
    v_mov_b32 v48, 0
    v_mov_b32 v49, 0
    v_mov_b32 v50, 0
    v_mov_b32 v51, 0
    v_mov_b32 v52, 0
    v_mov_b32 v53, 0
    v_mov_b32 v54, 0
    v_mov_b32 v55, 0
    v_mov_b32 v59, 0
    s_nop 1
    s_branch ploopL_29_nc
.p2align 6
    s_nop 0
    s_nop 0
    s_nop 0
    s_nop 0
    s_nop 0
    s_nop 0
    s_nop 0
    s_nop 0
    s_nop 0
    s_nop 0
    s_nop 0
ploopL_29:
    v_mov_b32 v32, 0
    v_mov_b32 v33, 0
    v_mov_b32 v34, 0
    v_mov_b32 v35, 0
    v_mov_b32 v36, 0
    v_mov_b32 v37, 0
    v_mov_b32 v38, 0
    v_mov_b32 v39, 0
    v_mov_b32 v40, 0
    v_mov_b32 v41, 0
    v_mov_b32 v42, 0
    v_mov_b32 v43, 0
    v_mov_b32 v44, 0
    v_mov_b32 v45, 0
    v_mov_b32 v46, 0
    v_mov_b32 v47, 0
    v_mov_b32 v48, 0
    v_mov_b32 v49, 0
    v_mov_b32 v50, 0
    v_mov_b32 v51, 0
    v_mov_b32 v52, 0
    v_mov_b32 v53, 0
    v_mov_b32 v54, 0
    v_mov_b32 v55, 0
    s_bitcmp1_b32 s29, 0
    s_cbranch_scc1 gate_30_ok
    s_add_u32 s21, s16, 1
    s_min_u32 s21, s21, 63
    s_cmp_ge_u32 s21, 16
    s_cselect_b32 s19, 12, 8
    s_and_b32 s32, s21, 4
    s_lshr_b32 s21, s21, 3
    s_lshl_b32 s21, s21, 8
    s_add_u32 s32, s32, s21
    s_add_u32 s32, s32, s35
gate_30:
    buffer_load_dword v9, off, s[4:7], s32 sc1
    s_waitcnt vmcnt(0)
    v_readfirstlane_b32 s21, v9
    s_cmp_ge_u32 s21, s19
    s_cbranch_scc1 gate_30_set
    s_sleep 8
    s_sub_u32 s22, s22, 1
    s_cbranch_scc0 gate_30
    s_mov_b32 s22, 0
gate_30_set:
    s_bitset1_b32 s29, 0
gate_30_ok:
    s_sleep 1
    buffer_load_dwordx4 v[16:19], v1, s[4:7], s23 offen offset:0 sc1
    buffer_load_dwordx4 v[20:23], v1, s[4:7], s23 offen offset:1024 sc1
    buffer_load_dwordx4 v[24:27], v1, s[4:7], s23 offen offset:2048 sc1
    buffer_load_dwordx4 v[28:31], v1, s[4:7], s23 offen offset:3072 sc1
    s_waitcnt vmcnt(3)
    v_cmp_eq_u32 vcc, -1, v16
    s_cbranch_vccnz ploopL_29_rm_0
ploopL_29_rm_0ok:
    v_smfmac_f32_16x16x64_bf16 v[32:35], v[16:19], v[64:71], v8
    v_smfmac_f32_16x16x64_bf16 v[36:39], v[16:19], v[72:79], v8
    s_waitcnt vmcnt(2)
    v_cmp_eq_u32 vcc, -1, v20
    v_smfmac_f32_16x16x64_bf16 v[40:43], v[16:19], v[80:87], v8
    v_smfmac_f32_16x16x64_bf16 v[44:47], v[16:19], v[88:95], v8
    v_smfmac_f32_16x16x64_bf16 v[48:51], v[16:19], v[96:103], v8
    v_smfmac_f32_16x16x64_bf16 v[52:55], v[16:19], v[104:111], v8
    s_cbranch_vccnz ploopL_29_rm_1
ploopL_29_rm_1ok:
    v_smfmac_f32_16x16x64_bf16 v[32:35], v[20:23], v[112:119], v8
    v_smfmac_f32_16x16x64_bf16 v[36:39], v[20:23], v[120:127], v8
    s_waitcnt vmcnt(1)
    v_cmp_eq_u32 vcc, -1, v24
    v_smfmac_f32_16x16x64_bf16 v[40:43], v[20:23], v[128:135], v8
    v_smfmac_f32_16x16x64_bf16 v[44:47], v[20:23], v[136:143], v8
    v_smfmac_f32_16x16x64_bf16 v[48:51], v[20:23], v[144:151], v8
    v_smfmac_f32_16x16x64_bf16 v[52:55], v[20:23], v[152:159], v8
    s_cbranch_vccnz ploopL_29_rm_2
ploopL_29_rm_2ok:
    v_smfmac_f32_16x16x64_bf16 v[32:35], v[24:27], v[160:167], v8
    v_smfmac_f32_16x16x64_bf16 v[36:39], v[24:27], v[168:175], v8
    s_waitcnt vmcnt(0)
    v_cmp_eq_u32 vcc, -1, v28
    v_smfmac_f32_16x16x64_bf16 v[40:43], v[24:27], v[176:183], v8
    v_smfmac_f32_16x16x64_bf16 v[44:47], v[24:27], v[184:191], v8
    v_smfmac_f32_16x16x64_bf16 v[48:51], v[24:27], v[192:199], v8
    v_smfmac_f32_16x16x64_bf16 v[52:55], v[24:27], v[200:207], v8
    s_cbranch_vccnz ploopL_29_rm_3
ploopL_29_rm_3ok:
    v_smfmac_f32_16x16x64_bf16 v[32:35], v[28:31], v[208:215], v8
    ds_write_b32 v63, v59 offset:32
    v_smfmac_f32_16x16x64_bf16 v[36:39], v[28:31], v[216:223], v8
    v_smfmac_f32_16x16x64_bf16 v[40:43], v[28:31], v[224:231], v8
    v_smfmac_f32_16x16x64_bf16 v[44:47], v[28:31], v[232:239], v8
    v_smfmac_f32_16x16x64_bf16 v[48:51], v[28:31], v[240:247], v8
    v_smfmac_f32_16x16x64_bf16 v[52:55], v[28:31], v[248:255], v8
    s_branch ploopL_29_mmd
ploopL_29_nc:
    v_smfmac_f32_16x16x64_bf16 v[32:35], v[16:19], v[64:71], v8
    v_smfmac_f32_16x16x64_bf16 v[36:39], v[16:19], v[72:79], v8
    v_smfmac_f32_16x16x64_bf16 v[40:43], v[16:19], v[80:87], v8
    v_smfmac_f32_16x16x64_bf16 v[44:47], v[16:19], v[88:95], v8
    v_smfmac_f32_16x16x64_bf16 v[48:51], v[16:19], v[96:103], v8
    v_smfmac_f32_16x16x64_bf16 v[52:55], v[16:19], v[104:111], v8
    v_smfmac_f32_16x16x64_bf16 v[32:35], v[20:23], v[112:119], v8
    v_smfmac_f32_16x16x64_bf16 v[36:39], v[20:23], v[120:127], v8
    v_smfmac_f32_16x16x64_bf16 v[40:43], v[20:23], v[128:135], v8
    v_smfmac_f32_16x16x64_bf16 v[44:47], v[20:23], v[136:143], v8
    v_smfmac_f32_16x16x64_bf16 v[48:51], v[20:23], v[144:151], v8
    v_smfmac_f32_16x16x64_bf16 v[52:55], v[20:23], v[152:159], v8
    v_smfmac_f32_16x16x64_bf16 v[32:35], v[24:27], v[160:167], v8
    v_smfmac_f32_16x16x64_bf16 v[36:39], v[24:27], v[168:175], v8
    v_smfmac_f32_16x16x64_bf16 v[40:43], v[24:27], v[176:183], v8
    v_smfmac_f32_16x16x64_bf16 v[44:47], v[24:27], v[184:191], v8
    v_smfmac_f32_16x16x64_bf16 v[48:51], v[24:27], v[192:199], v8
    v_smfmac_f32_16x16x64_bf16 v[52:55], v[24:27], v[200:207], v8
    v_smfmac_f32_16x16x64_bf16 v[32:35], v[28:31], v[208:215], v8
    ds_write_b32 v63, v59 offset:32
    v_smfmac_f32_16x16x64_bf16 v[36:39], v[28:31], v[216:223], v8
    v_smfmac_f32_16x16x64_bf16 v[40:43], v[28:31], v[224:231], v8
    v_smfmac_f32_16x16x64_bf16 v[44:47], v[28:31], v[232:239], v8
    v_smfmac_f32_16x16x64_bf16 v[48:51], v[28:31], v[240:247], v8
    v_smfmac_f32_16x16x64_bf16 v[52:55], v[28:31], v[248:255], v8
ploopL_29_mmd:
    s_cmp_eq_u32 s3, 3
    s_nop 1
    v_add_f32 v32, v32, v34
    v_add_f32 v33, v33, v35
    ds_write2_b32 v3, v32, v33 offset0:0 offset1:40
    v_add_f32 v36, v36, v38
    v_add_f32 v37, v37, v39
    ds_write2_b32 v3, v36, v37 offset0:16 offset1:56
    v_add_f32 v40, v40, v42
    v_add_f32 v41, v41, v43
    ds_write2_b32 v61, v40, v41 offset0:0 offset1:40
    v_add_f32 v44, v44, v46
    v_add_f32 v45, v45, v47
    ds_write2_b32 v61, v44, v45 offset0:16 offset1:56
    v_add_f32 v48, v48, v50
    v_add_f32 v49, v49, v51
    ds_write2_b32 v62, v48, v49 offset0:0 offset1:40
    v_add_f32 v52, v52, v54
    v_add_f32 v53, v53, v55
    ds_write2_b32 v62, v52, v53 offset0:16 offset1:56
    s_waitcnt lgkmcnt(0)
    s_barrier
    s_cbranch_scc1 ploopL_29_sk1
    ds_read_b128 v[32:35], v4 offset:0
    ds_read_b128 v[36:39], v4 offset:3840
    ds_read_b128 v[40:43], v4 offset:7680
    ds_read_b128 v[44:47], v4 offset:11520
    s_waitcnt lgkmcnt(2)
    v_add_f32 v32, v32, v36
    v_add_f32 v33, v33, v37
    v_add_f32 v34, v34, v38
    v_add_f32 v35, v35, v39
    s_waitcnt lgkmcnt(0)
    v_add_f32 v40, v40, v44
    v_add_f32 v41, v41, v45
    v_add_f32 v42, v42, v46
    v_add_f32 v43, v43, v47
    v_add_f32 v32, v32, v40
    v_add_f32 v33, v33, v41
    v_add_f32 v34, v34, v42
    v_add_f32 v35, v35, v43
    v_cvt_pk_bf16_f32 v56, v32, v33
    v_cvt_pk_bf16_f32 v57, v34, v35
    v_min_u32 v56, -2, v56
    buffer_store_dwordx2 v[56:57], v2, s[4:7], s26 offen sc1
    s_add_u32 s27, s16, 2
    s_and_b32 s27, s27, 3
    s_lshl_b32 s27, s27, 18
    s_add_u32 s27, s27, s38
    buffer_store_dwordx2 v[10:11], v2, s[4:7], s27 offen sc1
ploopL_29_sk1:
    s_setprio 0
    s_add_u32 s25, s16, 3
    s_and_b32 s25, s25, 3
    s_lshl_b32 s25, s25, 16
    s_add_u32 s25, s25, s37
    v_mov_b32 v44, -1
    v_mov_b32 v45, -1
    v_mov_b32 v46, -1
    v_mov_b32 v47, -1
    s_mov_b64 exec, s[56:57]
    buffer_store_dwordx4 v[44:47], v5, s[4:7], s25 offen sc1
    s_mov_b64 exec, -1
    v_mov_b32_dpp v48, v12 row_ror:8 row_mask:0xf bank_mask:0xf
    v_mov_b32_dpp v49, v13 row_ror:8 row_mask:0xf bank_mask:0xf
    v_mov_b32_dpp v50, v14 row_ror:8 row_mask:0xf bank_mask:0xf
    v_mov_b32_dpp v51, v15 row_ror:8 row_mask:0xf bank_mask:0xf
    s_and_b32 s28, s16, 3
    s_lshl_b32 s28, s28, 18
    s_add_u32 s28, s28, s39
    s_add_u32 s24, s16, 1
    s_and_b32 s24, s24, 3
    s_lshl_b32 s24, s24, 16
    s_add_u32 s24, s24, s37
    s_add_u32 s23, s16, 1
    s_and_b32 s23, s23, 3
    s_lshl_b32 s23, s23, 16
    s_add_u32 s23, s23, s36
    s_add_u32 s26, s16, 1
    s_and_b32 s26, s26, 3
    s_lshl_b32 s26, s26, 18
    s_add_u32 s26, s26, s38
    s_cmp_eq_u32 s59, 0
    s_cbranch_scc1 ofl_31
    s_lshl_b32 s17, s3, 10
    v_add_u32 v39, s17, v1
    ds_read_b128 v[40:43], v39 offset:32768
ofl_31:
    s_cmp_ge_u32 s16, 16
    s_cbranch_scc1 ploopL_29_nx
    v_mov_b32 v40, v2
    v_mov_b32 v42, v56
    v_mov_b32 v43, v57
    s_cmp_lg_u32 s3, 2
    s_cbranch_scc1 ploopL_29_nx
    v_and_b32 v40, 0x60, v1
    v_lshlrev_b32 v40, 2, v40
    v_lshrrev_b32 v41, 3, v1
    v_and_b32 v41, 0x70, v41
    v_or_b32 v40, v40, v41
    v_bfe_u32 v41, v1, 4, 1
    v_lshl_or_b32 v40, v41, 3, v40
    s_lshl_b32 s17, s53, 9
    s_add_u32 s17, s17, 4096
    v_add_u32 v40, s17, v40
    s_mov_b32 vcc_lo, 0x55555555
    s_mov_b32 vcc_hi, 0x55555555
    v_cndmask_b32_dpp v42, v57, v56, vcc quad_perm:[1,0,3,2] row_mask:0xf bank_mask:0xf
    s_not_b64 vcc, vcc
    v_cndmask_b32_dpp v43, v56, v57, vcc quad_perm:[1,0,3,2] row_mask:0xf bank_mask:0xf
ploopL_29_nx:
    v_readfirstlane_b32 s21, v60
    s_lshr_b32 s29, s29, 1
    s_cmp_ge_u32 s21, s58
    s_cselect_b32 s21, 2, 0
    s_or_b32 s29, s29, s21
    s_cmp_eq_u32 s3, 3
    s_cselect_b32 s20, s21, 0
    s_add_u32 s21, s16, 4
    s_min_u32 s21, s21, 63
    s_cmp_ge_u32 s21, 16
    s_cselect_b32 s58, 12, 8
    s_and_b32 s33, s21, 4
    s_lshr_b32 s21, s21, 3
    s_lshl_b32 s21, s21, 8
    s_add_u32 s33, s33, s21
    s_add_u32 s33, s33, s35
    s_setprio 3
ploopL_29_fs:
    ds_read_b128 v[32:35], v58 offset:0
    s_waitcnt lgkmcnt(0)
    v_min3_i32 v32, v32, v33, v34
    v_min_i32 v32, v32, v35
    s_nop 0
    v_readfirstlane_b32 s18, v32
    s_cmp_ge_i32 s18, s16
    s_cbranch_scc1 ploopL_29_fsok
    s_sleep 1
    s_branch ploopL_29_fs
ploopL_29_fsok:
    s_setprio 1
    s_sleep 4
ploopL_29_nofd:
    s_cmp_eq_u32 s20, 0
    s_cbranch_scc1 ploopL_29_nt
    s_cmp_ge_u32 s16, 13
    s_cselect_b32 exec_hi, 0xffff, 0
    buffer_load_dword v60, v0, s[4:7], s31 offen sc1
    s_mov_b32 exec_hi, -1
ploopL_29_nt:
    s_cmp_eq_u32 s59, 0
    s_cbranch_scc1 ofl_32
    s_lshl_b32 s17, s16, 18
    s_add_u32 s17, s17, s60
    buffer_store_dwordx4 v[40:43], v1, s[4:7], s17 offen sc1
    s_mov_b32 s59, 0
ofl_32:
    s_lshr_b32 s17, s34, 3
    s_xor_b32 s17, s17, s16
    s_andn2_b32 s59, 1, s17
    s_cmp_ge_u32 s16, 16
    s_cselect_b32 s59, s59, 0
    s_cbranch_scc1 ploopL_29_nx2
    s_cmp_eq_u32 s3, 3
    s_cbranch_scc1 ploopL_29_nx2
    buffer_store_dwordx2 v[42:43], v40, s[4:7], s55 offen sc1
ploopL_29_nx2:
    s_add_u32 s55, s55, 262144
    s_or_b32 s17, s13, s3
    s_cmp_lg_u32 s17, 0
    s_cbranch_scc1 ploopL_29_npg
    s_sub_u32 s21, s16, 1
    s_cbranch_scc1 ploopL_29_npg
    s_and_b32 s17, s21, 3
    s_cmp_ge_u32 s16, 58
    s_cselect_b32 s17, 0, s17
    s_cmp_lg_u32 s17, 0
    s_cbranch_scc1 ploopL_29_npg
    s_lshl_b32 s17, s12, 7
    s_add_u32 s17, s17, 218112000
    v_mov_b32 v9, s21
    s_mov_b64 exec, 1
    buffer_store_dword v9, off, s[4:7], s17 sc1
    s_mov_b64 exec, -1
ploopL_29_npg:
    s_barrier
    buffer_load_dword v60, off, s[4:7], s33 sc1
    s_add_u32 s16, s16, 1
    v_mov_b32 v59, s16
    s_add_u32 s41, s41, 262144
    s_add_u32 s31, s31, 262144
    s_setprio 3
    s_sleep 13
ploopL_29_pagain:
    buffer_load_dwordx4 v[16:19], v1, s[4:7], s28 offen offset:0 sc1
    buffer_load_dwordx4 v[20:23], v1, s[4:7], s28 offen offset:1024 sc1
    s_waitcnt vmcnt(1)
    v_mfma_f32_16x16x32_bf16 v[32:35], v[12:15], v[16:19], 0
    s_waitcnt vmcnt(0)
    v_mfma_f32_16x16x32_bf16 v[32:35], v[48:51], v[20:23], v[32:35]
    v_max_u32 v9, v16, v20
    v_cmp_eq_u32 vcc, -1, v9
    s_cbranch_vccnz ploopL_29_rp
ploopL_29_pgo:
    s_cmp_lt_u32 s16, 48
    s_nop 3
    v_add_f32_dpp v36, v32, v32 row_ror:8 row_mask:0xf bank_mask:0xf
    v_add_f32_dpp v37, v33, v33 row_ror:8 row_mask:0xf bank_mask:0xf
    v_add_f32_dpp v38, v34, v34 row_ror:8 row_mask:0xf bank_mask:0xf
    v_add_f32_dpp v39, v35, v35 row_ror:8 row_mask:0xf bank_mask:0xf
    v_cvt_pk_bf16_f32 v52, v36, v37
    v_cvt_pk_bf16_f32 v53, v38, v39
    s_nop 0
    v_permlane16_swap_b32 v52, v54
    v_permlane16_swap_b32 v53, v55
    s_mov_b64 exec, s[56:57]
    v_min_u32 v52, -2, v52
    buffer_store_dwordx4 v[52:55], v5, s[4:7], s24 offen sc1
    s_mov_b64 exec, -1
    ds_write_b32 v63, v59 offset:16
    s_cbranch_scc1 ploopL_29
    s_branch ploopH_28
ploopL_29_rm_0:
    s_sub_u32 s22, s22, 1
    s_cbranch_scc1 ploopL_29_rm_0_g
    buffer_load_dwordx4 v[16:19], v1, s[4:7], s23 offen offset:0 sc1
    buffer_load_dwordx4 v[20:23], v1, s[4:7], s23 offen offset:1024 sc1
    buffer_load_dwordx4 v[24:27], v1, s[4:7], s23 offen offset:2048 sc1
    buffer_load_dwordx4 v[28:31], v1, s[4:7], s23 offen offset:3072 sc1
    s_waitcnt vmcnt(3)
    v_cmp_eq_u32 vcc, -1, v16
    s_cbranch_vccnz ploopL_29_rm_0
    s_branch ploopL_29_rm_0ok
ploopL_29_rm_0_g:
    s_mov_b32 s22, 0
    s_waitcnt vmcnt(0)
    s_branch ploopL_29_rm_0ok
ploopL_29_rm_1:
    s_sub_u32 s22, s22, 1
    s_cbranch_scc1 ploopL_29_rm_1_g
    buffer_load_dwordx4 v[20:23], v1, s[4:7], s23 offen offset:1024 sc1
    buffer_load_dwordx4 v[24:27], v1, s[4:7], s23 offen offset:2048 sc1
    buffer_load_dwordx4 v[28:31], v1, s[4:7], s23 offen offset:3072 sc1
    s_waitcnt vmcnt(2)
    v_cmp_eq_u32 vcc, -1, v20
    s_cbranch_vccnz ploopL_29_rm_1
    s_branch ploopL_29_rm_1ok
ploopL_29_rm_1_g:
    s_mov_b32 s22, 0
    s_waitcnt vmcnt(0)
    s_branch ploopL_29_rm_1ok
ploopL_29_rm_2:
    s_sub_u32 s22, s22, 1
    s_cbranch_scc1 ploopL_29_rm_2_g
    buffer_load_dwordx4 v[24:27], v1, s[4:7], s23 offen offset:2048 sc1
    buffer_load_dwordx4 v[28:31], v1, s[4:7], s23 offen offset:3072 sc1
    s_waitcnt vmcnt(1)
    v_cmp_eq_u32 vcc, -1, v24
    s_cbranch_vccnz ploopL_29_rm_2
    s_branch ploopL_29_rm_2ok
ploopL_29_rm_2_g:
    s_mov_b32 s22, 0
    s_waitcnt vmcnt(0)
    s_branch ploopL_29_rm_2ok
ploopL_29_rm_3:
    s_sub_u32 s22, s22, 1
    s_cbranch_scc1 ploopL_29_rm_3_g
    buffer_load_dwordx4 v[28:31], v1, s[4:7], s23 offen offset:3072 sc1
    s_waitcnt vmcnt(0)
    v_cmp_eq_u32 vcc, -1, v28
    s_cbranch_vccnz ploopL_29_rm_3
    s_branch ploopL_29_rm_3ok
ploopL_29_rm_3_g:
    s_mov_b32 s22, 0
    s_waitcnt vmcnt(0)
    s_branch ploopL_29_rm_3ok
ploopL_29_rp:
    s_sub_u32 s22, s22, 1
    s_cbranch_scc0 ploopL_29_pagain
    s_mov_b32 s22, 0
    s_branch ploopL_29_pgo
.p2align 6
    s_nop 0
    s_nop 0
    s_nop 0
    s_nop 0
    s_nop 0
    s_nop 0
    s_nop 0
    s_nop 0
    s_nop 0
    s_nop 0
    s_nop 0
ploopH_28:
    v_mov_b32 v32, 0
    v_mov_b32 v33, 0
    v_mov_b32 v34, 0
    v_mov_b32 v35, 0
    v_mov_b32 v36, 0
    v_mov_b32 v37, 0
    v_mov_b32 v38, 0
    v_mov_b32 v39, 0
    v_mov_b32 v40, 0
    v_mov_b32 v41, 0
    v_mov_b32 v42, 0
    v_mov_b32 v43, 0
    v_mov_b32 v44, 0
    v_mov_b32 v45, 0
    v_mov_b32 v46, 0
    v_mov_b32 v47, 0
    v_mov_b32 v48, 0
    v_mov_b32 v49, 0
    v_mov_b32 v50, 0
    v_mov_b32 v51, 0
    v_mov_b32 v52, 0
    v_mov_b32 v53, 0
    v_mov_b32 v54, 0
    v_mov_b32 v55, 0
    s_sleep 1
    buffer_load_dwordx4 v[16:19], v1, s[4:7], s23 offen offset:0 sc1
    buffer_load_dwordx4 v[20:23], v1, s[4:7], s23 offen offset:1024 sc1
    buffer_load_dwordx4 v[24:27], v1, s[4:7], s23 offen offset:2048 sc1
    buffer_load_dwordx4 v[28:31], v1, s[4:7], s23 offen offset:3072 sc1
    s_waitcnt vmcnt(3)
    v_cmp_eq_u32 vcc, -1, v16
    s_cbranch_vccnz ploopH_28_rm_0
ploopH_28_rm_0ok:
    v_smfmac_f32_16x16x64_bf16 v[32:35], v[16:19], v[64:71], v8
    v_smfmac_f32_16x16x64_bf16 v[36:39], v[16:19], v[72:79], v8
    s_waitcnt vmcnt(2)
    v_cmp_eq_u32 vcc, -1, v20
    v_smfmac_f32_16x16x64_bf16 v[40:43], v[16:19], v[80:87], v8
    v_smfmac_f32_16x16x64_bf16 v[44:47], v[16:19], v[88:95], v8
    v_smfmac_f32_16x16x64_bf16 v[48:51], v[16:19], v[96:103], v8
    v_smfmac_f32_16x16x64_bf16 v[52:55], v[16:19], v[104:111], v8
    s_cbranch_vccnz ploopH_28_rm_1
ploopH_28_rm_1ok:
    v_smfmac_f32_16x16x64_bf16 v[32:35], v[20:23], v[112:119], v8
    v_smfmac_f32_16x16x64_bf16 v[36:39], v[20:23], v[120:127], v8
    s_waitcnt vmcnt(1)
    v_cmp_eq_u32 vcc, -1, v24
    v_smfmac_f32_16x16x64_bf16 v[40:43], v[20:23], v[128:135], v8
    v_smfmac_f32_16x16x64_bf16 v[44:47], v[20:23], v[136:143], v8
    v_smfmac_f32_16x16x64_bf16 v[48:51], v[20:23], v[144:151], v8
    v_smfmac_f32_16x16x64_bf16 v[52:55], v[20:23], v[152:159], v8
    s_cbranch_vccnz ploopH_28_rm_2
ploopH_28_rm_2ok:
    v_smfmac_f32_16x16x64_bf16 v[32:35], v[24:27], v[160:167], v8
    v_smfmac_f32_16x16x64_bf16 v[36:39], v[24:27], v[168:175], v8
    s_waitcnt vmcnt(0)
    v_cmp_eq_u32 vcc, -1, v28
    v_smfmac_f32_16x16x64_bf16 v[40:43], v[24:27], v[176:183], v8
    v_smfmac_f32_16x16x64_bf16 v[44:47], v[24:27], v[184:191], v8
    v_smfmac_f32_16x16x64_bf16 v[48:51], v[24:27], v[192:199], v8
    v_smfmac_f32_16x16x64_bf16 v[52:55], v[24:27], v[200:207], v8
    s_cbranch_vccnz ploopH_28_rm_3
ploopH_28_rm_3ok:
    v_smfmac_f32_16x16x64_bf16 v[32:35], v[28:31], v[208:215], v8
    ds_write_b32 v63, v59 offset:32
    v_smfmac_f32_16x16x64_bf16 v[36:39], v[28:31], v[216:223], v8
    v_smfmac_f32_16x16x64_bf16 v[40:43], v[28:31], v[224:231], v8
    v_smfmac_f32_16x16x64_bf16 v[44:47], v[28:31], v[232:239], v8
    v_smfmac_f32_16x16x64_bf16 v[48:51], v[28:31], v[240:247], v8
    v_smfmac_f32_16x16x64_bf16 v[52:55], v[28:31], v[248:255], v8
    s_cmp_eq_u32 s3, 3
    s_nop 1
    v_add_f32 v32, v32, v34
    v_add_f32 v33, v33, v35
    ds_write2_b32 v3, v32, v33 offset0:0 offset1:40
    v_add_f32 v36, v36, v38
    v_add_f32 v37, v37, v39
    ds_write2_b32 v3, v36, v37 offset0:16 offset1:56
    v_add_f32 v40, v40, v42
    v_add_f32 v41, v41, v43
    ds_write2_b32 v61, v40, v41 offset0:0 offset1:40
    v_add_f32 v44, v44, v46
    v_add_f32 v45, v45, v47
    ds_write2_b32 v61, v44, v45 offset0:16 offset1:56
    v_add_f32 v48, v48, v50
    v_add_f32 v49, v49, v51
    ds_write2_b32 v62, v48, v49 offset0:0 offset1:40
    v_add_f32 v52, v52, v54
    v_add_f32 v53, v53, v55
    ds_write2_b32 v62, v52, v53 offset0:16 offset1:56
    s_waitcnt lgkmcnt(0)
    s_barrier
    s_cbranch_scc1 ploopH_28_sk1
    ds_read_b128 v[32:35], v4 offset:0
    ds_read_b128 v[36:39], v4 offset:3840
    ds_read_b128 v[40:43], v4 offset:7680
    ds_read_b128 v[44:47], v4 offset:11520
    s_waitcnt lgkmcnt(2)
    v_add_f32 v32, v32, v36
    v_add_f32 v33, v33, v37
    v_add_f32 v34, v34, v38
    v_add_f32 v35, v35, v39
    s_waitcnt lgkmcnt(0)
    v_add_f32 v40, v40, v44
    v_add_f32 v41, v41, v45
    v_add_f32 v42, v42, v46
    v_add_f32 v43, v43, v47
    v_add_f32 v32, v32, v40
    v_add_f32 v33, v33, v41
    v_add_f32 v34, v34, v42
    v_add_f32 v35, v35, v43
    v_cvt_pk_bf16_f32 v56, v32, v33
    v_cvt_pk_bf16_f32 v57, v34, v35
    v_min_u32 v56, -2, v56
    buffer_store_dwordx2 v[56:57], v2, s[4:7], s26 offen sc1
    s_add_u32 s27, s16, 2
    s_and_b32 s27, s27, 3
    s_lshl_b32 s27, s27, 18
    s_add_u32 s27, s27, s38
    buffer_store_dwordx2 v[10:11], v2, s[4:7], s27 offen sc1
ploopH_28_sk1:
    s_setprio 0
    s_add_u32 s25, s16, 3
    s_and_b32 s25, s25, 3
    s_lshl_b32 s25, s25, 16
    s_add_u32 s25, s25, s37
    v_mov_b32 v44, -1
    v_mov_b32 v45, -1
    v_mov_b32 v46, -1
    v_mov_b32 v47, -1
    s_mov_b64 exec, s[56:57]
    buffer_store_dwordx4 v[44:47], v5, s[4:7], s25 offen sc1
    s_mov_b64 exec, -1
    v_mov_b32_dpp v48, v12 row_ror:8 row_mask:0xf bank_mask:0xf
    v_mov_b32_dpp v49, v13 row_ror:8 row_mask:0xf bank_mask:0xf
    v_mov_b32_dpp v50, v14 row_ror:8 row_mask:0xf bank_mask:0xf
    v_mov_b32_dpp v51, v15 row_ror:8 row_mask:0xf bank_mask:0xf
    s_and_b32 s28, s16, 3
    s_lshl_b32 s28, s28, 18
    s_add_u32 s28, s28, s39
    s_add_u32 s24, s16, 1
    s_and_b32 s24, s24, 3
    s_lshl_b32 s24, s24, 16
    s_add_u32 s24, s24, s37
    s_add_u32 s23, s16, 1
    s_and_b32 s23, s23, 3
    s_lshl_b32 s23, s23, 16
    s_add_u32 s23, s23, s36
    s_add_u32 s26, s16, 1
    s_and_b32 s26, s26, 3
    s_lshl_b32 s26, s26, 18
    s_add_u32 s26, s26, s38
    s_cmp_eq_u32 s59, 0
    s_cbranch_scc1 ofl_33
    s_lshl_b32 s17, s3, 10
    v_add_u32 v39, s17, v1
    ds_read_b128 v[40:43], v39 offset:32768
ofl_33:
    s_cmp_eq_u32 s16, 63
    s_cbranch_scc1 ploopH_28_tail
    s_cmp_eq_u32 s30, s54
    s_cbranch_scc1 pnoseg_34
    ds_read_b128 v[16:19], v6 offset:0
    ds_read_b128 v[20:23], v6 offset:256
    ds_read_b128 v[24:27], v6 offset:512
    ds_read_b128 v[28:31], v6 offset:768
    v_xor_b32 v6, 0x4000, v6
    s_waitcnt lgkmcnt(2)
    v_mfma_f32_16x16x32_bf16 v[40:43], v[12:15], v[16:19], 0
    v_mfma_f32_16x16x32_bf16 v[40:43], v[48:51], v[20:23], v[40:43]
    s_waitcnt lgkmcnt(0)
    v_mfma_f32_16x16x32_bf16 v[44:47], v[12:15], v[24:27], 0
    v_mfma_f32_16x16x32_bf16 v[44:47], v[48:51], v[28:31], v[44:47]
    s_nop 7
    v_cvt_pk_bf16_f32 v40, v40, v41
    v_cvt_pk_bf16_f32 v41, v42, v43
    v_cvt_pk_bf16_f32 v42, v44, v45
    v_cvt_pk_bf16_f32 v43, v46, v47
    s_nop 1
    v_permlane16_swap_b32 v40, v42
    v_permlane16_swap_b32 v41, v43
    s_nop 1
    v_min_u32 v40, -2, v40
pnoseg_34:
    s_bitcmp1_b32 s29, 0
    s_cbranch_scc1 gate_35_ok
    s_add_u32 s21, s16, 1
    s_min_u32 s21, s21, 63
    s_cmp_ge_u32 s21, 16
    s_cselect_b32 s19, 12, 8
    s_and_b32 s32, s21, 4
    s_lshr_b32 s21, s21, 3
    s_lshl_b32 s21, s21, 8
    s_add_u32 s32, s32, s21
    s_add_u32 s32, s32, s35
gate_35:
    buffer_load_dword v9, off, s[4:7], s32 sc1
    s_waitcnt vmcnt(0)
    v_readfirstlane_b32 s21, v9
    s_cmp_ge_u32 s21, s19
    s_cbranch_scc1 gate_35_set
    s_sleep 8
    s_sub_u32 s22, s22, 1
    s_cbranch_scc0 gate_35
    s_mov_b32 s22, 0
gate_35_set:
    s_bitset1_b32 s29, 0
gate_35_ok:
    v_readfirstlane_b32 s21, v60
    s_lshr_b32 s29, s29, 1
    s_cmp_ge_u32 s21, s58
    s_cselect_b32 s21, 2, 0
    s_or_b32 s29, s29, s21
    s_cmp_eq_u32 s3, 3
    s_cselect_b32 s20, s21, 0
    s_add_u32 s21, s16, 4
    s_min_u32 s21, s21, 63
    s_cmp_ge_u32 s21, 16
    s_cselect_b32 s58, 12, 8
    s_and_b32 s33, s21, 4
    s_lshr_b32 s21, s21, 3
    s_lshl_b32 s21, s21, 8
    s_add_u32 s33, s33, s21
    s_add_u32 s33, s33, s35
    s_setprio 3
ploopH_28_fs:
    ds_read_b128 v[32:35], v58 offset:0
    s_waitcnt lgkmcnt(0)
    v_min3_i32 v32, v32, v33, v34
    v_min_i32 v32, v32, v35
    s_nop 0
    v_readfirstlane_b32 s18, v32
    s_cmp_ge_i32 s18, s16
    s_cbranch_scc1 ploopH_28_fsok
    s_sleep 1
    s_branch ploopH_28_fs
ploopH_28_fsok:
    s_setprio 1
    s_add_u32 m0, s42, 8192
    s_add_u32 s17, s41, 37748736
    buffer_load_dwordx4 v1, s[4:7], s17 offen offset:0 sc1 lds
    buffer_load_dwordx4 v1, s[4:7], s17 offen offset:1024 sc1 lds
    buffer_load_dwordx4 v1, s[4:7], s17 offen offset:2048 sc1 lds
    buffer_load_dwordx4 v1, s[4:7], s17 offen offset:3072 sc1 lds
    s_add_u32 m0, s42, 12288
    s_add_u32 s17, s41, 37879808
    buffer_load_dwordx4 v1, s[4:7], s17 offen offset:0 sc1 lds
    buffer_load_dwordx4 v1, s[4:7], s17 offen offset:1024 sc1 lds
    buffer_load_dwordx4 v1, s[4:7], s17 offen offset:2048 sc1 lds
    buffer_load_dwordx4 v1, s[4:7], s17 offen offset:3072 sc1 lds
    s_cmp_eq_u32 s20, 0
    s_cbranch_scc1 ploopH_28_nt
    s_mov_b32 exec_hi, 0xffff
    buffer_load_dword v60, v0, s[4:7], s31 offen sc1
    s_mov_b32 exec_hi, -1
ploopH_28_nt:
    s_cmp_eq_u32 s59, 0
    s_cbranch_scc1 ofl_36
    s_lshl_b32 s17, s16, 18
    s_add_u32 s17, s17, s60
    buffer_store_dwordx4 v[40:43], v1, s[4:7], s17 offen sc1
    s_mov_b32 s59, 0
ofl_36:
    s_cmp_eq_u32 s30, s54
    s_cbranch_scc1 pnoseg_37
    buffer_store_dwordx4 v[40:43], v7, s[4:7], s30 offen sc1
    s_add_u32 s30, s30, 65536
pnoseg_37:
    s_or_b32 s17, s13, s3
    s_cmp_lg_u32 s17, 0
    s_cbranch_scc1 ploopH_28_npg
    s_sub_u32 s21, s16, 1
    s_cbranch_scc1 ploopH_28_npg
    s_and_b32 s17, s21, 3
    s_cmp_ge_u32 s16, 58
    s_cselect_b32 s17, 0, s17
    s_cmp_lg_u32 s17, 0
    s_cbranch_scc1 ploopH_28_npg
    s_lshl_b32 s17, s12, 7
    s_add_u32 s17, s17, 218112000
    v_mov_b32 v9, s21
    s_mov_b64 exec, 1
    buffer_store_dword v9, off, s[4:7], s17 sc1
    s_mov_b64 exec, -1
ploopH_28_npg:
    s_barrier
    buffer_load_dword v60, off, s[4:7], s33 sc1
    s_add_u32 s16, s16, 1
    v_mov_b32 v59, s16
    s_add_u32 s41, s41, 262144
    s_add_u32 s31, s31, 262144
    s_mov_b32 s54, 0
    s_setprio 3
    s_sleep 13
ploopH_28_pagain:
    buffer_load_dwordx4 v[16:19], v1, s[4:7], s28 offen offset:0 sc1
    buffer_load_dwordx4 v[20:23], v1, s[4:7], s28 offen offset:1024 sc1
    s_waitcnt vmcnt(1)
    v_mfma_f32_16x16x32_bf16 v[32:35], v[12:15], v[16:19], 0
    s_waitcnt vmcnt(0)
    v_mfma_f32_16x16x32_bf16 v[32:35], v[48:51], v[20:23], v[32:35]
    v_max_u32 v9, v16, v20
    v_cmp_eq_u32 vcc, -1, v9
    s_cbranch_vccnz ploopH_28_rp
ploopH_28_pgo:
    s_nop 4
    v_add_f32_dpp v36, v32, v32 row_ror:8 row_mask:0xf bank_mask:0xf
    v_add_f32_dpp v37, v33, v33 row_ror:8 row_mask:0xf bank_mask:0xf
    v_add_f32_dpp v38, v34, v34 row_ror:8 row_mask:0xf bank_mask:0xf
    v_add_f32_dpp v39, v35, v35 row_ror:8 row_mask:0xf bank_mask:0xf
    v_cvt_pk_bf16_f32 v52, v36, v37
    v_cvt_pk_bf16_f32 v53, v38, v39
    s_nop 0
    v_permlane16_swap_b32 v52, v54
    v_permlane16_swap_b32 v53, v55
    s_mov_b64 exec, s[56:57]
    v_min_u32 v52, -2, v52
    buffer_store_dwordx4 v[52:55], v5, s[4:7], s24 offen sc1
    s_mov_b64 exec, -1
    ds_write_b32 v63, v59 offset:16
    s_branch ploopH_28
ploopH_28_rm_0:
    s_sub_u32 s22, s22, 1
    s_cbranch_scc1 ploopH_28_rm_0_g
    buffer_load_dwordx4 v[16:19], v1, s[4:7], s23 offen offset:0 sc1
    buffer_load_dwordx4 v[20:23], v1, s[4:7], s23 offen offset:1024 sc1
    buffer_load_dwordx4 v[24:27], v1, s[4:7], s23 offen offset:2048 sc1
    buffer_load_dwordx4 v[28:31], v1, s[4:7], s23 offen offset:3072 sc1
    s_waitcnt vmcnt(3)
    v_cmp_eq_u32 vcc, -1, v16
    s_cbranch_vccnz ploopH_28_rm_0
    s_branch ploopH_28_rm_0ok
ploopH_28_rm_0_g:
    s_mov_b32 s22, 0
    s_waitcnt vmcnt(0)
    s_branch ploopH_28_rm_0ok
ploopH_28_rm_1:
    s_sub_u32 s22, s22, 1
    s_cbranch_scc1 ploopH_28_rm_1_g
    buffer_load_dwordx4 v[20:23], v1, s[4:7], s23 offen offset:1024 sc1
    buffer_load_dwordx4 v[24:27], v1, s[4:7], s23 offen offset:2048 sc1
    buffer_load_dwordx4 v[28:31], v1, s[4:7], s23 offen offset:3072 sc1
    s_waitcnt vmcnt(2)
    v_cmp_eq_u32 vcc, -1, v20
    s_cbranch_vccnz ploopH_28_rm_1
    s_branch ploopH_28_rm_1ok
ploopH_28_rm_1_g:
    s_mov_b32 s22, 0
    s_waitcnt vmcnt(0)
    s_branch ploopH_28_rm_1ok
ploopH_28_rm_2:
    s_sub_u32 s22, s22, 1
    s_cbranch_scc1 ploopH_28_rm_2_g
    buffer_load_dwordx4 v[24:27], v1, s[4:7], s23 offen offset:2048 sc1
    buffer_load_dwordx4 v[28:31], v1, s[4:7], s23 offen offset:3072 sc1
    s_waitcnt vmcnt(1)
    v_cmp_eq_u32 vcc, -1, v24
    s_cbranch_vccnz ploopH_28_rm_2
    s_branch ploopH_28_rm_2ok
ploopH_28_rm_2_g:
    s_mov_b32 s22, 0
    s_waitcnt vmcnt(0)
    s_branch ploopH_28_rm_2ok
ploopH_28_rm_3:
    s_sub_u32 s22, s22, 1
    s_cbranch_scc1 ploopH_28_rm_3_g
    buffer_load_dwordx4 v[28:31], v1, s[4:7], s23 offen offset:3072 sc1
    s_waitcnt vmcnt(0)
    v_cmp_eq_u32 vcc, -1, v28
    s_cbranch_vccnz ploopH_28_rm_3
    s_branch ploopH_28_rm_3ok
ploopH_28_rm_3_g:
    s_mov_b32 s22, 0
    s_waitcnt vmcnt(0)
    s_branch ploopH_28_rm_3ok
ploopH_28_rp:
    s_sub_u32 s22, s22, 1
    s_cbranch_scc0 ploopH_28_pagain
    s_mov_b32 s22, 0
    s_branch ploopH_28_pgo
ploopH_28_tail:
    ds_read_b128 v[16:19], v6 offset:0
    ds_read_b128 v[20:23], v6 offset:256
    ds_read_b128 v[24:27], v6 offset:512
    ds_read_b128 v[28:31], v6 offset:768
    v_xor_b32 v6, 0x4000, v6
    s_waitcnt lgkmcnt(2)
    v_mfma_f32_16x16x32_bf16 v[40:43], v[12:15], v[16:19], 0
    v_mfma_f32_16x16x32_bf16 v[40:43], v[48:51], v[20:23], v[40:43]
    s_waitcnt lgkmcnt(0)
    v_mfma_f32_16x16x32_bf16 v[44:47], v[12:15], v[24:27], 0
    v_mfma_f32_16x16x32_bf16 v[44:47], v[48:51], v[28:31], v[44:47]
    s_nop 7
    v_cvt_pk_bf16_f32 v40, v40, v41
    v_cvt_pk_bf16_f32 v41, v42, v43
    v_cvt_pk_bf16_f32 v42, v44, v45
    v_cvt_pk_bf16_f32 v43, v46, v47
    s_nop 1
    v_permlane16_swap_b32 v40, v42
    v_permlane16_swap_b32 v41, v43
    s_nop 1
    v_min_u32 v40, -2, v40
    buffer_store_dwordx4 v[40:43], v7, s[4:7], s30 offen sc1
    s_add_u32 s30, s30, 65536
    s_barrier
    ds_read_b128 v[16:19], v6 offset:0
    ds_read_b128 v[20:23], v6 offset:256
    ds_read_b128 v[24:27], v6 offset:512
    ds_read_b128 v[28:31], v6 offset:768
    v_xor_b32 v6, 0x4000, v6
    s_waitcnt lgkmcnt(2)
    v_mfma_f32_16x16x32_bf16 v[40:43], v[12:15], v[16:19], 0
    v_mfma_f32_16x16x32_bf16 v[40:43], v[48:51], v[20:23], v[40:43]
    s_waitcnt lgkmcnt(0)
    v_mfma_f32_16x16x32_bf16 v[44:47], v[12:15], v[24:27], 0
    v_mfma_f32_16x16x32_bf16 v[44:47], v[48:51], v[28:31], v[44:47]
    s_nop 7
    v_cvt_pk_bf16_f32 v40, v40, v41
    v_cvt_pk_bf16_f32 v41, v42, v43
    v_cvt_pk_bf16_f32 v42, v44, v45
    v_cvt_pk_bf16_f32 v43, v46, v47
    s_nop 1
    v_permlane16_swap_b32 v40, v42
    v_permlane16_swap_b32 v41, v43
    s_nop 1
    v_min_u32 v40, -2, v40
    buffer_store_dwordx4 v[40:43], v7, s[4:7], s30 offen sc1
    s_add_u32 s30, s30, 65536
    s_branch k_end
ch_a_pro:
    s_sub_u32 s21, s3, 4
    s_lshl_b32 s15, s14, 2
    s_add_u32 s15, s15, s21
    s_lshl_b32 s38, s15, 13
    s_add_u32 s38, s38, 214958080
    s_min_u32 s20, s21, 2
    s_lshl_b32 s18, s20, 3
    s_add_u32 s18, s18, 16
    s_load_dwordx2 s[8:9], s[0:1], s18
    s_mov_b32 s10, 8388608
    s_mov_b32 s11, 131072
    v_and_b32 v20, 63, v0
    v_lshlrev_b32 v21, 13, v20
    s_lshl_b32 s17, s34, 19
    s_lshl_b32 s18, s14, 10
    s_add_u32 s17, s17, s18
    s_waitcnt lgkmcnt(0)
    buffer_load_dword v26, v21, s[8:11], s17 offen offset:384
    v_and_b32 v20, 63, v0
    v_lshrrev_b32 v21, 4, v20
    v_bfe_u32 v22, v20, 1, 1
    v_xor_b32 v22, 1, v22
    v_lshl_add_u32 v23, v22, 2, v21
    v_bfe_u32 v22, v20, 2, 2
    v_and_b32 v24, 1, v20
    v_lshl_add_u32 v22, v22, 1, v24
    v_lshl_add_u32 v23, v23, 3, v22
    v_and_b32 v22, 7, v20
    v_lshlrev_b32 v23, 4, v23
    s_lshl_b32 s17, s21, 10
    s_add_u32 s17, s17, 16384
    v_add_u32 v160, s17, v23
    v_and_b32 v24, 15, v20
    v_lshlrev_b32 v24, 4, v24
    v_lshl_add_u32 v23, v21, 10, v24
    s_lshl_b32 s17, s21, 8
    s_add_u32 s17, s17, 16384
    v_add_u32 v161, s17, v23
    v_lshl_add_u32 v23, v21, 9, v24
    s_lshl_b32 s17, s21, 12
    s_add_u32 s17, s17, 32768
    v_add_u32 v162, s17, v23
    v_bfe_u32 v23, v20, 3, 1
    v_lshlrev_b32 v23, 10, v23
    v_lshl_add_u32 v23, v22, 4, v23
    v_mov_b32 v1, v23
    s_lshl_b32 s39, s34, 14
    s_lshl_b32 s17, s21, 11
    s_add_u32 s39, s39, s17
    s_lshl_b32 s17, s14, 7
    s_add_u32 s39, s39, s17
    s_add_u32 s39, s39, 209715200
    v_mov_b32 v176, -1
    v_mov_b32 v177, -1
    v_mov_b32 v178, -1
    v_mov_b32 v179, -1
    v_lshlrev_b32 v24, 4, v0
    s_lshl_b32 s17, s52, 13
    s_add_u32 s19, s17, 209711104
    s_add_u32 s17, s17, 214953984
    s_lshl_b32 s18, s52, 12
    s_add_u32 s18, s18, 213905408
    buffer_store_dwordx4 v[176:179], v24, s[4:7], s19 offen sc1
    s_add_u32 s19, s19, 4096
    buffer_store_dwordx4 v[176:179], v24, s[4:7], s19 offen sc1
    buffer_store_dwordx4 v[176:179], v24, s[4:7], s17 offen sc1
    s_add_u32 s17, s17, 4096
    buffer_store_dwordx4 v[176:179], v24, s[4:7], s17 offen sc1
    buffer_store_dwordx4 v[176:179], v24, s[4:7], s18 offen sc1
    s_and_b32 s17, s13, 7
    s_sub_u32 s18, s21, 1
    s_cmp_lt_u32 s18, 2
    s_cselect_b32 s54, s17, 1
    s_lshr_b32 s19, s52, 3
    s_lshl_b32 s19, s19, 8
    s_lshl_b32 s18, s18, 7
    s_add_u32 s19, s19, s18
    s_add_u32 s55, s19, 210763776
    s_cmp_lg_u32 s54, 0
    s_cbranch_scc1 ch_nv0
    v_lshlrev_b32 v24, 13, v20
    s_mov_b64 exec, 0xffff
    buffer_store_dword v176, v24, s[4:7], s55 offen sc1
    s_mov_b64 exec, -1
ch_nv0:
    v_mov_b32 v2, s40
    s_lshl_b32 s17, s12, 2
    s_add_u32 s17, s17, 128
    s_waitcnt vmcnt(0)
    s_barrier
    s_cmp_lg_u32 s3, 4
    s_cbranch_scc1 ch_nox
    s_mov_b64 exec, 1
    buffer_atomic_add v2, off, s[64:67], s17 sc1
    s_mov_b64 exec, -1
ch_nox:
    v_and_b32 v20, 63, v0
    v_lshlrev_b32 v0, 4, v20
    s_lshl_b32 s17, s15, 18
    s_lshl_b32 s18, s34, 7
    s_add_u32 s17, s17, s18
    s_lshl_b32 s19, s21, 13
    s_add_u32 s19, s19, 131072
    s_load_dwordx2 s[8:9], s[0:1], 40
    s_mov_b32 s10, 8388608
    s_mov_b32 s11, 131072
    v_lshrrev_b32 v21, 3, v20
    v_and_b32 v22, 7, v20
    v_lshlrev_b32 v21, 11, v21
    v_lshl_add_u32 v21, v22, 4, v21
    v_lshrrev_b32 v28, 4, v20
    v_and_b32 v29, 1, v28
    v_xor_b32 v29, 0, v29
    v_lshlrev_b32 v29, 2, v29
    v_lshl_add_u32 v29, v28, 3, v29
    v_bfe_u32 v28, v20, 2, 2
    v_add_u32 v29, v29, v28
    v_lshlrev_b32 v29, 7, v29
    v_and_b32 v28, 3, v20
    v_lshl_add_u32 v29, v28, 4, v29
    v_and_b32 v28, 1, v28
    v_xor_b32 v28, 0, v28
    v_lshl_add_u32 v24, v28, 3, v29
    v_add_u32 v24, s19, v24
    v_lshrrev_b32 v28, 4, v20
    v_and_b32 v29, 1, v28
    v_xor_b32 v29, 1, v29
    v_lshlrev_b32 v29, 2, v29
    v_lshl_add_u32 v29, v28, 3, v29
    v_bfe_u32 v28, v20, 2, 2
    v_add_u32 v29, v29, v28
    v_lshlrev_b32 v29, 7, v29
    v_and_b32 v28, 3, v20
    v_lshl_add_u32 v29, v28, 4, v29
    v_and_b32 v28, 1, v28
    v_xor_b32 v28, 0, v28
    v_lshl_add_u32 v25, v28, 3, v29
    v_add_u32 v25, s19, v25
    v_lshrrev_b32 v28, 4, v20
    v_and_b32 v29, 1, v28
    v_xor_b32 v29, 0, v29
    v_lshlrev_b32 v29, 2, v29
    v_lshl_add_u32 v29, v28, 3, v29
    v_bfe_u32 v28, v20, 2, 2
    v_add_u32 v29, v29, v28
    v_lshlrev_b32 v29, 7, v29
    v_and_b32 v28, 3, v20
    v_lshl_add_u32 v29, v28, 4, v29
    v_and_b32 v28, 1, v28
    v_xor_b32 v28, 1, v28
    v_lshl_add_u32 v26, v28, 3, v29
    v_add_u32 v26, s19, v26
    v_lshrrev_b32 v28, 4, v20
    v_and_b32 v29, 1, v28
    v_xor_b32 v29, 1, v29
    v_lshlrev_b32 v29, 2, v29
    v_lshl_add_u32 v29, v28, 3, v29
    v_bfe_u32 v28, v20, 2, 2
    v_add_u32 v29, v29, v28
    v_lshlrev_b32 v29, 7, v29
    v_and_b32 v28, 3, v20
    v_lshl_add_u32 v29, v28, 4, v29
    v_and_b32 v28, 1, v28
    v_xor_b32 v28, 1, v28
    v_lshl_add_u32 v27, v28, 3, v29
    v_add_u32 v27, s19, v27
    s_waitcnt lgkmcnt(0)
    s_add_u32 m0, s19, 0
    s_nop 0
    buffer_load_dwordx4 v21, s[8:11], s17 offen lds
    s_add_u32 s17, s17, 16384
    s_add_u32 m0, s19, 1024
    s_nop 0
    buffer_load_dwordx4 v21, s[8:11], s17 offen lds
    s_add_u32 s17, s17, 16384
    s_add_u32 m0, s19, 2048
    s_nop 0
    buffer_load_dwordx4 v21, s[8:11], s17 offen lds
    s_add_u32 s17, s17, 16384
    s_add_u32 m0, s19, 3072
    s_nop 0
    buffer_load_dwordx4 v21, s[8:11], s17 offen lds
    s_add_u32 s17, s17, 16384
    s_add_u32 m0, s19, 4096
    s_nop 0
    buffer_load_dwordx4 v21, s[8:11], s17 offen lds
    s_add_u32 s17, s17, 16384
    s_add_u32 m0, s19, 5120
    s_nop 0
    buffer_load_dwordx4 v21, s[8:11], s17 offen lds
    s_add_u32 s17, s17, 16384
    s_add_u32 m0, s19, 6144
    s_nop 0
    buffer_load_dwordx4 v21, s[8:11], s17 offen lds
    s_add_u32 s17, s17, 16384
    s_add_u32 m0, s19, 7168
    s_nop 0
    buffer_load_dwordx4 v21, s[8:11], s17 offen lds
    s_add_u32 s17, s17, 16384
    buffer_load_dwordx4 v[96:99], v21, s[8:11], s17 offen
    s_add_u32 s17, s17, 16384
    buffer_load_dwordx4 v[100:103], v21, s[8:11], s17 offen
    s_add_u32 s17, s17, 16384
    buffer_load_dwordx4 v[104:107], v21, s[8:11], s17 offen
    s_add_u32 s17, s17, 16384
    buffer_load_dwordx4 v[108:111], v21, s[8:11], s17 offen
    s_add_u32 s17, s17, 16384
    buffer_load_dwordx4 v[112:115], v21, s[8:11], s17 offen
    s_add_u32 s17, s17, 16384
    buffer_load_dwordx4 v[116:119], v21, s[8:11], s17 offen
    s_add_u32 s17, s17, 16384
    buffer_load_dwordx4 v[120:123], v21, s[8:11], s17 offen
    s_add_u32 s17, s17, 16384
    buffer_load_dwordx4 v[124:127], v21, s[8:11], s17 offen
    s_add_u32 s17, s17, 16384
    s_cmp_lg_u32 s54, 0
    s_cbranch_scc1 ch_nv1
    s_mov_b32 s58, -1
    s_mov_b32 s59, -1
    s_memtime s[60:61]
    s_add_u32 s56, s55, 0
    s_waitcnt lgkmcnt(0)
    s_load_dword s57, s[4:5], s56 glc
    s_waitcnt lgkmcnt(0)
    s_memtime s[62:63]
    s_waitcnt lgkmcnt(0)
    s_sub_u32 s57, s62, s60
    s_min_u32 s58, s58, s57
    s_memtime s[60:61]
    s_add_u32 s56, s55, 8192
    s_waitcnt lgkmcnt(0)
    s_load_dword s57, s[4:5], s56 glc
    s_waitcnt lgkmcnt(0)
    s_memtime s[62:63]
    s_waitcnt lgkmcnt(0)
    s_sub_u32 s57, s62, s60
    s_min_u32 s59, s59, s57
    s_memtime s[60:61]
    s_add_u32 s56, s55, 16384
    s_waitcnt lgkmcnt(0)
    s_load_dword s57, s[4:5], s56 glc
    s_waitcnt lgkmcnt(0)
    s_memtime s[62:63]
    s_waitcnt lgkmcnt(0)
    s_sub_u32 s57, s62, s60
    s_min_u32 s58, s58, s57
    s_memtime s[60:61]
    s_add_u32 s56, s55, 24576
    s_waitcnt lgkmcnt(0)
    s_load_dword s57, s[4:5], s56 glc
    s_waitcnt lgkmcnt(0)
    s_memtime s[62:63]
    s_waitcnt lgkmcnt(0)
    s_sub_u32 s57, s62, s60
    s_min_u32 s59, s59, s57
    s_memtime s[60:61]
    s_add_u32 s56, s55, 32768
    s_waitcnt lgkmcnt(0)
    s_load_dword s57, s[4:5], s56 glc
    s_waitcnt lgkmcnt(0)
    s_memtime s[62:63]
    s_waitcnt lgkmcnt(0)
    s_sub_u32 s57, s62, s60
    s_min_u32 s58, s58, s57
    s_memtime s[60:61]
    s_add_u32 s56, s55, 40960
    s_waitcnt lgkmcnt(0)
    s_load_dword s57, s[4:5], s56 glc
    s_waitcnt lgkmcnt(0)
    s_memtime s[62:63]
    s_waitcnt lgkmcnt(0)
    s_sub_u32 s57, s62, s60
    s_min_u32 s59, s59, s57
    s_memtime s[60:61]
    s_add_u32 s56, s55, 49152
    s_waitcnt lgkmcnt(0)
    s_load_dword s57, s[4:5], s56 glc
    s_waitcnt lgkmcnt(0)
    s_memtime s[62:63]
    s_waitcnt lgkmcnt(0)
    s_sub_u32 s57, s62, s60
    s_min_u32 s58, s58, s57
    s_memtime s[60:61]
    s_add_u32 s56, s55, 57344
    s_waitcnt lgkmcnt(0)
    s_load_dword s57, s[4:5], s56 glc
    s_waitcnt lgkmcnt(0)
    s_memtime s[62:63]
    s_waitcnt lgkmcnt(0)
    s_sub_u32 s57, s62, s60
    s_min_u32 s59, s59, s57
    s_memtime s[60:61]
    s_add_u32 s56, s55, 65536
    s_waitcnt lgkmcnt(0)
    s_load_dword s57, s[4:5], s56 glc
    s_waitcnt lgkmcnt(0)
    s_memtime s[62:63]
    s_waitcnt lgkmcnt(0)
    s_sub_u32 s57, s62, s60
    s_min_u32 s58, s58, s57
    s_memtime s[60:61]
    s_add_u32 s56, s55, 73728
    s_waitcnt lgkmcnt(0)
    s_load_dword s57, s[4:5], s56 glc
    s_waitcnt lgkmcnt(0)
    s_memtime s[62:63]
    s_waitcnt lgkmcnt(0)
    s_sub_u32 s57, s62, s60
    s_min_u32 s59, s59, s57
    s_memtime s[60:61]
    s_add_u32 s56, s55, 81920
    s_waitcnt lgkmcnt(0)
    s_load_dword s57, s[4:5], s56 glc
    s_waitcnt lgkmcnt(0)
    s_memtime s[62:63]
    s_waitcnt lgkmcnt(0)
    s_sub_u32 s57, s62, s60
    s_min_u32 s58, s58, s57
    s_memtime s[60:61]
    s_add_u32 s56, s55, 90112
    s_waitcnt lgkmcnt(0)
    s_load_dword s57, s[4:5], s56 glc
    s_waitcnt lgkmcnt(0)
    s_memtime s[62:63]
    s_waitcnt lgkmcnt(0)
    s_sub_u32 s57, s62, s60
    s_min_u32 s59, s59, s57
    s_memtime s[60:61]
    s_add_u32 s56, s55, 98304
    s_waitcnt lgkmcnt(0)
    s_load_dword s57, s[4:5], s56 glc
    s_waitcnt lgkmcnt(0)
    s_memtime s[62:63]
    s_waitcnt lgkmcnt(0)
    s_sub_u32 s57, s62, s60
    s_min_u32 s58, s58, s57
    s_memtime s[60:61]
    s_add_u32 s56, s55, 106496
    s_waitcnt lgkmcnt(0)
    s_load_dword s57, s[4:5], s56 glc
    s_waitcnt lgkmcnt(0)
    s_memtime s[62:63]
    s_waitcnt lgkmcnt(0)
    s_sub_u32 s57, s62, s60
    s_min_u32 s59, s59, s57
    s_memtime s[60:61]
    s_add_u32 s56, s55, 114688
    s_waitcnt lgkmcnt(0)
    s_load_dword s57, s[4:5], s56 glc
    s_waitcnt lgkmcnt(0)
    s_memtime s[62:63]
    s_waitcnt lgkmcnt(0)
    s_sub_u32 s57, s62, s60
    s_min_u32 s58, s58, s57
    s_memtime s[60:61]
    s_add_u32 s56, s55, 122880
    s_waitcnt lgkmcnt(0)
    s_load_dword s57, s[4:5], s56 glc
    s_waitcnt lgkmcnt(0)
    s_memtime s[62:63]
    s_waitcnt lgkmcnt(0)
    s_sub_u32 s57, s62, s60
    s_min_u32 s59, s59, s57
    s_sub_i32 s57, s58, s59
    s_min_i32 s57, s57, 400
    s_max_i32 s57, s57, -400
    s_add_u32 s57, s57, 16777616
    s_getreg_b32 s56, hwreg(HW_REG_XCC_ID)
    s_and_b32 s56, s56, 0
    v_mov_b32 v2, s57
    s_mov_b64 exec, 1
    buffer_atomic_add v2, off, s[64:67], s56 offset:160 sc1
    s_mov_b64 exec, -1
    s_waitcnt vmcnt(0)
ch_nv1:
    s_lshl_b32 s19, s21, 13
    s_add_u32 s19, s19, 131072
    v_add_u32 v30, s19, v0
    s_waitcnt vmcnt(8)
    ds_read_b64_tr_b16 v[192:193], v24 offset:0
    ds_read_b64_tr_b16 v[194:195], v25 offset:0
    ds_read_b64_tr_b16 v[208:209], v26 offset:0
    ds_read_b64_tr_b16 v[210:211], v27 offset:0
    ds_read_b64_tr_b16 v[224:225], v24 offset:64
    ds_read_b64_tr_b16 v[226:227], v25 offset:64
    ds_read_b64_tr_b16 v[240:241], v26 offset:64
    ds_read_b64_tr_b16 v[242:243], v27 offset:64
    s_waitcnt lgkmcnt(0)
    ds_read_b64_tr_b16 v[196:197], v24 offset:4096
    ds_read_b64_tr_b16 v[198:199], v25 offset:4096
    ds_read_b64_tr_b16 v[212:213], v26 offset:4096
    ds_read_b64_tr_b16 v[214:215], v27 offset:4096
    ds_read_b64_tr_b16 v[228:229], v24 offset:4160
    ds_read_b64_tr_b16 v[230:231], v25 offset:4160
    ds_read_b64_tr_b16 v[244:245], v26 offset:4160
    ds_read_b64_tr_b16 v[246:247], v27 offset:4160
    s_waitcnt lgkmcnt(0)
    s_waitcnt vmcnt(0)
    ds_write_b128 v30, v[96:99] offset:0
    ds_write_b128 v30, v[100:103] offset:1024
    ds_write_b128 v30, v[104:107] offset:2048
    ds_write_b128 v30, v[108:111] offset:3072
    ds_write_b128 v30, v[112:115] offset:4096
    ds_write_b128 v30, v[116:119] offset:5120
    ds_write_b128 v30, v[120:123] offset:6144
    ds_write_b128 v30, v[124:127] offset:7168
    s_waitcnt lgkmcnt(0)
    ds_read_b64_tr_b16 v[200:201], v24 offset:0
    ds_read_b64_tr_b16 v[202:203], v25 offset:0
    ds_read_b64_tr_b16 v[216:217], v26 offset:0
    ds_read_b64_tr_b16 v[218:219], v27 offset:0
    ds_read_b64_tr_b16 v[232:233], v24 offset:64
    ds_read_b64_tr_b16 v[234:235], v25 offset:64
    ds_read_b64_tr_b16 v[248:249], v26 offset:64
    ds_read_b64_tr_b16 v[250:251], v27 offset:64
    s_waitcnt lgkmcnt(0)
    ds_read_b64_tr_b16 v[204:205], v24 offset:4096
    ds_read_b64_tr_b16 v[206:207], v25 offset:4096
    ds_read_b64_tr_b16 v[220:221], v26 offset:4096
    ds_read_b64_tr_b16 v[222:223], v27 offset:4096
    ds_read_b64_tr_b16 v[236:237], v24 offset:4160
    ds_read_b64_tr_b16 v[238:239], v25 offset:4160
    ds_read_b64_tr_b16 v[252:253], v26 offset:4160
    ds_read_b64_tr_b16 v[254:255], v27 offset:4160
    s_waitcnt lgkmcnt(0)
    v_lshrrev_b32 v21, 4, v20
    v_and_b32 v22, 2, v20
    v_cmp_eq_u32 s[56:57], 2, v22
    v_and_b32 v23, 15, v20
    v_lshlrev_b32 v21, 2, v21
    v_mov_b32 v8, 0x44444444
    v_mov_b32 v9, 0xeeeeeeee
    v_cndmask_b32 v166, v8, v9, s[56:57]
    v_mov_b32 v8, 0x3f803f80
    v_mov_b32 v9, 0
    v_mov_b32 v10, 0
    v_mov_b32 v11, 0
    v_mov_b32 v4, 0x3f803f80
    v_mov_b32 v5, 0x3f803f80
    v_mov_b32 v6, 0x3f803f80
    v_mov_b32 v7, 0x3f803f80
    s_mov_b32 s29, 0x3e0293ee
    s_lshl_b32 s27, s13, 2
    s_add_u32 s27, s27, s21
    s_lshl_b32 s28, s12, 7
    s_add_u32 s28, s28, 218112000
    v_add_u32 v163, s42, v0
    s_lshl_b32 s17, s21, 2
    s_add_u32 s17, s17, 15872
    v_mov_b32 v164, s17
    v_mov_b32 v167, 15872
    v_and_b32 v24, 15, v20
    v_and_b32 v25, 1, v24
    v_lshlrev_b32 v25, 4, v25
    v_mov_b32 v184, 0x3f80
    v_lshlrev_b32 v25, v25, v184
    v_lshrrev_b32 v24, 1, v24
    v_cmp_eq_u32 vcc, 0, v24
    s_nop 1
    v_cndmask_b32 v184, 0, v25, vcc
    v_cmp_eq_u32 vcc, 1, v24
    s_nop 1
    v_cndmask_b32 v185, 0, v25, vcc
    v_cmp_eq_u32 vcc, 2, v24
    s_nop 1
    v_cndmask_b32 v186, 0, v25, vcc
    v_cmp_eq_u32 vcc, 3, v24
    s_nop 1
    v_cndmask_b32 v187, 0, v25, vcc
    v_lshrrev_b32 v24, 4, v20
    v_bfe_u32 v25, v20, 2, 2
    v_and_b32 v26, 1, v20
    v_lshl_add_u32 v26, v25, 1, v26
    v_lshlrev_b32 v26, 4, v26
    v_lshl_add_u32 v26, v24, 8, v26
    v_bfe_u32 v27, v20, 1, 1
    v_lshl_add_u32 v26, v27, 2, v26
    s_add_u32 s17, s42, 20480
    v_add_u32 v180, s17, v26
    v_and_b32 v26, 3, v20
    v_lshl_add_u32 v27, v24, 2, v25
    v_lshl_add_u32 v27, v26, 4, v27
    v_lshlrev_b32 v27, 4, v27
    v_add_u32 v181, s42, v27
    v_and_b32 v25, 1, v25
    v_lshl_add_u32 v25, v24, 1, v25
    v_lshl_add_u32 v25, v26, 3, v25
    v_lshlrev_b32 v25, 4, v25
    v_add_u32 v182, s17, v25
    s_bfe_u32 s17, s34, 0x20001
    s_lshr_b32 s30, s34, 3
    s_cmp_eq_u32 s17, s21
    s_cselect_b32 s30, s30, 2
    s_and_b32 s33, s34, 1
    s_lshl_b32 s33, s33, 17
    s_mov_b32 s32, 0
    v_add_u32 v24, 0, v21
    v_cmp_gt_u32 s[44:45], v24, v23
    v_add_u32 v24, 1, v21
    v_cmp_gt_u32 s[46:47], v24, v23
    v_add_u32 v24, 2, v21
    v_cmp_gt_u32 s[48:49], v24, v23
    v_add_u32 v24, 3, v21
    v_cmp_gt_u32 s[50:51], v24, v23
    s_cmp_lg_u32 s3, 4
    s_cbranch_scc1 ch_xcc_skip
    v_lshrrev_b32 v56, 2, v0
    v_add_u32 v56, 128, v56
    v_writelane_b32 v56, 0, 10
    v_mov_b32 v59, 63
    v_mov_b32 v60, 32
    v_writelane_b32 v59, 0, 8
    v_writelane_b32 v60, 0, 8
    v_writelane_b32 v59, 0, 9
    v_writelane_b32 v60, 0, 9
    v_writelane_b32 v59, -1, 10
    s_movk_i32 s17, 128
    v_writelane_b32 v60, s17, 10
    s_mov_b64 exec, 0x70f
ch_xcc:
    buffer_load_dword v57, v56, s[64:67], 0 offen sc1
    s_waitcnt vmcnt(0)
    v_and_b32 v62, v59, v57
    v_cmp_ne_u32 vcc, v62, v60
    v_readlane_b32 s18, v57, 8
    v_readlane_b32 s19, v57, 9
    s_add_u32 s17, s18, s19
    s_lshr_b32 s17, s17, 24
    s_cmp_lg_u32 s17, 32
    s_cbranch_scc1 ch_xcc_w
    s_cbranch_vccz ch_xcc_ok
ch_xcc_w:
    s_sleep 16
    s_sub_u32 s22, s22, 1
    s_cbranch_scc0 ch_xcc
    s_mov_b32 s22, 0
ch_xcc_ok:
    s_getreg_b32 s17, hwreg(HW_REG_XCC_ID)
    s_bitcmp1_b32 s17, 2
    s_cselect_b32 s18, s18, s18
    v_readlane_b32 s17, v57, s12
    s_mov_b64 exec, -1
    s_lshr_b32 s19, s18, 24
    s_mul_i32 s19, s19, 400
    s_and_b32 s18, s18, 0xffffff
    s_cmp_gt_u32 s18, s19
    s_cselect_b32 s18, 8192, 0
    v_mov_b32 v58, 15968
    v_mov_b32 v60, s17
    v_mov_b32 v61, s18
    s_barrier
    ds_write_b64 v58, v[60:61]
    s_waitcnt lgkmcnt(0)
    s_branch ch_xcc_b3
ch_xcc_skip:
    s_barrier
ch_xcc_b3:
    s_barrier
    v_mov_b32 v58, 15968
    ds_read_b64 v[60:61], v58
    v_and_b32 v23, 7, v20
    v_lshlrev_b32 v23, 7, v23
    v_bfe_u32 v24, v20, 3, 1
    v_lshl_add_u32 v23, v24, 17, v23
    v_lshrrev_b32 v24, 4, v20
    v_lshl_add_u32 v23, v24, 24, v23
    s_lshl_b32 s19, s14, 14
    s_lshl_b32 s18, s34, 10
    s_add_u32 s19, s19, s18
    s_and_b32 s18, s21, 1
    s_lshl_b32 s18, s18, 18
    s_add_u32 s19, s19, s18
    s_add_u32 s19, s19, 4456448
    s_waitcnt lgkmcnt(0)
    v_readfirstlane_b32 s17, v61
    s_add_u32 s39, s39, s17
ch_g0:
    buffer_load_dword v57, off, s[4:7], s35 sc1
    s_waitcnt vmcnt(0)
    v_readfirstlane_b32 s17, v57
    s_cmp_ge_u32 s17, 8
    s_cbranch_scc1 ch_g0b
    s_sleep 3
    s_sub_u32 s22, s22, 1
    s_cbranch_scc0 ch_g0
    s_mov_b32 s22, 0
ch_g0b:
    s_add_u32 s23, s41, 37748736
    buffer_load_dwordx4 v[128:131], v0, s[4:7], s23 offen offset:0 sc1
    buffer_load_dwordx4 v[132:135], v0, s[4:7], s23 offen offset:1024 sc1
    buffer_load_dwordx4 v[136:139], v0, s[4:7], s23 offen offset:2048 sc1
    buffer_load_dwordx4 v[140:143], v0, s[4:7], s23 offen offset:3072 sc1
    s_add_u32 s24, s41, 37879808
    buffer_load_dwordx4 v[144:147], v0, s[4:7], s24 offen offset:0 sc1
    buffer_load_dwordx4 v[148:151], v0, s[4:7], s24 offen offset:1024 sc1
    buffer_load_dwordx4 v[152:155], v0, s[4:7], s24 offen offset:2048 sc1
    buffer_load_dwordx4 v[156:159], v0, s[4:7], s24 offen offset:3072 sc1
    s_add_u32 s23, s41, 20971520
    buffer_load_dwordx4 v[96:99], v0, s[4:7], s23 offen offset:0 sc1
    buffer_load_dwordx4 v[100:103], v0, s[4:7], s23 offen offset:1024 sc1
    buffer_load_dwordx4 v[104:107], v0, s[4:7], s23 offen offset:2048 sc1
    buffer_load_dwordx4 v[108:111], v0, s[4:7], s23 offen offset:3072 sc1
    s_add_u32 s24, s41, 21102592
    buffer_load_dwordx4 v[112:115], v0, s[4:7], s24 offen offset:0 sc1
    buffer_load_dwordx4 v[116:119], v0, s[4:7], s24 offen offset:1024 sc1
    buffer_load_dwordx4 v[120:123], v0, s[4:7], s24 offen offset:2048 sc1
    buffer_load_dwordx4 v[124:127], v0, s[4:7], s24 offen offset:3072 sc1
    s_mov_b32 exec_hi, 0xffff
    buffer_load_dword v175, v23, s[4:7], s19 offen sc1
    s_mov_b32 exec_hi, -1
    v_mov_b32 v165, 0
    s_waitcnt vmcnt(1)
    ds_write_b32 v164, v165 offset:16
.p2align 6
aloopL_39:
    s_and_b32 s23, s16, 3
    s_lshl_b32 s23, s23, 18
    s_add_u32 s23, s23, s38
    s_add_u32 s24, s23, 4096
    s_and_b32 s25, s16, 3
    s_lshl_b32 s25, s25, 18
    s_add_u32 s25, s25, s39
    s_add_u32 s26, s16, 2
    s_and_b32 s26, s26, 3
    s_lshl_b32 s26, s26, 18
    s_add_u32 s26, s26, s39
    v_mov_b32 v165, s16
    s_waitcnt vmcnt(8)
    s_and_b32 s31, s16, 1
    s_cmp_lt_u32 s16, 16
    s_cselect_b32 s31, 3, s31
    s_cmp_lg_u32 s31, s30
    s_cbranch_scc1 aloopL_39_nd0
    ds_write_b128 v163, v[128:131] offset:0
    ds_write_b128 v163, v[132:135] offset:1024
    ds_write_b128 v163, v[136:139] offset:2048
    ds_write_b128 v163, v[140:143] offset:3072
    ds_write_b128 v163, v[144:147] offset:4096
    ds_write_b128 v163, v[148:151] offset:5120
    ds_write_b128 v163, v[152:155] offset:6144
    ds_write_b128 v163, v[156:159] offset:7168
aloopL_39_nd0:
    v_mfma_f32_16x16x32_bf16 v[48:51], v[128:131], v[192:195], 0
    v_mfma_f32_16x16x32_bf16 v[52:55], v[128:131], v[208:211], 0
    v_mfma_f32_16x16x32_bf16 v[56:59], v[128:131], v[224:227], 0
    v_mfma_f32_16x16x32_bf16 v[60:63], v[128:131], v[240:243], 0
    v_mfma_f32_16x16x32_bf16 v[64:67], v[144:147], v[192:195], 0
    v_mfma_f32_16x16x32_bf16 v[68:71], v[144:147], v[208:211], 0
    v_mfma_f32_16x16x32_bf16 v[72:75], v[144:147], v[224:227], 0
    v_mfma_f32_16x16x32_bf16 v[76:79], v[144:147], v[240:243], 0
    v_mfma_f32_16x16x32_bf16 v[48:51], v[132:135], v[196:199], v[48:51]
    v_mfma_f32_16x16x32_bf16 v[52:55], v[132:135], v[212:215], v[52:55]
    v_mfma_f32_16x16x32_bf16 v[56:59], v[132:135], v[228:231], v[56:59]
    v_mfma_f32_16x16x32_bf16 v[60:63], v[132:135], v[244:247], v[60:63]
    v_mfma_f32_16x16x32_bf16 v[64:67], v[148:151], v[196:199], v[64:67]
    v_mfma_f32_16x16x32_bf16 v[68:71], v[148:151], v[212:215], v[68:71]
    v_mfma_f32_16x16x32_bf16 v[72:75], v[148:151], v[228:231], v[72:75]
    v_mfma_f32_16x16x32_bf16 v[76:79], v[148:151], v[244:247], v[76:79]
    v_mfma_f32_16x16x32_bf16 v[48:51], v[136:139], v[200:203], v[48:51]
    v_mfma_f32_16x16x32_bf16 v[52:55], v[136:139], v[216:219], v[52:55]
    v_mfma_f32_16x16x32_bf16 v[56:59], v[136:139], v[232:235], v[56:59]
    v_mfma_f32_16x16x32_bf16 v[60:63], v[136:139], v[248:251], v[60:63]
    v_mfma_f32_16x16x32_bf16 v[64:67], v[152:155], v[200:203], v[64:67]
    v_mfma_f32_16x16x32_bf16 v[68:71], v[152:155], v[216:219], v[68:71]
    v_mfma_f32_16x16x32_bf16 v[72:75], v[152:155], v[232:235], v[72:75]
    v_mfma_f32_16x16x32_bf16 v[76:79], v[152:155], v[248:251], v[76:79]
    v_mfma_f32_16x16x32_bf16 v[48:51], v[140:143], v[204:207], v[48:51]
    v_mfma_f32_16x16x32_bf16 v[52:55], v[140:143], v[220:223], v[52:55]
    v_mfma_f32_16x16x32_bf16 v[56:59], v[140:143], v[236:239], v[56:59]
    v_mfma_f32_16x16x32_bf16 v[60:63], v[140:143], v[252:255], v[60:63]
    v_mfma_f32_16x16x32_bf16 v[64:67], v[156:159], v[204:207], v[64:67]
    v_mfma_f32_16x16x32_bf16 v[68:71], v[156:159], v[220:223], v[68:71]
    v_mfma_f32_16x16x32_bf16 v[72:75], v[156:159], v[236:239], v[72:75]
    v_mfma_f32_16x16x32_bf16 v[76:79], v[156:159], v[252:255], v[76:79]
    s_nop 2
    v_cvt_pk_bf16_f32 v80, v48, v49
    v_cvt_pk_bf16_f32 v81, v50, v51
    v_cvt_pk_bf16_f32 v82, v64, v65
    v_cvt_pk_bf16_f32 v83, v66, v67
    v_cvt_pk_bf16_f32 v84, v52, v53
    v_cvt_pk_bf16_f32 v85, v54, v55
    v_cvt_pk_bf16_f32 v86, v68, v69
    v_cvt_pk_bf16_f32 v87, v70, v71
    v_cvt_pk_bf16_f32 v88, v56, v57
    v_cvt_pk_bf16_f32 v89, v58, v59
    v_cvt_pk_bf16_f32 v90, v72, v73
    v_cvt_pk_bf16_f32 v91, v74, v75
    v_cvt_pk_bf16_f32 v92, v60, v61
    v_cvt_pk_bf16_f32 v93, v62, v63
    v_cvt_pk_bf16_f32 v94, v76, v77
    v_cvt_pk_bf16_f32 v95, v78, v79
    v_mov_b32 v24, 0
    v_mov_b32 v25, 0
    v_mov_b32 v26, 0
    v_mov_b32 v27, 0
    v_mov_b32 v28, 0
    v_mov_b32 v29, 0
    v_mov_b32 v30, 0
    v_mov_b32 v31, 0
    v_mov_b32 v32, 0
    v_mov_b32 v33, 0
    v_mov_b32 v34, 0
    v_mov_b32 v35, 0
    v_mov_b32 v36, 0
    v_mov_b32 v37, 0
    v_mov_b32 v38, 0
    v_mov_b32 v39, 0
    s_setprio 2
    s_cmp_lg_u32 s31, s30
    s_cbranch_scc1 aloopL_39_nd1
    s_add_u32 m0, s42, 16384
    s_add_u32 s17, s41, s33
    s_add_u32 s17, s17, 4194304
    buffer_load_dwordx4 v0, s[4:7], s17 offen offset:0 sc1 lds
    buffer_load_dwordx4 v0, s[4:7], s17 offen offset:1024 sc1 lds
    buffer_load_dwordx4 v0, s[4:7], s17 offen offset:2048 sc1 lds
    buffer_load_dwordx4 v0, s[4:7], s17 offen offset:3072 sc1 lds
aloopL_39_nd1:
    s_add_u32 s41, s41, 262144
    s_waitcnt lgkmcnt(0)
    s_barrier
    s_sleep 9
    s_waitcnt lgkmcnt(0)
    buffer_load_dwordx4 v[48:51], v0, s[4:7], s23 offen offset:0 sc1
    buffer_load_dwordx4 v[52:55], v0, s[4:7], s23 offen offset:1024 sc1
    buffer_load_dwordx4 v[56:59], v0, s[4:7], s23 offen offset:2048 sc1
    buffer_load_dwordx4 v[60:63], v0, s[4:7], s23 offen offset:3072 sc1
    s_sleep 2
    buffer_load_dwordx4 v[64:67], v0, s[4:7], s24 offen offset:0 sc1
    buffer_load_dwordx4 v[68:71], v0, s[4:7], s24 offen offset:1024 sc1
    s_waitcnt vmcnt(5)
    v_mfma_f32_16x16x32_bf16 v[12:15], v[96:99], v[48:51], 0
    v_mfma_f32_16x16x32_bf16 v[16:19], v[112:115], v[48:51], 0
    v_max_u32 v3, v48, v50
    v_cmp_eq_u32 vcc, -1, v3
    v_mfma_f32_16x16x32_bf16 v[20:23], v[48:51], v[48:51], 0
    s_cbranch_vccnz aloopL_39_rq_0
    s_waitcnt vmcnt(4)
    v_mfma_f32_16x16x32_bf16 v[12:15], v[100:103], v[52:55], v[12:15]
    v_mfma_f32_16x16x32_bf16 v[16:19], v[116:119], v[52:55], v[16:19]
    v_max_u32 v3, v52, v54
    v_cmp_eq_u32 vcc, -1, v3
    v_mfma_f32_16x16x32_bf16 v[20:23], v[52:55], v[52:55], v[20:23]
    s_cbranch_vccnz aloopL_39_rq_1
    s_waitcnt vmcnt(3)
    v_mfma_f32_16x16x32_bf16 v[12:15], v[104:107], v[56:59], v[12:15]
    v_mfma_f32_16x16x32_bf16 v[16:19], v[120:123], v[56:59], v[16:19]
    v_max_u32 v3, v56, v58
    v_cmp_eq_u32 vcc, -1, v3
    v_mfma_f32_16x16x32_bf16 v[20:23], v[56:59], v[56:59], v[20:23]
    s_cbranch_vccnz aloopL_39_rq_2
    s_waitcnt vmcnt(2)
    v_mfma_f32_16x16x32_bf16 v[12:15], v[108:111], v[60:63], v[12:15]
    v_mfma_f32_16x16x32_bf16 v[16:19], v[124:127], v[60:63], v[16:19]
    v_max_u32 v3, v60, v62
    v_cmp_eq_u32 vcc, -1, v3
    v_mfma_f32_16x16x32_bf16 v[20:23], v[60:63], v[60:63], v[20:23]
    s_cbranch_vccnz aloopL_39_rq_3
aloopL_39_sdone:
    s_nop 1
    ds_write_b32 v164, v165
    s_nop 0
    v_max3_f32 v2, v12, v13, v14
    v_max3_f32 v3, v15, v16, v17
    v_max3_f32 v2, v2, v18, v19
    v_max3_f32 v3, v3, v20, v21
    v_max_f32 v2, v2, v3
    v_mov_b32 v3, v2
    s_nop 1
    v_permlane16_swap_b32 v3, v2
    v_max_f32 v2, v2, v3
    v_mov_b32 v3, v2
    s_waitcnt vmcnt(0)
    v_max3_u32 v188, v64, v66, v68
    v_permlane32_swap_b32 v3, v2
    v_max_f32 v2, v2, v3
    v_max_u32 v188, v188, v70
    v_mul_f32 v2, s29, v2
    v_cmp_eq_u32 vcc, -1, v188
    v_fma_f32 v12, v12, s29, -v2
    v_fma_f32 v13, v13, s29, -v2
    s_cbranch_vccnz aloopL_39_rq_v
aloopL_39_vok:
    v_smfmac_f32_16x16x64_bf16 v[24:27], v[64:67], v[192:199], v166
    v_fma_f32 v14, v14, s29, -v2
    v_exp_f32 v12, v12
    v_smfmac_f32_16x16x64_bf16 v[32:35], v[64:67], v[224:231], v166
    s_add_u32 s17, s41, 37748736
    buffer_load_dwordx4 v[128:131], v0, s[4:7], s17 offen offset:0 sc1
    v_fma_f32 v15, v15, s29, -v2
    v_exp_f32 v13, v13
    v_smfmac_f32_16x16x64_bf16 v[28:31], v[64:67], v[208:215], v166
    buffer_load_dwordx4 v[132:135], v0, s[4:7], s17 offen offset:1024 sc1
    v_fma_f32 v16, v16, s29, -v2
    v_exp_f32 v14, v14
    v_smfmac_f32_16x16x64_bf16 v[36:39], v[64:67], v[240:247], v166
    buffer_load_dwordx4 v[136:139], v0, s[4:7], s17 offen offset:2048 sc1
    v_fma_f32 v17, v17, s29, -v2
    v_exp_f32 v15, v15
    v_smfmac_f32_16x16x64_bf16 v[24:27], v[68:71], v[200:207], v166
    buffer_load_dwordx4 v[140:143], v0, s[4:7], s17 offen offset:3072 sc1
    v_fma_f32 v18, v18, s29, -v2
    v_exp_f32 v16, v16
    v_smfmac_f32_16x16x64_bf16 v[32:35], v[68:71], v[232:239], v166
    s_add_u32 s18, s41, 37879808
    buffer_load_dwordx4 v[144:147], v0, s[4:7], s18 offen offset:0 sc1
    v_fma_f32 v19, v19, s29, -v2
    v_exp_f32 v17, v17
    v_smfmac_f32_16x16x64_bf16 v[28:31], v[68:71], v[216:223], v166
    buffer_load_dwordx4 v[148:151], v0, s[4:7], s18 offen offset:1024 sc1
    v_fma_f32 v20, v20, s29, -v2
    v_exp_f32 v18, v18
    v_smfmac_f32_16x16x64_bf16 v[36:39], v[68:71], v[248:255], v166
    buffer_load_dwordx4 v[152:155], v0, s[4:7], s18 offen offset:2048 sc1
    v_fma_f32 v21, v21, s29, -v2
    v_exp_f32 v19, v19
    buffer_load_dwordx4 v[156:159], v0, s[4:7], s18 offen offset:3072 sc1
    v_exp_f32 v20, v20
    v_exp_f32 v21, v21
    v_cvt_pk_bf16_f32 v12, v12, v13
    v_cvt_pk_bf16_f32 v13, v14, v15
    v_cvt_pk_bf16_f32 v14, v16, v17
    v_cvt_pk_bf16_f32 v15, v18, v19
    v_cvt_pk_bf16_f32 v20, v20, v21
    v_mov_b32 v22, 0
    v_mfma_f32_16x16x32_bf16 v[16:19], v[4:7], v[12:15], 0
    v_mov_b32 v21, v20
    v_mov_b32 v23, 0
    v_cvt_pk_bf16_f32 v40, v24, v25
    v_cvt_pk_bf16_f32 v41, v26, v27
    v_mfma_f32_16x16x32_bf16 v[16:19], v[8:11], v[20:23], v[16:19]
    v_mfma_f32_16x16x32_bf16 v[24:27], v[80:83], v[12:15], 0
    v_cvt_pk_bf16_f32 v44, v32, v33
    v_cvt_pk_bf16_f32 v45, v34, v35
    v_mfma_f32_16x16x32_bf16 v[32:35], v[88:91], v[12:15], 0
    v_cvt_pk_bf16_f32 v42, v28, v29
    v_cvt_pk_bf16_f32 v43, v30, v31
    v_mfma_f32_16x16x32_bf16 v[28:31], v[84:87], v[12:15], 0
    v_cvt_pk_bf16_f32 v46, v36, v37
    v_cvt_pk_bf16_f32 v47, v38, v39
    v_mfma_f32_16x16x32_bf16 v[36:39], v[92:95], v[12:15], 0
aloopL_39_midE:
    s_mov_b64 vcc, s[56:57]
    v_rcp_f32 v3, v16
    v_mfma_f32_16x16x32_bf16 v[24:27], v[40:43], v[20:23], v[24:27]
    v_mfma_f32_16x16x32_bf16 v[32:35], v[44:47], v[20:23], v[32:35]
    v_mfma_f32_16x16x32_bf16 v[28:31], v[42:45], v[20:23], v[28:31]
    v_mfma_f32_16x16x32_bf16 v[36:39], v[46:49], v[20:23], v[36:39]
    v_mov_b32_dpp v3, v3 quad_perm:[2,3,2,3] row_mask:0xf bank_mask:0xf
    s_nop 4
    v_cndmask_b32_dpp v24, v32, v24, vcc quad_perm:[2,3,2,3] row_mask:0xf bank_mask:0xf
    v_cndmask_b32_dpp v25, v33, v25, vcc quad_perm:[2,3,2,3] row_mask:0xf bank_mask:0xf
    v_cndmask_b32_dpp v26, v34, v26, vcc quad_perm:[2,3,2,3] row_mask:0xf bank_mask:0xf
    v_cndmask_b32_dpp v27, v35, v27, vcc quad_perm:[2,3,2,3] row_mask:0xf bank_mask:0xf
    v_cndmask_b32_dpp v28, v36, v28, vcc quad_perm:[2,3,2,3] row_mask:0xf bank_mask:0xf
    v_cndmask_b32_dpp v29, v37, v29, vcc quad_perm:[2,3,2,3] row_mask:0xf bank_mask:0xf
    v_cndmask_b32_dpp v30, v38, v30, vcc quad_perm:[2,3,2,3] row_mask:0xf bank_mask:0xf
    v_cndmask_b32_dpp v31, v39, v31, vcc quad_perm:[2,3,2,3] row_mask:0xf bank_mask:0xf
    v_mul_f32 v24, v24, v3
    v_mul_f32 v25, v25, v3
    v_mul_f32 v26, v26, v3
    v_mul_f32 v27, v27, v3
    v_mul_f32 v28, v28, v3
    v_mul_f32 v29, v29, v3
    v_mul_f32 v30, v30, v3
    v_mul_f32 v31, v31, v3
    v_cvt_pk_bf16_f32 v168, v24, v25
    v_cvt_pk_bf16_f32 v169, v26, v27
    v_cvt_pk_bf16_f32 v170, v28, v29
    v_cvt_pk_bf16_f32 v171, v30, v31
    ds_write_b128 v160, v[168:171]
    s_waitcnt lgkmcnt(0)
    s_barrier
    ds_read_b128 v[172:175], v161
    s_waitcnt lgkmcnt(0)
    v_mfma_f32_16x16x32_bf16 v[24:27], v[184:187], v[172:175], 0
    s_nop 7
    v_cvt_pk_bf16_f32 v168, v24, v25
    v_cvt_pk_bf16_f32 v169, v26, v27
    s_nop 0
    v_permlane16_swap_b32 v168, v170
    v_permlane16_swap_b32 v169, v171
    s_mov_b64 exec, 0xffff
    v_min_u32 v168, -2, v168
    buffer_store_dwordx4 v[168:171], v1, s[4:7], s25 offen sc1
    s_setprio 0
    buffer_store_dwordx4 v[176:179], v1, s[4:7], s26 offen sc1
    s_mov_b64 exec, -1
    s_branch pg_40
    s_cmp_lg_u32 s27, 0
    s_cbranch_scc1 pg_40
    s_sub_u32 s21, s16, 1
    s_cbranch_scc1 pg_40
    s_and_b32 s17, s21, 3
    s_cmp_ge_u32 s16, 58
    s_cselect_b32 s17, 0, s17
    s_cmp_lg_u32 s17, 0
    s_cbranch_scc1 pg_40
    v_mov_b32 v3, s21
    s_mov_b64 exec, 1
    buffer_store_dword v3, off, s[4:7], s28 sc1
    s_mov_b64 exec, -1
pg_40:
    s_cmp_lg_u32 s31, s30
    s_cbranch_scc1 aloopL_39_nd2
    ds_read_b128 v[24:27], v163 offset:16384
    ds_read_b128 v[28:31], v163 offset:17408
    ds_read_b128 v[32:35], v163 offset:18432
    ds_read_b128 v[36:39], v163 offset:19456
    ds_write_b32 v180, v64 offset:0
    ds_write_b32 v180, v65 offset:8
    ds_write_b32 v180, v66 offset:128
    ds_write_b32 v180, v67 offset:136
    ds_write_b32 v180, v68 offset:1024
    ds_write_b32 v180, v69 offset:1032
    ds_write_b32 v180, v70 offset:1152
    ds_write_b32 v180, v71 offset:1160
    s_mov_b32 s32, 1
    s_waitcnt lgkmcnt(11)
    v_mfma_f32_16x16x32_bf16 v[12:15], v[96:99], v[24:27], 0
    v_mfma_f32_16x16x32_bf16 v[16:19], v[112:115], v[24:27], 0
    v_mfma_f32_16x16x32_bf16 v[20:23], v[48:51], v[24:27], 0
    s_waitcnt lgkmcnt(10)
    v_mfma_f32_16x16x32_bf16 v[12:15], v[100:103], v[28:31], v[12:15]
    v_mfma_f32_16x16x32_bf16 v[16:19], v[116:119], v[28:31], v[16:19]
    v_mfma_f32_16x16x32_bf16 v[20:23], v[52:55], v[28:31], v[20:23]
    s_waitcnt lgkmcnt(9)
    v_mfma_f32_16x16x32_bf16 v[12:15], v[104:107], v[32:35], v[12:15]
    v_mfma_f32_16x16x32_bf16 v[16:19], v[120:123], v[32:35], v[16:19]
    v_mfma_f32_16x16x32_bf16 v[20:23], v[56:59], v[32:35], v[20:23]
    s_waitcnt lgkmcnt(8)
    v_mfma_f32_16x16x32_bf16 v[12:15], v[108:111], v[36:39], v[12:15]
    v_mfma_f32_16x16x32_bf16 v[16:19], v[124:127], v[36:39], v[16:19]
    v_mfma_f32_16x16x32_bf16 v[20:23], v[60:63], v[36:39], v[20:23]
    s_waitcnt lgkmcnt(0)
    s_nop 3
    s_nop 3
    s_cmp_eq_u32 s32, 0
    s_cbranch_scc1 aloopL_39_p2e
    s_mov_b32 s32, 0
    ds_read_b64_tr_b16 v[96:97], v181 offset:0
    ds_read_b64_tr_b16 v[98:99], v181 offset:4096
    ds_read_b64_tr_b16 v[64:65], v182 offset:0
    ds_read_b64_tr_b16 v[100:101], v181 offset:8
    ds_read_b64_tr_b16 v[102:103], v181 offset:4104
    ds_read_b64_tr_b16 v[66:67], v182 offset:8
    ds_read_b64_tr_b16 v[104:105], v181 offset:1024
    ds_read_b64_tr_b16 v[106:107], v181 offset:5120
    ds_read_b64_tr_b16 v[68:69], v182 offset:512
    ds_read_b64_tr_b16 v[108:109], v181 offset:1032
    ds_read_b64_tr_b16 v[110:111], v181 offset:5128
    ds_read_b64_tr_b16 v[70:71], v182 offset:520
    ds_read_b64_tr_b16 v[112:113], v181 offset:2048
    ds_read_b64_tr_b16 v[114:115], v181 offset:6144
    ds_read_b64_tr_b16 v[72:73], v182 offset:1024
    ds_read_b64_tr_b16 v[116:117], v181 offset:2056
    ds_read_b64_tr_b16 v[118:119], v181 offset:6152
    ds_read_b64_tr_b16 v[74:75], v182 offset:1032
    ds_read_b64_tr_b16 v[120:121], v181 offset:3072
    ds_read_b64_tr_b16 v[122:123], v181 offset:7168
    ds_read_b64_tr_b16 v[76:77], v182 offset:1536
    ds_read_b64_tr_b16 v[124:125], v181 offset:3080
    ds_read_b64_tr_b16 v[126:127], v181 offset:7176
    ds_read_b64_tr_b16 v[78:79], v182 offset:1544
    v_mov_b32 v188, 0xff61b1e6
    s_cmp_eq_u32 s33, 0
    s_cselect_b64 vcc, s[44:45], 0
    v_cndmask_b32 v12, v12, v188, vcc
    s_cselect_b64 vcc, -1, s[44:45]
    v_cndmask_b32 v16, v16, v188, vcc
    s_cselect_b64 vcc, s[46:47], 0
    v_cndmask_b32 v13, v13, v188, vcc
    s_cselect_b64 vcc, -1, s[46:47]
    v_cndmask_b32 v17, v17, v188, vcc
    s_cselect_b64 vcc, s[48:49], 0
    v_cndmask_b32 v14, v14, v188, vcc
    s_cselect_b64 vcc, -1, s[48:49]
    v_cndmask_b32 v18, v18, v188, vcc
    s_cselect_b64 vcc, s[50:51], 0
    v_cndmask_b32 v15, v15, v188, vcc
    s_cselect_b64 vcc, -1, s[50:51]
    v_cndmask_b32 v19, v19, v188, vcc
    v_max3_f32 v2, v12, v13, v14
    v_max3_f32 v3, v15, v16, v17
    v_max3_f32 v2, v2, v18, v19
    v_max3_f32 v3, v3, v20, v21
    v_max_f32 v2, v2, v3
    v_mov_b32 v3, v2
    s_nop 1
    v_permlane16_swap_b32 v3, v2
    v_max_f32 v2, v2, v3
    v_mov_b32 v3, v2
    s_nop 1
    v_permlane32_swap_b32 v3, v2
    v_max_f32 v2, v2, v3
    v_mul_f32 v2, s29, v2
    v_fma_f32 v12, v12, s29, -v2
    v_fma_f32 v13, v13, s29, -v2
    v_fma_f32 v14, v14, s29, -v2
    v_exp_f32 v12, v12
    v_fma_f32 v15, v15, s29, -v2
    v_exp_f32 v13, v13
    v_fma_f32 v16, v16, s29, -v2
    v_exp_f32 v14, v14
    v_fma_f32 v17, v17, s29, -v2
    v_exp_f32 v15, v15
    v_fma_f32 v18, v18, s29, -v2
    v_exp_f32 v16, v16
    v_fma_f32 v19, v19, s29, -v2
    v_exp_f32 v17, v17
    v_fma_f32 v20, v20, s29, -v2
    v_exp_f32 v18, v18
    v_fma_f32 v21, v21, s29, -v2
    v_exp_f32 v19, v19
    v_exp_f32 v20, v20
    v_exp_f32 v21, v21
    v_cvt_pk_bf16_f32 v12, v12, v13
    v_cvt_pk_bf16_f32 v13, v14, v15
    v_cvt_pk_bf16_f32 v14, v16, v17
    v_cvt_pk_bf16_f32 v15, v18, v19
    v_cvt_pk_bf16_f32 v20, v20, v21
    v_mov_b32 v22, 0
    v_mov_b32 v21, 0
    v_mov_b32 v23, 0
    s_waitcnt lgkmcnt(0)
    s_nop 0
    v_mfma_f32_16x16x32_bf16 v[16:19], v[4:7], v[12:15], 0
    v_mfma_f32_16x16x32_bf16 v[16:19], v[4:7], v[20:23], v[16:19]
    v_mfma_f32_16x16x32_bf16 v[24:27], v[96:99], v[12:15], 0
    v_mfma_f32_16x16x32_bf16 v[24:27], v[64:67], v[20:23], v[24:27]
    v_mfma_f32_16x16x32_bf16 v[28:31], v[100:103], v[12:15], 0
    v_mfma_f32_16x16x32_bf16 v[28:31], v[66:69], v[20:23], v[28:31]
    v_mfma_f32_16x16x32_bf16 v[32:35], v[104:107], v[12:15], 0
    v_mfma_f32_16x16x32_bf16 v[32:35], v[68:71], v[20:23], v[32:35]
    v_mfma_f32_16x16x32_bf16 v[36:39], v[108:111], v[12:15], 0
    v_mfma_f32_16x16x32_bf16 v[36:39], v[70:73], v[20:23], v[36:39]
    v_mfma_f32_16x16x32_bf16 v[48:51], v[112:115], v[12:15], 0
    v_mfma_f32_16x16x32_bf16 v[48:51], v[72:75], v[20:23], v[48:51]
    v_mfma_f32_16x16x32_bf16 v[52:55], v[116:119], v[12:15], 0
    v_mfma_f32_16x16x32_bf16 v[52:55], v[74:77], v[20:23], v[52:55]
    v_mfma_f32_16x16x32_bf16 v[56:59], v[120:123], v[12:15], 0
    v_mfma_f32_16x16x32_bf16 v[56:59], v[76:79], v[20:23], v[56:59]
    v_mfma_f32_16x16x32_bf16 v[60:63], v[124:127], v[12:15], 0
    v_mfma_f32_16x16x32_bf16 v[60:63], v[78:81], v[20:23], v[60:63]
    v_rcp_f32 v3, v16
    s_nop 0
    v_mul_f32 v24, v24, v3
    v_mul_f32 v25, v25, v3
    v_mul_f32 v26, v26, v3
    v_mul_f32 v27, v27, v3
    v_mul_f32 v28, v28, v3
    v_mul_f32 v29, v29, v3
    v_mul_f32 v30, v30, v3
    v_mul_f32 v31, v31, v3
    v_cvt_pk_bf16_f32 v24, v24, v25
    v_cvt_pk_bf16_f32 v25, v26, v27
    v_cvt_pk_bf16_f32 v26, v28, v29
    v_cvt_pk_bf16_f32 v27, v30, v31
    ds_write_b128 v0, v[24:27] offset:32768
    v_mul_f32 v32, v32, v3
    v_mul_f32 v33, v33, v3
    v_mul_f32 v34, v34, v3
    v_mul_f32 v35, v35, v3
    v_mul_f32 v36, v36, v3
    v_mul_f32 v37, v37, v3
    v_mul_f32 v38, v38, v3
    v_mul_f32 v39, v39, v3
    v_cvt_pk_bf16_f32 v32, v32, v33
    v_cvt_pk_bf16_f32 v33, v34, v35
    v_cvt_pk_bf16_f32 v34, v36, v37
    v_cvt_pk_bf16_f32 v35, v38, v39
    ds_write_b128 v0, v[32:35] offset:33792
    v_mul_f32 v48, v48, v3
    v_mul_f32 v49, v49, v3
    v_mul_f32 v50, v50, v3
    v_mul_f32 v51, v51, v3
    v_mul_f32 v52, v52, v3
    v_mul_f32 v53, v53, v3
    v_mul_f32 v54, v54, v3
    v_mul_f32 v55, v55, v3
    v_cvt_pk_bf16_f32 v48, v48, v49
    v_cvt_pk_bf16_f32 v49, v50, v51
    v_cvt_pk_bf16_f32 v50, v52, v53
    v_cvt_pk_bf16_f32 v51, v54, v55
    ds_write_b128 v0, v[48:51] offset:34816
    v_mul_f32 v56, v56, v3
    v_mul_f32 v57, v57, v3
    v_mul_f32 v58, v58, v3
    v_mul_f32 v59, v59, v3
    v_mul_f32 v60, v60, v3
    v_mul_f32 v61, v61, v3
    v_mul_f32 v62, v62, v3
    v_mul_f32 v63, v63, v3
    v_cvt_pk_bf16_f32 v56, v56, v57
    v_cvt_pk_bf16_f32 v57, v58, v59
    v_cvt_pk_bf16_f32 v58, v60, v61
    v_cvt_pk_bf16_f32 v59, v62, v63
    ds_write_b128 v0, v[56:59] offset:35840
aloopL_39_p2e:
    s_nop 3
aloopL_39_nd2:
    s_add_u32 s19, s41, 20971520
    buffer_load_dwordx4 v[96:99], v0, s[4:7], s19 offen offset:0 sc1
    buffer_load_dwordx4 v[100:103], v0, s[4:7], s19 offen offset:1024 sc1
    buffer_load_dwordx4 v[104:107], v0, s[4:7], s19 offen offset:2048 sc1
    buffer_load_dwordx4 v[108:111], v0, s[4:7], s19 offen offset:3072 sc1
    s_add_u32 s20, s41, 21102592
    buffer_load_dwordx4 v[112:115], v0, s[4:7], s20 offen offset:0 sc1
    buffer_load_dwordx4 v[116:119], v0, s[4:7], s20 offen offset:1024 sc1
    buffer_load_dwordx4 v[120:123], v0, s[4:7], s20 offen offset:2048 sc1
    buffer_load_dwordx4 v[124:127], v0, s[4:7], s20 offen offset:3072 sc1
    s_add_u32 s16, s16, 1
    s_cmp_lt_u32 s16, 48
    s_cbranch_scc1 aloopL_39
    s_waitcnt vmcnt(0)
    ds_write_b128 v163, v[128:131] offset:8192
    ds_write_b128 v163, v[132:135] offset:9216
    ds_write_b128 v163, v[136:139] offset:10240
    ds_write_b128 v163, v[140:143] offset:11264
    ds_write_b128 v163, v[144:147] offset:12288
    ds_write_b128 v163, v[148:151] offset:13312
    ds_write_b128 v163, v[152:155] offset:14336
    ds_write_b128 v163, v[156:159] offset:15360
    s_waitcnt lgkmcnt(0)
    s_branch aloopH_38
aloopL_39_rq_0:
    s_sub_u32 s22, s22, 1
    s_cbranch_scc1 aloopL_39_rq_0_g
    buffer_load_dwordx4 v[48:51], v0, s[4:7], s23 offen offset:0 sc1
    buffer_load_dwordx4 v[52:55], v0, s[4:7], s23 offen offset:1024 sc1
    buffer_load_dwordx4 v[56:59], v0, s[4:7], s23 offen offset:2048 sc1
    buffer_load_dwordx4 v[60:63], v0, s[4:7], s23 offen offset:3072 sc1
    buffer_load_dwordx4 v[64:67], v0, s[4:7], s24 offen offset:0 sc1
    buffer_load_dwordx4 v[68:71], v0, s[4:7], s24 offen offset:1024 sc1
    s_waitcnt vmcnt(5)
    v_max_u32 v3, v48, v50
    v_cmp_eq_u32 vcc, -1, v3
    s_cbranch_vccnz aloopL_39_rq_0
    s_branch aloopL_39_again
aloopL_39_rq_0_g:
    s_mov_b32 s22, 0
    s_waitcnt vmcnt(0)
    s_branch aloopL_39_nochk
aloopL_39_rq_1:
    s_sub_u32 s22, s22, 1
    s_cbranch_scc1 aloopL_39_rq_1_g
    buffer_load_dwordx4 v[52:55], v0, s[4:7], s23 offen offset:1024 sc1
    buffer_load_dwordx4 v[56:59], v0, s[4:7], s23 offen offset:2048 sc1
    buffer_load_dwordx4 v[60:63], v0, s[4:7], s23 offen offset:3072 sc1
    buffer_load_dwordx4 v[64:67], v0, s[4:7], s24 offen offset:0 sc1
    buffer_load_dwordx4 v[68:71], v0, s[4:7], s24 offen offset:1024 sc1
    s_waitcnt vmcnt(4)
    v_max_u32 v3, v52, v54
    v_cmp_eq_u32 vcc, -1, v3
    s_cbranch_vccnz aloopL_39_rq_1
    s_branch aloopL_39_again
aloopL_39_rq_1_g:
    s_mov_b32 s22, 0
    s_waitcnt vmcnt(0)
    s_branch aloopL_39_nochk
aloopL_39_rq_2:
    s_sub_u32 s22, s22, 1
    s_cbranch_scc1 aloopL_39_rq_2_g
    buffer_load_dwordx4 v[56:59], v0, s[4:7], s23 offen offset:2048 sc1
    buffer_load_dwordx4 v[60:63], v0, s[4:7], s23 offen offset:3072 sc1
    buffer_load_dwordx4 v[64:67], v0, s[4:7], s24 offen offset:0 sc1
    buffer_load_dwordx4 v[68:71], v0, s[4:7], s24 offen offset:1024 sc1
    s_waitcnt vmcnt(3)
    v_max_u32 v3, v56, v58
    v_cmp_eq_u32 vcc, -1, v3
    s_cbranch_vccnz aloopL_39_rq_2
    s_branch aloopL_39_again
aloopL_39_rq_2_g:
    s_mov_b32 s22, 0
    s_waitcnt vmcnt(0)
    s_branch aloopL_39_nochk
aloopL_39_rq_3:
    s_sub_u32 s22, s22, 1
    s_cbranch_scc1 aloopL_39_rq_3_g
    buffer_load_dwordx4 v[60:63], v0, s[4:7], s23 offen offset:3072 sc1
    buffer_load_dwordx4 v[64:67], v0, s[4:7], s24 offen offset:0 sc1
    buffer_load_dwordx4 v[68:71], v0, s[4:7], s24 offen offset:1024 sc1
    s_waitcnt vmcnt(2)
    v_max_u32 v3, v60, v62
    v_cmp_eq_u32 vcc, -1, v3
    s_cbranch_vccnz aloopL_39_rq_3
    s_branch aloopL_39_again
aloopL_39_rq_3_g:
    s_mov_b32 s22, 0
    s_waitcnt vmcnt(0)
    s_branch aloopL_39_nochk
aloopL_39_again:
    s_waitcnt vmcnt(5)
    v_mfma_f32_16x16x32_bf16 v[12:15], v[96:99], v[48:51], 0
    v_mfma_f32_16x16x32_bf16 v[16:19], v[112:115], v[48:51], 0
    v_max_u32 v3, v48, v50
    v_cmp_eq_u32 vcc, -1, v3
    v_mfma_f32_16x16x32_bf16 v[20:23], v[48:51], v[48:51], 0
    s_cbranch_vccnz aloopL_39_rq_0
    s_waitcnt vmcnt(4)
    v_mfma_f32_16x16x32_bf16 v[12:15], v[100:103], v[52:55], v[12:15]
    v_mfma_f32_16x16x32_bf16 v[16:19], v[116:119], v[52:55], v[16:19]
    v_max_u32 v3, v52, v54
    v_cmp_eq_u32 vcc, -1, v3
    v_mfma_f32_16x16x32_bf16 v[20:23], v[52:55], v[52:55], v[20:23]
    s_cbranch_vccnz aloopL_39_rq_1
    s_waitcnt vmcnt(3)
    v_mfma_f32_16x16x32_bf16 v[12:15], v[104:107], v[56:59], v[12:15]
    v_mfma_f32_16x16x32_bf16 v[16:19], v[120:123], v[56:59], v[16:19]
    v_max_u32 v3, v56, v58
    v_cmp_eq_u32 vcc, -1, v3
    v_mfma_f32_16x16x32_bf16 v[20:23], v[56:59], v[56:59], v[20:23]
    s_cbranch_vccnz aloopL_39_rq_2
    s_waitcnt vmcnt(2)
    v_mfma_f32_16x16x32_bf16 v[12:15], v[108:111], v[60:63], v[12:15]
    v_mfma_f32_16x16x32_bf16 v[16:19], v[124:127], v[60:63], v[16:19]
    v_max_u32 v3, v60, v62
    v_cmp_eq_u32 vcc, -1, v3
    v_mfma_f32_16x16x32_bf16 v[20:23], v[60:63], v[60:63], v[20:23]
    s_cbranch_vccnz aloopL_39_rq_3
    s_branch aloopL_39_sdone
aloopL_39_rq_v:
    s_sub_u32 s22, s22, 1
    s_cbranch_scc1 aloopL_39_rq_vg
    buffer_load_dwordx4 v[64:67], v0, s[4:7], s24 offen offset:0 sc1
    buffer_load_dwordx4 v[68:71], v0, s[4:7], s24 offen offset:1024 sc1
    s_waitcnt vmcnt(0)
    v_max3_u32 v188, v64, v66, v68
    v_max_u32 v188, v188, v70
    v_cmp_eq_u32 vcc, -1, v188
    s_cbranch_vccnz aloopL_39_rq_v
    s_branch aloopL_39_vok
aloopL_39_rq_vg:
    s_mov_b32 s22, 0
    s_branch aloopL_39_vok
aloopL_39_nochk:
    v_mfma_f32_16x16x32_bf16 v[12:15], v[96:99], v[48:51], 0
    v_mfma_f32_16x16x32_bf16 v[16:19], v[112:115], v[48:51], 0
    v_mfma_f32_16x16x32_bf16 v[20:23], v[48:51], v[48:51], 0
    v_mfma_f32_16x16x32_bf16 v[12:15], v[100:103], v[52:55], v[12:15]
    v_mfma_f32_16x16x32_bf16 v[16:19], v[116:119], v[52:55], v[16:19]
    v_mfma_f32_16x16x32_bf16 v[20:23], v[52:55], v[52:55], v[20:23]
    v_mfma_f32_16x16x32_bf16 v[12:15], v[104:107], v[56:59], v[12:15]
    v_mfma_f32_16x16x32_bf16 v[16:19], v[120:123], v[56:59], v[16:19]
    v_mfma_f32_16x16x32_bf16 v[20:23], v[56:59], v[56:59], v[20:23]
    v_mfma_f32_16x16x32_bf16 v[12:15], v[108:111], v[60:63], v[12:15]
    v_mfma_f32_16x16x32_bf16 v[16:19], v[124:127], v[60:63], v[16:19]
    v_mfma_f32_16x16x32_bf16 v[20:23], v[60:63], v[60:63], v[20:23]
    s_nop 1
    s_branch aloopL_39_sdone
ct_aH:
.p2align 6
aloopH_38:
    s_and_b32 s23, s16, 3
    s_lshl_b32 s23, s23, 18
    s_add_u32 s23, s23, s38
    s_add_u32 s24, s23, 4096
    s_and_b32 s25, s16, 3
    s_lshl_b32 s25, s25, 18
    s_add_u32 s25, s25, s39
    s_add_u32 s26, s16, 2
    s_and_b32 s26, s26, 3
    s_lshl_b32 s26, s26, 18
    s_add_u32 s26, s26, s39
    v_mov_b32 v165, s16
aloopH_38_wkv:
    ds_read_b32 v188, v164 offset:16
    s_waitcnt lgkmcnt(0)
    v_readfirstlane_b32 s19, v188
    s_cmp_ge_i32 s19, s16
    s_cbranch_scc1 aloopH_38_wkvok
    s_sleep 1
    s_branch aloopH_38_wkv
aloopH_38_wkvok:
    ds_read_b128 v[128:131], v163 offset:8192
    ds_read_b128 v[144:147], v163 offset:12288
    ds_read_b128 v[132:135], v163 offset:9216
    ds_read_b128 v[148:151], v163 offset:13312
    ds_read_b128 v[136:139], v163 offset:10240
    ds_read_b128 v[152:155], v163 offset:14336
    ds_read_b128 v[140:143], v163 offset:11264
    ds_read_b128 v[156:159], v163 offset:15360
    s_waitcnt lgkmcnt(6)
    v_mfma_f32_16x16x32_bf16 v[48:51], v[128:131], v[192:195], 0
    v_mfma_f32_16x16x32_bf16 v[52:55], v[128:131], v[208:211], 0
    v_mfma_f32_16x16x32_bf16 v[56:59], v[128:131], v[224:227], 0
    v_mfma_f32_16x16x32_bf16 v[60:63], v[128:131], v[240:243], 0
    v_mfma_f32_16x16x32_bf16 v[64:67], v[144:147], v[192:195], 0
    v_mfma_f32_16x16x32_bf16 v[68:71], v[144:147], v[208:211], 0
    v_mfma_f32_16x16x32_bf16 v[72:75], v[144:147], v[224:227], 0
    v_mfma_f32_16x16x32_bf16 v[76:79], v[144:147], v[240:243], 0
    s_setprio 2
aloopH_38_wm:
    ds_read_b32 v188, v164 offset:32
    s_waitcnt lgkmcnt(0)
    v_readfirstlane_b32 s19, v188
    s_cmp_ge_i32 s19, s16
    s_cbranch_scc1 aloopH_38_wmok
    s_sleep 1
    s_branch aloopH_38_wm
aloopH_38_wmok:
    s_add_u32 m0, s42, 16384
    s_add_u32 s17, s41, 4194304
    buffer_load_dwordx4 v0, s[4:7], s17 offen offset:0 sc1 lds
    buffer_load_dwordx4 v0, s[4:7], s17 offen offset:1024 sc1 lds
    buffer_load_dwordx4 v0, s[4:7], s17 offen offset:2048 sc1 lds
    buffer_load_dwordx4 v0, s[4:7], s17 offen offset:3072 sc1 lds
    s_add_u32 m0, s42, 20480
    s_add_u32 s17, s41, 4325376
    buffer_load_dwordx4 v0, s[4:7], s17 offen offset:0 sc1 lds
    buffer_load_dwordx4 v0, s[4:7], s17 offen offset:1024 sc1 lds
    buffer_load_dwordx4 v0, s[4:7], s17 offen offset:2048 sc1 lds
    buffer_load_dwordx4 v0, s[4:7], s17 offen offset:3072 sc1 lds
    s_add_u32 s41, s41, 262144
    s_barrier
    s_waitcnt lgkmcnt(4)
    v_mfma_f32_16x16x32_bf16 v[48:51], v[132:135], v[196:199], v[48:51]
    v_mfma_f32_16x16x32_bf16 v[52:55], v[132:135], v[212:215], v[52:55]
    v_mfma_f32_16x16x32_bf16 v[56:59], v[132:135], v[228:231], v[56:59]
    v_mfma_f32_16x16x32_bf16 v[60:63], v[132:135], v[244:247], v[60:63]
    v_mfma_f32_16x16x32_bf16 v[64:67], v[148:151], v[196:199], v[64:67]
    v_mfma_f32_16x16x32_bf16 v[68:71], v[148:151], v[212:215], v[68:71]
    v_mfma_f32_16x16x32_bf16 v[72:75], v[148:151], v[228:231], v[72:75]
    v_mfma_f32_16x16x32_bf16 v[76:79], v[148:151], v[244:247], v[76:79]
    s_waitcnt lgkmcnt(2)
    v_mfma_f32_16x16x32_bf16 v[48:51], v[136:139], v[200:203], v[48:51]
    v_mfma_f32_16x16x32_bf16 v[52:55], v[136:139], v[216:219], v[52:55]
    v_mfma_f32_16x16x32_bf16 v[56:59], v[136:139], v[232:235], v[56:59]
    v_mfma_f32_16x16x32_bf16 v[60:63], v[136:139], v[248:251], v[60:63]
    v_mfma_f32_16x16x32_bf16 v[64:67], v[152:155], v[200:203], v[64:67]
    v_mfma_f32_16x16x32_bf16 v[68:71], v[152:155], v[216:219], v[68:71]
    v_mfma_f32_16x16x32_bf16 v[72:75], v[152:155], v[232:235], v[72:75]
    v_mfma_f32_16x16x32_bf16 v[76:79], v[152:155], v[248:251], v[76:79]
    s_waitcnt lgkmcnt(0)
    v_mfma_f32_16x16x32_bf16 v[48:51], v[140:143], v[204:207], v[48:51]
    v_mfma_f32_16x16x32_bf16 v[52:55], v[140:143], v[220:223], v[52:55]
    v_mfma_f32_16x16x32_bf16 v[56:59], v[140:143], v[236:239], v[56:59]
    v_mfma_f32_16x16x32_bf16 v[60:63], v[140:143], v[252:255], v[60:63]
    v_mfma_f32_16x16x32_bf16 v[64:67], v[156:159], v[204:207], v[64:67]
    v_mfma_f32_16x16x32_bf16 v[68:71], v[156:159], v[220:223], v[68:71]
    v_mfma_f32_16x16x32_bf16 v[72:75], v[156:159], v[236:239], v[72:75]
    v_mfma_f32_16x16x32_bf16 v[76:79], v[156:159], v[252:255], v[76:79]
    s_nop 2
    v_cvt_pk_bf16_f32 v80, v48, v49
    v_cvt_pk_bf16_f32 v81, v50, v51
    v_cvt_pk_bf16_f32 v82, v64, v65
    v_cvt_pk_bf16_f32 v83, v66, v67
    v_cvt_pk_bf16_f32 v84, v52, v53
    v_cvt_pk_bf16_f32 v85, v54, v55
    v_cvt_pk_bf16_f32 v86, v68, v69
    v_cvt_pk_bf16_f32 v87, v70, v71
    v_cvt_pk_bf16_f32 v88, v56, v57
    v_cvt_pk_bf16_f32 v89, v58, v59
    v_cvt_pk_bf16_f32 v90, v72, v73
    v_cvt_pk_bf16_f32 v91, v74, v75
    v_cvt_pk_bf16_f32 v92, v60, v61
    v_cvt_pk_bf16_f32 v93, v62, v63
    v_cvt_pk_bf16_f32 v94, v76, v77
    v_cvt_pk_bf16_f32 v95, v78, v79
    v_mov_b32 v24, 0
    v_mov_b32 v25, 0
    v_mov_b32 v26, 0
    v_mov_b32 v27, 0
    v_mov_b32 v28, 0
    v_mov_b32 v29, 0
    v_mov_b32 v30, 0
    v_mov_b32 v31, 0
    v_mov_b32 v32, 0
    v_mov_b32 v33, 0
    v_mov_b32 v34, 0
    v_mov_b32 v35, 0
    v_mov_b32 v36, 0
    v_mov_b32 v37, 0
    v_mov_b32 v38, 0
    v_mov_b32 v39, 0
    s_waitcnt lgkmcnt(0)
    buffer_load_dwordx4 v[48:51], v0, s[4:7], s23 offen offset:0 sc1
    buffer_load_dwordx4 v[52:55], v0, s[4:7], s23 offen offset:1024 sc1
    buffer_load_dwordx4 v[56:59], v0, s[4:7], s23 offen offset:2048 sc1
    buffer_load_dwordx4 v[60:63], v0, s[4:7], s23 offen offset:3072 sc1
    s_sleep 2
    buffer_load_dwordx4 v[64:67], v0, s[4:7], s24 offen offset:0 sc1
    buffer_load_dwordx4 v[68:71], v0, s[4:7], s24 offen offset:1024 sc1
    s_waitcnt vmcnt(5)
    v_mfma_f32_16x16x32_bf16 v[12:15], v[96:99], v[48:51], 0
    v_mfma_f32_16x16x32_bf16 v[16:19], v[112:115], v[48:51], 0
    v_max_u32 v3, v48, v50
    v_cmp_eq_u32 vcc, -1, v3
    v_mfma_f32_16x16x32_bf16 v[20:23], v[48:51], v[48:51], 0
    s_cbranch_vccnz aloopH_38_rq_0
    s_waitcnt vmcnt(4)
    v_mfma_f32_16x16x32_bf16 v[12:15], v[100:103], v[52:55], v[12:15]
    v_mfma_f32_16x16x32_bf16 v[16:19], v[116:119], v[52:55], v[16:19]
    v_max_u32 v3, v52, v54
    v_cmp_eq_u32 vcc, -1, v3
    v_mfma_f32_16x16x32_bf16 v[20:23], v[52:55], v[52:55], v[20:23]
    s_cbranch_vccnz aloopH_38_rq_1
    s_waitcnt vmcnt(3)
    v_mfma_f32_16x16x32_bf16 v[12:15], v[104:107], v[56:59], v[12:15]
    v_mfma_f32_16x16x32_bf16 v[16:19], v[120:123], v[56:59], v[16:19]
    v_max_u32 v3, v56, v58
    v_cmp_eq_u32 vcc, -1, v3
    v_mfma_f32_16x16x32_bf16 v[20:23], v[56:59], v[56:59], v[20:23]
    s_cbranch_vccnz aloopH_38_rq_2
    s_waitcnt vmcnt(2)
    v_mfma_f32_16x16x32_bf16 v[12:15], v[108:111], v[60:63], v[12:15]
    v_mfma_f32_16x16x32_bf16 v[16:19], v[124:127], v[60:63], v[16:19]
    v_max_u32 v3, v60, v62
    v_cmp_eq_u32 vcc, -1, v3
    v_mfma_f32_16x16x32_bf16 v[20:23], v[60:63], v[60:63], v[20:23]
    s_cbranch_vccnz aloopH_38_rq_3
aloopH_38_sdone:
    s_cmp_eq_u32 s16, 63
    s_cbranch_scc1 aloopH_38_lsk
    ds_write_b32 v164, v165
    s_nop 0
    v_max3_f32 v2, v12, v13, v14
    v_max3_f32 v3, v15, v16, v17
    v_max3_f32 v2, v2, v18, v19
    v_max3_f32 v3, v3, v20, v21
    v_max_f32 v2, v2, v3
    v_mov_b32 v3, v2
    s_nop 1
    v_permlane16_swap_b32 v3, v2
    v_max_f32 v2, v2, v3
    v_mov_b32 v3, v2
    s_waitcnt vmcnt(0)
    v_max3_u32 v188, v64, v66, v68
    v_permlane32_swap_b32 v3, v2
    v_max_f32 v2, v2, v3
    v_max_u32 v188, v188, v70
    v_mul_f32 v2, s29, v2
    v_cmp_eq_u32 vcc, -1, v188
    v_fma_f32 v12, v12, s29, -v2
    v_fma_f32 v13, v13, s29, -v2
    s_cbranch_vccnz aloopH_38_rq_v
aloopH_38_vok:
    v_smfmac_f32_16x16x64_bf16 v[24:27], v[64:67], v[192:199], v166
    v_fma_f32 v14, v14, s29, -v2
    v_exp_f32 v12, v12
    v_smfmac_f32_16x16x64_bf16 v[32:35], v[64:67], v[224:231], v166
    v_fma_f32 v15, v15, s29, -v2
    v_exp_f32 v13, v13
    v_smfmac_f32_16x16x64_bf16 v[28:31], v[64:67], v[208:215], v166
    v_fma_f32 v16, v16, s29, -v2
    v_exp_f32 v14, v14
    v_smfmac_f32_16x16x64_bf16 v[36:39], v[64:67], v[240:247], v166
    v_fma_f32 v17, v17, s29, -v2
    v_exp_f32 v15, v15
    v_smfmac_f32_16x16x64_bf16 v[24:27], v[68:71], v[200:207], v166
    v_fma_f32 v18, v18, s29, -v2
    v_exp_f32 v16, v16
    v_smfmac_f32_16x16x64_bf16 v[32:35], v[68:71], v[232:239], v166
    v_fma_f32 v19, v19, s29, -v2
    v_exp_f32 v17, v17
    v_smfmac_f32_16x16x64_bf16 v[28:31], v[68:71], v[216:223], v166
    v_fma_f32 v20, v20, s29, -v2
    v_exp_f32 v18, v18
    v_smfmac_f32_16x16x64_bf16 v[36:39], v[68:71], v[248:255], v166
    v_fma_f32 v21, v21, s29, -v2
    v_exp_f32 v19, v19
    v_exp_f32 v20, v20
    v_exp_f32 v21, v21
    v_cvt_pk_bf16_f32 v12, v12, v13
    v_cvt_pk_bf16_f32 v13, v14, v15
    v_cvt_pk_bf16_f32 v14, v16, v17
    v_cvt_pk_bf16_f32 v15, v18, v19
    v_cvt_pk_bf16_f32 v20, v20, v21
    v_mov_b32 v22, 0
    v_mfma_f32_16x16x32_bf16 v[16:19], v[4:7], v[12:15], 0
    v_mov_b32 v21, v20
    v_mov_b32 v23, 0
    v_cvt_pk_bf16_f32 v40, v24, v25
    v_cvt_pk_bf16_f32 v41, v26, v27
    v_mfma_f32_16x16x32_bf16 v[16:19], v[8:11], v[20:23], v[16:19]
    v_mfma_f32_16x16x32_bf16 v[24:27], v[80:83], v[12:15], 0
    v_cvt_pk_bf16_f32 v44, v32, v33
    v_cvt_pk_bf16_f32 v45, v34, v35
    v_mfma_f32_16x16x32_bf16 v[32:35], v[88:91], v[12:15], 0
    v_cvt_pk_bf16_f32 v42, v28, v29
    v_cvt_pk_bf16_f32 v43, v30, v31
    v_mfma_f32_16x16x32_bf16 v[28:31], v[84:87], v[12:15], 0
    v_cvt_pk_bf16_f32 v46, v36, v37
    v_cvt_pk_bf16_f32 v47, v38, v39
    v_mfma_f32_16x16x32_bf16 v[36:39], v[92:95], v[12:15], 0
aloopH_38_midE:
    s_mov_b64 vcc, s[56:57]
    v_rcp_f32 v3, v16
    v_mfma_f32_16x16x32_bf16 v[24:27], v[40:43], v[20:23], v[24:27]
    v_mfma_f32_16x16x32_bf16 v[32:35], v[44:47], v[20:23], v[32:35]
    v_mfma_f32_16x16x32_bf16 v[28:31], v[42:45], v[20:23], v[28:31]
    v_mfma_f32_16x16x32_bf16 v[36:39], v[46:49], v[20:23], v[36:39]
    v_mov_b32_dpp v3, v3 quad_perm:[2,3,2,3] row_mask:0xf bank_mask:0xf
    s_nop 4
    v_cndmask_b32_dpp v24, v32, v24, vcc quad_perm:[2,3,2,3] row_mask:0xf bank_mask:0xf
    v_cndmask_b32_dpp v25, v33, v25, vcc quad_perm:[2,3,2,3] row_mask:0xf bank_mask:0xf
    v_cndmask_b32_dpp v26, v34, v26, vcc quad_perm:[2,3,2,3] row_mask:0xf bank_mask:0xf
    v_cndmask_b32_dpp v27, v35, v27, vcc quad_perm:[2,3,2,3] row_mask:0xf bank_mask:0xf
    v_cndmask_b32_dpp v28, v36, v28, vcc quad_perm:[2,3,2,3] row_mask:0xf bank_mask:0xf
    v_cndmask_b32_dpp v29, v37, v29, vcc quad_perm:[2,3,2,3] row_mask:0xf bank_mask:0xf
    v_cndmask_b32_dpp v30, v38, v30, vcc quad_perm:[2,3,2,3] row_mask:0xf bank_mask:0xf
    v_cndmask_b32_dpp v31, v39, v31, vcc quad_perm:[2,3,2,3] row_mask:0xf bank_mask:0xf
    v_mul_f32 v24, v24, v3
    v_mul_f32 v25, v25, v3
    v_mul_f32 v26, v26, v3
    v_mul_f32 v27, v27, v3
    v_mul_f32 v28, v28, v3
    v_mul_f32 v29, v29, v3
    v_mul_f32 v30, v30, v3
    v_mul_f32 v31, v31, v3
    v_cvt_pk_bf16_f32 v168, v24, v25
    v_cvt_pk_bf16_f32 v169, v26, v27
    v_cvt_pk_bf16_f32 v170, v28, v29
    v_cvt_pk_bf16_f32 v171, v30, v31
    ds_write_b128 v160, v[168:171]
    s_waitcnt lgkmcnt(0)
    s_barrier
    ds_read_b128 v[172:175], v161
    s_waitcnt lgkmcnt(0)
    v_mfma_f32_16x16x32_bf16 v[24:27], v[184:187], v[172:175], 0
    s_nop 7
    v_cvt_pk_bf16_f32 v168, v24, v25
    v_cvt_pk_bf16_f32 v169, v26, v27
    s_nop 0
    v_permlane16_swap_b32 v168, v170
    v_permlane16_swap_b32 v169, v171
    s_mov_b64 exec, 0xffff
    v_min_u32 v168, -2, v168
    buffer_store_dwordx4 v[168:171], v1, s[4:7], s25 offen sc1
    s_setprio 0
    buffer_store_dwordx4 v[176:179], v1, s[4:7], s26 offen sc1
    s_mov_b64 exec, -1
    s_branch pg_41
    s_cmp_lg_u32 s27, 0
    s_cbranch_scc1 pg_41
    s_sub_u32 s21, s16, 1
    s_cbranch_scc1 pg_41
    s_and_b32 s17, s21, 3
    s_cmp_ge_u32 s16, 58
    s_cselect_b32 s17, 0, s17
    s_cmp_lg_u32 s17, 0
    s_cbranch_scc1 pg_41
    v_mov_b32 v3, s21
    s_mov_b64 exec, 1
    buffer_store_dword v3, off, s[4:7], s28 sc1
    s_mov_b64 exec, -1
pg_41:
aloopH_38_lskb:
    v_mov_b32 v64, 0xff61b1e6
    ds_read_b128 v[128:131], v163 offset:16384
    ds_read_b128 v[132:135], v163 offset:17408
    ds_read_b128 v[136:139], v163 offset:18432
    ds_read_b128 v[140:143], v163 offset:19456
    ds_read_b128 v[144:147], v163 offset:20480
    ds_read_b128 v[148:151], v163 offset:21504
    ds_read_b128 v[152:155], v163 offset:22528
    ds_read_b128 v[156:159], v163 offset:23552
    s_waitcnt lgkmcnt(4)
    v_mfma_f32_16x16x32_bf16 v[12:15], v[96:99], v[128:131], 0
    v_mfma_f32_16x16x32_bf16 v[20:23], v[48:51], v[128:131], 0
    v_mfma_f32_16x16x32_bf16 v[12:15], v[100:103], v[132:135], v[12:15]
    v_mfma_f32_16x16x32_bf16 v[20:23], v[52:55], v[132:135], v[20:23]
    v_mfma_f32_16x16x32_bf16 v[12:15], v[104:107], v[136:139], v[12:15]
    v_mfma_f32_16x16x32_bf16 v[20:23], v[56:59], v[136:139], v[20:23]
    v_mfma_f32_16x16x32_bf16 v[12:15], v[108:111], v[140:143], v[12:15]
    v_mfma_f32_16x16x32_bf16 v[20:23], v[60:63], v[140:143], v[20:23]
    s_waitcnt lgkmcnt(0)
    v_mfma_f32_16x16x32_bf16 v[68:71], v[96:99], v[144:147], 0
    v_mfma_f32_16x16x32_bf16 v[72:75], v[112:115], v[144:147], 0
    v_mfma_f32_16x16x32_bf16 v[76:79], v[48:51], v[144:147], 0
    v_mfma_f32_16x16x32_bf16 v[68:71], v[100:103], v[148:151], v[68:71]
    v_mfma_f32_16x16x32_bf16 v[72:75], v[116:119], v[148:151], v[72:75]
    v_mfma_f32_16x16x32_bf16 v[76:79], v[52:55], v[148:151], v[76:79]
    v_mfma_f32_16x16x32_bf16 v[68:71], v[104:107], v[152:155], v[68:71]
    v_mfma_f32_16x16x32_bf16 v[72:75], v[120:123], v[152:155], v[72:75]
    v_mfma_f32_16x16x32_bf16 v[76:79], v[56:59], v[152:155], v[76:79]
    v_mfma_f32_16x16x32_bf16 v[68:71], v[108:111], v[156:159], v[68:71]
    v_mfma_f32_16x16x32_bf16 v[72:75], v[124:127], v[156:159], v[72:75]
    v_mfma_f32_16x16x32_bf16 v[76:79], v[60:63], v[156:159], v[76:79]
    v_cndmask_b32 v12, v12, v64, s[44:45]
    v_cndmask_b32 v13, v13, v64, s[46:47]
    v_cndmask_b32 v14, v14, v64, s[48:49]
    v_cndmask_b32 v15, v15, v64, s[50:51]
    s_add_u32 s17, s41, 20971520
    buffer_load_dwordx4 v[96:99], v0, s[4:7], s17 offen offset:0 sc1
    v_max3_f32 v2, v12, v13, v14
    buffer_load_dwordx4 v[100:103], v0, s[4:7], s17 offen offset:1024 sc1
    v_max3_f32 v3, v15, v20, v21
    buffer_load_dwordx4 v[104:107], v0, s[4:7], s17 offen offset:2048 sc1
    v_max_f32 v2, v2, v3
    buffer_load_dwordx4 v[108:111], v0, s[4:7], s17 offen offset:3072 sc1
    v_mov_b32 v3, v2
    s_add_u32 s18, s41, 21102592
    buffer_load_dwordx4 v[112:115], v0, s[4:7], s18 offen offset:0 sc1
    s_nop 1
    buffer_load_dwordx4 v[116:119], v0, s[4:7], s18 offen offset:1024 sc1
    v_permlane16_swap_b32 v3, v2
    buffer_load_dwordx4 v[120:123], v0, s[4:7], s18 offen offset:2048 sc1
    v_max_f32 v2, v2, v3
    buffer_load_dwordx4 v[124:127], v0, s[4:7], s18 offen offset:3072 sc1
    v_mov_b32 v3, v2
    s_nop 1
    v_permlane32_swap_b32 v3, v2
    v_max_f32 v2, v2, v3
    v_mul_f32 v2, s29, v2
    v_fma_f32 v12, v12, s29, -v2
    v_fma_f32 v13, v13, s29, -v2
    v_fma_f32 v14, v14, s29, -v2
    v_exp_f32 v12, v12
    v_fma_f32 v15, v15, s29, -v2
    v_exp_f32 v13, v13
    v_fma_f32 v20, v20, s29, -v2
    v_exp_f32 v14, v14
    v_fma_f32 v21, v21, s29, -v2
    v_exp_f32 v15, v15
    v_exp_f32 v20, v20
    v_exp_f32 v21, v21
    v_cvt_pk_bf16_f32 v12, v12, v13
    v_cvt_pk_bf16_f32 v13, v14, v15
    v_mov_b32 v14, 0
    v_mov_b32 v15, 0
    v_cvt_pk_bf16_f32 v20, v20, v21
    v_mov_b32 v22, 0
    v_mov_b32 v21, v20
    v_mov_b32 v23, 0
    s_nop 1
    v_cndmask_b32 v72, v72, v64, s[44:45]
    v_mfma_f32_16x16x32_bf16 v[16:19], v[4:7], v[12:15], 0
    v_cndmask_b32 v73, v73, v64, s[46:47]
    v_cndmask_b32 v74, v74, v64, s[48:49]
    v_mfma_f32_16x16x32_bf16 v[16:19], v[8:11], v[20:23], v[16:19]
    v_cndmask_b32 v75, v75, v64, s[50:51]
    v_max3_f32 v2, v68, v69, v70
    v_mfma_f32_16x16x32_bf16 v[24:27], v[80:83], v[12:15], 0
    v_max3_f32 v3, v71, v72, v73
    v_max3_f32 v2, v2, v74, v75
    v_mfma_f32_16x16x32_bf16 v[24:27], v[40:43], v[20:23], v[24:27]
    v_max3_f32 v3, v3, v76, v77
    v_max_f32 v2, v2, v3
    v_mfma_f32_16x16x32_bf16 v[28:31], v[84:87], v[12:15], 0
    v_mov_b32 v3, v2
    s_nop 1
    v_mfma_f32_16x16x32_bf16 v[28:31], v[42:45], v[20:23], v[28:31]
    v_permlane16_swap_b32 v3, v2
    v_max_f32 v2, v2, v3
    v_mfma_f32_16x16x32_bf16 v[32:35], v[88:91], v[12:15], 0
    v_mov_b32 v3, v2
    s_nop 1
    v_mfma_f32_16x16x32_bf16 v[32:35], v[44:47], v[20:23], v[32:35]
    v_permlane32_swap_b32 v3, v2
    v_max_f32 v2, v2, v3
    v_mfma_f32_16x16x32_bf16 v[36:39], v[92:95], v[12:15], 0
    v_mul_f32 v2, s29, v2
    v_fma_f32 v68, v68, s29, -v2
    v_mfma_f32_16x16x32_bf16 v[36:39], v[46:49], v[20:23], v[36:39]
    v_fma_f32 v69, v69, s29, -v2
    v_fma_f32 v70, v70, s29, -v2
    v_exp_f32 v68, v68
    v_fma_f32 v71, v71, s29, -v2
    v_exp_f32 v69, v69
    v_fma_f32 v72, v72, s29, -v2
    v_exp_f32 v70, v70
    v_fma_f32 v73, v73, s29, -v2
    v_exp_f32 v71, v71
    v_fma_f32 v74, v74, s29, -v2
    v_exp_f32 v72, v72
    v_fma_f32 v75, v75, s29, -v2
    v_exp_f32 v73, v73
    v_fma_f32 v76, v76, s29, -v2
    v_exp_f32 v74, v74
    v_fma_f32 v77, v77, s29, -v2
    v_exp_f32 v75, v75
    v_exp_f32 v76, v76
    v_exp_f32 v77, v77
    v_cvt_pk_bf16_f32 v68, v68, v69
    v_cvt_pk_bf16_f32 v69, v70, v71
    v_cvt_pk_bf16_f32 v70, v72, v73
    v_cvt_pk_bf16_f32 v71, v74, v75
    v_cvt_pk_bf16_f32 v76, v76, v77
    v_mov_b32 v78, 0
    v_mov_b32 v77, v76
    v_mov_b32 v79, 0
    v_rcp_f32 v66, v16
    s_nop 0
    v_mul_f32 v24, v24, v66
    v_mul_f32 v25, v25, v66
    v_mul_f32 v26, v26, v66
    v_mul_f32 v27, v27, v66
    v_cvt_pk_bf16_f32 v168, v24, v25
    v_cvt_pk_bf16_f32 v169, v26, v27
    v_mul_f32 v28, v28, v66
    v_mul_f32 v29, v29, v66
    v_mul_f32 v30, v30, v66
    v_mul_f32 v31, v31, v66
    v_cvt_pk_bf16_f32 v170, v28, v29
    v_cvt_pk_bf16_f32 v171, v30, v31
    v_mul_f32 v32, v32, v66
    v_mul_f32 v33, v33, v66
    v_mul_f32 v34, v34, v66
    v_mul_f32 v35, v35, v66
    v_cvt_pk_bf16_f32 v172, v32, v33
    v_cvt_pk_bf16_f32 v173, v34, v35
    v_mul_f32 v36, v36, v66
    v_mul_f32 v37, v37, v66
    v_mul_f32 v38, v38, v66
    v_mul_f32 v39, v39, v66
    v_cvt_pk_bf16_f32 v174, v36, v37
    v_cvt_pk_bf16_f32 v175, v38, v39
    ds_write_b128 v162, v[168:171] offset:0
    ds_write_b128 v162, v[172:175] offset:2048
    v_mfma_f32_16x16x32_bf16 v[72:75], v[4:7], v[68:71], 0
    v_mfma_f32_16x16x32_bf16 v[72:75], v[8:11], v[76:79], v[72:75]
    v_mfma_f32_16x16x32_bf16 v[24:27], v[80:83], v[68:71], 0
    v_mfma_f32_16x16x32_bf16 v[24:27], v[40:43], v[76:79], v[24:27]
    v_mfma_f32_16x16x32_bf16 v[28:31], v[84:87], v[68:71], 0
    v_mfma_f32_16x16x32_bf16 v[28:31], v[42:45], v[76:79], v[28:31]
    v_mfma_f32_16x16x32_bf16 v[32:35], v[88:91], v[68:71], 0
    v_mfma_f32_16x16x32_bf16 v[32:35], v[44:47], v[76:79], v[32:35]
    v_mfma_f32_16x16x32_bf16 v[36:39], v[92:95], v[68:71], 0
    v_mfma_f32_16x16x32_bf16 v[36:39], v[46:49], v[76:79], v[36:39]
    v_rcp_f32 v3, v72
    s_nop 0
    v_mul_f32 v24, v24, v3
    v_mul_f32 v25, v25, v3
    v_mul_f32 v26, v26, v3
    v_mul_f32 v27, v27, v3
    v_cvt_pk_bf16_f32 v168, v24, v25
    v_cvt_pk_bf16_f32 v169, v26, v27
    v_mul_f32 v28, v28, v3
    v_mul_f32 v29, v29, v3
    v_mul_f32 v30, v30, v3
    v_mul_f32 v31, v31, v3
    v_cvt_pk_bf16_f32 v170, v28, v29
    v_cvt_pk_bf16_f32 v171, v30, v31
    v_mul_f32 v32, v32, v3
    v_mul_f32 v33, v33, v3
    v_mul_f32 v34, v34, v3
    v_mul_f32 v35, v35, v3
    v_cvt_pk_bf16_f32 v172, v32, v33
    v_cvt_pk_bf16_f32 v173, v34, v35
    v_mul_f32 v36, v36, v3
    v_mul_f32 v37, v37, v3
    v_mul_f32 v38, v38, v3
    v_mul_f32 v39, v39, v3
    v_cvt_pk_bf16_f32 v174, v36, v37
    v_cvt_pk_bf16_f32 v175, v38, v39
    ds_write_b128 v162, v[168:171] offset:256
    ds_write_b128 v162, v[172:175] offset:2304
    v_xor_b32 v162, 0x4000, v162
    s_add_u32 s16, s16, 1
    s_cmp_le_u32 s16, 63
    s_cbranch_scc1 aloopH_38
    s_waitcnt lgkmcnt(0)
    s_barrier
    s_waitcnt vmcnt(0)
    s_branch k_end
aloopH_38_rq_0:
    s_sub_u32 s22, s22, 1
    s_cbranch_scc1 aloopH_38_rq_0_g
    buffer_load_dwordx4 v[48:51], v0, s[4:7], s23 offen offset:0 sc1
    buffer_load_dwordx4 v[52:55], v0, s[4:7], s23 offen offset:1024 sc1
    buffer_load_dwordx4 v[56:59], v0, s[4:7], s23 offen offset:2048 sc1
    buffer_load_dwordx4 v[60:63], v0, s[4:7], s23 offen offset:3072 sc1
    buffer_load_dwordx4 v[64:67], v0, s[4:7], s24 offen offset:0 sc1
    buffer_load_dwordx4 v[68:71], v0, s[4:7], s24 offen offset:1024 sc1
    s_waitcnt vmcnt(5)
    v_max_u32 v3, v48, v50
    v_cmp_eq_u32 vcc, -1, v3
    s_cbranch_vccnz aloopH_38_rq_0
    s_branch aloopH_38_again
aloopH_38_rq_0_g:
    s_mov_b32 s22, 0
    s_waitcnt vmcnt(0)
    s_branch aloopH_38_nochk
aloopH_38_rq_1:
    s_sub_u32 s22, s22, 1
    s_cbranch_scc1 aloopH_38_rq_1_g
    buffer_load_dwordx4 v[52:55], v0, s[4:7], s23 offen offset:1024 sc1
    buffer_load_dwordx4 v[56:59], v0, s[4:7], s23 offen offset:2048 sc1
    buffer_load_dwordx4 v[60:63], v0, s[4:7], s23 offen offset:3072 sc1
    buffer_load_dwordx4 v[64:67], v0, s[4:7], s24 offen offset:0 sc1
    buffer_load_dwordx4 v[68:71], v0, s[4:7], s24 offen offset:1024 sc1
    s_waitcnt vmcnt(4)
    v_max_u32 v3, v52, v54
    v_cmp_eq_u32 vcc, -1, v3
    s_cbranch_vccnz aloopH_38_rq_1
    s_branch aloopH_38_again
aloopH_38_rq_1_g:
    s_mov_b32 s22, 0
    s_waitcnt vmcnt(0)
    s_branch aloopH_38_nochk
aloopH_38_rq_2:
    s_sub_u32 s22, s22, 1
    s_cbranch_scc1 aloopH_38_rq_2_g
    buffer_load_dwordx4 v[56:59], v0, s[4:7], s23 offen offset:2048 sc1
    buffer_load_dwordx4 v[60:63], v0, s[4:7], s23 offen offset:3072 sc1
    buffer_load_dwordx4 v[64:67], v0, s[4:7], s24 offen offset:0 sc1
    buffer_load_dwordx4 v[68:71], v0, s[4:7], s24 offen offset:1024 sc1
    s_waitcnt vmcnt(3)
    v_max_u32 v3, v56, v58
    v_cmp_eq_u32 vcc, -1, v3
    s_cbranch_vccnz aloopH_38_rq_2
    s_branch aloopH_38_again
aloopH_38_rq_2_g:
    s_mov_b32 s22, 0
    s_waitcnt vmcnt(0)
    s_branch aloopH_38_nochk
aloopH_38_rq_3:
    s_sub_u32 s22, s22, 1
    s_cbranch_scc1 aloopH_38_rq_3_g
    buffer_load_dwordx4 v[60:63], v0, s[4:7], s23 offen offset:3072 sc1
    buffer_load_dwordx4 v[64:67], v0, s[4:7], s24 offen offset:0 sc1
    buffer_load_dwordx4 v[68:71], v0, s[4:7], s24 offen offset:1024 sc1
    s_waitcnt vmcnt(2)
    v_max_u32 v3, v60, v62
    v_cmp_eq_u32 vcc, -1, v3
    s_cbranch_vccnz aloopH_38_rq_3
    s_branch aloopH_38_again
aloopH_38_rq_3_g:
    s_mov_b32 s22, 0
    s_waitcnt vmcnt(0)
    s_branch aloopH_38_nochk
aloopH_38_again:
    s_waitcnt vmcnt(5)
    v_mfma_f32_16x16x32_bf16 v[12:15], v[96:99], v[48:51], 0
    v_mfma_f32_16x16x32_bf16 v[16:19], v[112:115], v[48:51], 0
    v_max_u32 v3, v48, v50
    v_cmp_eq_u32 vcc, -1, v3
    v_mfma_f32_16x16x32_bf16 v[20:23], v[48:51], v[48:51], 0
    s_cbranch_vccnz aloopH_38_rq_0
    s_waitcnt vmcnt(4)
    v_mfma_f32_16x16x32_bf16 v[12:15], v[100:103], v[52:55], v[12:15]
    v_mfma_f32_16x16x32_bf16 v[16:19], v[116:119], v[52:55], v[16:19]
    v_max_u32 v3, v52, v54
    v_cmp_eq_u32 vcc, -1, v3
    v_mfma_f32_16x16x32_bf16 v[20:23], v[52:55], v[52:55], v[20:23]
    s_cbranch_vccnz aloopH_38_rq_1
    s_waitcnt vmcnt(3)
    v_mfma_f32_16x16x32_bf16 v[12:15], v[104:107], v[56:59], v[12:15]
    v_mfma_f32_16x16x32_bf16 v[16:19], v[120:123], v[56:59], v[16:19]
    v_max_u32 v3, v56, v58
    v_cmp_eq_u32 vcc, -1, v3
    v_mfma_f32_16x16x32_bf16 v[20:23], v[56:59], v[56:59], v[20:23]
    s_cbranch_vccnz aloopH_38_rq_2
    s_waitcnt vmcnt(2)
    v_mfma_f32_16x16x32_bf16 v[12:15], v[108:111], v[60:63], v[12:15]
    v_mfma_f32_16x16x32_bf16 v[16:19], v[124:127], v[60:63], v[16:19]
    v_max_u32 v3, v60, v62
    v_cmp_eq_u32 vcc, -1, v3
    v_mfma_f32_16x16x32_bf16 v[20:23], v[60:63], v[60:63], v[20:23]
    s_cbranch_vccnz aloopH_38_rq_3
    s_branch aloopH_38_sdone
aloopH_38_rq_v:
    s_sub_u32 s22, s22, 1
    s_cbranch_scc1 aloopH_38_rq_vg
    buffer_load_dwordx4 v[64:67], v0, s[4:7], s24 offen offset:0 sc1
    buffer_load_dwordx4 v[68:71], v0, s[4:7], s24 offen offset:1024 sc1
    s_waitcnt vmcnt(0)
    v_max3_u32 v188, v64, v66, v68
    v_max_u32 v188, v188, v70
    v_cmp_eq_u32 vcc, -1, v188
    s_cbranch_vccnz aloopH_38_rq_v
    s_branch aloopH_38_vok
aloopH_38_rq_vg:
    s_mov_b32 s22, 0
    s_branch aloopH_38_vok
aloopH_38_nochk:
    v_mfma_f32_16x16x32_bf16 v[12:15], v[96:99], v[48:51], 0
    v_mfma_f32_16x16x32_bf16 v[16:19], v[112:115], v[48:51], 0
    v_mfma_f32_16x16x32_bf16 v[20:23], v[48:51], v[48:51], 0
    v_mfma_f32_16x16x32_bf16 v[12:15], v[100:103], v[52:55], v[12:15]
    v_mfma_f32_16x16x32_bf16 v[16:19], v[116:119], v[52:55], v[16:19]
    v_mfma_f32_16x16x32_bf16 v[20:23], v[52:55], v[52:55], v[20:23]
    v_mfma_f32_16x16x32_bf16 v[12:15], v[104:107], v[56:59], v[12:15]
    v_mfma_f32_16x16x32_bf16 v[16:19], v[120:123], v[56:59], v[16:19]
    v_mfma_f32_16x16x32_bf16 v[20:23], v[56:59], v[56:59], v[20:23]
    v_mfma_f32_16x16x32_bf16 v[12:15], v[108:111], v[60:63], v[12:15]
    v_mfma_f32_16x16x32_bf16 v[16:19], v[124:127], v[60:63], v[16:19]
    v_mfma_f32_16x16x32_bf16 v[20:23], v[60:63], v[60:63], v[20:23]
    s_nop 1
    s_branch aloopH_38_sdone
aloopH_38_rq_v2:
    s_sub_u32 s22, s22, 1
    s_cbranch_scc1 aloopH_38_rq_v2g
    buffer_load_dwordx4 v[64:67], v0, s[4:7], s24 offen offset:0 sc1
    buffer_load_dwordx4 v[68:71], v0, s[4:7], s24 offen offset:1024 sc1
    s_waitcnt vmcnt(0)
    v_max3_u32 v188, v64, v66, v68
    v_max_u32 v188, v188, v70
    v_cmp_eq_u32 vcc, -1, v188
    s_cbranch_vccnz aloopH_38_rq_v2
    s_branch aloopH_38_lsk3
aloopH_38_rq_v2g:
    s_mov_b32 s22, 0
    s_branch aloopH_38_lsk3
ct_tail:
aloopH_38_lsk:
    s_cmp_lg_u32 s27, 0
    s_cbranch_scc1 aloopH_38_lsk2
    v_mov_b32 v3, 62
    s_mov_b64 exec, 1
    buffer_store_dword v3, off, s[4:7], s28 sc1
    s_mov_b64 exec, -1
aloopH_38_lsk2:
    s_waitcnt vmcnt(0)
    v_max3_u32 v188, v64, v66, v68
    v_max_u32 v188, v188, v70
    v_cmp_eq_u32 vcc, -1, v188
    s_cbranch_vccnz aloopH_38_rq_v2
aloopH_38_lsk3:
    v_smfmac_f32_16x16x64_bf16 v[24:27], v[64:67], v[192:199], v166
    v_smfmac_f32_16x16x64_bf16 v[32:35], v[64:67], v[224:231], v166
    v_smfmac_f32_16x16x64_bf16 v[28:31], v[64:67], v[208:215], v166
    v_smfmac_f32_16x16x64_bf16 v[36:39], v[64:67], v[240:247], v166
    v_smfmac_f32_16x16x64_bf16 v[24:27], v[68:71], v[200:207], v166
    v_smfmac_f32_16x16x64_bf16 v[32:35], v[68:71], v[232:239], v166
    v_smfmac_f32_16x16x64_bf16 v[28:31], v[68:71], v[216:223], v166
    v_smfmac_f32_16x16x64_bf16 v[36:39], v[68:71], v[248:255], v166
    s_nop 7
    s_nop 1
    v_cvt_pk_bf16_f32 v40, v24, v25
    v_cvt_pk_bf16_f32 v41, v26, v27
    v_cvt_pk_bf16_f32 v42, v28, v29
    v_cvt_pk_bf16_f32 v43, v30, v31
    v_cvt_pk_bf16_f32 v44, v32, v33
    v_cvt_pk_bf16_f32 v45, v34, v35
    v_cvt_pk_bf16_f32 v46, v36, v37
    v_cvt_pk_bf16_f32 v47, v38, v39
    s_waitcnt lgkmcnt(0)
    s_branch aloopH_38_lskb
k_end:
k_exit:
    s_endpgm
.section .rodata,"a"
.p2align 6
jobtab:
    .long 4, 24, 24, 8192, 0, 262144, 8388608, 0, 32768, 4, 20971520, 131072, 0, 0, 218104321, 0
    .long 4, 24, 24, 8192, 256, 262400, 8388608, 0, 32768, 4, 20975616, 131072, 0, 0, 218104321, 0
    .long 4, 24, 24, 8192, 512, 262656, 8388608, 0, 32768, 4, 20979712, 131072, 0, 0, 218104321, 0
    .long 4, 24, 24, 8192, 768, 262912, 8388608, 0, 32768, 4, 20983808, 131072, 0, 0, 218104321, 0
    .long 4, 24, 24, 8192, 1024, 263168, 8388608, 0, 32768, 4, 20987904, 131072, 0, 0, 218104337, 0
    .long 4, 24, 24, 8192, 1280, 263424, 8388608, 0, 32768, 4, 20992000, 131072, 0, 0, 218104337, 0
    .long 4, 24, 24, 8192, 1536, 263680, 8388608, 0, 32768, 4, 20996096, 131072, 0, 0, 218104337, 0
    .long 4, 24, 24, 8192, 1792, 263936, 8388608, 0, 32768, 4, 21000192, 131072, 0, 0, 218104337, 0
    .long 4, 32, 32, 8192, 0, 262144, 8388608, 0, 32768, 4, 37748736, 131072, 0, 0, 218104321, 0
    .long 4, 32, 32, 8192, 256, 262400, 8388608, 0, 32768, 4, 37752832, 131072, 0, 0, 218104321, 0
    .long 4, 32, 32, 8192, 512, 262656, 8388608, 0, 32768, 4, 37756928, 131072, 0, 0, 218104321, 0
    .long 4, 32, 32, 8192, 768, 262912, 8388608, 0, 32768, 4, 37761024, 131072, 0, 0, 218104321, 0
    .long 4, 32, 32, 8192, 1024, 263168, 8388608, 0, 32768, 4, 37765120, 131072, 0, 0, 218104337, 0
    .long 4, 32, 32, 8192, 1280, 263424, 8388608, 0, 32768, 4, 37769216, 131072, 0, 0, 218104337, 0
    .long 4, 32, 32, 8192, 1536, 263680, 8388608, 0, 32768, 4, 37773312, 131072, 0, 0, 218104337, 0
    .long 4, 32, 32, 8192, 1792, 263936, 8388608, 0, 32768, 4, 37777408, 131072, 0, 0, 218104337, 0
    .long 4, 24, 24, 8192, 0, 262144, 8388608, 262144, 32768, 4, 22020096, 131072, 0, 0, 218104324, 0
    .long 4, 24, 24, 8192, 256, 262400, 8388608, 262144, 32768, 4, 22024192, 131072, 0, 0, 218104324, 0
    .long 4, 24, 24, 8192, 512, 262656, 8388608, 262144, 32768, 4, 22028288, 131072, 0, 0, 218104324, 0
    .long 4, 24, 24, 8192, 768, 262912, 8388608, 262144, 32768, 4, 22032384, 131072, 0, 0, 218104324, 0
    .long 4, 24, 24, 8192, 1024, 263168, 8388608, 262144, 32768, 4, 22036480, 131072, 0, 0, 218104340, 0
    .long 4, 24, 24, 8192, 1280, 263424, 8388608, 262144, 32768, 4, 22040576, 131072, 0, 0, 218104340, 0
    .long 4, 24, 24, 8192, 1536, 263680, 8388608, 262144, 32768, 4, 22044672, 131072, 0, 0, 218104340, 0
    .long 4, 24, 24, 8192, 1792, 263936, 8388608, 262144, 32768, 4, 22048768, 131072, 0, 0, 218104340, 0
    .long 4, 32, 32, 8192, 0, 262144, 8388608, 262144, 32768, 4, 38797312, 131072, 0, 0, 218104324, 0
    .long 4, 32, 32, 8192, 256, 262400, 8388608, 262144, 32768, 4, 38801408, 131072, 0, 0, 218104324, 0
    .long 4, 32, 32, 8192, 512, 262656, 8388608, 262144, 32768, 4, 38805504, 131072, 0, 0, 218104324, 0
    .long 4, 32, 32, 8192, 768, 262912, 8388608, 262144, 32768, 4, 38809600, 131072, 0, 0, 218104324, 0
    .long 4, 32, 32, 8192, 1024, 263168, 8388608, 262144, 32768, 4, 38813696, 131072, 0, 0, 218104340, 0
    .long 4, 32, 32, 8192, 1280, 263424, 8388608, 262144, 32768, 4, 38817792, 131072, 0, 0, 218104340, 0
    .long 4, 32, 32, 8192, 1536, 263680, 8388608, 262144, 32768, 4, 38821888, 131072, 0, 0, 218104340, 0
    .long 4, 32, 32, 8192, 1792, 263936, 8388608, 262144, 32768, 4, 38825984, 131072, 0, 0, 218104340, 0
    .long 4, 32, 32, 8192, 512, 262656, 8388608, 786432, 32768, 4, 40902656, 131072, 0, 0, 218104580, 0
    .long 4, 32, 32, 8192, 1536, 263680, 8388608, 786432, 32768, 4, 40919040, 131072, 0, 0, 218104596, 0
    .long 4, 32, 32, 8192, 1792, 263936, 8388608, 524288, 32768, 4, 39874560, 131072, 0, 0, 218104593, 0
    .long 4, 24, 24, 8192, 512, 262656, 8388608, 786432, 32768, 4, 24125440, 131072, 0, 0, 218104580, 0
    .long 4, 32, 32, 8192, 512, 262656, 8388608, 524288, 32768, 4, 39854080, 131072, 0, 0, 218104577, 0
    .long 4, 32, 32, 8192, 1792, 263936, 8388608, 786432, 32768, 4, 40923136, 131072, 0, 0, 218104596, 0
    .long 4, 24, 24, 8192, 1536, 263680, 8388608, 786432, 32768, 4, 24141824, 131072, 0, 0, 218104596, 0
    .long 4, 24, 24, 8192, 256, 262400, 8388608, 524288, 32768, 4, 23072768, 131072, 0, 0, 218104577, 0
    .long 4, 24, 24, 8192, 768, 262912, 8388608, 524288, 32768, 4, 23080960, 131072, 0, 0, 218104577, 0
    .long 4, 24, 24, 8192, 1280, 263424, 8388608, 524288, 32768, 4, 23089152, 131072, 0, 0, 218104593, 0
    .long 4, 24, 24, 8192, 768, 262912, 8388608, 786432, 32768, 4, 24129536, 131072, 0, 0, 218104580, 0
    .long 4, 32, 32, 8192, 256, 262400, 8388608, 524288, 32768, 4, 39849984, 131072, 0, 0, 218104577, 0
    .long 4, 32, 32, 8192, 1024, 263168, 8388608, 524288, 32768, 4, 39862272, 131072, 0, 0, 218104593, 0
    .long 4, 24, 24, 8192, 1536, 263680, 8388608, 524288, 32768, 4, 23093248, 131072, 0, 0, 218104593, 0
    .long 4, 32, 32, 8192, 768, 262912, 8388608, 524288, 32768, 4, 39858176, 131072, 0, 0, 218104577, 0
    .long 4, 24, 24, 8192, 0, 262144, 8388608, 524288, 32768, 4, 23068672, 131072, 0, 0, 218104577, 0
    .long 4, 32, 32, 8192, 1024, 263168, 8388608, 786432, 32768, 4, 40910848, 131072, 0, 0, 218104596, 0
    .long 4, 24, 24, 8192, 1792, 263936, 8388608, 786432, 32768, 4, 24145920, 131072, 0, 0, 218104596, 0
    .long 4, 32, 32, 8192, 0, 262144, 8388608, 524288, 32768, 4, 39845888, 131072, 0, 0, 218104577, 0
    .long 4, 24, 24, 8192, 1280, 263424, 8388608, 786432, 32768, 4, 24137728, 131072, 0, 0, 218104596, 0
    .long 4, 32, 32, 8192, 256, 262400, 8388608, 786432, 32768, 4, 40898560, 131072, 0, 0, 218104580, 0
    .long 4, 24, 24, 8192, 1024, 263168, 8388608, 786432, 32768, 4, 24133632, 131072, 0, 0, 218104596, 0
    .long 4, 24, 24, 8192, 512, 262656, 8388608, 524288, 32768, 4, 23076864, 131072, 0, 0, 218104577, 0
    .long 4, 24, 24, 8192, 256, 262400, 8388608, 786432, 32768, 4, 24121344, 131072, 0, 0, 218104580, 0
    .long 4, 32, 32, 8192, 1280, 263424, 8388608, 786432, 32768, 4, 40914944, 131072, 0, 0, 218104596, 0
    .long 4, 24, 24, 8192, 0, 262144, 8388608, 786432, 32768, 4, 24117248, 131072, 0, 0, 218104580, 0
    .long 4, 32, 32, 8192, 1536, 263680, 8388608, 524288, 32768, 4, 39870464, 131072, 0, 0, 218104593, 0
    .long 4, 32, 32, 8192, 768, 262912, 8388608, 786432, 32768, 4, 40906752, 131072, 0, 0, 218104580, 0
    .long 4, 32, 32, 8192, 1280, 263424, 8388608, 524288, 32768, 4, 39866368, 131072, 0, 0, 218104593, 0
    .long 4, 24, 24, 8192, 1024, 263168, 8388608, 524288, 32768, 4, 23085056, 131072, 0, 0, 218104593, 0
    .long 4, 24, 24, 8192, 1792, 263936, 8388608, 524288, 32768, 4, 23097344, 131072, 0, 0, 218104593, 0
    .long 4, 32, 32, 8192, 0, 262144, 8388608, 786432, 32768, 4, 40894464, 131072, 0, 0, 218104580, 0
    .long 1, 16, 16, 8192, 0, 256, 8388608, 1572864, 32768, 8, 10485760, 131072, 0, 0, 218105098, 0
    .long 1, 32, 32, 8192, 512, 768, 8388608, 1048576, 32768, 8, 41951232, 131072, 0, 0, 218104842, 0
    .long 1, 32, 32, 8192, 512, 768, 8388608, 1572864, 32768, 8, 44048384, 131072, 0, 0, 218105098, 0
    .long 1, 24, 24, 8192, 512, 768, 8388608, 1048576, 32768, 8, 25174016, 131072, 0, 0, 218104842, 0
    .long 1, 16, 16, 8192, 1024, 1280, 8388608, 1048576, 32768, 8, 8404992, 131072, 0, 0, 218104858, 0
    .long 1, 16, 16, 8192, 1536, 1792, 8388608, 1048576, 32768, 8, 8413184, 131072, 0, 0, 218104858, 0
    .long 1, 32, 32, 8192, 1536, 1792, 8388608, 1048576, 32768, 8, 41967616, 131072, 0, 0, 218104858, 0
    .long 1, 24, 24, 8192, 1024, 1280, 8388608, 1048576, 32768, 8, 25182208, 131072, 0, 0, 218104858, 0
    .long 1, 24, 24, 8192, 1536, 1792, 8388608, 2097152, 32768, 8, 29384704, 131072, 0, 0, 218105370, 0
    .long 1, 24, 24, 8192, 1536, 1792, 8388608, 1048576, 32768, 8, 25190400, 131072, 0, 0, 218104858, 0
    .long 1, 32, 32, 8192, 1024, 1280, 8388608, 1048576, 32768, 8, 41959424, 131072, 0, 0, 218104858, 0
    .long 1, 24, 24, 8192, 1024, 1280, 8388608, 2097152, 32768, 8, 29376512, 131072, 0, 0, 218105370, 0
    .long 1, 24, 24, 8192, 0, 256, 8388608, 1572864, 32768, 8, 27262976, 131072, 0, 0, 218105098, 0
    .long 1, 32, 32, 8192, 0, 256, 8388608, 1572864, 32768, 8, 44040192, 131072, 0, 0, 218105098, 0
    .long 1, 24, 24, 8192, 1024, 1280, 8388608, 1572864, 32768, 8, 27279360, 131072, 0, 0, 218105114, 0
    .long 1, 16, 16, 8192, 0, 256, 8388608, 1048576, 32768, 8, 8388608, 131072, 0, 0, 218104842, 0
    .long 1, 24, 24, 8192, 512, 768, 8388608, 1572864, 32768, 8, 27271168, 131072, 0, 0, 218105098, 0
    .long 1, 16, 16, 8192, 512, 768, 8388608, 1572864, 32768, 8, 10493952, 131072, 0, 0, 218105098, 0
    .long 1, 32, 32, 8192, 1024, 1280, 8388608, 1572864, 32768, 8, 44056576, 131072, 0, 0, 218105114, 0
    .long 1, 16, 16, 8192, 1024, 1280, 8388608, 1572864, 32768, 8, 10502144, 131072, 0, 0, 218105114, 0
    .long 1, 32, 32, 8192, 1536, 1792, 8388608, 2097152, 32768, 8, 46161920, 131072, 0, 0, 218105370, 0
    .long 1, 24, 24, 8192, 0, 256, 8388608, 1048576, 32768, 8, 25165824, 131072, 0, 0, 218104842, 0
    .long 1, 24, 24, 8192, 0, 256, 8388608, 2097152, 32768, 8, 29360128, 131072, 0, 0, 218105354, 0
    .long 1, 16, 16, 8192, 1536, 1792, 8388608, 1572864, 32768, 8, 10510336, 131072, 0, 0, 218105114, 0
    .long 2, 64, 72, 7168, 768, 768, 7340032, 1572864, 32768, 8, 60043264, 114688, 0, 0, 218104001, 0
    .long 1, 32, 32, 8192, 0, 256, 8388608, 2097152, 32768, 8, 46137344, 131072, 0, 0, 218105354, 0
    .long 1, 32, 32, 8192, 0, 256, 8388608, 1048576, 32768, 8, 41943040, 131072, 0, 0, 218104842, 0
    .long 1, 32, 32, 8192, 512, 768, 8388608, 2097152, 32768, 8, 46145536, 131072, 0, 0, 218105354, 0
    .long 1, 24, 24, 8192, 1536, 1792, 8388608, 1572864, 32768, 8, 27287552, 131072, 0, 0, 218105114, 0
    .long 1, 32, 32, 8192, 1536, 1792, 8388608, 1572864, 32768, 8, 44064768, 131072, 0, 0, 218105114, 0
    .long 1, 16, 16, 8192, 512, 768, 8388608, 1048576, 32768, 8, 8396800, 131072, 0, 0, 218104842, 0
    .long 1, 32, 32, 8192, 1024, 1280, 8388608, 2097152, 32768, 8, 46153728, 131072, 0, 0, 218105370, 0
    .long 1, 16, 16, 8192, 512, 768, 8388608, 0, 32768, 8, 4202496, 131072, 0, 0, 218107914, 0
    .long 2, 64, 72, 7168, 768, 768, 7340032, 2097152, 32768, 8, 61878272, 114688, 0, 0, 218104065, 0
    .long 1, 16, 16, 8192, 1536, 1792, 8388608, 2097152, 32768, 8, 12607488, 131072, 0, 0, 218105370, 0
    .long 1, 16, 16, 8192, 512, 768, 8388608, 524288, 32768, 8, 6299648, 131072, 0, 0, 218108170, 0
    .long 1, 16, 16, 8192, 1536, 1792, 8388608, 3145728, 32768, 8, 16801792, 131072, 0, 0, 218105882, 0
    .long 1, 32, 32, 8192, 1536, 1792, 8388608, 2621440, 32768, 8, 48259072, 131072, 0, 0, 218105626, 0
    .long 1, 16, 16, 8192, 1024, 1280, 8388608, 0, 32768, 8, 4210688, 131072, 0, 0, 218107930, 0
    .long 1, 16, 16, 8192, 0, 256, 8388608, 2097152, 32768, 8, 12582912, 131072, 0, 0, 218105354, 0
    .long 1, 16, 16, 8192, 1536, 1792, 8388608, 0, 32768, 8, 4218880, 131072, 0, 0, 218107930, 0
    .long 1, 16, 16, 8192, 0, 256, 8388608, 524288, 32768, 8, 6291456, 131072, 0, 0, 218108170, 0
    .long 1, 24, 24, 8192, 1024, 1280, 8388608, 3145728, 32768, 8, 33570816, 131072, 0, 0, 218105882, 0
    .long 1, 24, 24, 8192, 512, 768, 8388608, 2621440, 32768, 8, 31465472, 131072, 0, 0, 218105610, 0
    .long 1, 16, 16, 8192, 512, 768, 8388608, 2621440, 32768, 8, 14688256, 131072, 0, 0, 218105610, 0
    .long 1, 16, 16, 8192, 1024, 1280, 8388608, 524288, 32768, 8, 6307840, 131072, 0, 0, 218108186, 0
    .long 2, 64, 72, 7168, 1280, 1280, 7340032, 0, 32768, 8, 54546432, 114688, 0, 0, 218103809, 0
    .long 2, 64, 72, 7168, 768, 768, 7340032, 0, 32768, 8, 54538240, 114688, 0, 0, 218103809, 0
    .long 2, 64, 72, 7168, 1280, 1280, 7340032, 1048576, 32768, 8, 58216448, 114688, 0, 0, 218103937, 0
    .long 1, 16, 16, 8192, 0, 256, 8388608, 0, 32768, 8, 4194304, 131072, 0, 0, 218107914, 0
    .long 1, 16, 16, 8192, 1536, 1792, 8388608, 524288, 32768, 8, 6316032, 131072, 0, 0, 218108186, 0
    .long 1, 24, 24, 8192, 1024, 1280, 8388608, 2621440, 32768, 8, 31473664, 131072, 0, 0, 218105626, 0
    .long 1, 16, 16, 8192, 1536, 1792, 8388608, 2621440, 32768, 8, 14704640, 131072, 0, 0, 218105626, 0
    .long 1, 24, 24, 8192, 512, 768, 8388608, 2097152, 32768, 8, 29368320, 131072, 0, 0, 218105354, 0
    .long 2, 64, 72, 7168, 1280, 1280, 7340032, 2097152, 32768, 8, 61886464, 114688, 0, 0, 218104065, 0
    .long 1, 16, 16, 8192, 512, 768, 8388608, 3145728, 32768, 8, 16785408, 131072, 0, 0, 218105866, 0
    .long 1, 16, 16, 8192, 512, 768, 8388608, 2097152, 32768, 8, 12591104, 131072, 0, 0, 218105354, 0
    .long 2, 64, 72, 7168, 768, 768, 7340032, 3670016, 32768, 8, 67383296, 114688, 0, 0, 218104257, 0
    .long 1, 24, 24, 8192, 512, 768, 8388608, 3145728, 32768, 8, 33562624, 131072, 0, 0, 218105866, 0
    .long 2, 64, 72, 7168, 512, 512, 7340032, 2097152, 32768, 8, 61874176, 114688, 0, 0, 218104065, 0
    .long 1, 16, 16, 8192, 1024, 1280, 8388608, 2097152, 32768, 8, 12599296, 131072, 0, 0, 218105370, 0
    .long 2, 64, 72, 7168, 1280, 1280, 7340032, 2621440, 32768, 8, 63721472, 114688, 0, 0, 218104129, 0
    .long 1, 32, 32, 8192, 1536, 1792, 8388608, 3145728, 32768, 8, 50356224, 131072, 0, 0, 218105882, 0
    .long 1, 24, 24, 8192, 0, 256, 8388608, 2621440, 32768, 8, 31457280, 131072, 0, 0, 218105610, 0
    .long 2, 64, 72, 7168, 0, 0, 7340032, 1048576, 32768, 8, 58195968, 114688, 0, 0, 218103937, 0
    .long 1, 32, 32, 8192, 1024, 1280, 8388608, 3145728, 32768, 8, 50348032, 131072, 0, 0, 218105882, 0
    .long 2, 64, 72, 7168, 768, 768, 7340032, 3145728, 32768, 8, 65548288, 114688, 0, 0, 218104193, 0
    .long 1, 16, 16, 8192, 0, 256, 8388608, 3145728, 32768, 8, 16777216, 131072, 0, 0, 218105866, 0
    .long 2, 64, 72, 7168, 1536, 1536, 7340032, 1048576, 32768, 8, 58220544, 114688, 0, 0, 218103937, 0
    .long 2, 64, 72, 7168, 0, 0, 7340032, 3145728, 32768, 8, 65536000, 114688, 0, 0, 218104193, 0
    .long 2, 64, 72, 7168, 768, 768, 7340032, 2621440, 32768, 8, 63713280, 114688, 0, 0, 218104129, 0
    .long 2, 64, 72, 7168, 256, 256, 7340032, 1048576, 32768, 8, 58200064, 114688, 0, 0, 218103937, 0
    .long 2, 64, 72, 7168, 1024, 1024, 7340032, 3145728, 32768, 8, 65552384, 114688, 0, 0, 218104193, 0
    .long 1, 16, 16, 8192, 1024, 1280, 8388608, 2621440, 32768, 8, 14696448, 131072, 0, 0, 218105626, 0
    .long 1, 32, 32, 8192, 0, 256, 8388608, 2621440, 32768, 8, 48234496, 131072, 0, 0, 218105610, 0
    .long 1, 16, 16, 8192, 0, 256, 8388608, 2621440, 32768, 8, 14680064, 131072, 0, 0, 218105610, 0
    .long 5, 218108160, 0, 0, 0, 0, 0, 8, 0, 0, 0, 0, 218112000, 11, 218106945, 0
    .long 2, 64, 72, 7168, 256, 256, 7340032, 524288, 32768, 8, 56365056, 114688, 0, 0, 218103873, 0
    .long 2, 64, 72, 7168, 1024, 1024, 7340032, 0, 32768, 8, 54542336, 114688, 0, 0, 218103809, 0
    .long 1, 24, 24, 8192, 0, 256, 8388608, 3145728, 32768, 8, 33554432, 131072, 0, 0, 218105866, 0
    .long 2, 64, 72, 7168, 1536, 1536, 7340032, 0, 32768, 8, 54550528, 114688, 0, 0, 218103809, 0
    .long 5, 218107904, 0, 0, 0, 0, 0, 0, 0, 0, 0, 0, 218112000, 3, 218106881, 0
    .long 1, 32, 32, 8192, 512, 768, 8388608, 3145728, 32768, 8, 50339840, 131072, 0, 0, 218105866, 0
    .long 5, 218108176, 0, 0, 4, 0, 0, 8, 0, 0, 0, 0, 218112000, 11, 218106945, 0
    .long 1, 24, 24, 8192, 1536, 1792, 8388608, 2621440, 32768, 8, 31481856, 131072, 0, 0, 218105626, 0
    .long 1, 32, 32, 8192, 1024, 1280, 8388608, 2621440, 32768, 8, 48250880, 131072, 0, 0, 218105626, 0
    .long 2, 64, 72, 7168, 768, 768, 7340032, 1048576, 32768, 8, 58208256, 114688, 0, 0, 218103937, 0
    .long 2, 64, 72, 7168, 768, 768, 7340032, 524288, 32768, 8, 56373248, 114688, 0, 0, 218103873, 0
    .long 2, 64, 72, 7168, 512, 512, 7340032, 524288, 32768, 8, 56369152, 114688, 0, 0, 218103873, 0
    .long 2, 64, 72, 7168, 1024, 1024, 7340032, 1048576, 32768, 8, 58212352, 114688, 0, 0, 218103937, 0
    .long 1, 32, 32, 8192, 512, 768, 8388608, 2621440, 32768, 8, 48242688, 131072, 0, 0, 218105610, 0
    .long 2, 64, 72, 7168, 512, 512, 7340032, 1048576, 32768, 8, 58204160, 114688, 0, 0, 218103937, 0
    .long 1, 16, 16, 8192, 1024, 1280, 8388608, 3670016, 32768, 8, 18890752, 131072, 0, 0, 218106138, 0
    .long 2, 64, 72, 7168, 1024, 1024, 7340032, 524288, 32768, 8, 56377344, 114688, 0, 0, 218103873, 0
    .long 1, 16, 16, 8192, 1024, 1280, 8388608, 3145728, 32768, 8, 16793600, 131072, 0, 0, 218105882, 0
    .long 5, 218107920, 0, 0, 4, 0, 0, 0, 0, 0, 0, 0, 218112000, 3, 218106881, 0
    .long 5, 218107920, 0, 0, 4, 0, 0, 4, 0, 0, 0, 0, 218112000, 7, 218106881, 0
    .long 5, 218108176, 0, 0, 4, 0, 0, 12, 0, 0, 0, 0, 218112000, 15, 218106945, 0
    .long 5, 218108160, 0, 0, 0, 0, 0, 12, 0, 0, 0, 0, 218112000, 15, 218106945, 0
    .long 5, 218107904, 0, 0, 0, 0, 0, 4, 0, 0, 0, 0, 218112000, 7, 218106881, 0
    .long 1, 32, 32, 8192, 0, 256, 8388608, 3145728, 32768, 8, 50331648, 131072, 0, 0, 218105866, 0
    .long 2, 64, 72, 7168, 512, 512, 7340032, 1572864, 32768, 8, 60039168, 114688, 0, 0, 218104001, 0
    .long 2, 64, 72, 7168, 0, 0, 7340032, 1572864, 32768, 8, 60030976, 114688, 0, 0, 218104001, 0
    .long 2, 64, 72, 7168, 256, 256, 7340032, 0, 32768, 8, 54530048, 114688, 0, 0, 218103809, 0
    .long 1, 24, 24, 8192, 1536, 1792, 8388608, 3145728, 32768, 8, 33579008, 131072, 0, 0, 218105882, 0
    .long 2, 64, 72, 7168, 1536, 1536, 7340032, 3145728, 32768, 8, 65560576, 114688, 0, 0, 218104193, 0
    .long 2, 64, 72, 7168, 0, 0, 7340032, 2621440, 32768, 8, 63700992, 114688, 0, 0, 218104129, 0
    .long 2, 64, 72, 7168, 512, 512, 7340032, 0, 32768, 8, 54534144, 114688, 0, 0, 218103809, 0
    .long 2, 64, 72, 7168, 1024, 1024, 7340032, 2097152, 32768, 8, 61882368, 114688, 0, 0, 218104065, 0
    .long 2, 64, 72, 7168, 1536, 1536, 7340032, 524288, 32768, 8, 56385536, 114688, 0, 0, 218103873, 0
    .long 2, 64, 72, 7168, 256, 256, 7340032, 2097152, 32768, 8, 61870080, 114688, 0, 0, 218104065, 0
    .long 2, 64, 72, 7168, 1536, 1536, 7340032, 1572864, 32768, 8, 60055552, 114688, 0, 0, 218104001, 0
    .long 2, 64, 72, 7168, 0, 0, 7340032, 0, 32768, 8, 54525952, 114688, 0, 0, 218103809, 0
    .long 2, 64, 72, 7168, 1024, 1024, 7340032, 3670016, 32768, 8, 67387392, 114688, 0, 0, 218104257, 0
    .long 2, 64, 72, 7168, 0, 0, 7340032, 524288, 32768, 8, 56360960, 114688, 0, 0, 218103873, 0
    .long 2, 64, 72, 7168, 1280, 1280, 7340032, 524288, 32768, 8, 56381440, 114688, 0, 0, 218103873, 0
    .long 2, 64, 72, 7168, 1536, 1536, 7340032, 2097152, 32768, 8, 61890560, 114688, 0, 0, 218104065, 0
    .long 1, 24, 24, 8192, 1536, 1792, 8388608, 3670016, 32768, 8, 35676160, 131072, 0, 0, 218106138, 0
    .long 2, 64, 72, 7168, 512, 512, 7340032, 2621440, 32768, 8, 63709184, 114688, 0, 0, 218104129, 0
    .long 2, 64, 72, 7168, 1024, 1024, 7340032, 1572864, 32768, 8, 60047360, 114688, 0, 0, 218104001, 0
    .long 2, 64, 72, 7168, 0, 0, 7340032, 2097152, 32768, 8, 61865984, 114688, 0, 0, 218104065, 0
    .long 2, 64, 72, 7168, 1280, 1280, 7340032, 3145728, 32768, 8, 65556480, 114688, 0, 0, 218104193, 0
    .long 2, 64, 72, 7168, 256, 256, 7340032, 1572864, 32768, 8, 60035072, 114688, 0, 0, 218104001, 0
    .long 2, 64, 72, 7168, 256, 256, 7340032, 2621440, 32768, 8, 63705088, 114688, 0, 0, 218104129, 0
    .long 1, 24, 24, 8192, 0, 256, 8388608, 3670016, 32768, 8, 35651584, 131072, 0, 0, 218106122, 0
    .long 2, 64, 72, 7168, 1536, 1536, 7340032, 2621440, 32768, 8, 63725568, 114688, 0, 0, 218104129, 0
    .long 2, 64, 72, 7168, 1024, 1024, 7340032, 2621440, 32768, 8, 63717376, 114688, 0, 0, 218104129, 0
    .long 2, 64, 72, 7168, 1280, 1280, 7340032, 3670016, 32768, 8, 67391488, 114688, 0, 0, 218104257, 0
    .long 2, 64, 72, 7168, 1280, 1280, 7340032, 1572864, 32768, 8, 60051456, 114688, 0, 0, 218104001, 0
    .long 1, 40, 40, 2048, 512, 768, 8388608, 180355072, 131072, 16, 76554240, 32768, 218112000, 25, 218106504, 0
    .long 1, 80, 80, 2048, 0, 256, 7340032, 58195968, 114688, 14, 118489088, 32768, 218103936, 14, 218106498, 0
    .long 1, 24, 24, 8192, 1024, 1280, 8388608, 3670016, 32768, 8, 35667968, 131072, 0, 0, 218106138, 0
    .long 1, 40, 40, 2048, 0, 256, 8388608, 180355072, 131072, 16, 76546048, 32768, 218112000, 25, 218106504, 0
    .long 1, 40, 40, 2048, 0, 256, 8388608, 178257920, 131072, 16, 76021760, 32768, 218106944, 8, 218106440, 0
    .long 2, 64, 72, 7168, 512, 512, 7340032, 3145728, 32768, 8, 65544192, 114688, 0, 0, 218104193, 0
    .long 1, 40, 40, 2048, 512, 768, 8388608, 178257920, 131072, 16, 76029952, 32768, 218106944, 8, 218106440, 0
    .long 1, 80, 80, 2048, 512, 768, 7340032, 58195968, 114688, 14, 118497280, 32768, 218103936, 14, 218106498, 0
    .long 2, 64, 72, 7168, 256, 256, 7340032, 3145728, 32768, 8, 65540096, 114688, 0, 0, 218104193, 0
    .long 1, 32, 32, 8192, 512, 768, 8388608, 3670016, 32768, 8, 52436992, 131072, 0, 0, 218106122, 0
    .long 1, 16, 16, 8192, 512, 768, 8388608, 3670016, 32768, 8, 18882560, 131072, 0, 0, 218106122, 0
    .long 1, 40, 40, 2048, 512, 768, 8388608, 176160768, 131072, 16, 75505664, 32768, 218106880, 8, 218106376, 0
    .long 1, 40, 40, 2048, 0, 256, 8388608, 176160768, 131072, 16, 75497472, 32768, 218106880, 8, 218106376, 0
    .long 1, 32, 32, 8192, 0, 256, 8388608, 3670016, 32768, 8, 52428800, 131072, 0, 0, 218106122, 0
    .long 1, 24, 24, 8192, 512, 768, 8388608, 3670016, 32768, 8, 35659776, 131072, 0, 0, 218106122, 0
    .long 1, 16, 16, 8192, 0, 256, 8388608, 3670016, 32768, 8, 18874368, 131072, 0, 0, 218106122, 0
    .long 1, 32, 32, 8192, 1024, 1280, 8388608, 3670016, 32768, 8, 52445184, 131072, 0, 0, 218106138, 0
    .long 1, 32, 32, 8192, 1536, 1792, 8388608, 3670016, 32768, 8, 52453376, 131072, 0, 0, 218106138, 0
    .long 2, 64, 72, 7168, 512, 512, 7340032, 3670016, 32768, 8, 67379200, 114688, 0, 0, 218104257, 0
    .long 2, 64, 72, 7168, 0, 0, 7340032, 3670016, 32768, 8, 67371008, 114688, 0, 0, 218104257, 0
    .long 1, 16, 16, 8192, 1536, 1792, 8388608, 3670016, 32768, 8, 18898944, 131072, 0, 0, 218106138, 0
    .long 2, 64, 72, 7168, 1536, 1536, 7340032, 3670016, 32768, 8, 67395584, 114688, 0, 0, 218104257, 0
    .long 1, 80, 80, 2048, 512, 768, 7340032, 56360960, 114688, 14, 117972992, 32768, 218103872, 14, 218106434, 0
    .long 1, 80, 80, 2048, 0, 256, 7340032, 54525952, 114688, 14, 117440512, 32768, 218103808, 14, 218106370, 0
    .long 1, 80, 80, 2048, 0, 256, 7340032, 61865984, 114688, 14, 119537664, 32768, 218104064, 14, 218106626, 0
    .long 1, 80, 80, 2048, 0, 256, 7340032, 56360960, 114688, 14, 117964800, 32768, 218103872, 14, 218106434, 0
    .long 2, 64, 72, 7168, 256, 256, 7340032, 3670016, 32768, 8, 67375104, 114688, 0, 0, 218104257, 0
    .long 1, 40, 40, 2048, 0, 256, 8388608, 182452224, 131072, 16, 77070336, 32768, 218112000, 33, 218106568, 0
    .long 1, 40, 40, 2048, 512, 768, 8388608, 182452224, 131072, 16, 77078528, 32768, 218112000, 33, 218106568, 0
    .long 1, 80, 80, 2048, 512, 768, 7340032, 61865984, 114688, 14, 119545856, 32768, 218104064, 14, 218106626, 0
    .long 1, 80, 80, 2048, 512, 768, 7340032, 54525952, 114688, 14, 117448704, 32768, 218103808, 14, 218106370, 0
    .long 1, 80, 80, 2048, 512, 768, 7340032, 60030976, 114688, 14, 119021568, 32768, 218104000, 14, 218106562, 0
    .long 1, 80, 80, 2048, 0, 256, 7340032, 60030976, 114688, 14, 119013376, 32768, 218104000, 14, 218106562, 0
    .long 1, 40, 40, 2048, 512, 768, 8388608, 184549376, 131072, 8, 77602816, 32768, 218112000, 40, 218106628, 0
    .long 1, 40, 40, 2048, 0, 256, 8388608, 184549376, 131072, 8, 77594624, 32768, 218112000, 40, 218106628, 0
    .long 1, 40, 40, 2048, 1536, 1792, 8388608, 184549376, 131072, 8, 77619200, 32768, 218112000, 40, 218106628, 0
    .long 1, 40, 40, 2048, 1024, 1280, 8388608, 184549376, 131072, 8, 77611008, 32768, 218112000, 40, 218106628, 0
    .long 1, 80, 80, 2048, 1536, 1792, 7340032, 63700992, 114688, 7, 120086528, 32768, 218104128, 7, 218106689, 0
    .long 1, 80, 80, 2048, 1024, 1280, 7340032, 63700992, 114688, 7, 120078336, 32768, 218104128, 7, 218106689, 0
    .long 1, 80, 80, 2048, 0, 256, 7340032, 63700992, 114688, 7, 120061952, 32768, 218104128, 7, 218106689, 0
    .long 1, 80, 80, 2048, 512, 768, 7340032, 63700992, 114688, 7, 120070144, 32768, 218104128, 7, 218106689, 0
    .long 1, 80, 80, 2048, 512, 768, 7340032, 65536000, 114688, 7, 120594432, 32768, 218104192, 7, 218106753, 0
    .long 1, 80, 80, 2048, 0, 256, 7340032, 65536000, 114688, 7, 120586240, 32768, 218104192, 7, 218106753, 0
    .long 1, 80, 80, 2048, 1536, 1792, 7340032, 65536000, 114688, 7, 120610816, 32768, 218104192, 7, 218106753, 0
    .long 1, 40, 40, 2048, 512, 768, 8388608, 186646528, 131072, 8, 78127104, 32768, 218112000, 48, 218106692, 0
    .long 1, 80, 80, 2048, 1024, 1280, 7340032, 65536000, 114688, 7, 120602624, 32768, 218104192, 7, 218106753, 0
    .long 1, 40, 40, 2048, 1024, 1280, 8388608, 186646528, 131072, 8, 78135296, 32768, 218112000, 48, 218106692, 0
    .long 1, 40, 40, 2048, 1536, 1792, 8388608, 186646528, 131072, 8, 78143488, 32768, 218112000, 48, 218106692, 0
    .long 1, 40, 40, 2048, 0, 256, 8388608, 186646528, 131072, 8, 78118912, 32768, 218112000, 48, 218106692, 0
    .long 1, 80, 80, 2048, 1536, 1792, 7340032, 67371008, 114688, 7, 121135104, 32768, 218104256, 7, 218106817, 0
    .long 1, 80, 80, 2048, 512, 768, 7340032, 67371008, 114688, 7, 121118720, 32768, 218104256, 7, 218106817, 0
    .long 1, 80, 80, 2048, 1024, 1280, 7340032, 67371008, 114688, 7, 121126912, 32768, 218104256, 7, 218106817, 0
    .long 1, 80, 80, 2048, 0, 256, 7340032, 67371008, 114688, 7, 121110528, 32768, 218104256, 7, 218106817, 0
    .long 6, 1, 0, 2, 0, 16, 0, 23, 0, 0, 0, 0, 0, 0, 0, 0
    .long 6, 1, 0, 2, 0, 16, 0, 17, 0, 0, 0, 0, 0, 0, 0, 0
    .long 6, 1, 0, 2, 0, 16, 0, 20, 0, 0, 0, 0, 0, 0, 0, 0
    .long 6, 1, 0, 2, 0, 16, 0, 10, 0, 0, 0, 0, 0, 0, 0, 0
    .long 6, 1, 0, 2, 0, 16, 0, 6, 0, 0, 0, 0, 0, 0, 0, 0
    .long 6, 1, 0, 2, 0, 16, 0, 13, 0, 0, 0, 0, 0, 0, 0, 0
    .long 6, 1, 0, 1, 0, 16, 0, 38, 0, 0, 0, 0, 0, 0, 0, 0
    .long 6, 1, 0, 2, 0, 16, 0, 18, 0, 0, 0, 0, 0, 0, 0, 0
    .long 6, 1, 0, 2, 0, 16, 0, 9, 0, 0, 0, 0, 0, 0, 0, 0
    .long 6, 1, 0, 2, 0, 16, 0, 2, 0, 0, 0, 0, 0, 0, 0, 0
    .long 6, 1, 0, 2, 0, 16, 0, 5, 0, 0, 0, 0, 0, 0, 0, 0
    .long 6, 1, 0, 1, 0, 16, 0, 34, 0, 0, 0, 0, 0, 0, 0, 0
    .long 6, 1, 0, 2, 0, 16, 0, 7, 0, 0, 0, 0, 0, 0, 0, 0
    .long 6, 1, 0, 2, 0, 16, 0, 1, 0, 0, 0, 0, 0, 0, 0, 0
    .long 6, 1, 0, 2, 0, 16, 0, 12, 0, 0, 0, 0, 0, 0, 0, 0
    .long 6, 1, 0, 2, 0, 16, 0, 14, 0, 0, 0, 0, 0, 0, 0, 0
    .long 6, 1, 0, 2, 0, 16, 0, 0, 0, 0, 0, 0, 0, 0, 0, 0
    .long 6, 1, 0, 2, 0, 16, 0, 3, 0, 0, 0, 0, 0, 0, 0, 0
    .long 6, 1, 0, 2, 0, 16, 0, 22, 0, 0, 0, 0, 0, 0, 0, 0
    .long 6, 1, 0, 2, 0, 16, 0, 21, 0, 0, 0, 0, 0, 0, 0, 0
    .long 6, 1, 0, 2, 0, 16, 0, 8, 0, 0, 0, 0, 0, 0, 0, 0
    .long 6, 1, 0, 2, 0, 16, 0, 15, 0, 0, 0, 0, 0, 0, 0, 0
    .long 6, 1, 0, 2, 0, 16, 0, 19, 0, 0, 0, 0, 0, 0, 0, 0
    .long 6, 1, 0, 2, 0, 16, 0, 11, 0, 0, 0, 0, 0, 0, 0, 0
    .long 6, 1, 0, 2, 0, 16, 0, 16, 0, 0, 0, 0, 0, 0, 0, 0
    .long 6, 1, 0, 2, 0, 16, 0, 4, 0, 0, 0, 0, 0, 0, 0, 0
    .long 6, 0, 0, 0, 0, 0, 0, 54, 0, 0, 0, 0, 0, 0, 0, 0
    .long 6, 0, 0, 0, 0, 0, 0, 51, 0, 0, 0, 0, 0, 0, 0, 0
    .long 6, 0, 0, 0, 0, 0, 0, 48, 0, 0, 0, 0, 0, 0, 0, 0
    .long 6, 0, 0, 0, 0, 0, 0, 49, 0, 0, 0, 0, 0, 0, 0, 0
    .long 6, 0, 0, 0, 0, 0, 0, 50, 0, 0, 0, 0, 0, 0, 0, 0
    .long 6, 0, 0, 0, 0, 0, 0, 52, 0, 0, 0, 0, 0, 0, 0, 0
    .long 6, 0, 0, 0, 0, 0, 0, 53, 0, 0, 0, 0, 0, 0, 0, 0
    .long 6, 0, 0, 0, 0, 0, 0, 55, 0, 0, 0, 0, 0, 0, 0, 0
    .long 6, 1, 0, 1, 0, 16, 0, 32, 0, 0, 0, 0, 0, 0, 0, 0
    .long 6, 1, 0, 1, 0, 16, 0, 33, 0, 0, 0, 0, 0, 0, 0, 0
    .long 6, 1, 0, 1, 0, 16, 0, 35, 0, 0, 0, 0, 0, 0, 0, 0
    .long 6, 1, 0, 1, 0, 16, 0, 36, 0, 0, 0, 0, 0, 0, 0, 0
    .long 6, 1, 0, 1, 0, 16, 0, 37, 0, 0, 0, 0, 0, 0, 0, 0
    .long 6, 1, 0, 1, 0, 16, 0, 39, 0, 0, 0, 0, 0, 0, 0, 0
    .long 6, 1, 0, 2, 0, 16, 0, 24, 0, 0, 0, 0, 0, 0, 0, 0
    .long 6, 1, 0, 2, 0, 16, 0, 26, 0, 0, 0, 0, 0, 0, 0, 0
    .long 6, 1, 0, 2, 0, 16, 0, 27, 0, 0, 0, 0, 0, 0, 0, 0
    .long 6, 1, 0, 2, 0, 16, 0, 28, 0, 0, 0, 0, 0, 0, 0, 0
    .long 6, 1, 0, 2, 0, 16, 0, 29, 0, 0, 0, 0, 0, 0, 0, 0
    .long 6, 1, 0, 2, 0, 16, 0, 30, 0, 0, 0, 0, 0, 0, 0, 0
    .long 6, 1, 0, 2, 0, 16, 0, 31, 0, 0, 0, 0, 0, 0, 0, 0
    .long 6, 1, 0, 2, 0, 16, 0, 25, 0, 0, 0, 0, 0, 0, 0, 0
    .long 6, 0, 0, 1, 0, 16, 0, 40, 0, 0, 0, 0, 0, 0, 0, 0
    .long 6, 0, 0, 1, 0, 16, 0, 41, 0, 0, 0, 0, 0, 0, 0, 0
    .long 6, 0, 0, 1, 0, 16, 0, 42, 0, 0, 0, 0, 0, 0, 0, 0
    .long 6, 0, 0, 1, 0, 16, 0, 43, 0, 0, 0, 0, 0, 0, 0, 0
    .long 6, 0, 0, 1, 0, 16, 0, 44, 0, 0, 0, 0, 0, 0, 0, 0
    .long 6, 0, 0, 1, 0, 16, 0, 47, 0, 0, 0, 0, 0, 0, 0, 0
    .long 6, 0, 0, 1, 0, 16, 0, 46, 0, 0, 0, 0, 0, 0, 0, 0
    .long 6, 0, 0, 1, 0, 16, 0, 45, 0, 0, 0, 0, 0, 0, 0, 0
    .long 6, 0, 0, 0, 0, 0, 0, 56, 0, 0, 0, 0, 0, 0, 0, 0
    .long 6, 0, 0, 0, 0, 0, 0, 57, 0, 0, 0, 0, 0, 0, 0, 0
    .long 6, 0, 0, 0, 0, 0, 0, 58, 0, 0, 0, 0, 0, 0, 0, 0
    .long 6, 0, 0, 0, 0, 0, 0, 59, 0, 0, 0, 0, 0, 0, 0, 0
    .long 6, 0, 0, 0, 0, 0, 0, 60, 0, 0, 0, 0, 0, 0, 0, 0
    .long 7, 0, 0, 0, 0, 0, 0, 61, 0, 0, 0, 0, 0, 0, 0, 0
    .long 7, 0, 0, 0, 1, 0, 0, 61, 0, 0, 0, 0, 0, 0, 0, 0
    .long 7, 0, 0, 0, 2, 0, 0, 61, 0, 0, 0, 0, 0, 0, 0, 0
    .long 7, 0, 0, 0, 3, 0, 0, 61, 0, 0, 0, 0, 0, 0, 0, 0
    .long 7, 0, 0, 0, 0, 0, 0, 62, 0, 0, 0, 0, 0, 0, 0, 0
    .long 7, 0, 0, 0, 1, 0, 0, 62, 0, 0, 0, 0, 0, 0, 0, 0
    .long 7, 0, 0, 0, 2, 0, 0, 62, 0, 0, 0, 0, 0, 0, 0, 0
    .long 7, 0, 0, 0, 3, 0, 0, 62, 0, 0, 0, 0, 0, 0, 0, 0
    .long 7, 0, 0, 0, 0, 0, 0, 63, 0, 0, 0, 0, 0, 0, 0, 0
    .long 7, 0, 0, 0, 1, 0, 0, 63, 0, 0, 0, 0, 0, 0, 0, 0
    .long 7, 0, 0, 0, 2, 0, 0, 63, 0, 0, 0, 0, 0, 0, 0, 0
    .long 7, 0, 0, 0, 3, 0, 0, 63, 0, 0, 0, 0, 0, 0, 0, 0
    .long 0, 0, 0, 0, 0, 0, 0, 0, 0, 0, 0, 0, 0, 0, 0, 0
    .long 4, 24, 24, 8192, 2048, 264192, 8388608, 0, 32768, 4, 21004288, 131072, 0, 0, 218104353, 0
    .long 4, 24, 24, 8192, 2304, 264448, 8388608, 0, 32768, 4, 21008384, 131072, 0, 0, 218104353, 0
    .long 4, 24, 24, 8192, 2560, 264704, 8388608, 0, 32768, 4, 21012480, 131072, 0, 0, 218104353, 0
    .long 4, 24, 24, 8192, 2816, 264960, 8388608, 0, 32768, 4, 21016576, 131072, 0, 0, 218104353, 0
    .long 4, 24, 24, 8192, 3072, 265216, 8388608, 0, 32768, 4, 21020672, 131072, 0, 0, 218104369, 0
    .long 4, 24, 24, 8192, 3328, 265472, 8388608, 0, 32768, 4, 21024768, 131072, 0, 0, 218104369, 0
    .long 4, 24, 24, 8192, 3584, 265728, 8388608, 0, 32768, 4, 21028864, 131072, 0, 0, 218104369, 0
    .long 4, 24, 24, 8192, 3840, 265984, 8388608, 0, 32768, 4, 21032960, 131072, 0, 0, 218104369, 0
    .long 4, 32, 32, 8192, 2048, 264192, 8388608, 0, 32768, 4, 37781504, 131072, 0, 0, 218104353, 0
    .long 4, 32, 32, 8192, 2304, 264448, 8388608, 0, 32768, 4, 37785600, 131072, 0, 0, 218104353, 0
    .long 4, 32, 32, 8192, 2560, 264704, 8388608, 0, 32768, 4, 37789696, 131072, 0, 0, 218104353, 0
    .long 4, 32, 32, 8192, 2816, 264960, 8388608, 0, 32768, 4, 37793792, 131072, 0, 0, 218104353, 0
    .long 4, 32, 32, 8192, 3072, 265216, 8388608, 0, 32768, 4, 37797888, 131072, 0, 0, 218104369, 0
    .long 4, 32, 32, 8192, 3328, 265472, 8388608, 0, 32768, 4, 37801984, 131072, 0, 0, 218104369, 0
    .long 4, 32, 32, 8192, 3584, 265728, 8388608, 0, 32768, 4, 37806080, 131072, 0, 0, 218104369, 0
    .long 4, 32, 32, 8192, 3840, 265984, 8388608, 0, 32768, 4, 37810176, 131072, 0, 0, 218104369, 0
    .long 4, 24, 24, 8192, 2048, 264192, 8388608, 262144, 32768, 4, 22052864, 131072, 0, 0, 218104356, 0
    .long 4, 24, 24, 8192, 2304, 264448, 8388608, 262144, 32768, 4, 22056960, 131072, 0, 0, 218104356, 0
    .long 4, 24, 24, 8192, 2560, 264704, 8388608, 262144, 32768, 4, 22061056, 131072, 0, 0, 218104356, 0
    .long 4, 24, 24, 8192, 2816, 264960, 8388608, 262144, 32768, 4, 22065152, 131072, 0, 0, 218104356, 0
    .long 4, 24, 24, 8192, 3072, 265216, 8388608, 262144, 32768, 4, 22069248, 131072, 0, 0, 218104372, 0
    .long 4, 24, 24, 8192, 3328, 265472, 8388608, 262144, 32768, 4, 22073344, 131072, 0, 0, 218104372, 0
    .long 4, 24, 24, 8192, 3584, 265728, 8388608, 262144, 32768, 4, 22077440, 131072, 0, 0, 218104372, 0
    .long 4, 24, 24, 8192, 3840, 265984, 8388608, 262144, 32768, 4, 22081536, 131072, 0, 0, 218104372, 0
    .long 4, 32, 32, 8192, 2048, 264192, 8388608, 262144, 32768, 4, 38830080, 131072, 0, 0, 218104356, 0
    .long 4, 32, 32, 8192, 2304, 264448, 8388608, 262144, 32768, 4, 38834176, 131072, 0, 0, 218104356, 0
    .long 4, 32, 32, 8192, 2560, 264704, 8388608, 262144, 32768, 4, 38838272, 131072, 0, 0, 218104356, 0
    .long 4, 32, 32, 8192, 2816, 264960, 8388608, 262144, 32768, 4, 38842368, 131072, 0, 0, 218104356, 0
    .long 4, 32, 32, 8192, 3072, 265216, 8388608, 262144, 32768, 4, 38846464, 131072, 0, 0, 218104372, 0
    .long 4, 32, 32, 8192, 3328, 265472, 8388608, 262144, 32768, 4, 38850560, 131072, 0, 0, 218104372, 0
    .long 4, 32, 32, 8192, 3584, 265728, 8388608, 262144, 32768, 4, 38854656, 131072, 0, 0, 218104372, 0
    .long 4, 32, 32, 8192, 3840, 265984, 8388608, 262144, 32768, 4, 38858752, 131072, 0, 0, 218104372, 0
    .long 4, 32, 32, 8192, 2560, 264704, 8388608, 786432, 32768, 4, 40935424, 131072, 0, 0, 218104612, 0
    .long 4, 32, 32, 8192, 3584, 265728, 8388608, 786432, 32768, 4, 40951808, 131072, 0, 0, 218104628, 0
    .long 4, 32, 32, 8192, 3840, 265984, 8388608, 524288, 32768, 4, 39907328, 131072, 0, 0, 218104625, 0
    .long 4, 24, 24, 8192, 2560, 264704, 8388608, 786432, 32768, 4, 24158208, 131072, 0, 0, 218104612, 0
    .long 4, 32, 32, 8192, 2560, 264704, 8388608, 524288, 32768, 4, 39886848, 131072, 0, 0, 218104609, 0
    .long 4, 32, 32, 8192, 3840, 265984, 8388608, 786432, 32768, 4, 40955904, 131072, 0, 0, 218104628, 0
    .long 4, 24, 24, 8192, 3584, 265728, 8388608, 786432, 32768, 4, 24174592, 131072, 0, 0, 218104628, 0
    .long 4, 24, 24, 8192, 2304, 264448, 8388608, 524288, 32768, 4, 23105536, 131072, 0, 0, 218104609, 0
    .long 4, 24, 24, 8192, 2816, 264960, 8388608, 524288, 32768, 4, 23113728, 131072, 0, 0, 218104609, 0
    .long 4, 24, 24, 8192, 3328, 265472, 8388608, 524288, 32768, 4, 23121920, 131072, 0, 0, 218104625, 0
    .long 4, 24, 24, 8192, 2816, 264960, 8388608, 786432, 32768, 4, 24162304, 131072, 0, 0, 218104612, 0
    .long 4, 32, 32, 8192, 2304, 264448, 8388608, 524288, 32768, 4, 39882752, 131072, 0, 0, 218104609, 0
    .long 4, 32, 32, 8192, 3072, 265216, 8388608, 524288, 32768, 4, 39895040, 131072, 0, 0, 218104625, 0
    .long 4, 24, 24, 8192, 3584, 265728, 8388608, 524288, 32768, 4, 23126016, 131072, 0, 0, 218104625, 0
    .long 4, 32, 32, 8192, 2816, 264960, 8388608, 524288, 32768, 4, 39890944, 131072, 0, 0, 218104609, 0
    .long 4, 24, 24, 8192, 2048, 264192, 8388608, 524288, 32768, 4, 23101440, 131072, 0, 0, 218104609, 0
    .long 4, 32, 32, 8192, 3072, 265216, 8388608, 786432, 32768, 4, 40943616, 131072, 0, 0, 218104628, 0
    .long 4, 24, 24, 8192, 3840, 265984, 8388608, 786432, 32768, 4, 24178688, 131072, 0, 0, 218104628, 0
    .long 4, 32, 32, 8192, 2048, 264192, 8388608, 524288, 32768, 4, 39878656, 131072, 0, 0, 218104609, 0
    .long 4, 24, 24, 8192, 3328, 265472, 8388608, 786432, 32768, 4, 24170496, 131072, 0, 0, 218104628, 0
    .long 4, 32, 32, 8192, 2304, 264448, 8388608, 786432, 32768, 4, 40931328, 131072, 0, 0, 218104612, 0
    .long 4, 24, 24, 8192, 3072, 265216, 8388608, 786432, 32768, 4, 24166400, 131072, 0, 0, 218104628, 0
    .long 4, 24, 24, 8192, 2560, 264704, 8388608, 524288, 32768, 4, 23109632, 131072, 0, 0, 218104609, 0
    .long 4, 24, 24, 8192, 2304, 264448, 8388608, 786432, 32768, 4, 24154112, 131072, 0, 0, 218104612, 0
    .long 4, 32, 32, 8192, 3328, 265472, 8388608, 786432, 32768, 4, 40947712, 131072, 0, 0, 218104628, 0
    .long 4, 24, 24, 8192, 2048, 264192, 8388608, 786432, 32768, 4, 24150016, 131072, 0, 0, 218104612, 0
    .long 4, 32, 32, 8192, 3584, 265728, 8388608, 524288, 32768, 4, 39903232, 131072, 0, 0, 218104625, 0
    .long 4, 32, 32, 8192, 2816, 264960, 8388608, 786432, 32768, 4, 40939520, 131072, 0, 0, 218104612, 0
    .long 4, 32, 32, 8192, 3328, 265472, 8388608, 524288, 32768, 4, 39899136, 131072, 0, 0, 218104625, 0
    .long 4, 24, 24, 8192, 3072, 265216, 8388608, 524288, 32768, 4, 23117824, 131072, 0, 0, 218104625, 0
    .long 4, 24, 24, 8192, 3840, 265984, 8388608, 524288, 32768, 4, 23130112, 131072, 0, 0, 218104625, 0
    .long 4, 32, 32, 8192, 2048, 264192, 8388608, 786432, 32768, 4, 40927232, 131072, 0, 0, 218104612, 0
    .long 1, 16, 16, 8192, 2048, 2304, 8388608, 1572864, 32768, 8, 10518528, 131072, 0, 0, 218105130, 0
    .long 1, 32, 32, 8192, 2560, 2816, 8388608, 1048576, 32768, 8, 41984000, 131072, 0, 0, 218104874, 0
    .long 1, 32, 32, 8192, 2560, 2816, 8388608, 1572864, 32768, 8, 44081152, 131072, 0, 0, 218105130, 0
    .long 1, 24, 24, 8192, 2560, 2816, 8388608, 1048576, 32768, 8, 25206784, 131072, 0, 0, 218104874, 0
    .long 1, 16, 16, 8192, 3072, 3328, 8388608, 1048576, 32768, 8, 8437760, 131072, 0, 0, 218104890, 0
    .long 1, 16, 16, 8192, 3584, 3840, 8388608, 1048576, 32768, 8, 8445952, 131072, 0, 0, 218104890, 0
    .long 1, 32, 32, 8192, 3584, 3840, 8388608, 1048576, 32768, 8, 42000384, 131072, 0, 0, 218104890, 0
    .long 1, 24, 24, 8192, 3072, 3328, 8388608, 1048576, 32768, 8, 25214976, 131072, 0, 0, 218104890, 0
    .long 1, 24, 24, 8192, 3584, 3840, 8388608, 2097152, 32768, 8, 29417472, 131072, 0, 0, 218105402, 0
    .long 1, 24, 24, 8192, 3584, 3840, 8388608, 1048576, 32768, 8, 25223168, 131072, 0, 0, 218104890, 0
    .long 1, 32, 32, 8192, 3072, 3328, 8388608, 1048576, 32768, 8, 41992192, 131072, 0, 0, 218104890, 0
    .long 1, 24, 24, 8192, 3072, 3328, 8388608, 2097152, 32768, 8, 29409280, 131072, 0, 0, 218105402, 0
    .long 1, 24, 24, 8192, 2048, 2304, 8388608, 1572864, 32768, 8, 27295744, 131072, 0, 0, 218105130, 0
    .long 1, 32, 32, 8192, 2048, 2304, 8388608, 1572864, 32768, 8, 44072960, 131072, 0, 0, 218105130, 0
    .long 1, 24, 24, 8192, 3072, 3328, 8388608, 1572864, 32768, 8, 27312128, 131072, 0, 0, 218105146, 0
    .long 1, 16, 16, 8192, 2048, 2304, 8388608, 1048576, 32768, 8, 8421376, 131072, 0, 0, 218104874, 0
    .long 1, 24, 24, 8192, 2560, 2816, 8388608, 1572864, 32768, 8, 27303936, 131072, 0, 0, 218105130, 0
    .long 1, 16, 16, 8192, 2560, 2816, 8388608, 1572864, 32768, 8, 10526720, 131072, 0, 0, 218105130, 0
    .long 1, 32, 32, 8192, 3072, 3328, 8388608, 1572864, 32768, 8, 44089344, 131072, 0, 0, 218105146, 0
    .long 1, 16, 16, 8192, 3072, 3328, 8388608, 1572864, 32768, 8, 10534912, 131072, 0, 0, 218105146, 0
    .long 1, 32, 32, 8192, 3584, 3840, 8388608, 2097152, 32768, 8, 46194688, 131072, 0, 0, 218105402, 0
    .long 1, 24, 24, 8192, 2048, 2304, 8388608, 1048576, 32768, 8, 25198592, 131072, 0, 0, 218104874, 0
    .long 1, 24, 24, 8192, 2048, 2304, 8388608, 2097152, 32768, 8, 29392896, 131072, 0, 0, 218105386, 0
    .long 1, 16, 16, 8192, 3584, 3840, 8388608, 1572864, 32768, 8, 10543104, 131072, 0, 0, 218105146, 0
    .long 2, 64, 72, 7168, 2560, 2560, 7340032, 1572864, 32768, 8, 60071936, 114688, 0, 0, 218104001, 0
    .long 1, 32, 32, 8192, 2048, 2304, 8388608, 2097152, 32768, 8, 46170112, 131072, 0, 0, 218105386, 0
    .long 1, 32, 32, 8192, 2048, 2304, 8388608, 1048576, 32768, 8, 41975808, 131072, 0, 0, 218104874, 0
    .long 1, 32, 32, 8192, 2560, 2816, 8388608, 2097152, 32768, 8, 46178304, 131072, 0, 0, 218105386, 0
    .long 1, 24, 24, 8192, 3584, 3840, 8388608, 1572864, 32768, 8, 27320320, 131072, 0, 0, 218105146, 0
    .long 1, 32, 32, 8192, 3584, 3840, 8388608, 1572864, 32768, 8, 44097536, 131072, 0, 0, 218105146, 0
    .long 1, 16, 16, 8192, 2560, 2816, 8388608, 1048576, 32768, 8, 8429568, 131072, 0, 0, 218104874, 0
    .long 1, 32, 32, 8192, 3072, 3328, 8388608, 2097152, 32768, 8, 46186496, 131072, 0, 0, 218105402, 0
    .long 1, 16, 16, 8192, 2560, 2816, 8388608, 0, 32768, 8, 4235264, 131072, 0, 0, 218107946, 0
    .long 2, 64, 72, 7168, 2560, 2560, 7340032, 2097152, 32768, 8, 61906944, 114688, 0, 0, 218104065, 0
    .long 1, 16, 16, 8192, 3584, 3840, 8388608, 2097152, 32768, 8, 12640256, 131072, 0, 0, 218105402, 0
    .long 1, 16, 16, 8192, 2560, 2816, 8388608, 524288, 32768, 8, 6332416, 131072, 0, 0, 218108202, 0
    .long 1, 16, 16, 8192, 3584, 3840, 8388608, 3145728, 32768, 8, 16834560, 131072, 0, 0, 218105914, 0
    .long 1, 32, 32, 8192, 3584, 3840, 8388608, 2621440, 32768, 8, 48291840, 131072, 0, 0, 218105658, 0
    .long 1, 16, 16, 8192, 3072, 3328, 8388608, 0, 32768, 8, 4243456, 131072, 0, 0, 218107962, 0
    .long 1, 16, 16, 8192, 2048, 2304, 8388608, 2097152, 32768, 8, 12615680, 131072, 0, 0, 218105386, 0
    .long 1, 16, 16, 8192, 3584, 3840, 8388608, 0, 32768, 8, 4251648, 131072, 0, 0, 218107962, 0
    .long 1, 16, 16, 8192, 2048, 2304, 8388608, 524288, 32768, 8, 6324224, 131072, 0, 0, 218108202, 0
    .long 1, 24, 24, 8192, 3072, 3328, 8388608, 3145728, 32768, 8, 33603584, 131072, 0, 0, 218105914, 0
    .long 1, 24, 24, 8192, 2560, 2816, 8388608, 2621440, 32768, 8, 31498240, 131072, 0, 0, 218105642, 0
    .long 1, 16, 16, 8192, 2560, 2816, 8388608, 2621440, 32768, 8, 14721024, 131072, 0, 0, 218105642, 0
    .long 1, 16, 16, 8192, 3072, 3328, 8388608, 524288, 32768, 8, 6340608, 131072, 0, 0, 218108218, 0
    .long 2, 64, 72, 7168, 3072, 3072, 7340032, 0, 32768, 8, 54575104, 114688, 0, 0, 218103809, 0
    .long 2, 64, 72, 7168, 2560, 2560, 7340032, 0, 32768, 8, 54566912, 114688, 0, 0, 218103809, 0
    .long 2, 64, 72, 7168, 3072, 3072, 7340032, 1048576, 32768, 8, 58245120, 114688, 0, 0, 218103937, 0
    .long 1, 16, 16, 8192, 2048, 2304, 8388608, 0, 32768, 8, 4227072, 131072, 0, 0, 218107946, 0
    .long 1, 16, 16, 8192, 3584, 3840, 8388608, 524288, 32768, 8, 6348800, 131072, 0, 0, 218108218, 0
    .long 1, 24, 24, 8192, 3072, 3328, 8388608, 2621440, 32768, 8, 31506432, 131072, 0, 0, 218105658, 0
    .long 1, 16, 16, 8192, 3584, 3840, 8388608, 2621440, 32768, 8, 14737408, 131072, 0, 0, 218105658, 0
    .long 1, 24, 24, 8192, 2560, 2816, 8388608, 2097152, 32768, 8, 29401088, 131072, 0, 0, 218105386, 0
    .long 2, 64, 72, 7168, 3072, 3072, 7340032, 2097152, 32768, 8, 61915136, 114688, 0, 0, 218104065, 0
    .long 1, 16, 16, 8192, 2560, 2816, 8388608, 3145728, 32768, 8, 16818176, 131072, 0, 0, 218105898, 0
    .long 1, 16, 16, 8192, 2560, 2816, 8388608, 2097152, 32768, 8, 12623872, 131072, 0, 0, 218105386, 0
    .long 2, 64, 72, 7168, 2560, 2560, 7340032, 3670016, 32768, 8, 67411968, 114688, 0, 0, 218104260, 0
    .long 1, 24, 24, 8192, 2560, 2816, 8388608, 3145728, 32768, 8, 33595392, 131072, 0, 0, 218105898, 0
    .long 2, 64, 72, 7168, 2304, 2304, 7340032, 2097152, 32768, 8, 61902848, 114688, 0, 0, 218104065, 0
    .long 1, 16, 16, 8192, 3072, 3328, 8388608, 2097152, 32768, 8, 12632064, 131072, 0, 0, 218105402, 0
    .long 2, 64, 72, 7168, 3072, 3072, 7340032, 2621440, 32768, 8, 63750144, 114688, 0, 0, 218104132, 0
    .long 1, 32, 32, 8192, 3584, 3840, 8388608, 3145728, 32768, 8, 50388992, 131072, 0, 0, 218105914, 0
    .long 1, 24, 24, 8192, 2048, 2304, 8388608, 2621440, 32768, 8, 31490048, 131072, 0, 0, 218105642, 0
    .long 2, 64, 72, 7168, 1792, 1792, 7340032, 1048576, 32768, 8, 58224640, 114688, 0, 0, 218103937, 0
    .long 1, 32, 32, 8192, 3072, 3328, 8388608, 3145728, 32768, 8, 50380800, 131072, 0, 0, 218105914, 0
    .long 2, 64, 72, 7168, 2560, 2560, 7340032, 3145728, 32768, 8, 65576960, 114688, 0, 0, 218104196, 0
    .long 1, 16, 16, 8192, 2048, 2304, 8388608, 3145728, 32768, 8, 16809984, 131072, 0, 0, 218105898, 0
    .long 2, 64, 72, 7168, 3328, 3328, 7340032, 1048576, 32768, 8, 58249216, 114688, 0, 0, 218103937, 0
    .long 2, 64, 72, 7168, 1792, 1792, 7340032, 3145728, 32768, 8, 65564672, 114688, 0, 0, 218104196, 0
    .long 2, 64, 72, 7168, 2560, 2560, 7340032, 2621440, 32768, 8, 63741952, 114688, 0, 0, 218104132, 0
    .long 2, 64, 72, 7168, 2048, 2048, 7340032, 1048576, 32768, 8, 58228736, 114688, 0, 0, 218103937, 0
    .long 2, 64, 72, 7168, 2816, 2816, 7340032, 3145728, 32768, 8, 65581056, 114688, 0, 0, 218104196, 0
    .long 1, 16, 16, 8192, 3072, 3328, 8388608, 2621440, 32768, 8, 14729216, 131072, 0, 0, 218105658, 0
    .long 1, 32, 32, 8192, 2048, 2304, 8388608, 2621440, 32768, 8, 48267264, 131072, 0, 0, 218105642, 0
    .long 1, 16, 16, 8192, 2048, 2304, 8388608, 2621440, 32768, 8, 14712832, 131072, 0, 0, 218105642, 0
    .long 5, 218108192, 0, 0, 8, 0, 0, 8, 0, 0, 0, 0, 218112128, 11, 218106945, 0
    .long 2, 64, 72, 7168, 2048, 2048, 7340032, 524288, 32768, 8, 56393728, 114688, 0, 0, 218103873, 0
    .long 2, 64, 72, 7168, 2816, 2816, 7340032, 0, 32768, 8, 54571008, 114688, 0, 0, 218103809, 0
    .long 1, 24, 24, 8192, 2048, 2304, 8388608, 3145728, 32768, 8, 33587200, 131072, 0, 0, 218105898, 0
    .long 2, 64, 72, 7168, 3328, 3328, 7340032, 0, 32768, 8, 54579200, 114688, 0, 0, 218103809, 0
    .long 5, 218107936, 0, 0, 8, 0, 0, 0, 0, 0, 0, 0, 218112128, 3, 218106881, 0
    .long 1, 32, 32, 8192, 2560, 2816, 8388608, 3145728, 32768, 8, 50372608, 131072, 0, 0, 218105898, 0
    .long 5, 218108208, 0, 0, 12, 0, 0, 8, 0, 0, 0, 0, 218112128, 11, 218106945, 0
    .long 1, 24, 24, 8192, 3584, 3840, 8388608, 2621440, 32768, 8, 31514624, 131072, 0, 0, 218105658, 0
    .long 1, 32, 32, 8192, 3072, 3328, 8388608, 2621440, 32768, 8, 48283648, 131072, 0, 0, 218105658, 0
    .long 2, 64, 72, 7168, 2560, 2560, 7340032, 1048576, 32768, 8, 58236928, 114688, 0, 0, 218103937, 0
    .long 2, 64, 72, 7168, 2560, 2560, 7340032, 524288, 32768, 8, 56401920, 114688, 0, 0, 218103873, 0
    .long 2, 64, 72, 7168, 2304, 2304, 7340032, 524288, 32768, 8, 56397824, 114688, 0, 0, 218103873, 0
    .long 2, 64, 72, 7168, 2816, 2816, 7340032, 1048576, 32768, 8, 58241024, 114688, 0, 0, 218103937, 0
    .long 1, 32, 32, 8192, 2560, 2816, 8388608, 2621440, 32768, 8, 48275456, 131072, 0, 0, 218105642, 0
    .long 2, 64, 72, 7168, 2304, 2304, 7340032, 1048576, 32768, 8, 58232832, 114688, 0, 0, 218103937, 0
    .long 1, 16, 16, 8192, 3072, 3328, 8388608, 3670016, 32768, 8, 18923520, 131072, 0, 0, 218106170, 0
    .long 2, 64, 72, 7168, 2816, 2816, 7340032, 524288, 32768, 8, 56406016, 114688, 0, 0, 218103873, 0
    .long 1, 16, 16, 8192, 3072, 3328, 8388608, 3145728, 32768, 8, 16826368, 131072, 0, 0, 218105914, 0
    .long 5, 218107952, 0, 0, 12, 0, 0, 0, 0, 0, 0, 0, 218112128, 3, 218106881, 0
    .long 5, 218107952, 0, 0, 12, 0, 0, 4, 0, 0, 0, 0, 218112128, 7, 218106881, 0
    .long 5, 218108208, 0, 0, 12, 0, 0, 12, 0, 0, 0, 0, 218112128, 15, 218106945, 0
    .long 5, 218108192, 0, 0, 8, 0, 0, 12, 0, 0, 0, 0, 218112128, 15, 218106945, 0
    .long 5, 218107936, 0, 0, 8, 0, 0, 4, 0, 0, 0, 0, 218112128, 7, 218106881, 0
    .long 1, 32, 32, 8192, 2048, 2304, 8388608, 3145728, 32768, 8, 50364416, 131072, 0, 0, 218105898, 0
    .long 2, 64, 72, 7168, 2304, 2304, 7340032, 1572864, 32768, 8, 60067840, 114688, 0, 0, 218104001, 0
    .long 2, 64, 72, 7168, 1792, 1792, 7340032, 1572864, 32768, 8, 60059648, 114688, 0, 0, 218104001, 0
    .long 2, 64, 72, 7168, 2048, 2048, 7340032, 0, 32768, 8, 54558720, 114688, 0, 0, 218103809, 0
    .long 1, 24, 24, 8192, 3584, 3840, 8388608, 3145728, 32768, 8, 33611776, 131072, 0, 0, 218105914, 0
    .long 2, 64, 72, 7168, 3328, 3328, 7340032, 3145728, 32768, 8, 65589248, 114688, 0, 0, 218104196, 0
    .long 2, 64, 72, 7168, 1792, 1792, 7340032, 2621440, 32768, 8, 63729664, 114688, 0, 0, 218104132, 0
    .long 2, 64, 72, 7168, 2304, 2304, 7340032, 0, 32768, 8, 54562816, 114688, 0, 0, 218103809, 0
    .long 2, 64, 72, 7168, 2816, 2816, 7340032, 2097152, 32768, 8, 61911040, 114688, 0, 0, 218104065, 0
    .long 2, 64, 72, 7168, 3328, 3328, 7340032, 524288, 32768, 8, 56414208, 114688, 0, 0, 218103873, 0
    .long 2, 64, 72, 7168, 2048, 2048, 7340032, 2097152, 32768, 8, 61898752, 114688, 0, 0, 218104065, 0
    .long 2, 64, 72, 7168, 3328, 3328, 7340032, 1572864, 32768, 8, 60084224, 114688, 0, 0, 218104001, 0
    .long 2, 64, 72, 7168, 1792, 1792, 7340032, 0, 32768, 8, 54554624, 114688, 0, 0, 218103809, 0
    .long 2, 64, 72, 7168, 2816, 2816, 7340032, 3670016, 32768, 8, 67416064, 114688, 0, 0, 218104260, 0
    .long 2, 64, 72, 7168, 1792, 1792, 7340032, 524288, 32768, 8, 56389632, 114688, 0, 0, 218103873, 0
    .long 2, 64, 72, 7168, 3072, 3072, 7340032, 524288, 32768, 8, 56410112, 114688, 0, 0, 218103873, 0
    .long 2, 64, 72, 7168, 3328, 3328, 7340032, 2097152, 32768, 8, 61919232, 114688, 0, 0, 218104065, 0
    .long 1, 24, 24, 8192, 3584, 3840, 8388608, 3670016, 32768, 8, 35708928, 131072, 0, 0, 218106170, 0
    .long 2, 64, 72, 7168, 2304, 2304, 7340032, 2621440, 32768, 8, 63737856, 114688, 0, 0, 218104132, 0
    .long 2, 64, 72, 7168, 2816, 2816, 7340032, 1572864, 32768, 8, 60076032, 114688, 0, 0, 218104001, 0
    .long 2, 64, 72, 7168, 1792, 1792, 7340032, 2097152, 32768, 8, 61894656, 114688, 0, 0, 218104065, 0
    .long 2, 64, 72, 7168, 3072, 3072, 7340032, 3145728, 32768, 8, 65585152, 114688, 0, 0, 218104196, 0
    .long 2, 64, 72, 7168, 2048, 2048, 7340032, 1572864, 32768, 8, 60063744, 114688, 0, 0, 218104001, 0
    .long 2, 64, 72, 7168, 2048, 2048, 7340032, 2621440, 32768, 8, 63733760, 114688, 0, 0, 218104132, 0
    .long 1, 24, 24, 8192, 2048, 2304, 8388608, 3670016, 32768, 8, 35684352, 131072, 0, 0, 218106154, 0
    .long 2, 64, 72, 7168, 3328, 3328, 7340032, 2621440, 32768, 8, 63754240, 114688, 0, 0, 218104132, 0
    .long 2, 64, 72, 7168, 2816, 2816, 7340032, 2621440, 32768, 8, 63746048, 114688, 0, 0, 218104132, 0
    .long 2, 64, 72, 7168, 3072, 3072, 7340032, 3670016, 32768, 8, 67420160, 114688, 0, 0, 218104260, 0
    .long 2, 64, 72, 7168, 3072, 3072, 7340032, 1572864, 32768, 8, 60080128, 114688, 0, 0, 218104001, 0
    .long 1, 40, 40, 2048, 1536, 1792, 8388608, 180355072, 131072, 16, 76570624, 32768, 218112128, 25, 218106504, 0
    .long 1, 80, 80, 2048, 1024, 1280, 7340032, 58195968, 114688, 14, 118505472, 32768, 218103936, 14, 218106498, 0
    .long 1, 24, 24, 8192, 3072, 3328, 8388608, 3670016, 32768, 8, 35700736, 131072, 0, 0, 218106170, 0
    .long 1, 40, 40, 2048, 1024, 1280, 8388608, 180355072, 131072, 16, 76562432, 32768, 218112128, 25, 218106504, 0
    .long 1, 40, 40, 2048, 1024, 1280, 8388608, 178257920, 131072, 16, 76038144, 32768, 218106944, 8, 218106440, 0
    .long 2, 64, 72, 7168, 2304, 2304, 7340032, 3145728, 32768, 8, 65572864, 114688, 0, 0, 218104196, 0
    .long 1, 40, 40, 2048, 1536, 1792, 8388608, 178257920, 131072, 16, 76046336, 32768, 218106944, 8, 218106440, 0
    .long 1, 80, 80, 2048, 1536, 1792, 7340032, 58195968, 114688, 14, 118513664, 32768, 218103936, 14, 218106498, 0
    .long 2, 64, 72, 7168, 2048, 2048, 7340032, 3145728, 32768, 8, 65568768, 114688, 0, 0, 218104196, 0
    .long 1, 32, 32, 8192, 2560, 2816, 8388608, 3670016, 32768, 8, 52469760, 131072, 0, 0, 218106154, 0
    .long 1, 16, 16, 8192, 2560, 2816, 8388608, 3670016, 32768, 8, 18915328, 131072, 0, 0, 218106154, 0
    .long 1, 40, 40, 2048, 1536, 1792, 8388608, 176160768, 131072, 16, 75522048, 32768, 218106880, 8, 218106376, 0
    .long 1, 40, 40, 2048, 1024, 1280, 8388608, 176160768, 131072, 16, 75513856, 32768, 218106880, 8, 218106376, 0
    .long 1, 32, 32, 8192, 2048, 2304, 8388608, 3670016, 32768, 8, 52461568, 131072, 0, 0, 218106154, 0
    .long 1, 24, 24, 8192, 2560, 2816, 8388608, 3670016, 32768, 8, 35692544, 131072, 0, 0, 218106154, 0
    .long 1, 16, 16, 8192, 2048, 2304, 8388608, 3670016, 32768, 8, 18907136, 131072, 0, 0, 218106154, 0
    .long 1, 32, 32, 8192, 3072, 3328, 8388608, 3670016, 32768, 8, 52477952, 131072, 0, 0, 218106170, 0
    .long 1, 32, 32, 8192, 3584, 3840, 8388608, 3670016, 32768, 8, 52486144, 131072, 0, 0, 218106170, 0
    .long 2, 64, 72, 7168, 2304, 2304, 7340032, 3670016, 32768, 8, 67407872, 114688, 0, 0, 218104260, 0
    .long 2, 64, 72, 7168, 1792, 1792, 7340032, 3670016, 32768, 8, 67399680, 114688, 0, 0, 218104260, 0
    .long 1, 16, 16, 8192, 3584, 3840, 8388608, 3670016, 32768, 8, 18931712, 131072, 0, 0, 218106170, 0
    .long 2, 64, 72, 7168, 3328, 3328, 7340032, 3670016, 32768, 8, 67424256, 114688, 0, 0, 218104260, 0
    .long 1, 80, 80, 2048, 1536, 1792, 7340032, 56360960, 114688, 14, 117989376, 32768, 218103872, 14, 218106434, 0
    .long 1, 80, 80, 2048, 1024, 1280, 7340032, 54525952, 114688, 14, 117456896, 32768, 218103808, 14, 218106370, 0
    .long 1, 80, 80, 2048, 1024, 1280, 7340032, 61865984, 114688, 14, 119554048, 32768, 218104064, 14, 218106626, 0
    .long 1, 80, 80, 2048, 1024, 1280, 7340032, 56360960, 114688, 14, 117981184, 32768, 218103872, 14, 218106434, 0
    .long 2, 64, 72, 7168, 2048, 2048, 7340032, 3670016, 32768, 8, 67403776, 114688, 0, 0, 218104260, 0
    .long 1, 40, 40, 2048, 1024, 1280, 8388608, 182452224, 131072, 16, 77086720, 32768, 218112128, 33, 218106568, 0
    .long 1, 40, 40, 2048, 1536, 1792, 8388608, 182452224, 131072, 16, 77094912, 32768, 218112128, 33, 218106568, 0
    .long 1, 80, 80, 2048, 1536, 1792, 7340032, 61865984, 114688, 14, 119562240, 32768, 218104064, 14, 218106626, 0
    .long 1, 80, 80, 2048, 1536, 1792, 7340032, 54525952, 114688, 14, 117465088, 32768, 218103808, 14, 218106370, 0
    .long 1, 80, 80, 2048, 1536, 1792, 7340032, 60030976, 114688, 14, 119037952, 32768, 218104000, 14, 218106562, 0
    .long 1, 80, 80, 2048, 1024, 1280, 7340032, 60030976, 114688, 14, 119029760, 32768, 218104000, 14, 218106562, 0
    .long 1, 40, 40, 2048, 2097664, 2097920, 8388608, 184582144, 131072, 8, 81797120, 32768, 218112128, 40, 218106628, 0
    .long 1, 40, 40, 2048, 2097152, 2097408, 8388608, 184582144, 131072, 8, 81788928, 32768, 218112128, 40, 218106628, 0
    .long 1, 40, 40, 2048, 2098688, 2098944, 8388608, 184582144, 131072, 8, 81813504, 32768, 218112128, 40, 218106628, 0
    .long 1, 40, 40, 2048, 2098176, 2098432, 8388608, 184582144, 131072, 8, 81805312, 32768, 218112128, 40, 218106628, 0
    .long 1, 80, 80, 2048, 1836544, 1836800, 7340032, 63729664, 114688, 7, 124280832, 32768, 218104132, 7, 218106689, 0
    .long 1, 80, 80, 2048, 1836032, 1836288, 7340032, 63729664, 114688, 7, 124272640, 32768, 218104132, 7, 218106689, 0
    .long 1, 80, 80, 2048, 1835008, 1835264, 7340032, 63729664, 114688, 7, 124256256, 32768, 218104132, 7, 218106689, 0
    .long 1, 80, 80, 2048, 1835520, 1835776, 7340032, 63729664, 114688, 7, 124264448, 32768, 218104132, 7, 218106689, 0
    .long 1, 80, 80, 2048, 1835520, 1835776, 7340032, 65564672, 114688, 7, 124788736, 32768, 218104196, 7, 218106753, 0
    .long 1, 80, 80, 2048, 1835008, 1835264, 7340032, 65564672, 114688, 7, 124780544, 32768, 218104196, 7, 218106753, 0
    .long 1, 80, 80, 2048, 1836544, 1836800, 7340032, 65564672, 114688, 7, 124805120, 32768, 218104196, 7, 218106753, 0
    .long 1, 40, 40, 2048, 2097664, 2097920, 8388608, 186679296, 131072, 8, 82321408, 32768, 218112128, 48, 218106692, 0
    .long 1, 80, 80, 2048, 1836032, 1836288, 7340032, 65564672, 114688, 7, 124796928, 32768, 218104196, 7, 218106753, 0
    .long 1, 40, 40, 2048, 2098176, 2098432, 8388608, 186679296, 131072, 8, 82329600, 32768, 218112128, 48, 218106692, 0
    .long 1, 40, 40, 2048, 2098688, 2098944, 8388608, 186679296, 131072, 8, 82337792, 32768, 218112128, 48, 218106692, 0
    .long 1, 40, 40, 2048, 2097152, 2097408, 8388608, 186679296, 131072, 8, 82313216, 32768, 218112128, 48, 218106692, 0
    .long 1, 80, 80, 2048, 1836544, 1836800, 7340032, 67399680, 114688, 7, 125329408, 32768, 218104260, 7, 218106817, 0
    .long 1, 80, 80, 2048, 1835520, 1835776, 7340032, 67399680, 114688, 7, 125313024, 32768, 218104260, 7, 218106817, 0
    .long 1, 80, 80, 2048, 1836032, 1836288, 7340032, 67399680, 114688, 7, 125321216, 32768, 218104260, 7, 218106817, 0
    .long 1, 80, 80, 2048, 1835008, 1835264, 7340032, 67399680, 114688, 7, 125304832, 32768, 218104260, 7, 218106817, 0
    .long 6, 1, 0, 2, 1, 16, 0, 23, 0, 0, 0, 0, 0, 0, 0, 0
    .long 6, 1, 0, 2, 1, 16, 0, 17, 0, 0, 0, 0, 0, 0, 0, 0
    .long 6, 1, 0, 2, 1, 16, 0, 20, 0, 0, 0, 0, 0, 0, 0, 0
    .long 6, 1, 0, 2, 1, 16, 0, 10, 0, 0, 0, 0, 0, 0, 0, 0
    .long 6, 1, 0, 2, 1, 16, 0, 6, 0, 0, 0, 0, 0, 0, 0, 0
    .long 6, 1, 0, 2, 1, 16, 0, 13, 0, 0, 0, 0, 0, 0, 0, 0
    .long 6, 1, 0, 1, 1, 16, 0, 38, 0, 0, 0, 0, 0, 0, 0, 0
    .long 6, 1, 0, 2, 1, 16, 0, 18, 0, 0, 0, 0, 0, 0, 0, 0
    .long 6, 1, 0, 2, 1, 16, 0, 9, 0, 0, 0, 0, 0, 0, 0, 0
    .long 6, 1, 0, 2, 1, 16, 0, 2, 0, 0, 0, 0, 0, 0, 0, 0
    .long 6, 1, 0, 2, 1, 16, 0, 5, 0, 0, 0, 0, 0, 0, 0, 0
    .long 6, 1, 0, 1, 1, 16, 0, 34, 0, 0, 0, 0, 0, 0, 0, 0
    .long 6, 1, 0, 2, 1, 16, 0, 7, 0, 0, 0, 0, 0, 0, 0, 0
    .long 6, 1, 0, 2, 1, 16, 0, 1, 0, 0, 0, 0, 0, 0, 0, 0
    .long 6, 1, 0, 2, 1, 16, 0, 12, 0, 0, 0, 0, 0, 0, 0, 0
    .long 6, 1, 0, 2, 1, 16, 0, 14, 0, 0, 0, 0, 0, 0, 0, 0
    .long 6, 1, 0, 2, 1, 16, 0, 0, 0, 0, 0, 0, 0, 0, 0, 0
    .long 6, 1, 0, 2, 1, 16, 0, 3, 0, 0, 0, 0, 0, 0, 0, 0
    .long 6, 1, 0, 2, 1, 16, 0, 22, 0, 0, 0, 0, 0, 0, 0, 0
    .long 6, 1, 0, 2, 1, 16, 0, 21, 0, 0, 0, 0, 0, 0, 0, 0
    .long 6, 1, 0, 2, 1, 16, 0, 8, 0, 0, 0, 0, 0, 0, 0, 0
    .long 6, 1, 0, 2, 1, 16, 0, 15, 0, 0, 0, 0, 0, 0, 0, 0
    .long 6, 1, 0, 2, 1, 16, 0, 19, 0, 0, 0, 0, 0, 0, 0, 0
    .long 6, 1, 0, 2, 1, 16, 0, 11, 0, 0, 0, 0, 0, 0, 0, 0
    .long 6, 1, 0, 2, 1, 16, 0, 16, 0, 0, 0, 0, 0, 0, 0, 0
    .long 6, 1, 0, 2, 1, 16, 0, 4, 0, 0, 0, 0, 0, 0, 0, 0
    .long 6, 0, 0, 0, 1, 0, 0, 54, 0, 0, 0, 0, 0, 0, 0, 0
    .long 6, 0, 0, 0, 1, 0, 0, 51, 0, 0, 0, 0, 0, 0, 0, 0
    .long 6, 0, 0, 0, 1, 0, 0, 48, 0, 0, 0, 0, 0, 0, 0, 0
    .long 6, 0, 0, 0, 1, 0, 0, 49, 0, 0, 0, 0, 0, 0, 0, 0
    .long 6, 0, 0, 0, 1, 0, 0, 50, 0, 0, 0, 0, 0, 0, 0, 0
    .long 6, 0, 0, 0, 1, 0, 0, 52, 0, 0, 0, 0, 0, 0, 0, 0
    .long 6, 0, 0, 0, 1, 0, 0, 53, 0, 0, 0, 0, 0, 0, 0, 0
    .long 6, 0, 0, 0, 1, 0, 0, 55, 0, 0, 0, 0, 0, 0, 0, 0
    .long 6, 1, 0, 1, 1, 16, 0, 32, 0, 0, 0, 0, 0, 0, 0, 0
    .long 6, 1, 0, 1, 1, 16, 0, 33, 0, 0, 0, 0, 0, 0, 0, 0
    .long 6, 1, 0, 1, 1, 16, 0, 35, 0, 0, 0, 0, 0, 0, 0, 0
    .long 6, 1, 0, 1, 1, 16, 0, 36, 0, 0, 0, 0, 0, 0, 0, 0
    .long 6, 1, 0, 1, 1, 16, 0, 37, 0, 0, 0, 0, 0, 0, 0, 0
    .long 6, 1, 0, 1, 1, 16, 0, 39, 0, 0, 0, 0, 0, 0, 0, 0
    .long 6, 1, 0, 2, 1, 16, 0, 24, 0, 0, 0, 0, 0, 0, 0, 0
    .long 6, 1, 0, 2, 1, 16, 0, 26, 0, 0, 0, 0, 0, 0, 0, 0
    .long 6, 1, 0, 2, 1, 16, 0, 27, 0, 0, 0, 0, 0, 0, 0, 0
    .long 6, 1, 0, 2, 1, 16, 0, 28, 0, 0, 0, 0, 0, 0, 0, 0
    .long 6, 1, 0, 2, 1, 16, 0, 29, 0, 0, 0, 0, 0, 0, 0, 0
    .long 6, 1, 0, 2, 1, 16, 0, 30, 0, 0, 0, 0, 0, 0, 0, 0
    .long 6, 1, 0, 2, 1, 16, 0, 31, 0, 0, 0, 0, 0, 0, 0, 0
    .long 6, 1, 0, 2, 1, 16, 0, 25, 0, 0, 0, 0, 0, 0, 0, 0
    .long 6, 0, 0, 1, 1, 16, 0, 40, 0, 0, 0, 0, 0, 0, 0, 0
    .long 6, 0, 0, 1, 1, 16, 0, 41, 0, 0, 0, 0, 0, 0, 0, 0
    .long 6, 0, 0, 1, 1, 16, 0, 42, 0, 0, 0, 0, 0, 0, 0, 0
    .long 6, 0, 0, 1, 1, 16, 0, 43, 0, 0, 0, 0, 0, 0, 0, 0
    .long 6, 0, 0, 1, 1, 16, 0, 44, 0, 0, 0, 0, 0, 0, 0, 0
    .long 6, 0, 0, 1, 1, 16, 0, 47, 0, 0, 0, 0, 0, 0, 0, 0
    .long 6, 0, 0, 1, 1, 16, 0, 46, 0, 0, 0, 0, 0, 0, 0, 0
    .long 6, 0, 0, 1, 1, 16, 0, 45, 0, 0, 0, 0, 0, 0, 0, 0
    .long 6, 0, 0, 0, 1, 0, 0, 56, 0, 0, 0, 0, 0, 0, 0, 0
    .long 6, 0, 0, 0, 1, 0, 0, 57, 0, 0, 0, 0, 0, 0, 0, 0
    .long 6, 0, 0, 0, 1, 0, 0, 58, 0, 0, 0, 0, 0, 0, 0, 0
    .long 6, 0, 0, 0, 1, 0, 0, 59, 0, 0, 0, 0, 0, 0, 0, 0
    .long 6, 0, 0, 0, 1, 0, 0, 60, 0, 0, 0, 0, 0, 0, 0, 0
    .long 7, 0, 0, 0, 4, 0, 0, 61, 0, 0, 0, 0, 0, 0, 0, 0
    .long 7, 0, 0, 0, 5, 0, 0, 61, 0, 0, 0, 0, 0, 0, 0, 0
    .long 7, 0, 0, 0, 6, 0, 0, 61, 0, 0, 0, 0, 0, 0, 0, 0
    .long 7, 0, 0, 0, 7, 0, 0, 61, 0, 0, 0, 0, 0, 0, 0, 0
    .long 7, 0, 0, 0, 4, 0, 0, 62, 0, 0, 0, 0, 0, 0, 0, 0
    .long 7, 0, 0, 0, 5, 0, 0, 62, 0, 0, 0, 0, 0, 0, 0, 0
    .long 7, 0, 0, 0, 6, 0, 0, 62, 0, 0, 0, 0, 0, 0, 0, 0
    .long 7, 0, 0, 0, 7, 0, 0, 62, 0, 0, 0, 0, 0, 0, 0, 0
    .long 7, 0, 0, 0, 4, 0, 0, 63, 0, 0, 0, 0, 0, 0, 0, 0
    .long 7, 0, 0, 0, 5, 0, 0, 63, 0, 0, 0, 0, 0, 0, 0, 0
    .long 7, 0, 0, 0, 6, 0, 0, 63, 0, 0, 0, 0, 0, 0, 0, 0
    .long 7, 0, 0, 0, 7, 0, 0, 63, 0, 0, 0, 0, 0, 0, 0, 0
    .long 0, 0, 0, 0, 0, 0, 0, 0, 0, 0, 0, 0, 0, 0, 0, 0
    .long 4, 24, 24, 8192, 4096, 266240, 8388608, 0, 32768, 4, 21037056, 131072, 0, 0, 218104385, 0
    .long 4, 24, 24, 8192, 4352, 266496, 8388608, 0, 32768, 4, 21041152, 131072, 0, 0, 218104385, 0
    .long 4, 24, 24, 8192, 4608, 266752, 8388608, 0, 32768, 4, 21045248, 131072, 0, 0, 218104385, 0
    .long 4, 24, 24, 8192, 4864, 267008, 8388608, 0, 32768, 4, 21049344, 131072, 0, 0, 218104385, 0
    .long 4, 24, 24, 8192, 5120, 267264, 8388608, 0, 32768, 4, 21053440, 131072, 0, 0, 218104401, 0
    .long 4, 24, 24, 8192, 5376, 267520, 8388608, 0, 32768, 4, 21057536, 131072, 0, 0, 218104401, 0
    .long 4, 24, 24, 8192, 5632, 267776, 8388608, 0, 32768, 4, 21061632, 131072, 0, 0, 218104401, 0
    .long 4, 24, 24, 8192, 5888, 268032, 8388608, 0, 32768, 4, 21065728, 131072, 0, 0, 218104401, 0
    .long 4, 32, 32, 8192, 4096, 266240, 8388608, 0, 32768, 4, 37814272, 131072, 0, 0, 218104385, 0
    .long 4, 32, 32, 8192, 4352, 266496, 8388608, 0, 32768, 4, 37818368, 131072, 0, 0, 218104385, 0
    .long 4, 32, 32, 8192, 4608, 266752, 8388608, 0, 32768, 4, 37822464, 131072, 0, 0, 218104385, 0
    .long 4, 32, 32, 8192, 4864, 267008, 8388608, 0, 32768, 4, 37826560, 131072, 0, 0, 218104385, 0
    .long 4, 32, 32, 8192, 5120, 267264, 8388608, 0, 32768, 4, 37830656, 131072, 0, 0, 218104401, 0
    .long 4, 32, 32, 8192, 5376, 267520, 8388608, 0, 32768, 4, 37834752, 131072, 0, 0, 218104401, 0
    .long 4, 32, 32, 8192, 5632, 267776, 8388608, 0, 32768, 4, 37838848, 131072, 0, 0, 218104401, 0
    .long 4, 32, 32, 8192, 5888, 268032, 8388608, 0, 32768, 4, 37842944, 131072, 0, 0, 218104401, 0
    .long 4, 24, 24, 8192, 4096, 266240, 8388608, 262144, 32768, 4, 22085632, 131072, 0, 0, 218104388, 0
    .long 4, 24, 24, 8192, 4352, 266496, 8388608, 262144, 32768, 4, 22089728, 131072, 0, 0, 218104388, 0
    .long 4, 24, 24, 8192, 4608, 266752, 8388608, 262144, 32768, 4, 22093824, 131072, 0, 0, 218104388, 0
    .long 4, 24, 24, 8192, 4864, 267008, 8388608, 262144, 32768, 4, 22097920, 131072, 0, 0, 218104388, 0
    .long 4, 24, 24, 8192, 5120, 267264, 8388608, 262144, 32768, 4, 22102016, 131072, 0, 0, 218104404, 0
    .long 4, 24, 24, 8192, 5376, 267520, 8388608, 262144, 32768, 4, 22106112, 131072, 0, 0, 218104404, 0
    .long 4, 24, 24, 8192, 5632, 267776, 8388608, 262144, 32768, 4, 22110208, 131072, 0, 0, 218104404, 0
    .long 4, 24, 24, 8192, 5888, 268032, 8388608, 262144, 32768, 4, 22114304, 131072, 0, 0, 218104404, 0
    .long 4, 32, 32, 8192, 4096, 266240, 8388608, 262144, 32768, 4, 38862848, 131072, 0, 0, 218104388, 0
    .long 4, 32, 32, 8192, 4352, 266496, 8388608, 262144, 32768, 4, 38866944, 131072, 0, 0, 218104388, 0
    .long 4, 32, 32, 8192, 4608, 266752, 8388608, 262144, 32768, 4, 38871040, 131072, 0, 0, 218104388, 0
    .long 4, 32, 32, 8192, 4864, 267008, 8388608, 262144, 32768, 4, 38875136, 131072, 0, 0, 218104388, 0
    .long 4, 32, 32, 8192, 5120, 267264, 8388608, 262144, 32768, 4, 38879232, 131072, 0, 0, 218104404, 0
    .long 4, 32, 32, 8192, 5376, 267520, 8388608, 262144, 32768, 4, 38883328, 131072, 0, 0, 218104404, 0
    .long 4, 32, 32, 8192, 5632, 267776, 8388608, 262144, 32768, 4, 38887424, 131072, 0, 0, 218104404, 0
    .long 4, 32, 32, 8192, 5888, 268032, 8388608, 262144, 32768, 4, 38891520, 131072, 0, 0, 218104404, 0
    .long 4, 32, 32, 8192, 4608, 266752, 8388608, 786432, 32768, 4, 40968192, 131072, 0, 0, 218104644, 0
    .long 4, 32, 32, 8192, 5632, 267776, 8388608, 786432, 32768, 4, 40984576, 131072, 0, 0, 218104660, 0
    .long 4, 32, 32, 8192, 5888, 268032, 8388608, 524288, 32768, 4, 39940096, 131072, 0, 0, 218104657, 0
    .long 4, 24, 24, 8192, 4608, 266752, 8388608, 786432, 32768, 4, 24190976, 131072, 0, 0, 218104644, 0
    .long 4, 32, 32, 8192, 4608, 266752, 8388608, 524288, 32768, 4, 39919616, 131072, 0, 0, 218104641, 0
    .long 4, 32, 32, 8192, 5888, 268032, 8388608, 786432, 32768, 4, 40988672, 131072, 0, 0, 218104660, 0
    .long 4, 24, 24, 8192, 5632, 267776, 8388608, 786432, 32768, 4, 24207360, 131072, 0, 0, 218104660, 0
    .long 4, 24, 24, 8192, 4352, 266496, 8388608, 524288, 32768, 4, 23138304, 131072, 0, 0, 218104641, 0
    .long 4, 24, 24, 8192, 4864, 267008, 8388608, 524288, 32768, 4, 23146496, 131072, 0, 0, 218104641, 0
    .long 4, 24, 24, 8192, 5376, 267520, 8388608, 524288, 32768, 4, 23154688, 131072, 0, 0, 218104657, 0
    .long 4, 24, 24, 8192, 4864, 267008, 8388608, 786432, 32768, 4, 24195072, 131072, 0, 0, 218104644, 0
    .long 4, 32, 32, 8192, 4352, 266496, 8388608, 524288, 32768, 4, 39915520, 131072, 0, 0, 218104641, 0
    .long 4, 32, 32, 8192, 5120, 267264, 8388608, 524288, 32768, 4, 39927808, 131072, 0, 0, 218104657, 0
    .long 4, 24, 24, 8192, 5632, 267776, 8388608, 524288, 32768, 4, 23158784, 131072, 0, 0, 218104657, 0
    .long 4, 32, 32, 8192, 4864, 267008, 8388608, 524288, 32768, 4, 39923712, 131072, 0, 0, 218104641, 0
    .long 4, 24, 24, 8192, 4096, 266240, 8388608, 524288, 32768, 4, 23134208, 131072, 0, 0, 218104641, 0
    .long 4, 32, 32, 8192, 5120, 267264, 8388608, 786432, 32768, 4, 40976384, 131072, 0, 0, 218104660, 0
    .long 4, 24, 24, 8192, 5888, 268032, 8388608, 786432, 32768, 4, 24211456, 131072, 0, 0, 218104660, 0
    .long 4, 32, 32, 8192, 4096, 266240, 8388608, 524288, 32768, 4, 39911424, 131072, 0, 0, 218104641, 0
    .long 4, 24, 24, 8192, 5376, 267520, 8388608, 786432, 32768, 4, 24203264, 131072, 0, 0, 218104660, 0
    .long 4, 32, 32, 8192, 4352, 266496, 8388608, 786432, 32768, 4, 40964096, 131072, 0, 0, 218104644, 0
    .long 4, 24, 24, 8192, 5120, 267264, 8388608, 786432, 32768, 4, 24199168, 131072, 0, 0, 218104660, 0
    .long 4, 24, 24, 8192, 4608, 266752, 8388608, 524288, 32768, 4, 23142400, 131072, 0, 0, 218104641, 0
    .long 4, 24, 24, 8192, 4352, 266496, 8388608, 786432, 32768, 4, 24186880, 131072, 0, 0, 218104644, 0
    .long 4, 32, 32, 8192, 5376, 267520, 8388608, 786432, 32768, 4, 40980480, 131072, 0, 0, 218104660, 0
    .long 4, 24, 24, 8192, 4096, 266240, 8388608, 786432, 32768, 4, 24182784, 131072, 0, 0, 218104644, 0
    .long 4, 32, 32, 8192, 5632, 267776, 8388608, 524288, 32768, 4, 39936000, 131072, 0, 0, 218104657, 0
    .long 4, 32, 32, 8192, 4864, 267008, 8388608, 786432, 32768, 4, 40972288, 131072, 0, 0, 218104644, 0
    .long 4, 32, 32, 8192, 5376, 267520, 8388608, 524288, 32768, 4, 39931904, 131072, 0, 0, 218104657, 0
    .long 4, 24, 24, 8192, 5120, 267264, 8388608, 524288, 32768, 4, 23150592, 131072, 0, 0, 218104657, 0
    .long 4, 24, 24, 8192, 5888, 268032, 8388608, 524288, 32768, 4, 23162880, 131072, 0, 0, 218104657, 0
    .long 4, 32, 32, 8192, 4096, 266240, 8388608, 786432, 32768, 4, 40960000, 131072, 0, 0, 218104644, 0
    .long 1, 16, 16, 8192, 4096, 4352, 8388608, 1572864, 32768, 8, 10551296, 131072, 0, 0, 218105162, 0
    .long 1, 32, 32, 8192, 4608, 4864, 8388608, 1048576, 32768, 8, 42016768, 131072, 0, 0, 218104906, 0
    .long 1, 32, 32, 8192, 4608, 4864, 8388608, 1572864, 32768, 8, 44113920, 131072, 0, 0, 218105162, 0
    .long 1, 24, 24, 8192, 4608, 4864, 8388608, 1048576, 32768, 8, 25239552, 131072, 0, 0, 218104906, 0
    .long 1, 16, 16, 8192, 5120, 5376, 8388608, 1048576, 32768, 8, 8470528, 131072, 0, 0, 218104922, 0
    .long 1, 16, 16, 8192, 5632, 5888, 8388608, 1048576, 32768, 8, 8478720, 131072, 0, 0, 218104922, 0
    .long 1, 32, 32, 8192, 5632, 5888, 8388608, 1048576, 32768, 8, 42033152, 131072, 0, 0, 218104922, 0
    .long 1, 24, 24, 8192, 5120, 5376, 8388608, 1048576, 32768, 8, 25247744, 131072, 0, 0, 218104922, 0
    .long 1, 24, 24, 8192, 5632, 5888, 8388608, 2097152, 32768, 8, 29450240, 131072, 0, 0, 218105434, 0
    .long 1, 24, 24, 8192, 5632, 5888, 8388608, 1048576, 32768, 8, 25255936, 131072, 0, 0, 218104922, 0
    .long 1, 32, 32, 8192, 5120, 5376, 8388608, 1048576, 32768, 8, 42024960, 131072, 0, 0, 218104922, 0
    .long 1, 24, 24, 8192, 5120, 5376, 8388608, 2097152, 32768, 8, 29442048, 131072, 0, 0, 218105434, 0
    .long 1, 24, 24, 8192, 4096, 4352, 8388608, 1572864, 32768, 8, 27328512, 131072, 0, 0, 218105162, 0
    .long 1, 32, 32, 8192, 4096, 4352, 8388608, 1572864, 32768, 8, 44105728, 131072, 0, 0, 218105162, 0
    .long 1, 24, 24, 8192, 5120, 5376, 8388608, 1572864, 32768, 8, 27344896, 131072, 0, 0, 218105178, 0
    .long 1, 16, 16, 8192, 4096, 4352, 8388608, 1048576, 32768, 8, 8454144, 131072, 0, 0, 218104906, 0
    .long 1, 24, 24, 8192, 4608, 4864, 8388608, 1572864, 32768, 8, 27336704, 131072, 0, 0, 218105162, 0
    .long 1, 16, 16, 8192, 4608, 4864, 8388608, 1572864, 32768, 8, 10559488, 131072, 0, 0, 218105162, 0
    .long 1, 32, 32, 8192, 5120, 5376, 8388608, 1572864, 32768, 8, 44122112, 131072, 0, 0, 218105178, 0
    .long 1, 16, 16, 8192, 5120, 5376, 8388608, 1572864, 32768, 8, 10567680, 131072, 0, 0, 218105178, 0
    .long 1, 32, 32, 8192, 5632, 5888, 8388608, 2097152, 32768, 8, 46227456, 131072, 0, 0, 218105434, 0
    .long 1, 24, 24, 8192, 4096, 4352, 8388608, 1048576, 32768, 8, 25231360, 131072, 0, 0, 218104906, 0
    .long 1, 24, 24, 8192, 4096, 4352, 8388608, 2097152, 32768, 8, 29425664, 131072, 0, 0, 218105418, 0
    .long 1, 16, 16, 8192, 5632, 5888, 8388608, 1572864, 32768, 8, 10575872, 131072, 0, 0, 218105178, 0
    .long 2, 64, 72, 7168, 4352, 4352, 7340032, 1572864, 32768, 8, 60100608, 114688, 0, 0, 218104017, 0
    .long 1, 32, 32, 8192, 4096, 4352, 8388608, 2097152, 32768, 8, 46202880, 131072, 0, 0, 218105418, 0
    .long 1, 32, 32, 8192, 4096, 4352, 8388608, 1048576, 32768, 8, 42008576, 131072, 0, 0, 218104906, 0
    .long 1, 32, 32, 8192, 4608, 4864, 8388608, 2097152, 32768, 8, 46211072, 131072, 0, 0, 218105418, 0
    .long 1, 24, 24, 8192, 5632, 5888, 8388608, 1572864, 32768, 8, 27353088, 131072, 0, 0, 218105178, 0
    .long 1, 32, 32, 8192, 5632, 5888, 8388608, 1572864, 32768, 8, 44130304, 131072, 0, 0, 218105178, 0
    .long 1, 16, 16, 8192, 4608, 4864, 8388608, 1048576, 32768, 8, 8462336, 131072, 0, 0, 218104906, 0
    .long 1, 32, 32, 8192, 5120, 5376, 8388608, 2097152, 32768, 8, 46219264, 131072, 0, 0, 218105434, 0
    .long 1, 16, 16, 8192, 4608, 4864, 8388608, 0, 32768, 8, 4268032, 131072, 0, 0, 218107978, 0
    .long 2, 64, 72, 7168, 4352, 4352, 7340032, 2097152, 32768, 8, 61935616, 114688, 0, 0, 218104081, 0
    .long 1, 16, 16, 8192, 5632, 5888, 8388608, 2097152, 32768, 8, 12673024, 131072, 0, 0, 218105434, 0
    .long 1, 16, 16, 8192, 4608, 4864, 8388608, 524288, 32768, 8, 6365184, 131072, 0, 0, 218108234, 0
    .long 1, 16, 16, 8192, 5632, 5888, 8388608, 3145728, 32768, 8, 16867328, 131072, 0, 0, 218105946, 0
    .long 1, 32, 32, 8192, 5632, 5888, 8388608, 2621440, 32768, 8, 48324608, 131072, 0, 0, 218105690, 0
    .long 1, 16, 16, 8192, 5120, 5376, 8388608, 0, 32768, 8, 4276224, 131072, 0, 0, 218107994, 0
    .long 1, 16, 16, 8192, 4096, 4352, 8388608, 2097152, 32768, 8, 12648448, 131072, 0, 0, 218105418, 0
    .long 1, 16, 16, 8192, 5632, 5888, 8388608, 0, 32768, 8, 4284416, 131072, 0, 0, 218107994, 0
    .long 1, 16, 16, 8192, 4096, 4352, 8388608, 524288, 32768, 8, 6356992, 131072, 0, 0, 218108234, 0
    .long 1, 24, 24, 8192, 5120, 5376, 8388608, 3145728, 32768, 8, 33636352, 131072, 0, 0, 218105946, 0
    .long 1, 24, 24, 8192, 4608, 4864, 8388608, 2621440, 32768, 8, 31531008, 131072, 0, 0, 218105674, 0
    .long 1, 16, 16, 8192, 4608, 4864, 8388608, 2621440, 32768, 8, 14753792, 131072, 0, 0, 218105674, 0
    .long 1, 16, 16, 8192, 5120, 5376, 8388608, 524288, 32768, 8, 6373376, 131072, 0, 0, 218108250, 0
    .long 2, 64, 72, 7168, 4864, 4864, 7340032, 0, 32768, 8, 54603776, 114688, 0, 0, 218103825, 0
    .long 2, 64, 72, 7168, 4352, 4352, 7340032, 0, 32768, 8, 54595584, 114688, 0, 0, 218103825, 0
    .long 2, 64, 72, 7168, 4864, 4864, 7340032, 1048576, 32768, 8, 58273792, 114688, 0, 0, 218103953, 0
    .long 1, 16, 16, 8192, 4096, 4352, 8388608, 0, 32768, 8, 4259840, 131072, 0, 0, 218107978, 0
    .long 1, 16, 16, 8192, 5632, 5888, 8388608, 524288, 32768, 8, 6381568, 131072, 0, 0, 218108250, 0
    .long 1, 24, 24, 8192, 5120, 5376, 8388608, 2621440, 32768, 8, 31539200, 131072, 0, 0, 218105690, 0
    .long 1, 16, 16, 8192, 5632, 5888, 8388608, 2621440, 32768, 8, 14770176, 131072, 0, 0, 218105690, 0
    .long 1, 24, 24, 8192, 4608, 4864, 8388608, 2097152, 32768, 8, 29433856, 131072, 0, 0, 218105418, 0
    .long 2, 64, 72, 7168, 4864, 4864, 7340032, 2097152, 32768, 8, 61943808, 114688, 0, 0, 218104081, 0
    .long 1, 16, 16, 8192, 4608, 4864, 8388608, 3145728, 32768, 8, 16850944, 131072, 0, 0, 218105930, 0
    .long 1, 16, 16, 8192, 4608, 4864, 8388608, 2097152, 32768, 8, 12656640, 131072, 0, 0, 218105418, 0
    .long 2, 64, 72, 7168, 4352, 4352, 7340032, 3670016, 32768, 8, 67440640, 114688, 0, 0, 218104273, 0
    .long 1, 24, 24, 8192, 4608, 4864, 8388608, 3145728, 32768, 8, 33628160, 131072, 0, 0, 218105930, 0
    .long 2, 64, 72, 7168, 4096, 4096, 7340032, 2097152, 32768, 8, 61931520, 114688, 0, 0, 218104081, 0
    .long 1, 16, 16, 8192, 5120, 5376, 8388608, 2097152, 32768, 8, 12664832, 131072, 0, 0, 218105434, 0
    .long 2, 64, 72, 7168, 4864, 4864, 7340032, 2621440, 32768, 8, 63778816, 114688, 0, 0, 218104145, 0
    .long 1, 32, 32, 8192, 5632, 5888, 8388608, 3145728, 32768, 8, 50421760, 131072, 0, 0, 218105946, 0
    .long 1, 24, 24, 8192, 4096, 4352, 8388608, 2621440, 32768, 8, 31522816, 131072, 0, 0, 218105674, 0
    .long 2, 64, 72, 7168, 3584, 3584, 7340032, 1048576, 32768, 8, 58253312, 114688, 0, 0, 218103953, 0
    .long 1, 32, 32, 8192, 5120, 5376, 8388608, 3145728, 32768, 8, 50413568, 131072, 0, 0, 218105946, 0
    .long 2, 64, 72, 7168, 4352, 4352, 7340032, 3145728, 32768, 8, 65605632, 114688, 0, 0, 218104209, 0
    .long 1, 16, 16, 8192, 4096, 4352, 8388608, 3145728, 32768, 8, 16842752, 131072, 0, 0, 218105930, 0
    .long 2, 64, 72, 7168, 5120, 5120, 7340032, 1048576, 32768, 8, 58277888, 114688, 0, 0, 218103953, 0
    .long 2, 64, 72, 7168, 3584, 3584, 7340032, 3145728, 32768, 8, 65593344, 114688, 0, 0, 218104209, 0
    .long 2, 64, 72, 7168, 4352, 4352, 7340032, 2621440, 32768, 8, 63770624, 114688, 0, 0, 218104145, 0
    .long 2, 64, 72, 7168, 3840, 3840, 7340032, 1048576, 32768, 8, 58257408, 114688, 0, 0, 218103953, 0
    .long 2, 64, 72, 7168, 4608, 4608, 7340032, 3145728, 32768, 8, 65609728, 114688, 0, 0, 218104209, 0
    .long 1, 16, 16, 8192, 5120, 5376, 8388608, 2621440, 32768, 8, 14761984, 131072, 0, 0, 218105690, 0
    .long 1, 32, 32, 8192, 4096, 4352, 8388608, 2621440, 32768, 8, 48300032, 131072, 0, 0, 218105674, 0
    .long 1, 16, 16, 8192, 4096, 4352, 8388608, 2621440, 32768, 8, 14745600, 131072, 0, 0, 218105674, 0
    .long 5, 218108224, 0, 0, 16, 0, 0, 8, 0, 0, 0, 0, 218112256, 11, 218106961, 0
    .long 2, 64, 72, 7168, 3840, 3840, 7340032, 524288, 32768, 8, 56422400, 114688, 0, 0, 218103889, 0
    .long 2, 64, 72, 7168, 4608, 4608, 7340032, 0, 32768, 8, 54599680, 114688, 0, 0, 218103825, 0
    .long 1, 24, 24, 8192, 4096, 4352, 8388608, 3145728, 32768, 8, 33619968, 131072, 0, 0, 218105930, 0
    .long 2, 64, 72, 7168, 5120, 5120, 7340032, 0, 32768, 8, 54607872, 114688, 0, 0, 218103825, 0
    .long 5, 218107968, 0, 0, 16, 0, 0, 0, 0, 0, 0, 0, 218112256, 3, 218106897, 0
    .long 1, 32, 32, 8192, 4608, 4864, 8388608, 3145728, 32768, 8, 50405376, 131072, 0, 0, 218105930, 0
    .long 5, 218108240, 0, 0, 20, 0, 0, 8, 0, 0, 0, 0, 218112256, 11, 218106961, 0
    .long 1, 24, 24, 8192, 5632, 5888, 8388608, 2621440, 32768, 8, 31547392, 131072, 0, 0, 218105690, 0
    .long 1, 32, 32, 8192, 5120, 5376, 8388608, 2621440, 32768, 8, 48316416, 131072, 0, 0, 218105690, 0
    .long 2, 64, 72, 7168, 4352, 4352, 7340032, 1048576, 32768, 8, 58265600, 114688, 0, 0, 218103953, 0
    .long 2, 64, 72, 7168, 4352, 4352, 7340032, 524288, 32768, 8, 56430592, 114688, 0, 0, 218103889, 0
    .long 2, 64, 72, 7168, 4096, 4096, 7340032, 524288, 32768, 8, 56426496, 114688, 0, 0, 218103889, 0
    .long 2, 64, 72, 7168, 4608, 4608, 7340032, 1048576, 32768, 8, 58269696, 114688, 0, 0, 218103953, 0
    .long 1, 32, 32, 8192, 4608, 4864, 8388608, 2621440, 32768, 8, 48308224, 131072, 0, 0, 218105674, 0
    .long 2, 64, 72, 7168, 4096, 4096, 7340032, 1048576, 32768, 8, 58261504, 114688, 0, 0, 218103953, 0
    .long 1, 16, 16, 8192, 5120, 5376, 8388608, 3670016, 32768, 8, 18956288, 131072, 0, 0, 218106202, 0
    .long 2, 64, 72, 7168, 4608, 4608, 7340032, 524288, 32768, 8, 56434688, 114688, 0, 0, 218103889, 0
    .long 1, 16, 16, 8192, 5120, 5376, 8388608, 3145728, 32768, 8, 16859136, 131072, 0, 0, 218105946, 0
    .long 5, 218107984, 0, 0, 20, 0, 0, 0, 0, 0, 0, 0, 218112256, 3, 218106897, 0
    .long 5, 218107984, 0, 0, 20, 0, 0, 4, 0, 0, 0, 0, 218112256, 7, 218106897, 0
    .long 5, 218108240, 0, 0, 20, 0, 0, 12, 0, 0, 0, 0, 218112256, 15, 218106961, 0
    .long 5, 218108224, 0, 0, 16, 0, 0, 12, 0, 0, 0, 0, 218112256, 15, 218106961, 0
    .long 5, 218107968, 0, 0, 16, 0, 0, 4, 0, 0, 0, 0, 218112256, 7, 218106897, 0
    .long 1, 32, 32, 8192, 4096, 4352, 8388608, 3145728, 32768, 8, 50397184, 131072, 0, 0, 218105930, 0
    .long 2, 64, 72, 7168, 4096, 4096, 7340032, 1572864, 32768, 8, 60096512, 114688, 0, 0, 218104017, 0
    .long 2, 64, 72, 7168, 3584, 3584, 7340032, 1572864, 32768, 8, 60088320, 114688, 0, 0, 218104017, 0
    .long 2, 64, 72, 7168, 3840, 3840, 7340032, 0, 32768, 8, 54587392, 114688, 0, 0, 218103825, 0
    .long 1, 24, 24, 8192, 5632, 5888, 8388608, 3145728, 32768, 8, 33644544, 131072, 0, 0, 218105946, 0
    .long 2, 64, 72, 7168, 5120, 5120, 7340032, 3145728, 32768, 8, 65617920, 114688, 0, 0, 218104209, 0
    .long 2, 64, 72, 7168, 3584, 3584, 7340032, 2621440, 32768, 8, 63758336, 114688, 0, 0, 218104145, 0
    .long 2, 64, 72, 7168, 4096, 4096, 7340032, 0, 32768, 8, 54591488, 114688, 0, 0, 218103825, 0
    .long 2, 64, 72, 7168, 4608, 4608, 7340032, 2097152, 32768, 8, 61939712, 114688, 0, 0, 218104081, 0
    .long 2, 64, 72, 7168, 5120, 5120, 7340032, 524288, 32768, 8, 56442880, 114688, 0, 0, 218103889, 0
    .long 2, 64, 72, 7168, 3840, 3840, 7340032, 2097152, 32768, 8, 61927424, 114688, 0, 0, 218104081, 0
    .long 2, 64, 72, 7168, 5120, 5120, 7340032, 1572864, 32768, 8, 60112896, 114688, 0, 0, 218104017, 0
    .long 2, 64, 72, 7168, 3584, 3584, 7340032, 0, 32768, 8, 54583296, 114688, 0, 0, 218103825, 0
    .long 2, 64, 72, 7168, 4608, 4608, 7340032, 3670016, 32768, 8, 67444736, 114688, 0, 0, 218104273, 0
    .long 2, 64, 72, 7168, 3584, 3584, 7340032, 524288, 32768, 8, 56418304, 114688, 0, 0, 218103889, 0
    .long 2, 64, 72, 7168, 4864, 4864, 7340032, 524288, 32768, 8, 56438784, 114688, 0, 0, 218103889, 0
    .long 2, 64, 72, 7168, 5120, 5120, 7340032, 2097152, 32768, 8, 61947904, 114688, 0, 0, 218104081, 0
    .long 1, 24, 24, 8192, 5632, 5888, 8388608, 3670016, 32768, 8, 35741696, 131072, 0, 0, 218106202, 0
    .long 2, 64, 72, 7168, 4096, 4096, 7340032, 2621440, 32768, 8, 63766528, 114688, 0, 0, 218104145, 0
    .long 2, 64, 72, 7168, 4608, 4608, 7340032, 1572864, 32768, 8, 60104704, 114688, 0, 0, 218104017, 0
    .long 2, 64, 72, 7168, 3584, 3584, 7340032, 2097152, 32768, 8, 61923328, 114688, 0, 0, 218104081, 0
    .long 2, 64, 72, 7168, 4864, 4864, 7340032, 3145728, 32768, 8, 65613824, 114688, 0, 0, 218104209, 0
    .long 2, 64, 72, 7168, 3840, 3840, 7340032, 1572864, 32768, 8, 60092416, 114688, 0, 0, 218104017, 0
    .long 2, 64, 72, 7168, 3840, 3840, 7340032, 2621440, 32768, 8, 63762432, 114688, 0, 0, 218104145, 0
    .long 1, 24, 24, 8192, 4096, 4352, 8388608, 3670016, 32768, 8, 35717120, 131072, 0, 0, 218106186, 0
    .long 2, 64, 72, 7168, 5120, 5120, 7340032, 2621440, 32768, 8, 63782912, 114688, 0, 0, 218104145, 0
    .long 2, 64, 72, 7168, 4608, 4608, 7340032, 2621440, 32768, 8, 63774720, 114688, 0, 0, 218104145, 0
    .long 2, 64, 72, 7168, 4864, 4864, 7340032, 3670016, 32768, 8, 67448832, 114688, 0, 0, 218104273, 0
    .long 2, 64, 72, 7168, 4864, 4864, 7340032, 1572864, 32768, 8, 60108800, 114688, 0, 0, 218104017, 0
    .long 1, 40, 40, 2048, 4194816, 4195072, 8388608, 180420608, 131072, 16, 80748544, 32768, 218112256, 25, 218106504, 0
    .long 1, 80, 80, 2048, 3670016, 3670272, 7340032, 58253312, 114688, 14, 122683392, 32768, 218103952, 14, 218106498, 0
    .long 1, 24, 24, 8192, 5120, 5376, 8388608, 3670016, 32768, 8, 35733504, 131072, 0, 0, 218106202, 0
    .long 1, 40, 40, 2048, 4194304, 4194560, 8388608, 180420608, 131072, 16, 80740352, 32768, 218112256, 25, 218106504, 0
    .long 1, 40, 40, 2048, 4194304, 4194560, 8388608, 178323456, 131072, 16, 80216064, 32768, 218106960, 8, 218106440, 0
    .long 2, 64, 72, 7168, 4096, 4096, 7340032, 3145728, 32768, 8, 65601536, 114688, 0, 0, 218104209, 0
    .long 1, 40, 40, 2048, 4194816, 4195072, 8388608, 178323456, 131072, 16, 80224256, 32768, 218106960, 8, 218106440, 0
    .long 1, 80, 80, 2048, 3670528, 3670784, 7340032, 58253312, 114688, 14, 122691584, 32768, 218103952, 14, 218106498, 0
    .long 2, 64, 72, 7168, 3840, 3840, 7340032, 3145728, 32768, 8, 65597440, 114688, 0, 0, 218104209, 0
    .long 1, 32, 32, 8192, 4608, 4864, 8388608, 3670016, 32768, 8, 52502528, 131072, 0, 0, 218106186, 0
    .long 1, 16, 16, 8192, 4608, 4864, 8388608, 3670016, 32768, 8, 18948096, 131072, 0, 0, 218106186, 0
    .long 1, 40, 40, 2048, 4194816, 4195072, 8388608, 176226304, 131072, 16, 79699968, 32768, 218106896, 8, 218106376, 0
    .long 1, 40, 40, 2048, 4194304, 4194560, 8388608, 176226304, 131072, 16, 79691776, 32768, 218106896, 8, 218106376, 0
    .long 1, 32, 32, 8192, 4096, 4352, 8388608, 3670016, 32768, 8, 52494336, 131072, 0, 0, 218106186, 0
    .long 1, 24, 24, 8192, 4608, 4864, 8388608, 3670016, 32768, 8, 35725312, 131072, 0, 0, 218106186, 0
    .long 1, 16, 16, 8192, 4096, 4352, 8388608, 3670016, 32768, 8, 18939904, 131072, 0, 0, 218106186, 0
    .long 1, 32, 32, 8192, 5120, 5376, 8388608, 3670016, 32768, 8, 52510720, 131072, 0, 0, 218106202, 0
    .long 1, 32, 32, 8192, 5632, 5888, 8388608, 3670016, 32768, 8, 52518912, 131072, 0, 0, 218106202, 0
    .long 2, 64, 72, 7168, 4096, 4096, 7340032, 3670016, 32768, 8, 67436544, 114688, 0, 0, 218104273, 0
    .long 2, 64, 72, 7168, 3584, 3584, 7340032, 3670016, 32768, 8, 67428352, 114688, 0, 0, 218104273, 0
    .long 1, 16, 16, 8192, 5632, 5888, 8388608, 3670016, 32768, 8, 18964480, 131072, 0, 0, 218106202, 0
    .long 2, 64, 72, 7168, 5120, 5120, 7340032, 3670016, 32768, 8, 67452928, 114688, 0, 0, 218104273, 0
    .long 1, 80, 80, 2048, 3670528, 3670784, 7340032, 56418304, 114688, 14, 122167296, 32768, 218103888, 14, 218106434, 0
    .long 1, 80, 80, 2048, 3670016, 3670272, 7340032, 54583296, 114688, 14, 121634816, 32768, 218103824, 14, 218106370, 0
    .long 1, 80, 80, 2048, 3670016, 3670272, 7340032, 61923328, 114688, 14, 123731968, 32768, 218104080, 14, 218106626, 0
    .long 1, 80, 80, 2048, 3670016, 3670272, 7340032, 56418304, 114688, 14, 122159104, 32768, 218103888, 14, 218106434, 0
    .long 2, 64, 72, 7168, 3840, 3840, 7340032, 3670016, 32768, 8, 67432448, 114688, 0, 0, 218104273, 0
    .long 1, 40, 40, 2048, 4194304, 4194560, 8388608, 182517760, 131072, 16, 81264640, 32768, 218112256, 33, 218106568, 0
    .long 1, 40, 40, 2048, 4194816, 4195072, 8388608, 182517760, 131072, 16, 81272832, 32768, 218112256, 33, 218106568, 0
    .long 1, 80, 80, 2048, 3670528, 3670784, 7340032, 61923328, 114688, 14, 123740160, 32768, 218104080, 14, 218106626, 0
    .long 1, 80, 80, 2048, 3670528, 3670784, 7340032, 54583296, 114688, 14, 121643008, 32768, 218103824, 14, 218106370, 0
    .long 1, 80, 80, 2048, 3670528, 3670784, 7340032, 60088320, 114688, 14, 123215872, 32768, 218104016, 14, 218106562, 0
    .long 1, 80, 80, 2048, 3670016, 3670272, 7340032, 60088320, 114688, 14, 123207680, 32768, 218104016, 14, 218106562, 0
    .long 1, 40, 40, 2048, 4194816, 4195072, 8388608, 184614912, 131072, 8, 85991424, 32768, 218112256, 40, 218106628, 0
    .long 1, 40, 40, 2048, 4194304, 4194560, 8388608, 184614912, 131072, 8, 85983232, 32768, 218112256, 40, 218106628, 0
    .long 1, 40, 40, 2048, 4195840, 4196096, 8388608, 184614912, 131072, 8, 86007808, 32768, 218112256, 40, 218106628, 0
    .long 1, 40, 40, 2048, 4195328, 4195584, 8388608, 184614912, 131072, 8, 85999616, 32768, 218112256, 40, 218106628, 0
    .long 1, 80, 80, 2048, 3671552, 3671808, 7340032, 63758336, 114688, 7, 128475136, 32768, 218104144, 7, 218106689, 0
    .long 1, 80, 80, 2048, 3671040, 3671296, 7340032, 63758336, 114688, 7, 128466944, 32768, 218104144, 7, 218106689, 0
    .long 1, 80, 80, 2048, 3670016, 3670272, 7340032, 63758336, 114688, 7, 128450560, 32768, 218104144, 7, 218106689, 0
    .long 1, 80, 80, 2048, 3670528, 3670784, 7340032, 63758336, 114688, 7, 128458752, 32768, 218104144, 7, 218106689, 0
    .long 1, 80, 80, 2048, 3670528, 3670784, 7340032, 65593344, 114688, 7, 128983040, 32768, 218104208, 7, 218106753, 0
    .long 1, 80, 80, 2048, 3670016, 3670272, 7340032, 65593344, 114688, 7, 128974848, 32768, 218104208, 7, 218106753, 0
    .long 1, 80, 80, 2048, 3671552, 3671808, 7340032, 65593344, 114688, 7, 128999424, 32768, 218104208, 7, 218106753, 0
    .long 1, 40, 40, 2048, 4194816, 4195072, 8388608, 186712064, 131072, 8, 86515712, 32768, 218112256, 48, 218106692, 0
    .long 1, 80, 80, 2048, 3671040, 3671296, 7340032, 65593344, 114688, 7, 128991232, 32768, 218104208, 7, 218106753, 0
    .long 1, 40, 40, 2048, 4195328, 4195584, 8388608, 186712064, 131072, 8, 86523904, 32768, 218112256, 48, 218106692, 0
    .long 1, 40, 40, 2048, 4195840, 4196096, 8388608, 186712064, 131072, 8, 86532096, 32768, 218112256, 48, 218106692, 0
    .long 1, 40, 40, 2048, 4194304, 4194560, 8388608, 186712064, 131072, 8, 86507520, 32768, 218112256, 48, 218106692, 0
    .long 1, 80, 80, 2048, 3671552, 3671808, 7340032, 67428352, 114688, 7, 129523712, 32768, 218104272, 7, 218106817, 0
    .long 1, 80, 80, 2048, 3670528, 3670784, 7340032, 67428352, 114688, 7, 129507328, 32768, 218104272, 7, 218106817, 0
    .long 1, 80, 80, 2048, 3671040, 3671296, 7340032, 67428352, 114688, 7, 129515520, 32768, 218104272, 7, 218106817, 0
    .long 1, 80, 80, 2048, 3670016, 3670272, 7340032, 67428352, 114688, 7, 129499136, 32768, 218104272, 7, 218106817, 0
    .long 6, 1, 0, 2, 2, 16, 0, 23, 0, 0, 0, 0, 0, 0, 0, 0
    .long 6, 1, 0, 2, 2, 16, 0, 17, 0, 0, 0, 0, 0, 0, 0, 0
    .long 6, 1, 0, 2, 2, 16, 0, 20, 0, 0, 0, 0, 0, 0, 0, 0
    .long 6, 1, 0, 2, 2, 16, 0, 10, 0, 0, 0, 0, 0, 0, 0, 0
    .long 6, 1, 0, 2, 2, 16, 0, 6, 0, 0, 0, 0, 0, 0, 0, 0
    .long 6, 1, 0, 2, 2, 16, 0, 13, 0, 0, 0, 0, 0, 0, 0, 0
    .long 6, 1, 0, 1, 2, 16, 0, 38, 0, 0, 0, 0, 0, 0, 0, 0
    .long 6, 1, 0, 2, 2, 16, 0, 18, 0, 0, 0, 0, 0, 0, 0, 0
    .long 6, 1, 0, 2, 2, 16, 0, 9, 0, 0, 0, 0, 0, 0, 0, 0
    .long 6, 1, 0, 2, 2, 16, 0, 2, 0, 0, 0, 0, 0, 0, 0, 0
    .long 6, 1, 0, 2, 2, 16, 0, 5, 0, 0, 0, 0, 0, 0, 0, 0
    .long 6, 1, 0, 1, 2, 16, 0, 34, 0, 0, 0, 0, 0, 0, 0, 0
    .long 6, 1, 0, 2, 2, 16, 0, 7, 0, 0, 0, 0, 0, 0, 0, 0
    .long 6, 1, 0, 2, 2, 16, 0, 1, 0, 0, 0, 0, 0, 0, 0, 0
    .long 6, 1, 0, 2, 2, 16, 0, 12, 0, 0, 0, 0, 0, 0, 0, 0
    .long 6, 1, 0, 2, 2, 16, 0, 14, 0, 0, 0, 0, 0, 0, 0, 0
    .long 6, 1, 0, 2, 2, 16, 0, 0, 0, 0, 0, 0, 0, 0, 0, 0
    .long 6, 1, 0, 2, 2, 16, 0, 3, 0, 0, 0, 0, 0, 0, 0, 0
    .long 6, 1, 0, 2, 2, 16, 0, 22, 0, 0, 0, 0, 0, 0, 0, 0
    .long 6, 1, 0, 2, 2, 16, 0, 21, 0, 0, 0, 0, 0, 0, 0, 0
    .long 6, 1, 0, 2, 2, 16, 0, 8, 0, 0, 0, 0, 0, 0, 0, 0
    .long 6, 1, 0, 2, 2, 16, 0, 15, 0, 0, 0, 0, 0, 0, 0, 0
    .long 6, 1, 0, 2, 2, 16, 0, 19, 0, 0, 0, 0, 0, 0, 0, 0
    .long 6, 1, 0, 2, 2, 16, 0, 11, 0, 0, 0, 0, 0, 0, 0, 0
    .long 6, 1, 0, 2, 2, 16, 0, 16, 0, 0, 0, 0, 0, 0, 0, 0
    .long 6, 1, 0, 2, 2, 16, 0, 4, 0, 0, 0, 0, 0, 0, 0, 0
    .long 6, 0, 0, 0, 2, 0, 0, 54, 0, 0, 0, 0, 0, 0, 0, 0
    .long 6, 0, 0, 0, 2, 0, 0, 51, 0, 0, 0, 0, 0, 0, 0, 0
    .long 6, 0, 0, 0, 2, 0, 0, 48, 0, 0, 0, 0, 0, 0, 0, 0
    .long 6, 0, 0, 0, 2, 0, 0, 49, 0, 0, 0, 0, 0, 0, 0, 0
    .long 6, 0, 0, 0, 2, 0, 0, 50, 0, 0, 0, 0, 0, 0, 0, 0
    .long 6, 0, 0, 0, 2, 0, 0, 52, 0, 0, 0, 0, 0, 0, 0, 0
    .long 6, 0, 0, 0, 2, 0, 0, 53, 0, 0, 0, 0, 0, 0, 0, 0
    .long 6, 0, 0, 0, 2, 0, 0, 55, 0, 0, 0, 0, 0, 0, 0, 0
    .long 6, 1, 0, 1, 2, 16, 0, 32, 0, 0, 0, 0, 0, 0, 0, 0
    .long 6, 1, 0, 1, 2, 16, 0, 33, 0, 0, 0, 0, 0, 0, 0, 0
    .long 6, 1, 0, 1, 2, 16, 0, 35, 0, 0, 0, 0, 0, 0, 0, 0
    .long 6, 1, 0, 1, 2, 16, 0, 36, 0, 0, 0, 0, 0, 0, 0, 0
    .long 6, 1, 0, 1, 2, 16, 0, 37, 0, 0, 0, 0, 0, 0, 0, 0
    .long 6, 1, 0, 1, 2, 16, 0, 39, 0, 0, 0, 0, 0, 0, 0, 0
    .long 6, 1, 0, 2, 2, 16, 0, 24, 0, 0, 0, 0, 0, 0, 0, 0
    .long 6, 1, 0, 2, 2, 16, 0, 26, 0, 0, 0, 0, 0, 0, 0, 0
    .long 6, 1, 0, 2, 2, 16, 0, 27, 0, 0, 0, 0, 0, 0, 0, 0
    .long 6, 1, 0, 2, 2, 16, 0, 28, 0, 0, 0, 0, 0, 0, 0, 0
    .long 6, 1, 0, 2, 2, 16, 0, 29, 0, 0, 0, 0, 0, 0, 0, 0
    .long 6, 1, 0, 2, 2, 16, 0, 30, 0, 0, 0, 0, 0, 0, 0, 0
    .long 6, 1, 0, 2, 2, 16, 0, 31, 0, 0, 0, 0, 0, 0, 0, 0
    .long 6, 1, 0, 2, 2, 16, 0, 25, 0, 0, 0, 0, 0, 0, 0, 0
    .long 6, 0, 0, 1, 2, 16, 0, 40, 0, 0, 0, 0, 0, 0, 0, 0
    .long 6, 0, 0, 1, 2, 16, 0, 41, 0, 0, 0, 0, 0, 0, 0, 0
    .long 6, 0, 0, 1, 2, 16, 0, 42, 0, 0, 0, 0, 0, 0, 0, 0
    .long 6, 0, 0, 1, 2, 16, 0, 43, 0, 0, 0, 0, 0, 0, 0, 0
    .long 6, 0, 0, 1, 2, 16, 0, 44, 0, 0, 0, 0, 0, 0, 0, 0
    .long 6, 0, 0, 1, 2, 16, 0, 47, 0, 0, 0, 0, 0, 0, 0, 0
    .long 6, 0, 0, 1, 2, 16, 0, 46, 0, 0, 0, 0, 0, 0, 0, 0
    .long 6, 0, 0, 1, 2, 16, 0, 45, 0, 0, 0, 0, 0, 0, 0, 0
    .long 6, 0, 0, 0, 2, 0, 0, 56, 0, 0, 0, 0, 0, 0, 0, 0
    .long 6, 0, 0, 0, 2, 0, 0, 57, 0, 0, 0, 0, 0, 0, 0, 0
    .long 6, 0, 0, 0, 2, 0, 0, 58, 0, 0, 0, 0, 0, 0, 0, 0
    .long 6, 0, 0, 0, 2, 0, 0, 59, 0, 0, 0, 0, 0, 0, 0, 0
    .long 6, 0, 0, 0, 2, 0, 0, 60, 0, 0, 0, 0, 0, 0, 0, 0
    .long 7, 0, 0, 0, 8, 0, 0, 61, 0, 0, 0, 0, 0, 0, 0, 0
    .long 7, 0, 0, 0, 9, 0, 0, 61, 0, 0, 0, 0, 0, 0, 0, 0
    .long 7, 0, 0, 0, 10, 0, 0, 61, 0, 0, 0, 0, 0, 0, 0, 0
    .long 7, 0, 0, 0, 11, 0, 0, 61, 0, 0, 0, 0, 0, 0, 0, 0
    .long 7, 0, 0, 0, 8, 0, 0, 62, 0, 0, 0, 0, 0, 0, 0, 0
    .long 7, 0, 0, 0, 9, 0, 0, 62, 0, 0, 0, 0, 0, 0, 0, 0
    .long 7, 0, 0, 0, 10, 0, 0, 62, 0, 0, 0, 0, 0, 0, 0, 0
    .long 7, 0, 0, 0, 11, 0, 0, 62, 0, 0, 0, 0, 0, 0, 0, 0
    .long 7, 0, 0, 0, 8, 0, 0, 63, 0, 0, 0, 0, 0, 0, 0, 0
    .long 7, 0, 0, 0, 9, 0, 0, 63, 0, 0, 0, 0, 0, 0, 0, 0
    .long 7, 0, 0, 0, 10, 0, 0, 63, 0, 0, 0, 0, 0, 0, 0, 0
    .long 7, 0, 0, 0, 11, 0, 0, 63, 0, 0, 0, 0, 0, 0, 0, 0
    .long 0, 0, 0, 0, 0, 0, 0, 0, 0, 0, 0, 0, 0, 0, 0, 0
    .long 4, 24, 24, 8192, 6144, 268288, 8388608, 0, 32768, 4, 21069824, 131072, 0, 0, 218104417, 0
    .long 4, 24, 24, 8192, 6400, 268544, 8388608, 0, 32768, 4, 21073920, 131072, 0, 0, 218104417, 0
    .long 4, 24, 24, 8192, 6656, 268800, 8388608, 0, 32768, 4, 21078016, 131072, 0, 0, 218104417, 0
    .long 4, 24, 24, 8192, 6912, 269056, 8388608, 0, 32768, 4, 21082112, 131072, 0, 0, 218104417, 0
    .long 4, 24, 24, 8192, 7168, 269312, 8388608, 0, 32768, 4, 21086208, 131072, 0, 0, 218104433, 0
    .long 4, 24, 24, 8192, 7424, 269568, 8388608, 0, 32768, 4, 21090304, 131072, 0, 0, 218104433, 0
    .long 4, 24, 24, 8192, 7680, 269824, 8388608, 0, 32768, 4, 21094400, 131072, 0, 0, 218104433, 0
    .long 4, 24, 24, 8192, 7936, 270080, 8388608, 0, 32768, 4, 21098496, 131072, 0, 0, 218104433, 0
    .long 4, 32, 32, 8192, 6144, 268288, 8388608, 0, 32768, 4, 37847040, 131072, 0, 0, 218104417, 0
    .long 4, 32, 32, 8192, 6400, 268544, 8388608, 0, 32768, 4, 37851136, 131072, 0, 0, 218104417, 0
    .long 4, 32, 32, 8192, 6656, 268800, 8388608, 0, 32768, 4, 37855232, 131072, 0, 0, 218104417, 0
    .long 4, 32, 32, 8192, 6912, 269056, 8388608, 0, 32768, 4, 37859328, 131072, 0, 0, 218104417, 0
    .long 4, 32, 32, 8192, 7168, 269312, 8388608, 0, 32768, 4, 37863424, 131072, 0, 0, 218104433, 0
    .long 4, 32, 32, 8192, 7424, 269568, 8388608, 0, 32768, 4, 37867520, 131072, 0, 0, 218104433, 0
    .long 4, 32, 32, 8192, 7680, 269824, 8388608, 0, 32768, 4, 37871616, 131072, 0, 0, 218104433, 0
    .long 4, 32, 32, 8192, 7936, 270080, 8388608, 0, 32768, 4, 37875712, 131072, 0, 0, 218104433, 0
    .long 4, 24, 24, 8192, 6144, 268288, 8388608, 262144, 32768, 4, 22118400, 131072, 0, 0, 218104420, 0
    .long 4, 24, 24, 8192, 6400, 268544, 8388608, 262144, 32768, 4, 22122496, 131072, 0, 0, 218104420, 0
    .long 4, 24, 24, 8192, 6656, 268800, 8388608, 262144, 32768, 4, 22126592, 131072, 0, 0, 218104420, 0
    .long 4, 24, 24, 8192, 6912, 269056, 8388608, 262144, 32768, 4, 22130688, 131072, 0, 0, 218104420, 0
    .long 4, 24, 24, 8192, 7168, 269312, 8388608, 262144, 32768, 4, 22134784, 131072, 0, 0, 218104436, 0
    .long 4, 24, 24, 8192, 7424, 269568, 8388608, 262144, 32768, 4, 22138880, 131072, 0, 0, 218104436, 0
    .long 4, 24, 24, 8192, 7680, 269824, 8388608, 262144, 32768, 4, 22142976, 131072, 0, 0, 218104436, 0
    .long 4, 24, 24, 8192, 7936, 270080, 8388608, 262144, 32768, 4, 22147072, 131072, 0, 0, 218104436, 0
    .long 4, 32, 32, 8192, 6144, 268288, 8388608, 262144, 32768, 4, 38895616, 131072, 0, 0, 218104420, 0
    .long 4, 32, 32, 8192, 6400, 268544, 8388608, 262144, 32768, 4, 38899712, 131072, 0, 0, 218104420, 0
    .long 4, 32, 32, 8192, 6656, 268800, 8388608, 262144, 32768, 4, 38903808, 131072, 0, 0, 218104420, 0
    .long 4, 32, 32, 8192, 6912, 269056, 8388608, 262144, 32768, 4, 38907904, 131072, 0, 0, 218104420, 0
    .long 4, 32, 32, 8192, 7168, 269312, 8388608, 262144, 32768, 4, 38912000, 131072, 0, 0, 218104436, 0
    .long 4, 32, 32, 8192, 7424, 269568, 8388608, 262144, 32768, 4, 38916096, 131072, 0, 0, 218104436, 0
    .long 4, 32, 32, 8192, 7680, 269824, 8388608, 262144, 32768, 4, 38920192, 131072, 0, 0, 218104436, 0
    .long 4, 32, 32, 8192, 7936, 270080, 8388608, 262144, 32768, 4, 38924288, 131072, 0, 0, 218104436, 0
    .long 4, 32, 32, 8192, 6656, 268800, 8388608, 786432, 32768, 4, 41000960, 131072, 0, 0, 218104676, 0
    .long 4, 32, 32, 8192, 7680, 269824, 8388608, 786432, 32768, 4, 41017344, 131072, 0, 0, 218104692, 0
    .long 4, 32, 32, 8192, 7936, 270080, 8388608, 524288, 32768, 4, 39972864, 131072, 0, 0, 218104689, 0
    .long 4, 24, 24, 8192, 6656, 268800, 8388608, 786432, 32768, 4, 24223744, 131072, 0, 0, 218104676, 0
    .long 4, 32, 32, 8192, 6656, 268800, 8388608, 524288, 32768, 4, 39952384, 131072, 0, 0, 218104673, 0
    .long 4, 32, 32, 8192, 7936, 270080, 8388608, 786432, 32768, 4, 41021440, 131072, 0, 0, 218104692, 0
    .long 4, 24, 24, 8192, 7680, 269824, 8388608, 786432, 32768, 4, 24240128, 131072, 0, 0, 218104692, 0
    .long 4, 24, 24, 8192, 6400, 268544, 8388608, 524288, 32768, 4, 23171072, 131072, 0, 0, 218104673, 0
    .long 4, 24, 24, 8192, 6912, 269056, 8388608, 524288, 32768, 4, 23179264, 131072, 0, 0, 218104673, 0
    .long 4, 24, 24, 8192, 7424, 269568, 8388608, 524288, 32768, 4, 23187456, 131072, 0, 0, 218104689, 0
    .long 4, 24, 24, 8192, 6912, 269056, 8388608, 786432, 32768, 4, 24227840, 131072, 0, 0, 218104676, 0
    .long 4, 32, 32, 8192, 6400, 268544, 8388608, 524288, 32768, 4, 39948288, 131072, 0, 0, 218104673, 0
    .long 4, 32, 32, 8192, 7168, 269312, 8388608, 524288, 32768, 4, 39960576, 131072, 0, 0, 218104689, 0
    .long 4, 24, 24, 8192, 7680, 269824, 8388608, 524288, 32768, 4, 23191552, 131072, 0, 0, 218104689, 0
    .long 4, 32, 32, 8192, 6912, 269056, 8388608, 524288, 32768, 4, 39956480, 131072, 0, 0, 218104673, 0
    .long 4, 24, 24, 8192, 6144, 268288, 8388608, 524288, 32768, 4, 23166976, 131072, 0, 0, 218104673, 0
    .long 4, 32, 32, 8192, 7168, 269312, 8388608, 786432, 32768, 4, 41009152, 131072, 0, 0, 218104692, 0
    .long 4, 24, 24, 8192, 7936, 270080, 8388608, 786432, 32768, 4, 24244224, 131072, 0, 0, 218104692, 0
    .long 4, 32, 32, 8192, 6144, 268288, 8388608, 524288, 32768, 4, 39944192, 131072, 0, 0, 218104673, 0
    .long 4, 24, 24, 8192, 7424, 269568, 8388608, 786432, 32768, 4, 24236032, 131072, 0, 0, 218104692, 0
    .long 4, 32, 32, 8192, 6400, 268544, 8388608, 786432, 32768, 4, 40996864, 131072, 0, 0, 218104676, 0
    .long 4, 24, 24, 8192, 7168, 269312, 8388608, 786432, 32768, 4, 24231936, 131072, 0, 0, 218104692, 0
    .long 4, 24, 24, 8192, 6656, 268800, 8388608, 524288, 32768, 4, 23175168, 131072, 0, 0, 218104673, 0
    .long 4, 24, 24, 8192, 6400, 268544, 8388608, 786432, 32768, 4, 24219648, 131072, 0, 0, 218104676, 0
    .long 4, 32, 32, 8192, 7424, 269568, 8388608, 786432, 32768, 4, 41013248, 131072, 0, 0, 218104692, 0
    .long 4, 24, 24, 8192, 6144, 268288, 8388608, 786432, 32768, 4, 24215552, 131072, 0, 0, 218104676, 0
    .long 4, 32, 32, 8192, 7680, 269824, 8388608, 524288, 32768, 4, 39968768, 131072, 0, 0, 218104689, 0
    .long 4, 32, 32, 8192, 6912, 269056, 8388608, 786432, 32768, 4, 41005056, 131072, 0, 0, 218104676, 0
    .long 4, 32, 32, 8192, 7424, 269568, 8388608, 524288, 32768, 4, 39964672, 131072, 0, 0, 218104689, 0
    .long 4, 24, 24, 8192, 7168, 269312, 8388608, 524288, 32768, 4, 23183360, 131072, 0, 0, 218104689, 0
    .long 4, 24, 24, 8192, 7936, 270080, 8388608, 524288, 32768, 4, 23195648, 131072, 0, 0, 218104689, 0
    .long 4, 32, 32, 8192, 6144, 268288, 8388608, 786432, 32768, 4, 40992768, 131072, 0, 0, 218104676, 0
    .long 1, 16, 16, 8192, 6144, 6400, 8388608, 1572864, 32768, 8, 10584064, 131072, 0, 0, 218105194, 0
    .long 1, 32, 32, 8192, 6656, 6912, 8388608, 1048576, 32768, 8, 42049536, 131072, 0, 0, 218104938, 0
    .long 1, 32, 32, 8192, 6656, 6912, 8388608, 1572864, 32768, 8, 44146688, 131072, 0, 0, 218105194, 0
    .long 1, 24, 24, 8192, 6656, 6912, 8388608, 1048576, 32768, 8, 25272320, 131072, 0, 0, 218104938, 0
    .long 1, 16, 16, 8192, 7168, 7424, 8388608, 1048576, 32768, 8, 8503296, 131072, 0, 0, 218104954, 0
    .long 1, 16, 16, 8192, 7680, 7936, 8388608, 1048576, 32768, 8, 8511488, 131072, 0, 0, 218104954, 0
    .long 1, 32, 32, 8192, 7680, 7936, 8388608, 1048576, 32768, 8, 42065920, 131072, 0, 0, 218104954, 0
    .long 1, 24, 24, 8192, 7168, 7424, 8388608, 1048576, 32768, 8, 25280512, 131072, 0, 0, 218104954, 0
    .long 1, 24, 24, 8192, 7680, 7936, 8388608, 2097152, 32768, 8, 29483008, 131072, 0, 0, 218105466, 0
    .long 1, 24, 24, 8192, 7680, 7936, 8388608, 1048576, 32768, 8, 25288704, 131072, 0, 0, 218104954, 0
    .long 1, 32, 32, 8192, 7168, 7424, 8388608, 1048576, 32768, 8, 42057728, 131072, 0, 0, 218104954, 0
    .long 1, 24, 24, 8192, 7168, 7424, 8388608, 2097152, 32768, 8, 29474816, 131072, 0, 0, 218105466, 0
    .long 1, 24, 24, 8192, 6144, 6400, 8388608, 1572864, 32768, 8, 27361280, 131072, 0, 0, 218105194, 0
    .long 1, 32, 32, 8192, 6144, 6400, 8388608, 1572864, 32768, 8, 44138496, 131072, 0, 0, 218105194, 0
    .long 1, 24, 24, 8192, 7168, 7424, 8388608, 1572864, 32768, 8, 27377664, 131072, 0, 0, 218105210, 0
    .long 1, 16, 16, 8192, 6144, 6400, 8388608, 1048576, 32768, 8, 8486912, 131072, 0, 0, 218104938, 0
    .long 1, 24, 24, 8192, 6656, 6912, 8388608, 1572864, 32768, 8, 27369472, 131072, 0, 0, 218105194, 0
    .long 1, 16, 16, 8192, 6656, 6912, 8388608, 1572864, 32768, 8, 10592256, 131072, 0, 0, 218105194, 0
    .long 1, 32, 32, 8192, 7168, 7424, 8388608, 1572864, 32768, 8, 44154880, 131072, 0, 0, 218105210, 0
    .long 1, 16, 16, 8192, 7168, 7424, 8388608, 1572864, 32768, 8, 10600448, 131072, 0, 0, 218105210, 0
    .long 1, 32, 32, 8192, 7680, 7936, 8388608, 2097152, 32768, 8, 46260224, 131072, 0, 0, 218105466, 0
    .long 1, 24, 24, 8192, 6144, 6400, 8388608, 1048576, 32768, 8, 25264128, 131072, 0, 0, 218104938, 0
    .long 1, 24, 24, 8192, 6144, 6400, 8388608, 2097152, 32768, 8, 29458432, 131072, 0, 0, 218105450, 0
    .long 1, 16, 16, 8192, 7680, 7936, 8388608, 1572864, 32768, 8, 10608640, 131072, 0, 0, 218105210, 0
    .long 2, 64, 72, 7168, 6144, 6144, 7340032, 1572864, 32768, 8, 60129280, 114688, 0, 0, 218104017, 0
    .long 1, 32, 32, 8192, 6144, 6400, 8388608, 2097152, 32768, 8, 46235648, 131072, 0, 0, 218105450, 0
    .long 1, 32, 32, 8192, 6144, 6400, 8388608, 1048576, 32768, 8, 42041344, 131072, 0, 0, 218104938, 0
    .long 1, 32, 32, 8192, 6656, 6912, 8388608, 2097152, 32768, 8, 46243840, 131072, 0, 0, 218105450, 0
    .long 1, 24, 24, 8192, 7680, 7936, 8388608, 1572864, 32768, 8, 27385856, 131072, 0, 0, 218105210, 0
    .long 1, 32, 32, 8192, 7680, 7936, 8388608, 1572864, 32768, 8, 44163072, 131072, 0, 0, 218105210, 0
    .long 1, 16, 16, 8192, 6656, 6912, 8388608, 1048576, 32768, 8, 8495104, 131072, 0, 0, 218104938, 0
    .long 1, 32, 32, 8192, 7168, 7424, 8388608, 2097152, 32768, 8, 46252032, 131072, 0, 0, 218105466, 0
    .long 1, 16, 16, 8192, 6656, 6912, 8388608, 0, 32768, 8, 4300800, 131072, 0, 0, 218108010, 0
    .long 2, 64, 72, 7168, 6144, 6144, 7340032, 2097152, 32768, 8, 61964288, 114688, 0, 0, 218104081, 0
    .long 1, 16, 16, 8192, 7680, 7936, 8388608, 2097152, 32768, 8, 12705792, 131072, 0, 0, 218105466, 0
    .long 1, 16, 16, 8192, 6656, 6912, 8388608, 524288, 32768, 8, 6397952, 131072, 0, 0, 218108266, 0
    .long 1, 16, 16, 8192, 7680, 7936, 8388608, 3145728, 32768, 8, 16900096, 131072, 0, 0, 218105978, 0
    .long 1, 32, 32, 8192, 7680, 7936, 8388608, 2621440, 32768, 8, 48357376, 131072, 0, 0, 218105722, 0
    .long 1, 16, 16, 8192, 7168, 7424, 8388608, 0, 32768, 8, 4308992, 131072, 0, 0, 218108026, 0
    .long 1, 16, 16, 8192, 6144, 6400, 8388608, 2097152, 32768, 8, 12681216, 131072, 0, 0, 218105450, 0
    .long 1, 16, 16, 8192, 7680, 7936, 8388608, 0, 32768, 8, 4317184, 131072, 0, 0, 218108026, 0
    .long 1, 16, 16, 8192, 6144, 6400, 8388608, 524288, 32768, 8, 6389760, 131072, 0, 0, 218108266, 0
    .long 1, 24, 24, 8192, 7168, 7424, 8388608, 3145728, 32768, 8, 33669120, 131072, 0, 0, 218105978, 0
    .long 1, 24, 24, 8192, 6656, 6912, 8388608, 2621440, 32768, 8, 31563776, 131072, 0, 0, 218105706, 0
    .long 1, 16, 16, 8192, 6656, 6912, 8388608, 2621440, 32768, 8, 14786560, 131072, 0, 0, 218105706, 0
    .long 1, 16, 16, 8192, 7168, 7424, 8388608, 524288, 32768, 8, 6406144, 131072, 0, 0, 218108282, 0
    .long 2, 64, 72, 7168, 6656, 6656, 7340032, 0, 32768, 8, 54632448, 114688, 0, 0, 218103825, 0
    .long 2, 64, 72, 7168, 6144, 6144, 7340032, 0, 32768, 8, 54624256, 114688, 0, 0, 218103825, 0
    .long 2, 64, 72, 7168, 6656, 6656, 7340032, 1048576, 32768, 8, 58302464, 114688, 0, 0, 218103953, 0
    .long 1, 16, 16, 8192, 6144, 6400, 8388608, 0, 32768, 8, 4292608, 131072, 0, 0, 218108010, 0
    .long 1, 16, 16, 8192, 7680, 7936, 8388608, 524288, 32768, 8, 6414336, 131072, 0, 0, 218108282, 0
    .long 1, 24, 24, 8192, 7168, 7424, 8388608, 2621440, 32768, 8, 31571968, 131072, 0, 0, 218105722, 0
    .long 1, 16, 16, 8192, 7680, 7936, 8388608, 2621440, 32768, 8, 14802944, 131072, 0, 0, 218105722, 0
    .long 1, 24, 24, 8192, 6656, 6912, 8388608, 2097152, 32768, 8, 29466624, 131072, 0, 0, 218105450, 0
    .long 2, 64, 72, 7168, 6656, 6656, 7340032, 2097152, 32768, 8, 61972480, 114688, 0, 0, 218104081, 0
    .long 1, 16, 16, 8192, 6656, 6912, 8388608, 3145728, 32768, 8, 16883712, 131072, 0, 0, 218105962, 0
    .long 1, 16, 16, 8192, 6656, 6912, 8388608, 2097152, 32768, 8, 12689408, 131072, 0, 0, 218105450, 0
    .long 2, 64, 72, 7168, 6144, 6144, 7340032, 3670016, 32768, 8, 67469312, 114688, 0, 0, 218104276, 0
    .long 1, 24, 24, 8192, 6656, 6912, 8388608, 3145728, 32768, 8, 33660928, 131072, 0, 0, 218105962, 0
    .long 2, 64, 72, 7168, 5888, 5888, 7340032, 2097152, 32768, 8, 61960192, 114688, 0, 0, 218104081, 0
    .long 1, 16, 16, 8192, 7168, 7424, 8388608, 2097152, 32768, 8, 12697600, 131072, 0, 0, 218105466, 0
    .long 2, 64, 72, 7168, 6656, 6656, 7340032, 2621440, 32768, 8, 63807488, 114688, 0, 0, 218104148, 0
    .long 1, 32, 32, 8192, 7680, 7936, 8388608, 3145728, 32768, 8, 50454528, 131072, 0, 0, 218105978, 0
    .long 1, 24, 24, 8192, 6144, 6400, 8388608, 2621440, 32768, 8, 31555584, 131072, 0, 0, 218105706, 0
    .long 2, 64, 72, 7168, 5376, 5376, 7340032, 1048576, 32768, 8, 58281984, 114688, 0, 0, 218103953, 0
    .long 1, 32, 32, 8192, 7168, 7424, 8388608, 3145728, 32768, 8, 50446336, 131072, 0, 0, 218105978, 0
    .long 2, 64, 72, 7168, 6144, 6144, 7340032, 3145728, 32768, 8, 65634304, 114688, 0, 0, 218104212, 0
    .long 1, 16, 16, 8192, 6144, 6400, 8388608, 3145728, 32768, 8, 16875520, 131072, 0, 0, 218105962, 0
    .long 2, 64, 72, 7168, 6912, 6912, 7340032, 1048576, 32768, 8, 58306560, 114688, 0, 0, 218103953, 0
    .long 2, 64, 72, 7168, 5376, 5376, 7340032, 3145728, 32768, 8, 65622016, 114688, 0, 0, 218104212, 0
    .long 2, 64, 72, 7168, 6144, 6144, 7340032, 2621440, 32768, 8, 63799296, 114688, 0, 0, 218104148, 0
    .long 2, 64, 72, 7168, 5632, 5632, 7340032, 1048576, 32768, 8, 58286080, 114688, 0, 0, 218103953, 0
    .long 2, 64, 72, 7168, 6400, 6400, 7340032, 3145728, 32768, 8, 65638400, 114688, 0, 0, 218104212, 0
    .long 1, 16, 16, 8192, 7168, 7424, 8388608, 2621440, 32768, 8, 14794752, 131072, 0, 0, 218105722, 0
    .long 1, 32, 32, 8192, 6144, 6400, 8388608, 2621440, 32768, 8, 48332800, 131072, 0, 0, 218105706, 0
    .long 1, 16, 16, 8192, 6144, 6400, 8388608, 2621440, 32768, 8, 14778368, 131072, 0, 0, 218105706, 0
    .long 5, 218108256, 0, 0, 24, 0, 0, 8, 0, 0, 0, 0, 218112384, 11, 218106961, 0
    .long 2, 64, 72, 7168, 5632, 5632, 7340032, 524288, 32768, 8, 56451072, 114688, 0, 0, 218103889, 0
    .long 2, 64, 72, 7168, 6400, 6400, 7340032, 0, 32768, 8, 54628352, 114688, 0, 0, 218103825, 0
    .long 1, 24, 24, 8192, 6144, 6400, 8388608, 3145728, 32768, 8, 33652736, 131072, 0, 0, 218105962, 0
    .long 2, 64, 72, 7168, 6912, 6912, 7340032, 0, 32768, 8, 54636544, 114688, 0, 0, 218103825, 0
    .long 5, 218108000, 0, 0, 24, 0, 0, 0, 0, 0, 0, 0, 218112384, 3, 218106897, 0
    .long 1, 32, 32, 8192, 6656, 6912, 8388608, 3145728, 32768, 8, 50438144, 131072, 0, 0, 218105962, 0
    .long 5, 218108272, 0, 0, 28, 0, 0, 8, 0, 0, 0, 0, 218112384, 11, 218106961, 0
    .long 1, 24, 24, 8192, 7680, 7936, 8388608, 2621440, 32768, 8, 31580160, 131072, 0, 0, 218105722, 0
    .long 1, 32, 32, 8192, 7168, 7424, 8388608, 2621440, 32768, 8, 48349184, 131072, 0, 0, 218105722, 0
    .long 2, 64, 72, 7168, 6144, 6144, 7340032, 1048576, 32768, 8, 58294272, 114688, 0, 0, 218103953, 0
    .long 2, 64, 72, 7168, 6144, 6144, 7340032, 524288, 32768, 8, 56459264, 114688, 0, 0, 218103889, 0
    .long 2, 64, 72, 7168, 5888, 5888, 7340032, 524288, 32768, 8, 56455168, 114688, 0, 0, 218103889, 0
    .long 2, 64, 72, 7168, 6400, 6400, 7340032, 1048576, 32768, 8, 58298368, 114688, 0, 0, 218103953, 0
    .long 1, 32, 32, 8192, 6656, 6912, 8388608, 2621440, 32768, 8, 48340992, 131072, 0, 0, 218105706, 0
    .long 2, 64, 72, 7168, 5888, 5888, 7340032, 1048576, 32768, 8, 58290176, 114688, 0, 0, 218103953, 0
    .long 1, 16, 16, 8192, 7168, 7424, 8388608, 3670016, 32768, 8, 18989056, 131072, 0, 0, 218106234, 0
    .long 2, 64, 72, 7168, 6400, 6400, 7340032, 524288, 32768, 8, 56463360, 114688, 0, 0, 218103889, 0
    .long 1, 16, 16, 8192, 7168, 7424, 8388608, 3145728, 32768, 8, 16891904, 131072, 0, 0, 218105978, 0
    .long 5, 218108016, 0, 0, 28, 0, 0, 0, 0, 0, 0, 0, 218112384, 3, 218106897, 0
    .long 5, 218108016, 0, 0, 28, 0, 0, 4, 0, 0, 0, 0, 218112384, 7, 218106897, 0
    .long 5, 218108272, 0, 0, 28, 0, 0, 12, 0, 0, 0, 0, 218112384, 15, 218106961, 0
    .long 5, 218108256, 0, 0, 24, 0, 0, 12, 0, 0, 0, 0, 218112384, 15, 218106961, 0
    .long 5, 218108000, 0, 0, 24, 0, 0, 4, 0, 0, 0, 0, 218112384, 7, 218106897, 0
    .long 1, 32, 32, 8192, 6144, 6400, 8388608, 3145728, 32768, 8, 50429952, 131072, 0, 0, 218105962, 0
    .long 2, 64, 72, 7168, 5888, 5888, 7340032, 1572864, 32768, 8, 60125184, 114688, 0, 0, 218104017, 0
    .long 2, 64, 72, 7168, 5376, 5376, 7340032, 1572864, 32768, 8, 60116992, 114688, 0, 0, 218104017, 0
    .long 2, 64, 72, 7168, 5632, 5632, 7340032, 0, 32768, 8, 54616064, 114688, 0, 0, 218103825, 0
    .long 1, 24, 24, 8192, 7680, 7936, 8388608, 3145728, 32768, 8, 33677312, 131072, 0, 0, 218105978, 0
    .long 2, 64, 72, 7168, 6912, 6912, 7340032, 3145728, 32768, 8, 65646592, 114688, 0, 0, 218104212, 0
    .long 2, 64, 72, 7168, 5376, 5376, 7340032, 2621440, 32768, 8, 63787008, 114688, 0, 0, 218104148, 0
    .long 2, 64, 72, 7168, 5888, 5888, 7340032, 0, 32768, 8, 54620160, 114688, 0, 0, 218103825, 0
    .long 2, 64, 72, 7168, 6400, 6400, 7340032, 2097152, 32768, 8, 61968384, 114688, 0, 0, 218104081, 0
    .long 2, 64, 72, 7168, 6912, 6912, 7340032, 524288, 32768, 8, 56471552, 114688, 0, 0, 218103889, 0
    .long 2, 64, 72, 7168, 5632, 5632, 7340032, 2097152, 32768, 8, 61956096, 114688, 0, 0, 218104081, 0
    .long 2, 64, 72, 7168, 6912, 6912, 7340032, 1572864, 32768, 8, 60141568, 114688, 0, 0, 218104017, 0
    .long 2, 64, 72, 7168, 5376, 5376, 7340032, 0, 32768, 8, 54611968, 114688, 0, 0, 218103825, 0
    .long 2, 64, 72, 7168, 6400, 6400, 7340032, 3670016, 32768, 8, 67473408, 114688, 0, 0, 218104276, 0
    .long 2, 64, 72, 7168, 5376, 5376, 7340032, 524288, 32768, 8, 56446976, 114688, 0, 0, 218103889, 0
    .long 2, 64, 72, 7168, 6656, 6656, 7340032, 524288, 32768, 8, 56467456, 114688, 0, 0, 218103889, 0
    .long 2, 64, 72, 7168, 6912, 6912, 7340032, 2097152, 32768, 8, 61976576, 114688, 0, 0, 218104081, 0
    .long 1, 24, 24, 8192, 7680, 7936, 8388608, 3670016, 32768, 8, 35774464, 131072, 0, 0, 218106234, 0
    .long 2, 64, 72, 7168, 5888, 5888, 7340032, 2621440, 32768, 8, 63795200, 114688, 0, 0, 218104148, 0
    .long 2, 64, 72, 7168, 6400, 6400, 7340032, 1572864, 32768, 8, 60133376, 114688, 0, 0, 218104017, 0
    .long 2, 64, 72, 7168, 5376, 5376, 7340032, 2097152, 32768, 8, 61952000, 114688, 0, 0, 218104081, 0
    .long 2, 64, 72, 7168, 6656, 6656, 7340032, 3145728, 32768, 8, 65642496, 114688, 0, 0, 218104212, 0
    .long 2, 64, 72, 7168, 5632, 5632, 7340032, 1572864, 32768, 8, 60121088, 114688, 0, 0, 218104017, 0
    .long 2, 64, 72, 7168, 5632, 5632, 7340032, 2621440, 32768, 8, 63791104, 114688, 0, 0, 218104148, 0
    .long 1, 24, 24, 8192, 6144, 6400, 8388608, 3670016, 32768, 8, 35749888, 131072, 0, 0, 218106218, 0
    .long 2, 64, 72, 7168, 6912, 6912, 7340032, 2621440, 32768, 8, 63811584, 114688, 0, 0, 218104148, 0
    .long 2, 64, 72, 7168, 6400, 6400, 7340032, 2621440, 32768, 8, 63803392, 114688, 0, 0, 218104148, 0
    .long 2, 64, 72, 7168, 6656, 6656, 7340032, 3670016, 32768, 8, 67477504, 114688, 0, 0, 218104276, 0
    .long 2, 64, 72, 7168, 6656, 6656, 7340032, 1572864, 32768, 8, 60137472, 114688, 0, 0, 218104017, 0
    .long 1, 40, 40, 2048, 4195840, 4196096, 8388608, 180420608, 131072, 16, 80764928, 32768, 218112384, 25, 218106504, 0
    .long 1, 80, 80, 2048, 3671040, 3671296, 7340032, 58253312, 114688, 14, 122699776, 32768, 218103952, 14, 218106498, 0
    .long 1, 24, 24, 8192, 7168, 7424, 8388608, 3670016, 32768, 8, 35766272, 131072, 0, 0, 218106234, 0
    .long 1, 40, 40, 2048, 4195328, 4195584, 8388608, 180420608, 131072, 16, 80756736, 32768, 218112384, 25, 218106504, 0
    .long 1, 40, 40, 2048, 4195328, 4195584, 8388608, 178323456, 131072, 16, 80232448, 32768, 218106960, 8, 218106440, 0
    .long 2, 64, 72, 7168, 5888, 5888, 7340032, 3145728, 32768, 8, 65630208, 114688, 0, 0, 218104212, 0
    .long 1, 40, 40, 2048, 4195840, 4196096, 8388608, 178323456, 131072, 16, 80240640, 32768, 218106960, 8, 218106440, 0
    .long 1, 80, 80, 2048, 3671552, 3671808, 7340032, 58253312, 114688, 14, 122707968, 32768, 218103952, 14, 218106498, 0
    .long 2, 64, 72, 7168, 5632, 5632, 7340032, 3145728, 32768, 8, 65626112, 114688, 0, 0, 218104212, 0
    .long 1, 32, 32, 8192, 6656, 6912, 8388608, 3670016, 32768, 8, 52535296, 131072, 0, 0, 218106218, 0
    .long 1, 16, 16, 8192, 6656, 6912, 8388608, 3670016, 32768, 8, 18980864, 131072, 0, 0, 218106218, 0
    .long 1, 40, 40, 2048, 4195840, 4196096, 8388608, 176226304, 131072, 16, 79716352, 32768, 218106896, 8, 218106376, 0
    .long 1, 40, 40, 2048, 4195328, 4195584, 8388608, 176226304, 131072, 16, 79708160, 32768, 218106896, 8, 218106376, 0
    .long 1, 32, 32, 8192, 6144, 6400, 8388608, 3670016, 32768, 8, 52527104, 131072, 0, 0, 218106218, 0
    .long 1, 24, 24, 8192, 6656, 6912, 8388608, 3670016, 32768, 8, 35758080, 131072, 0, 0, 218106218, 0
    .long 1, 16, 16, 8192, 6144, 6400, 8388608, 3670016, 32768, 8, 18972672, 131072, 0, 0, 218106218, 0
    .long 1, 32, 32, 8192, 7168, 7424, 8388608, 3670016, 32768, 8, 52543488, 131072, 0, 0, 218106234, 0
    .long 1, 32, 32, 8192, 7680, 7936, 8388608, 3670016, 32768, 8, 52551680, 131072, 0, 0, 218106234, 0
    .long 2, 64, 72, 7168, 5888, 5888, 7340032, 3670016, 32768, 8, 67465216, 114688, 0, 0, 218104276, 0
    .long 2, 64, 72, 7168, 5376, 5376, 7340032, 3670016, 32768, 8, 67457024, 114688, 0, 0, 218104276, 0
    .long 1, 16, 16, 8192, 7680, 7936, 8388608, 3670016, 32768, 8, 18997248, 131072, 0, 0, 218106234, 0
    .long 2, 64, 72, 7168, 6912, 6912, 7340032, 3670016, 32768, 8, 67481600, 114688, 0, 0, 218104276, 0
    .long 1, 80, 80, 2048, 3671552, 3671808, 7340032, 56418304, 114688, 14, 122183680, 32768, 218103888, 14, 218106434, 0
    .long 1, 80, 80, 2048, 3671040, 3671296, 7340032, 54583296, 114688, 14, 121651200, 32768, 218103824, 14, 218106370, 0
    .long 1, 80, 80, 2048, 3671040, 3671296, 7340032, 61923328, 114688, 14, 123748352, 32768, 218104080, 14, 218106626, 0
    .long 1, 80, 80, 2048, 3671040, 3671296, 7340032, 56418304, 114688, 14, 122175488, 32768, 218103888, 14, 218106434, 0
    .long 2, 64, 72, 7168, 5632, 5632, 7340032, 3670016, 32768, 8, 67461120, 114688, 0, 0, 218104276, 0
    .long 1, 40, 40, 2048, 4195328, 4195584, 8388608, 182517760, 131072, 16, 81281024, 32768, 218112384, 33, 218106568, 0
    .long 1, 40, 40, 2048, 4195840, 4196096, 8388608, 182517760, 131072, 16, 81289216, 32768, 218112384, 33, 218106568, 0
    .long 1, 80, 80, 2048, 3671552, 3671808, 7340032, 61923328, 114688, 14, 123756544, 32768, 218104080, 14, 218106626, 0
    .long 1, 80, 80, 2048, 3671552, 3671808, 7340032, 54583296, 114688, 14, 121659392, 32768, 218103824, 14, 218106370, 0
    .long 1, 80, 80, 2048, 3671552, 3671808, 7340032, 60088320, 114688, 14, 123232256, 32768, 218104016, 14, 218106562, 0
    .long 1, 80, 80, 2048, 3671040, 3671296, 7340032, 60088320, 114688, 14, 123224064, 32768, 218104016, 14, 218106562, 0
    .long 1, 40, 40, 2048, 6291968, 6292224, 8388608, 184647680, 131072, 8, 90185728, 32768, 218112384, 40, 218106628, 0
    .long 1, 40, 40, 2048, 6291456, 6291712, 8388608, 184647680, 131072, 8, 90177536, 32768, 218112384, 40, 218106628, 0
    .long 1, 40, 40, 2048, 6292992, 6293248, 8388608, 184647680, 131072, 8, 90202112, 32768, 218112384, 40, 218106628, 0
    .long 1, 40, 40, 2048, 6292480, 6292736, 8388608, 184647680, 131072, 8, 90193920, 32768, 218112384, 40, 218106628, 0
    .long 1, 80, 80, 2048, 5506560, 5506816, 7340032, 63787008, 114688, 7, 132669440, 32768, 218104148, 7, 218106689, 0
    .long 1, 80, 80, 2048, 5506048, 5506304, 7340032, 63787008, 114688, 7, 132661248, 32768, 218104148, 7, 218106689, 0
    .long 1, 80, 80, 2048, 5505024, 5505280, 7340032, 63787008, 114688, 7, 132644864, 32768, 218104148, 7, 218106689, 0
    .long 1, 80, 80, 2048, 5505536, 5505792, 7340032, 63787008, 114688, 7, 132653056, 32768, 218104148, 7, 218106689, 0
    .long 1, 80, 80, 2048, 5505536, 5505792, 7340032, 65622016, 114688, 7, 133177344, 32768, 218104212, 7, 218106753, 0
    .long 1, 80, 80, 2048, 5505024, 5505280, 7340032, 65622016, 114688, 7, 133169152, 32768, 218104212, 7, 218106753, 0
    .long 1, 80, 80, 2048, 5506560, 5506816, 7340032, 65622016, 114688, 7, 133193728, 32768, 218104212, 7, 218106753, 0
    .long 1, 40, 40, 2048, 6291968, 6292224, 8388608, 186744832, 131072, 8, 90710016, 32768, 218112384, 48, 218106692, 0
    .long 1, 80, 80, 2048, 5506048, 5506304, 7340032, 65622016, 114688, 7, 133185536, 32768, 218104212, 7, 218106753, 0
    .long 1, 40, 40, 2048, 6292480, 6292736, 8388608, 186744832, 131072, 8, 90718208, 32768, 218112384, 48, 218106692, 0
    .long 1, 40, 40, 2048, 6292992, 6293248, 8388608, 186744832, 131072, 8, 90726400, 32768, 218112384, 48, 218106692, 0
    .long 1, 40, 40, 2048, 6291456, 6291712, 8388608, 186744832, 131072, 8, 90701824, 32768, 218112384, 48, 218106692, 0
    .long 1, 80, 80, 2048, 5506560, 5506816, 7340032, 67457024, 114688, 7, 133718016, 32768, 218104276, 7, 218106817, 0
    .long 1, 80, 80, 2048, 5505536, 5505792, 7340032, 67457024, 114688, 7, 133701632, 32768, 218104276, 7, 218106817, 0
    .long 1, 80, 80, 2048, 5506048, 5506304, 7340032, 67457024, 114688, 7, 133709824, 32768, 218104276, 7, 218106817, 0
    .long 1, 80, 80, 2048, 5505024, 5505280, 7340032, 67457024, 114688, 7, 133693440, 32768, 218104276, 7, 218106817, 0
    .long 6, 1, 0, 2, 3, 16, 0, 23, 0, 0, 0, 0, 0, 0, 0, 0
    .long 6, 1, 0, 2, 3, 16, 0, 17, 0, 0, 0, 0, 0, 0, 0, 0
    .long 6, 1, 0, 2, 3, 16, 0, 20, 0, 0, 0, 0, 0, 0, 0, 0
    .long 6, 1, 0, 2, 3, 16, 0, 10, 0, 0, 0, 0, 0, 0, 0, 0
    .long 6, 1, 0, 2, 3, 16, 0, 6, 0, 0, 0, 0, 0, 0, 0, 0
    .long 6, 1, 0, 2, 3, 16, 0, 13, 0, 0, 0, 0, 0, 0, 0, 0
    .long 6, 1, 0, 1, 3, 16, 0, 38, 0, 0, 0, 0, 0, 0, 0, 0
    .long 6, 1, 0, 2, 3, 16, 0, 18, 0, 0, 0, 0, 0, 0, 0, 0
    .long 6, 1, 0, 2, 3, 16, 0, 9, 0, 0, 0, 0, 0, 0, 0, 0
    .long 6, 1, 0, 2, 3, 16, 0, 2, 0, 0, 0, 0, 0, 0, 0, 0
    .long 6, 1, 0, 2, 3, 16, 0, 5, 0, 0, 0, 0, 0, 0, 0, 0
    .long 6, 1, 0, 1, 3, 16, 0, 34, 0, 0, 0, 0, 0, 0, 0, 0
    .long 6, 1, 0, 2, 3, 16, 0, 7, 0, 0, 0, 0, 0, 0, 0, 0
    .long 6, 1, 0, 2, 3, 16, 0, 1, 0, 0, 0, 0, 0, 0, 0, 0
    .long 6, 1, 0, 2, 3, 16, 0, 12, 0, 0, 0, 0, 0, 0, 0, 0
    .long 6, 1, 0, 2, 3, 16, 0, 14, 0, 0, 0, 0, 0, 0, 0, 0
    .long 6, 1, 0, 2, 3, 16, 0, 0, 0, 0, 0, 0, 0, 0, 0, 0
    .long 6, 1, 0, 2, 3, 16, 0, 3, 0, 0, 0, 0, 0, 0, 0, 0
    .long 6, 1, 0, 2, 3, 16, 0, 22, 0, 0, 0, 0, 0, 0, 0, 0
    .long 6, 1, 0, 2, 3, 16, 0, 21, 0, 0, 0, 0, 0, 0, 0, 0
    .long 6, 1, 0, 2, 3, 16, 0, 8, 0, 0, 0, 0, 0, 0, 0, 0
    .long 6, 1, 0, 2, 3, 16, 0, 15, 0, 0, 0, 0, 0, 0, 0, 0
    .long 6, 1, 0, 2, 3, 16, 0, 19, 0, 0, 0, 0, 0, 0, 0, 0
    .long 6, 1, 0, 2, 3, 16, 0, 11, 0, 0, 0, 0, 0, 0, 0, 0
    .long 6, 1, 0, 2, 3, 16, 0, 16, 0, 0, 0, 0, 0, 0, 0, 0
    .long 6, 1, 0, 2, 3, 16, 0, 4, 0, 0, 0, 0, 0, 0, 0, 0
    .long 6, 0, 0, 0, 3, 0, 0, 54, 0, 0, 0, 0, 0, 0, 0, 0
    .long 6, 0, 0, 0, 3, 0, 0, 51, 0, 0, 0, 0, 0, 0, 0, 0
    .long 6, 0, 0, 0, 3, 0, 0, 48, 0, 0, 0, 0, 0, 0, 0, 0
    .long 6, 0, 0, 0, 3, 0, 0, 49, 0, 0, 0, 0, 0, 0, 0, 0
    .long 6, 0, 0, 0, 3, 0, 0, 50, 0, 0, 0, 0, 0, 0, 0, 0
    .long 6, 0, 0, 0, 3, 0, 0, 52, 0, 0, 0, 0, 0, 0, 0, 0
    .long 6, 0, 0, 0, 3, 0, 0, 53, 0, 0, 0, 0, 0, 0, 0, 0
    .long 6, 0, 0, 0, 3, 0, 0, 55, 0, 0, 0, 0, 0, 0, 0, 0
    .long 6, 1, 0, 1, 3, 16, 0, 32, 0, 0, 0, 0, 0, 0, 0, 0
    .long 6, 1, 0, 1, 3, 16, 0, 33, 0, 0, 0, 0, 0, 0, 0, 0
    .long 6, 1, 0, 1, 3, 16, 0, 35, 0, 0, 0, 0, 0, 0, 0, 0
    .long 6, 1, 0, 1, 3, 16, 0, 36, 0, 0, 0, 0, 0, 0, 0, 0
    .long 6, 1, 0, 1, 3, 16, 0, 37, 0, 0, 0, 0, 0, 0, 0, 0
    .long 6, 1, 0, 1, 3, 16, 0, 39, 0, 0, 0, 0, 0, 0, 0, 0
    .long 6, 1, 0, 2, 3, 16, 0, 24, 0, 0, 0, 0, 0, 0, 0, 0
    .long 6, 1, 0, 2, 3, 16, 0, 26, 0, 0, 0, 0, 0, 0, 0, 0
    .long 6, 1, 0, 2, 3, 16, 0, 27, 0, 0, 0, 0, 0, 0, 0, 0
    .long 6, 1, 0, 2, 3, 16, 0, 28, 0, 0, 0, 0, 0, 0, 0, 0
    .long 6, 1, 0, 2, 3, 16, 0, 29, 0, 0, 0, 0, 0, 0, 0, 0
    .long 6, 1, 0, 2, 3, 16, 0, 30, 0, 0, 0, 0, 0, 0, 0, 0
    .long 6, 1, 0, 2, 3, 16, 0, 31, 0, 0, 0, 0, 0, 0, 0, 0
    .long 6, 1, 0, 2, 3, 16, 0, 25, 0, 0, 0, 0, 0, 0, 0, 0
    .long 6, 0, 0, 1, 3, 16, 0, 40, 0, 0, 0, 0, 0, 0, 0, 0
    .long 6, 0, 0, 1, 3, 16, 0, 41, 0, 0, 0, 0, 0, 0, 0, 0
    .long 6, 0, 0, 1, 3, 16, 0, 42, 0, 0, 0, 0, 0, 0, 0, 0
    .long 6, 0, 0, 1, 3, 16, 0, 43, 0, 0, 0, 0, 0, 0, 0, 0
    .long 6, 0, 0, 1, 3, 16, 0, 44, 0, 0, 0, 0, 0, 0, 0, 0
    .long 6, 0, 0, 1, 3, 16, 0, 47, 0, 0, 0, 0, 0, 0, 0, 0
    .long 6, 0, 0, 1, 3, 16, 0, 46, 0, 0, 0, 0, 0, 0, 0, 0
    .long 6, 0, 0, 1, 3, 16, 0, 45, 0, 0, 0, 0, 0, 0, 0, 0
    .long 6, 0, 0, 0, 3, 0, 0, 56, 0, 0, 0, 0, 0, 0, 0, 0
    .long 6, 0, 0, 0, 3, 0, 0, 57, 0, 0, 0, 0, 0, 0, 0, 0
    .long 6, 0, 0, 0, 3, 0, 0, 58, 0, 0, 0, 0, 0, 0, 0, 0
    .long 6, 0, 0, 0, 3, 0, 0, 59, 0, 0, 0, 0, 0, 0, 0, 0
    .long 6, 0, 0, 0, 3, 0, 0, 60, 0, 0, 0, 0, 0, 0, 0, 0
    .long 7, 0, 0, 0, 12, 0, 0, 61, 0, 0, 0, 0, 0, 0, 0, 0
    .long 7, 0, 0, 0, 13, 0, 0, 61, 0, 0, 0, 0, 0, 0, 0, 0
    .long 7, 0, 0, 0, 14, 0, 0, 61, 0, 0, 0, 0, 0, 0, 0, 0
    .long 7, 0, 0, 0, 15, 0, 0, 61, 0, 0, 0, 0, 0, 0, 0, 0
    .long 7, 0, 0, 0, 12, 0, 0, 62, 0, 0, 0, 0, 0, 0, 0, 0
    .long 7, 0, 0, 0, 13, 0, 0, 62, 0, 0, 0, 0, 0, 0, 0, 0
    .long 7, 0, 0, 0, 14, 0, 0, 62, 0, 0, 0, 0, 0, 0, 0, 0
    .long 7, 0, 0, 0, 15, 0, 0, 62, 0, 0, 0, 0, 0, 0, 0, 0
    .long 7, 0, 0, 0, 12, 0, 0, 63, 0, 0, 0, 0, 0, 0, 0, 0
    .long 7, 0, 0, 0, 13, 0, 0, 63, 0, 0, 0, 0, 0, 0, 0, 0
    .long 7, 0, 0, 0, 14, 0, 0, 63, 0, 0, 0, 0, 0, 0, 0, 0
    .long 7, 0, 0, 0, 15, 0, 0, 63, 0, 0, 0, 0, 0, 0, 0, 0
    .long 0, 0, 0, 0, 0, 0, 0, 0, 0, 0, 0, 0, 0, 0, 0, 0
.p2align 6
.amdhsa_kernel recurrent_scan__memory_aug_recurrent_mem_tr__glu_gated_glu__prompt_kernel
  .amdhsa_next_free_vgpr 256
  .amdhsa_next_free_sgpr 102
  .amdhsa_accum_offset 256
  .amdhsa_group_segment_fixed_size 0
  .amdhsa_kernarg_size 112
  .amdhsa_user_sgpr_count 2
  .amdhsa_user_sgpr_kernarg_segment_ptr 1
  .amdhsa_system_sgpr_workgroup_id_x 1
  .amdhsa_float_denorm_mode_32 3
.end_amdhsa_kernel
```

```asm
; @launch grid=(256,1,1) block=(512,1,1) lds=163840
.amdgcn_target "amdgcn-amd-amdhsa--gfx950"
.text
.globl recurrent_scan__memory_aug_recurrent_mem_tr__glu_gated_glu__prompt_kernel
.p2align 8
.type recurrent_scan__memory_aug_recurrent_mem_tr__glu_gated_glu__prompt_kernel,@function
recurrent_scan__memory_aug_recurrent_mem_tr__glu_gated_glu__prompt_kernel:
    s_cmp_ge_u32 s2, 256
    s_cbranch_scc1 k_exit
    s_mov_b32 s99, s2
    s_load_dwordx2 s[4:5], s[0:1], 104
    s_load_dwordx2 s[64:65], s[0:1], 96
    v_lshrrev_b32 v2, 6, v0
    s_mov_b32 s6, 268435456
    s_mov_b32 s7, 131072
    s_mov_b32 s66, 256
    s_mov_b32 s67, 131072
    v_readfirstlane_b32 s3, v2
    s_getreg_b32 s14, hwreg(HW_REG_XCC_ID)
    s_waitcnt lgkmcnt(0)
    s_mov_b32 s98, s2
    s_sub_u32 s97, s14, s2
    s_and_b32 s97, s97, 7
    s_or_b32 s15, s2, s3
    s_cmp_lg_u32 s15, 0
    s_cbranch_scc1 k_disp
    s_add_u32 s14, s97, 1
    v_mov_b32 v2, s14
    s_mov_b64 exec, 1
    buffer_store_dword v2, off, s[64:67], 0 offset:224 sc1
    s_mov_b64 exec, -1
    s_branch k_disp
k_restart:
    s_waitcnt vmcnt(0) lgkmcnt(0)
    s_barrier
k_disp:
    s_add_u32 s14, s97, s98
    s_and_b32 s14, s14, 7
    s_andn2_b32 s2, s98, 7
    s_or_b32 s2, s2, s14
    s_mov_b32 s99, s2
    s_lshr_b32 s13, s2, 3
    s_and_b32 s12, s2, 3
    s_waitcnt lgkmcnt(0)
    s_bitcmp0_b32 s2, 2
    s_cbranch_scc1 chain_map
    s_lshl_b32 s63, s13, 2
    s_add_u32 s63, s63, s12
    s_cmp_ge_u32 s3, 4
    s_cbranch_scc1 ln_touch
    s_load_dwordx2 s[8:9], s[0:1], 0
    v_and_b32 v1, 63, v0
    s_mov_b32 s10, 4194304
    s_mov_b32 s11, 131072
    v_and_b32 v3, 15, v1
    v_lshrrev_b32 v4, 4, v1
    v_lshlrev_b32 v5, 11, v3
    v_lshl_add_u32 v5, v4, 4, v5
    s_lshl_b32 s12, s63, 15
    s_lshl_b32 s13, s3, 9
    s_add_u32 s12, s12, s13
    s_waitcnt lgkmcnt(0)
    buffer_load_dwordx4 v[16:19], v5, s[8:11], s12 offen offset:0
    buffer_load_dwordx4 v[20:23], v5, s[8:11], s12 offen offset:64
    buffer_load_dwordx4 v[24:27], v5, s[8:11], s12 offen offset:128
    buffer_load_dwordx4 v[28:31], v5, s[8:11], s12 offen offset:192
    buffer_load_dwordx4 v[32:35], v5, s[8:11], s12 offen offset:256
    buffer_load_dwordx4 v[36:39], v5, s[8:11], s12 offen offset:320
    buffer_load_dwordx4 v[40:43], v5, s[8:11], s12 offen offset:384
    buffer_load_dwordx4 v[44:47], v5, s[8:11], s12 offen offset:448
    v_mov_b32 v14, 0
    s_lshl_b32 s13, s63, 7
    s_add_u32 s13, s13, 218103808
    v_lshlrev_b32 v13, 2, v0
    v_lshlrev_b32 v6, 4, v3
    s_lshl_b32 s14, s3, 2
    v_add_u32 v7, s14, v6
    v_lshlrev_b32 v8, 4, v1
    s_lshl_b32 s15, s63, 15
    s_lshl_b32 s16, s3, 13
    s_add_u32 s15, s15, s16
    s_add_u32 s16, s15, 4096
    v_and_b32 v9, 1, v4
    v_cmp_eq_u32 s[20:21], 1, v9
    s_waitcnt vmcnt(0)
    v_lshlrev_b32 v48, 16, v16
    v_and_b32 v49, 0xffff0000, v16
    v_lshlrev_b32 v50, 16, v17
    v_and_b32 v51, 0xffff0000, v17
    v_lshlrev_b32 v52, 16, v18
    v_and_b32 v53, 0xffff0000, v18
    v_lshlrev_b32 v54, 16, v19
    v_and_b32 v55, 0xffff0000, v19
    v_lshlrev_b32 v56, 16, v20
    v_and_b32 v57, 0xffff0000, v20
    v_lshlrev_b32 v58, 16, v21
    v_and_b32 v59, 0xffff0000, v21
    v_lshlrev_b32 v60, 16, v22
    v_and_b32 v61, 0xffff0000, v22
    v_lshlrev_b32 v62, 16, v23
    v_and_b32 v63, 0xffff0000, v23
    v_lshlrev_b32 v64, 16, v24
    v_and_b32 v65, 0xffff0000, v24
    v_lshlrev_b32 v66, 16, v25
    v_and_b32 v67, 0xffff0000, v25
    v_lshlrev_b32 v68, 16, v26
    v_and_b32 v69, 0xffff0000, v26
    v_lshlrev_b32 v70, 16, v27
    v_and_b32 v71, 0xffff0000, v27
    v_lshlrev_b32 v72, 16, v28
    v_and_b32 v73, 0xffff0000, v28
    v_lshlrev_b32 v74, 16, v29
    v_and_b32 v75, 0xffff0000, v29
    v_lshlrev_b32 v76, 16, v30
    v_and_b32 v77, 0xffff0000, v30
    v_lshlrev_b32 v78, 16, v31
    v_and_b32 v79, 0xffff0000, v31
    v_lshlrev_b32 v80, 16, v32
    v_and_b32 v81, 0xffff0000, v32
    v_lshlrev_b32 v82, 16, v33
    v_and_b32 v83, 0xffff0000, v33
    v_lshlrev_b32 v84, 16, v34
    v_and_b32 v85, 0xffff0000, v34
    v_lshlrev_b32 v86, 16, v35
    v_and_b32 v87, 0xffff0000, v35
    v_lshlrev_b32 v88, 16, v36
    v_and_b32 v89, 0xffff0000, v36
    v_lshlrev_b32 v90, 16, v37
    v_and_b32 v91, 0xffff0000, v37
    v_lshlrev_b32 v92, 16, v38
    v_and_b32 v93, 0xffff0000, v38
    v_lshlrev_b32 v94, 16, v39
    v_and_b32 v95, 0xffff0000, v39
    v_lshlrev_b32 v96, 16, v40
    v_and_b32 v97, 0xffff0000, v40
    v_lshlrev_b32 v98, 16, v41
    v_and_b32 v99, 0xffff0000, v41
    v_lshlrev_b32 v100, 16, v42
    v_and_b32 v101, 0xffff0000, v42
    v_lshlrev_b32 v102, 16, v43
    v_and_b32 v103, 0xffff0000, v43
    v_lshlrev_b32 v104, 16, v44
    v_and_b32 v105, 0xffff0000, v44
    v_lshlrev_b32 v106, 16, v45
    v_and_b32 v107, 0xffff0000, v45
    v_lshlrev_b32 v108, 16, v46
    v_and_b32 v109, 0xffff0000, v46
    v_lshlrev_b32 v110, 16, v47
    v_and_b32 v111, 0xffff0000, v47
    v_add_f32 v112, v48, v80
    v_add_f32 v113, v49, v81
    v_add_f32 v114, v50, v82
    v_add_f32 v115, v51, v83
    v_add_f32 v116, v52, v84
    v_add_f32 v117, v53, v85
    v_add_f32 v118, v54, v86
    v_add_f32 v119, v55, v87
    v_add_f32 v120, v56, v88
    v_add_f32 v121, v57, v89
    v_add_f32 v122, v58, v90
    v_add_f32 v123, v59, v91
    v_add_f32 v124, v60, v92
    v_add_f32 v125, v61, v93
    v_add_f32 v126, v62, v94
    v_add_f32 v127, v63, v95
    v_add_f32 v128, v64, v96
    v_add_f32 v129, v65, v97
    v_add_f32 v130, v66, v98
    v_add_f32 v131, v67, v99
    v_add_f32 v132, v68, v100
    v_add_f32 v133, v69, v101
    v_add_f32 v134, v70, v102
    v_add_f32 v135, v71, v103
    v_add_f32 v136, v72, v104
    v_add_f32 v137, v73, v105
    v_add_f32 v138, v74, v106
    v_add_f32 v139, v75, v107
    v_add_f32 v140, v76, v108
    v_add_f32 v141, v77, v109
    v_add_f32 v142, v78, v110
    v_add_f32 v143, v79, v111
    v_add_f32 v112, v112, v128
    v_add_f32 v113, v113, v129
    v_add_f32 v114, v114, v130
    v_add_f32 v115, v115, v131
    v_add_f32 v116, v116, v132
    v_add_f32 v117, v117, v133
    v_add_f32 v118, v118, v134
    v_add_f32 v119, v119, v135
    v_add_f32 v120, v120, v136
    v_add_f32 v121, v121, v137
    v_add_f32 v122, v122, v138
    v_add_f32 v123, v123, v139
    v_add_f32 v124, v124, v140
    v_add_f32 v125, v125, v141
    v_add_f32 v126, v126, v142
    v_add_f32 v127, v127, v143
    v_add_f32 v112, v112, v120
    v_add_f32 v113, v113, v121
    v_add_f32 v114, v114, v122
    v_add_f32 v115, v115, v123
    v_add_f32 v116, v116, v124
    v_add_f32 v117, v117, v125
    v_add_f32 v118, v118, v126
    v_add_f32 v119, v119, v127
    v_add_f32 v112, v112, v116
    v_add_f32 v113, v113, v117
    v_add_f32 v114, v114, v118
    v_add_f32 v115, v115, v119
    v_add_f32 v112, v112, v114
    v_add_f32 v113, v113, v115
    v_add_f32 v112, v112, v113
    v_mov_b32 v113, v112
    s_nop 1
    v_permlane16_swap_b32 v113, v112
    v_add_f32 v112, v112, v113
    v_mov_b32 v113, v112
    s_nop 1
    v_permlane32_swap_b32 v113, v112
    v_add_f32 v112, v112, v113
    ds_write_b32 v7, v112
    s_waitcnt lgkmcnt(0)
    s_barrier
    ds_read_b128 v[112:115], v6
    s_waitcnt lgkmcnt(0)
    v_add_f32 v112, v112, v114
    v_add_f32 v113, v113, v115
    v_add_f32 v112, v112, v113
    v_mul_f32 v10, 0x3a800000, v112
    v_sub_f32 v176, v48, v10
    v_sub_f32 v177, v49, v10
    v_sub_f32 v178, v50, v10
    v_sub_f32 v179, v51, v10
    v_sub_f32 v180, v52, v10
    v_sub_f32 v181, v53, v10
    v_sub_f32 v182, v54, v10
    v_sub_f32 v183, v55, v10
    v_sub_f32 v184, v56, v10
    v_sub_f32 v185, v57, v10
    v_sub_f32 v186, v58, v10
    v_sub_f32 v187, v59, v10
    v_sub_f32 v188, v60, v10
    v_sub_f32 v189, v61, v10
    v_sub_f32 v190, v62, v10
    v_sub_f32 v191, v63, v10
    v_sub_f32 v192, v64, v10
    v_sub_f32 v193, v65, v10
    v_sub_f32 v194, v66, v10
    v_sub_f32 v195, v67, v10
    v_sub_f32 v196, v68, v10
    v_sub_f32 v197, v69, v10
    v_sub_f32 v198, v70, v10
    v_sub_f32 v199, v71, v10
    v_sub_f32 v200, v72, v10
    v_sub_f32 v201, v73, v10
    v_sub_f32 v202, v74, v10
    v_sub_f32 v203, v75, v10
    v_sub_f32 v204, v76, v10
    v_sub_f32 v205, v77, v10
    v_sub_f32 v206, v78, v10
    v_sub_f32 v207, v79, v10
    v_sub_f32 v208, v80, v10
    v_sub_f32 v209, v81, v10
    v_sub_f32 v210, v82, v10
    v_sub_f32 v211, v83, v10
    v_sub_f32 v212, v84, v10
    v_sub_f32 v213, v85, v10
    v_sub_f32 v214, v86, v10
    v_sub_f32 v215, v87, v10
    v_sub_f32 v216, v88, v10
    v_sub_f32 v217, v89, v10
    v_sub_f32 v218, v90, v10
    v_sub_f32 v219, v91, v10
    v_sub_f32 v220, v92, v10
    v_sub_f32 v221, v93, v10
    v_sub_f32 v222, v94, v10
    v_sub_f32 v223, v95, v10
    v_sub_f32 v224, v96, v10
    v_sub_f32 v225, v97, v10
    v_sub_f32 v226, v98, v10
    v_sub_f32 v227, v99, v10
    v_sub_f32 v228, v100, v10
    v_sub_f32 v229, v101, v10
    v_sub_f32 v230, v102, v10
    v_sub_f32 v231, v103, v10
    v_sub_f32 v232, v104, v10
    v_sub_f32 v233, v105, v10
    v_sub_f32 v234, v106, v10
    v_sub_f32 v235, v107, v10
    v_sub_f32 v236, v108, v10
    v_sub_f32 v237, v109, v10
    v_sub_f32 v238, v110, v10
    v_sub_f32 v239, v111, v10
    v_mul_f32 v112, v176, v176
    v_fmac_f32 v112, v208, v208
    v_mul_f32 v113, v177, v177
    v_fmac_f32 v113, v209, v209
    v_mul_f32 v114, v178, v178
    v_fmac_f32 v114, v210, v210
    v_mul_f32 v115, v179, v179
    v_fmac_f32 v115, v211, v211
    v_mul_f32 v116, v180, v180
    v_fmac_f32 v116, v212, v212
    v_mul_f32 v117, v181, v181
    v_fmac_f32 v117, v213, v213
    v_mul_f32 v118, v182, v182
    v_fmac_f32 v118, v214, v214
    v_mul_f32 v119, v183, v183
    v_fmac_f32 v119, v215, v215
    v_mul_f32 v120, v184, v184
    v_fmac_f32 v120, v216, v216
    v_mul_f32 v121, v185, v185
    v_fmac_f32 v121, v217, v217
    v_mul_f32 v122, v186, v186
    v_fmac_f32 v122, v218, v218
    v_mul_f32 v123, v187, v187
    v_fmac_f32 v123, v219, v219
    v_mul_f32 v124, v188, v188
    v_fmac_f32 v124, v220, v220
    v_mul_f32 v125, v189, v189
    v_fmac_f32 v125, v221, v221
    v_mul_f32 v126, v190, v190
    v_fmac_f32 v126, v222, v222
    v_mul_f32 v127, v191, v191
    v_fmac_f32 v127, v223, v223
    v_mul_f32 v128, v192, v192
    v_fmac_f32 v128, v224, v224
    v_mul_f32 v129, v193, v193
    v_fmac_f32 v129, v225, v225
    v_mul_f32 v130, v194, v194
    v_fmac_f32 v130, v226, v226
    v_mul_f32 v131, v195, v195
    v_fmac_f32 v131, v227, v227
    v_mul_f32 v132, v196, v196
    v_fmac_f32 v132, v228, v228
    v_mul_f32 v133, v197, v197
    v_fmac_f32 v133, v229, v229
    v_mul_f32 v134, v198, v198
    v_fmac_f32 v134, v230, v230
    v_mul_f32 v135, v199, v199
    v_fmac_f32 v135, v231, v231
    v_mul_f32 v136, v200, v200
    v_fmac_f32 v136, v232, v232
    v_mul_f32 v137, v201, v201
    v_fmac_f32 v137, v233, v233
    v_mul_f32 v138, v202, v202
    v_fmac_f32 v138, v234, v234
    v_mul_f32 v139, v203, v203
    v_fmac_f32 v139, v235, v235
    v_mul_f32 v140, v204, v204
    v_fmac_f32 v140, v236, v236
    v_mul_f32 v141, v205, v205
    v_fmac_f32 v141, v237, v237
    v_mul_f32 v142, v206, v206
    v_fmac_f32 v142, v238, v238
    v_mul_f32 v143, v207, v207
    v_fmac_f32 v143, v239, v239
    v_add_f32 v112, v112, v128
    v_add_f32 v113, v113, v129
    v_add_f32 v114, v114, v130
    v_add_f32 v115, v115, v131
    v_add_f32 v116, v116, v132
    v_add_f32 v117, v117, v133
    v_add_f32 v118, v118, v134
    v_add_f32 v119, v119, v135
    v_add_f32 v120, v120, v136
    v_add_f32 v121, v121, v137
    v_add_f32 v122, v122, v138
    v_add_f32 v123, v123, v139
    v_add_f32 v124, v124, v140
    v_add_f32 v125, v125, v141
    v_add_f32 v126, v126, v142
    v_add_f32 v127, v127, v143
    v_add_f32 v112, v112, v120
    v_add_f32 v113, v113, v121
    v_add_f32 v114, v114, v122
    v_add_f32 v115, v115, v123
    v_add_f32 v116, v116, v124
    v_add_f32 v117, v117, v125
    v_add_f32 v118, v118, v126
    v_add_f32 v119, v119, v127
    v_add_f32 v112, v112, v116
    v_add_f32 v113, v113, v117
    v_add_f32 v114, v114, v118
    v_add_f32 v115, v115, v119
    v_add_f32 v112, v112, v114
    v_add_f32 v113, v113, v115
    v_add_f32 v112, v112, v113
    v_mov_b32 v113, v112
    s_nop 1
    v_permlane16_swap_b32 v113, v112
    v_add_f32 v112, v112, v113
    v_mov_b32 v113, v112
    s_nop 1
    v_permlane32_swap_b32 v113, v112
    v_add_f32 v112, v112, v113
    ds_write_b32 v7, v112 offset:512
    s_waitcnt lgkmcnt(0)
    s_barrier
    ds_read_b128 v[112:115], v6 offset:512
    v_mov_b32 v12, 2048
    ds_read_b32 v12, v12
    s_mov_b32 s96, s97
    s_waitcnt lgkmcnt(0)
    v_readfirstlane_b32 s97, v12
    s_cmp_lg_u32 s96, s97
    s_cbranch_scc1 k_restart
    s_waitcnt lgkmcnt(0)
    v_cmp_gt_u32 vcc, 32, v0
    s_and_saveexec_b64 s[22:23], vcc
    s_cbranch_execz ln_nz
    buffer_store_dword v14, v13, s[4:7], s13 offen sc1
ln_nz:
    s_mov_b64 exec, -1
    v_add_f32 v112, v112, v114
    v_add_f32 v113, v113, v115
    v_add_f32 v112, v112, v113
    v_mul_f32 v11, 0x3a800000, v112
    v_cvt_pk_bf16_f32 v10, v10, v10
    v_lshlrev_b32 v10, 16, v10
    v_cvt_pk_bf16_f32 v11, v11, v11
    v_lshlrev_b32 v11, 16, v11
    v_add_f32 v11, 0x3727c5ac, v11
    v_cvt_pk_bf16_f32 v11, v11, v11
    v_lshlrev_b32 v11, 16, v11
    v_sqrt_f32 v11, v11
    s_nop 0
    v_cvt_pk_bf16_f32 v11, v11, v11
    v_lshlrev_b32 v11, 16, v11
    v_rcp_f32 v11, v11
    s_nop 0
    v_sub_f32 v48, v48, v10
    v_sub_f32 v49, v49, v10
    v_cvt_pk_bf16_f32 v16, v48, v49
    v_lshlrev_b32 v48, 16, v16
    v_and_b32 v49, 0xffff0000, v16
    v_mul_f32 v48, v48, v11
    v_mul_f32 v49, v49, v11
    v_cvt_pk_bf16_f32 v16, v48, v49
    v_sub_f32 v50, v50, v10
    v_sub_f32 v51, v51, v10
    v_cvt_pk_bf16_f32 v17, v50, v51
    v_lshlrev_b32 v50, 16, v17
    v_and_b32 v51, 0xffff0000, v17
    v_mul_f32 v50, v50, v11
    v_mul_f32 v51, v51, v11
    v_cvt_pk_bf16_f32 v17, v50, v51
    v_sub_f32 v52, v52, v10
    v_sub_f32 v53, v53, v10
    v_cvt_pk_bf16_f32 v18, v52, v53
    v_lshlrev_b32 v52, 16, v18
    v_and_b32 v53, 0xffff0000, v18
    v_mul_f32 v52, v52, v11
    v_mul_f32 v53, v53, v11
    v_cvt_pk_bf16_f32 v18, v52, v53
    v_sub_f32 v54, v54, v10
    v_sub_f32 v55, v55, v10
    v_cvt_pk_bf16_f32 v19, v54, v55
    v_lshlrev_b32 v54, 16, v19
    v_and_b32 v55, 0xffff0000, v19
    v_mul_f32 v54, v54, v11
    v_mul_f32 v55, v55, v11
    v_cvt_pk_bf16_f32 v19, v54, v55
    v_cndmask_b32 v112, v16, v18, s[20:21]
    v_cndmask_b32 v113, v17, v19, s[20:21]
    v_cndmask_b32 v114, v18, v16, s[20:21]
    v_cndmask_b32 v115, v19, v17, s[20:21]
    buffer_store_dwordx4 v[112:115], v8, s[4:7], s15 offen offset:0 sc1
    v_sub_f32 v56, v56, v10
    v_sub_f32 v57, v57, v10
    v_cvt_pk_bf16_f32 v20, v56, v57
    v_lshlrev_b32 v56, 16, v20
    v_and_b32 v57, 0xffff0000, v20
    v_mul_f32 v56, v56, v11
    v_mul_f32 v57, v57, v11
    v_cvt_pk_bf16_f32 v20, v56, v57
    v_sub_f32 v58, v58, v10
    v_sub_f32 v59, v59, v10
    v_cvt_pk_bf16_f32 v21, v58, v59
    v_lshlrev_b32 v58, 16, v21
    v_and_b32 v59, 0xffff0000, v21
    v_mul_f32 v58, v58, v11
    v_mul_f32 v59, v59, v11
    v_cvt_pk_bf16_f32 v21, v58, v59
    v_sub_f32 v60, v60, v10
    v_sub_f32 v61, v61, v10
    v_cvt_pk_bf16_f32 v22, v60, v61
    v_lshlrev_b32 v60, 16, v22
    v_and_b32 v61, 0xffff0000, v22
    v_mul_f32 v60, v60, v11
    v_mul_f32 v61, v61, v11
    v_cvt_pk_bf16_f32 v22, v60, v61
    v_sub_f32 v62, v62, v10
    v_sub_f32 v63, v63, v10
    v_cvt_pk_bf16_f32 v23, v62, v63
    v_lshlrev_b32 v62, 16, v23
    v_and_b32 v63, 0xffff0000, v23
    v_mul_f32 v62, v62, v11
    v_mul_f32 v63, v63, v11
    v_cvt_pk_bf16_f32 v23, v62, v63
    v_cndmask_b32 v116, v20, v22, s[20:21]
    v_cndmask_b32 v117, v21, v23, s[20:21]
    v_cndmask_b32 v118, v22, v20, s[20:21]
    v_cndmask_b32 v119, v23, v21, s[20:21]
    buffer_store_dwordx4 v[116:119], v8, s[4:7], s15 offen offset:1024 sc1
    v_sub_f32 v64, v64, v10
    v_sub_f32 v65, v65, v10
    v_cvt_pk_bf16_f32 v24, v64, v65
    v_lshlrev_b32 v64, 16, v24
    v_and_b32 v65, 0xffff0000, v24
    v_mul_f32 v64, v64, v11
    v_mul_f32 v65, v65, v11
    v_cvt_pk_bf16_f32 v24, v64, v65
    v_sub_f32 v66, v66, v10
    v_sub_f32 v67, v67, v10
    v_cvt_pk_bf16_f32 v25, v66, v67
    v_lshlrev_b32 v66, 16, v25
    v_and_b32 v67, 0xffff0000, v25
    v_mul_f32 v66, v66, v11
    v_mul_f32 v67, v67, v11
    v_cvt_pk_bf16_f32 v25, v66, v67
    v_sub_f32 v68, v68, v10
    v_sub_f32 v69, v69, v10
    v_cvt_pk_bf16_f32 v26, v68, v69
    v_lshlrev_b32 v68, 16, v26
    v_and_b32 v69, 0xffff0000, v26
    v_mul_f32 v68, v68, v11
    v_mul_f32 v69, v69, v11
    v_cvt_pk_bf16_f32 v26, v68, v69
    v_sub_f32 v70, v70, v10
    v_sub_f32 v71, v71, v10
    v_cvt_pk_bf16_f32 v27, v70, v71
    v_lshlrev_b32 v70, 16, v27
    v_and_b32 v71, 0xffff0000, v27
    v_mul_f32 v70, v70, v11
    v_mul_f32 v71, v71, v11
    v_cvt_pk_bf16_f32 v27, v70, v71
    v_cndmask_b32 v120, v24, v26, s[20:21]
    v_cndmask_b32 v121, v25, v27, s[20:21]
    v_cndmask_b32 v122, v26, v24, s[20:21]
    v_cndmask_b32 v123, v27, v25, s[20:21]
    buffer_store_dwordx4 v[120:123], v8, s[4:7], s15 offen offset:2048 sc1
    v_sub_f32 v72, v72, v10
    v_sub_f32 v73, v73, v10
    v_cvt_pk_bf16_f32 v28, v72, v73
    v_lshlrev_b32 v72, 16, v28
    v_and_b32 v73, 0xffff0000, v28
    v_mul_f32 v72, v72, v11
    v_mul_f32 v73, v73, v11
    v_cvt_pk_bf16_f32 v28, v72, v73
    v_sub_f32 v74, v74, v10
    v_sub_f32 v75, v75, v10
    v_cvt_pk_bf16_f32 v29, v74, v75
    v_lshlrev_b32 v74, 16, v29
    v_and_b32 v75, 0xffff0000, v29
    v_mul_f32 v74, v74, v11
    v_mul_f32 v75, v75, v11
    v_cvt_pk_bf16_f32 v29, v74, v75
    v_sub_f32 v76, v76, v10
    v_sub_f32 v77, v77, v10
    v_cvt_pk_bf16_f32 v30, v76, v77
    v_lshlrev_b32 v76, 16, v30
    v_and_b32 v77, 0xffff0000, v30
    v_mul_f32 v76, v76, v11
    v_mul_f32 v77, v77, v11
    v_cvt_pk_bf16_f32 v30, v76, v77
    v_sub_f32 v78, v78, v10
    v_sub_f32 v79, v79, v10
    v_cvt_pk_bf16_f32 v31, v78, v79
    v_lshlrev_b32 v78, 16, v31
    v_and_b32 v79, 0xffff0000, v31
    v_mul_f32 v78, v78, v11
    v_mul_f32 v79, v79, v11
    v_cvt_pk_bf16_f32 v31, v78, v79
    v_cndmask_b32 v124, v28, v30, s[20:21]
    v_cndmask_b32 v125, v29, v31, s[20:21]
    v_cndmask_b32 v126, v30, v28, s[20:21]
    v_cndmask_b32 v127, v31, v29, s[20:21]
    buffer_store_dwordx4 v[124:127], v8, s[4:7], s15 offen offset:3072 sc1
    v_sub_f32 v80, v80, v10
    v_sub_f32 v81, v81, v10
    v_cvt_pk_bf16_f32 v32, v80, v81
    v_lshlrev_b32 v80, 16, v32
    v_and_b32 v81, 0xffff0000, v32
    v_mul_f32 v80, v80, v11
    v_mul_f32 v81, v81, v11
    v_cvt_pk_bf16_f32 v32, v80, v81
    v_sub_f32 v82, v82, v10
    v_sub_f32 v83, v83, v10
    v_cvt_pk_bf16_f32 v33, v82, v83
    v_lshlrev_b32 v82, 16, v33
    v_and_b32 v83, 0xffff0000, v33
    v_mul_f32 v82, v82, v11
    v_mul_f32 v83, v83, v11
    v_cvt_pk_bf16_f32 v33, v82, v83
    v_sub_f32 v84, v84, v10
    v_sub_f32 v85, v85, v10
    v_cvt_pk_bf16_f32 v34, v84, v85
    v_lshlrev_b32 v84, 16, v34
    v_and_b32 v85, 0xffff0000, v34
    v_mul_f32 v84, v84, v11
    v_mul_f32 v85, v85, v11
    v_cvt_pk_bf16_f32 v34, v84, v85
    v_sub_f32 v86, v86, v10
    v_sub_f32 v87, v87, v10
    v_cvt_pk_bf16_f32 v35, v86, v87
    v_lshlrev_b32 v86, 16, v35
    v_and_b32 v87, 0xffff0000, v35
    v_mul_f32 v86, v86, v11
    v_mul_f32 v87, v87, v11
    v_cvt_pk_bf16_f32 v35, v86, v87
    v_cndmask_b32 v128, v32, v34, s[20:21]
    v_cndmask_b32 v129, v33, v35, s[20:21]
    v_cndmask_b32 v130, v34, v32, s[20:21]
    v_cndmask_b32 v131, v35, v33, s[20:21]
    buffer_store_dwordx4 v[128:131], v8, s[4:7], s16 offen offset:0 sc1
    v_sub_f32 v88, v88, v10
    v_sub_f32 v89, v89, v10
    v_cvt_pk_bf16_f32 v36, v88, v89
    v_lshlrev_b32 v88, 16, v36
    v_and_b32 v89, 0xffff0000, v36
    v_mul_f32 v88, v88, v11
    v_mul_f32 v89, v89, v11
    v_cvt_pk_bf16_f32 v36, v88, v89
    v_sub_f32 v90, v90, v10
    v_sub_f32 v91, v91, v10
    v_cvt_pk_bf16_f32 v37, v90, v91
    v_lshlrev_b32 v90, 16, v37
    v_and_b32 v91, 0xffff0000, v37
    v_mul_f32 v90, v90, v11
    v_mul_f32 v91, v91, v11
    v_cvt_pk_bf16_f32 v37, v90, v91
    v_sub_f32 v92, v92, v10
    v_sub_f32 v93, v93, v10
    v_cvt_pk_bf16_f32 v38, v92, v93
    v_lshlrev_b32 v92, 16, v38
    v_and_b32 v93, 0xffff0000, v38
    v_mul_f32 v92, v92, v11
    v_mul_f32 v93, v93, v11
    v_cvt_pk_bf16_f32 v38, v92, v93
    v_sub_f32 v94, v94, v10
    v_sub_f32 v95, v95, v10
    v_cvt_pk_bf16_f32 v39, v94, v95
    v_lshlrev_b32 v94, 16, v39
    v_and_b32 v95, 0xffff0000, v39
    v_mul_f32 v94, v94, v11
    v_mul_f32 v95, v95, v11
    v_cvt_pk_bf16_f32 v39, v94, v95
    v_cndmask_b32 v132, v36, v38, s[20:21]
    v_cndmask_b32 v133, v37, v39, s[20:21]
    v_cndmask_b32 v134, v38, v36, s[20:21]
    v_cndmask_b32 v135, v39, v37, s[20:21]
    buffer_store_dwordx4 v[132:135], v8, s[4:7], s16 offen offset:1024 sc1
    v_sub_f32 v96, v96, v10
    v_sub_f32 v97, v97, v10
    v_cvt_pk_bf16_f32 v40, v96, v97
    v_lshlrev_b32 v96, 16, v40
    v_and_b32 v97, 0xffff0000, v40
    v_mul_f32 v96, v96, v11
    v_mul_f32 v97, v97, v11
    v_cvt_pk_bf16_f32 v40, v96, v97
    v_sub_f32 v98, v98, v10
    v_sub_f32 v99, v99, v10
    v_cvt_pk_bf16_f32 v41, v98, v99
    v_lshlrev_b32 v98, 16, v41
    v_and_b32 v99, 0xffff0000, v41
    v_mul_f32 v98, v98, v11
    v_mul_f32 v99, v99, v11
    v_cvt_pk_bf16_f32 v41, v98, v99
    v_sub_f32 v100, v100, v10
    v_sub_f32 v101, v101, v10
    v_cvt_pk_bf16_f32 v42, v100, v101
    v_lshlrev_b32 v100, 16, v42
    v_and_b32 v101, 0xffff0000, v42
    v_mul_f32 v100, v100, v11
    v_mul_f32 v101, v101, v11
    v_cvt_pk_bf16_f32 v42, v100, v101
    v_sub_f32 v102, v102, v10
    v_sub_f32 v103, v103, v10
    v_cvt_pk_bf16_f32 v43, v102, v103
    v_lshlrev_b32 v102, 16, v43
    v_and_b32 v103, 0xffff0000, v43
    v_mul_f32 v102, v102, v11
    v_mul_f32 v103, v103, v11
    v_cvt_pk_bf16_f32 v43, v102, v103
    v_cndmask_b32 v136, v40, v42, s[20:21]
    v_cndmask_b32 v137, v41, v43, s[20:21]
    v_cndmask_b32 v138, v42, v40, s[20:21]
    v_cndmask_b32 v139, v43, v41, s[20:21]
    buffer_store_dwordx4 v[136:139], v8, s[4:7], s16 offen offset:2048 sc1
    v_sub_f32 v104, v104, v10
    v_sub_f32 v105, v105, v10
    v_cvt_pk_bf16_f32 v44, v104, v105
    v_lshlrev_b32 v104, 16, v44
    v_and_b32 v105, 0xffff0000, v44
    v_mul_f32 v104, v104, v11
    v_mul_f32 v105, v105, v11
    v_cvt_pk_bf16_f32 v44, v104, v105
    v_sub_f32 v106, v106, v10
    v_sub_f32 v107, v107, v10
    v_cvt_pk_bf16_f32 v45, v106, v107
    v_lshlrev_b32 v106, 16, v45
    v_and_b32 v107, 0xffff0000, v45
    v_mul_f32 v106, v106, v11
    v_mul_f32 v107, v107, v11
    v_cvt_pk_bf16_f32 v45, v106, v107
    v_sub_f32 v108, v108, v10
    v_sub_f32 v109, v109, v10
    v_cvt_pk_bf16_f32 v46, v108, v109
    v_lshlrev_b32 v108, 16, v46
    v_and_b32 v109, 0xffff0000, v46
    v_mul_f32 v108, v108, v11
    v_mul_f32 v109, v109, v11
    v_cvt_pk_bf16_f32 v46, v108, v109
    v_sub_f32 v110, v110, v10
    v_sub_f32 v111, v111, v10
    v_cvt_pk_bf16_f32 v47, v110, v111
    v_lshlrev_b32 v110, 16, v47
    v_and_b32 v111, 0xffff0000, v47
    v_mul_f32 v110, v110, v11
    v_mul_f32 v111, v111, v11
    v_cvt_pk_bf16_f32 v47, v110, v111
    v_cndmask_b32 v140, v44, v46, s[20:21]
    v_cndmask_b32 v141, v45, v47, s[20:21]
    v_cndmask_b32 v142, v46, v44, s[20:21]
    v_cndmask_b32 v143, v47, v45, s[20:21]
    buffer_store_dwordx4 v[140:143], v8, s[4:7], s16 offen offset:3072 sc1
    s_waitcnt vmcnt(0)
    s_barrier
    s_cmp_lg_u32 s3, 0
    s_cbranch_scc1 ln_sig
    v_mov_b32 v2, 1
    s_mov_b64 exec, 1
    s_cmp_ge_u32 s63, 8
    s_cbranch_scc1 ln_sb
    buffer_atomic_add v2, off, s[64:67], 0 offset:192 sc1
ln_sb:
    buffer_atomic_add v2, off, s[64:67], 0 offset:0 sc1
    s_mov_b64 exec, -1
    s_branch ln_sig
ln_touch:
    s_getpc_b64 s[24:25]
    s_add_u32 s24, s24, jobtab@rel32@lo+4
    s_addc_u32 s25, s25, jobtab@rel32@hi+12
    s_and_b32 s30, s63, 3
    s_mul_i32 s30, s30, 320
    s_lshr_b32 s31, s63, 2
    s_add_u32 s30, s30, s31
    s_lshl_b32 s30, s30, 6
    s_add_u32 s24, s24, s30
    s_addc_u32 s25, s25, 0
    s_load_dwordx16 s[32:47], s[24:25], 0
    s_mov_b32 s11, 131072
    v_and_b32 v20, 63, v0
    s_waitcnt lgkmcnt(0)
    s_load_dwordx2 s[8:9], s[0:1], s33
    s_mov_b32 s10, s38
    s_lshl_b32 s30, s35, 4
    v_mul_lo_u32 v21, s30, v20
    v_and_b32 v22, 15, v20
    v_mul_lo_u32 v22, s43, v22
    s_waitcnt lgkmcnt(0)
    s_cmp_eq_u32 s3, 4
    s_cbranch_scc0 tlb_1_1
    buffer_load_dword v23, v21, s[8:11], s36 offen
    s_branch tlb_1
tlb_1_1:
    s_cmp_eq_u32 s3, 5
    s_cbranch_scc0 tlb_1
    buffer_load_dword v23, v22, s[4:7], s42 offen
    buffer_load_dword v23, off, s[4:7], s46
tlb_1:
    s_cmp_lg_u32 s3, 7
    s_cbranch_scc1 ln_nrp
    s_mov_b32 s95, 0x10000
rp_2:
    buffer_load_dword v13, off, s[64:67], 0 offset:224 sc1
    s_waitcnt vmcnt(0)
    v_readfirstlane_b32 s96, v13
    s_cmp_lg_u32 s96, 0
    s_cbranch_scc1 rp_2_ok
    s_sleep 2
    s_sub_u32 s95, s95, 1
    s_cbranch_scc0 rp_2
    s_add_u32 s96, s97, 1
rp_2_ok:
    s_sub_u32 s96, s96, 1
    v_mov_b32 v12, 2048
    v_mov_b32 v13, s96
    ds_write_b32 v12, v13
    s_waitcnt lgkmcnt(0)
ln_nrp:
    s_barrier
    s_barrier
    v_mov_b32 v12, 2048
    ds_read_b32 v12, v12
    s_mov_b32 s96, s97
    s_waitcnt lgkmcnt(0)
    v_readfirstlane_b32 s97, v12
    s_cmp_lg_u32 s96, s97
    s_cbranch_scc1 k_restart
    s_barrier
ln_sig:
    s_mov_b32 s29, s63
    v_and_b32 v20, 63, v0
    v_lshlrev_b32 v1, 4, v20
    v_add_u32 v19, 0x1000, v1
    v_lshrrev_b32 v4, 4, v20
    v_mov_b32 v17, 0
    v_mov_b32 v18, 1
    s_lshr_b32 s26, s3, 2
    s_and_b32 s27, s3, 3
    s_lshl_b32 s21, s3, 11
    s_lshl_b32 s22, s3, 10
    s_add_u32 s22, s22, 16384
    s_mov_b32 s11, 131072
    s_mov_b32 s15, 131072
    s_mov_b32 s28, 0
    v_and_b32 v21, 15, v20
    v_lshlrev_b32 v22, 2, v4
    v_xor_b32 v21, v21, v22
    s_lshr_b32 s30, s3, 1
    s_and_b32 s30, s30, 1
    v_xor_b32 v21, s30, v21
    v_lshlrev_b32 v3, 4, v21
    s_lshl_b32 s30, s26, 13
    v_add_u32 v5, s30, v1
    v_add_u32 v6, 0x10000, v5
    v_bfe_u32 v21, v20, 2, 2
    v_and_b32 v22, 3, v20
    v_and_b32 v23, 1, v4
    v_xor_b32 v24, s27, v21
    v_xor_b32 v25, v22, v23
    v_lshl_add_u32 v24, v24, 2, v25
    v_lshlrev_b32 v24, 4, v24
    v_lshl_add_u32 v25, v4, 3, v21
    v_lshl_add_u32 v24, v25, 8, v24
    v_and_b32 v22, 1, v22
    v_xor_b32 v25, 0, v23
    v_lshl_add_u32 v8, v25, 10, v24
    v_xor_b32 v25, 0, v22
    v_lshl_add_u32 v8, v25, 3, v8
    v_add_u32 v12, 0x10000, v8
    v_xor_b32 v25, 1, v23
    v_lshl_add_u32 v9, v25, 10, v24
    v_xor_b32 v25, 0, v22
    v_lshl_add_u32 v9, v25, 3, v9
    v_add_u32 v13, 0x10000, v9
    v_xor_b32 v25, 0, v23
    v_lshl_add_u32 v10, v25, 10, v24
    v_xor_b32 v25, 1, v22
    v_lshl_add_u32 v10, v25, 3, v10
    v_add_u32 v14, 0x10000, v10
    v_xor_b32 v25, 1, v23
    v_lshl_add_u32 v11, v25, 10, v24
    v_xor_b32 v25, 1, v22
    v_lshl_add_u32 v11, v25, 3, v11
    v_add_u32 v15, 0x10000, v11
    s_lshl_b32 s30, s3, 2
    s_add_u32 s30, s30, 131072
    v_mov_b32 v7, s30
    s_cmp_ge_u32 s3, 4
    s_cbranch_scc0 w_np
    s_setprio 1
w_np:
    s_getpc_b64 s[24:25]
    s_add_u32 s24, s24, jobtab@rel32@lo+4
    s_addc_u32 s25, s25, jobtab@rel32@hi+12
    s_and_b32 s31, s29, 3
    s_mul_i32 s30, s31, 20480
    s_add_u32 s24, s24, s30
    s_addc_u32 s25, s25, 0
    s_lshl_b32 s71, s31, 2
    s_add_u32 s71, s71, 64
    s_lshr_b32 s59, s29, 2
    s_lshl_b32 s30, s59, 6
    s_load_dwordx16 s[32:47], s[24:25], s30
    s_waitcnt lgkmcnt(0)
    s_cmp_lg_u32 s32, 4
    s_cbranch_scc1 w_nopre
    s_load_dwordx2 s[8:9], s[0:1], s33
    s_load_dwordx2 s[12:13], s[0:1], s34
    s_mov_b32 s10, s38
    s_mov_b32 s14, s38
    s_cmp_eq_u32 s32, 4
    s_cselect_b32 s31, 0, 1
    s_lshl_b32 s30, s3, s31
    s_mul_i32 s30, s30, s40
    s_add_u32 s16, s39, s30
    s_cmp_eq_u32 s32, 4
    s_cselect_b32 s30, 1024, s40
    s_cselect_b32 s31, 6, 5
    s_lshl_b32 s62, 32, s31
    s_add_u32 s17, s16, s30
    s_lshl_b32 s30, s3, 2
    s_mul_i32 s30, s30, s35
    s_add_u32 s18, s36, s30
    s_add_u32 s19, s37, s30
    s_lshl_b32 s20, s35, s31
    v_mul_u32_u24 v2, s35, v4
    v_add_u32 v2, v2, v3
    s_waitcnt lgkmcnt(0)
    s_add_u32 m0, s22, 0
    s_nop 0
    buffer_load_dwordx4 v2, s[8:11], s18 offen lds
    s_add_u32 s18, s18, s20
    s_add_u32 m0, s22, 8192
    s_nop 0
    buffer_load_dwordx4 v2, s[12:15], s19 offen lds
    s_add_u32 s19, s19, s20
    s_add_u32 m0, s22, 32768
    s_nop 0
    buffer_load_dwordx4 v2, s[8:11], s18 offen lds
    s_add_u32 s18, s18, s20
    s_add_u32 m0, s22, 40960
    s_nop 0
    buffer_load_dwordx4 v2, s[12:15], s19 offen lds
    s_add_u32 s19, s19, s20
    s_add_u32 m0, s22, 65536
    s_nop 0
    buffer_load_dwordx4 v2, s[8:11], s18 offen lds
    s_add_u32 s18, s18, s20
    s_add_u32 m0, s22, 73728
    s_nop 0
    buffer_load_dwordx4 v2, s[12:15], s19 offen lds
    s_add_u32 s19, s19, s20
    s_add_u32 m0, s22, 98304
    s_nop 0
    buffer_load_dwordx4 v2, s[8:11], s18 offen lds
    s_add_u32 s18, s18, s20
    s_add_u32 m0, s22, 106496
    s_nop 0
    buffer_load_dwordx4 v2, s[12:15], s19 offen lds
    s_add_u32 s19, s19, s20
    s_cmp_eq_u32 s32, 4
    s_cselect_b32 s70, 1, 0
    s_cmp_eq_u32 s39, 0
    s_cselect_b32 s70, s70, 0
    s_cmp_lg_u32 s3, 0
    s_cbranch_scc1 lnwp_ok
    s_cmp_eq_u32 s70, 0
    s_cbranch_scc1 lnwp_full
    s_mov_b32 s69, 65536
lnwap:
    buffer_load_dword v20, off, s[64:67], 0 offset:192 sc1
    s_waitcnt vmcnt(0)
    v_readfirstlane_b32 s68, v20
    s_cmp_ge_u32 s68, 8
    s_cbranch_scc1 lnwap_ok
    s_sleep 8
    s_sub_u32 s69, s69, 1
    s_cbranch_scc0 lnwap
lnwap_ok:
    s_branch lnwp_ok
lnwp_full:
    s_mov_b32 s69, 65536
lnwp:
    buffer_load_dword v20, off, s[64:67], 0 offset:0 sc1
    s_waitcnt vmcnt(0)
    v_readfirstlane_b32 s68, v20
    s_cmp_ge_u32 s68, 128
    s_cbranch_scc1 lnwp_ok
    s_sleep 8
    s_sub_u32 s69, s69, 1
    s_cbranch_scc0 lnwp
lnwp_ok:
    s_barrier
    s_add_u32 m0, s21, 0
    s_nop 0
    buffer_load_dwordx4 v1, s[4:7], s16 offen sc1 lds
    s_add_u32 s16, s16, s62
    s_add_u32 m0, s21, 1024
    s_nop 0
    buffer_load_dwordx4 v1, s[4:7], s17 offen sc1 lds
    s_add_u32 s17, s17, s62
    s_add_u32 m0, s21, 32768
    s_nop 0
    buffer_load_dwordx4 v1, s[4:7], s16 offen sc1 lds
    s_add_u32 s16, s16, s62
    s_add_u32 m0, s21, 33792
    s_nop 0
    buffer_load_dwordx4 v1, s[4:7], s17 offen sc1 lds
    s_add_u32 s17, s17, s62
    s_add_u32 m0, s21, 65536
    s_nop 0
    buffer_load_dwordx4 v1, s[4:7], s16 offen sc1 lds
    s_add_u32 s16, s16, s62
    s_add_u32 m0, s21, 66560
    s_nop 0
    buffer_load_dwordx4 v1, s[4:7], s17 offen sc1 lds
    s_add_u32 s17, s17, s62
    s_add_u32 m0, s21, 98304
    s_nop 0
    buffer_load_dwordx4 v1, s[4:7], s16 offen sc1 lds
    s_add_u32 s16, s16, s62
    s_add_u32 m0, s21, 99328
    s_nop 0
    buffer_load_dwordx4 v1, s[4:7], s17 offen sc1 lds
    s_add_u32 s17, s17, s62
    s_branch w_adopt
w_nopre:
    s_cmp_eq_u32 s32, 4
    s_cselect_b32 s70, 1, 0
    s_cmp_eq_u32 s39, 0
    s_cselect_b32 s70, s70, 0
    s_cmp_lg_u32 s3, 0
    s_cbranch_scc1 lnw_ok
    s_cmp_eq_u32 s70, 0
    s_cbranch_scc1 lnw_full
    s_mov_b32 s69, 65536
lnwa:
    buffer_load_dword v20, off, s[64:67], 0 offset:192 sc1
    s_waitcnt vmcnt(0)
    v_readfirstlane_b32 s68, v20
    s_cmp_ge_u32 s68, 8
    s_cbranch_scc1 lnwa_ok
    s_sleep 8
    s_sub_u32 s69, s69, 1
    s_cbranch_scc0 lnwa
lnwa_ok:
    s_branch lnw_ok
lnw_full:
    s_mov_b32 s69, 65536
lnw:
    buffer_load_dword v20, off, s[64:67], 0 offset:0 sc1
    s_waitcnt vmcnt(0)
    v_readfirstlane_b32 s68, v20
    s_cmp_ge_u32 s68, 128
    s_cbranch_scc1 lnw_ok
    s_sleep 8
    s_sub_u32 s69, s69, 1
    s_cbranch_scc0 lnw
lnw_ok:
    s_barrier
w_cold:
    s_cmp_eq_u32 s32, 0
    s_cbranch_scc1 k_end
    s_cmp_ge_u32 s32, 6
    s_cbranch_scc1 w_fin
    s_cmp_lg_u32 s3, 0
    s_cbranch_scc1 w_depok
    s_cmp_eq_u32 s45, 0
    s_cbranch_scc1 w_depok
    s_mov_b32 s31, 0x40000
w_waitdep:
    buffer_load_dword v16, v17, s[4:7], s44 offen sc1
    s_waitcnt vmcnt(0)
    v_readfirstlane_b32 s30, v16
    s_cmp_ge_u32 s30, s45
    s_cbranch_scc1 w_depok
    s_sleep 16
    s_sub_u32 s31, s31, 1
    s_cbranch_scc0 w_waitdep
w_depok:
    s_cmp_eq_u32 s32, 5
    s_cbranch_scc1 w_att
    s_load_dwordx2 s[8:9], s[0:1], s33
    s_load_dwordx2 s[12:13], s[0:1], s34
    s_mov_b32 s10, s38
    s_mov_b32 s14, s38
    s_cmp_eq_u32 s32, 4
    s_cselect_b32 s31, 0, 1
    s_lshl_b32 s30, s3, s31
    s_mul_i32 s30, s30, s40
    s_add_u32 s16, s39, s30
    s_cmp_eq_u32 s32, 4
    s_cselect_b32 s30, 1024, s40
    s_cselect_b32 s31, 6, 5
    s_lshl_b32 s62, 32, s31
    s_add_u32 s17, s16, s30
    s_lshl_b32 s30, s3, 2
    s_mul_i32 s30, s30, s35
    s_add_u32 s18, s36, s30
    s_add_u32 s19, s37, s30
    s_lshl_b32 s20, s35, s31
    v_mul_u32_u24 v2, s35, v4
    v_add_u32 v2, v2, v3
    s_waitcnt lgkmcnt(0)
    s_barrier
    s_add_u32 m0, s21, 0
    s_nop 0
    buffer_load_dwordx4 v1, s[4:7], s16 offen sc1 lds
    s_add_u32 s16, s16, s62
    s_add_u32 m0, s21, 1024
    s_nop 0
    buffer_load_dwordx4 v1, s[4:7], s17 offen sc1 lds
    s_add_u32 s17, s17, s62
    s_add_u32 m0, s22, 0
    s_nop 0
    buffer_load_dwordx4 v2, s[8:11], s18 offen lds
    s_add_u32 s18, s18, s20
    s_add_u32 m0, s22, 8192
    s_nop 0
    buffer_load_dwordx4 v2, s[12:15], s19 offen lds
    s_add_u32 s19, s19, s20
    s_add_u32 m0, s21, 32768
    s_nop 0
    buffer_load_dwordx4 v1, s[4:7], s16 offen sc1 lds
    s_add_u32 s16, s16, s62
    s_add_u32 m0, s21, 33792
    s_nop 0
    buffer_load_dwordx4 v1, s[4:7], s17 offen sc1 lds
    s_add_u32 s17, s17, s62
    s_add_u32 m0, s22, 32768
    s_nop 0
    buffer_load_dwordx4 v2, s[8:11], s18 offen lds
    s_add_u32 s18, s18, s20
    s_add_u32 m0, s22, 40960
    s_nop 0
    buffer_load_dwordx4 v2, s[12:15], s19 offen lds
    s_add_u32 s19, s19, s20
    s_add_u32 m0, s21, 65536
    s_nop 0
    buffer_load_dwordx4 v1, s[4:7], s16 offen sc1 lds
    s_add_u32 s16, s16, s62
    s_add_u32 m0, s21, 66560
    s_nop 0
    buffer_load_dwordx4 v1, s[4:7], s17 offen sc1 lds
    s_add_u32 s17, s17, s62
    s_add_u32 m0, s22, 65536
    s_nop 0
    buffer_load_dwordx4 v2, s[8:11], s18 offen lds
    s_add_u32 s18, s18, s20
    s_add_u32 m0, s22, 73728
    s_nop 0
    buffer_load_dwordx4 v2, s[12:15], s19 offen lds
    s_add_u32 s19, s19, s20
    s_add_u32 m0, s21, 98304
    s_nop 0
    buffer_load_dwordx4 v1, s[4:7], s16 offen sc1 lds
    s_add_u32 s16, s16, s62
    s_add_u32 m0, s21, 99328
    s_nop 0
    buffer_load_dwordx4 v1, s[4:7], s17 offen sc1 lds
    s_add_u32 s17, s17, s62
    s_add_u32 m0, s22, 98304
    s_nop 0
    buffer_load_dwordx4 v2, s[8:11], s18 offen lds
    s_add_u32 s18, s18, s20
    s_add_u32 m0, s22, 106496
    s_nop 0
    buffer_load_dwordx4 v2, s[12:15], s19 offen lds
    s_add_u32 s19, s19, s20
w_adopt:
    s_mov_b32 s48, s32
    s_cmp_eq_u32 s32, 4
    s_cselect_b32 s30, 2, 3
    s_lshl_b32 s30, s26, s30
    s_mul_i32 s30, s30, s43
    s_add_u32 s49, s42, s30
    s_mov_b32 s50, s43
    s_mov_b32 s51, s46
    s_mov_b32 s23, s41
    s_mov_b32 s53, s41
    s_waitcnt vmcnt(0)
    s_barrier
    ds_read_b64_tr_b16 v[64:65], v8 offset:16384
    ds_read_b64_tr_b16 v[66:67], v9 offset:16384
    ds_read_b64_tr_b16 v[68:69], v10 offset:16384
    ds_read_b64_tr_b16 v[70:71], v11 offset:16384
    ds_read_b64_tr_b16 v[72:73], v8 offset:24576
    ds_read_b64_tr_b16 v[74:75], v9 offset:24576
    ds_read_b64_tr_b16 v[76:77], v10 offset:24576
    ds_read_b64_tr_b16 v[78:79], v11 offset:24576
    ds_read_b128 v[32:35], v5 offset:0
    ds_read_b128 v[36:39], v5 offset:1024
    ds_read_b128 v[40:43], v5 offset:2048
    ds_read_b128 v[44:47], v5 offset:3072
    ds_read_b128 v[48:51], v5 offset:4096
    ds_read_b128 v[52:55], v5 offset:5120
    ds_read_b128 v[56:59], v5 offset:6144
    ds_read_b128 v[60:63], v5 offset:7168
    s_waitcnt lgkmcnt(0)
    s_cmp_eq_u32 s48, 4
    s_cbranch_scc1 w_firstH
    s_branch w_first16
w_first4:
    s_waitcnt vmcnt(12)
    s_barrier
    v_mfma_f32_16x16x32_bf16 v[128:131], v[64:67], v[32:35], 0
    s_add_u32 m0, s21, 0
    s_nop 0
    buffer_load_dwordx4 v1, s[4:7], s16 offen sc1 lds
    s_add_u32 s16, s16, s62
    v_mfma_f32_16x16x32_bf16 v[132:135], v[68:71], v[32:35], 0
    ds_read_b64_tr_b16 v[112:113], v8 offset:49152
    v_mfma_f32_16x16x32_bf16 v[136:139], v[72:75], v[32:35], 0
    ds_read_b64_tr_b16 v[114:115], v9 offset:49152
    v_mfma_f32_16x16x32_bf16 v[140:143], v[76:79], v[32:35], 0
    ds_read_b64_tr_b16 v[116:117], v10 offset:49152
    v_mfma_f32_16x16x32_bf16 v[144:147], v[64:67], v[36:39], 0
    s_add_u32 m0, s21, 1024
    s_nop 0
    buffer_load_dwordx4 v1, s[4:7], s17 offen sc1 lds
    s_add_u32 s17, s17, s62
    v_mfma_f32_16x16x32_bf16 v[148:151], v[68:71], v[36:39], 0
    ds_read_b64_tr_b16 v[118:119], v11 offset:49152
    v_mfma_f32_16x16x32_bf16 v[152:155], v[72:75], v[36:39], 0
    ds_read_b64_tr_b16 v[120:121], v8 offset:57344
    v_mfma_f32_16x16x32_bf16 v[156:159], v[76:79], v[36:39], 0
    ds_read_b64_tr_b16 v[122:123], v9 offset:57344
    v_mfma_f32_16x16x32_bf16 v[160:163], v[64:67], v[40:43], 0
    s_add_u32 m0, s22, 0
    s_nop 0
    buffer_load_dwordx4 v2, s[8:11], s18 offen lds
    s_add_u32 s18, s18, s20
    v_mfma_f32_16x16x32_bf16 v[164:167], v[68:71], v[40:43], 0
    ds_read_b64_tr_b16 v[124:125], v10 offset:57344
    v_mfma_f32_16x16x32_bf16 v[168:171], v[72:75], v[40:43], 0
    ds_read_b64_tr_b16 v[126:127], v11 offset:57344
    v_mfma_f32_16x16x32_bf16 v[172:175], v[76:79], v[40:43], 0
    ds_read_b128 v[80:83], v5 offset:32768
    v_mfma_f32_16x16x32_bf16 v[176:179], v[64:67], v[44:47], 0
    s_add_u32 m0, s22, 8192
    s_nop 0
    buffer_load_dwordx4 v2, s[12:15], s19 offen lds
    s_add_u32 s19, s19, s20
    v_mfma_f32_16x16x32_bf16 v[180:183], v[68:71], v[44:47], 0
    ds_read_b128 v[84:87], v5 offset:33792
    v_mfma_f32_16x16x32_bf16 v[184:187], v[72:75], v[44:47], 0
    ds_read_b128 v[88:91], v5 offset:34816
    v_mfma_f32_16x16x32_bf16 v[188:191], v[76:79], v[44:47], 0
    ds_read_b128 v[92:95], v5 offset:35840
    v_mfma_f32_16x16x32_bf16 v[192:195], v[64:67], v[48:51], 0
    ds_read_b128 v[96:99], v5 offset:36864
    v_mfma_f32_16x16x32_bf16 v[196:199], v[68:71], v[48:51], 0
    ds_read_b128 v[100:103], v5 offset:37888
    v_mfma_f32_16x16x32_bf16 v[200:203], v[72:75], v[48:51], 0
    ds_read_b128 v[104:107], v5 offset:38912
    v_mfma_f32_16x16x32_bf16 v[204:207], v[76:79], v[48:51], 0
    ds_read_b128 v[108:111], v5 offset:39936
    v_mfma_f32_16x16x32_bf16 v[208:211], v[64:67], v[52:55], 0
    v_mfma_f32_16x16x32_bf16 v[212:215], v[68:71], v[52:55], 0
    v_mfma_f32_16x16x32_bf16 v[216:219], v[72:75], v[52:55], 0
    v_mfma_f32_16x16x32_bf16 v[220:223], v[76:79], v[52:55], 0
    v_mfma_f32_16x16x32_bf16 v[224:227], v[64:67], v[56:59], 0
    v_mfma_f32_16x16x32_bf16 v[228:231], v[68:71], v[56:59], 0
    v_mfma_f32_16x16x32_bf16 v[232:235], v[72:75], v[56:59], 0
    v_mfma_f32_16x16x32_bf16 v[236:239], v[76:79], v[56:59], 0
    v_mfma_f32_16x16x32_bf16 v[240:243], v[64:67], v[60:63], 0
    v_mfma_f32_16x16x32_bf16 v[244:247], v[68:71], v[60:63], 0
    v_mfma_f32_16x16x32_bf16 v[248:251], v[72:75], v[60:63], 0
    v_mfma_f32_16x16x32_bf16 v[252:255], v[76:79], v[60:63], 0
    s_waitcnt lgkmcnt(0)
w_first4_q1:
    s_waitcnt vmcnt(12)
    s_barrier
    v_mfma_f32_16x16x32_bf16 v[128:131], v[112:115], v[80:83], v[128:131]
    s_add_u32 m0, s21, 32768
    s_nop 0
    buffer_load_dwordx4 v1, s[4:7], s16 offen sc1 lds
    s_add_u32 s16, s16, s62
    v_mfma_f32_16x16x32_bf16 v[132:135], v[116:119], v[80:83], v[132:135]
    ds_read_b64_tr_b16 v[64:65], v12 offset:16384
    v_mfma_f32_16x16x32_bf16 v[136:139], v[120:123], v[80:83], v[136:139]
    ds_read_b64_tr_b16 v[66:67], v13 offset:16384
    v_mfma_f32_16x16x32_bf16 v[140:143], v[124:127], v[80:83], v[140:143]
    ds_read_b64_tr_b16 v[68:69], v14 offset:16384
    v_mfma_f32_16x16x32_bf16 v[144:147], v[112:115], v[84:87], v[144:147]
    s_add_u32 m0, s21, 33792
    s_nop 0
    buffer_load_dwordx4 v1, s[4:7], s17 offen sc1 lds
    s_add_u32 s17, s17, s62
    v_mfma_f32_16x16x32_bf16 v[148:151], v[116:119], v[84:87], v[148:151]
    ds_read_b64_tr_b16 v[70:71], v15 offset:16384
    v_mfma_f32_16x16x32_bf16 v[152:155], v[120:123], v[84:87], v[152:155]
    ds_read_b64_tr_b16 v[72:73], v12 offset:24576
    v_mfma_f32_16x16x32_bf16 v[156:159], v[124:127], v[84:87], v[156:159]
    ds_read_b64_tr_b16 v[74:75], v13 offset:24576
    v_mfma_f32_16x16x32_bf16 v[160:163], v[112:115], v[88:91], v[160:163]
    s_add_u32 m0, s22, 32768
    s_nop 0
    buffer_load_dwordx4 v2, s[8:11], s18 offen lds
    s_add_u32 s18, s18, s20
    v_mfma_f32_16x16x32_bf16 v[164:167], v[116:119], v[88:91], v[164:167]
    ds_read_b64_tr_b16 v[76:77], v14 offset:24576
    v_mfma_f32_16x16x32_bf16 v[168:171], v[120:123], v[88:91], v[168:171]
    ds_read_b64_tr_b16 v[78:79], v15 offset:24576
    v_mfma_f32_16x16x32_bf16 v[172:175], v[124:127], v[88:91], v[172:175]
    ds_read_b128 v[32:35], v6 offset:0
    v_mfma_f32_16x16x32_bf16 v[176:179], v[112:115], v[92:95], v[176:179]
    s_add_u32 m0, s22, 40960
    s_nop 0
    buffer_load_dwordx4 v2, s[12:15], s19 offen lds
    s_add_u32 s19, s19, s20
    v_mfma_f32_16x16x32_bf16 v[180:183], v[116:119], v[92:95], v[180:183]
    ds_read_b128 v[36:39], v6 offset:1024
    v_mfma_f32_16x16x32_bf16 v[184:187], v[120:123], v[92:95], v[184:187]
    ds_read_b128 v[40:43], v6 offset:2048
    v_mfma_f32_16x16x32_bf16 v[188:191], v[124:127], v[92:95], v[188:191]
    ds_read_b128 v[44:47], v6 offset:3072
    v_mfma_f32_16x16x32_bf16 v[192:195], v[112:115], v[96:99], v[192:195]
    ds_read_b128 v[48:51], v6 offset:4096
    v_mfma_f32_16x16x32_bf16 v[196:199], v[116:119], v[96:99], v[196:199]
    ds_read_b128 v[52:55], v6 offset:5120
    v_mfma_f32_16x16x32_bf16 v[200:203], v[120:123], v[96:99], v[200:203]
    ds_read_b128 v[56:59], v6 offset:6144
    v_mfma_f32_16x16x32_bf16 v[204:207], v[124:127], v[96:99], v[204:207]
    ds_read_b128 v[60:63], v6 offset:7168
    v_mfma_f32_16x16x32_bf16 v[208:211], v[112:115], v[100:103], v[208:211]
    v_mfma_f32_16x16x32_bf16 v[212:215], v[116:119], v[100:103], v[212:215]
    v_mfma_f32_16x16x32_bf16 v[216:219], v[120:123], v[100:103], v[216:219]
    v_mfma_f32_16x16x32_bf16 v[220:223], v[124:127], v[100:103], v[220:223]
    v_mfma_f32_16x16x32_bf16 v[224:227], v[112:115], v[104:107], v[224:227]
    v_mfma_f32_16x16x32_bf16 v[228:231], v[116:119], v[104:107], v[228:231]
    v_mfma_f32_16x16x32_bf16 v[232:235], v[120:123], v[104:107], v[232:235]
    v_mfma_f32_16x16x32_bf16 v[236:239], v[124:127], v[104:107], v[236:239]
    v_mfma_f32_16x16x32_bf16 v[240:243], v[112:115], v[108:111], v[240:243]
    v_mfma_f32_16x16x32_bf16 v[244:247], v[116:119], v[108:111], v[244:247]
    v_mfma_f32_16x16x32_bf16 v[248:251], v[120:123], v[108:111], v[248:251]
    v_mfma_f32_16x16x32_bf16 v[252:255], v[124:127], v[108:111], v[252:255]
    s_waitcnt lgkmcnt(0)
    s_waitcnt vmcnt(12)
    s_barrier
    v_mfma_f32_16x16x32_bf16 v[128:131], v[64:67], v[32:35], v[128:131]
    s_add_u32 m0, s21, 65536
    s_nop 0
    buffer_load_dwordx4 v1, s[4:7], s16 offen sc1 lds
    s_add_u32 s16, s16, s62
    v_mfma_f32_16x16x32_bf16 v[132:135], v[68:71], v[32:35], v[132:135]
    ds_read_b64_tr_b16 v[112:113], v12 offset:49152
    v_mfma_f32_16x16x32_bf16 v[136:139], v[72:75], v[32:35], v[136:139]
    ds_read_b64_tr_b16 v[114:115], v13 offset:49152
    v_mfma_f32_16x16x32_bf16 v[140:143], v[76:79], v[32:35], v[140:143]
    ds_read_b64_tr_b16 v[116:117], v14 offset:49152
    v_mfma_f32_16x16x32_bf16 v[144:147], v[64:67], v[36:39], v[144:147]
    s_add_u32 m0, s21, 66560
    s_nop 0
    buffer_load_dwordx4 v1, s[4:7], s17 offen sc1 lds
    s_add_u32 s17, s17, s62
    v_mfma_f32_16x16x32_bf16 v[148:151], v[68:71], v[36:39], v[148:151]
    ds_read_b64_tr_b16 v[118:119], v15 offset:49152
    v_mfma_f32_16x16x32_bf16 v[152:155], v[72:75], v[36:39], v[152:155]
    ds_read_b64_tr_b16 v[120:121], v12 offset:57344
    v_mfma_f32_16x16x32_bf16 v[156:159], v[76:79], v[36:39], v[156:159]
    ds_read_b64_tr_b16 v[122:123], v13 offset:57344
    v_mfma_f32_16x16x32_bf16 v[160:163], v[64:67], v[40:43], v[160:163]
    s_add_u32 m0, s22, 65536
    s_nop 0
    buffer_load_dwordx4 v2, s[8:11], s18 offen lds
    s_add_u32 s18, s18, s20
    v_mfma_f32_16x16x32_bf16 v[164:167], v[68:71], v[40:43], v[164:167]
    ds_read_b64_tr_b16 v[124:125], v14 offset:57344
    v_mfma_f32_16x16x32_bf16 v[168:171], v[72:75], v[40:43], v[168:171]
    ds_read_b64_tr_b16 v[126:127], v15 offset:57344
    v_mfma_f32_16x16x32_bf16 v[172:175], v[76:79], v[40:43], v[172:175]
    ds_read_b128 v[80:83], v6 offset:32768
    v_mfma_f32_16x16x32_bf16 v[176:179], v[64:67], v[44:47], v[176:179]
    s_add_u32 m0, s22, 73728
    s_nop 0
    buffer_load_dwordx4 v2, s[12:15], s19 offen lds
    s_add_u32 s19, s19, s20
    v_mfma_f32_16x16x32_bf16 v[180:183], v[68:71], v[44:47], v[180:183]
    ds_read_b128 v[84:87], v6 offset:33792
    v_mfma_f32_16x16x32_bf16 v[184:187], v[72:75], v[44:47], v[184:187]
    ds_read_b128 v[88:91], v6 offset:34816
    v_mfma_f32_16x16x32_bf16 v[188:191], v[76:79], v[44:47], v[188:191]
    ds_read_b128 v[92:95], v6 offset:35840
    v_mfma_f32_16x16x32_bf16 v[192:195], v[64:67], v[48:51], v[192:195]
    ds_read_b128 v[96:99], v6 offset:36864
    v_mfma_f32_16x16x32_bf16 v[196:199], v[68:71], v[48:51], v[196:199]
    ds_read_b128 v[100:103], v6 offset:37888
    v_mfma_f32_16x16x32_bf16 v[200:203], v[72:75], v[48:51], v[200:203]
    ds_read_b128 v[104:107], v6 offset:38912
    v_mfma_f32_16x16x32_bf16 v[204:207], v[76:79], v[48:51], v[204:207]
    ds_read_b128 v[108:111], v6 offset:39936
    v_mfma_f32_16x16x32_bf16 v[208:211], v[64:67], v[52:55], v[208:211]
    v_mfma_f32_16x16x32_bf16 v[212:215], v[68:71], v[52:55], v[212:215]
    v_mfma_f32_16x16x32_bf16 v[216:219], v[72:75], v[52:55], v[216:219]
    v_mfma_f32_16x16x32_bf16 v[220:223], v[76:79], v[52:55], v[220:223]
    v_mfma_f32_16x16x32_bf16 v[224:227], v[64:67], v[56:59], v[224:227]
    v_mfma_f32_16x16x32_bf16 v[228:231], v[68:71], v[56:59], v[228:231]
    v_mfma_f32_16x16x32_bf16 v[232:235], v[72:75], v[56:59], v[232:235]
    v_mfma_f32_16x16x32_bf16 v[236:239], v[76:79], v[56:59], v[236:239]
    v_mfma_f32_16x16x32_bf16 v[240:243], v[64:67], v[60:63], v[240:243]
    v_mfma_f32_16x16x32_bf16 v[244:247], v[68:71], v[60:63], v[244:247]
    v_mfma_f32_16x16x32_bf16 v[248:251], v[72:75], v[60:63], v[248:251]
    v_mfma_f32_16x16x32_bf16 v[252:255], v[76:79], v[60:63], v[252:255]
    s_waitcnt lgkmcnt(0)
    s_waitcnt vmcnt(8)
    s_barrier
    s_cmp_eq_u32 s28, 0
    s_cbranch_scc1 sig_3
    s_cmp_lg_u32 s3, 0
    s_cbranch_scc1 sig_3
    s_and_b32 s57, s28, 3
    v_mov_b32 v24, s57
    s_bfe_u32 s57, s28, 0x20002
    v_mov_b32 v25, s57
    s_andn2_b32 s28, s28, 15
    s_mov_b64 exec, 1
    buffer_atomic_add_x2 v[24:25], v17, s[4:7], s28 offen sc1
    s_mov_b64 exec, -1
sig_3:
    s_mov_b32 s28, 0
    v_mfma_f32_16x16x32_bf16 v[128:131], v[112:115], v[80:83], v[128:131]
    s_add_u32 m0, s21, 98304
    s_nop 0
    buffer_load_dwordx4 v1, s[4:7], s16 offen sc1 lds
    s_add_u32 s16, s16, s62
    v_mfma_f32_16x16x32_bf16 v[132:135], v[116:119], v[80:83], v[132:135]
    ds_read_b64_tr_b16 v[64:65], v8 offset:16384
    v_mfma_f32_16x16x32_bf16 v[136:139], v[120:123], v[80:83], v[136:139]
    ds_read_b64_tr_b16 v[66:67], v9 offset:16384
    v_mfma_f32_16x16x32_bf16 v[140:143], v[124:127], v[80:83], v[140:143]
    ds_read_b64_tr_b16 v[68:69], v10 offset:16384
    v_mfma_f32_16x16x32_bf16 v[144:147], v[112:115], v[84:87], v[144:147]
    s_add_u32 m0, s21, 99328
    s_nop 0
    buffer_load_dwordx4 v1, s[4:7], s17 offen sc1 lds
    s_add_u32 s17, s17, s62
    v_mfma_f32_16x16x32_bf16 v[148:151], v[116:119], v[84:87], v[148:151]
    ds_read_b64_tr_b16 v[70:71], v11 offset:16384
    v_mfma_f32_16x16x32_bf16 v[152:155], v[120:123], v[84:87], v[152:155]
    ds_read_b64_tr_b16 v[72:73], v8 offset:24576
    v_mfma_f32_16x16x32_bf16 v[156:159], v[124:127], v[84:87], v[156:159]
    ds_read_b64_tr_b16 v[74:75], v9 offset:24576
    v_mfma_f32_16x16x32_bf16 v[160:163], v[112:115], v[88:91], v[160:163]
    s_add_u32 m0, s22, 98304
    s_nop 0
    buffer_load_dwordx4 v2, s[8:11], s18 offen lds
    s_add_u32 s18, s18, s20
    v_mfma_f32_16x16x32_bf16 v[164:167], v[116:119], v[88:91], v[164:167]
    ds_read_b64_tr_b16 v[76:77], v10 offset:24576
    v_mfma_f32_16x16x32_bf16 v[168:171], v[120:123], v[88:91], v[168:171]
    ds_read_b64_tr_b16 v[78:79], v11 offset:24576
    v_mfma_f32_16x16x32_bf16 v[172:175], v[124:127], v[88:91], v[172:175]
    ds_read_b128 v[32:35], v5 offset:0
    v_mfma_f32_16x16x32_bf16 v[176:179], v[112:115], v[92:95], v[176:179]
    s_add_u32 m0, s22, 106496
    s_nop 0
    buffer_load_dwordx4 v2, s[12:15], s19 offen lds
    s_add_u32 s19, s19, s20
    v_mfma_f32_16x16x32_bf16 v[180:183], v[116:119], v[92:95], v[180:183]
    ds_read_b128 v[36:39], v5 offset:1024
    v_mfma_f32_16x16x32_bf16 v[184:187], v[120:123], v[92:95], v[184:187]
    ds_read_b128 v[40:43], v5 offset:2048
    v_mfma_f32_16x16x32_bf16 v[188:191], v[124:127], v[92:95], v[188:191]
    ds_read_b128 v[44:47], v5 offset:3072
    v_mfma_f32_16x16x32_bf16 v[192:195], v[112:115], v[96:99], v[192:195]
    ds_read_b128 v[48:51], v5 offset:4096
    v_mfma_f32_16x16x32_bf16 v[196:199], v[116:119], v[96:99], v[196:199]
    ds_read_b128 v[52:55], v5 offset:5120
    v_mfma_f32_16x16x32_bf16 v[200:203], v[120:123], v[96:99], v[200:203]
    ds_read_b128 v[56:59], v5 offset:6144
    v_mfma_f32_16x16x32_bf16 v[204:207], v[124:127], v[96:99], v[204:207]
    ds_read_b128 v[60:63], v5 offset:7168
    v_mfma_f32_16x16x32_bf16 v[208:211], v[112:115], v[100:103], v[208:211]
    v_mfma_f32_16x16x32_bf16 v[212:215], v[116:119], v[100:103], v[212:215]
    v_mfma_f32_16x16x32_bf16 v[216:219], v[120:123], v[100:103], v[216:219]
    v_mfma_f32_16x16x32_bf16 v[220:223], v[124:127], v[100:103], v[220:223]
    v_mfma_f32_16x16x32_bf16 v[224:227], v[112:115], v[104:107], v[224:227]
    v_mfma_f32_16x16x32_bf16 v[228:231], v[116:119], v[104:107], v[228:231]
    v_mfma_f32_16x16x32_bf16 v[232:235], v[120:123], v[104:107], v[232:235]
    v_mfma_f32_16x16x32_bf16 v[236:239], v[124:127], v[104:107], v[236:239]
    v_mfma_f32_16x16x32_bf16 v[240:243], v[112:115], v[108:111], v[240:243]
    v_mfma_f32_16x16x32_bf16 v[244:247], v[116:119], v[108:111], v[244:247]
    v_mfma_f32_16x16x32_bf16 v[248:251], v[120:123], v[108:111], v[248:251]
    v_mfma_f32_16x16x32_bf16 v[252:255], v[124:127], v[108:111], v[252:255]
    s_waitcnt lgkmcnt(0)
    s_branch w_loop_chk
w_first8:
    s_waitcnt vmcnt(16)
    s_barrier
    v_mfma_f32_16x16x32_bf16 v[128:131], v[64:67], v[32:35], 0
    s_add_u32 m0, s21, 0
    s_nop 0
    buffer_load_dwordx4 v1, s[4:7], s16 offen sc1 lds
    s_add_u32 s16, s16, s62
    v_mfma_f32_16x16x32_bf16 v[132:135], v[68:71], v[32:35], 0
    ds_read_b64_tr_b16 v[112:113], v8 offset:49152
    v_mfma_f32_16x16x32_bf16 v[136:139], v[72:75], v[32:35], 0
    ds_read_b64_tr_b16 v[114:115], v9 offset:49152
    v_mfma_f32_16x16x32_bf16 v[140:143], v[76:79], v[32:35], 0
    ds_read_b64_tr_b16 v[116:117], v10 offset:49152
    v_mfma_f32_16x16x32_bf16 v[144:147], v[64:67], v[36:39], 0
    s_add_u32 m0, s21, 1024
    s_nop 0
    buffer_load_dwordx4 v1, s[4:7], s17 offen sc1 lds
    s_add_u32 s17, s17, s62
    v_mfma_f32_16x16x32_bf16 v[148:151], v[68:71], v[36:39], 0
    ds_read_b64_tr_b16 v[118:119], v11 offset:49152
    v_mfma_f32_16x16x32_bf16 v[152:155], v[72:75], v[36:39], 0
    ds_read_b64_tr_b16 v[120:121], v8 offset:57344
    v_mfma_f32_16x16x32_bf16 v[156:159], v[76:79], v[36:39], 0
    ds_read_b64_tr_b16 v[122:123], v9 offset:57344
    v_mfma_f32_16x16x32_bf16 v[160:163], v[64:67], v[40:43], 0
    s_add_u32 m0, s22, 0
    s_nop 0
    buffer_load_dwordx4 v2, s[8:11], s18 offen lds
    s_add_u32 s18, s18, s20
    v_mfma_f32_16x16x32_bf16 v[164:167], v[68:71], v[40:43], 0
    ds_read_b64_tr_b16 v[124:125], v10 offset:57344
    v_mfma_f32_16x16x32_bf16 v[168:171], v[72:75], v[40:43], 0
    ds_read_b64_tr_b16 v[126:127], v11 offset:57344
    v_mfma_f32_16x16x32_bf16 v[172:175], v[76:79], v[40:43], 0
    ds_read_b128 v[80:83], v5 offset:32768
    v_mfma_f32_16x16x32_bf16 v[176:179], v[64:67], v[44:47], 0
    s_add_u32 m0, s22, 8192
    s_nop 0
    buffer_load_dwordx4 v2, s[12:15], s19 offen lds
    s_add_u32 s19, s19, s20
    v_mfma_f32_16x16x32_bf16 v[180:183], v[68:71], v[44:47], 0
    ds_read_b128 v[84:87], v5 offset:33792
    v_mfma_f32_16x16x32_bf16 v[184:187], v[72:75], v[44:47], 0
    ds_read_b128 v[88:91], v5 offset:34816
    v_mfma_f32_16x16x32_bf16 v[188:191], v[76:79], v[44:47], 0
    ds_read_b128 v[92:95], v5 offset:35840
    v_mfma_f32_16x16x32_bf16 v[192:195], v[64:67], v[48:51], 0
    ds_read_b128 v[96:99], v5 offset:36864
    v_mfma_f32_16x16x32_bf16 v[196:199], v[68:71], v[48:51], 0
    ds_read_b128 v[100:103], v5 offset:37888
    v_mfma_f32_16x16x32_bf16 v[200:203], v[72:75], v[48:51], 0
    ds_read_b128 v[104:107], v5 offset:38912
    v_mfma_f32_16x16x32_bf16 v[204:207], v[76:79], v[48:51], 0
    ds_read_b128 v[108:111], v5 offset:39936
    v_mfma_f32_16x16x32_bf16 v[208:211], v[64:67], v[52:55], 0
    v_mfma_f32_16x16x32_bf16 v[212:215], v[68:71], v[52:55], 0
    v_mfma_f32_16x16x32_bf16 v[216:219], v[72:75], v[52:55], 0
    v_mfma_f32_16x16x32_bf16 v[220:223], v[76:79], v[52:55], 0
    v_mfma_f32_16x16x32_bf16 v[224:227], v[64:67], v[56:59], 0
    v_mfma_f32_16x16x32_bf16 v[228:231], v[68:71], v[56:59], 0
    v_mfma_f32_16x16x32_bf16 v[232:235], v[72:75], v[56:59], 0
    v_mfma_f32_16x16x32_bf16 v[236:239], v[76:79], v[56:59], 0
    v_mfma_f32_16x16x32_bf16 v[240:243], v[64:67], v[60:63], 0
    v_mfma_f32_16x16x32_bf16 v[244:247], v[68:71], v[60:63], 0
    v_mfma_f32_16x16x32_bf16 v[248:251], v[72:75], v[60:63], 0
    v_mfma_f32_16x16x32_bf16 v[252:255], v[76:79], v[60:63], 0
    s_waitcnt lgkmcnt(0)
w_first8_q1:
    s_waitcnt vmcnt(16)
    s_barrier
    v_mfma_f32_16x16x32_bf16 v[128:131], v[112:115], v[80:83], v[128:131]
    s_add_u32 m0, s21, 32768
    s_nop 0
    buffer_load_dwordx4 v1, s[4:7], s16 offen sc1 lds
    s_add_u32 s16, s16, s62
    v_mfma_f32_16x16x32_bf16 v[132:135], v[116:119], v[80:83], v[132:135]
    ds_read_b64_tr_b16 v[64:65], v12 offset:16384
    v_mfma_f32_16x16x32_bf16 v[136:139], v[120:123], v[80:83], v[136:139]
    ds_read_b64_tr_b16 v[66:67], v13 offset:16384
    v_mfma_f32_16x16x32_bf16 v[140:143], v[124:127], v[80:83], v[140:143]
    ds_read_b64_tr_b16 v[68:69], v14 offset:16384
    v_mfma_f32_16x16x32_bf16 v[144:147], v[112:115], v[84:87], v[144:147]
    s_add_u32 m0, s21, 33792
    s_nop 0
    buffer_load_dwordx4 v1, s[4:7], s17 offen sc1 lds
    s_add_u32 s17, s17, s62
    v_mfma_f32_16x16x32_bf16 v[148:151], v[116:119], v[84:87], v[148:151]
    ds_read_b64_tr_b16 v[70:71], v15 offset:16384
    v_mfma_f32_16x16x32_bf16 v[152:155], v[120:123], v[84:87], v[152:155]
    ds_read_b64_tr_b16 v[72:73], v12 offset:24576
    v_mfma_f32_16x16x32_bf16 v[156:159], v[124:127], v[84:87], v[156:159]
    ds_read_b64_tr_b16 v[74:75], v13 offset:24576
    v_mfma_f32_16x16x32_bf16 v[160:163], v[112:115], v[88:91], v[160:163]
    s_add_u32 m0, s22, 32768
    s_nop 0
    buffer_load_dwordx4 v2, s[8:11], s18 offen lds
    s_add_u32 s18, s18, s20
    v_mfma_f32_16x16x32_bf16 v[164:167], v[116:119], v[88:91], v[164:167]
    ds_read_b64_tr_b16 v[76:77], v14 offset:24576
    v_mfma_f32_16x16x32_bf16 v[168:171], v[120:123], v[88:91], v[168:171]
    ds_read_b64_tr_b16 v[78:79], v15 offset:24576
    v_mfma_f32_16x16x32_bf16 v[172:175], v[124:127], v[88:91], v[172:175]
    ds_read_b128 v[32:35], v6 offset:0
    v_mfma_f32_16x16x32_bf16 v[176:179], v[112:115], v[92:95], v[176:179]
    s_add_u32 m0, s22, 40960
    s_nop 0
    buffer_load_dwordx4 v2, s[12:15], s19 offen lds
    s_add_u32 s19, s19, s20
    v_mfma_f32_16x16x32_bf16 v[180:183], v[116:119], v[92:95], v[180:183]
    ds_read_b128 v[36:39], v6 offset:1024
    v_mfma_f32_16x16x32_bf16 v[184:187], v[120:123], v[92:95], v[184:187]
    ds_read_b128 v[40:43], v6 offset:2048
    v_mfma_f32_16x16x32_bf16 v[188:191], v[124:127], v[92:95], v[188:191]
    ds_read_b128 v[44:47], v6 offset:3072
    v_mfma_f32_16x16x32_bf16 v[192:195], v[112:115], v[96:99], v[192:195]
    ds_read_b128 v[48:51], v6 offset:4096
    v_mfma_f32_16x16x32_bf16 v[196:199], v[116:119], v[96:99], v[196:199]
    ds_read_b128 v[52:55], v6 offset:5120
    v_mfma_f32_16x16x32_bf16 v[200:203], v[120:123], v[96:99], v[200:203]
    ds_read_b128 v[56:59], v6 offset:6144
    v_mfma_f32_16x16x32_bf16 v[204:207], v[124:127], v[96:99], v[204:207]
    ds_read_b128 v[60:63], v6 offset:7168
    v_mfma_f32_16x16x32_bf16 v[208:211], v[112:115], v[100:103], v[208:211]
    v_mfma_f32_16x16x32_bf16 v[212:215], v[116:119], v[100:103], v[212:215]
    v_mfma_f32_16x16x32_bf16 v[216:219], v[120:123], v[100:103], v[216:219]
    v_mfma_f32_16x16x32_bf16 v[220:223], v[124:127], v[100:103], v[220:223]
    v_mfma_f32_16x16x32_bf16 v[224:227], v[112:115], v[104:107], v[224:227]
    v_mfma_f32_16x16x32_bf16 v[228:231], v[116:119], v[104:107], v[228:231]
    v_mfma_f32_16x16x32_bf16 v[232:235], v[120:123], v[104:107], v[232:235]
    v_mfma_f32_16x16x32_bf16 v[236:239], v[124:127], v[104:107], v[236:239]
    v_mfma_f32_16x16x32_bf16 v[240:243], v[112:115], v[108:111], v[240:243]
    v_mfma_f32_16x16x32_bf16 v[244:247], v[116:119], v[108:111], v[244:247]
    v_mfma_f32_16x16x32_bf16 v[248:251], v[120:123], v[108:111], v[248:251]
    v_mfma_f32_16x16x32_bf16 v[252:255], v[124:127], v[108:111], v[252:255]
    s_waitcnt lgkmcnt(0)
    s_waitcnt vmcnt(16)
    s_barrier
    v_mfma_f32_16x16x32_bf16 v[128:131], v[64:67], v[32:35], v[128:131]
    s_add_u32 m0, s21, 65536
    s_nop 0
    buffer_load_dwordx4 v1, s[4:7], s16 offen sc1 lds
    s_add_u32 s16, s16, s62
    v_mfma_f32_16x16x32_bf16 v[132:135], v[68:71], v[32:35], v[132:135]
    ds_read_b64_tr_b16 v[112:113], v12 offset:49152
    v_mfma_f32_16x16x32_bf16 v[136:139], v[72:75], v[32:35], v[136:139]
    ds_read_b64_tr_b16 v[114:115], v13 offset:49152
    v_mfma_f32_16x16x32_bf16 v[140:143], v[76:79], v[32:35], v[140:143]
    ds_read_b64_tr_b16 v[116:117], v14 offset:49152
    v_mfma_f32_16x16x32_bf16 v[144:147], v[64:67], v[36:39], v[144:147]
    s_add_u32 m0, s21, 66560
    s_nop 0
    buffer_load_dwordx4 v1, s[4:7], s17 offen sc1 lds
    s_add_u32 s17, s17, s62
    v_mfma_f32_16x16x32_bf16 v[148:151], v[68:71], v[36:39], v[148:151]
    ds_read_b64_tr_b16 v[118:119], v15 offset:49152
    v_mfma_f32_16x16x32_bf16 v[152:155], v[72:75], v[36:39], v[152:155]
    ds_read_b64_tr_b16 v[120:121], v12 offset:57344
    v_mfma_f32_16x16x32_bf16 v[156:159], v[76:79], v[36:39], v[156:159]
    ds_read_b64_tr_b16 v[122:123], v13 offset:57344
    v_mfma_f32_16x16x32_bf16 v[160:163], v[64:67], v[40:43], v[160:163]
    s_add_u32 m0, s22, 65536
    s_nop 0
    buffer_load_dwordx4 v2, s[8:11], s18 offen lds
    s_add_u32 s18, s18, s20
    v_mfma_f32_16x16x32_bf16 v[164:167], v[68:71], v[40:43], v[164:167]
    ds_read_b64_tr_b16 v[124:125], v14 offset:57344
    v_mfma_f32_16x16x32_bf16 v[168:171], v[72:75], v[40:43], v[168:171]
    ds_read_b64_tr_b16 v[126:127], v15 offset:57344
    v_mfma_f32_16x16x32_bf16 v[172:175], v[76:79], v[40:43], v[172:175]
    ds_read_b128 v[80:83], v6 offset:32768
    v_mfma_f32_16x16x32_bf16 v[176:179], v[64:67], v[44:47], v[176:179]
    s_add_u32 m0, s22, 73728
    s_nop 0
    buffer_load_dwordx4 v2, s[12:15], s19 offen lds
    s_add_u32 s19, s19, s20
    v_mfma_f32_16x16x32_bf16 v[180:183], v[68:71], v[44:47], v[180:183]
    ds_read_b128 v[84:87], v6 offset:33792
    v_mfma_f32_16x16x32_bf16 v[184:187], v[72:75], v[44:47], v[184:187]
    ds_read_b128 v[88:91], v6 offset:34816
    v_mfma_f32_16x16x32_bf16 v[188:191], v[76:79], v[44:47], v[188:191]
    ds_read_b128 v[92:95], v6 offset:35840
    v_mfma_f32_16x16x32_bf16 v[192:195], v[64:67], v[48:51], v[192:195]
    ds_read_b128 v[96:99], v6 offset:36864
    v_mfma_f32_16x16x32_bf16 v[196:199], v[68:71], v[48:51], v[196:199]
    ds_read_b128 v[100:103], v6 offset:37888
    v_mfma_f32_16x16x32_bf16 v[200:203], v[72:75], v[48:51], v[200:203]
    ds_read_b128 v[104:107], v6 offset:38912
    v_mfma_f32_16x16x32_bf16 v[204:207], v[76:79], v[48:51], v[204:207]
    ds_read_b128 v[108:111], v6 offset:39936
    v_mfma_f32_16x16x32_bf16 v[208:211], v[64:67], v[52:55], v[208:211]
    v_mfma_f32_16x16x32_bf16 v[212:215], v[68:71], v[52:55], v[212:215]
    v_mfma_f32_16x16x32_bf16 v[216:219], v[72:75], v[52:55], v[216:219]
    v_mfma_f32_16x16x32_bf16 v[220:223], v[76:79], v[52:55], v[220:223]
    v_mfma_f32_16x16x32_bf16 v[224:227], v[64:67], v[56:59], v[224:227]
    v_mfma_f32_16x16x32_bf16 v[228:231], v[68:71], v[56:59], v[228:231]
    v_mfma_f32_16x16x32_bf16 v[232:235], v[72:75], v[56:59], v[232:235]
    v_mfma_f32_16x16x32_bf16 v[236:239], v[76:79], v[56:59], v[236:239]
    v_mfma_f32_16x16x32_bf16 v[240:243], v[64:67], v[60:63], v[240:243]
    v_mfma_f32_16x16x32_bf16 v[244:247], v[68:71], v[60:63], v[244:247]
    v_mfma_f32_16x16x32_bf16 v[248:251], v[72:75], v[60:63], v[248:251]
    v_mfma_f32_16x16x32_bf16 v[252:255], v[76:79], v[60:63], v[252:255]
    s_waitcnt lgkmcnt(0)
    s_waitcnt vmcnt(8)
    s_barrier
    s_cmp_eq_u32 s28, 0
    s_cbranch_scc1 sig_4
    s_cmp_lg_u32 s3, 0
    s_cbranch_scc1 sig_4
    s_and_b32 s57, s28, 3
    v_mov_b32 v24, s57
    s_bfe_u32 s57, s28, 0x20002
    v_mov_b32 v25, s57
    s_andn2_b32 s28, s28, 15
    s_mov_b64 exec, 1
    buffer_atomic_add_x2 v[24:25], v17, s[4:7], s28 offen sc1
    s_mov_b64 exec, -1
sig_4:
    s_mov_b32 s28, 0
    v_mfma_f32_16x16x32_bf16 v[128:131], v[112:115], v[80:83], v[128:131]
    s_add_u32 m0, s21, 98304
    s_nop 0
    buffer_load_dwordx4 v1, s[4:7], s16 offen sc1 lds
    s_add_u32 s16, s16, s62
    v_mfma_f32_16x16x32_bf16 v[132:135], v[116:119], v[80:83], v[132:135]
    ds_read_b64_tr_b16 v[64:65], v8 offset:16384
    v_mfma_f32_16x16x32_bf16 v[136:139], v[120:123], v[80:83], v[136:139]
    ds_read_b64_tr_b16 v[66:67], v9 offset:16384
    v_mfma_f32_16x16x32_bf16 v[140:143], v[124:127], v[80:83], v[140:143]
    ds_read_b64_tr_b16 v[68:69], v10 offset:16384
    v_mfma_f32_16x16x32_bf16 v[144:147], v[112:115], v[84:87], v[144:147]
    s_add_u32 m0, s21, 99328
    s_nop 0
    buffer_load_dwordx4 v1, s[4:7], s17 offen sc1 lds
    s_add_u32 s17, s17, s62
    v_mfma_f32_16x16x32_bf16 v[148:151], v[116:119], v[84:87], v[148:151]
    ds_read_b64_tr_b16 v[70:71], v11 offset:16384
    v_mfma_f32_16x16x32_bf16 v[152:155], v[120:123], v[84:87], v[152:155]
    ds_read_b64_tr_b16 v[72:73], v8 offset:24576
    v_mfma_f32_16x16x32_bf16 v[156:159], v[124:127], v[84:87], v[156:159]
    ds_read_b64_tr_b16 v[74:75], v9 offset:24576
    v_mfma_f32_16x16x32_bf16 v[160:163], v[112:115], v[88:91], v[160:163]
    s_add_u32 m0, s22, 98304
    s_nop 0
    buffer_load_dwordx4 v2, s[8:11], s18 offen lds
    s_add_u32 s18, s18, s20
    v_mfma_f32_16x16x32_bf16 v[164:167], v[116:119], v[88:91], v[164:167]
    ds_read_b64_tr_b16 v[76:77], v10 offset:24576
    v_mfma_f32_16x16x32_bf16 v[168:171], v[120:123], v[88:91], v[168:171]
    ds_read_b64_tr_b16 v[78:79], v11 offset:24576
    v_mfma_f32_16x16x32_bf16 v[172:175], v[124:127], v[88:91], v[172:175]
    ds_read_b128 v[32:35], v5 offset:0
    v_mfma_f32_16x16x32_bf16 v[176:179], v[112:115], v[92:95], v[176:179]
    s_add_u32 m0, s22, 106496
    s_nop 0
    buffer_load_dwordx4 v2, s[12:15], s19 offen lds
    s_add_u32 s19, s19, s20
    v_mfma_f32_16x16x32_bf16 v[180:183], v[116:119], v[92:95], v[180:183]
    ds_read_b128 v[36:39], v5 offset:1024
    v_mfma_f32_16x16x32_bf16 v[184:187], v[120:123], v[92:95], v[184:187]
    ds_read_b128 v[40:43], v5 offset:2048
    v_mfma_f32_16x16x32_bf16 v[188:191], v[124:127], v[92:95], v[188:191]
    ds_read_b128 v[44:47], v5 offset:3072
    v_mfma_f32_16x16x32_bf16 v[192:195], v[112:115], v[96:99], v[192:195]
    ds_read_b128 v[48:51], v5 offset:4096
    v_mfma_f32_16x16x32_bf16 v[196:199], v[116:119], v[96:99], v[196:199]
    ds_read_b128 v[52:55], v5 offset:5120
    v_mfma_f32_16x16x32_bf16 v[200:203], v[120:123], v[96:99], v[200:203]
    ds_read_b128 v[56:59], v5 offset:6144
    v_mfma_f32_16x16x32_bf16 v[204:207], v[124:127], v[96:99], v[204:207]
    ds_read_b128 v[60:63], v5 offset:7168
    v_mfma_f32_16x16x32_bf16 v[208:211], v[112:115], v[100:103], v[208:211]
    v_mfma_f32_16x16x32_bf16 v[212:215], v[116:119], v[100:103], v[212:215]
    v_mfma_f32_16x16x32_bf16 v[216:219], v[120:123], v[100:103], v[216:219]
    v_mfma_f32_16x16x32_bf16 v[220:223], v[124:127], v[100:103], v[220:223]
    v_mfma_f32_16x16x32_bf16 v[224:227], v[112:115], v[104:107], v[224:227]
    v_mfma_f32_16x16x32_bf16 v[228:231], v[116:119], v[104:107], v[228:231]
    v_mfma_f32_16x16x32_bf16 v[232:235], v[120:123], v[104:107], v[232:235]
    v_mfma_f32_16x16x32_bf16 v[236:239], v[124:127], v[104:107], v[236:239]
    v_mfma_f32_16x16x32_bf16 v[240:243], v[112:115], v[108:111], v[240:243]
    v_mfma_f32_16x16x32_bf16 v[244:247], v[116:119], v[108:111], v[244:247]
    v_mfma_f32_16x16x32_bf16 v[248:251], v[120:123], v[108:111], v[248:251]
    v_mfma_f32_16x16x32_bf16 v[252:255], v[124:127], v[108:111], v[252:255]
    s_waitcnt lgkmcnt(0)
    s_branch w_loop_chk
w_first16:
    s_waitcnt vmcnt(24)
    s_barrier
    v_mfma_f32_16x16x32_bf16 v[128:131], v[64:67], v[32:35], 0
    s_add_u32 m0, s21, 0
    s_nop 0
    buffer_load_dwordx4 v1, s[4:7], s16 offen sc1 lds
    s_add_u32 s16, s16, s62
    v_mfma_f32_16x16x32_bf16 v[132:135], v[68:71], v[32:35], 0
    ds_read_b64_tr_b16 v[112:113], v8 offset:49152
    v_mfma_f32_16x16x32_bf16 v[136:139], v[72:75], v[32:35], 0
    ds_read_b64_tr_b16 v[114:115], v9 offset:49152
    v_mfma_f32_16x16x32_bf16 v[140:143], v[76:79], v[32:35], 0
    ds_read_b64_tr_b16 v[116:117], v10 offset:49152
    v_mfma_f32_16x16x32_bf16 v[144:147], v[64:67], v[36:39], 0
    s_add_u32 m0, s21, 1024
    s_nop 0
    buffer_load_dwordx4 v1, s[4:7], s17 offen sc1 lds
    s_add_u32 s17, s17, s62
    v_mfma_f32_16x16x32_bf16 v[148:151], v[68:71], v[36:39], 0
    ds_read_b64_tr_b16 v[118:119], v11 offset:49152
    v_mfma_f32_16x16x32_bf16 v[152:155], v[72:75], v[36:39], 0
    ds_read_b64_tr_b16 v[120:121], v8 offset:57344
    v_mfma_f32_16x16x32_bf16 v[156:159], v[76:79], v[36:39], 0
    ds_read_b64_tr_b16 v[122:123], v9 offset:57344
    v_mfma_f32_16x16x32_bf16 v[160:163], v[64:67], v[40:43], 0
    s_add_u32 m0, s22, 0
    s_nop 0
    buffer_load_dwordx4 v2, s[8:11], s18 offen lds
    s_add_u32 s18, s18, s20
    v_mfma_f32_16x16x32_bf16 v[164:167], v[68:71], v[40:43], 0
    ds_read_b64_tr_b16 v[124:125], v10 offset:57344
    v_mfma_f32_16x16x32_bf16 v[168:171], v[72:75], v[40:43], 0
    ds_read_b64_tr_b16 v[126:127], v11 offset:57344
    v_mfma_f32_16x16x32_bf16 v[172:175], v[76:79], v[40:43], 0
    ds_read_b128 v[80:83], v5 offset:32768
    v_mfma_f32_16x16x32_bf16 v[176:179], v[64:67], v[44:47], 0
    s_add_u32 m0, s22, 8192
    s_nop 0
    buffer_load_dwordx4 v2, s[12:15], s19 offen lds
    s_add_u32 s19, s19, s20
    v_mfma_f32_16x16x32_bf16 v[180:183], v[68:71], v[44:47], 0
    ds_read_b128 v[84:87], v5 offset:33792
    v_mfma_f32_16x16x32_bf16 v[184:187], v[72:75], v[44:47], 0
    ds_read_b128 v[88:91], v5 offset:34816
    v_mfma_f32_16x16x32_bf16 v[188:191], v[76:79], v[44:47], 0
    ds_read_b128 v[92:95], v5 offset:35840
    v_mfma_f32_16x16x32_bf16 v[192:195], v[64:67], v[48:51], 0
    ds_read_b128 v[96:99], v5 offset:36864
    v_mfma_f32_16x16x32_bf16 v[196:199], v[68:71], v[48:51], 0
    ds_read_b128 v[100:103], v5 offset:37888
    v_mfma_f32_16x16x32_bf16 v[200:203], v[72:75], v[48:51], 0
    ds_read_b128 v[104:107], v5 offset:38912
    v_mfma_f32_16x16x32_bf16 v[204:207], v[76:79], v[48:51], 0
    ds_read_b128 v[108:111], v5 offset:39936
    v_mfma_f32_16x16x32_bf16 v[208:211], v[64:67], v[52:55], 0
    v_mfma_f32_16x16x32_bf16 v[212:215], v[68:71], v[52:55], 0
    v_mfma_f32_16x16x32_bf16 v[216:219], v[72:75], v[52:55], 0
    v_mfma_f32_16x16x32_bf16 v[220:223], v[76:79], v[52:55], 0
    v_mfma_f32_16x16x32_bf16 v[224:227], v[64:67], v[56:59], 0
    v_mfma_f32_16x16x32_bf16 v[228:231], v[68:71], v[56:59], 0
    v_mfma_f32_16x16x32_bf16 v[232:235], v[72:75], v[56:59], 0
    v_mfma_f32_16x16x32_bf16 v[236:239], v[76:79], v[56:59], 0
    v_mfma_f32_16x16x32_bf16 v[240:243], v[64:67], v[60:63], 0
    v_mfma_f32_16x16x32_bf16 v[244:247], v[68:71], v[60:63], 0
    v_mfma_f32_16x16x32_bf16 v[248:251], v[72:75], v[60:63], 0
    v_mfma_f32_16x16x32_bf16 v[252:255], v[76:79], v[60:63], 0
    s_waitcnt lgkmcnt(0)
w_first16_q1:
    s_waitcnt vmcnt(24)
    s_barrier
    v_mfma_f32_16x16x32_bf16 v[128:131], v[112:115], v[80:83], v[128:131]
    s_add_u32 m0, s21, 32768
    s_nop 0
    buffer_load_dwordx4 v1, s[4:7], s16 offen sc1 lds
    s_add_u32 s16, s16, s62
    v_mfma_f32_16x16x32_bf16 v[132:135], v[116:119], v[80:83], v[132:135]
    ds_read_b64_tr_b16 v[64:65], v12 offset:16384
    v_mfma_f32_16x16x32_bf16 v[136:139], v[120:123], v[80:83], v[136:139]
    ds_read_b64_tr_b16 v[66:67], v13 offset:16384
    v_mfma_f32_16x16x32_bf16 v[140:143], v[124:127], v[80:83], v[140:143]
    ds_read_b64_tr_b16 v[68:69], v14 offset:16384
    v_mfma_f32_16x16x32_bf16 v[144:147], v[112:115], v[84:87], v[144:147]
    s_add_u32 m0, s21, 33792
    s_nop 0
    buffer_load_dwordx4 v1, s[4:7], s17 offen sc1 lds
    s_add_u32 s17, s17, s62
    v_mfma_f32_16x16x32_bf16 v[148:151], v[116:119], v[84:87], v[148:151]
    ds_read_b64_tr_b16 v[70:71], v15 offset:16384
    v_mfma_f32_16x16x32_bf16 v[152:155], v[120:123], v[84:87], v[152:155]
    ds_read_b64_tr_b16 v[72:73], v12 offset:24576
    v_mfma_f32_16x16x32_bf16 v[156:159], v[124:127], v[84:87], v[156:159]
    ds_read_b64_tr_b16 v[74:75], v13 offset:24576
    v_mfma_f32_16x16x32_bf16 v[160:163], v[112:115], v[88:91], v[160:163]
    s_add_u32 m0, s22, 32768
    s_nop 0
    buffer_load_dwordx4 v2, s[8:11], s18 offen lds
    s_add_u32 s18, s18, s20
    v_mfma_f32_16x16x32_bf16 v[164:167], v[116:119], v[88:91], v[164:167]
    ds_read_b64_tr_b16 v[76:77], v14 offset:24576
    v_mfma_f32_16x16x32_bf16 v[168:171], v[120:123], v[88:91], v[168:171]
    ds_read_b64_tr_b16 v[78:79], v15 offset:24576
    v_mfma_f32_16x16x32_bf16 v[172:175], v[124:127], v[88:91], v[172:175]
    ds_read_b128 v[32:35], v6 offset:0
    v_mfma_f32_16x16x32_bf16 v[176:179], v[112:115], v[92:95], v[176:179]
    s_add_u32 m0, s22, 40960
    s_nop 0
    buffer_load_dwordx4 v2, s[12:15], s19 offen lds
    s_add_u32 s19, s19, s20
    v_mfma_f32_16x16x32_bf16 v[180:183], v[116:119], v[92:95], v[180:183]
    ds_read_b128 v[36:39], v6 offset:1024
    v_mfma_f32_16x16x32_bf16 v[184:187], v[120:123], v[92:95], v[184:187]
    ds_read_b128 v[40:43], v6 offset:2048
    v_mfma_f32_16x16x32_bf16 v[188:191], v[124:127], v[92:95], v[188:191]
    ds_read_b128 v[44:47], v6 offset:3072
    v_mfma_f32_16x16x32_bf16 v[192:195], v[112:115], v[96:99], v[192:195]
    ds_read_b128 v[48:51], v6 offset:4096
    v_mfma_f32_16x16x32_bf16 v[196:199], v[116:119], v[96:99], v[196:199]
    ds_read_b128 v[52:55], v6 offset:5120
    v_mfma_f32_16x16x32_bf16 v[200:203], v[120:123], v[96:99], v[200:203]
    ds_read_b128 v[56:59], v6 offset:6144
    v_mfma_f32_16x16x32_bf16 v[204:207], v[124:127], v[96:99], v[204:207]
    ds_read_b128 v[60:63], v6 offset:7168
    v_mfma_f32_16x16x32_bf16 v[208:211], v[112:115], v[100:103], v[208:211]
    v_mfma_f32_16x16x32_bf16 v[212:215], v[116:119], v[100:103], v[212:215]
    v_mfma_f32_16x16x32_bf16 v[216:219], v[120:123], v[100:103], v[216:219]
    v_mfma_f32_16x16x32_bf16 v[220:223], v[124:127], v[100:103], v[220:223]
    v_mfma_f32_16x16x32_bf16 v[224:227], v[112:115], v[104:107], v[224:227]
    v_mfma_f32_16x16x32_bf16 v[228:231], v[116:119], v[104:107], v[228:231]
    v_mfma_f32_16x16x32_bf16 v[232:235], v[120:123], v[104:107], v[232:235]
    v_mfma_f32_16x16x32_bf16 v[236:239], v[124:127], v[104:107], v[236:239]
    v_mfma_f32_16x16x32_bf16 v[240:243], v[112:115], v[108:111], v[240:243]
    v_mfma_f32_16x16x32_bf16 v[244:247], v[116:119], v[108:111], v[244:247]
    v_mfma_f32_16x16x32_bf16 v[248:251], v[120:123], v[108:111], v[248:251]
    v_mfma_f32_16x16x32_bf16 v[252:255], v[124:127], v[108:111], v[252:255]
    s_waitcnt lgkmcnt(0)
    s_waitcnt vmcnt(24)
    s_barrier
    v_mfma_f32_16x16x32_bf16 v[128:131], v[64:67], v[32:35], v[128:131]
    s_add_u32 m0, s21, 65536
    s_nop 0
    buffer_load_dwordx4 v1, s[4:7], s16 offen sc1 lds
    s_add_u32 s16, s16, s62
    v_mfma_f32_16x16x32_bf16 v[132:135], v[68:71], v[32:35], v[132:135]
    ds_read_b64_tr_b16 v[112:113], v12 offset:49152
    v_mfma_f32_16x16x32_bf16 v[136:139], v[72:75], v[32:35], v[136:139]
    ds_read_b64_tr_b16 v[114:115], v13 offset:49152
    v_mfma_f32_16x16x32_bf16 v[140:143], v[76:79], v[32:35], v[140:143]
    ds_read_b64_tr_b16 v[116:117], v14 offset:49152
    v_mfma_f32_16x16x32_bf16 v[144:147], v[64:67], v[36:39], v[144:147]
    s_add_u32 m0, s21, 66560
    s_nop 0
    buffer_load_dwordx4 v1, s[4:7], s17 offen sc1 lds
    s_add_u32 s17, s17, s62
    v_mfma_f32_16x16x32_bf16 v[148:151], v[68:71], v[36:39], v[148:151]
    ds_read_b64_tr_b16 v[118:119], v15 offset:49152
    v_mfma_f32_16x16x32_bf16 v[152:155], v[72:75], v[36:39], v[152:155]
    ds_read_b64_tr_b16 v[120:121], v12 offset:57344
    v_mfma_f32_16x16x32_bf16 v[156:159], v[76:79], v[36:39], v[156:159]
    ds_read_b64_tr_b16 v[122:123], v13 offset:57344
    v_mfma_f32_16x16x32_bf16 v[160:163], v[64:67], v[40:43], v[160:163]
    s_add_u32 m0, s22, 65536
    s_nop 0
    buffer_load_dwordx4 v2, s[8:11], s18 offen lds
    s_add_u32 s18, s18, s20
    v_mfma_f32_16x16x32_bf16 v[164:167], v[68:71], v[40:43], v[164:167]
    ds_read_b64_tr_b16 v[124:125], v14 offset:57344
    v_mfma_f32_16x16x32_bf16 v[168:171], v[72:75], v[40:43], v[168:171]
    ds_read_b64_tr_b16 v[126:127], v15 offset:57344
    v_mfma_f32_16x16x32_bf16 v[172:175], v[76:79], v[40:43], v[172:175]
    ds_read_b128 v[80:83], v6 offset:32768
    v_mfma_f32_16x16x32_bf16 v[176:179], v[64:67], v[44:47], v[176:179]
    s_add_u32 m0, s22, 73728
    s_nop 0
    buffer_load_dwordx4 v2, s[12:15], s19 offen lds
    s_add_u32 s19, s19, s20
    v_mfma_f32_16x16x32_bf16 v[180:183], v[68:71], v[44:47], v[180:183]
    ds_read_b128 v[84:87], v6 offset:33792
    v_mfma_f32_16x16x32_bf16 v[184:187], v[72:75], v[44:47], v[184:187]
    ds_read_b128 v[88:91], v6 offset:34816
    v_mfma_f32_16x16x32_bf16 v[188:191], v[76:79], v[44:47], v[188:191]
    ds_read_b128 v[92:95], v6 offset:35840
    v_mfma_f32_16x16x32_bf16 v[192:195], v[64:67], v[48:51], v[192:195]
    ds_read_b128 v[96:99], v6 offset:36864
    v_mfma_f32_16x16x32_bf16 v[196:199], v[68:71], v[48:51], v[196:199]
    ds_read_b128 v[100:103], v6 offset:37888
    v_mfma_f32_16x16x32_bf16 v[200:203], v[72:75], v[48:51], v[200:203]
    ds_read_b128 v[104:107], v6 offset:38912
    v_mfma_f32_16x16x32_bf16 v[204:207], v[76:79], v[48:51], v[204:207]
    ds_read_b128 v[108:111], v6 offset:39936
    v_mfma_f32_16x16x32_bf16 v[208:211], v[64:67], v[52:55], v[208:211]
    v_mfma_f32_16x16x32_bf16 v[212:215], v[68:71], v[52:55], v[212:215]
    v_mfma_f32_16x16x32_bf16 v[216:219], v[72:75], v[52:55], v[216:219]
    v_mfma_f32_16x16x32_bf16 v[220:223], v[76:79], v[52:55], v[220:223]
    v_mfma_f32_16x16x32_bf16 v[224:227], v[64:67], v[56:59], v[224:227]
    v_mfma_f32_16x16x32_bf16 v[228:231], v[68:71], v[56:59], v[228:231]
    v_mfma_f32_16x16x32_bf16 v[232:235], v[72:75], v[56:59], v[232:235]
    v_mfma_f32_16x16x32_bf16 v[236:239], v[76:79], v[56:59], v[236:239]
    v_mfma_f32_16x16x32_bf16 v[240:243], v[64:67], v[60:63], v[240:243]
    v_mfma_f32_16x16x32_bf16 v[244:247], v[68:71], v[60:63], v[244:247]
    v_mfma_f32_16x16x32_bf16 v[248:251], v[72:75], v[60:63], v[248:251]
    v_mfma_f32_16x16x32_bf16 v[252:255], v[76:79], v[60:63], v[252:255]
    s_waitcnt lgkmcnt(0)
    s_waitcnt vmcnt(8)
    s_barrier
    s_cmp_eq_u32 s28, 0
    s_cbranch_scc1 sig_5
    s_cmp_lg_u32 s3, 0
    s_cbranch_scc1 sig_5
    s_and_b32 s57, s28, 3
    v_mov_b32 v24, s57
    s_bfe_u32 s57, s28, 0x20002
    v_mov_b32 v25, s57
    s_andn2_b32 s28, s28, 15
    s_mov_b64 exec, 1
    buffer_atomic_add_x2 v[24:25], v17, s[4:7], s28 offen sc1
    s_mov_b64 exec, -1
sig_5:
    s_mov_b32 s28, 0
    v_mfma_f32_16x16x32_bf16 v[128:131], v[112:115], v[80:83], v[128:131]
    s_add_u32 m0, s21, 98304
    s_nop 0
    buffer_load_dwordx4 v1, s[4:7], s16 offen sc1 lds
    s_add_u32 s16, s16, s62
    v_mfma_f32_16x16x32_bf16 v[132:135], v[116:119], v[80:83], v[132:135]
    ds_read_b64_tr_b16 v[64:65], v8 offset:16384
    v_mfma_f32_16x16x32_bf16 v[136:139], v[120:123], v[80:83], v[136:139]
    ds_read_b64_tr_b16 v[66:67], v9 offset:16384
    v_mfma_f32_16x16x32_bf16 v[140:143], v[124:127], v[80:83], v[140:143]
    ds_read_b64_tr_b16 v[68:69], v10 offset:16384
    v_mfma_f32_16x16x32_bf16 v[144:147], v[112:115], v[84:87], v[144:147]
    s_add_u32 m0, s21, 99328
    s_nop 0
    buffer_load_dwordx4 v1, s[4:7], s17 offen sc1 lds
    s_add_u32 s17, s17, s62
    v_mfma_f32_16x16x32_bf16 v[148:151], v[116:119], v[84:87], v[148:151]
    ds_read_b64_tr_b16 v[70:71], v11 offset:16384
    v_mfma_f32_16x16x32_bf16 v[152:155], v[120:123], v[84:87], v[152:155]
    ds_read_b64_tr_b16 v[72:73], v8 offset:24576
    v_mfma_f32_16x16x32_bf16 v[156:159], v[124:127], v[84:87], v[156:159]
    ds_read_b64_tr_b16 v[74:75], v9 offset:24576
    v_mfma_f32_16x16x32_bf16 v[160:163], v[112:115], v[88:91], v[160:163]
    s_add_u32 m0, s22, 98304
    s_nop 0
    buffer_load_dwordx4 v2, s[8:11], s18 offen lds
    s_add_u32 s18, s18, s20
    v_mfma_f32_16x16x32_bf16 v[164:167], v[116:119], v[88:91], v[164:167]
    ds_read_b64_tr_b16 v[76:77], v10 offset:24576
    v_mfma_f32_16x16x32_bf16 v[168:171], v[120:123], v[88:91], v[168:171]
    ds_read_b64_tr_b16 v[78:79], v11 offset:24576
    v_mfma_f32_16x16x32_bf16 v[172:175], v[124:127], v[88:91], v[172:175]
    ds_read_b128 v[32:35], v5 offset:0
    v_mfma_f32_16x16x32_bf16 v[176:179], v[112:115], v[92:95], v[176:179]
    s_add_u32 m0, s22, 106496
    s_nop 0
    buffer_load_dwordx4 v2, s[12:15], s19 offen lds
    s_add_u32 s19, s19, s20
    v_mfma_f32_16x16x32_bf16 v[180:183], v[116:119], v[92:95], v[180:183]
    ds_read_b128 v[36:39], v5 offset:1024
    v_mfma_f32_16x16x32_bf16 v[184:187], v[120:123], v[92:95], v[184:187]
    ds_read_b128 v[40:43], v5 offset:2048
    v_mfma_f32_16x16x32_bf16 v[188:191], v[124:127], v[92:95], v[188:191]
    ds_read_b128 v[44:47], v5 offset:3072
    v_mfma_f32_16x16x32_bf16 v[192:195], v[112:115], v[96:99], v[192:195]
    ds_read_b128 v[48:51], v5 offset:4096
    v_mfma_f32_16x16x32_bf16 v[196:199], v[116:119], v[96:99], v[196:199]
    ds_read_b128 v[52:55], v5 offset:5120
    v_mfma_f32_16x16x32_bf16 v[200:203], v[120:123], v[96:99], v[200:203]
    ds_read_b128 v[56:59], v5 offset:6144
    v_mfma_f32_16x16x32_bf16 v[204:207], v[124:127], v[96:99], v[204:207]
    ds_read_b128 v[60:63], v5 offset:7168
    v_mfma_f32_16x16x32_bf16 v[208:211], v[112:115], v[100:103], v[208:211]
    v_mfma_f32_16x16x32_bf16 v[212:215], v[116:119], v[100:103], v[212:215]
    v_mfma_f32_16x16x32_bf16 v[216:219], v[120:123], v[100:103], v[216:219]
    v_mfma_f32_16x16x32_bf16 v[220:223], v[124:127], v[100:103], v[220:223]
    v_mfma_f32_16x16x32_bf16 v[224:227], v[112:115], v[104:107], v[224:227]
    v_mfma_f32_16x16x32_bf16 v[228:231], v[116:119], v[104:107], v[228:231]
    v_mfma_f32_16x16x32_bf16 v[232:235], v[120:123], v[104:107], v[232:235]
    v_mfma_f32_16x16x32_bf16 v[236:239], v[124:127], v[104:107], v[236:239]
    v_mfma_f32_16x16x32_bf16 v[240:243], v[112:115], v[108:111], v[240:243]
    v_mfma_f32_16x16x32_bf16 v[244:247], v[116:119], v[108:111], v[244:247]
    v_mfma_f32_16x16x32_bf16 v[248:251], v[120:123], v[108:111], v[248:251]
    v_mfma_f32_16x16x32_bf16 v[252:255], v[124:127], v[108:111], v[252:255]
    s_waitcnt lgkmcnt(0)
w_loop_chk:
    s_sub_u32 s23, s23, 1
w_loop:
    s_cmp_gt_u32 s23, 3
    s_cbranch_scc1 w_body
    s_cmp_lg_u32 s23, 3
    s_cbranch_scc1 w_l2
    s_cmp_lg_u32 s3, 0
    s_cbranch_scc1 clm_6
    v_mov_b32 v26, 1
    s_mov_b64 exec, 1
    buffer_atomic_add v26, off, s[64:67], s71 sc0 sc1
    s_mov_b64 exec, -1
clm_6:
    s_branch w_body
w_l2:
    s_cmp_lg_u32 s23, 2
    s_cbranch_scc1 w_l1
    s_cmp_lg_u32 s3, 0
    s_cbranch_scc1 pub_7
    v_mov_b32 v20, 131136
    s_mov_b64 exec, 1
    ds_write_b32 v20, v26
    s_mov_b64 exec, -1
    s_waitcnt lgkmcnt(0)
pub_7:
    s_branch w_body
w_l1:
    s_waitcnt vmcnt(8)
    v_readfirstlane_b32 s30, v16
    s_cmp_ge_u32 s30, s45
    s_cselect_b32 s30, 0, 1
    s_or_b32 s30, s30, s70
    s_cmp_eq_u32 s32, 4
    s_cselect_b32 s30, 1, s30
    s_sub_u32 s57, s32, 1
    s_cmp_ge_u32 s57, 4
    s_cselect_b32 s30, 1, s30
    v_mov_b32 v20, s30
    ds_write_b32 v7, v20
    s_cbranch_scc1 w_body
    s_load_dwordx2 s[8:9], s[0:1], s33
    s_load_dwordx2 s[12:13], s[0:1], s34
    s_mov_b32 s10, s38
    s_mov_b32 s14, s38
    s_cmp_eq_u32 s32, 4
    s_cselect_b32 s31, 0, 1
    s_lshl_b32 s30, s3, s31
    s_mul_i32 s30, s30, s40
    s_add_u32 s16, s39, s30
    s_cmp_eq_u32 s32, 4
    s_cselect_b32 s30, 1024, s40
    s_cselect_b32 s31, 6, 5
    s_lshl_b32 s62, 32, s31
    s_add_u32 s17, s16, s30
    s_lshl_b32 s30, s3, 2
    s_mul_i32 s30, s30, s35
    s_add_u32 s18, s36, s30
    s_add_u32 s19, s37, s30
    s_lshl_b32 s20, s35, s31
    v_mul_u32_u24 v2, s35, v4
    v_add_u32 v2, v2, v3
    s_waitcnt lgkmcnt(0)
w_body:
    s_waitcnt vmcnt(8)
    s_barrier
    s_cmp_lg_u32 s23, 2
    s_cbranch_scc1 w_nf
    v_mov_b32 v20, 131136
    ds_read_b32 v20, v20
    s_waitcnt lgkmcnt(0)
    v_readfirstlane_b32 s59, v20
    s_add_u32 s59, s59, 32
    s_min_u32 s59, s59, 319
    s_lshl_b32 s57, s59, 6
    s_load_dwordx16 s[32:47], s[24:25], s57
w_nf:
    v_mfma_f32_16x16x32_bf16 v[128:131], v[64:67], v[32:35], v[128:131]
    s_add_u32 m0, s21, 0
    s_nop 0
    buffer_load_dwordx4 v1, s[4:7], s16 offen sc1 lds
    s_add_u32 s16, s16, s62
    v_mfma_f32_16x16x32_bf16 v[132:135], v[68:71], v[32:35], v[132:135]
    ds_read_b64_tr_b16 v[112:113], v8 offset:49152
    v_mfma_f32_16x16x32_bf16 v[136:139], v[72:75], v[32:35], v[136:139]
    ds_read_b64_tr_b16 v[114:115], v9 offset:49152
    v_mfma_f32_16x16x32_bf16 v[140:143], v[76:79], v[32:35], v[140:143]
    ds_read_b64_tr_b16 v[116:117], v10 offset:49152
    v_mfma_f32_16x16x32_bf16 v[144:147], v[64:67], v[36:39], v[144:147]
    s_add_u32 m0, s21, 1024
    s_nop 0
    buffer_load_dwordx4 v1, s[4:7], s17 offen sc1 lds
    s_add_u32 s17, s17, s62
    v_mfma_f32_16x16x32_bf16 v[148:151], v[68:71], v[36:39], v[148:151]
    ds_read_b64_tr_b16 v[118:119], v11 offset:49152
    v_mfma_f32_16x16x32_bf16 v[152:155], v[72:75], v[36:39], v[152:155]
    ds_read_b64_tr_b16 v[120:121], v8 offset:57344
    v_mfma_f32_16x16x32_bf16 v[156:159], v[76:79], v[36:39], v[156:159]
    ds_read_b64_tr_b16 v[122:123], v9 offset:57344
    v_mfma_f32_16x16x32_bf16 v[160:163], v[64:67], v[40:43], v[160:163]
    s_add_u32 m0, s22, 0
    s_nop 0
    buffer_load_dwordx4 v2, s[8:11], s18 offen lds
    s_add_u32 s18, s18, s20
    v_mfma_f32_16x16x32_bf16 v[164:167], v[68:71], v[40:43], v[164:167]
    ds_read_b64_tr_b16 v[124:125], v10 offset:57344
    v_mfma_f32_16x16x32_bf16 v[168:171], v[72:75], v[40:43], v[168:171]
    ds_read_b64_tr_b16 v[126:127], v11 offset:57344
    v_mfma_f32_16x16x32_bf16 v[172:175], v[76:79], v[40:43], v[172:175]
    ds_read_b128 v[80:83], v5 offset:32768
    v_mfma_f32_16x16x32_bf16 v[176:179], v[64:67], v[44:47], v[176:179]
    s_add_u32 m0, s22, 8192
    s_nop 0
    buffer_load_dwordx4 v2, s[12:15], s19 offen lds
    s_add_u32 s19, s19, s20
    v_mfma_f32_16x16x32_bf16 v[180:183], v[68:71], v[44:47], v[180:183]
    ds_read_b128 v[84:87], v5 offset:33792
    v_mfma_f32_16x16x32_bf16 v[184:187], v[72:75], v[44:47], v[184:187]
    ds_read_b128 v[88:91], v5 offset:34816
    v_mfma_f32_16x16x32_bf16 v[188:191], v[76:79], v[44:47], v[188:191]
    ds_read_b128 v[92:95], v5 offset:35840
    v_mfma_f32_16x16x32_bf16 v[192:195], v[64:67], v[48:51], v[192:195]
    ds_read_b128 v[96:99], v5 offset:36864
    v_mfma_f32_16x16x32_bf16 v[196:199], v[68:71], v[48:51], v[196:199]
    ds_read_b128 v[100:103], v5 offset:37888
    v_mfma_f32_16x16x32_bf16 v[200:203], v[72:75], v[48:51], v[200:203]
    ds_read_b128 v[104:107], v5 offset:38912
    v_mfma_f32_16x16x32_bf16 v[204:207], v[76:79], v[48:51], v[204:207]
    ds_read_b128 v[108:111], v5 offset:39936
    v_mfma_f32_16x16x32_bf16 v[208:211], v[64:67], v[52:55], v[208:211]
    v_mfma_f32_16x16x32_bf16 v[212:215], v[68:71], v[52:55], v[212:215]
    v_mfma_f32_16x16x32_bf16 v[216:219], v[72:75], v[52:55], v[216:219]
    v_mfma_f32_16x16x32_bf16 v[220:223], v[76:79], v[52:55], v[220:223]
    v_mfma_f32_16x16x32_bf16 v[224:227], v[64:67], v[56:59], v[224:227]
    v_mfma_f32_16x16x32_bf16 v[228:231], v[68:71], v[56:59], v[228:231]
    v_mfma_f32_16x16x32_bf16 v[232:235], v[72:75], v[56:59], v[232:235]
    v_mfma_f32_16x16x32_bf16 v[236:239], v[76:79], v[56:59], v[236:239]
    v_mfma_f32_16x16x32_bf16 v[240:243], v[64:67], v[60:63], v[240:243]
    v_mfma_f32_16x16x32_bf16 v[244:247], v[68:71], v[60:63], v[244:247]
    v_mfma_f32_16x16x32_bf16 v[248:251], v[72:75], v[60:63], v[248:251]
    v_mfma_f32_16x16x32_bf16 v[252:255], v[76:79], v[60:63], v[252:255]
    s_waitcnt lgkmcnt(0)
    s_waitcnt vmcnt(8)
    s_barrier
    buffer_load_dword v16, v17, s[4:7], s44 offen sc1
    v_mfma_f32_16x16x32_bf16 v[128:131], v[112:115], v[80:83], v[128:131]
    s_add_u32 m0, s21, 32768
    s_nop 0
    buffer_load_dwordx4 v1, s[4:7], s16 offen sc1 lds
    s_add_u32 s16, s16, s62
    v_mfma_f32_16x16x32_bf16 v[132:135], v[116:119], v[80:83], v[132:135]
    ds_read_b64_tr_b16 v[64:65], v12 offset:16384
    v_mfma_f32_16x16x32_bf16 v[136:139], v[120:123], v[80:83], v[136:139]
    ds_read_b64_tr_b16 v[66:67], v13 offset:16384
    v_mfma_f32_16x16x32_bf16 v[140:143], v[124:127], v[80:83], v[140:143]
    ds_read_b64_tr_b16 v[68:69], v14 offset:16384
    v_mfma_f32_16x16x32_bf16 v[144:147], v[112:115], v[84:87], v[144:147]
    s_add_u32 m0, s21, 33792
    s_nop 0
    buffer_load_dwordx4 v1, s[4:7], s17 offen sc1 lds
    s_add_u32 s17, s17, s62
    v_mfma_f32_16x16x32_bf16 v[148:151], v[116:119], v[84:87], v[148:151]
    ds_read_b64_tr_b16 v[70:71], v15 offset:16384
    v_mfma_f32_16x16x32_bf16 v[152:155], v[120:123], v[84:87], v[152:155]
    ds_read_b64_tr_b16 v[72:73], v12 offset:24576
    v_mfma_f32_16x16x32_bf16 v[156:159], v[124:127], v[84:87], v[156:159]
    ds_read_b64_tr_b16 v[74:75], v13 offset:24576
    v_mfma_f32_16x16x32_bf16 v[160:163], v[112:115], v[88:91], v[160:163]
    s_add_u32 m0, s22, 32768
    s_nop 0
    buffer_load_dwordx4 v2, s[8:11], s18 offen lds
    s_add_u32 s18, s18, s20
    v_mfma_f32_16x16x32_bf16 v[164:167], v[116:119], v[88:91], v[164:167]
    ds_read_b64_tr_b16 v[76:77], v14 offset:24576
    v_mfma_f32_16x16x32_bf16 v[168:171], v[120:123], v[88:91], v[168:171]
    ds_read_b64_tr_b16 v[78:79], v15 offset:24576
    v_mfma_f32_16x16x32_bf16 v[172:175], v[124:127], v[88:91], v[172:175]
    ds_read_b128 v[32:35], v6 offset:0
    v_mfma_f32_16x16x32_bf16 v[176:179], v[112:115], v[92:95], v[176:179]
    s_add_u32 m0, s22, 40960
    s_nop 0
    buffer_load_dwordx4 v2, s[12:15], s19 offen lds
    s_add_u32 s19, s19, s20
    v_mfma_f32_16x16x32_bf16 v[180:183], v[116:119], v[92:95], v[180:183]
    ds_read_b128 v[36:39], v6 offset:1024
    v_mfma_f32_16x16x32_bf16 v[184:187], v[120:123], v[92:95], v[184:187]
    ds_read_b128 v[40:43], v6 offset:2048
    v_mfma_f32_16x16x32_bf16 v[188:191], v[124:127], v[92:95], v[188:191]
    ds_read_b128 v[44:47], v6 offset:3072
    v_mfma_f32_16x16x32_bf16 v[192:195], v[112:115], v[96:99], v[192:195]
    ds_read_b128 v[48:51], v6 offset:4096
    v_mfma_f32_16x16x32_bf16 v[196:199], v[116:119], v[96:99], v[196:199]
    ds_read_b128 v[52:55], v6 offset:5120
    v_mfma_f32_16x16x32_bf16 v[200:203], v[120:123], v[96:99], v[200:203]
    ds_read_b128 v[56:59], v6 offset:6144
    v_mfma_f32_16x16x32_bf16 v[204:207], v[124:127], v[96:99], v[204:207]
    ds_read_b128 v[60:63], v6 offset:7168
    v_mfma_f32_16x16x32_bf16 v[208:211], v[112:115], v[100:103], v[208:211]
    v_mfma_f32_16x16x32_bf16 v[212:215], v[116:119], v[100:103], v[212:215]
    v_mfma_f32_16x16x32_bf16 v[216:219], v[120:123], v[100:103], v[216:219]
    v_mfma_f32_16x16x32_bf16 v[220:223], v[124:127], v[100:103], v[220:223]
    v_mfma_f32_16x16x32_bf16 v[224:227], v[112:115], v[104:107], v[224:227]
    v_mfma_f32_16x16x32_bf16 v[228:231], v[116:119], v[104:107], v[228:231]
    v_mfma_f32_16x16x32_bf16 v[232:235], v[120:123], v[104:107], v[232:235]
    v_mfma_f32_16x16x32_bf16 v[236:239], v[124:127], v[104:107], v[236:239]
    v_mfma_f32_16x16x32_bf16 v[240:243], v[112:115], v[108:111], v[240:243]
    v_mfma_f32_16x16x32_bf16 v[244:247], v[116:119], v[108:111], v[244:247]
    v_mfma_f32_16x16x32_bf16 v[248:251], v[120:123], v[108:111], v[248:251]
    v_mfma_f32_16x16x32_bf16 v[252:255], v[124:127], v[108:111], v[252:255]
    s_waitcnt lgkmcnt(0)
    s_waitcnt vmcnt(8)
    s_barrier
    v_mfma_f32_16x16x32_bf16 v[128:131], v[64:67], v[32:35], v[128:131]
    s_add_u32 m0, s21, 65536
    s_nop 0
    buffer_load_dwordx4 v1, s[4:7], s16 offen sc1 lds
    s_add_u32 s16, s16, s62
    v_mfma_f32_16x16x32_bf16 v[132:135], v[68:71], v[32:35], v[132:135]
    ds_read_b64_tr_b16 v[112:113], v12 offset:49152
    v_mfma_f32_16x16x32_bf16 v[136:139], v[72:75], v[32:35], v[136:139]
    ds_read_b64_tr_b16 v[114:115], v13 offset:49152
    v_mfma_f32_16x16x32_bf16 v[140:143], v[76:79], v[32:35], v[140:143]
    ds_read_b64_tr_b16 v[116:117], v14 offset:49152
    v_mfma_f32_16x16x32_bf16 v[144:147], v[64:67], v[36:39], v[144:147]
    s_add_u32 m0, s21, 66560
    s_nop 0
    buffer_load_dwordx4 v1, s[4:7], s17 offen sc1 lds
    s_add_u32 s17, s17, s62
    v_mfma_f32_16x16x32_bf16 v[148:151], v[68:71], v[36:39], v[148:151]
    ds_read_b64_tr_b16 v[118:119], v15 offset:49152
    v_mfma_f32_16x16x32_bf16 v[152:155], v[72:75], v[36:39], v[152:155]
    ds_read_b64_tr_b16 v[120:121], v12 offset:57344
    v_mfma_f32_16x16x32_bf16 v[156:159], v[76:79], v[36:39], v[156:159]
    ds_read_b64_tr_b16 v[122:123], v13 offset:57344
    v_mfma_f32_16x16x32_bf16 v[160:163], v[64:67], v[40:43], v[160:163]
    s_add_u32 m0, s22, 65536
    s_nop 0
    buffer_load_dwordx4 v2, s[8:11], s18 offen lds
    s_add_u32 s18, s18, s20
    v_mfma_f32_16x16x32_bf16 v[164:167], v[68:71], v[40:43], v[164:167]
    ds_read_b64_tr_b16 v[124:125], v14 offset:57344
    v_mfma_f32_16x16x32_bf16 v[168:171], v[72:75], v[40:43], v[168:171]
    ds_read_b64_tr_b16 v[126:127], v15 offset:57344
    v_mfma_f32_16x16x32_bf16 v[172:175], v[76:79], v[40:43], v[172:175]
    ds_read_b128 v[80:83], v6 offset:32768
    v_mfma_f32_16x16x32_bf16 v[176:179], v[64:67], v[44:47], v[176:179]
    s_add_u32 m0, s22, 73728
    s_nop 0
    buffer_load_dwordx4 v2, s[12:15], s19 offen lds
    s_add_u32 s19, s19, s20
    v_mfma_f32_16x16x32_bf16 v[180:183], v[68:71], v[44:47], v[180:183]
    ds_read_b128 v[84:87], v6 offset:33792
    v_mfma_f32_16x16x32_bf16 v[184:187], v[72:75], v[44:47], v[184:187]
    ds_read_b128 v[88:91], v6 offset:34816
    v_mfma_f32_16x16x32_bf16 v[188:191], v[76:79], v[44:47], v[188:191]
    ds_read_b128 v[92:95], v6 offset:35840
    v_mfma_f32_16x16x32_bf16 v[192:195], v[64:67], v[48:51], v[192:195]
    ds_read_b128 v[96:99], v6 offset:36864
    v_mfma_f32_16x16x32_bf16 v[196:199], v[68:71], v[48:51], v[196:199]
    ds_read_b128 v[100:103], v6 offset:37888
    v_mfma_f32_16x16x32_bf16 v[200:203], v[72:75], v[48:51], v[200:203]
    ds_read_b128 v[104:107], v6 offset:38912
    v_mfma_f32_16x16x32_bf16 v[204:207], v[76:79], v[48:51], v[204:207]
    ds_read_b128 v[108:111], v6 offset:39936
    v_mfma_f32_16x16x32_bf16 v[208:211], v[64:67], v[52:55], v[208:211]
    v_mfma_f32_16x16x32_bf16 v[212:215], v[68:71], v[52:55], v[212:215]
    v_mfma_f32_16x16x32_bf16 v[216:219], v[72:75], v[52:55], v[216:219]
    v_mfma_f32_16x16x32_bf16 v[220:223], v[76:79], v[52:55], v[220:223]
    v_mfma_f32_16x16x32_bf16 v[224:227], v[64:67], v[56:59], v[224:227]
    v_mfma_f32_16x16x32_bf16 v[228:231], v[68:71], v[56:59], v[228:231]
    v_mfma_f32_16x16x32_bf16 v[232:235], v[72:75], v[56:59], v[232:235]
    v_mfma_f32_16x16x32_bf16 v[236:239], v[76:79], v[56:59], v[236:239]
    v_mfma_f32_16x16x32_bf16 v[240:243], v[64:67], v[60:63], v[240:243]
    v_mfma_f32_16x16x32_bf16 v[244:247], v[68:71], v[60:63], v[244:247]
    v_mfma_f32_16x16x32_bf16 v[248:251], v[72:75], v[60:63], v[248:251]
    v_mfma_f32_16x16x32_bf16 v[252:255], v[76:79], v[60:63], v[252:255]
    s_waitcnt lgkmcnt(0)
    s_waitcnt vmcnt(8)
    s_barrier
    v_mfma_f32_16x16x32_bf16 v[128:131], v[112:115], v[80:83], v[128:131]
    s_add_u32 m0, s21, 98304
    s_nop 0
    buffer_load_dwordx4 v1, s[4:7], s16 offen sc1 lds
    s_add_u32 s16, s16, s62
    v_mfma_f32_16x16x32_bf16 v[132:135], v[116:119], v[80:83], v[132:135]
    ds_read_b64_tr_b16 v[64:65], v8 offset:16384
    v_mfma_f32_16x16x32_bf16 v[136:139], v[120:123], v[80:83], v[136:139]
    ds_read_b64_tr_b16 v[66:67], v9 offset:16384
    v_mfma_f32_16x16x32_bf16 v[140:143], v[124:127], v[80:83], v[140:143]
    ds_read_b64_tr_b16 v[68:69], v10 offset:16384
    v_mfma_f32_16x16x32_bf16 v[144:147], v[112:115], v[84:87], v[144:147]
    s_add_u32 m0, s21, 99328
    s_nop 0
    buffer_load_dwordx4 v1, s[4:7], s17 offen sc1 lds
    s_add_u32 s17, s17, s62
    v_mfma_f32_16x16x32_bf16 v[148:151], v[116:119], v[84:87], v[148:151]
    ds_read_b64_tr_b16 v[70:71], v11 offset:16384
    v_mfma_f32_16x16x32_bf16 v[152:155], v[120:123], v[84:87], v[152:155]
    ds_read_b64_tr_b16 v[72:73], v8 offset:24576
    v_mfma_f32_16x16x32_bf16 v[156:159], v[124:127], v[84:87], v[156:159]
    ds_read_b64_tr_b16 v[74:75], v9 offset:24576
    v_mfma_f32_16x16x32_bf16 v[160:163], v[112:115], v[88:91], v[160:163]
    s_add_u32 m0, s22, 98304
    s_nop 0
    buffer_load_dwordx4 v2, s[8:11], s18 offen lds
    s_add_u32 s18, s18, s20
    v_mfma_f32_16x16x32_bf16 v[164:167], v[116:119], v[88:91], v[164:167]
    ds_read_b64_tr_b16 v[76:77], v10 offset:24576
    v_mfma_f32_16x16x32_bf16 v[168:171], v[120:123], v[88:91], v[168:171]
    ds_read_b64_tr_b16 v[78:79], v11 offset:24576
    v_mfma_f32_16x16x32_bf16 v[172:175], v[124:127], v[88:91], v[172:175]
    ds_read_b128 v[32:35], v5 offset:0
    v_mfma_f32_16x16x32_bf16 v[176:179], v[112:115], v[92:95], v[176:179]
    s_add_u32 m0, s22, 106496
    s_nop 0
    buffer_load_dwordx4 v2, s[12:15], s19 offen lds
    s_add_u32 s19, s19, s20
    v_mfma_f32_16x16x32_bf16 v[180:183], v[116:119], v[92:95], v[180:183]
    ds_read_b128 v[36:39], v5 offset:1024
    v_mfma_f32_16x16x32_bf16 v[184:187], v[120:123], v[92:95], v[184:187]
    ds_read_b128 v[40:43], v5 offset:2048
    v_mfma_f32_16x16x32_bf16 v[188:191], v[124:127], v[92:95], v[188:191]
    ds_read_b128 v[44:47], v5 offset:3072
    v_mfma_f32_16x16x32_bf16 v[192:195], v[112:115], v[96:99], v[192:195]
    ds_read_b128 v[48:51], v5 offset:4096
    v_mfma_f32_16x16x32_bf16 v[196:199], v[116:119], v[96:99], v[196:199]
    ds_read_b128 v[52:55], v5 offset:5120
    v_mfma_f32_16x16x32_bf16 v[200:203], v[120:123], v[96:99], v[200:203]
    ds_read_b128 v[56:59], v5 offset:6144
    v_mfma_f32_16x16x32_bf16 v[204:207], v[124:127], v[96:99], v[204:207]
    ds_read_b128 v[60:63], v5 offset:7168
    v_mfma_f32_16x16x32_bf16 v[208:211], v[112:115], v[100:103], v[208:211]
    v_mfma_f32_16x16x32_bf16 v[212:215], v[116:119], v[100:103], v[212:215]
    v_mfma_f32_16x16x32_bf16 v[216:219], v[120:123], v[100:103], v[216:219]
    v_mfma_f32_16x16x32_bf16 v[220:223], v[124:127], v[100:103], v[220:223]
    v_mfma_f32_16x16x32_bf16 v[224:227], v[112:115], v[104:107], v[224:227]
    v_mfma_f32_16x16x32_bf16 v[228:231], v[116:119], v[104:107], v[228:231]
    v_mfma_f32_16x16x32_bf16 v[232:235], v[120:123], v[104:107], v[232:235]
    v_mfma_f32_16x16x32_bf16 v[236:239], v[124:127], v[104:107], v[236:239]
    v_mfma_f32_16x16x32_bf16 v[240:243], v[112:115], v[108:111], v[240:243]
    v_mfma_f32_16x16x32_bf16 v[244:247], v[116:119], v[108:111], v[244:247]
    v_mfma_f32_16x16x32_bf16 v[248:251], v[120:123], v[108:111], v[248:251]
    v_mfma_f32_16x16x32_bf16 v[252:255], v[124:127], v[108:111], v[252:255]
    s_waitcnt lgkmcnt(0)
    s_sub_u32 s23, s23, 1
    s_cmp_lg_u32 s23, 0
    s_cbranch_scc1 w_loop
    v_mov_b32 v20, 131072
    ds_read_b128 v[24:27], v20
    ds_read_b128 v[28:31], v20 offset:16
    s_cmp_eq_u32 s48, 2
    s_cbranch_scc1 w_epi_glu
    s_lshl_b32 s30, s27, 10
    s_add_u32 s30, s30, s49
    s_nop 7
    v_cvt_pk_bf16_f32 v80, v128, v129
    v_cvt_pk_bf16_f32 v81, v130, v131
    v_cvt_pk_bf16_f32 v82, v132, v133
    v_cvt_pk_bf16_f32 v83, v134, v135
    buffer_store_dwordx4 v[80:83], v1, s[4:7], s30 offen sc1
    v_cvt_pk_bf16_f32 v84, v136, v137
    v_cvt_pk_bf16_f32 v85, v138, v139
    v_cvt_pk_bf16_f32 v86, v140, v141
    v_cvt_pk_bf16_f32 v87, v142, v143
    buffer_store_dwordx4 v[84:87], v19, s[4:7], s30 offen sc1
    s_add_u32 s30, s30, s50
    v_cvt_pk_bf16_f32 v88, v144, v145
    v_cvt_pk_bf16_f32 v89, v146, v147
    v_cvt_pk_bf16_f32 v90, v148, v149
    v_cvt_pk_bf16_f32 v91, v150, v151
    buffer_store_dwordx4 v[88:91], v1, s[4:7], s30 offen sc1
    v_cvt_pk_bf16_f32 v92, v152, v153
    v_cvt_pk_bf16_f32 v93, v154, v155
    v_cvt_pk_bf16_f32 v94, v156, v157
    v_cvt_pk_bf16_f32 v95, v158, v159
    buffer_store_dwordx4 v[92:95], v19, s[4:7], s30 offen sc1
    s_add_u32 s30, s30, s50
    v_cvt_pk_bf16_f32 v80, v160, v161
    v_cvt_pk_bf16_f32 v81, v162, v163
    v_cvt_pk_bf16_f32 v82, v164, v165
    v_cvt_pk_bf16_f32 v83, v166, v167
    buffer_store_dwordx4 v[80:83], v1, s[4:7], s30 offen sc1
    v_cvt_pk_bf16_f32 v84, v168, v169
    v_cvt_pk_bf16_f32 v85, v170, v171
    v_cvt_pk_bf16_f32 v86, v172, v173
    v_cvt_pk_bf16_f32 v87, v174, v175
    buffer_store_dwordx4 v[84:87], v19, s[4:7], s30 offen sc1
    s_add_u32 s30, s30, s50
    v_cvt_pk_bf16_f32 v88, v176, v177
    v_cvt_pk_bf16_f32 v89, v178, v179
    v_cvt_pk_bf16_f32 v90, v180, v181
    v_cvt_pk_bf16_f32 v91, v182, v183
    buffer_store_dwordx4 v[88:91], v1, s[4:7], s30 offen sc1
    v_cvt_pk_bf16_f32 v92, v184, v185
    v_cvt_pk_bf16_f32 v93, v186, v187
    v_cvt_pk_bf16_f32 v94, v188, v189
    v_cvt_pk_bf16_f32 v95, v190, v191
    buffer_store_dwordx4 v[92:95], v19, s[4:7], s30 offen sc1
    s_add_u32 s30, s30, s50
    v_cvt_pk_bf16_f32 v80, v192, v193
    v_cvt_pk_bf16_f32 v81, v194, v195
    v_cvt_pk_bf16_f32 v82, v196, v197
    v_cvt_pk_bf16_f32 v83, v198, v199
    buffer_store_dwordx4 v[80:83], v1, s[4:7], s30 offen sc1
    v_cvt_pk_bf16_f32 v84, v200, v201
    v_cvt_pk_bf16_f32 v85, v202, v203
    v_cvt_pk_bf16_f32 v86, v204, v205
    v_cvt_pk_bf16_f32 v87, v206, v207
    buffer_store_dwordx4 v[84:87], v19, s[4:7], s30 offen sc1
    s_add_u32 s30, s30, s50
    v_cvt_pk_bf16_f32 v88, v208, v209
    v_cvt_pk_bf16_f32 v89, v210, v211
    v_cvt_pk_bf16_f32 v90, v212, v213
    v_cvt_pk_bf16_f32 v91, v214, v215
    buffer_store_dwordx4 v[88:91], v1, s[4:7], s30 offen sc1
    v_cvt_pk_bf16_f32 v92, v216, v217
    v_cvt_pk_bf16_f32 v93, v218, v219
    v_cvt_pk_bf16_f32 v94, v220, v221
    v_cvt_pk_bf16_f32 v95, v222, v223
    buffer_store_dwordx4 v[92:95], v19, s[4:7], s30 offen sc1
    s_add_u32 s30, s30, s50
    v_cvt_pk_bf16_f32 v80, v224, v225
    v_cvt_pk_bf16_f32 v81, v226, v227
    v_cvt_pk_bf16_f32 v82, v228, v229
    v_cvt_pk_bf16_f32 v83, v230, v231
    buffer_store_dwordx4 v[80:83], v1, s[4:7], s30 offen sc1
    v_cvt_pk_bf16_f32 v84, v232, v233
    v_cvt_pk_bf16_f32 v85, v234, v235
    v_cvt_pk_bf16_f32 v86, v236, v237
    v_cvt_pk_bf16_f32 v87, v238, v239
    buffer_store_dwordx4 v[84:87], v19, s[4:7], s30 offen sc1
    s_add_u32 s30, s30, s50
    v_cvt_pk_bf16_f32 v88, v240, v241
    v_cvt_pk_bf16_f32 v89, v242, v243
    v_cvt_pk_bf16_f32 v90, v244, v245
    v_cvt_pk_bf16_f32 v91, v246, v247
    buffer_store_dwordx4 v[88:91], v1, s[4:7], s30 offen sc1
    v_cvt_pk_bf16_f32 v92, v248, v249
    v_cvt_pk_bf16_f32 v93, v250, v251
    v_cvt_pk_bf16_f32 v94, v252, v253
    v_cvt_pk_bf16_f32 v95, v254, v255
    buffer_store_dwordx4 v[92:95], v19, s[4:7], s30 offen sc1
    s_waitcnt lgkmcnt(0)
    v_or3_b32 v24, v24, v25, v26
    v_or3_b32 v28, v28, v29, v30
    v_or3_b32 v24, v24, v27, v31
    v_or_b32 v24, v24, v28
    s_mov_b32 s28, s51
    v_readfirstlane_b32 s30, v24
    s_cmp_lg_u32 s30, 0
    s_cbranch_scc1 w_drain
    s_mov_b32 s48, s32
    s_cmp_eq_u32 s32, 4
    s_cselect_b32 s30, 2, 3
    s_lshl_b32 s30, s26, s30
    s_mul_i32 s30, s30, s43
    s_add_u32 s49, s42, s30
    s_mov_b32 s50, s43
    s_mov_b32 s51, s46
    s_mov_b32 s23, s41
    s_mov_b32 s53, s41
    s_branch w_first16
w_epi_glu:
    s_lshl_b32 s30, s27, 10
    s_add_u32 s30, s30, s49
    s_mov_b32 s54, 0xbfb8aa3b
    s_nop 7
    v_cvt_pk_bf16_f32 v80, v128, v129
    v_cvt_pk_bf16_f32 v81, v130, v131
    v_cvt_pk_bf16_f32 v82, v132, v133
    v_cvt_pk_bf16_f32 v83, v134, v135
    v_lshlrev_b32 v96, 16, v80
    v_and_b32 v97, 0xffff0000, v80
    v_lshlrev_b32 v98, 16, v81
    v_and_b32 v99, 0xffff0000, v81
    v_lshlrev_b32 v100, 16, v82
    v_and_b32 v101, 0xffff0000, v82
    v_lshlrev_b32 v102, 16, v83
    v_and_b32 v103, 0xffff0000, v83
    v_mul_f32 v96, s54, v96
    v_mul_f32 v97, s54, v97
    v_mul_f32 v98, s54, v98
    v_mul_f32 v99, s54, v99
    v_mul_f32 v100, s54, v100
    v_mul_f32 v101, s54, v101
    v_mul_f32 v102, s54, v102
    v_mul_f32 v103, s54, v103
    v_exp_f32 v96, v96
    v_exp_f32 v97, v97
    v_exp_f32 v98, v98
    v_exp_f32 v99, v99
    v_exp_f32 v100, v100
    v_exp_f32 v101, v101
    v_exp_f32 v102, v102
    v_exp_f32 v103, v103
    v_add_f32 v96, 1.0, v96
    v_add_f32 v97, 1.0, v97
    v_add_f32 v98, 1.0, v98
    v_add_f32 v99, 1.0, v99
    v_add_f32 v100, 1.0, v100
    v_add_f32 v101, 1.0, v101
    v_add_f32 v102, 1.0, v102
    v_add_f32 v103, 1.0, v103
    v_rcp_f32 v96, v96
    v_rcp_f32 v97, v97
    v_rcp_f32 v98, v98
    v_rcp_f32 v99, v99
    v_rcp_f32 v100, v100
    v_rcp_f32 v101, v101
    v_rcp_f32 v102, v102
    v_rcp_f32 v103, v103
    v_mul_f32 v96, v96, v136
    v_mul_f32 v97, v97, v137
    v_mul_f32 v98, v98, v138
    v_mul_f32 v99, v99, v139
    v_mul_f32 v100, v100, v140
    v_mul_f32 v101, v101, v141
    v_mul_f32 v102, v102, v142
    v_mul_f32 v103, v103, v143
    v_cvt_pk_bf16_f32 v80, v96, v97
    v_cvt_pk_bf16_f32 v81, v98, v99
    v_cvt_pk_bf16_f32 v82, v100, v101
    v_cvt_pk_bf16_f32 v83, v102, v103
    buffer_store_dwordx4 v[80:83], v1, s[4:7], s30 offen sc1
    s_add_u32 s30, s30, s50
    v_cvt_pk_bf16_f32 v84, v144, v145
    v_cvt_pk_bf16_f32 v85, v146, v147
    v_cvt_pk_bf16_f32 v86, v148, v149
    v_cvt_pk_bf16_f32 v87, v150, v151
    v_lshlrev_b32 v104, 16, v84
    v_and_b32 v105, 0xffff0000, v84
    v_lshlrev_b32 v106, 16, v85
    v_and_b32 v107, 0xffff0000, v85
    v_lshlrev_b32 v108, 16, v86
    v_and_b32 v109, 0xffff0000, v86
    v_lshlrev_b32 v110, 16, v87
    v_and_b32 v111, 0xffff0000, v87
    v_mul_f32 v104, s54, v104
    v_mul_f32 v105, s54, v105
    v_mul_f32 v106, s54, v106
    v_mul_f32 v107, s54, v107
    v_mul_f32 v108, s54, v108
    v_mul_f32 v109, s54, v109
    v_mul_f32 v110, s54, v110
    v_mul_f32 v111, s54, v111
    v_exp_f32 v104, v104
    v_exp_f32 v105, v105
    v_exp_f32 v106, v106
    v_exp_f32 v107, v107
    v_exp_f32 v108, v108
    v_exp_f32 v109, v109
    v_exp_f32 v110, v110
    v_exp_f32 v111, v111
    v_add_f32 v104, 1.0, v104
    v_add_f32 v105, 1.0, v105
    v_add_f32 v106, 1.0, v106
    v_add_f32 v107, 1.0, v107
    v_add_f32 v108, 1.0, v108
    v_add_f32 v109, 1.0, v109
    v_add_f32 v110, 1.0, v110
    v_add_f32 v111, 1.0, v111
    v_rcp_f32 v104, v104
    v_rcp_f32 v105, v105
    v_rcp_f32 v106, v106
    v_rcp_f32 v107, v107
    v_rcp_f32 v108, v108
    v_rcp_f32 v109, v109
    v_rcp_f32 v110, v110
    v_rcp_f32 v111, v111
    v_mul_f32 v104, v104, v152
    v_mul_f32 v105, v105, v153
    v_mul_f32 v106, v106, v154
    v_mul_f32 v107, v107, v155
    v_mul_f32 v108, v108, v156
    v_mul_f32 v109, v109, v157
    v_mul_f32 v110, v110, v158
    v_mul_f32 v111, v111, v159
    v_cvt_pk_bf16_f32 v84, v104, v105
    v_cvt_pk_bf16_f32 v85, v106, v107
    v_cvt_pk_bf16_f32 v86, v108, v109
    v_cvt_pk_bf16_f32 v87, v110, v111
    buffer_store_dwordx4 v[84:87], v1, s[4:7], s30 offen sc1
    s_add_u32 s30, s30, s50
    v_cvt_pk_bf16_f32 v88, v160, v161
    v_cvt_pk_bf16_f32 v89, v162, v163
    v_cvt_pk_bf16_f32 v90, v164, v165
    v_cvt_pk_bf16_f32 v91, v166, v167
    v_lshlrev_b32 v96, 16, v88
    v_and_b32 v97, 0xffff0000, v88
    v_lshlrev_b32 v98, 16, v89
    v_and_b32 v99, 0xffff0000, v89
    v_lshlrev_b32 v100, 16, v90
    v_and_b32 v101, 0xffff0000, v90
    v_lshlrev_b32 v102, 16, v91
    v_and_b32 v103, 0xffff0000, v91
    v_mul_f32 v96, s54, v96
    v_mul_f32 v97, s54, v97
    v_mul_f32 v98, s54, v98
    v_mul_f32 v99, s54, v99
    v_mul_f32 v100, s54, v100
    v_mul_f32 v101, s54, v101
    v_mul_f32 v102, s54, v102
    v_mul_f32 v103, s54, v103
    v_exp_f32 v96, v96
    v_exp_f32 v97, v97
    v_exp_f32 v98, v98
    v_exp_f32 v99, v99
    v_exp_f32 v100, v100
    v_exp_f32 v101, v101
    v_exp_f32 v102, v102
    v_exp_f32 v103, v103
    v_add_f32 v96, 1.0, v96
    v_add_f32 v97, 1.0, v97
    v_add_f32 v98, 1.0, v98
    v_add_f32 v99, 1.0, v99
    v_add_f32 v100, 1.0, v100
    v_add_f32 v101, 1.0, v101
    v_add_f32 v102, 1.0, v102
    v_add_f32 v103, 1.0, v103
    v_rcp_f32 v96, v96
    v_rcp_f32 v97, v97
    v_rcp_f32 v98, v98
    v_rcp_f32 v99, v99
    v_rcp_f32 v100, v100
    v_rcp_f32 v101, v101
    v_rcp_f32 v102, v102
    v_rcp_f32 v103, v103
    v_mul_f32 v96, v96, v168
    v_mul_f32 v97, v97, v169
    v_mul_f32 v98, v98, v170
    v_mul_f32 v99, v99, v171
    v_mul_f32 v100, v100, v172
    v_mul_f32 v101, v101, v173
    v_mul_f32 v102, v102, v174
    v_mul_f32 v103, v103, v175
    v_cvt_pk_bf16_f32 v88, v96, v97
    v_cvt_pk_bf16_f32 v89, v98, v99
    v_cvt_pk_bf16_f32 v90, v100, v101
    v_cvt_pk_bf16_f32 v91, v102, v103
    buffer_store_dwordx4 v[88:91], v1, s[4:7], s30 offen sc1
    s_add_u32 s30, s30, s50
    v_cvt_pk_bf16_f32 v92, v176, v177
    v_cvt_pk_bf16_f32 v93, v178, v179
    v_cvt_pk_bf16_f32 v94, v180, v181
    v_cvt_pk_bf16_f32 v95, v182, v183
    v_lshlrev_b32 v104, 16, v92
    v_and_b32 v105, 0xffff0000, v92
    v_lshlrev_b32 v106, 16, v93
    v_and_b32 v107, 0xffff0000, v93
    v_lshlrev_b32 v108, 16, v94
    v_and_b32 v109, 0xffff0000, v94
    v_lshlrev_b32 v110, 16, v95
    v_and_b32 v111, 0xffff0000, v95
    v_mul_f32 v104, s54, v104
    v_mul_f32 v105, s54, v105
    v_mul_f32 v106, s54, v106
    v_mul_f32 v107, s54, v107
    v_mul_f32 v108, s54, v108
    v_mul_f32 v109, s54, v109
    v_mul_f32 v110, s54, v110
    v_mul_f32 v111, s54, v111
    v_exp_f32 v104, v104
    v_exp_f32 v105, v105
    v_exp_f32 v106, v106
    v_exp_f32 v107, v107
    v_exp_f32 v108, v108
    v_exp_f32 v109, v109
    v_exp_f32 v110, v110
    v_exp_f32 v111, v111
    v_add_f32 v104, 1.0, v104
    v_add_f32 v105, 1.0, v105
    v_add_f32 v106, 1.0, v106
    v_add_f32 v107, 1.0, v107
    v_add_f32 v108, 1.0, v108
    v_add_f32 v109, 1.0, v109
    v_add_f32 v110, 1.0, v110
    v_add_f32 v111, 1.0, v111
    v_rcp_f32 v104, v104
    v_rcp_f32 v105, v105
    v_rcp_f32 v106, v106
    v_rcp_f32 v107, v107
    v_rcp_f32 v108, v108
    v_rcp_f32 v109, v109
    v_rcp_f32 v110, v110
    v_rcp_f32 v111, v111
    v_mul_f32 v104, v104, v184
    v_mul_f32 v105, v105, v185
    v_mul_f32 v106, v106, v186
    v_mul_f32 v107, v107, v187
    v_mul_f32 v108, v108, v188
    v_mul_f32 v109, v109, v189
    v_mul_f32 v110, v110, v190
    v_mul_f32 v111, v111, v191
    v_cvt_pk_bf16_f32 v92, v104, v105
    v_cvt_pk_bf16_f32 v93, v106, v107
    v_cvt_pk_bf16_f32 v94, v108, v109
    v_cvt_pk_bf16_f32 v95, v110, v111
    buffer_store_dwordx4 v[92:95], v1, s[4:7], s30 offen sc1
    s_add_u32 s30, s30, s50
    v_cvt_pk_bf16_f32 v80, v192, v193
    v_cvt_pk_bf16_f32 v81, v194, v195
    v_cvt_pk_bf16_f32 v82, v196, v197
    v_cvt_pk_bf16_f32 v83, v198, v199
    v_lshlrev_b32 v96, 16, v80
    v_and_b32 v97, 0xffff0000, v80
    v_lshlrev_b32 v98, 16, v81
    v_and_b32 v99, 0xffff0000, v81
    v_lshlrev_b32 v100, 16, v82
    v_and_b32 v101, 0xffff0000, v82
    v_lshlrev_b32 v102, 16, v83
    v_and_b32 v103, 0xffff0000, v83
    v_mul_f32 v96, s54, v96
    v_mul_f32 v97, s54, v97
    v_mul_f32 v98, s54, v98
    v_mul_f32 v99, s54, v99
    v_mul_f32 v100, s54, v100
    v_mul_f32 v101, s54, v101
    v_mul_f32 v102, s54, v102
    v_mul_f32 v103, s54, v103
    v_exp_f32 v96, v96
    v_exp_f32 v97, v97
    v_exp_f32 v98, v98
    v_exp_f32 v99, v99
    v_exp_f32 v100, v100
    v_exp_f32 v101, v101
    v_exp_f32 v102, v102
    v_exp_f32 v103, v103
    v_add_f32 v96, 1.0, v96
    v_add_f32 v97, 1.0, v97
    v_add_f32 v98, 1.0, v98
    v_add_f32 v99, 1.0, v99
    v_add_f32 v100, 1.0, v100
    v_add_f32 v101, 1.0, v101
    v_add_f32 v102, 1.0, v102
    v_add_f32 v103, 1.0, v103
    v_rcp_f32 v96, v96
    v_rcp_f32 v97, v97
    v_rcp_f32 v98, v98
    v_rcp_f32 v99, v99
    v_rcp_f32 v100, v100
    v_rcp_f32 v101, v101
    v_rcp_f32 v102, v102
    v_rcp_f32 v103, v103
    v_mul_f32 v96, v96, v200
    v_mul_f32 v97, v97, v201
    v_mul_f32 v98, v98, v202
    v_mul_f32 v99, v99, v203
    v_mul_f32 v100, v100, v204
    v_mul_f32 v101, v101, v205
    v_mul_f32 v102, v102, v206
    v_mul_f32 v103, v103, v207
    v_cvt_pk_bf16_f32 v80, v96, v97
    v_cvt_pk_bf16_f32 v81, v98, v99
    v_cvt_pk_bf16_f32 v82, v100, v101
    v_cvt_pk_bf16_f32 v83, v102, v103
    buffer_store_dwordx4 v[80:83], v1, s[4:7], s30 offen sc1
    s_add_u32 s30, s30, s50
    v_cvt_pk_bf16_f32 v84, v208, v209
    v_cvt_pk_bf16_f32 v85, v210, v211
    v_cvt_pk_bf16_f32 v86, v212, v213
    v_cvt_pk_bf16_f32 v87, v214, v215
    v_lshlrev_b32 v104, 16, v84
    v_and_b32 v105, 0xffff0000, v84
    v_lshlrev_b32 v106, 16, v85
    v_and_b32 v107, 0xffff0000, v85
    v_lshlrev_b32 v108, 16, v86
    v_and_b32 v109, 0xffff0000, v86
    v_lshlrev_b32 v110, 16, v87
    v_and_b32 v111, 0xffff0000, v87
    v_mul_f32 v104, s54, v104
    v_mul_f32 v105, s54, v105
    v_mul_f32 v106, s54, v106
    v_mul_f32 v107, s54, v107
    v_mul_f32 v108, s54, v108
    v_mul_f32 v109, s54, v109
    v_mul_f32 v110, s54, v110
    v_mul_f32 v111, s54, v111
    v_exp_f32 v104, v104
    v_exp_f32 v105, v105
    v_exp_f32 v106, v106
    v_exp_f32 v107, v107
    v_exp_f32 v108, v108
    v_exp_f32 v109, v109
    v_exp_f32 v110, v110
    v_exp_f32 v111, v111
    v_add_f32 v104, 1.0, v104
    v_add_f32 v105, 1.0, v105
    v_add_f32 v106, 1.0, v106
    v_add_f32 v107, 1.0, v107
    v_add_f32 v108, 1.0, v108
    v_add_f32 v109, 1.0, v109
    v_add_f32 v110, 1.0, v110
    v_add_f32 v111, 1.0, v111
    v_rcp_f32 v104, v104
    v_rcp_f32 v105, v105
    v_rcp_f32 v106, v106
    v_rcp_f32 v107, v107
    v_rcp_f32 v108, v108
    v_rcp_f32 v109, v109
    v_rcp_f32 v110, v110
    v_rcp_f32 v111, v111
    v_mul_f32 v104, v104, v216
    v_mul_f32 v105, v105, v217
    v_mul_f32 v106, v106, v218
    v_mul_f32 v107, v107, v219
    v_mul_f32 v108, v108, v220
    v_mul_f32 v109, v109, v221
    v_mul_f32 v110, v110, v222
    v_mul_f32 v111, v111, v223
    v_cvt_pk_bf16_f32 v84, v104, v105
    v_cvt_pk_bf16_f32 v85, v106, v107
    v_cvt_pk_bf16_f32 v86, v108, v109
    v_cvt_pk_bf16_f32 v87, v110, v111
    buffer_store_dwordx4 v[84:87], v1, s[4:7], s30 offen sc1
    s_add_u32 s30, s30, s50
    v_cvt_pk_bf16_f32 v88, v224, v225
    v_cvt_pk_bf16_f32 v89, v226, v227
    v_cvt_pk_bf16_f32 v90, v228, v229
    v_cvt_pk_bf16_f32 v91, v230, v231
    v_lshlrev_b32 v96, 16, v88
    v_and_b32 v97, 0xffff0000, v88
    v_lshlrev_b32 v98, 16, v89
    v_and_b32 v99, 0xffff0000, v89
    v_lshlrev_b32 v100, 16, v90
    v_and_b32 v101, 0xffff0000, v90
    v_lshlrev_b32 v102, 16, v91
    v_and_b32 v103, 0xffff0000, v91
    v_mul_f32 v96, s54, v96
    v_mul_f32 v97, s54, v97
    v_mul_f32 v98, s54, v98
    v_mul_f32 v99, s54, v99
    v_mul_f32 v100, s54, v100
    v_mul_f32 v101, s54, v101
    v_mul_f32 v102, s54, v102
    v_mul_f32 v103, s54, v103
    v_exp_f32 v96, v96
    v_exp_f32 v97, v97
    v_exp_f32 v98, v98
    v_exp_f32 v99, v99
    v_exp_f32 v100, v100
    v_exp_f32 v101, v101
    v_exp_f32 v102, v102
    v_exp_f32 v103, v103
    v_add_f32 v96, 1.0, v96
    v_add_f32 v97, 1.0, v97
    v_add_f32 v98, 1.0, v98
    v_add_f32 v99, 1.0, v99
    v_add_f32 v100, 1.0, v100
    v_add_f32 v101, 1.0, v101
    v_add_f32 v102, 1.0, v102
    v_add_f32 v103, 1.0, v103
    v_rcp_f32 v96, v96
    v_rcp_f32 v97, v97
    v_rcp_f32 v98, v98
    v_rcp_f32 v99, v99
    v_rcp_f32 v100, v100
    v_rcp_f32 v101, v101
    v_rcp_f32 v102, v102
    v_rcp_f32 v103, v103
    v_mul_f32 v96, v96, v232
    v_mul_f32 v97, v97, v233
    v_mul_f32 v98, v98, v234
    v_mul_f32 v99, v99, v235
    v_mul_f32 v100, v100, v236
    v_mul_f32 v101, v101, v237
    v_mul_f32 v102, v102, v238
    v_mul_f32 v103, v103, v239
    v_cvt_pk_bf16_f32 v88, v96, v97
    v_cvt_pk_bf16_f32 v89, v98, v99
    v_cvt_pk_bf16_f32 v90, v100, v101
    v_cvt_pk_bf16_f32 v91, v102, v103
    buffer_store_dwordx4 v[88:91], v1, s[4:7], s30 offen sc1
    s_add_u32 s30, s30, s50
    v_cvt_pk_bf16_f32 v92, v240, v241
    v_cvt_pk_bf16_f32 v93, v242, v243
    v_cvt_pk_bf16_f32 v94, v244, v245
    v_cvt_pk_bf16_f32 v95, v246, v247
    v_lshlrev_b32 v104, 16, v92
    v_and_b32 v105, 0xffff0000, v92
    v_lshlrev_b32 v106, 16, v93
    v_and_b32 v107, 0xffff0000, v93
    v_lshlrev_b32 v108, 16, v94
    v_and_b32 v109, 0xffff0000, v94
    v_lshlrev_b32 v110, 16, v95
    v_and_b32 v111, 0xffff0000, v95
    v_mul_f32 v104, s54, v104
    v_mul_f32 v105, s54, v105
    v_mul_f32 v106, s54, v106
    v_mul_f32 v107, s54, v107
    v_mul_f32 v108, s54, v108
    v_mul_f32 v109, s54, v109
    v_mul_f32 v110, s54, v110
    v_mul_f32 v111, s54, v111
    v_exp_f32 v104, v104
    v_exp_f32 v105, v105
    v_exp_f32 v106, v106
    v_exp_f32 v107, v107
    v_exp_f32 v108, v108
    v_exp_f32 v109, v109
    v_exp_f32 v110, v110
    v_exp_f32 v111, v111
    v_add_f32 v104, 1.0, v104
    v_add_f32 v105, 1.0, v105
    v_add_f32 v106, 1.0, v106
    v_add_f32 v107, 1.0, v107
    v_add_f32 v108, 1.0, v108
    v_add_f32 v109, 1.0, v109
    v_add_f32 v110, 1.0, v110
    v_add_f32 v111, 1.0, v111
    v_rcp_f32 v104, v104
    v_rcp_f32 v105, v105
    v_rcp_f32 v106, v106
    v_rcp_f32 v107, v107
    v_rcp_f32 v108, v108
    v_rcp_f32 v109, v109
    v_rcp_f32 v110, v110
    v_rcp_f32 v111, v111
    v_mul_f32 v104, v104, v248
    v_mul_f32 v105, v105, v249
    v_mul_f32 v106, v106, v250
    v_mul_f32 v107, v107, v251
    v_mul_f32 v108, v108, v252
    v_mul_f32 v109, v109, v253
    v_mul_f32 v110, v110, v254
    v_mul_f32 v111, v111, v255
    v_cvt_pk_bf16_f32 v92, v104, v105
    v_cvt_pk_bf16_f32 v93, v106, v107
    v_cvt_pk_bf16_f32 v94, v108, v109
    v_cvt_pk_bf16_f32 v95, v110, v111
    buffer_store_dwordx4 v[92:95], v1, s[4:7], s30 offen sc1
    s_waitcnt lgkmcnt(0)
    v_or3_b32 v24, v24, v25, v26
    v_or3_b32 v28, v28, v29, v30
    v_or3_b32 v24, v24, v27, v31
    v_or_b32 v24, v24, v28
    s_mov_b32 s28, s51
    v_readfirstlane_b32 s30, v24
    s_cmp_lg_u32 s30, 0
    s_cbranch_scc1 w_drain
    s_mov_b32 s48, s32
    s_cmp_eq_u32 s32, 4
    s_cselect_b32 s30, 2, 3
    s_lshl_b32 s30, s26, s30
    s_mul_i32 s30, s30, s43
    s_add_u32 s49, s42, s30
    s_mov_b32 s50, s43
    s_mov_b32 s51, s46
    s_mov_b32 s23, s41
    s_mov_b32 s53, s41
    s_branch w_first8
w_firstH:
    s_waitcnt vmcnt(8)
    s_barrier
    s_add_u32 m0, s21, 0
    s_nop 0
    buffer_load_dwordx4 v1, s[4:7], s16 offen sc1 lds
    s_add_u32 s16, s16, s62
    s_add_u32 m0, s21, 1024
    s_nop 0
    buffer_load_dwordx4 v1, s[4:7], s17 offen sc1 lds
    s_add_u32 s17, s17, s62
    s_add_u32 m0, s22, 0
    s_nop 0
    buffer_load_dwordx4 v2, s[8:11], s18 offen lds
    s_add_u32 s18, s18, s20
    s_add_u32 m0, s22, 8192
    s_nop 0
    buffer_load_dwordx4 v2, s[12:15], s19 offen lds
    s_add_u32 s19, s19, s20
    v_mfma_f32_16x16x32_bf16 v[128:131], v[64:67], v[32:35], 0
    ds_read_b64_tr_b16 v[112:113], v8 offset:49152
    v_mfma_f32_16x16x32_bf16 v[132:135], v[68:71], v[32:35], 0
    ds_read_b64_tr_b16 v[114:115], v9 offset:49152
    v_mfma_f32_16x16x32_bf16 v[144:147], v[64:67], v[40:43], 0
    ds_read_b64_tr_b16 v[116:117], v10 offset:49152
    v_mfma_f32_16x16x32_bf16 v[148:151], v[68:71], v[40:43], 0
    ds_read_b64_tr_b16 v[118:119], v11 offset:49152
    v_mfma_f32_16x16x32_bf16 v[160:163], v[64:67], v[48:51], 0
    ds_read_b64_tr_b16 v[120:121], v8 offset:57344
    v_mfma_f32_16x16x32_bf16 v[164:167], v[68:71], v[48:51], 0
    ds_read_b64_tr_b16 v[122:123], v9 offset:57344
    v_mfma_f32_16x16x32_bf16 v[176:179], v[64:67], v[56:59], 0
    ds_read_b64_tr_b16 v[124:125], v10 offset:57344
    v_mfma_f32_16x16x32_bf16 v[180:183], v[68:71], v[56:59], 0
    ds_read_b64_tr_b16 v[126:127], v11 offset:57344
    v_mfma_f32_16x16x32_bf16 v[128:131], v[72:75], v[36:39], v[128:131]
    ds_read_b128 v[80:83], v5 offset:32768
    v_mfma_f32_16x16x32_bf16 v[132:135], v[76:79], v[36:39], v[132:135]
    ds_read_b128 v[84:87], v5 offset:33792
    v_mfma_f32_16x16x32_bf16 v[144:147], v[72:75], v[44:47], v[144:147]
    ds_read_b128 v[88:91], v5 offset:34816
    v_mfma_f32_16x16x32_bf16 v[148:151], v[76:79], v[44:47], v[148:151]
    ds_read_b128 v[92:95], v5 offset:35840
    v_mfma_f32_16x16x32_bf16 v[160:163], v[72:75], v[52:55], v[160:163]
    ds_read_b128 v[96:99], v5 offset:36864
    v_mfma_f32_16x16x32_bf16 v[164:167], v[76:79], v[52:55], v[164:167]
    ds_read_b128 v[100:103], v5 offset:37888
    v_mfma_f32_16x16x32_bf16 v[176:179], v[72:75], v[60:63], v[176:179]
    ds_read_b128 v[104:107], v5 offset:38912
    v_mfma_f32_16x16x32_bf16 v[180:183], v[76:79], v[60:63], v[180:183]
    ds_read_b128 v[108:111], v5 offset:39936
    s_waitcnt lgkmcnt(0)
    s_waitcnt vmcnt(8)
    s_barrier
    s_add_u32 m0, s21, 32768
    s_nop 0
    buffer_load_dwordx4 v1, s[4:7], s16 offen sc1 lds
    s_add_u32 s16, s16, s62
    s_add_u32 m0, s21, 33792
    s_nop 0
    buffer_load_dwordx4 v1, s[4:7], s17 offen sc1 lds
    s_add_u32 s17, s17, s62
    s_add_u32 m0, s22, 32768
    s_nop 0
    buffer_load_dwordx4 v2, s[8:11], s18 offen lds
    s_add_u32 s18, s18, s20
    s_add_u32 m0, s22, 40960
    s_nop 0
    buffer_load_dwordx4 v2, s[12:15], s19 offen lds
    s_add_u32 s19, s19, s20
    v_mfma_f32_16x16x32_bf16 v[128:131], v[112:115], v[80:83], v[128:131]
    ds_read_b64_tr_b16 v[64:65], v12 offset:16384
    v_mfma_f32_16x16x32_bf16 v[132:135], v[116:119], v[80:83], v[132:135]
    ds_read_b64_tr_b16 v[66:67], v13 offset:16384
    v_mfma_f32_16x16x32_bf16 v[144:147], v[112:115], v[88:91], v[144:147]
    ds_read_b64_tr_b16 v[68:69], v14 offset:16384
    v_mfma_f32_16x16x32_bf16 v[148:151], v[116:119], v[88:91], v[148:151]
    ds_read_b64_tr_b16 v[70:71], v15 offset:16384
    v_mfma_f32_16x16x32_bf16 v[160:163], v[112:115], v[96:99], v[160:163]
    ds_read_b64_tr_b16 v[72:73], v12 offset:24576
    v_mfma_f32_16x16x32_bf16 v[164:167], v[116:119], v[96:99], v[164:167]
    ds_read_b64_tr_b16 v[74:75], v13 offset:24576
    v_mfma_f32_16x16x32_bf16 v[176:179], v[112:115], v[104:107], v[176:179]
    ds_read_b64_tr_b16 v[76:77], v14 offset:24576
    v_mfma_f32_16x16x32_bf16 v[180:183], v[116:119], v[104:107], v[180:183]
    ds_read_b64_tr_b16 v[78:79], v15 offset:24576
    v_mfma_f32_16x16x32_bf16 v[128:131], v[120:123], v[84:87], v[128:131]
    ds_read_b128 v[32:35], v6 offset:0
    v_mfma_f32_16x16x32_bf16 v[132:135], v[124:127], v[84:87], v[132:135]
    ds_read_b128 v[36:39], v6 offset:1024
    v_mfma_f32_16x16x32_bf16 v[144:147], v[120:123], v[92:95], v[144:147]
    ds_read_b128 v[40:43], v6 offset:2048
    v_mfma_f32_16x16x32_bf16 v[148:151], v[124:127], v[92:95], v[148:151]
    ds_read_b128 v[44:47], v6 offset:3072
    v_mfma_f32_16x16x32_bf16 v[160:163], v[120:123], v[100:103], v[160:163]
    ds_read_b128 v[48:51], v6 offset:4096
    v_mfma_f32_16x16x32_bf16 v[164:167], v[124:127], v[100:103], v[164:167]
    ds_read_b128 v[52:55], v6 offset:5120
    v_mfma_f32_16x16x32_bf16 v[176:179], v[120:123], v[108:111], v[176:179]
    ds_read_b128 v[56:59], v6 offset:6144
    v_mfma_f32_16x16x32_bf16 v[180:183], v[124:127], v[108:111], v[180:183]
    ds_read_b128 v[60:63], v6 offset:7168
    s_waitcnt lgkmcnt(0)
    s_waitcnt vmcnt(8)
    s_barrier
    s_add_u32 m0, s21, 65536
    s_nop 0
    buffer_load_dwordx4 v1, s[4:7], s16 offen sc1 lds
    s_add_u32 s16, s16, s62
    s_add_u32 m0, s21, 66560
    s_nop 0
    buffer_load_dwordx4 v1, s[4:7], s17 offen sc1 lds
    s_add_u32 s17, s17, s62
    s_add_u32 m0, s22, 65536
    s_nop 0
    buffer_load_dwordx4 v2, s[8:11], s18 offen lds
    s_add_u32 s18, s18, s20
    s_add_u32 m0, s22, 73728
    s_nop 0
    buffer_load_dwordx4 v2, s[12:15], s19 offen lds
    s_add_u32 s19, s19, s20
    v_mfma_f32_16x16x32_bf16 v[128:131], v[64:67], v[32:35], v[128:131]
    ds_read_b64_tr_b16 v[112:113], v12 offset:49152
    v_mfma_f32_16x16x32_bf16 v[132:135], v[68:71], v[32:35], v[132:135]
    ds_read_b64_tr_b16 v[114:115], v13 offset:49152
    v_mfma_f32_16x16x32_bf16 v[144:147], v[64:67], v[40:43], v[144:147]
    ds_read_b64_tr_b16 v[116:117], v14 offset:49152
    v_mfma_f32_16x16x32_bf16 v[148:151], v[68:71], v[40:43], v[148:151]
    ds_read_b64_tr_b16 v[118:119], v15 offset:49152
    v_mfma_f32_16x16x32_bf16 v[160:163], v[64:67], v[48:51], v[160:163]
    ds_read_b64_tr_b16 v[120:121], v12 offset:57344
    v_mfma_f32_16x16x32_bf16 v[164:167], v[68:71], v[48:51], v[164:167]
    ds_read_b64_tr_b16 v[122:123], v13 offset:57344
    v_mfma_f32_16x16x32_bf16 v[176:179], v[64:67], v[56:59], v[176:179]
    ds_read_b64_tr_b16 v[124:125], v14 offset:57344
    v_mfma_f32_16x16x32_bf16 v[180:183], v[68:71], v[56:59], v[180:183]
    ds_read_b64_tr_b16 v[126:127], v15 offset:57344
    v_mfma_f32_16x16x32_bf16 v[128:131], v[72:75], v[36:39], v[128:131]
    ds_read_b128 v[80:83], v6 offset:32768
    v_mfma_f32_16x16x32_bf16 v[132:135], v[76:79], v[36:39], v[132:135]
    ds_read_b128 v[84:87], v6 offset:33792
    v_mfma_f32_16x16x32_bf16 v[144:147], v[72:75], v[44:47], v[144:147]
    ds_read_b128 v[88:91], v6 offset:34816
    v_mfma_f32_16x16x32_bf16 v[148:151], v[76:79], v[44:47], v[148:151]
    ds_read_b128 v[92:95], v6 offset:35840
    v_mfma_f32_16x16x32_bf16 v[160:163], v[72:75], v[52:55], v[160:163]
    ds_read_b128 v[96:99], v6 offset:36864
    v_mfma_f32_16x16x32_bf16 v[164:167], v[76:79], v[52:55], v[164:167]
    ds_read_b128 v[100:103], v6 offset:37888
    v_mfma_f32_16x16x32_bf16 v[176:179], v[72:75], v[60:63], v[176:179]
    ds_read_b128 v[104:107], v6 offset:38912
    v_mfma_f32_16x16x32_bf16 v[180:183], v[76:79], v[60:63], v[180:183]
    ds_read_b128 v[108:111], v6 offset:39936
    s_waitcnt lgkmcnt(0)
    s_waitcnt vmcnt(8)
    s_barrier
    s_add_u32 m0, s21, 98304
    s_nop 0
    buffer_load_dwordx4 v1, s[4:7], s16 offen sc1 lds
    s_add_u32 s16, s16, s62
    s_add_u32 m0, s21, 99328
    s_nop 0
    buffer_load_dwordx4 v1, s[4:7], s17 offen sc1 lds
    s_add_u32 s17, s17, s62
    s_add_u32 m0, s22, 98304
    s_nop 0
    buffer_load_dwordx4 v2, s[8:11], s18 offen lds
    s_add_u32 s18, s18, s20
    s_add_u32 m0, s22, 106496
    s_nop 0
    buffer_load_dwordx4 v2, s[12:15], s19 offen lds
    s_add_u32 s19, s19, s20
    v_mfma_f32_16x16x32_bf16 v[128:131], v[112:115], v[80:83], v[128:131]
    ds_read_b64_tr_b16 v[64:65], v8 offset:16384
    v_mfma_f32_16x16x32_bf16 v[132:135], v[116:119], v[80:83], v[132:135]
    ds_read_b64_tr_b16 v[66:67], v9 offset:16384
    v_mfma_f32_16x16x32_bf16 v[144:147], v[112:115], v[88:91], v[144:147]
    ds_read_b64_tr_b16 v[68:69], v10 offset:16384
    v_mfma_f32_16x16x32_bf16 v[148:151], v[116:119], v[88:91], v[148:151]
    ds_read_b64_tr_b16 v[70:71], v11 offset:16384
    v_mfma_f32_16x16x32_bf16 v[160:163], v[112:115], v[96:99], v[160:163]
    ds_read_b64_tr_b16 v[72:73], v8 offset:24576
    v_mfma_f32_16x16x32_bf16 v[164:167], v[116:119], v[96:99], v[164:167]
    ds_read_b64_tr_b16 v[74:75], v9 offset:24576
    v_mfma_f32_16x16x32_bf16 v[176:179], v[112:115], v[104:107], v[176:179]
    ds_read_b64_tr_b16 v[76:77], v10 offset:24576
    v_mfma_f32_16x16x32_bf16 v[180:183], v[116:119], v[104:107], v[180:183]
    ds_read_b64_tr_b16 v[78:79], v11 offset:24576
    v_mfma_f32_16x16x32_bf16 v[128:131], v[120:123], v[84:87], v[128:131]
    ds_read_b128 v[32:35], v5 offset:0
    v_mfma_f32_16x16x32_bf16 v[132:135], v[124:127], v[84:87], v[132:135]
    ds_read_b128 v[36:39], v5 offset:1024
    v_mfma_f32_16x16x32_bf16 v[144:147], v[120:123], v[92:95], v[144:147]
    ds_read_b128 v[40:43], v5 offset:2048
    v_mfma_f32_16x16x32_bf16 v[148:151], v[124:127], v[92:95], v[148:151]
    ds_read_b128 v[44:47], v5 offset:3072
    v_mfma_f32_16x16x32_bf16 v[160:163], v[120:123], v[100:103], v[160:163]
    ds_read_b128 v[48:51], v5 offset:4096
    v_mfma_f32_16x16x32_bf16 v[164:167], v[124:127], v[100:103], v[164:167]
    ds_read_b128 v[52:55], v5 offset:5120
    v_mfma_f32_16x16x32_bf16 v[176:179], v[120:123], v[108:111], v[176:179]
    ds_read_b128 v[56:59], v5 offset:6144
    v_mfma_f32_16x16x32_bf16 v[180:183], v[124:127], v[108:111], v[180:183]
    ds_read_b128 v[60:63], v5 offset:7168
    s_waitcnt lgkmcnt(0)
w_loop_chkH:
    s_sub_u32 s23, s23, 1
w_loopH:
    s_cmp_gt_u32 s23, 3
    s_cbranch_scc1 w_bodyH
    s_cmp_lg_u32 s23, 3
    s_cbranch_scc1 w_l2H
    s_cmp_lg_u32 s3, 0
    s_cbranch_scc1 clm_8
    v_mov_b32 v26, 1
    s_mov_b64 exec, 1
    buffer_atomic_add v26, off, s[64:67], s71 sc0 sc1
    s_mov_b64 exec, -1
clm_8:
    s_branch w_bodyH
w_l2H:
    s_cmp_lg_u32 s23, 2
    s_cbranch_scc1 w_l1H
    s_cmp_lg_u32 s3, 0
    s_cbranch_scc1 pub_9
    v_mov_b32 v20, 131136
    s_mov_b64 exec, 1
    ds_write_b32 v20, v26
    s_mov_b64 exec, -1
    s_waitcnt lgkmcnt(0)
pub_9:
    s_branch w_bodyH
w_l1H:
    s_waitcnt vmcnt(8)
    buffer_load_dword v22, off, s[64:67], 0 sc1
    v_readfirstlane_b32 s30, v16
    s_cmp_ge_u32 s30, s45
    s_cselect_b32 s30, 0, 1
    s_or_b32 s30, s30, s70
    s_cmp_eq_u32 s32, 4
    s_cselect_b32 s30, 1, s30
    s_sub_u32 s57, s32, 1
    s_cmp_ge_u32 s57, 4
    s_cselect_b32 s30, 1, s30
    v_mov_b32 v20, s30
    ds_write_b32 v7, v20
    s_cbranch_scc1 w_bodyH
    s_load_dwordx2 s[8:9], s[0:1], s33
    s_load_dwordx2 s[12:13], s[0:1], s34
    s_mov_b32 s10, s38
    s_mov_b32 s14, s38
    s_cmp_eq_u32 s32, 4
    s_cselect_b32 s31, 0, 1
    s_lshl_b32 s30, s3, s31
    s_mul_i32 s30, s30, s40
    s_add_u32 s16, s39, s30
    s_cmp_eq_u32 s32, 4
    s_cselect_b32 s30, 1024, s40
    s_cselect_b32 s31, 6, 5
    s_lshl_b32 s62, 32, s31
    s_add_u32 s17, s16, s30
    s_lshl_b32 s30, s3, 2
    s_mul_i32 s30, s30, s35
    s_add_u32 s18, s36, s30
    s_add_u32 s19, s37, s30
    s_lshl_b32 s20, s35, s31
    v_mul_u32_u24 v2, s35, v4
    v_add_u32 v2, v2, v3
    s_waitcnt lgkmcnt(0)
w_bodyH:
    s_waitcnt vmcnt(8)
    s_barrier
    s_cmp_lg_u32 s23, 2
    s_cbranch_scc1 w_nfH
    v_mov_b32 v20, 131136
    ds_read_b32 v20, v20
    s_waitcnt lgkmcnt(0)
    v_readfirstlane_b32 s59, v20
    s_add_u32 s59, s59, 32
    s_min_u32 s59, s59, 319
    s_lshl_b32 s57, s59, 6
    s_load_dwordx16 s[32:47], s[24:25], s57
w_nfH:
    s_add_u32 m0, s21, 0
    s_nop 0
    buffer_load_dwordx4 v1, s[4:7], s16 offen sc1 lds
    s_add_u32 s16, s16, s62
    s_add_u32 m0, s21, 1024
    s_nop 0
    buffer_load_dwordx4 v1, s[4:7], s17 offen sc1 lds
    s_add_u32 s17, s17, s62
    s_add_u32 m0, s22, 0
    s_nop 0
    buffer_load_dwordx4 v2, s[8:11], s18 offen lds
    s_add_u32 s18, s18, s20
    s_add_u32 m0, s22, 8192
    s_nop 0
    buffer_load_dwordx4 v2, s[12:15], s19 offen lds
    s_add_u32 s19, s19, s20
    v_mfma_f32_16x16x32_bf16 v[128:131], v[64:67], v[32:35], v[128:131]
    ds_read_b64_tr_b16 v[112:113], v8 offset:49152
    v_mfma_f32_16x16x32_bf16 v[132:135], v[68:71], v[32:35], v[132:135]
    ds_read_b64_tr_b16 v[114:115], v9 offset:49152
    v_mfma_f32_16x16x32_bf16 v[144:147], v[64:67], v[40:43], v[144:147]
    ds_read_b64_tr_b16 v[116:117], v10 offset:49152
    v_mfma_f32_16x16x32_bf16 v[148:151], v[68:71], v[40:43], v[148:151]
    ds_read_b64_tr_b16 v[118:119], v11 offset:49152
    v_mfma_f32_16x16x32_bf16 v[160:163], v[64:67], v[48:51], v[160:163]
    ds_read_b64_tr_b16 v[120:121], v8 offset:57344
    v_mfma_f32_16x16x32_bf16 v[164:167], v[68:71], v[48:51], v[164:167]
    ds_read_b64_tr_b16 v[122:123], v9 offset:57344
    v_mfma_f32_16x16x32_bf16 v[176:179], v[64:67], v[56:59], v[176:179]
    ds_read_b64_tr_b16 v[124:125], v10 offset:57344
    v_mfma_f32_16x16x32_bf16 v[180:183], v[68:71], v[56:59], v[180:183]
    ds_read_b64_tr_b16 v[126:127], v11 offset:57344
    v_mfma_f32_16x16x32_bf16 v[128:131], v[72:75], v[36:39], v[128:131]
    ds_read_b128 v[80:83], v5 offset:32768
    v_mfma_f32_16x16x32_bf16 v[132:135], v[76:79], v[36:39], v[132:135]
    ds_read_b128 v[84:87], v5 offset:33792
    v_mfma_f32_16x16x32_bf16 v[144:147], v[72:75], v[44:47], v[144:147]
    ds_read_b128 v[88:91], v5 offset:34816
    v_mfma_f32_16x16x32_bf16 v[148:151], v[76:79], v[44:47], v[148:151]
    ds_read_b128 v[92:95], v5 offset:35840
    v_mfma_f32_16x16x32_bf16 v[160:163], v[72:75], v[52:55], v[160:163]
    ds_read_b128 v[96:99], v5 offset:36864
    v_mfma_f32_16x16x32_bf16 v[164:167], v[76:79], v[52:55], v[164:167]
    ds_read_b128 v[100:103], v5 offset:37888
    v_mfma_f32_16x16x32_bf16 v[176:179], v[72:75], v[60:63], v[176:179]
    ds_read_b128 v[104:107], v5 offset:38912
    v_mfma_f32_16x16x32_bf16 v[180:183], v[76:79], v[60:63], v[180:183]
    ds_read_b128 v[108:111], v5 offset:39936
    s_waitcnt lgkmcnt(0)
    s_waitcnt vmcnt(8)
    s_barrier
    buffer_load_dword v16, v17, s[4:7], s44 offen sc1
    s_add_u32 m0, s21, 32768
    s_nop 0
    buffer_load_dwordx4 v1, s[4:7], s16 offen sc1 lds
    s_add_u32 s16, s16, s62
    s_add_u32 m0, s21, 33792
    s_nop 0
    buffer_load_dwordx4 v1, s[4:7], s17 offen sc1 lds
    s_add_u32 s17, s17, s62
    s_add_u32 m0, s22, 32768
    s_nop 0
    buffer_load_dwordx4 v2, s[8:11], s18 offen lds
    s_add_u32 s18, s18, s20
    s_add_u32 m0, s22, 40960
    s_nop 0
    buffer_load_dwordx4 v2, s[12:15], s19 offen lds
    s_add_u32 s19, s19, s20
    v_mfma_f32_16x16x32_bf16 v[128:131], v[112:115], v[80:83], v[128:131]
    ds_read_b64_tr_b16 v[64:65], v12 offset:16384
    v_mfma_f32_16x16x32_bf16 v[132:135], v[116:119], v[80:83], v[132:135]
    ds_read_b64_tr_b16 v[66:67], v13 offset:16384
    v_mfma_f32_16x16x32_bf16 v[144:147], v[112:115], v[88:91], v[144:147]
    ds_read_b64_tr_b16 v[68:69], v14 offset:16384
    v_mfma_f32_16x16x32_bf16 v[148:151], v[116:119], v[88:91], v[148:151]
    ds_read_b64_tr_b16 v[70:71], v15 offset:16384
    v_mfma_f32_16x16x32_bf16 v[160:163], v[112:115], v[96:99], v[160:163]
    ds_read_b64_tr_b16 v[72:73], v12 offset:24576
    v_mfma_f32_16x16x32_bf16 v[164:167], v[116:119], v[96:99], v[164:167]
    ds_read_b64_tr_b16 v[74:75], v13 offset:24576
    v_mfma_f32_16x16x32_bf16 v[176:179], v[112:115], v[104:107], v[176:179]
    ds_read_b64_tr_b16 v[76:77], v14 offset:24576
    v_mfma_f32_16x16x32_bf16 v[180:183], v[116:119], v[104:107], v[180:183]
    ds_read_b64_tr_b16 v[78:79], v15 offset:24576
    v_mfma_f32_16x16x32_bf16 v[128:131], v[120:123], v[84:87], v[128:131]
    ds_read_b128 v[32:35], v6 offset:0
    v_mfma_f32_16x16x32_bf16 v[132:135], v[124:127], v[84:87], v[132:135]
    ds_read_b128 v[36:39], v6 offset:1024
    v_mfma_f32_16x16x32_bf16 v[144:147], v[120:123], v[92:95], v[144:147]
    ds_read_b128 v[40:43], v6 offset:2048
    v_mfma_f32_16x16x32_bf16 v[148:151], v[124:127], v[92:95], v[148:151]
    ds_read_b128 v[44:47], v6 offset:3072
    v_mfma_f32_16x16x32_bf16 v[160:163], v[120:123], v[100:103], v[160:163]
    ds_read_b128 v[48:51], v6 offset:4096
    v_mfma_f32_16x16x32_bf16 v[164:167], v[124:127], v[100:103], v[164:167]
    ds_read_b128 v[52:55], v6 offset:5120
    v_mfma_f32_16x16x32_bf16 v[176:179], v[120:123], v[108:111], v[176:179]
    ds_read_b128 v[56:59], v6 offset:6144
    v_mfma_f32_16x16x32_bf16 v[180:183], v[124:127], v[108:111], v[180:183]
    ds_read_b128 v[60:63], v6 offset:7168
    s_waitcnt lgkmcnt(0)
    s_waitcnt vmcnt(8)
    s_barrier
    s_add_u32 m0, s21, 65536
    s_nop 0
    buffer_load_dwordx4 v1, s[4:7], s16 offen sc1 lds
    s_add_u32 s16, s16, s62
    s_add_u32 m0, s21, 66560
    s_nop 0
    buffer_load_dwordx4 v1, s[4:7], s17 offen sc1 lds
    s_add_u32 s17, s17, s62
    s_add_u32 m0, s22, 65536
    s_nop 0
    buffer_load_dwordx4 v2, s[8:11], s18 offen lds
    s_add_u32 s18, s18, s20
    s_add_u32 m0, s22, 73728
    s_nop 0
    buffer_load_dwordx4 v2, s[12:15], s19 offen lds
    s_add_u32 s19, s19, s20
    v_mfma_f32_16x16x32_bf16 v[128:131], v[64:67], v[32:35], v[128:131]
    ds_read_b64_tr_b16 v[112:113], v12 offset:49152
    v_mfma_f32_16x16x32_bf16 v[132:135], v[68:71], v[32:35], v[132:135]
    ds_read_b64_tr_b16 v[114:115], v13 offset:49152
    v_mfma_f32_16x16x32_bf16 v[144:147], v[64:67], v[40:43], v[144:147]
    ds_read_b64_tr_b16 v[116:117], v14 offset:49152
    v_mfma_f32_16x16x32_bf16 v[148:151], v[68:71], v[40:43], v[148:151]
    ds_read_b64_tr_b16 v[118:119], v15 offset:49152
    v_mfma_f32_16x16x32_bf16 v[160:163], v[64:67], v[48:51], v[160:163]
    ds_read_b64_tr_b16 v[120:121], v12 offset:57344
    v_mfma_f32_16x16x32_bf16 v[164:167], v[68:71], v[48:51], v[164:167]
    ds_read_b64_tr_b16 v[122:123], v13 offset:57344
    v_mfma_f32_16x16x32_bf16 v[176:179], v[64:67], v[56:59], v[176:179]
    ds_read_b64_tr_b16 v[124:125], v14 offset:57344
    v_mfma_f32_16x16x32_bf16 v[180:183], v[68:71], v[56:59], v[180:183]
    ds_read_b64_tr_b16 v[126:127], v15 offset:57344
    v_mfma_f32_16x16x32_bf16 v[128:131], v[72:75], v[36:39], v[128:131]
    ds_read_b128 v[80:83], v6 offset:32768
    v_mfma_f32_16x16x32_bf16 v[132:135], v[76:79], v[36:39], v[132:135]
    ds_read_b128 v[84:87], v6 offset:33792
    v_mfma_f32_16x16x32_bf16 v[144:147], v[72:75], v[44:47], v[144:147]
    ds_read_b128 v[88:91], v6 offset:34816
    v_mfma_f32_16x16x32_bf16 v[148:151], v[76:79], v[44:47], v[148:151]
    ds_read_b128 v[92:95], v6 offset:35840
    v_mfma_f32_16x16x32_bf16 v[160:163], v[72:75], v[52:55], v[160:163]
    ds_read_b128 v[96:99], v6 offset:36864
    v_mfma_f32_16x16x32_bf16 v[164:167], v[76:79], v[52:55], v[164:167]
    ds_read_b128 v[100:103], v6 offset:37888
    v_mfma_f32_16x16x32_bf16 v[176:179], v[72:75], v[60:63], v[176:179]
    ds_read_b128 v[104:107], v6 offset:38912
    v_mfma_f32_16x16x32_bf16 v[180:183], v[76:79], v[60:63], v[180:183]
    ds_read_b128 v[108:111], v6 offset:39936
    s_waitcnt lgkmcnt(0)
    s_waitcnt vmcnt(8)
    s_barrier
    s_add_u32 m0, s21, 98304
    s_nop 0
    buffer_load_dwordx4 v1, s[4:7], s16 offen sc1 lds
    s_add_u32 s16, s16, s62
    s_add_u32 m0, s21, 99328
    s_nop 0
    buffer_load_dwordx4 v1, s[4:7], s17 offen sc1 lds
    s_add_u32 s17, s17, s62
    s_add_u32 m0, s22, 98304
    s_nop 0
    buffer_load_dwordx4 v2, s[8:11], s18 offen lds
    s_add_u32 s18, s18, s20
    s_add_u32 m0, s22, 106496
    s_nop 0
    buffer_load_dwordx4 v2, s[12:15], s19 offen lds
    s_add_u32 s19, s19, s20
    v_mfma_f32_16x16x32_bf16 v[128:131], v[112:115], v[80:83], v[128:131]
    ds_read_b64_tr_b16 v[64:65], v8 offset:16384
    v_mfma_f32_16x16x32_bf16 v[132:135], v[116:119], v[80:83], v[132:135]
    ds_read_b64_tr_b16 v[66:67], v9 offset:16384
    v_mfma_f32_16x16x32_bf16 v[144:147], v[112:115], v[88:91], v[144:147]
    ds_read_b64_tr_b16 v[68:69], v10 offset:16384
    v_mfma_f32_16x16x32_bf16 v[148:151], v[116:119], v[88:91], v[148:151]
    ds_read_b64_tr_b16 v[70:71], v11 offset:16384
    v_mfma_f32_16x16x32_bf16 v[160:163], v[112:115], v[96:99], v[160:163]
    ds_read_b64_tr_b16 v[72:73], v8 offset:24576
    v_mfma_f32_16x16x32_bf16 v[164:167], v[116:119], v[96:99], v[164:167]
    ds_read_b64_tr_b16 v[74:75], v9 offset:24576
    v_mfma_f32_16x16x32_bf16 v[176:179], v[112:115], v[104:107], v[176:179]
    ds_read_b64_tr_b16 v[76:77], v10 offset:24576
    v_mfma_f32_16x16x32_bf16 v[180:183], v[116:119], v[104:107], v[180:183]
    ds_read_b64_tr_b16 v[78:79], v11 offset:24576
    v_mfma_f32_16x16x32_bf16 v[128:131], v[120:123], v[84:87], v[128:131]
    ds_read_b128 v[32:35], v5 offset:0
    v_mfma_f32_16x16x32_bf16 v[132:135], v[124:127], v[84:87], v[132:135]
    ds_read_b128 v[36:39], v5 offset:1024
    v_mfma_f32_16x16x32_bf16 v[144:147], v[120:123], v[92:95], v[144:147]
    ds_read_b128 v[40:43], v5 offset:2048
    v_mfma_f32_16x16x32_bf16 v[148:151], v[124:127], v[92:95], v[148:151]
    ds_read_b128 v[44:47], v5 offset:3072
    v_mfma_f32_16x16x32_bf16 v[160:163], v[120:123], v[100:103], v[160:163]
    ds_read_b128 v[48:51], v5 offset:4096
    v_mfma_f32_16x16x32_bf16 v[164:167], v[124:127], v[100:103], v[164:167]
    ds_read_b128 v[52:55], v5 offset:5120
    v_mfma_f32_16x16x32_bf16 v[176:179], v[120:123], v[108:111], v[176:179]
    ds_read_b128 v[56:59], v5 offset:6144
    v_mfma_f32_16x16x32_bf16 v[180:183], v[124:127], v[108:111], v[180:183]
    ds_read_b128 v[60:63], v5 offset:7168
    s_waitcnt lgkmcnt(0)
    s_sub_u32 s23, s23, 1
    s_cmp_lg_u32 s23, 0
    s_cbranch_scc1 w_loopH
    v_mov_b32 v20, 131072
    ds_read_b128 v[24:27], v20
    ds_read_b128 v[28:31], v20 offset:16
    s_lshl_b32 s30, s27, 10
    s_add_u32 s30, s30, s49
    s_nop 7
    v_cvt_pk_bf16_f32 v80, v128, v129
    v_cvt_pk_bf16_f32 v81, v130, v131
    v_cvt_pk_bf16_f32 v82, v132, v133
    v_cvt_pk_bf16_f32 v83, v134, v135
    buffer_store_dwordx4 v[80:83], v1, s[4:7], s30 offen sc1
    s_add_u32 s30, s30, s50
    v_cvt_pk_bf16_f32 v84, v144, v145
    v_cvt_pk_bf16_f32 v85, v146, v147
    v_cvt_pk_bf16_f32 v86, v148, v149
    v_cvt_pk_bf16_f32 v87, v150, v151
    buffer_store_dwordx4 v[84:87], v1, s[4:7], s30 offen sc1
    s_add_u32 s30, s30, s50
    v_cvt_pk_bf16_f32 v88, v160, v161
    v_cvt_pk_bf16_f32 v89, v162, v163
    v_cvt_pk_bf16_f32 v90, v164, v165
    v_cvt_pk_bf16_f32 v91, v166, v167
    buffer_store_dwordx4 v[88:91], v1, s[4:7], s30 offen sc1
    s_add_u32 s30, s30, s50
    v_cvt_pk_bf16_f32 v92, v176, v177
    v_cvt_pk_bf16_f32 v93, v178, v179
    v_cvt_pk_bf16_f32 v94, v180, v181
    v_cvt_pk_bf16_f32 v95, v182, v183
    buffer_store_dwordx4 v[92:95], v1, s[4:7], s30 offen sc1
    s_add_u32 s30, s30, s50
    s_waitcnt lgkmcnt(0)
    v_or3_b32 v24, v24, v25, v26
    v_or3_b32 v28, v28, v29, v30
    v_or3_b32 v24, v24, v27, v31
    v_or_b32 v24, v24, v28
    s_mov_b32 s28, s51
    v_readfirstlane_b32 s30, v24
    s_cmp_lg_u32 s30, 0
    s_cbranch_scc1 w_drain
    s_mov_b32 s48, s32
    s_cmp_eq_u32 s32, 4
    s_cselect_b32 s30, 2, 3
    s_lshl_b32 s30, s26, s30
    s_mul_i32 s30, s30, s43
    s_add_u32 s49, s42, s30
    s_mov_b32 s50, s43
    s_mov_b32 s51, s46
    s_mov_b32 s23, s41
    s_mov_b32 s53, s41
    s_branch w_first4
w_drain:
    s_waitcnt vmcnt(0)
    s_barrier
    s_cmp_eq_u32 s70, 0
    s_cbranch_scc1 drw_ok
    s_mov_b32 s70, 0
    s_cmp_lg_u32 s3, 0
    s_cbranch_scc1 drw_ok
    v_readfirstlane_b32 s68, v22
    s_cmp_ge_u32 s68, 128
    s_cbranch_scc1 drw_ok
    s_mov_b32 s69, 65536
drw:
    buffer_load_dword v20, off, s[64:67], 0 offset:0 sc1
    s_waitcnt vmcnt(0)
    v_readfirstlane_b32 s68, v20
    s_cmp_ge_u32 s68, 128
    s_cbranch_scc1 drw_ok
    s_sleep 8
    s_sub_u32 s69, s69, 1
    s_cbranch_scc0 drw
drw_ok:
    s_cmp_eq_u32 s28, 0
    s_cbranch_scc1 sig_10
    s_cmp_lg_u32 s3, 0
    s_cbranch_scc1 sig_10
    s_and_b32 s57, s28, 3
    v_mov_b32 v24, s57
    s_bfe_u32 s57, s28, 0x20002
    v_mov_b32 v25, s57
    s_andn2_b32 s28, s28, 15
    s_mov_b64 exec, 1
    buffer_atomic_add_x2 v[24:25], v17, s[4:7], s28 offen sc1
    s_mov_b64 exec, -1
sig_10:
    s_mov_b32 s28, 0
    s_cmp_ge_u32 s53, 4
    s_cbranch_scc1 w_cold
    s_cmp_lg_u32 s3, 0
    s_cbranch_scc1 clm_11
    v_mov_b32 v26, 1
    s_mov_b64 exec, 1
    buffer_atomic_add v26, off, s[64:67], s71 sc0 sc1
    s_mov_b64 exec, -1
clm_11:
    s_waitcnt vmcnt(0)
    s_cmp_lg_u32 s3, 0
    s_cbranch_scc1 pub_12
    v_mov_b32 v20, 131136
    s_mov_b64 exec, 1
    ds_write_b32 v20, v26
    s_mov_b64 exec, -1
    s_waitcnt lgkmcnt(0)
pub_12:
    s_barrier
    v_mov_b32 v20, 131136
    ds_read_b32 v20, v20
    s_waitcnt lgkmcnt(0)
    v_readfirstlane_b32 s59, v20
    s_add_u32 s59, s59, 32
    s_min_u32 s59, s59, 319
    s_lshl_b32 s57, s59, 6
    s_load_dwordx16 s[32:47], s[24:25], s57
    s_waitcnt lgkmcnt(0)
    s_barrier
    s_branch w_cold
w_att:
    s_cmp_lg_u32 s3, 0
    s_cbranch_scc1 w_att_go
    s_mov_b32 s31, 0x40000
w_att_w:
    buffer_load_dwordx2 v[20:21], off, s[4:7], s33 sc1
    s_waitcnt vmcnt(0)
    v_add_u32 v20, v20, v21
    s_nop 0
    v_readfirstlane_b32 s30, v20
    s_cmp_ge_u32 s30, 8
    s_cbranch_scc1 w_att_go
    s_sleep 16
    s_sub_u32 s31, s31, 1
    s_cbranch_scc0 w_att_w
w_att_go:
    s_cmp_lg_u32 s3, 0
    s_cbranch_scc1 clm_13
    v_mov_b32 v250, 1
    s_mov_b64 exec, 1
    buffer_atomic_add v250, off, s[64:67], s71 sc0 sc1
    s_mov_b64 exec, -1
clm_13:
    s_barrier
    v_lshrrev_b32 v20, 4, v1
    v_lshrrev_b32 v21, 4, v20
    v_and_b32 v22, 15, v20
    v_lshlrev_b32 v23, 2, v21
    v_add_u32 v24, 0, v23
    v_cmp_gt_u32 s[72:73], v24, v22
    v_add_u32 v24, 1, v23
    v_cmp_gt_u32 s[74:75], v24, v22
    v_add_u32 v24, 2, v23
    v_cmp_gt_u32 s[76:77], v24, v22
    v_add_u32 v24, 3, v23
    v_cmp_gt_u32 s[78:79], v24, v22
    s_mul_i32 s83, s3, 10240
    v_and_b32 v22, 3, v20
    v_bfe_u32 v24, v20, 2, 2
    v_add_u32 v23, v23, v24
    v_lshl_add_u32 v23, v22, 4, v23
    v_lshlrev_b32 v23, 4, v23
    v_add_u32 v25, s83, v23
    v_and_b32 v24, 1, v24
    v_lshl_add_u32 v24, v21, 1, v24
    v_lshl_add_u32 v24, v22, 3, v24
    v_lshlrev_b32 v24, 4, v24
    v_add_u32 v26, s83, v24
    v_mov_b32 v22, 0xff61b1e6
    v_mov_b32 v136, 0
    v_mov_b32 v137, 0
    v_mov_b32 v220, 0
    v_mov_b32 v221, 0
    s_mov_b32 s80, 0x3e0293ee
    s_lshr_b32 s85, s3, 2
    s_add_u32 s85, s85, s39
    s_lshl_b32 s81, s85, 18
    s_and_b32 s85, s3, 3
    s_add_u32 s85, s85, s36
    s_lshl_b32 s82, s85, 13
    s_add_u32 s82, s82, s81
    s_add_u32 s82, s82, 192937984
    s_lshl_b32 s85, s85, 12
    s_add_u32 s81, s81, s85
    v_mov_b32 v28, 0x3f803f80
    v_mov_b32 v29, 0x3f803f80
    v_mov_b32 v30, 0x3f803f80
    v_mov_b32 v31, 0x3f803f80
    s_add_u32 s86, s82, 0
    buffer_load_dwordx4 v[120:123], v1, s[4:7], s86 offen offset:0 sc1
    buffer_load_dwordx4 v[124:127], v1, s[4:7], s86 offen offset:1024 sc1
    buffer_load_dwordx4 v[128:131], v1, s[4:7], s86 offen offset:2048 sc1
    buffer_load_dwordx4 v[132:135], v1, s[4:7], s86 offen offset:3072 sc1
    s_add_u32 s85, s81, 4194304
    buffer_load_dwordx4 v[56:59], v1, s[4:7], s85 offen offset:0 sc1
    buffer_load_dwordx4 v[60:63], v1, s[4:7], s85 offen offset:1024 sc1
    buffer_load_dwordx4 v[64:67], v1, s[4:7], s85 offen offset:2048 sc1
    buffer_load_dwordx4 v[68:71], v1, s[4:7], s85 offen offset:3072 sc1
    s_add_u32 s85, s81, 4325376
    buffer_load_dwordx4 v[72:75], v1, s[4:7], s85 offen offset:0 sc1
    buffer_load_dwordx4 v[76:79], v1, s[4:7], s85 offen offset:1024 sc1
    buffer_load_dwordx4 v[80:83], v1, s[4:7], s85 offen offset:2048 sc1
    buffer_load_dwordx4 v[84:87], v1, s[4:7], s85 offen offset:3072 sc1
    s_add_u32 s85, s81, 20971520
    buffer_load_dwordx4 v[88:91], v1, s[4:7], s85 offen offset:0 sc1
    buffer_load_dwordx4 v[92:95], v1, s[4:7], s85 offen offset:1024 sc1
    buffer_load_dwordx4 v[96:99], v1, s[4:7], s85 offen offset:2048 sc1
    buffer_load_dwordx4 v[100:103], v1, s[4:7], s85 offen offset:3072 sc1
    s_add_u32 s85, s81, 21102592
    buffer_load_dwordx4 v[104:107], v1, s[4:7], s85 offen offset:0 sc1
    buffer_load_dwordx4 v[108:111], v1, s[4:7], s85 offen offset:1024 sc1
    buffer_load_dwordx4 v[112:115], v1, s[4:7], s85 offen offset:2048 sc1
    buffer_load_dwordx4 v[116:119], v1, s[4:7], s85 offen offset:3072 sc1
    s_add_u32 m0, s83, 0
    s_add_u32 s85, s81, 37748736
    buffer_load_dwordx4 v1, s[4:7], s85 offen offset:0 sc1 lds
    buffer_load_dwordx4 v1, s[4:7], s85 offen offset:1024 sc1 lds
    buffer_load_dwordx4 v1, s[4:7], s85 offen offset:2048 sc1 lds
    buffer_load_dwordx4 v1, s[4:7], s85 offen offset:3072 sc1 lds
    s_add_u32 m0, s83, 4096
    s_add_u32 s85, s81, 37879808
    buffer_load_dwordx4 v1, s[4:7], s85 offen offset:0 sc1 lds
    buffer_load_dwordx4 v1, s[4:7], s85 offen offset:1024 sc1 lds
    buffer_load_dwordx4 v1, s[4:7], s85 offen offset:2048 sc1 lds
    buffer_load_dwordx4 v1, s[4:7], s85 offen offset:3072 sc1 lds
    s_add_u32 m0, s83, 8192
    s_add_u32 s85, s82, 4096
    buffer_load_dwordx4 v1, s[4:7], s85 offen offset:0 sc1 lds
    buffer_load_dwordx4 v1, s[4:7], s85 offen offset:1024 sc1 lds
    s_add_u32 s86, s82, 524288
    buffer_load_dwordx4 v[204:207], v1, s[4:7], s86 offen offset:0 sc1
    buffer_load_dwordx4 v[208:211], v1, s[4:7], s86 offen offset:1024 sc1
    buffer_load_dwordx4 v[212:215], v1, s[4:7], s86 offen offset:2048 sc1
    buffer_load_dwordx4 v[216:219], v1, s[4:7], s86 offen offset:3072 sc1
    s_add_u32 s85, s81, 4718592
    buffer_load_dwordx4 v[140:143], v1, s[4:7], s85 offen offset:0 sc1
    buffer_load_dwordx4 v[144:147], v1, s[4:7], s85 offen offset:1024 sc1
    buffer_load_dwordx4 v[148:151], v1, s[4:7], s85 offen offset:2048 sc1
    buffer_load_dwordx4 v[152:155], v1, s[4:7], s85 offen offset:3072 sc1
    s_add_u32 s85, s81, 4849664
    buffer_load_dwordx4 v[156:159], v1, s[4:7], s85 offen offset:0 sc1
    buffer_load_dwordx4 v[160:163], v1, s[4:7], s85 offen offset:1024 sc1
    buffer_load_dwordx4 v[164:167], v1, s[4:7], s85 offen offset:2048 sc1
    buffer_load_dwordx4 v[168:171], v1, s[4:7], s85 offen offset:3072 sc1
    s_add_u32 s85, s81, 21495808
    buffer_load_dwordx4 v[172:175], v1, s[4:7], s85 offen offset:0 sc1
    buffer_load_dwordx4 v[176:179], v1, s[4:7], s85 offen offset:1024 sc1
    buffer_load_dwordx4 v[180:183], v1, s[4:7], s85 offen offset:2048 sc1
    buffer_load_dwordx4 v[184:187], v1, s[4:7], s85 offen offset:3072 sc1
    s_add_u32 s85, s81, 21626880
    buffer_load_dwordx4 v[188:191], v1, s[4:7], s85 offen offset:0 sc1
    buffer_load_dwordx4 v[192:195], v1, s[4:7], s85 offen offset:1024 sc1
    buffer_load_dwordx4 v[196:199], v1, s[4:7], s85 offen offset:2048 sc1
    buffer_load_dwordx4 v[200:203], v1, s[4:7], s85 offen offset:3072 sc1
    s_add_u32 m0, s83, 81920
    s_add_u32 s85, s81, 38273024
    buffer_load_dwordx4 v1, s[4:7], s85 offen offset:0 sc1 lds
    buffer_load_dwordx4 v1, s[4:7], s85 offen offset:1024 sc1 lds
    buffer_load_dwordx4 v1, s[4:7], s85 offen offset:2048 sc1 lds
    buffer_load_dwordx4 v1, s[4:7], s85 offen offset:3072 sc1 lds
    s_add_u32 m0, s83, 86016
    s_add_u32 s85, s81, 38404096
    buffer_load_dwordx4 v1, s[4:7], s85 offen offset:0 sc1 lds
    buffer_load_dwordx4 v1, s[4:7], s85 offen offset:1024 sc1 lds
    buffer_load_dwordx4 v1, s[4:7], s85 offen offset:2048 sc1 lds
    buffer_load_dwordx4 v1, s[4:7], s85 offen offset:3072 sc1 lds
    s_add_u32 m0, s83, 90112
    s_add_u32 s85, s82, 528384
    buffer_load_dwordx4 v1, s[4:7], s85 offen offset:0 sc1 lds
    buffer_load_dwordx4 v1, s[4:7], s85 offen offset:1024 sc1 lds
    s_waitcnt vmcnt(40)
    v_mfma_f32_16x16x32_bf16 v[32:35], v[88:91], v[56:59], 0
    v_mfma_f32_16x16x32_bf16 v[40:43], v[120:123], v[56:59], 0
    v_mfma_f32_16x16x32_bf16 v[32:35], v[92:95], v[60:63], v[32:35]
    v_mfma_f32_16x16x32_bf16 v[40:43], v[124:127], v[60:63], v[40:43]
    v_mfma_f32_16x16x32_bf16 v[32:35], v[96:99], v[64:67], v[32:35]
    v_mfma_f32_16x16x32_bf16 v[40:43], v[128:131], v[64:67], v[40:43]
    v_mfma_f32_16x16x32_bf16 v[32:35], v[100:103], v[68:71], v[32:35]
    v_mfma_f32_16x16x32_bf16 v[40:43], v[132:135], v[68:71], v[40:43]
    v_mfma_f32_16x16x32_bf16 v[44:47], v[88:91], v[72:75], 0
    v_mfma_f32_16x16x32_bf16 v[48:51], v[104:107], v[72:75], 0
    v_mfma_f32_16x16x32_bf16 v[52:55], v[120:123], v[72:75], 0
    v_mfma_f32_16x16x32_bf16 v[44:47], v[92:95], v[76:79], v[44:47]
    v_mfma_f32_16x16x32_bf16 v[48:51], v[108:111], v[76:79], v[48:51]
    v_mfma_f32_16x16x32_bf16 v[52:55], v[124:127], v[76:79], v[52:55]
    v_mfma_f32_16x16x32_bf16 v[44:47], v[96:99], v[80:83], v[44:47]
    v_mfma_f32_16x16x32_bf16 v[48:51], v[112:115], v[80:83], v[48:51]
    v_mfma_f32_16x16x32_bf16 v[52:55], v[128:131], v[80:83], v[52:55]
    v_mfma_f32_16x16x32_bf16 v[44:47], v[100:103], v[84:87], v[44:47]
    v_mfma_f32_16x16x32_bf16 v[48:51], v[116:119], v[84:87], v[48:51]
    v_mfma_f32_16x16x32_bf16 v[52:55], v[132:135], v[84:87], v[52:55]
    v_cndmask_b32 v32, v32, v22, s[72:73]
    v_cndmask_b32 v33, v33, v22, s[74:75]
    v_cndmask_b32 v34, v34, v22, s[76:77]
    v_cndmask_b32 v35, v35, v22, s[78:79]
    v_max3_f32 v20, v32, v33, v34
    v_max3_f32 v21, v35, v40, v41
    v_max_f32 v20, v20, v21
    v_mov_b32 v21, v20
    s_nop 1
    v_permlane16_swap_b32 v21, v20
    v_max_f32 v20, v20, v21
    v_mov_b32 v21, v20
    s_nop 1
    v_permlane32_swap_b32 v21, v20
    v_max_f32 v20, v20, v21
    v_mul_f32 v20, s80, v20
    v_fma_f32 v32, v32, s80, -v20
    v_fma_f32 v33, v33, s80, -v20
    v_fma_f32 v34, v34, s80, -v20
    v_fma_f32 v35, v35, s80, -v20
    v_fma_f32 v40, v40, s80, -v20
    v_fma_f32 v41, v41, s80, -v20
    v_exp_f32 v32, v32
    v_exp_f32 v33, v33
    v_exp_f32 v34, v34
    v_exp_f32 v35, v35
    v_exp_f32 v40, v40
    v_exp_f32 v41, v41
    s_nop 0
    v_cvt_pk_bf16_f32 v32, v32, v33
    v_cvt_pk_bf16_f32 v33, v34, v35
    v_mov_b32 v34, 0
    v_mov_b32 v35, 0
    v_cvt_pk_bf16_f32 v40, v40, v41
    v_mov_b32 v41, 0
    v_mov_b32 v42, 0
    v_mov_b32 v43, 0
    s_nop 1
    s_waitcnt vmcnt(30)
    ds_read_b64_tr_b16 v[56:57], v25 offset:0
    ds_read_b64_tr_b16 v[58:59], v25 offset:4096
    ds_read_b64_tr_b16 v[120:121], v26 offset:8192
    ds_read_b64_tr_b16 v[60:61], v25 offset:8
    ds_read_b64_tr_b16 v[62:63], v25 offset:4104
    ds_read_b64_tr_b16 v[122:123], v26 offset:8200
    ds_read_b64_tr_b16 v[64:65], v25 offset:1024
    ds_read_b64_tr_b16 v[66:67], v25 offset:5120
    ds_read_b64_tr_b16 v[124:125], v26 offset:8704
    ds_read_b64_tr_b16 v[68:69], v25 offset:1032
    ds_read_b64_tr_b16 v[70:71], v25 offset:5128
    ds_read_b64_tr_b16 v[126:127], v26 offset:8712
    ds_read_b64_tr_b16 v[72:73], v25 offset:2048
    ds_read_b64_tr_b16 v[74:75], v25 offset:6144
    ds_read_b64_tr_b16 v[128:129], v26 offset:9216
    ds_read_b64_tr_b16 v[76:77], v25 offset:2056
    ds_read_b64_tr_b16 v[78:79], v25 offset:6152
    ds_read_b64_tr_b16 v[130:131], v26 offset:9224
    ds_read_b64_tr_b16 v[80:81], v25 offset:3072
    ds_read_b64_tr_b16 v[82:83], v25 offset:7168
    ds_read_b64_tr_b16 v[132:133], v26 offset:9728
    ds_read_b64_tr_b16 v[84:85], v25 offset:3080
    ds_read_b64_tr_b16 v[86:87], v25 offset:7176
    ds_read_b64_tr_b16 v[134:135], v26 offset:9736
    v_cndmask_b32 v48, v48, v22, s[72:73]
    v_cndmask_b32 v49, v49, v22, s[74:75]
    v_cndmask_b32 v50, v50, v22, s[76:77]
    v_cndmask_b32 v51, v51, v22, s[78:79]
    v_max3_f32 v20, v44, v45, v46
    v_max3_f32 v21, v47, v48, v49
    v_max3_f32 v20, v20, v50, v51
    v_max3_f32 v21, v21, v52, v53
    v_max_f32 v20, v20, v21
    v_mov_b32 v21, v20
    s_nop 1
    v_permlane16_swap_b32 v21, v20
    v_max_f32 v20, v20, v21
    v_mov_b32 v21, v20
    s_nop 1
    v_permlane32_swap_b32 v21, v20
    v_max_f32 v20, v20, v21
    v_mul_f32 v20, s80, v20
    v_fma_f32 v44, v44, s80, -v20
    v_fma_f32 v45, v45, s80, -v20
    v_fma_f32 v46, v46, s80, -v20
    v_fma_f32 v47, v47, s80, -v20
    v_fma_f32 v48, v48, s80, -v20
    v_fma_f32 v49, v49, s80, -v20
    v_fma_f32 v50, v50, s80, -v20
    v_fma_f32 v51, v51, s80, -v20
    v_fma_f32 v52, v52, s80, -v20
    v_fma_f32 v53, v53, s80, -v20
    v_exp_f32 v44, v44
    v_exp_f32 v45, v45
    v_exp_f32 v46, v46
    v_exp_f32 v47, v47
    v_exp_f32 v48, v48
    v_exp_f32 v49, v49
    v_exp_f32 v50, v50
    v_exp_f32 v51, v51
    v_exp_f32 v52, v52
    v_exp_f32 v53, v53
    s_nop 0
    v_cvt_pk_bf16_f32 v44, v44, v45
    v_cvt_pk_bf16_f32 v45, v46, v47
    v_cvt_pk_bf16_f32 v46, v48, v49
    v_cvt_pk_bf16_f32 v47, v50, v51
    v_cvt_pk_bf16_f32 v52, v52, v53
    v_mov_b32 v53, 0
    v_mov_b32 v54, 0
    v_mov_b32 v55, 0
    s_nop 1
    s_waitcnt lgkmcnt(0)
    v_mfma_f32_16x16x32_bf16 v[36:39], v[28:31], v[32:35], 0
    v_mfma_f32_16x16x32_bf16 v[36:39], v[28:31], v[40:43], v[36:39]
    v_mfma_f32_16x16x32_bf16 v[88:91], v[56:59], v[32:35], 0
    v_mfma_f32_16x16x32_bf16 v[88:91], v[120:123], v[40:43], v[88:91]
    v_mfma_f32_16x16x32_bf16 v[92:95], v[60:63], v[32:35], 0
    v_mfma_f32_16x16x32_bf16 v[92:95], v[122:125], v[40:43], v[92:95]
    v_mfma_f32_16x16x32_bf16 v[96:99], v[64:67], v[32:35], 0
    v_mfma_f32_16x16x32_bf16 v[96:99], v[124:127], v[40:43], v[96:99]
    v_mfma_f32_16x16x32_bf16 v[100:103], v[68:71], v[32:35], 0
    v_mfma_f32_16x16x32_bf16 v[100:103], v[126:129], v[40:43], v[100:103]
    v_mfma_f32_16x16x32_bf16 v[104:107], v[72:75], v[32:35], 0
    v_mfma_f32_16x16x32_bf16 v[104:107], v[128:131], v[40:43], v[104:107]
    v_mfma_f32_16x16x32_bf16 v[108:111], v[76:79], v[32:35], 0
    v_mfma_f32_16x16x32_bf16 v[108:111], v[130:133], v[40:43], v[108:111]
    v_mfma_f32_16x16x32_bf16 v[112:115], v[80:83], v[32:35], 0
    v_mfma_f32_16x16x32_bf16 v[112:115], v[132:135], v[40:43], v[112:115]
    v_mfma_f32_16x16x32_bf16 v[116:119], v[84:87], v[32:35], 0
    v_mfma_f32_16x16x32_bf16 v[116:119], v[134:137], v[40:43], v[116:119]
    v_rcp_f32 v23, v36
    s_add_u32 s85, s81, 176160768
    v_mul_f32 v88, v88, v23
    v_mul_f32 v89, v89, v23
    v_mul_f32 v90, v90, v23
    v_mul_f32 v91, v91, v23
    v_mul_f32 v92, v92, v23
    v_mul_f32 v93, v93, v23
    v_mul_f32 v94, v94, v23
    v_mul_f32 v95, v95, v23
    v_cvt_pk_bf16_f32 v224, v88, v89
    v_cvt_pk_bf16_f32 v225, v90, v91
    v_cvt_pk_bf16_f32 v226, v92, v93
    v_cvt_pk_bf16_f32 v227, v94, v95
    buffer_store_dwordx4 v[224:227], v1, s[4:7], s85 offen offset:0 sc1
    v_mul_f32 v96, v96, v23
    v_mul_f32 v97, v97, v23
    v_mul_f32 v98, v98, v23
    v_mul_f32 v99, v99, v23
    v_mul_f32 v100, v100, v23
    v_mul_f32 v101, v101, v23
    v_mul_f32 v102, v102, v23
    v_mul_f32 v103, v103, v23
    v_cvt_pk_bf16_f32 v228, v96, v97
    v_cvt_pk_bf16_f32 v229, v98, v99
    v_cvt_pk_bf16_f32 v230, v100, v101
    v_cvt_pk_bf16_f32 v231, v102, v103
    buffer_store_dwordx4 v[228:231], v1, s[4:7], s85 offen offset:1024 sc1
    v_mul_f32 v104, v104, v23
    v_mul_f32 v105, v105, v23
    v_mul_f32 v106, v106, v23
    v_mul_f32 v107, v107, v23
    v_mul_f32 v108, v108, v23
    v_mul_f32 v109, v109, v23
    v_mul_f32 v110, v110, v23
    v_mul_f32 v111, v111, v23
    v_cvt_pk_bf16_f32 v232, v104, v105
    v_cvt_pk_bf16_f32 v233, v106, v107
    v_cvt_pk_bf16_f32 v234, v108, v109
    v_cvt_pk_bf16_f32 v235, v110, v111
    buffer_store_dwordx4 v[232:235], v1, s[4:7], s85 offen offset:2048 sc1
    v_mul_f32 v112, v112, v23
    v_mul_f32 v113, v113, v23
    v_mul_f32 v114, v114, v23
    v_mul_f32 v115, v115, v23
    v_mul_f32 v116, v116, v23
    v_mul_f32 v117, v117, v23
    v_mul_f32 v118, v118, v23
    v_mul_f32 v119, v119, v23
    v_cvt_pk_bf16_f32 v236, v112, v113
    v_cvt_pk_bf16_f32 v237, v114, v115
    v_cvt_pk_bf16_f32 v238, v116, v117
    v_cvt_pk_bf16_f32 v239, v118, v119
    buffer_store_dwordx4 v[236:239], v1, s[4:7], s85 offen offset:3072 sc1
    v_mfma_f32_16x16x32_bf16 v[48:51], v[28:31], v[44:47], 0
    v_mfma_f32_16x16x32_bf16 v[48:51], v[28:31], v[52:55], v[48:51]
    v_mfma_f32_16x16x32_bf16 v[88:91], v[56:59], v[44:47], 0
    v_mfma_f32_16x16x32_bf16 v[88:91], v[120:123], v[52:55], v[88:91]
    v_mfma_f32_16x16x32_bf16 v[92:95], v[60:63], v[44:47], 0
    v_mfma_f32_16x16x32_bf16 v[92:95], v[122:125], v[52:55], v[92:95]
    v_mfma_f32_16x16x32_bf16 v[96:99], v[64:67], v[44:47], 0
    v_mfma_f32_16x16x32_bf16 v[96:99], v[124:127], v[52:55], v[96:99]
    v_mfma_f32_16x16x32_bf16 v[100:103], v[68:71], v[44:47], 0
    v_mfma_f32_16x16x32_bf16 v[100:103], v[126:129], v[52:55], v[100:103]
    v_mfma_f32_16x16x32_bf16 v[104:107], v[72:75], v[44:47], 0
    v_mfma_f32_16x16x32_bf16 v[104:107], v[128:131], v[52:55], v[104:107]
    v_mfma_f32_16x16x32_bf16 v[108:111], v[76:79], v[44:47], 0
    v_mfma_f32_16x16x32_bf16 v[108:111], v[130:133], v[52:55], v[108:111]
    v_mfma_f32_16x16x32_bf16 v[112:115], v[80:83], v[44:47], 0
    v_mfma_f32_16x16x32_bf16 v[112:115], v[132:135], v[52:55], v[112:115]
    v_mfma_f32_16x16x32_bf16 v[116:119], v[84:87], v[44:47], 0
    v_mfma_f32_16x16x32_bf16 v[116:119], v[134:137], v[52:55], v[116:119]
    v_rcp_f32 v23, v48
    s_add_u32 s85, s81, 176291840
    v_mul_f32 v88, v88, v23
    v_mul_f32 v89, v89, v23
    v_mul_f32 v90, v90, v23
    v_mul_f32 v91, v91, v23
    v_mul_f32 v92, v92, v23
    v_mul_f32 v93, v93, v23
    v_mul_f32 v94, v94, v23
    v_mul_f32 v95, v95, v23
    v_cvt_pk_bf16_f32 v224, v88, v89
    v_cvt_pk_bf16_f32 v225, v90, v91
    v_cvt_pk_bf16_f32 v226, v92, v93
    v_cvt_pk_bf16_f32 v227, v94, v95
    buffer_store_dwordx4 v[224:227], v1, s[4:7], s85 offen offset:0 sc1
    v_mul_f32 v96, v96, v23
    v_mul_f32 v97, v97, v23
    v_mul_f32 v98, v98, v23
    v_mul_f32 v99, v99, v23
    v_mul_f32 v100, v100, v23
    v_mul_f32 v101, v101, v23
    v_mul_f32 v102, v102, v23
    v_mul_f32 v103, v103, v23
    v_cvt_pk_bf16_f32 v228, v96, v97
    v_cvt_pk_bf16_f32 v229, v98, v99
    v_cvt_pk_bf16_f32 v230, v100, v101
    v_cvt_pk_bf16_f32 v231, v102, v103
    buffer_store_dwordx4 v[228:231], v1, s[4:7], s85 offen offset:1024 sc1
    v_mul_f32 v104, v104, v23
    v_mul_f32 v105, v105, v23
    v_mul_f32 v106, v106, v23
    v_mul_f32 v107, v107, v23
    v_mul_f32 v108, v108, v23
    v_mul_f32 v109, v109, v23
    v_mul_f32 v110, v110, v23
    v_mul_f32 v111, v111, v23
    v_cvt_pk_bf16_f32 v232, v104, v105
    v_cvt_pk_bf16_f32 v233, v106, v107
    v_cvt_pk_bf16_f32 v234, v108, v109
    v_cvt_pk_bf16_f32 v235, v110, v111
    buffer_store_dwordx4 v[232:235], v1, s[4:7], s85 offen offset:2048 sc1
    v_mul_f32 v112, v112, v23
    v_mul_f32 v113, v113, v23
    v_mul_f32 v114, v114, v23
    v_mul_f32 v115, v115, v23
    v_mul_f32 v116, v116, v23
    v_mul_f32 v117, v117, v23
    v_mul_f32 v118, v118, v23
    v_mul_f32 v119, v119, v23
    v_cvt_pk_bf16_f32 v236, v112, v113
    v_cvt_pk_bf16_f32 v237, v114, v115
    v_cvt_pk_bf16_f32 v238, v116, v117
    v_cvt_pk_bf16_f32 v239, v118, v119
    buffer_store_dwordx4 v[236:239], v1, s[4:7], s85 offen offset:3072 sc1
    s_waitcnt vmcnt(18)
    v_mfma_f32_16x16x32_bf16 v[32:35], v[172:175], v[140:143], 0
    v_mfma_f32_16x16x32_bf16 v[40:43], v[204:207], v[140:143], 0
    v_mfma_f32_16x16x32_bf16 v[32:35], v[176:179], v[144:147], v[32:35]
    v_mfma_f32_16x16x32_bf16 v[40:43], v[208:211], v[144:147], v[40:43]
    v_mfma_f32_16x16x32_bf16 v[32:35], v[180:183], v[148:151], v[32:35]
    v_mfma_f32_16x16x32_bf16 v[40:43], v[212:215], v[148:151], v[40:43]
    v_mfma_f32_16x16x32_bf16 v[32:35], v[184:187], v[152:155], v[32:35]
    v_mfma_f32_16x16x32_bf16 v[40:43], v[216:219], v[152:155], v[40:43]
    v_mfma_f32_16x16x32_bf16 v[44:47], v[172:175], v[156:159], 0
    v_mfma_f32_16x16x32_bf16 v[48:51], v[188:191], v[156:159], 0
    v_mfma_f32_16x16x32_bf16 v[52:55], v[204:207], v[156:159], 0
    v_mfma_f32_16x16x32_bf16 v[44:47], v[176:179], v[160:163], v[44:47]
    v_mfma_f32_16x16x32_bf16 v[48:51], v[192:195], v[160:163], v[48:51]
    v_mfma_f32_16x16x32_bf16 v[52:55], v[208:211], v[160:163], v[52:55]
    v_mfma_f32_16x16x32_bf16 v[44:47], v[180:183], v[164:167], v[44:47]
    v_mfma_f32_16x16x32_bf16 v[48:51], v[196:199], v[164:167], v[48:51]
    v_mfma_f32_16x16x32_bf16 v[52:55], v[212:215], v[164:167], v[52:55]
    v_mfma_f32_16x16x32_bf16 v[44:47], v[184:187], v[168:171], v[44:47]
    v_mfma_f32_16x16x32_bf16 v[48:51], v[200:203], v[168:171], v[48:51]
    v_mfma_f32_16x16x32_bf16 v[52:55], v[216:219], v[168:171], v[52:55]
    v_cndmask_b32 v32, v32, v22, s[72:73]
    v_cndmask_b32 v33, v33, v22, s[74:75]
    v_cndmask_b32 v34, v34, v22, s[76:77]
    v_cndmask_b32 v35, v35, v22, s[78:79]
    v_max3_f32 v20, v32, v33, v34
    v_max3_f32 v21, v35, v40, v41
    v_max_f32 v20, v20, v21
    v_mov_b32 v21, v20
    s_nop 1
    v_permlane16_swap_b32 v21, v20
    v_max_f32 v20, v20, v21
    v_mov_b32 v21, v20
    s_nop 1
    v_permlane32_swap_b32 v21, v20
    v_max_f32 v20, v20, v21
    v_mul_f32 v20, s80, v20
    v_fma_f32 v32, v32, s80, -v20
    v_fma_f32 v33, v33, s80, -v20
    v_fma_f32 v34, v34, s80, -v20
    v_fma_f32 v35, v35, s80, -v20
    v_fma_f32 v40, v40, s80, -v20
    v_fma_f32 v41, v41, s80, -v20
    v_exp_f32 v32, v32
    v_exp_f32 v33, v33
    v_exp_f32 v34, v34
    v_exp_f32 v35, v35
    v_exp_f32 v40, v40
    v_exp_f32 v41, v41
    s_nop 0
    v_cvt_pk_bf16_f32 v32, v32, v33
    v_cvt_pk_bf16_f32 v33, v34, v35
    v_mov_b32 v34, 0
    v_mov_b32 v35, 0
    v_cvt_pk_bf16_f32 v40, v40, v41
    v_mov_b32 v41, 0
    v_mov_b32 v42, 0
    v_mov_b32 v43, 0
    s_nop 1
    s_waitcnt vmcnt(8)
    v_add_u32 v25, 81920, v25
    v_add_u32 v26, 81920, v26
    ds_read_b64_tr_b16 v[140:141], v25 offset:0
    ds_read_b64_tr_b16 v[142:143], v25 offset:4096
    ds_read_b64_tr_b16 v[204:205], v26 offset:8192
    ds_read_b64_tr_b16 v[144:145], v25 offset:8
    ds_read_b64_tr_b16 v[146:147], v25 offset:4104
    ds_read_b64_tr_b16 v[206:207], v26 offset:8200
    ds_read_b64_tr_b16 v[148:149], v25 offset:1024
    ds_read_b64_tr_b16 v[150:151], v25 offset:5120
    ds_read_b64_tr_b16 v[208:209], v26 offset:8704
    ds_read_b64_tr_b16 v[152:153], v25 offset:1032
    ds_read_b64_tr_b16 v[154:155], v25 offset:5128
    ds_read_b64_tr_b16 v[210:211], v26 offset:8712
    ds_read_b64_tr_b16 v[156:157], v25 offset:2048
    ds_read_b64_tr_b16 v[158:159], v25 offset:6144
    ds_read_b64_tr_b16 v[212:213], v26 offset:9216
    ds_read_b64_tr_b16 v[160:161], v25 offset:2056
    ds_read_b64_tr_b16 v[162:163], v25 offset:6152
    ds_read_b64_tr_b16 v[214:215], v26 offset:9224
    ds_read_b64_tr_b16 v[164:165], v25 offset:3072
    ds_read_b64_tr_b16 v[166:167], v25 offset:7168
    ds_read_b64_tr_b16 v[216:217], v26 offset:9728
    ds_read_b64_tr_b16 v[168:169], v25 offset:3080
    ds_read_b64_tr_b16 v[170:171], v25 offset:7176
    ds_read_b64_tr_b16 v[218:219], v26 offset:9736
    v_cndmask_b32 v48, v48, v22, s[72:73]
    v_cndmask_b32 v49, v49, v22, s[74:75]
    v_cndmask_b32 v50, v50, v22, s[76:77]
    v_cndmask_b32 v51, v51, v22, s[78:79]
    v_max3_f32 v20, v44, v45, v46
    v_max3_f32 v21, v47, v48, v49
    v_max3_f32 v20, v20, v50, v51
    v_max3_f32 v21, v21, v52, v53
    v_max_f32 v20, v20, v21
    v_mov_b32 v21, v20
    s_nop 1
    v_permlane16_swap_b32 v21, v20
    v_max_f32 v20, v20, v21
    v_mov_b32 v21, v20
    s_nop 1
    v_permlane32_swap_b32 v21, v20
    v_max_f32 v20, v20, v21
    v_mul_f32 v20, s80, v20
    v_fma_f32 v44, v44, s80, -v20
    v_fma_f32 v45, v45, s80, -v20
    v_fma_f32 v46, v46, s80, -v20
    v_fma_f32 v47, v47, s80, -v20
    v_fma_f32 v48, v48, s80, -v20
    v_fma_f32 v49, v49, s80, -v20
    v_fma_f32 v50, v50, s80, -v20
    v_fma_f32 v51, v51, s80, -v20
    v_fma_f32 v52, v52, s80, -v20
    v_fma_f32 v53, v53, s80, -v20
    v_exp_f32 v44, v44
    v_exp_f32 v45, v45
    v_exp_f32 v46, v46
    v_exp_f32 v47, v47
    v_exp_f32 v48, v48
    v_exp_f32 v49, v49
    v_exp_f32 v50, v50
    v_exp_f32 v51, v51
    v_exp_f32 v52, v52
    v_exp_f32 v53, v53
    s_nop 0
    v_cvt_pk_bf16_f32 v44, v44, v45
    v_cvt_pk_bf16_f32 v45, v46, v47
    v_cvt_pk_bf16_f32 v46, v48, v49
    v_cvt_pk_bf16_f32 v47, v50, v51
    v_cvt_pk_bf16_f32 v52, v52, v53
    v_mov_b32 v53, 0
    v_mov_b32 v54, 0
    v_mov_b32 v55, 0
    s_nop 1
    s_waitcnt lgkmcnt(0)
    v_mfma_f32_16x16x32_bf16 v[36:39], v[28:31], v[32:35], 0
    v_mfma_f32_16x16x32_bf16 v[36:39], v[28:31], v[40:43], v[36:39]
    v_mfma_f32_16x16x32_bf16 v[172:175], v[140:143], v[32:35], 0
    v_mfma_f32_16x16x32_bf16 v[172:175], v[204:207], v[40:43], v[172:175]
    v_mfma_f32_16x16x32_bf16 v[176:179], v[144:147], v[32:35], 0
    v_mfma_f32_16x16x32_bf16 v[176:179], v[206:209], v[40:43], v[176:179]
    v_mfma_f32_16x16x32_bf16 v[180:183], v[148:151], v[32:35], 0
    v_mfma_f32_16x16x32_bf16 v[180:183], v[208:211], v[40:43], v[180:183]
    v_mfma_f32_16x16x32_bf16 v[184:187], v[152:155], v[32:35], 0
    v_mfma_f32_16x16x32_bf16 v[184:187], v[210:213], v[40:43], v[184:187]
    v_mfma_f32_16x16x32_bf16 v[188:191], v[156:159], v[32:35], 0
    v_mfma_f32_16x16x32_bf16 v[188:191], v[212:215], v[40:43], v[188:191]
    v_mfma_f32_16x16x32_bf16 v[192:195], v[160:163], v[32:35], 0
    v_mfma_f32_16x16x32_bf16 v[192:195], v[214:217], v[40:43], v[192:195]
    v_mfma_f32_16x16x32_bf16 v[196:199], v[164:167], v[32:35], 0
    v_mfma_f32_16x16x32_bf16 v[196:199], v[216:219], v[40:43], v[196:199]
    v_mfma_f32_16x16x32_bf16 v[200:203], v[168:171], v[32:35], 0
    v_mfma_f32_16x16x32_bf16 v[200:203], v[218:221], v[40:43], v[200:203]
    v_rcp_f32 v23, v36
    s_add_u32 s85, s81, 176685056
    v_mul_f32 v172, v172, v23
    v_mul_f32 v173, v173, v23
    v_mul_f32 v174, v174, v23
    v_mul_f32 v175, v175, v23
    v_mul_f32 v176, v176, v23
    v_mul_f32 v177, v177, v23
    v_mul_f32 v178, v178, v23
    v_mul_f32 v179, v179, v23
    v_cvt_pk_bf16_f32 v224, v172, v173
    v_cvt_pk_bf16_f32 v225, v174, v175
    v_cvt_pk_bf16_f32 v226, v176, v177
    v_cvt_pk_bf16_f32 v227, v178, v179
    buffer_store_dwordx4 v[224:227], v1, s[4:7], s85 offen offset:0 sc1
    v_mul_f32 v180, v180, v23
    v_mul_f32 v181, v181, v23
    v_mul_f32 v182, v182, v23
    v_mul_f32 v183, v183, v23
    v_mul_f32 v184, v184, v23
    v_mul_f32 v185, v185, v23
    v_mul_f32 v186, v186, v23
    v_mul_f32 v187, v187, v23
    v_cvt_pk_bf16_f32 v228, v180, v181
    v_cvt_pk_bf16_f32 v229, v182, v183
    v_cvt_pk_bf16_f32 v230, v184, v185
    v_cvt_pk_bf16_f32 v231, v186, v187
    buffer_store_dwordx4 v[228:231], v1, s[4:7], s85 offen offset:1024 sc1
    v_mul_f32 v188, v188, v23
    v_mul_f32 v189, v189, v23
    v_mul_f32 v190, v190, v23
    v_mul_f32 v191, v191, v23
    v_mul_f32 v192, v192, v23
    v_mul_f32 v193, v193, v23
    v_mul_f32 v194, v194, v23
    v_mul_f32 v195, v195, v23
    v_cvt_pk_bf16_f32 v232, v188, v189
    v_cvt_pk_bf16_f32 v233, v190, v191
    v_cvt_pk_bf16_f32 v234, v192, v193
    v_cvt_pk_bf16_f32 v235, v194, v195
    buffer_store_dwordx4 v[232:235], v1, s[4:7], s85 offen offset:2048 sc1
    v_mul_f32 v196, v196, v23
    v_mul_f32 v197, v197, v23
    v_mul_f32 v198, v198, v23
    v_mul_f32 v199, v199, v23
    v_mul_f32 v200, v200, v23
    v_mul_f32 v201, v201, v23
    v_mul_f32 v202, v202, v23
    v_mul_f32 v203, v203, v23
    v_cvt_pk_bf16_f32 v236, v196, v197
    v_cvt_pk_bf16_f32 v237, v198, v199
    v_cvt_pk_bf16_f32 v238, v200, v201
    v_cvt_pk_bf16_f32 v239, v202, v203
    buffer_store_dwordx4 v[236:239], v1, s[4:7], s85 offen offset:3072 sc1
    v_mfma_f32_16x16x32_bf16 v[48:51], v[28:31], v[44:47], 0
    v_mfma_f32_16x16x32_bf16 v[48:51], v[28:31], v[52:55], v[48:51]
    v_mfma_f32_16x16x32_bf16 v[172:175], v[140:143], v[44:47], 0
    v_mfma_f32_16x16x32_bf16 v[172:175], v[204:207], v[52:55], v[172:175]
    v_mfma_f32_16x16x32_bf16 v[176:179], v[144:147], v[44:47], 0
    v_mfma_f32_16x16x32_bf16 v[176:179], v[206:209], v[52:55], v[176:179]
    v_mfma_f32_16x16x32_bf16 v[180:183], v[148:151], v[44:47], 0
    v_mfma_f32_16x16x32_bf16 v[180:183], v[208:211], v[52:55], v[180:183]
    v_mfma_f32_16x16x32_bf16 v[184:187], v[152:155], v[44:47], 0
    v_mfma_f32_16x16x32_bf16 v[184:187], v[210:213], v[52:55], v[184:187]
    v_mfma_f32_16x16x32_bf16 v[188:191], v[156:159], v[44:47], 0
    v_mfma_f32_16x16x32_bf16 v[188:191], v[212:215], v[52:55], v[188:191]
    v_mfma_f32_16x16x32_bf16 v[192:195], v[160:163], v[44:47], 0
    v_mfma_f32_16x16x32_bf16 v[192:195], v[214:217], v[52:55], v[192:195]
    v_mfma_f32_16x16x32_bf16 v[196:199], v[164:167], v[44:47], 0
    v_mfma_f32_16x16x32_bf16 v[196:199], v[216:219], v[52:55], v[196:199]
    v_mfma_f32_16x16x32_bf16 v[200:203], v[168:171], v[44:47], 0
    v_mfma_f32_16x16x32_bf16 v[200:203], v[218:221], v[52:55], v[200:203]
    v_rcp_f32 v23, v48
    s_add_u32 s85, s81, 176816128
    v_mul_f32 v172, v172, v23
    v_mul_f32 v173, v173, v23
    v_mul_f32 v174, v174, v23
    v_mul_f32 v175, v175, v23
    v_mul_f32 v176, v176, v23
    v_mul_f32 v177, v177, v23
    v_mul_f32 v178, v178, v23
    v_mul_f32 v179, v179, v23
    v_cvt_pk_bf16_f32 v224, v172, v173
    v_cvt_pk_bf16_f32 v225, v174, v175
    v_cvt_pk_bf16_f32 v226, v176, v177
    v_cvt_pk_bf16_f32 v227, v178, v179
    buffer_store_dwordx4 v[224:227], v1, s[4:7], s85 offen offset:0 sc1
    v_mul_f32 v180, v180, v23
    v_mul_f32 v181, v181, v23
    v_mul_f32 v182, v182, v23
    v_mul_f32 v183, v183, v23
    v_mul_f32 v184, v184, v23
    v_mul_f32 v185, v185, v23
    v_mul_f32 v186, v186, v23
    v_mul_f32 v187, v187, v23
    v_cvt_pk_bf16_f32 v228, v180, v181
    v_cvt_pk_bf16_f32 v229, v182, v183
    v_cvt_pk_bf16_f32 v230, v184, v185
    v_cvt_pk_bf16_f32 v231, v186, v187
    buffer_store_dwordx4 v[228:231], v1, s[4:7], s85 offen offset:1024 sc1
    v_mul_f32 v188, v188, v23
    v_mul_f32 v189, v189, v23
    v_mul_f32 v190, v190, v23
    v_mul_f32 v191, v191, v23
    v_mul_f32 v192, v192, v23
    v_mul_f32 v193, v193, v23
    v_mul_f32 v194, v194, v23
    v_mul_f32 v195, v195, v23
    v_cvt_pk_bf16_f32 v232, v188, v189
    v_cvt_pk_bf16_f32 v233, v190, v191
    v_cvt_pk_bf16_f32 v234, v192, v193
    v_cvt_pk_bf16_f32 v235, v194, v195
    buffer_store_dwordx4 v[232:235], v1, s[4:7], s85 offen offset:2048 sc1
    v_mul_f32 v196, v196, v23
    v_mul_f32 v197, v197, v23
    v_mul_f32 v198, v198, v23
    v_mul_f32 v199, v199, v23
    v_mul_f32 v200, v200, v23
    v_mul_f32 v201, v201, v23
    v_mul_f32 v202, v202, v23
    v_mul_f32 v203, v203, v23
    v_cvt_pk_bf16_f32 v236, v196, v197
    v_cvt_pk_bf16_f32 v237, v198, v199
    v_cvt_pk_bf16_f32 v238, v200, v201
    v_cvt_pk_bf16_f32 v239, v202, v203
    buffer_store_dwordx4 v[236:239], v1, s[4:7], s85 offen offset:3072 sc1
    s_mov_b32 s28, s46
    s_waitcnt vmcnt(0)
    s_barrier
    s_cmp_eq_u32 s28, 0
    s_cbranch_scc1 sig_14
    s_cmp_lg_u32 s3, 0
    s_cbranch_scc1 sig_14
    s_and_b32 s57, s28, 3
    v_mov_b32 v24, s57
    s_bfe_u32 s57, s28, 0x20002
    v_mov_b32 v25, s57
    s_andn2_b32 s28, s28, 15
    s_mov_b64 exec, 1
    buffer_atomic_add_x2 v[24:25], v17, s[4:7], s28 offen sc1
    s_mov_b64 exec, -1
sig_14:
    s_mov_b32 s28, 0
    s_cmp_lg_u32 s3, 0
    s_cbranch_scc1 pub_15
    v_mov_b32 v20, 131136
    s_mov_b64 exec, 1
    ds_write_b32 v20, v250
    s_mov_b64 exec, -1
    s_waitcnt lgkmcnt(0)
pub_15:
    s_barrier
    v_mov_b32 v20, 131136
    ds_read_b32 v20, v20
    s_waitcnt lgkmcnt(0)
    v_readfirstlane_b32 s59, v20
    s_add_u32 s59, s59, 32
    s_min_u32 s59, s59, 319
    s_lshl_b32 s57, s59, 6
    s_load_dwordx16 s[32:47], s[24:25], s57
    s_waitcnt lgkmcnt(0)
    s_branch w_cold
w_fin:
    s_load_dwordx2 s[8:9], s[0:1], 0
    s_load_dwordx2 s[12:13], s[0:1], 88
    v_mbcnt_lo_u32_b32 v1, -1, 0
    v_mbcnt_hi_u32_b32 v1, -1, v1
    s_mov_b32 s10, 4194304
    s_mov_b32 s11, 131072
    s_mov_b32 s14, 4194304
    s_mov_b32 s15, 131072
    s_mov_b32 s89, 0xbfb8aa3b
    v_lshlrev_b32 v3, 4, v1
    v_and_b32 v4, 15, v1
    v_lshrrev_b32 v5, 4, v1
    v_lshlrev_b32 v4, 11, v4
    v_lshl_add_u32 v4, v5, 4, v4
    v_and_b32 v5, 1, v5
    v_cmp_eq_u32 s[76:77], 1, v5
    v_and_b32 v6, 3, v1
    v_lshlrev_b32 v6, 7, v6
    s_mov_b32 s80, s39
    s_lshl_b32 s81, s36, 2
    s_and_b32 s82, s3, 3
    s_add_u32 s81, s81, s82
    s_lshr_b32 s82, s3, 2
    s_mov_b32 s84, 65536
    s_mov_b32 s85, 218112000
    s_waitcnt lgkmcnt(0)
    s_cmp_eq_u32 s32, 7
    s_cbranch_scc1 fin_tail
fin_job:
    s_lshl_b32 s72, s80, 1
    s_add_u32 s72, s72, s82
    s_lshl_b32 s74, s72, 15
    s_lshl_b32 s73, s81, 11
    s_add_u32 s73, s73, s74
    s_lshl_b32 s75, s81, 7
    s_add_u32 s74, s74, s75
    s_add_u32 s78, s73, 117440512
    s_add_u32 s79, s73, 75497472
    s_lshr_b32 s83, s80, 3
    s_lshl_b32 s83, s83, 6
    s_add_u32 s83, s83, 218106368
    s_add_u32 s87, s80, 2
    buffer_load_dwordx4 v[88:91], v4, s[8:11], s74 offen offset:0
    buffer_load_dwordx4 v[92:95], v4, s[8:11], s74 offen offset:64
    s_cmp_lg_u32 s3, 0
    s_cbranch_scc1 fin_ws_ok
fin_wd:
    buffer_load_dwordx2 v[8:9], off, s[4:7], s83 sc1
    s_waitcnt vmcnt(0)
    v_readfirstlane_b32 s86, v8
    v_readfirstlane_b32 s88, v9
    s_cmp_ge_u32 s88, s37
    s_cselect_b32 s86, s86, 0
    s_cmp_ge_u32 s86, 16
    s_cbranch_scc1 fin_wd2
    s_sleep 64
    s_sub_u32 s84, s84, 1
    s_cbranch_scc0 fin_wd
    s_mov_b32 s84, 0
fin_wd2:
    s_cmp_lg_u32 s37, 0
    s_cbranch_scc1 fin_ws_ok
fin_ws:
    buffer_load_dword v7, v6, s[4:7], s85 offen sc1
    s_waitcnt vmcnt(0)
    v_cmp_gt_u32 vcc, s87, v7
    s_cbranch_vccz fin_ws_ok
    s_sleep 12
    s_sub_u32 s86, s87, 2
    v_cmp_gt_i32 vcc, s86, v7
    s_cbranch_vccz fin_ws_f
    s_sleep 64
    s_sub_u32 s86, s87, 6
    v_cmp_gt_i32 vcc, s86, v7
    s_cbranch_vccz fin_ws_f
    s_sleep 127
    s_sleep 127
fin_ws_f:
    s_sub_u32 s84, s84, 1
    s_cbranch_scc0 fin_ws
    s_mov_b32 s84, 0
fin_ws_ok:
    s_cmp_lg_u32 s3, 0
    s_cbranch_scc1 clm_16
    v_mov_b32 v250, 1
    s_mov_b64 exec, 1
    buffer_atomic_add v250, off, s[64:67], s71 sc0 sc1
    s_mov_b64 exec, -1
clm_16:
    s_barrier
    buffer_load_dwordx4 v[136:139], v3, s[4:7], s78 offen offset:0 sc1
    buffer_load_dwordx4 v[140:143], v3, s[4:7], s78 offen offset:1024 sc1
    s_add_u32 s78, s78, 4194304
    buffer_load_dwordx4 v[144:147], v3, s[4:7], s78 offen offset:0 sc1
    buffer_load_dwordx4 v[148:151], v3, s[4:7], s78 offen offset:1024 sc1
    s_add_u32 s78, s78, 4194304
    s_cmp_lg_u32 s33, 0
    s_cbranch_scc1 fin_g2
    buffer_load_dwordx4 v[152:155], v3, s[4:7], s78 offen offset:0 sc1
    buffer_load_dwordx4 v[156:159], v3, s[4:7], s78 offen offset:1024 sc1
    s_add_u32 s78, s78, 4194304
    buffer_load_dwordx4 v[160:163], v3, s[4:7], s78 offen offset:0 sc1
    buffer_load_dwordx4 v[164:167], v3, s[4:7], s78 offen offset:1024 sc1
    s_add_u32 s78, s78, 4194304
    s_branch fin_g4
fin_g2:
    v_mov_b32 v152, 0
    v_mov_b32 v153, 0
    v_mov_b32 v154, 0
    v_mov_b32 v155, 0
    v_mov_b32 v156, 0
    v_mov_b32 v157, 0
    v_mov_b32 v158, 0
    v_mov_b32 v159, 0
    v_mov_b32 v160, 0
    v_mov_b32 v161, 0
    v_mov_b32 v162, 0
    v_mov_b32 v163, 0
    v_mov_b32 v164, 0
    v_mov_b32 v165, 0
    v_mov_b32 v166, 0
    v_mov_b32 v167, 0
fin_g4:
    buffer_load_dwordx4 v[16:19], v3, s[4:7], s79 offen offset:0 sc1
    buffer_load_dwordx4 v[48:51], v3, s[4:7], s79 offen offset:1024 sc1
    s_add_u32 s79, s79, 4194304
    buffer_load_dwordx4 v[20:23], v3, s[4:7], s79 offen offset:0 sc1
    buffer_load_dwordx4 v[52:55], v3, s[4:7], s79 offen offset:1024 sc1
    s_add_u32 s79, s79, 4194304
    s_cmp_ge_u32 s35, 2
    s_cbranch_scc1 fin_2p
    buffer_load_dwordx4 v[24:27], v3, s[4:7], s79 offen offset:0 sc1
    buffer_load_dwordx4 v[56:59], v3, s[4:7], s79 offen offset:1024 sc1
    s_add_u32 s79, s79, 4194304
    buffer_load_dwordx4 v[28:31], v3, s[4:7], s79 offen offset:0 sc1
    buffer_load_dwordx4 v[60:63], v3, s[4:7], s79 offen offset:1024 sc1
    s_add_u32 s79, s79, 4194304
    s_cmp_ge_u32 s35, 1
    s_cbranch_scc1 fin_4p
    buffer_load_dwordx4 v[32:35], v3, s[4:7], s79 offen offset:0 sc1
    buffer_load_dwordx4 v[64:67], v3, s[4:7], s79 offen offset:1024 sc1
    s_add_u32 s79, s79, 4194304
    buffer_load_dwordx4 v[36:39], v3, s[4:7], s79 offen offset:0 sc1
    buffer_load_dwordx4 v[68:71], v3, s[4:7], s79 offen offset:1024 sc1
    s_add_u32 s79, s79, 4194304
    buffer_load_dwordx4 v[40:43], v3, s[4:7], s79 offen offset:0 sc1
    buffer_load_dwordx4 v[72:75], v3, s[4:7], s79 offen offset:1024 sc1
    s_add_u32 s79, s79, 4194304
    buffer_load_dwordx4 v[44:47], v3, s[4:7], s79 offen offset:0 sc1
    buffer_load_dwordx4 v[76:79], v3, s[4:7], s79 offen offset:1024 sc1
    s_add_u32 s79, s79, 4194304
    s_waitcnt vmcnt(16)
    s_branch fin_8p
fin_2p:
    v_mov_b32 v24, 0
    v_mov_b32 v25, 0
    v_mov_b32 v26, 0
    v_mov_b32 v27, 0
    v_mov_b32 v28, 0
    v_mov_b32 v29, 0
    v_mov_b32 v30, 0
    v_mov_b32 v31, 0
    v_mov_b32 v32, 0
    v_mov_b32 v33, 0
    v_mov_b32 v34, 0
    v_mov_b32 v35, 0
    v_mov_b32 v36, 0
    v_mov_b32 v37, 0
    v_mov_b32 v38, 0
    v_mov_b32 v39, 0
    v_mov_b32 v40, 0
    v_mov_b32 v41, 0
    v_mov_b32 v42, 0
    v_mov_b32 v43, 0
    v_mov_b32 v44, 0
    v_mov_b32 v45, 0
    v_mov_b32 v46, 0
    v_mov_b32 v47, 0
    v_mov_b32 v56, 0
    v_mov_b32 v57, 0
    v_mov_b32 v58, 0
    v_mov_b32 v59, 0
    v_mov_b32 v60, 0
    v_mov_b32 v61, 0
    v_mov_b32 v62, 0
    v_mov_b32 v63, 0
    v_mov_b32 v64, 0
    v_mov_b32 v65, 0
    v_mov_b32 v66, 0
    v_mov_b32 v67, 0
    v_mov_b32 v68, 0
    v_mov_b32 v69, 0
    v_mov_b32 v70, 0
    v_mov_b32 v71, 0
    v_mov_b32 v72, 0
    v_mov_b32 v73, 0
    v_mov_b32 v74, 0
    v_mov_b32 v75, 0
    v_mov_b32 v76, 0
    v_mov_b32 v77, 0
    v_mov_b32 v78, 0
    v_mov_b32 v79, 0
    s_waitcnt vmcnt(4)
    s_branch fin_8p
fin_4p:
    v_mov_b32 v32, 0
    v_mov_b32 v33, 0
    v_mov_b32 v34, 0
    v_mov_b32 v35, 0
    v_mov_b32 v36, 0
    v_mov_b32 v37, 0
    v_mov_b32 v38, 0
    v_mov_b32 v39, 0
    v_mov_b32 v40, 0
    v_mov_b32 v41, 0
    v_mov_b32 v42, 0
    v_mov_b32 v43, 0
    v_mov_b32 v44, 0
    v_mov_b32 v45, 0
    v_mov_b32 v46, 0
    v_mov_b32 v47, 0
    v_mov_b32 v64, 0
    v_mov_b32 v65, 0
    v_mov_b32 v66, 0
    v_mov_b32 v67, 0
    v_mov_b32 v68, 0
    v_mov_b32 v69, 0
    v_mov_b32 v70, 0
    v_mov_b32 v71, 0
    v_mov_b32 v72, 0
    v_mov_b32 v73, 0
    v_mov_b32 v74, 0
    v_mov_b32 v75, 0
    v_mov_b32 v76, 0
    v_mov_b32 v77, 0
    v_mov_b32 v78, 0
    v_mov_b32 v79, 0
    s_waitcnt vmcnt(8)
fin_8p:
    v_lshlrev_b32 v120, 16, v136
    v_and_b32 v121, 0xffff0000, v136
    v_lshlrev_b32 v136, 16, v144
    v_and_b32 v144, 0xffff0000, v144
    v_add_f32 v120, v120, v136
    v_add_f32 v121, v121, v144
    v_lshlrev_b32 v136, 16, v152
    v_and_b32 v152, 0xffff0000, v152
    v_add_f32 v120, v120, v136
    v_add_f32 v121, v121, v152
    v_lshlrev_b32 v136, 16, v160
    v_and_b32 v160, 0xffff0000, v160
    v_add_f32 v120, v120, v136
    v_add_f32 v121, v121, v160
    v_cvt_pk_bf16_f32 v136, v120, v121
    v_lshlrev_b32 v120, 16, v136
    v_and_b32 v121, 0xffff0000, v136
    v_mul_f32 v136, s89, v120
    v_mul_f32 v144, s89, v121
    v_lshlrev_b32 v122, 16, v137
    v_and_b32 v123, 0xffff0000, v137
    v_lshlrev_b32 v137, 16, v145
    v_and_b32 v145, 0xffff0000, v145
    v_add_f32 v122, v122, v137
    v_add_f32 v123, v123, v145
    v_lshlrev_b32 v137, 16, v153
    v_and_b32 v153, 0xffff0000, v153
    v_add_f32 v122, v122, v137
    v_add_f32 v123, v123, v153
    v_lshlrev_b32 v137, 16, v161
    v_and_b32 v161, 0xffff0000, v161
    v_add_f32 v122, v122, v137
    v_add_f32 v123, v123, v161
    v_cvt_pk_bf16_f32 v137, v122, v123
    v_lshlrev_b32 v122, 16, v137
    v_and_b32 v123, 0xffff0000, v137
    v_mul_f32 v137, s89, v122
    v_mul_f32 v145, s89, v123
    v_lshlrev_b32 v124, 16, v138
    v_and_b32 v125, 0xffff0000, v138
    v_lshlrev_b32 v138, 16, v146
    v_and_b32 v146, 0xffff0000, v146
    v_add_f32 v124, v124, v138
    v_add_f32 v125, v125, v146
    v_lshlrev_b32 v138, 16, v154
    v_and_b32 v154, 0xffff0000, v154
    v_add_f32 v124, v124, v138
    v_add_f32 v125, v125, v154
    v_lshlrev_b32 v138, 16, v162
    v_and_b32 v162, 0xffff0000, v162
    v_add_f32 v124, v124, v138
    v_add_f32 v125, v125, v162
    v_cvt_pk_bf16_f32 v138, v124, v125
    v_lshlrev_b32 v124, 16, v138
    v_and_b32 v125, 0xffff0000, v138
    v_mul_f32 v138, s89, v124
    v_mul_f32 v146, s89, v125
    v_lshlrev_b32 v126, 16, v139
    v_and_b32 v127, 0xffff0000, v139
    v_lshlrev_b32 v139, 16, v147
    v_and_b32 v147, 0xffff0000, v147
    v_add_f32 v126, v126, v139
    v_add_f32 v127, v127, v147
    v_lshlrev_b32 v139, 16, v155
    v_and_b32 v155, 0xffff0000, v155
    v_add_f32 v126, v126, v139
    v_add_f32 v127, v127, v155
    v_lshlrev_b32 v139, 16, v163
    v_and_b32 v163, 0xffff0000, v163
    v_add_f32 v126, v126, v139
    v_add_f32 v127, v127, v163
    v_cvt_pk_bf16_f32 v139, v126, v127
    v_lshlrev_b32 v126, 16, v139
    v_and_b32 v127, 0xffff0000, v139
    v_mul_f32 v139, s89, v126
    v_mul_f32 v147, s89, v127
    v_exp_f32 v136, v136
    v_exp_f32 v144, v144
    v_exp_f32 v137, v137
    v_exp_f32 v145, v145
    v_exp_f32 v138, v138
    v_exp_f32 v146, v146
    v_exp_f32 v139, v139
    v_exp_f32 v147, v147
    s_nop 0
    v_add_f32 v136, 1.0, v136
    v_add_f32 v144, 1.0, v144
    v_add_f32 v137, 1.0, v137
    v_add_f32 v145, 1.0, v145
    v_add_f32 v138, 1.0, v138
    v_add_f32 v146, 1.0, v146
    v_add_f32 v139, 1.0, v139
    v_add_f32 v147, 1.0, v147
    v_rcp_f32 v136, v136
    v_rcp_f32 v144, v144
    v_rcp_f32 v137, v137
    v_rcp_f32 v145, v145
    v_rcp_f32 v138, v138
    v_rcp_f32 v146, v146
    v_rcp_f32 v139, v139
    v_rcp_f32 v147, v147
    s_nop 0
    v_mul_f32 v120, v120, v136
    v_mul_f32 v121, v121, v144
    v_cvt_pk_bf16_f32 v136, v120, v121
    v_mul_f32 v122, v122, v137
    v_mul_f32 v123, v123, v145
    v_cvt_pk_bf16_f32 v137, v122, v123
    v_mul_f32 v124, v124, v138
    v_mul_f32 v125, v125, v146
    v_cvt_pk_bf16_f32 v138, v124, v125
    v_mul_f32 v126, v126, v139
    v_mul_f32 v127, v127, v147
    v_cvt_pk_bf16_f32 v139, v126, v127
    v_lshlrev_b32 v120, 16, v140
    v_and_b32 v121, 0xffff0000, v140
    v_lshlrev_b32 v140, 16, v148
    v_and_b32 v148, 0xffff0000, v148
    v_add_f32 v120, v120, v140
    v_add_f32 v121, v121, v148
    v_lshlrev_b32 v140, 16, v156
    v_and_b32 v156, 0xffff0000, v156
    v_add_f32 v120, v120, v140
    v_add_f32 v121, v121, v156
    v_lshlrev_b32 v140, 16, v164
    v_and_b32 v164, 0xffff0000, v164
    v_add_f32 v120, v120, v140
    v_add_f32 v121, v121, v164
    v_cvt_pk_bf16_f32 v140, v120, v121
    v_lshlrev_b32 v120, 16, v140
    v_and_b32 v121, 0xffff0000, v140
    v_mul_f32 v140, s89, v120
    v_mul_f32 v148, s89, v121
    v_lshlrev_b32 v122, 16, v141
    v_and_b32 v123, 0xffff0000, v141
    v_lshlrev_b32 v141, 16, v149
    v_and_b32 v149, 0xffff0000, v149
    v_add_f32 v122, v122, v141
    v_add_f32 v123, v123, v149
    v_lshlrev_b32 v141, 16, v157
    v_and_b32 v157, 0xffff0000, v157
    v_add_f32 v122, v122, v141
    v_add_f32 v123, v123, v157
    v_lshlrev_b32 v141, 16, v165
    v_and_b32 v165, 0xffff0000, v165
    v_add_f32 v122, v122, v141
    v_add_f32 v123, v123, v165
    v_cvt_pk_bf16_f32 v141, v122, v123
    v_lshlrev_b32 v122, 16, v141
    v_and_b32 v123, 0xffff0000, v141
    v_mul_f32 v141, s89, v122
    v_mul_f32 v149, s89, v123
    v_lshlrev_b32 v124, 16, v142
    v_and_b32 v125, 0xffff0000, v142
    v_lshlrev_b32 v142, 16, v150
    v_and_b32 v150, 0xffff0000, v150
    v_add_f32 v124, v124, v142
    v_add_f32 v125, v125, v150
    v_lshlrev_b32 v142, 16, v158
    v_and_b32 v158, 0xffff0000, v158
    v_add_f32 v124, v124, v142
    v_add_f32 v125, v125, v158
    v_lshlrev_b32 v142, 16, v166
    v_and_b32 v166, 0xffff0000, v166
    v_add_f32 v124, v124, v142
    v_add_f32 v125, v125, v166
    v_cvt_pk_bf16_f32 v142, v124, v125
    v_lshlrev_b32 v124, 16, v142
    v_and_b32 v125, 0xffff0000, v142
    v_mul_f32 v142, s89, v124
    v_mul_f32 v150, s89, v125
    v_lshlrev_b32 v126, 16, v143
    v_and_b32 v127, 0xffff0000, v143
    v_lshlrev_b32 v143, 16, v151
    v_and_b32 v151, 0xffff0000, v151
    v_add_f32 v126, v126, v143
    v_add_f32 v127, v127, v151
    v_lshlrev_b32 v143, 16, v159
    v_and_b32 v159, 0xffff0000, v159
    v_add_f32 v126, v126, v143
    v_add_f32 v127, v127, v159
    v_lshlrev_b32 v143, 16, v167
    v_and_b32 v167, 0xffff0000, v167
    v_add_f32 v126, v126, v143
    v_add_f32 v127, v127, v167
    v_cvt_pk_bf16_f32 v143, v126, v127
    v_lshlrev_b32 v126, 16, v143
    v_and_b32 v127, 0xffff0000, v143
    v_mul_f32 v143, s89, v126
    v_mul_f32 v151, s89, v127
    v_exp_f32 v140, v140
    v_exp_f32 v148, v148
    v_exp_f32 v141, v141
    v_exp_f32 v149, v149
    v_exp_f32 v142, v142
    v_exp_f32 v150, v150
    v_exp_f32 v143, v143
    v_exp_f32 v151, v151
    s_nop 0
    v_add_f32 v140, 1.0, v140
    v_add_f32 v148, 1.0, v148
    v_add_f32 v141, 1.0, v141
    v_add_f32 v149, 1.0, v149
    v_add_f32 v142, 1.0, v142
    v_add_f32 v150, 1.0, v150
    v_add_f32 v143, 1.0, v143
    v_add_f32 v151, 1.0, v151
    v_rcp_f32 v140, v140
    v_rcp_f32 v148, v148
    v_rcp_f32 v141, v141
    v_rcp_f32 v149, v149
    v_rcp_f32 v142, v142
    v_rcp_f32 v150, v150
    v_rcp_f32 v143, v143
    v_rcp_f32 v151, v151
    s_nop 0
    v_mul_f32 v120, v120, v140
    v_mul_f32 v121, v121, v148
    v_cvt_pk_bf16_f32 v140, v120, v121
    v_mul_f32 v122, v122, v141
    v_mul_f32 v123, v123, v149
    v_cvt_pk_bf16_f32 v141, v122, v123
    v_mul_f32 v124, v124, v142
    v_mul_f32 v125, v125, v150
    v_cvt_pk_bf16_f32 v142, v124, v125
    v_mul_f32 v126, v126, v143
    v_mul_f32 v127, v127, v151
    v_cvt_pk_bf16_f32 v143, v126, v127
    s_waitcnt vmcnt(0)
    v_lshlrev_b32 v96, 16, v16
    v_and_b32 v97, 0xffff0000, v16
    v_lshlrev_b32 v98, 16, v17
    v_and_b32 v99, 0xffff0000, v17
    v_lshlrev_b32 v100, 16, v18
    v_and_b32 v101, 0xffff0000, v18
    v_lshlrev_b32 v102, 16, v19
    v_and_b32 v103, 0xffff0000, v19
    v_lshlrev_b32 v120, 16, v20
    v_and_b32 v121, 0xffff0000, v20
    v_lshlrev_b32 v122, 16, v21
    v_and_b32 v123, 0xffff0000, v21
    v_lshlrev_b32 v124, 16, v22
    v_and_b32 v125, 0xffff0000, v22
    v_lshlrev_b32 v126, 16, v23
    v_and_b32 v127, 0xffff0000, v23
    v_add_f32 v96, v96, v120
    v_add_f32 v97, v97, v121
    v_add_f32 v98, v98, v122
    v_add_f32 v99, v99, v123
    v_add_f32 v100, v100, v124
    v_add_f32 v101, v101, v125
    v_add_f32 v102, v102, v126
    v_add_f32 v103, v103, v127
    v_lshlrev_b32 v120, 16, v24
    v_and_b32 v121, 0xffff0000, v24
    v_lshlrev_b32 v122, 16, v25
    v_and_b32 v123, 0xffff0000, v25
    v_lshlrev_b32 v124, 16, v26
    v_and_b32 v125, 0xffff0000, v26
    v_lshlrev_b32 v126, 16, v27
    v_and_b32 v127, 0xffff0000, v27
    v_add_f32 v96, v96, v120
    v_add_f32 v97, v97, v121
    v_add_f32 v98, v98, v122
    v_add_f32 v99, v99, v123
    v_add_f32 v100, v100, v124
    v_add_f32 v101, v101, v125
    v_add_f32 v102, v102, v126
    v_add_f32 v103, v103, v127
    v_lshlrev_b32 v120, 16, v28
    v_and_b32 v121, 0xffff0000, v28
    v_lshlrev_b32 v122, 16, v29
    v_and_b32 v123, 0xffff0000, v29
    v_lshlrev_b32 v124, 16, v30
    v_and_b32 v125, 0xffff0000, v30
    v_lshlrev_b32 v126, 16, v31
    v_and_b32 v127, 0xffff0000, v31
    v_add_f32 v96, v96, v120
    v_add_f32 v97, v97, v121
    v_add_f32 v98, v98, v122
    v_add_f32 v99, v99, v123
    v_add_f32 v100, v100, v124
    v_add_f32 v101, v101, v125
    v_add_f32 v102, v102, v126
    v_add_f32 v103, v103, v127
    v_lshlrev_b32 v120, 16, v32
    v_and_b32 v121, 0xffff0000, v32
    v_lshlrev_b32 v122, 16, v33
    v_and_b32 v123, 0xffff0000, v33
    v_lshlrev_b32 v124, 16, v34
    v_and_b32 v125, 0xffff0000, v34
    v_lshlrev_b32 v126, 16, v35
    v_and_b32 v127, 0xffff0000, v35
    v_add_f32 v96, v96, v120
    v_add_f32 v97, v97, v121
    v_add_f32 v98, v98, v122
    v_add_f32 v99, v99, v123
    v_add_f32 v100, v100, v124
    v_add_f32 v101, v101, v125
    v_add_f32 v102, v102, v126
    v_add_f32 v103, v103, v127
    v_lshlrev_b32 v120, 16, v36
    v_and_b32 v121, 0xffff0000, v36
    v_lshlrev_b32 v122, 16, v37
    v_and_b32 v123, 0xffff0000, v37
    v_lshlrev_b32 v124, 16, v38
    v_and_b32 v125, 0xffff0000, v38
    v_lshlrev_b32 v126, 16, v39
    v_and_b32 v127, 0xffff0000, v39
    v_add_f32 v96, v96, v120
    v_add_f32 v97, v97, v121
    v_add_f32 v98, v98, v122
    v_add_f32 v99, v99, v123
    v_add_f32 v100, v100, v124
    v_add_f32 v101, v101, v125
    v_add_f32 v102, v102, v126
    v_add_f32 v103, v103, v127
    v_lshlrev_b32 v120, 16, v40
    v_and_b32 v121, 0xffff0000, v40
    v_lshlrev_b32 v122, 16, v41
    v_and_b32 v123, 0xffff0000, v41
    v_lshlrev_b32 v124, 16, v42
    v_and_b32 v125, 0xffff0000, v42
    v_lshlrev_b32 v126, 16, v43
    v_and_b32 v127, 0xffff0000, v43
    v_add_f32 v96, v96, v120
    v_add_f32 v97, v97, v121
    v_add_f32 v98, v98, v122
    v_add_f32 v99, v99, v123
    v_add_f32 v100, v100, v124
    v_add_f32 v101, v101, v125
    v_add_f32 v102, v102, v126
    v_add_f32 v103, v103, v127
    v_lshlrev_b32 v120, 16, v44
    v_and_b32 v121, 0xffff0000, v44
    v_lshlrev_b32 v122, 16, v45
    v_and_b32 v123, 0xffff0000, v45
    v_lshlrev_b32 v124, 16, v46
    v_and_b32 v125, 0xffff0000, v46
    v_lshlrev_b32 v126, 16, v47
    v_and_b32 v127, 0xffff0000, v47
    v_add_f32 v96, v96, v120
    v_add_f32 v97, v97, v121
    v_add_f32 v98, v98, v122
    v_add_f32 v99, v99, v123
    v_add_f32 v100, v100, v124
    v_add_f32 v101, v101, v125
    v_add_f32 v102, v102, v126
    v_add_f32 v103, v103, v127
    v_cndmask_b32 v108, v88, v90, s[76:77]
    v_cndmask_b32 v109, v89, v91, s[76:77]
    v_cndmask_b32 v110, v90, v88, s[76:77]
    v_cndmask_b32 v111, v91, v89, s[76:77]
    v_cvt_pk_bf16_f32 v104, v96, v97
    v_lshlrev_b32 v96, 16, v104
    v_and_b32 v97, 0xffff0000, v104
    v_lshlrev_b32 v104, 16, v136
    v_and_b32 v105, 0xffff0000, v136
    v_mul_f32 v96, v96, v104
    v_mul_f32 v97, v97, v105
    v_cvt_pk_bf16_f32 v104, v96, v97
    v_lshlrev_b32 v96, 16, v104
    v_and_b32 v97, 0xffff0000, v104
    v_lshlrev_b32 v104, 16, v108
    v_and_b32 v105, 0xffff0000, v108
    v_add_f32 v96, v96, v104
    v_add_f32 v97, v97, v105
    v_cvt_pk_bf16_f32 v112, v96, v97
    v_cvt_pk_bf16_f32 v104, v98, v99
    v_lshlrev_b32 v98, 16, v104
    v_and_b32 v99, 0xffff0000, v104
    v_lshlrev_b32 v104, 16, v137
    v_and_b32 v105, 0xffff0000, v137
    v_mul_f32 v98, v98, v104
    v_mul_f32 v99, v99, v105
    v_cvt_pk_bf16_f32 v104, v98, v99
    v_lshlrev_b32 v98, 16, v104
    v_and_b32 v99, 0xffff0000, v104
    v_lshlrev_b32 v104, 16, v109
    v_and_b32 v105, 0xffff0000, v109
    v_add_f32 v98, v98, v104
    v_add_f32 v99, v99, v105
    v_cvt_pk_bf16_f32 v113, v98, v99
    v_cvt_pk_bf16_f32 v104, v100, v101
    v_lshlrev_b32 v100, 16, v104
    v_and_b32 v101, 0xffff0000, v104
    v_lshlrev_b32 v104, 16, v138
    v_and_b32 v105, 0xffff0000, v138
    v_mul_f32 v100, v100, v104
    v_mul_f32 v101, v101, v105
    v_cvt_pk_bf16_f32 v104, v100, v101
    v_lshlrev_b32 v100, 16, v104
    v_and_b32 v101, 0xffff0000, v104
    v_lshlrev_b32 v104, 16, v110
    v_and_b32 v105, 0xffff0000, v110
    v_add_f32 v100, v100, v104
    v_add_f32 v101, v101, v105
    v_cvt_pk_bf16_f32 v114, v100, v101
    v_cvt_pk_bf16_f32 v104, v102, v103
    v_lshlrev_b32 v102, 16, v104
    v_and_b32 v103, 0xffff0000, v104
    v_lshlrev_b32 v104, 16, v139
    v_and_b32 v105, 0xffff0000, v139
    v_mul_f32 v102, v102, v104
    v_mul_f32 v103, v103, v105
    v_cvt_pk_bf16_f32 v104, v102, v103
    v_lshlrev_b32 v102, 16, v104
    v_and_b32 v103, 0xffff0000, v104
    v_lshlrev_b32 v104, 16, v111
    v_and_b32 v105, 0xffff0000, v111
    v_add_f32 v102, v102, v104
    v_add_f32 v103, v103, v105
    v_cvt_pk_bf16_f32 v115, v102, v103
    v_cndmask_b32 v128, v112, v114, s[76:77]
    v_cndmask_b32 v129, v113, v115, s[76:77]
    v_cndmask_b32 v130, v114, v112, s[76:77]
    v_cndmask_b32 v131, v115, v113, s[76:77]
    buffer_store_dwordx4 v[128:131], v4, s[12:15], s74 offen offset:0
    v_lshlrev_b32 v96, 16, v48
    v_and_b32 v97, 0xffff0000, v48
    v_lshlrev_b32 v98, 16, v49
    v_and_b32 v99, 0xffff0000, v49
    v_lshlrev_b32 v100, 16, v50
    v_and_b32 v101, 0xffff0000, v50
    v_lshlrev_b32 v102, 16, v51
    v_and_b32 v103, 0xffff0000, v51
    v_lshlrev_b32 v120, 16, v52
    v_and_b32 v121, 0xffff0000, v52
    v_lshlrev_b32 v122, 16, v53
    v_and_b32 v123, 0xffff0000, v53
    v_lshlrev_b32 v124, 16, v54
    v_and_b32 v125, 0xffff0000, v54
    v_lshlrev_b32 v126, 16, v55
    v_and_b32 v127, 0xffff0000, v55
    v_add_f32 v96, v96, v120
    v_add_f32 v97, v97, v121
    v_add_f32 v98, v98, v122
    v_add_f32 v99, v99, v123
    v_add_f32 v100, v100, v124
    v_add_f32 v101, v101, v125
    v_add_f32 v102, v102, v126
    v_add_f32 v103, v103, v127
    v_lshlrev_b32 v120, 16, v56
    v_and_b32 v121, 0xffff0000, v56
    v_lshlrev_b32 v122, 16, v57
    v_and_b32 v123, 0xffff0000, v57
    v_lshlrev_b32 v124, 16, v58
    v_and_b32 v125, 0xffff0000, v58
    v_lshlrev_b32 v126, 16, v59
    v_and_b32 v127, 0xffff0000, v59
    v_add_f32 v96, v96, v120
    v_add_f32 v97, v97, v121
    v_add_f32 v98, v98, v122
    v_add_f32 v99, v99, v123
    v_add_f32 v100, v100, v124
    v_add_f32 v101, v101, v125
    v_add_f32 v102, v102, v126
    v_add_f32 v103, v103, v127
    v_lshlrev_b32 v120, 16, v60
    v_and_b32 v121, 0xffff0000, v60
    v_lshlrev_b32 v122, 16, v61
    v_and_b32 v123, 0xffff0000, v61
    v_lshlrev_b32 v124, 16, v62
    v_and_b32 v125, 0xffff0000, v62
    v_lshlrev_b32 v126, 16, v63
    v_and_b32 v127, 0xffff0000, v63
    v_add_f32 v96, v96, v120
    v_add_f32 v97, v97, v121
    v_add_f32 v98, v98, v122
    v_add_f32 v99, v99, v123
    v_add_f32 v100, v100, v124
    v_add_f32 v101, v101, v125
    v_add_f32 v102, v102, v126
    v_add_f32 v103, v103, v127
    v_lshlrev_b32 v120, 16, v64
    v_and_b32 v121, 0xffff0000, v64
    v_lshlrev_b32 v122, 16, v65
    v_and_b32 v123, 0xffff0000, v65
    v_lshlrev_b32 v124, 16, v66
    v_and_b32 v125, 0xffff0000, v66
    v_lshlrev_b32 v126, 16, v67
    v_and_b32 v127, 0xffff0000, v67
    v_add_f32 v96, v96, v120
    v_add_f32 v97, v97, v121
    v_add_f32 v98, v98, v122
    v_add_f32 v99, v99, v123
    v_add_f32 v100, v100, v124
    v_add_f32 v101, v101, v125
    v_add_f32 v102, v102, v126
    v_add_f32 v103, v103, v127
    v_lshlrev_b32 v120, 16, v68
    v_and_b32 v121, 0xffff0000, v68
    v_lshlrev_b32 v122, 16, v69
    v_and_b32 v123, 0xffff0000, v69
    v_lshlrev_b32 v124, 16, v70
    v_and_b32 v125, 0xffff0000, v70
    v_lshlrev_b32 v126, 16, v71
    v_and_b32 v127, 0xffff0000, v71
    v_add_f32 v96, v96, v120
    v_add_f32 v97, v97, v121
    v_add_f32 v98, v98, v122
    v_add_f32 v99, v99, v123
    v_add_f32 v100, v100, v124
    v_add_f32 v101, v101, v125
    v_add_f32 v102, v102, v126
    v_add_f32 v103, v103, v127
    v_lshlrev_b32 v120, 16, v72
    v_and_b32 v121, 0xffff0000, v72
    v_lshlrev_b32 v122, 16, v73
    v_and_b32 v123, 0xffff0000, v73
    v_lshlrev_b32 v124, 16, v74
    v_and_b32 v125, 0xffff0000, v74
    v_lshlrev_b32 v126, 16, v75
    v_and_b32 v127, 0xffff0000, v75
    v_add_f32 v96, v96, v120
    v_add_f32 v97, v97, v121
    v_add_f32 v98, v98, v122
    v_add_f32 v99, v99, v123
    v_add_f32 v100, v100, v124
    v_add_f32 v101, v101, v125
    v_add_f32 v102, v102, v126
    v_add_f32 v103, v103, v127
    v_lshlrev_b32 v120, 16, v76
    v_and_b32 v121, 0xffff0000, v76
    v_lshlrev_b32 v122, 16, v77
    v_and_b32 v123, 0xffff0000, v77
    v_lshlrev_b32 v124, 16, v78
    v_and_b32 v125, 0xffff0000, v78
    v_lshlrev_b32 v126, 16, v79
    v_and_b32 v127, 0xffff0000, v79
    v_add_f32 v96, v96, v120
    v_add_f32 v97, v97, v121
    v_add_f32 v98, v98, v122
    v_add_f32 v99, v99, v123
    v_add_f32 v100, v100, v124
    v_add_f32 v101, v101, v125
    v_add_f32 v102, v102, v126
    v_add_f32 v103, v103, v127
    v_cndmask_b32 v108, v92, v94, s[76:77]
    v_cndmask_b32 v109, v93, v95, s[76:77]
    v_cndmask_b32 v110, v94, v92, s[76:77]
    v_cndmask_b32 v111, v95, v93, s[76:77]
    v_cvt_pk_bf16_f32 v104, v96, v97
    v_lshlrev_b32 v96, 16, v104
    v_and_b32 v97, 0xffff0000, v104
    v_lshlrev_b32 v104, 16, v140
    v_and_b32 v105, 0xffff0000, v140
    v_mul_f32 v96, v96, v104
    v_mul_f32 v97, v97, v105
    v_cvt_pk_bf16_f32 v104, v96, v97
    v_lshlrev_b32 v96, 16, v104
    v_and_b32 v97, 0xffff0000, v104
    v_lshlrev_b32 v104, 16, v108
    v_and_b32 v105, 0xffff0000, v108
    v_add_f32 v96, v96, v104
    v_add_f32 v97, v97, v105
    v_cvt_pk_bf16_f32 v112, v96, v97
    v_cvt_pk_bf16_f32 v104, v98, v99
    v_lshlrev_b32 v98, 16, v104
    v_and_b32 v99, 0xffff0000, v104
    v_lshlrev_b32 v104, 16, v141
    v_and_b32 v105, 0xffff0000, v141
    v_mul_f32 v98, v98, v104
    v_mul_f32 v99, v99, v105
    v_cvt_pk_bf16_f32 v104, v98, v99
    v_lshlrev_b32 v98, 16, v104
    v_and_b32 v99, 0xffff0000, v104
    v_lshlrev_b32 v104, 16, v109
    v_and_b32 v105, 0xffff0000, v109
    v_add_f32 v98, v98, v104
    v_add_f32 v99, v99, v105
    v_cvt_pk_bf16_f32 v113, v98, v99
    v_cvt_pk_bf16_f32 v104, v100, v101
    v_lshlrev_b32 v100, 16, v104
    v_and_b32 v101, 0xffff0000, v104
    v_lshlrev_b32 v104, 16, v142
    v_and_b32 v105, 0xffff0000, v142
    v_mul_f32 v100, v100, v104
    v_mul_f32 v101, v101, v105
    v_cvt_pk_bf16_f32 v104, v100, v101
    v_lshlrev_b32 v100, 16, v104
    v_and_b32 v101, 0xffff0000, v104
    v_lshlrev_b32 v104, 16, v110
    v_and_b32 v105, 0xffff0000, v110
    v_add_f32 v100, v100, v104
    v_add_f32 v101, v101, v105
    v_cvt_pk_bf16_f32 v114, v100, v101
    v_cvt_pk_bf16_f32 v104, v102, v103
    v_lshlrev_b32 v102, 16, v104
    v_and_b32 v103, 0xffff0000, v104
    v_lshlrev_b32 v104, 16, v143
    v_and_b32 v105, 0xffff0000, v143
    v_mul_f32 v102, v102, v104
    v_mul_f32 v103, v103, v105
    v_cvt_pk_bf16_f32 v104, v102, v103
    v_lshlrev_b32 v102, 16, v104
    v_and_b32 v103, 0xffff0000, v104
    v_lshlrev_b32 v104, 16, v111
    v_and_b32 v105, 0xffff0000, v111
    v_add_f32 v102, v102, v104
    v_add_f32 v103, v103, v105
    v_cvt_pk_bf16_f32 v115, v102, v103
    v_cndmask_b32 v132, v112, v114, s[76:77]
    v_cndmask_b32 v133, v113, v115, s[76:77]
    v_cndmask_b32 v134, v114, v112, s[76:77]
    v_cndmask_b32 v135, v115, v113, s[76:77]
    buffer_store_dwordx4 v[132:135], v4, s[12:15], s74 offen offset:64
    s_branch w_fin_done
fin_tail:
    s_mov_b32 s81, s36
    s_lshl_b32 s81, s81, 2
    s_and_b32 s82, s3, 3
    s_add_u32 s81, s81, s82
    s_lshr_b32 s82, s81, 5
    s_and_b32 s81, s81, 31
    s_lshl_b32 s72, s80, 1
    s_add_u32 s72, s72, s82
    s_lshl_b32 s74, s72, 15
    s_lshl_b32 s73, s81, 10
    s_add_u32 s73, s73, s74
    s_lshl_b32 s75, s81, 6
    s_add_u32 s74, s74, s75
    s_add_u32 s78, s73, 117440512
    s_add_u32 s79, s73, 75497472
    s_mov_b32 s83, 218106816
    s_mov_b32 s84, 65536
    s_min_u32 s87, s80, 62
    v_and_b32 v8, 7, v1
    v_lshlrev_b32 v8, 22, v8
    s_cmp_lg_u32 s3, 0
    s_cbranch_scc1 ft_ok
ft_wd:
    buffer_load_dword v7, off, s[4:7], s83 sc1
    s_waitcnt vmcnt(0)
    v_readfirstlane_b32 s86, v7
    s_cmp_ge_u32 s86, 16
    s_cbranch_scc1 ft_wdok
    s_sleep 32
    s_sub_u32 s84, s84, 1
    s_cbranch_scc0 ft_wd
    s_mov_b32 s84, 0
ft_wdok:
ft_ok:
    s_barrier
    s_cmp_ge_u32 s3, 4
    s_cbranch_scc1 w_fin_done
    buffer_load_dwordx4 v[88:91], v4, s[8:11], s74 offen
    buffer_load_dwordx4 v[136:139], v3, s[4:7], s78 offen sc1
    s_add_u32 s78, s78, 4194304
    buffer_load_dwordx4 v[144:147], v3, s[4:7], s78 offen sc1
    s_add_u32 s78, s78, 4194304
    buffer_load_dwordx4 v[152:155], v3, s[4:7], s78 offen sc1
    s_add_u32 s78, s78, 4194304
    buffer_load_dwordx4 v[160:163], v3, s[4:7], s78 offen sc1
    s_add_u32 s78, s78, 4194304
    s_waitcnt vmcnt(0)
    v_lshlrev_b32 v120, 16, v136
    v_and_b32 v121, 0xffff0000, v136
    v_lshlrev_b32 v136, 16, v144
    v_and_b32 v144, 0xffff0000, v144
    v_add_f32 v120, v120, v136
    v_add_f32 v121, v121, v144
    v_lshlrev_b32 v136, 16, v152
    v_and_b32 v152, 0xffff0000, v152
    v_add_f32 v120, v120, v136
    v_add_f32 v121, v121, v152
    v_lshlrev_b32 v136, 16, v160
    v_and_b32 v160, 0xffff0000, v160
    v_add_f32 v120, v120, v136
    v_add_f32 v121, v121, v160
    v_cvt_pk_bf16_f32 v136, v120, v121
    v_lshlrev_b32 v120, 16, v136
    v_and_b32 v121, 0xffff0000, v136
    v_mul_f32 v136, s89, v120
    v_mul_f32 v144, s89, v121
    v_lshlrev_b32 v122, 16, v137
    v_and_b32 v123, 0xffff0000, v137
    v_lshlrev_b32 v137, 16, v145
    v_and_b32 v145, 0xffff0000, v145
    v_add_f32 v122, v122, v137
    v_add_f32 v123, v123, v145
    v_lshlrev_b32 v137, 16, v153
    v_and_b32 v153, 0xffff0000, v153
    v_add_f32 v122, v122, v137
    v_add_f32 v123, v123, v153
    v_lshlrev_b32 v137, 16, v161
    v_and_b32 v161, 0xffff0000, v161
    v_add_f32 v122, v122, v137
    v_add_f32 v123, v123, v161
    v_cvt_pk_bf16_f32 v137, v122, v123
    v_lshlrev_b32 v122, 16, v137
    v_and_b32 v123, 0xffff0000, v137
    v_mul_f32 v137, s89, v122
    v_mul_f32 v145, s89, v123
    v_lshlrev_b32 v124, 16, v138
    v_and_b32 v125, 0xffff0000, v138
    v_lshlrev_b32 v138, 16, v146
    v_and_b32 v146, 0xffff0000, v146
    v_add_f32 v124, v124, v138
    v_add_f32 v125, v125, v146
    v_lshlrev_b32 v138, 16, v154
    v_and_b32 v154, 0xffff0000, v154
    v_add_f32 v124, v124, v138
    v_add_f32 v125, v125, v154
    v_lshlrev_b32 v138, 16, v162
    v_and_b32 v162, 0xffff0000, v162
    v_add_f32 v124, v124, v138
    v_add_f32 v125, v125, v162
    v_cvt_pk_bf16_f32 v138, v124, v125
    v_lshlrev_b32 v124, 16, v138
    v_and_b32 v125, 0xffff0000, v138
    v_mul_f32 v138, s89, v124
    v_mul_f32 v146, s89, v125
    v_lshlrev_b32 v126, 16, v139
    v_and_b32 v127, 0xffff0000, v139
    v_lshlrev_b32 v139, 16, v147
    v_and_b32 v147, 0xffff0000, v147
    v_add_f32 v126, v126, v139
    v_add_f32 v127, v127, v147
    v_lshlrev_b32 v139, 16, v155
    v_and_b32 v155, 0xffff0000, v155
    v_add_f32 v126, v126, v139
    v_add_f32 v127, v127, v155
    v_lshlrev_b32 v139, 16, v163
    v_and_b32 v163, 0xffff0000, v163
    v_add_f32 v126, v126, v139
    v_add_f32 v127, v127, v163
    v_cvt_pk_bf16_f32 v139, v126, v127
    v_lshlrev_b32 v126, 16, v139
    v_and_b32 v127, 0xffff0000, v139
    v_mul_f32 v139, s89, v126
    v_mul_f32 v147, s89, v127
    v_exp_f32 v136, v136
    v_exp_f32 v144, v144
    v_exp_f32 v137, v137
    v_exp_f32 v145, v145
    v_exp_f32 v138, v138
    v_exp_f32 v146, v146
    v_exp_f32 v139, v139
    v_exp_f32 v147, v147
    s_nop 0
    v_add_f32 v136, 1.0, v136
    v_add_f32 v144, 1.0, v144
    v_add_f32 v137, 1.0, v137
    v_add_f32 v145, 1.0, v145
    v_add_f32 v138, 1.0, v138
    v_add_f32 v146, 1.0, v146
    v_add_f32 v139, 1.0, v139
    v_add_f32 v147, 1.0, v147
    v_rcp_f32 v136, v136
    v_rcp_f32 v144, v144
    v_rcp_f32 v137, v137
    v_rcp_f32 v145, v145
    v_rcp_f32 v138, v138
    v_rcp_f32 v146, v146
    v_rcp_f32 v139, v139
    v_rcp_f32 v147, v147
    s_nop 0
    v_mul_f32 v120, v120, v136
    v_mul_f32 v121, v121, v144
    v_cvt_pk_bf16_f32 v136, v120, v121
    v_mul_f32 v122, v122, v137
    v_mul_f32 v123, v123, v145
    v_cvt_pk_bf16_f32 v137, v122, v123
    v_mul_f32 v124, v124, v138
    v_mul_f32 v125, v125, v146
    v_cvt_pk_bf16_f32 v138, v124, v125
    v_mul_f32 v126, v126, v139
    v_mul_f32 v127, v127, v147
    v_cvt_pk_bf16_f32 v139, v126, v127
ft_ws:
    buffer_load_dword v7, v6, s[4:7], s85 offen sc1
    s_waitcnt vmcnt(0)
    v_cmp_gt_u32 vcc, s87, v7
    s_cbranch_vccz ft_p
    s_sleep 12
    v_cmp_gt_u32 vcc, 59, v7
    s_cbranch_vccz ft_wsf
    s_sleep 64
    v_cmp_gt_u32 vcc, 56, v7
    s_cbranch_vccz ft_wsf
    s_sleep 127
    s_sleep 127
ft_wsf:
    s_sub_u32 s84, s84, 1
    s_cbranch_scc0 ft_ws
    s_mov_b32 s84, 0
ft_p:
    buffer_load_dword v7, v8, s[4:7], s79 offen offset:1008 sc1
    s_waitcnt vmcnt(0)
    v_cmp_eq_u32 vcc, -1, v7
    s_cbranch_vccz ft_l0
    s_sleep 4
    s_sub_u32 s84, s84, 1
    s_cbranch_scc0 ft_p
    s_mov_b32 s84, 0
ft_l0:
    s_cmp_lg_u32 s3, 0
    s_cbranch_scc1 clm_17
    v_mov_b32 v250, 1
    s_mov_b64 exec, 1
    buffer_atomic_add v250, off, s[64:67], s71 sc0 sc1
    s_mov_b64 exec, -1
clm_17:
ft_l:
    s_mov_b32 s86, s79
    buffer_load_dwordx4 v[16:19], v3, s[4:7], s86 offen sc1
    s_add_u32 s86, s86, 4194304
    buffer_load_dwordx4 v[20:23], v3, s[4:7], s86 offen sc1
    s_add_u32 s86, s86, 4194304
    buffer_load_dwordx4 v[24:27], v3, s[4:7], s86 offen sc1
    s_add_u32 s86, s86, 4194304
    buffer_load_dwordx4 v[28:31], v3, s[4:7], s86 offen sc1
    s_add_u32 s86, s86, 4194304
    buffer_load_dwordx4 v[32:35], v3, s[4:7], s86 offen sc1
    s_add_u32 s86, s86, 4194304
    buffer_load_dwordx4 v[36:39], v3, s[4:7], s86 offen sc1
    s_add_u32 s86, s86, 4194304
    buffer_load_dwordx4 v[40:43], v3, s[4:7], s86 offen sc1
    s_add_u32 s86, s86, 4194304
    buffer_load_dwordx4 v[44:47], v3, s[4:7], s86 offen sc1
    s_waitcnt vmcnt(0)
    v_max3_u32 v7, v16, v20, v24
    v_max3_u32 v7, v7, v28, v32
    v_max3_u32 v7, v7, v36, v40
    v_max_u32 v7, v7, v44
    v_cmp_eq_u32 vcc, -1, v7
    s_cbranch_vccz ft_go
    s_sub_u32 s84, s84, 1
    s_cbranch_scc0 ft_l
ft_go:
    v_lshlrev_b32 v96, 16, v16
    v_and_b32 v97, 0xffff0000, v16
    v_lshlrev_b32 v98, 16, v17
    v_and_b32 v99, 0xffff0000, v17
    v_lshlrev_b32 v100, 16, v18
    v_and_b32 v101, 0xffff0000, v18
    v_lshlrev_b32 v102, 16, v19
    v_and_b32 v103, 0xffff0000, v19
    v_lshlrev_b32 v120, 16, v20
    v_and_b32 v121, 0xffff0000, v20
    v_lshlrev_b32 v122, 16, v21
    v_and_b32 v123, 0xffff0000, v21
    v_lshlrev_b32 v124, 16, v22
    v_and_b32 v125, 0xffff0000, v22
    v_lshlrev_b32 v126, 16, v23
    v_and_b32 v127, 0xffff0000, v23
    v_add_f32 v96, v96, v120
    v_add_f32 v97, v97, v121
    v_add_f32 v98, v98, v122
    v_add_f32 v99, v99, v123
    v_add_f32 v100, v100, v124
    v_add_f32 v101, v101, v125
    v_add_f32 v102, v102, v126
    v_add_f32 v103, v103, v127
    v_lshlrev_b32 v120, 16, v24
    v_and_b32 v121, 0xffff0000, v24
    v_lshlrev_b32 v122, 16, v25
    v_and_b32 v123, 0xffff0000, v25
    v_lshlrev_b32 v124, 16, v26
    v_and_b32 v125, 0xffff0000, v26
    v_lshlrev_b32 v126, 16, v27
    v_and_b32 v127, 0xffff0000, v27
    v_add_f32 v96, v96, v120
    v_add_f32 v97, v97, v121
    v_add_f32 v98, v98, v122
    v_add_f32 v99, v99, v123
    v_add_f32 v100, v100, v124
    v_add_f32 v101, v101, v125
    v_add_f32 v102, v102, v126
    v_add_f32 v103, v103, v127
    v_lshlrev_b32 v120, 16, v28
    v_and_b32 v121, 0xffff0000, v28
    v_lshlrev_b32 v122, 16, v29
    v_and_b32 v123, 0xffff0000, v29
    v_lshlrev_b32 v124, 16, v30
    v_and_b32 v125, 0xffff0000, v30
    v_lshlrev_b32 v126, 16, v31
    v_and_b32 v127, 0xffff0000, v31
    v_add_f32 v96, v96, v120
    v_add_f32 v97, v97, v121
    v_add_f32 v98, v98, v122
    v_add_f32 v99, v99, v123
    v_add_f32 v100, v100, v124
    v_add_f32 v101, v101, v125
    v_add_f32 v102, v102, v126
    v_add_f32 v103, v103, v127
    v_lshlrev_b32 v120, 16, v32
    v_and_b32 v121, 0xffff0000, v32
    v_lshlrev_b32 v122, 16, v33
    v_and_b32 v123, 0xffff0000, v33
    v_lshlrev_b32 v124, 16, v34
    v_and_b32 v125, 0xffff0000, v34
    v_lshlrev_b32 v126, 16, v35
    v_and_b32 v127, 0xffff0000, v35
    v_add_f32 v96, v96, v120
    v_add_f32 v97, v97, v121
    v_add_f32 v98, v98, v122
    v_add_f32 v99, v99, v123
    v_add_f32 v100, v100, v124
    v_add_f32 v101, v101, v125
    v_add_f32 v102, v102, v126
    v_add_f32 v103, v103, v127
    v_lshlrev_b32 v120, 16, v36
    v_and_b32 v121, 0xffff0000, v36
    v_lshlrev_b32 v122, 16, v37
    v_and_b32 v123, 0xffff0000, v37
    v_lshlrev_b32 v124, 16, v38
    v_and_b32 v125, 0xffff0000, v38
    v_lshlrev_b32 v126, 16, v39
    v_and_b32 v127, 0xffff0000, v39
    v_add_f32 v96, v96, v120
    v_add_f32 v97, v97, v121
    v_add_f32 v98, v98, v122
    v_add_f32 v99, v99, v123
    v_add_f32 v100, v100, v124
    v_add_f32 v101, v101, v125
    v_add_f32 v102, v102, v126
    v_add_f32 v103, v103, v127
    v_lshlrev_b32 v120, 16, v40
    v_and_b32 v121, 0xffff0000, v40
    v_lshlrev_b32 v122, 16, v41
    v_and_b32 v123, 0xffff0000, v41
    v_lshlrev_b32 v124, 16, v42
    v_and_b32 v125, 0xffff0000, v42
    v_lshlrev_b32 v126, 16, v43
    v_and_b32 v127, 0xffff0000, v43
    v_add_f32 v96, v96, v120
    v_add_f32 v97, v97, v121
    v_add_f32 v98, v98, v122
    v_add_f32 v99, v99, v123
    v_add_f32 v100, v100, v124
    v_add_f32 v101, v101, v125
    v_add_f32 v102, v102, v126
    v_add_f32 v103, v103, v127
    v_lshlrev_b32 v120, 16, v44
    v_and_b32 v121, 0xffff0000, v44
    v_lshlrev_b32 v122, 16, v45
    v_and_b32 v123, 0xffff0000, v45
    v_lshlrev_b32 v124, 16, v46
    v_and_b32 v125, 0xffff0000, v46
    v_lshlrev_b32 v126, 16, v47
    v_and_b32 v127, 0xffff0000, v47
    v_add_f32 v96, v96, v120
    v_add_f32 v97, v97, v121
    v_add_f32 v98, v98, v122
    v_add_f32 v99, v99, v123
    v_add_f32 v100, v100, v124
    v_add_f32 v101, v101, v125
    v_add_f32 v102, v102, v126
    v_add_f32 v103, v103, v127
    v_cndmask_b32 v108, v88, v90, s[76:77]
    v_cndmask_b32 v109, v89, v91, s[76:77]
    v_cndmask_b32 v110, v90, v88, s[76:77]
    v_cndmask_b32 v111, v91, v89, s[76:77]
    v_cvt_pk_bf16_f32 v104, v96, v97
    v_lshlrev_b32 v96, 16, v104
    v_and_b32 v97, 0xffff0000, v104
    v_lshlrev_b32 v104, 16, v136
    v_and_b32 v105, 0xffff0000, v136
    v_mul_f32 v96, v96, v104
    v_mul_f32 v97, v97, v105
    v_cvt_pk_bf16_f32 v104, v96, v97
    v_lshlrev_b32 v96, 16, v104
    v_and_b32 v97, 0xffff0000, v104
    v_lshlrev_b32 v104, 16, v108
    v_and_b32 v105, 0xffff0000, v108
    v_add_f32 v96, v96, v104
    v_add_f32 v97, v97, v105
    v_cvt_pk_bf16_f32 v112, v96, v97
    v_cvt_pk_bf16_f32 v104, v98, v99
    v_lshlrev_b32 v98, 16, v104
    v_and_b32 v99, 0xffff0000, v104
    v_lshlrev_b32 v104, 16, v137
    v_and_b32 v105, 0xffff0000, v137
    v_mul_f32 v98, v98, v104
    v_mul_f32 v99, v99, v105
    v_cvt_pk_bf16_f32 v104, v98, v99
    v_lshlrev_b32 v98, 16, v104
    v_and_b32 v99, 0xffff0000, v104
    v_lshlrev_b32 v104, 16, v109
    v_and_b32 v105, 0xffff0000, v109
    v_add_f32 v98, v98, v104
    v_add_f32 v99, v99, v105
    v_cvt_pk_bf16_f32 v113, v98, v99
    v_cvt_pk_bf16_f32 v104, v100, v101
    v_lshlrev_b32 v100, 16, v104
    v_and_b32 v101, 0xffff0000, v104
    v_lshlrev_b32 v104, 16, v138
    v_and_b32 v105, 0xffff0000, v138
    v_mul_f32 v100, v100, v104
    v_mul_f32 v101, v101, v105
    v_cvt_pk_bf16_f32 v104, v100, v101
    v_lshlrev_b32 v100, 16, v104
    v_and_b32 v101, 0xffff0000, v104
    v_lshlrev_b32 v104, 16, v110
    v_and_b32 v105, 0xffff0000, v110
    v_add_f32 v100, v100, v104
    v_add_f32 v101, v101, v105
    v_cvt_pk_bf16_f32 v114, v100, v101
    v_cvt_pk_bf16_f32 v104, v102, v103
    v_lshlrev_b32 v102, 16, v104
    v_and_b32 v103, 0xffff0000, v104
    v_lshlrev_b32 v104, 16, v139
    v_and_b32 v105, 0xffff0000, v139
    v_mul_f32 v102, v102, v104
    v_mul_f32 v103, v103, v105
    v_cvt_pk_bf16_f32 v104, v102, v103
    v_lshlrev_b32 v102, 16, v104
    v_and_b32 v103, 0xffff0000, v104
    v_lshlrev_b32 v104, 16, v111
    v_and_b32 v105, 0xffff0000, v111
    v_add_f32 v102, v102, v104
    v_add_f32 v103, v103, v105
    v_cvt_pk_bf16_f32 v115, v102, v103
    v_cndmask_b32 v128, v112, v114, s[76:77]
    v_cndmask_b32 v129, v113, v115, s[76:77]
    v_cndmask_b32 v130, v114, v112, s[76:77]
    v_cndmask_b32 v131, v115, v113, s[76:77]
    buffer_store_dwordx4 v[128:131], v4, s[12:15], s74 offen offset:0
    s_branch w_fin_done
w_fin_done:
    s_cmp_lg_u32 s3, 0
    s_cbranch_scc1 pub_18
    v_mov_b32 v20, 131136
    s_mov_b64 exec, 1
    ds_write_b32 v20, v250
    s_mov_b64 exec, -1
    s_waitcnt lgkmcnt(0)
pub_18:
    s_barrier
    v_mov_b32 v20, 131136
    ds_read_b32 v20, v20
    s_waitcnt lgkmcnt(0)
    v_readfirstlane_b32 s59, v20
    s_add_u32 s59, s59, 32
    s_min_u32 s59, s59, 319
    s_lshl_b32 s57, s59, 6
    s_load_dwordx16 s[32:47], s[24:25], s57
    s_waitcnt lgkmcnt(0)
    s_barrier
    s_sub_u32 s57, s32, 1
    s_cmp_ge_u32 s57, 5
    s_cbranch_scc1 w_cold
    v_and_b32 v20, 63, v0
    v_lshlrev_b32 v1, 4, v20
    v_add_u32 v19, 0x1000, v1
    v_lshrrev_b32 v4, 4, v20
    v_mov_b32 v17, 0
    v_mov_b32 v18, 1
    s_lshr_b32 s26, s3, 2
    s_and_b32 s27, s3, 3
    s_lshl_b32 s21, s3, 11
    s_lshl_b32 s22, s3, 10
    s_add_u32 s22, s22, 16384
    s_mov_b32 s11, 131072
    s_mov_b32 s15, 131072
    s_mov_b32 s28, 0
    v_and_b32 v21, 15, v20
    v_lshlrev_b32 v22, 2, v4
    v_xor_b32 v21, v21, v22
    s_lshr_b32 s30, s3, 1
    s_and_b32 s30, s30, 1
    v_xor_b32 v21, s30, v21
    v_lshlrev_b32 v3, 4, v21
    s_lshl_b32 s30, s26, 13
    v_add_u32 v5, s30, v1
    v_add_u32 v6, 0x10000, v5
    v_bfe_u32 v21, v20, 2, 2
    v_and_b32 v22, 3, v20
    v_and_b32 v23, 1, v4
    v_xor_b32 v24, s27, v21
    v_xor_b32 v25, v22, v23
    v_lshl_add_u32 v24, v24, 2, v25
    v_lshlrev_b32 v24, 4, v24
    v_lshl_add_u32 v25, v4, 3, v21
    v_lshl_add_u32 v24, v25, 8, v24
    v_and_b32 v22, 1, v22
    v_xor_b32 v25, 0, v23
    v_lshl_add_u32 v8, v25, 10, v24
    v_xor_b32 v25, 0, v22
    v_lshl_add_u32 v8, v25, 3, v8
    v_add_u32 v12, 0x10000, v8
    v_xor_b32 v25, 1, v23
    v_lshl_add_u32 v9, v25, 10, v24
    v_xor_b32 v25, 0, v22
    v_lshl_add_u32 v9, v25, 3, v9
    v_add_u32 v13, 0x10000, v9
    v_xor_b32 v25, 0, v23
    v_lshl_add_u32 v10, v25, 10, v24
    v_xor_b32 v25, 1, v22
    v_lshl_add_u32 v10, v25, 3, v10
    v_add_u32 v14, 0x10000, v10
    v_xor_b32 v25, 1, v23
    v_lshl_add_u32 v11, v25, 10, v24
    v_xor_b32 v25, 1, v22
    v_lshl_add_u32 v11, v25, 3, v11
    v_add_u32 v15, 0x10000, v11
    s_lshl_b32 s30, s3, 2
    s_add_u32 s30, s30, 131072
    v_mov_b32 v7, s30
    s_branch w_cold
chain_map:
    s_lshl_b32 s52, s12, 5
    s_add_u32 s52, s52, s13
    s_lshr_b32 s15, s52, 2
    s_lshr_b32 s14, s52, 4
    s_and_b32 s34, s13, 15
    s_and_b32 s53, s13, 3
    s_mov_b32 s16, 0
    s_mov_b32 s22, 131072
    s_mov_b32 s100, 131072
    s_getreg_b32 s40, hwreg(HW_REG_XCC_ID)
    s_and_b32 s40, s40, 15
    s_mul_i32 s19, s40, s40
    s_lshl_b32 s19, s19, 18
    s_lshl_b32 s40, s40, 8
    s_add_u32 s40, s40, s19
    s_add_u32 s40, s40, 1
    s_lshl_b32 s35, s14, 4
    s_add_u32 s35, s35, 218104320
    s_and_b32 s21, s3, 3
    s_mul_i32 s42, s21, 24576
    s_add_u32 s42, s42, 65536
    s_lshl_b32 s41, s14, 2
    s_add_u32 s41, s41, s21
    s_lshl_b32 s41, s41, 12
    s_add_u32 s101, s42, 8192
    s_bfe_u32 s17, s34, 0x20001
    s_cmp_eq_u32 s17, s21
    s_cselect_b32 s68, 20480, s42
    s_xor_b32 s68, s68, s101
    s_lshl_b32 s43, s21, 13
    s_add_u32 s43, s43, 138412032
    s_lshl_b32 s69, s21, 24
    s_lshl_b32 s17, s52, 10
    s_add_u32 s69, s69, s17
    s_add_u32 s69, s69, 20971520
    s_cmp_ge_u32 s3, 4
    s_cbranch_scc1 ch_a_pro
    s_add_u32 s41, s41, 262144
    s_lshl_b32 s38, s15, 13
    s_add_u32 s38, s38, 214958080
    s_lshl_b32 s17, s13, 1
    s_and_b32 s18, s3, 1
    s_add_u32 s17, s17, s18
    s_lshl_b32 s17, s17, 1
    s_cmp_lt_u32 s3, 2
    s_cselect_b32 s56, 0xff, 0
    s_mov_b32 s57, s56
    s_lshr_b32 s18, s17, 1
    s_and_b32 s19, s17, 1
    s_lshl_b32 s20, s12, 14
    s_add_u32 s20, s20, 213909504
    s_lshl_b32 s36, s3, 12
    s_add_u32 s36, s36, s20
    s_lshl_b32 s37, s18, 8
    s_add_u32 s37, s37, s20
    s_lshl_b32 s20, s19, 5
    s_add_u32 s37, s37, s20
    s_lshr_b32 s39, s17, 3
    s_lshl_b32 s39, s39, 14
    s_and_b32 s20, s17, 7
    s_lshl_b32 s20, s20, 10
    s_add_u32 s39, s39, s20
    s_add_u32 s39, s39, 209715200
    s_lshl_b32 s30, s14, 22
    s_lshl_b32 s20, s34, 11
    s_add_u32 s30, s30, s20
    s_lshl_b32 s20, s3, 9
    s_add_u32 s30, s30, s20
    s_add_u32 s30, s30, 78643200
    s_lshl_b32 s55, s15, 13
    s_add_u32 s55, s55, 192937984
    s_mov_b32 s26, s38
    s_mov_b32 s54, s30
    s_mov_b32 s29, 2
    s_mov_b32 s58, 0
    s_mov_b32 s59, 0
    s_bfe_u32 s17, s34, 0x20001
    s_lshl_b32 s60, s14, 2
    s_add_u32 s60, s60, s17
    s_lshl_b32 s60, s60, 2
    s_add_u32 s60, s60, s3
    s_lshl_b32 s60, s60, 10
    s_and_b32 s17, s34, 1
    s_lshl_b32 s17, s17, 17
    s_add_u32 s60, s60, s17
    s_add_u32 s60, s60, 175898624
    s_mov_b32 s31, 786432
    v_and_b32 v20, 63, v0
    v_lshlrev_b32 v1, 4, v20
    v_mov_b32 v10, -1
    v_mov_b32 v11, -1
    v_lshrrev_b32 v21, 2, v20
    v_and_b32 v22, 3, v20
    v_lshlrev_b32 v21, 13, v21
    v_lshl_add_u32 v21, v22, 4, v21
    s_lshl_b32 s17, s3, 21
    s_lshl_b32 s18, s52, 6
    s_add_u32 s17, s17, s18
    s_lshl_b32 s19, s3, 15
    s_mov_b32 s10, 8388608
    s_mov_b32 s11, 131072
    v_lshrrev_b32 v24, 5, v20
    v_bfe_u32 v25, v20, 3, 1
    v_lshl_add_u32 v24, v24, 1, v25
    v_bfe_u32 v26, v20, 4, 1
    v_xor_b32 v26, v26, v25
    v_lshl_add_u32 v24, v24, 1, v26
    v_bfe_u32 v25, v20, 2, 1
    v_lshl_add_u32 v24, v24, 2, v25
    v_lshlrev_b32 v24, 6, v24
    v_lshl_add_u32 v24, v22, 3, v24
    v_add_u32 v24, s19, v24
    s_and_b32 s70, s13, 0
    s_lshl_b32 s72, s70, 20
    s_lshl_b32 s73, s70, 21
    s_lshl_b32 s70, s70, 13
    s_sub_u32 s71, s19, s70
    s_add_u32 s70, s19, s70
    s_load_dwordx2 s[8:9], s[0:1], 16
    s_add_u32 s20, s17, s72
    s_waitcnt lgkmcnt(0)
    s_add_u32 m0, s70, 0
    s_nop 0
    buffer_load_dwordx4 v21, s[8:11], s20 offen lds
    s_add_u32 s20, s20, 131072
    s_add_u32 m0, s70, 1024
    s_nop 0
    buffer_load_dwordx4 v21, s[8:11], s20 offen lds
    s_add_u32 s20, s20, 131072
    s_barrier
    v_mov_b32 v27, 131136
    ds_read_b32 v27, v27
    s_mov_b32 s96, s97
    s_waitcnt lgkmcnt(0)
    v_readfirstlane_b32 s97, v27
    s_cmp_lg_u32 s96, s97
    s_cbranch_scc1 k_restart
    s_add_u32 m0, s70, 2048
    s_nop 0
    buffer_load_dwordx4 v21, s[8:11], s20 offen lds
    s_add_u32 s20, s20, 131072
    s_add_u32 m0, s70, 3072
    s_nop 0
    buffer_load_dwordx4 v21, s[8:11], s20 offen lds
    s_add_u32 s20, s20, 131072
    s_add_u32 m0, s70, 4096
    s_nop 0
    buffer_load_dwordx4 v21, s[8:11], s20 offen lds
    s_add_u32 s20, s20, 131072
    s_add_u32 m0, s70, 5120
    s_nop 0
    buffer_load_dwordx4 v21, s[8:11], s20 offen lds
    s_add_u32 s20, s20, 131072
    s_add_u32 m0, s70, 6144
    s_nop 0
    buffer_load_dwordx4 v21, s[8:11], s20 offen lds
    s_add_u32 s20, s20, 131072
    s_add_u32 m0, s70, 7168
    s_nop 0
    buffer_load_dwordx4 v21, s[8:11], s20 offen lds
    s_add_u32 s20, s20, 131072
    s_sub_u32 s20, s20, s73
    s_add_u32 m0, s71, 8192
    s_nop 0
    buffer_load_dwordx4 v21, s[8:11], s20 offen lds
    s_add_u32 s20, s20, 131072
    s_add_u32 m0, s71, 9216
    s_nop 0
    buffer_load_dwordx4 v21, s[8:11], s20 offen lds
    s_add_u32 s20, s20, 131072
    s_add_u32 m0, s71, 10240
    s_nop 0
    buffer_load_dwordx4 v21, s[8:11], s20 offen lds
    s_add_u32 s20, s20, 131072
    s_add_u32 m0, s71, 11264
    s_nop 0
    buffer_load_dwordx4 v21, s[8:11], s20 offen lds
    s_add_u32 s20, s20, 131072
    s_add_u32 m0, s71, 12288
    s_nop 0
    buffer_load_dwordx4 v21, s[8:11], s20 offen lds
    s_add_u32 s20, s20, 131072
    s_add_u32 m0, s71, 13312
    s_nop 0
    buffer_load_dwordx4 v21, s[8:11], s20 offen lds
    s_add_u32 s20, s20, 131072
    s_add_u32 m0, s71, 14336
    s_nop 0
    buffer_load_dwordx4 v21, s[8:11], s20 offen lds
    s_add_u32 s20, s20, 131072
    s_add_u32 m0, s71, 15360
    s_nop 0
    buffer_load_dwordx4 v21, s[8:11], s20 offen lds
    s_add_u32 s20, s20, 131072
    s_load_dwordx2 s[8:9], s[0:1], 24
    s_add_u32 s20, s17, s72
    s_waitcnt lgkmcnt(0)
    s_add_u32 m0, s70, 16384
    s_nop 0
    buffer_load_dwordx4 v21, s[8:11], s20 offen lds
    s_add_u32 s20, s20, 131072
    s_add_u32 m0, s70, 17408
    s_nop 0
    buffer_load_dwordx4 v21, s[8:11], s20 offen lds
    s_add_u32 s20, s20, 131072
    s_add_u32 m0, s70, 18432
    s_nop 0
    buffer_load_dwordx4 v21, s[8:11], s20 offen lds
    s_add_u32 s20, s20, 131072
    s_add_u32 m0, s70, 19456
    s_nop 0
    buffer_load_dwordx4 v21, s[8:11], s20 offen lds
    s_add_u32 s20, s20, 131072
    s_add_u32 m0, s70, 20480
    s_nop 0
    buffer_load_dwordx4 v21, s[8:11], s20 offen lds
    s_add_u32 s20, s20, 131072
    s_add_u32 m0, s70, 21504
    s_nop 0
    buffer_load_dwordx4 v21, s[8:11], s20 offen lds
    s_add_u32 s20, s20, 131072
    s_add_u32 m0, s70, 22528
    s_nop 0
    buffer_load_dwordx4 v21, s[8:11], s20 offen lds
    s_add_u32 s20, s20, 131072
    s_add_u32 m0, s70, 23552
    s_nop 0
    buffer_load_dwordx4 v21, s[8:11], s20 offen lds
    s_add_u32 s20, s20, 131072
    s_sub_u32 s20, s20, s73
    s_add_u32 m0, s71, 24576
    s_nop 0
    buffer_load_dwordx4 v21, s[8:11], s20 offen lds
    s_add_u32 s20, s20, 131072
    s_add_u32 m0, s71, 25600
    s_nop 0
    buffer_load_dwordx4 v21, s[8:11], s20 offen lds
    s_add_u32 s20, s20, 131072
    s_add_u32 m0, s71, 26624
    s_nop 0
    buffer_load_dwordx4 v21, s[8:11], s20 offen lds
    s_add_u32 s20, s20, 131072
    s_add_u32 m0, s71, 27648
    s_nop 0
    buffer_load_dwordx4 v21, s[8:11], s20 offen lds
    s_add_u32 s20, s20, 131072
    s_add_u32 m0, s71, 28672
    s_nop 0
    buffer_load_dwordx4 v21, s[8:11], s20 offen lds
    s_add_u32 s20, s20, 131072
    s_add_u32 m0, s71, 29696
    s_nop 0
    buffer_load_dwordx4 v21, s[8:11], s20 offen lds
    s_add_u32 s20, s20, 131072
    s_add_u32 m0, s71, 30720
    s_nop 0
    buffer_load_dwordx4 v21, s[8:11], s20 offen lds
    s_add_u32 s20, s20, 131072
    s_add_u32 m0, s71, 31744
    s_nop 0
    buffer_load_dwordx4 v21, s[8:11], s20 offen lds
    s_add_u32 s20, s20, 131072
    s_load_dwordx2 s[8:9], s[0:1], 32
    s_add_u32 s20, s17, s72
    s_waitcnt lgkmcnt(0)
    buffer_load_dwordx4 v[96:99], v21, s[8:11], s20 offen
    s_add_u32 s20, s20, 131072
    buffer_load_dwordx4 v[100:103], v21, s[8:11], s20 offen
    s_add_u32 s20, s20, 131072
    buffer_load_dwordx4 v[104:107], v21, s[8:11], s20 offen
    s_add_u32 s20, s20, 131072
    buffer_load_dwordx4 v[108:111], v21, s[8:11], s20 offen
    s_add_u32 s20, s20, 131072
    buffer_load_dwordx4 v[144:147], v21, s[8:11], s20 offen
    s_add_u32 s20, s20, 131072
    buffer_load_dwordx4 v[148:151], v21, s[8:11], s20 offen
    s_add_u32 s20, s20, 131072
    buffer_load_dwordx4 v[152:155], v21, s[8:11], s20 offen
    s_add_u32 s20, s20, 131072
    buffer_load_dwordx4 v[156:159], v21, s[8:11], s20 offen
    s_add_u32 s20, s20, 131072
    s_sub_u32 s20, s20, s73
    buffer_load_dwordx4 v[192:195], v21, s[8:11], s20 offen
    s_add_u32 s20, s20, 131072
    buffer_load_dwordx4 v[196:199], v21, s[8:11], s20 offen
    s_add_u32 s20, s20, 131072
    buffer_load_dwordx4 v[200:203], v21, s[8:11], s20 offen
    s_add_u32 s20, s20, 131072
    buffer_load_dwordx4 v[204:207], v21, s[8:11], s20 offen
    s_add_u32 s20, s20, 131072
    buffer_load_dwordx4 v[240:243], v21, s[8:11], s20 offen
    s_add_u32 s20, s20, 131072
    buffer_load_dwordx4 v[244:247], v21, s[8:11], s20 offen
    s_add_u32 s20, s20, 131072
    buffer_load_dwordx4 v[248:251], v21, s[8:11], s20 offen
    s_add_u32 s20, s20, 131072
    buffer_load_dwordx4 v[252:255], v21, s[8:11], s20 offen
    s_add_u32 s20, s20, 131072
    s_load_dwordx2 s[8:9], s[0:1], 8
    s_mov_b32 s10, 16384
    v_bfe_u32 v57, v20, 2, 2
    v_and_b32 v58, 1, v20
    v_lshl_add_u32 v57, v57, 1, v58
    v_lshlrev_b32 v57, 11, v57
    v_lshrrev_b32 v58, 4, v20
    v_lshl_add_u32 v57, v58, 5, v57
    v_bfe_u32 v58, v20, 1, 1
    v_lshl_add_u32 v57, v58, 4, v57
    v_lshl_add_u32 v59, v58, 3, v57
    v_xor_b32 v60, 8, v59
    s_lshl_b32 s20, s3, 9
    s_waitcnt lgkmcnt(0)
    buffer_load_dwordx2 v[32:33], v59, s[8:11], s20 offen offset:0
    buffer_load_dwordx2 v[34:35], v60, s[8:11], s20 offen offset:0
    buffer_load_dwordx2 v[36:37], v59, s[8:11], s20 offen offset:128
    buffer_load_dwordx2 v[38:39], v60, s[8:11], s20 offen offset:128
    buffer_load_dwordx2 v[40:41], v59, s[8:11], s20 offen offset:256
    buffer_load_dwordx2 v[42:43], v60, s[8:11], s20 offen offset:256
    buffer_load_dwordx2 v[44:45], v59, s[8:11], s20 offen offset:384
    buffer_load_dwordx2 v[46:47], v60, s[8:11], s20 offen offset:384
    s_barrier
    v_add_u32 v56, s70, v1
    v_add_u32 v26, s71, v1
    s_waitcnt vmcnt(40)
    ds_read_b64_tr_b16 v[64:65], v24 offset:0
    ds_read_b64_tr_b16 v[66:67], v24 offset:128
    ds_read_b64_tr_b16 v[68:69], v24 offset:2048
    ds_read_b64_tr_b16 v[70:71], v24 offset:2176
    ds_read_b64_tr_b16 v[72:73], v24 offset:32
    ds_read_b64_tr_b16 v[74:75], v24 offset:160
    ds_read_b64_tr_b16 v[76:77], v24 offset:2080
    ds_read_b64_tr_b16 v[78:79], v24 offset:2208
    s_waitcnt lgkmcnt(0)
    ds_read_b64_tr_b16 v[112:113], v24 offset:4096
    ds_read_b64_tr_b16 v[114:115], v24 offset:4224
    ds_read_b64_tr_b16 v[116:117], v24 offset:6144
    ds_read_b64_tr_b16 v[118:119], v24 offset:6272
    ds_read_b64_tr_b16 v[120:121], v24 offset:4128
    ds_read_b64_tr_b16 v[122:123], v24 offset:4256
    ds_read_b64_tr_b16 v[124:125], v24 offset:6176
    ds_read_b64_tr_b16 v[126:127], v24 offset:6304
    s_waitcnt lgkmcnt(0)
    ds_read_b64_tr_b16 v[160:161], v24 offset:8192
    ds_read_b64_tr_b16 v[162:163], v24 offset:8320
    ds_read_b64_tr_b16 v[164:165], v24 offset:10240
    ds_read_b64_tr_b16 v[166:167], v24 offset:10368
    ds_read_b64_tr_b16 v[168:169], v24 offset:8224
    ds_read_b64_tr_b16 v[170:171], v24 offset:8352
    ds_read_b64_tr_b16 v[172:173], v24 offset:10272
    ds_read_b64_tr_b16 v[174:175], v24 offset:10400
    s_waitcnt lgkmcnt(0)
    ds_read_b64_tr_b16 v[208:209], v24 offset:12288
    ds_read_b64_tr_b16 v[210:211], v24 offset:12416
    ds_read_b64_tr_b16 v[212:213], v24 offset:14336
    ds_read_b64_tr_b16 v[214:215], v24 offset:14464
    ds_read_b64_tr_b16 v[216:217], v24 offset:12320
    ds_read_b64_tr_b16 v[218:219], v24 offset:12448
    ds_read_b64_tr_b16 v[220:221], v24 offset:14368
    ds_read_b64_tr_b16 v[222:223], v24 offset:14496
    s_waitcnt lgkmcnt(0)
    s_waitcnt vmcnt(24)
    ds_read_b64_tr_b16 v[80:81], v24 offset:16384
    ds_read_b64_tr_b16 v[82:83], v24 offset:16512
    ds_read_b64_tr_b16 v[84:85], v24 offset:18432
    ds_read_b64_tr_b16 v[86:87], v24 offset:18560
    ds_read_b64_tr_b16 v[88:89], v24 offset:16416
    ds_read_b64_tr_b16 v[90:91], v24 offset:16544
    ds_read_b64_tr_b16 v[92:93], v24 offset:18464
    ds_read_b64_tr_b16 v[94:95], v24 offset:18592
    s_waitcnt lgkmcnt(0)
    ds_read_b64_tr_b16 v[128:129], v24 offset:20480
    ds_read_b64_tr_b16 v[130:131], v24 offset:20608
    ds_read_b64_tr_b16 v[132:133], v24 offset:22528
    ds_read_b64_tr_b16 v[134:135], v24 offset:22656
    ds_read_b64_tr_b16 v[136:137], v24 offset:20512
    ds_read_b64_tr_b16 v[138:139], v24 offset:20640
    ds_read_b64_tr_b16 v[140:141], v24 offset:22560
    ds_read_b64_tr_b16 v[142:143], v24 offset:22688
    s_waitcnt lgkmcnt(0)
    ds_read_b64_tr_b16 v[176:177], v24 offset:24576
    ds_read_b64_tr_b16 v[178:179], v24 offset:24704
    ds_read_b64_tr_b16 v[180:181], v24 offset:26624
    ds_read_b64_tr_b16 v[182:183], v24 offset:26752
    ds_read_b64_tr_b16 v[184:185], v24 offset:24608
    ds_read_b64_tr_b16 v[186:187], v24 offset:24736
    ds_read_b64_tr_b16 v[188:189], v24 offset:26656
    ds_read_b64_tr_b16 v[190:191], v24 offset:26784
    s_waitcnt lgkmcnt(0)
    ds_read_b64_tr_b16 v[224:225], v24 offset:28672
    ds_read_b64_tr_b16 v[226:227], v24 offset:28800
    ds_read_b64_tr_b16 v[228:229], v24 offset:30720
    ds_read_b64_tr_b16 v[230:231], v24 offset:30848
    ds_read_b64_tr_b16 v[232:233], v24 offset:28704
    ds_read_b64_tr_b16 v[234:235], v24 offset:28832
    ds_read_b64_tr_b16 v[236:237], v24 offset:30752
    ds_read_b64_tr_b16 v[238:239], v24 offset:30880
    s_waitcnt lgkmcnt(0)
    s_waitcnt vmcnt(8)
    ds_write_b128 v56, v[96:99] offset:0
    ds_write_b128 v56, v[100:103] offset:1024
    ds_write_b128 v56, v[104:107] offset:2048
    ds_write_b128 v56, v[108:111] offset:3072
    ds_write_b128 v56, v[144:147] offset:4096
    ds_write_b128 v56, v[148:151] offset:5120
    ds_write_b128 v56, v[152:155] offset:6144
    ds_write_b128 v56, v[156:159] offset:7168
    ds_write_b128 v26, v[192:195] offset:8192
    ds_write_b128 v26, v[196:199] offset:9216
    ds_write_b128 v26, v[200:203] offset:10240
    ds_write_b128 v26, v[204:207] offset:11264
    ds_write_b128 v26, v[240:243] offset:12288
    ds_write_b128 v26, v[244:247] offset:13312
    ds_write_b128 v26, v[248:251] offset:14336
    ds_write_b128 v26, v[252:255] offset:15360
    s_waitcnt lgkmcnt(0)
    ds_read_b64_tr_b16 v[96:97], v24 offset:0
    ds_read_b64_tr_b16 v[98:99], v24 offset:128
    ds_read_b64_tr_b16 v[100:101], v24 offset:2048
    ds_read_b64_tr_b16 v[102:103], v24 offset:2176
    ds_read_b64_tr_b16 v[104:105], v24 offset:32
    ds_read_b64_tr_b16 v[106:107], v24 offset:160
    ds_read_b64_tr_b16 v[108:109], v24 offset:2080
    ds_read_b64_tr_b16 v[110:111], v24 offset:2208
    s_waitcnt lgkmcnt(0)
    ds_read_b64_tr_b16 v[144:145], v24 offset:4096
    ds_read_b64_tr_b16 v[146:147], v24 offset:4224
    ds_read_b64_tr_b16 v[148:149], v24 offset:6144
    ds_read_b64_tr_b16 v[150:151], v24 offset:6272
    ds_read_b64_tr_b16 v[152:153], v24 offset:4128
    ds_read_b64_tr_b16 v[154:155], v24 offset:4256
    ds_read_b64_tr_b16 v[156:157], v24 offset:6176
    ds_read_b64_tr_b16 v[158:159], v24 offset:6304
    s_waitcnt lgkmcnt(0)
    ds_read_b64_tr_b16 v[192:193], v24 offset:8192
    ds_read_b64_tr_b16 v[194:195], v24 offset:8320
    ds_read_b64_tr_b16 v[196:197], v24 offset:10240
    ds_read_b64_tr_b16 v[198:199], v24 offset:10368
    ds_read_b64_tr_b16 v[200:201], v24 offset:8224
    ds_read_b64_tr_b16 v[202:203], v24 offset:8352
    ds_read_b64_tr_b16 v[204:205], v24 offset:10272
    ds_read_b64_tr_b16 v[206:207], v24 offset:10400
    s_waitcnt lgkmcnt(0)
    ds_read_b64_tr_b16 v[240:241], v24 offset:12288
    ds_read_b64_tr_b16 v[242:243], v24 offset:12416
    ds_read_b64_tr_b16 v[244:245], v24 offset:14336
    ds_read_b64_tr_b16 v[246:247], v24 offset:14464
    ds_read_b64_tr_b16 v[248:249], v24 offset:12320
    ds_read_b64_tr_b16 v[250:251], v24 offset:12448
    ds_read_b64_tr_b16 v[252:253], v24 offset:14368
    ds_read_b64_tr_b16 v[254:255], v24 offset:14496
    s_waitcnt lgkmcnt(0)
    v_mov_b32 v21, 0x44444444
    v_mov_b32 v22, 0xeeeeeeee
    v_and_b32 v23, 2, v20
    v_cmp_eq_u32 vcc, 0, v23
    s_nop 1
    v_cndmask_b32 v8, v22, v21, vcc
    v_bfe_u32 v21, v20, 2, 3
    v_lshrrev_b32 v22, 5, v20
    v_mul_u32_u24 v23, 160, v21
    v_mul_u32_u24 v24, 1280, v22
    v_add_u32 v23, v23, v24
    v_and_b32 v24, 3, v20
    v_lshl_add_u32 v27, v24, 4, v23
    v_lshrrev_b32 v23, 1, v21
    v_and_b32 v21, 1, v21
    v_lshl_add_u32 v21, v23, 2, v21
    v_xor_b32 v22, 1, v22
    v_lshl_add_u32 v21, v22, 1, v21
    v_bfe_u32 v22, v20, 1, 1
    v_lshl_add_u32 v21, v22, 4, v21
    v_xor_b32 v22, v20, v22
    v_and_b32 v22, 1, v22
    v_lshlrev_b32 v21, 4, v21
    v_lshl_add_u32 v25, v22, 3, v21
    v_lshrrev_b32 v21, 3, v20
    v_mul_u32_u24 v23, 160, v21
    v_and_b32 v24, 7, v20
    v_lshl_add_u32 v28, v24, 4, v23
    v_lshrrev_b32 v23, 1, v21
    v_and_b32 v21, 1, v21
    v_lshl_add_u32 v21, v23, 2, v21
    v_and_b32 v22, 1, v20
    v_lshl_add_u32 v21, v22, 1, v21
    v_bfe_u32 v22, v20, 2, 1
    v_lshl_add_u32 v21, v22, 4, v21
    v_bfe_u32 v22, v20, 1, 1
    v_lshlrev_b32 v21, 4, v21
    v_lshl_add_u32 v26, v22, 3, v21
    s_lshl_b32 s17, s53, 10
    s_lshl_b32 s18, s3, 9
    s_add_u32 s17, s17, s18
    s_lshl_b32 s18, s3, 6
    s_lshl_b32 s19, s53, 9
    s_add_u32 s19, s19, 4096
    s_cmp_ge_u32 s3, 2
    s_cselect_b32 s17, s19, s17
    s_cselect_b32 s18, 2560, s18
    s_cselect_b64 vcc, -1, 0
    v_cndmask_b32 v22, v25, v26, vcc
    v_cndmask_b32 v23, v27, v28, vcc
    v_add_u32 v2, s17, v22
    v_add_u32 v4, s18, v23
    v_lshrrev_b32 v21, 4, v20
    v_and_b32 v22, 15, v20
    v_mul_u32_u24 v23, 320, v21
    v_lshl_add_u32 v23, v22, 2, v23
    s_mul_i32 s17, s3, 3840
    v_add_u32 v3, s17, v23
    v_add_u32 v61, 1280, v3
    v_bfe_u32 v24, v20, 3, 1
    v_bfe_u32 v25, v20, 2, 1
    v_xor_b32 v25, v25, v24
    v_bfe_u32 v26, v20, 1, 1
    v_lshl_add_u32 v25, v26, 1, v25
    v_lshl_add_u32 v25, v24, 2, v25
    v_and_b32 v26, 1, v20
    v_lshl_add_u32 v25, v25, 1, v26
    v_sub_u32 v25, v25, v22
    v_lshl_add_u32 v25, v25, 2, v3
    v_add_u32 v62, 2560, v25
    v_lshlrev_b32 v23, 4, v22
    v_lshl_add_u32 v6, v21, 12, v23
    s_lshl_b32 s17, s3, 10
    s_add_u32 s17, s17, 32768
    v_add_u32 v6, s17, v6
    v_lshrrev_b32 v24, 1, v21
    v_lshl_add_u32 v23, v24, 15, v23
    v_and_b32 v24, 1, v21
    v_lshl_add_u32 v7, v24, 8, v23
    v_mov_b32 v58, 15872
    v_bfe_u32 v23, v20, 1, 2
    v_lshlrev_b32 v23, 6, v23
    v_and_b32 v25, 1, v20
    v_lshl_add_u32 v23, v25, 4, v23
    v_lshrrev_b32 v24, 5, v20
    v_lshl_add_u32 v5, v24, 5, v23
    v_and_b32 v23, 7, v20
    v_lshlrev_b32 v23, 7, v23
    v_bfe_u32 v24, v20, 3, 1
    v_lshl_add_u32 v23, v24, 17, v23
    v_lshrrev_b32 v24, 4, v20
    v_add_u32 v24, 1, v24
    v_cmp_le_u32 vcc, 3, v24
    s_nop 1
    v_cndmask_b32 v24, v24, 0, vcc
    v_lshl_add_u32 v23, v24, 24, v23
    s_lshl_b32 s17, s14, 14
    s_lshl_b32 s18, s34, 10
    s_add_u32 s17, s17, s18
    s_add_u32 s17, s17, 4194304
    v_add_u32 v0, s17, v23
    s_lshl_b32 s17, s3, 2
    s_add_u32 s17, s17, 15872
    v_mov_b32 v63, s17
    v_and_b32 v21, 15, v20
    v_and_b32 v22, 1, v21
    v_lshlrev_b32 v22, 4, v22
    v_mov_b32 v12, 0x3f80
    v_lshlrev_b32 v22, v22, v12
    v_lshrrev_b32 v21, 1, v21
    v_cmp_eq_u32 vcc, 0, v21
    s_nop 1
    v_cndmask_b32 v12, 0, v22, vcc
    v_cmp_eq_u32 vcc, 1, v21
    s_nop 1
    v_cndmask_b32 v13, 0, v22, vcc
    v_cmp_eq_u32 vcc, 2, v21
    s_nop 1
    v_cndmask_b32 v14, 0, v22, vcc
    v_cmp_eq_u32 vcc, 3, v21
    s_nop 1
    v_cndmask_b32 v15, 0, v22, vcc
    s_waitcnt vmcnt(0)
    v_mov_b32 v16, v32
    v_mov_b32 v17, v33
    v_mov_b32 v18, v34
    v_mov_b32 v19, v35
    v_mov_b32 v20, v36
    v_mov_b32 v21, v37
    v_mov_b32 v22, v38
    v_mov_b32 v23, v39
    v_mov_b32 v24, v40
    v_mov_b32 v25, v41
    v_mov_b32 v26, v42
    v_mov_b32 v27, v43
    v_mov_b32 v28, v44
    v_mov_b32 v29, v45
    v_mov_b32 v30, v46
    v_mov_b32 v31, v47
    v_mov_b32 v52, -1
    v_mov_b32 v53, -1
    v_mov_b32 v54, -1
    v_mov_b32 v55, -1
    s_add_u32 s17, s30, 851968
    buffer_store_dwordx4 v[52:55], v7, s[4:7], s17 offen sc1
    s_add_u32 s17, s30, 917504
    buffer_store_dwordx4 v[52:55], v7, s[4:7], s17 offen sc1
    s_add_u32 s17, s30, 983040
    buffer_store_dwordx4 v[52:55], v7, s[4:7], s17 offen sc1
    s_lshl_b32 s40, s40, 5
    s_barrier
    ds_write_b32 v63, v10
    ds_write_b32 v63, v10 offset:16
    ds_write_b32 v63, v10 offset:32
    ds_write_b32 v63, v10 offset:48
    v_mov_b32 v60, 12
    v_mov_b32 v56, 15968
    s_waitcnt lgkmcnt(0)
    s_barrier
    ds_read_b64 v[32:33], v56
    s_waitcnt lgkmcnt(0)
    v_cmp_ne_u32 vcc, s40, v32
    s_setprio 3
    v_readfirstlane_b32 s17, v33
    s_add_u32 s39, s39, s17
    s_cbranch_vccnz ch_p_slow
    v_mov_b32 v32, 0
    v_mov_b32 v33, 0
    v_mov_b32 v34, 0
    v_mov_b32 v35, 0
    v_mov_b32 v36, 0
    v_mov_b32 v37, 0
    v_mov_b32 v38, 0
    v_mov_b32 v39, 0
    v_mov_b32 v40, 0
    v_mov_b32 v41, 0
    v_mov_b32 v42, 0
    v_mov_b32 v43, 0
    v_mov_b32 v44, 0
    v_mov_b32 v45, 0
    v_mov_b32 v46, 0
    v_mov_b32 v47, 0
    v_mov_b32 v48, 0
    v_mov_b32 v49, 0
    v_mov_b32 v50, 0
    v_mov_b32 v51, 0
    v_mov_b32 v52, 0
    v_mov_b32 v53, 0
    v_mov_b32 v54, 0
    v_mov_b32 v55, 0
    v_mov_b32 v59, 0
    s_nop 1
    s_branch ploopL_20_nc
.p2align 6
    s_nop 0
    s_nop 0
    s_nop 0
    s_nop 0
    s_nop 0
    s_nop 0
    s_nop 0
    s_nop 0
    s_nop 0
    s_nop 0
    s_nop 0
ploopL_20:
    v_mov_b32 v32, 0
    v_mov_b32 v33, 0
    v_mov_b32 v34, 0
    v_mov_b32 v35, 0
    v_mov_b32 v36, 0
    v_mov_b32 v37, 0
    v_mov_b32 v38, 0
    v_mov_b32 v39, 0
    v_mov_b32 v40, 0
    v_mov_b32 v41, 0
    v_mov_b32 v42, 0
    v_mov_b32 v43, 0
    v_mov_b32 v44, 0
    v_mov_b32 v45, 0
    v_mov_b32 v46, 0
    v_mov_b32 v47, 0
    v_mov_b32 v48, 0
    v_mov_b32 v49, 0
    v_mov_b32 v50, 0
    v_mov_b32 v51, 0
    v_mov_b32 v52, 0
    v_mov_b32 v53, 0
    v_mov_b32 v54, 0
    v_mov_b32 v55, 0
    s_bitcmp1_b32 s29, 0
    s_cbranch_scc1 gate_21_ok
    s_add_u32 s21, s16, 1
    s_min_u32 s21, s21, 63
    s_cmp_ge_u32 s21, 16
    s_cselect_b32 s19, 12, 8
    s_and_b32 s32, s21, 4
    s_lshr_b32 s21, s21, 3
    s_lshl_b32 s21, s21, 8
    s_add_u32 s32, s32, s21
    s_add_u32 s32, s32, s35
gate_21:
    buffer_load_dword v9, off, s[4:7], s32 sc1
    s_waitcnt vmcnt(0)
    v_readfirstlane_b32 s21, v9
    s_cmp_ge_u32 s21, s19
    s_cbranch_scc1 gate_21_set
    s_sleep 8
    s_sub_u32 s22, s22, 1
    s_cbranch_scc0 gate_21
    s_mov_b32 s22, 0
gate_21_set:
    s_bitset1_b32 s29, 0
gate_21_ok:
    s_sleep 1
    buffer_load_dwordx4 v[16:19], v1, s[4:7], s23 offen offset:0 sc1
    buffer_load_dwordx4 v[20:23], v1, s[4:7], s23 offen offset:1024 sc1
    buffer_load_dwordx4 v[24:27], v1, s[4:7], s23 offen offset:2048 sc1
    buffer_load_dwordx4 v[28:31], v1, s[4:7], s23 offen offset:3072 sc1
    s_waitcnt vmcnt(3)
    v_cmp_eq_u32 vcc, -1, v16
    s_cbranch_vccnz ploopL_20_rm_0
ploopL_20_rm_0ok:
    v_smfmac_f32_16x16x64_bf16 v[32:35], v[16:19], v[64:71], v8
    v_smfmac_f32_16x16x64_bf16 v[36:39], v[16:19], v[72:79], v8
    s_waitcnt vmcnt(2)
    v_cmp_eq_u32 vcc, -1, v20
    v_smfmac_f32_16x16x64_bf16 v[40:43], v[16:19], v[80:87], v8
    v_smfmac_f32_16x16x64_bf16 v[44:47], v[16:19], v[88:95], v8
    v_smfmac_f32_16x16x64_bf16 v[48:51], v[16:19], v[96:103], v8
    v_smfmac_f32_16x16x64_bf16 v[52:55], v[16:19], v[104:111], v8
    s_cbranch_vccnz ploopL_20_rm_1
ploopL_20_rm_1ok:
    v_smfmac_f32_16x16x64_bf16 v[32:35], v[20:23], v[112:119], v8
    v_smfmac_f32_16x16x64_bf16 v[36:39], v[20:23], v[120:127], v8
    s_waitcnt vmcnt(1)
    v_cmp_eq_u32 vcc, -1, v24
    v_smfmac_f32_16x16x64_bf16 v[40:43], v[20:23], v[128:135], v8
    v_smfmac_f32_16x16x64_bf16 v[44:47], v[20:23], v[136:143], v8
    v_smfmac_f32_16x16x64_bf16 v[48:51], v[20:23], v[144:151], v8
    v_smfmac_f32_16x16x64_bf16 v[52:55], v[20:23], v[152:159], v8
    s_cbranch_vccnz ploopL_20_rm_2
ploopL_20_rm_2ok:
    v_smfmac_f32_16x16x64_bf16 v[32:35], v[24:27], v[160:167], v8
    v_smfmac_f32_16x16x64_bf16 v[36:39], v[24:27], v[168:175], v8
    s_waitcnt vmcnt(0)
    v_cmp_eq_u32 vcc, -1, v28
    v_smfmac_f32_16x16x64_bf16 v[40:43], v[24:27], v[176:183], v8
    v_smfmac_f32_16x16x64_bf16 v[44:47], v[24:27], v[184:191], v8
    v_smfmac_f32_16x16x64_bf16 v[48:51], v[24:27], v[192:199], v8
    v_smfmac_f32_16x16x64_bf16 v[52:55], v[24:27], v[200:207], v8
    s_cbranch_vccnz ploopL_20_rm_3
ploopL_20_rm_3ok:
    v_smfmac_f32_16x16x64_bf16 v[32:35], v[28:31], v[208:215], v8
    ds_write_b32 v63, v59 offset:32
    v_smfmac_f32_16x16x64_bf16 v[36:39], v[28:31], v[216:223], v8
    v_smfmac_f32_16x16x64_bf16 v[40:43], v[28:31], v[224:231], v8
    v_smfmac_f32_16x16x64_bf16 v[44:47], v[28:31], v[232:239], v8
    v_smfmac_f32_16x16x64_bf16 v[48:51], v[28:31], v[240:247], v8
    v_smfmac_f32_16x16x64_bf16 v[52:55], v[28:31], v[248:255], v8
    s_branch ploopL_20_mmd
ploopL_20_nc:
    v_smfmac_f32_16x16x64_bf16 v[32:35], v[16:19], v[64:71], v8
    v_smfmac_f32_16x16x64_bf16 v[36:39], v[16:19], v[72:79], v8
    v_smfmac_f32_16x16x64_bf16 v[40:43], v[16:19], v[80:87], v8
    v_smfmac_f32_16x16x64_bf16 v[44:47], v[16:19], v[88:95], v8
    v_smfmac_f32_16x16x64_bf16 v[48:51], v[16:19], v[96:103], v8
    v_smfmac_f32_16x16x64_bf16 v[52:55], v[16:19], v[104:111], v8
    v_smfmac_f32_16x16x64_bf16 v[32:35], v[20:23], v[112:119], v8
    v_smfmac_f32_16x16x64_bf16 v[36:39], v[20:23], v[120:127], v8
    v_smfmac_f32_16x16x64_bf16 v[40:43], v[20:23], v[128:135], v8
    v_smfmac_f32_16x16x64_bf16 v[44:47], v[20:23], v[136:143], v8
    v_smfmac_f32_16x16x64_bf16 v[48:51], v[20:23], v[144:151], v8
    v_smfmac_f32_16x16x64_bf16 v[52:55], v[20:23], v[152:159], v8
    v_smfmac_f32_16x16x64_bf16 v[32:35], v[24:27], v[160:167], v8
    v_smfmac_f32_16x16x64_bf16 v[36:39], v[24:27], v[168:175], v8
    v_smfmac_f32_16x16x64_bf16 v[40:43], v[24:27], v[176:183], v8
    v_smfmac_f32_16x16x64_bf16 v[44:47], v[24:27], v[184:191], v8
    v_smfmac_f32_16x16x64_bf16 v[48:51], v[24:27], v[192:199], v8
    v_smfmac_f32_16x16x64_bf16 v[52:55], v[24:27], v[200:207], v8
    v_smfmac_f32_16x16x64_bf16 v[32:35], v[28:31], v[208:215], v8
    ds_write_b32 v63, v59 offset:32
    v_smfmac_f32_16x16x64_bf16 v[36:39], v[28:31], v[216:223], v8
    v_smfmac_f32_16x16x64_bf16 v[40:43], v[28:31], v[224:231], v8
    v_smfmac_f32_16x16x64_bf16 v[44:47], v[28:31], v[232:239], v8
    v_smfmac_f32_16x16x64_bf16 v[48:51], v[28:31], v[240:247], v8
    v_smfmac_f32_16x16x64_bf16 v[52:55], v[28:31], v[248:255], v8
ploopL_20_mmd:
    s_cmp_eq_u32 s3, 3
    s_nop 1
    v_add_f32 v32, v32, v34
    v_add_f32 v33, v33, v35
    ds_write2_b32 v3, v32, v33 offset0:0 offset1:40
    v_add_f32 v36, v36, v38
    v_add_f32 v37, v37, v39
    ds_write2_b32 v3, v36, v37 offset0:16 offset1:56
    v_add_f32 v40, v40, v42
    v_add_f32 v41, v41, v43
    ds_write2_b32 v61, v40, v41 offset0:0 offset1:40
    v_add_f32 v44, v44, v46
    v_add_f32 v45, v45, v47
    ds_write2_b32 v61, v44, v45 offset0:16 offset1:56
    v_add_f32 v48, v48, v50
    v_add_f32 v49, v49, v51
    ds_write2_b32 v62, v48, v49 offset0:0 offset1:40
    v_add_f32 v52, v52, v54
    v_add_f32 v53, v53, v55
    ds_write2_b32 v62, v52, v53 offset0:16 offset1:56
    s_waitcnt lgkmcnt(0)
    s_barrier
    s_cbranch_scc1 ploopL_20_sk1
    ds_read_b128 v[32:35], v4 offset:0
    ds_read_b128 v[36:39], v4 offset:3840
    ds_read_b128 v[40:43], v4 offset:7680
    ds_read_b128 v[44:47], v4 offset:11520
    s_waitcnt lgkmcnt(2)
    v_add_f32 v32, v32, v36
    v_add_f32 v33, v33, v37
    v_add_f32 v34, v34, v38
    v_add_f32 v35, v35, v39
    s_waitcnt lgkmcnt(0)
    v_add_f32 v40, v40, v44
    v_add_f32 v41, v41, v45
    v_add_f32 v42, v42, v46
    v_add_f32 v43, v43, v47
    v_add_f32 v32, v32, v40
    v_add_f32 v33, v33, v41
    v_add_f32 v34, v34, v42
    v_add_f32 v35, v35, v43
    v_cvt_pk_bf16_f32 v56, v32, v33
    v_cvt_pk_bf16_f32 v57, v34, v35
    v_min_u32 v56, -2, v56
    buffer_store_dwordx2 v[56:57], v2, s[4:7], s26 offen
    s_add_u32 s27, s16, 2
    s_and_b32 s27, s27, 3
    s_lshl_b32 s27, s27, 18
    s_add_u32 s27, s27, s38
    buffer_store_dwordx2 v[10:11], v2, s[4:7], s27 offen
ploopL_20_sk1:
    s_setprio 0
    s_add_u32 s25, s16, 3
    s_and_b32 s25, s25, 3
    s_lshl_b32 s25, s25, 16
    s_add_u32 s25, s25, s37
    v_mov_b32 v44, -1
    v_mov_b32 v45, -1
    v_mov_b32 v46, -1
    v_mov_b32 v47, -1
    s_mov_b64 exec, s[56:57]
    buffer_store_dwordx4 v[44:47], v5, s[4:7], s25 offen
    s_mov_b64 exec, -1
    v_mov_b32_dpp v48, v12 row_ror:8 row_mask:0xf bank_mask:0xf
    v_mov_b32_dpp v49, v13 row_ror:8 row_mask:0xf bank_mask:0xf
    v_mov_b32_dpp v50, v14 row_ror:8 row_mask:0xf bank_mask:0xf
    v_mov_b32_dpp v51, v15 row_ror:8 row_mask:0xf bank_mask:0xf
    s_and_b32 s28, s16, 3
    s_lshl_b32 s28, s28, 18
    s_add_u32 s28, s28, s39
    s_add_u32 s24, s16, 1
    s_and_b32 s24, s24, 3
    s_lshl_b32 s24, s24, 16
    s_add_u32 s24, s24, s37
    s_add_u32 s23, s16, 1
    s_and_b32 s23, s23, 3
    s_lshl_b32 s23, s23, 16
    s_add_u32 s23, s23, s36
    s_add_u32 s26, s16, 1
    s_and_b32 s26, s26, 3
    s_lshl_b32 s26, s26, 18
    s_add_u32 s26, s26, s38
    s_cmp_eq_u32 s59, 0
    s_cbranch_scc1 ofl_22
    s_lshl_b32 s17, s3, 10
    v_add_u32 v39, s17, v1
    ds_read_b128 v[40:43], v39 offset:32768
ofl_22:
    s_cmp_ge_u32 s16, 16
    s_cbranch_scc1 ploopL_20_nx
    v_mov_b32 v40, v2
    v_mov_b32 v42, v56
    v_mov_b32 v43, v57
    s_cmp_lg_u32 s3, 2
    s_cbranch_scc1 ploopL_20_nx
    v_and_b32 v40, 0x60, v1
    v_lshlrev_b32 v40, 2, v40
    v_lshrrev_b32 v41, 3, v1
    v_and_b32 v41, 0x70, v41
    v_or_b32 v40, v40, v41
    v_bfe_u32 v41, v1, 4, 1
    v_lshl_or_b32 v40, v41, 3, v40
    s_lshl_b32 s17, s53, 9
    s_add_u32 s17, s17, 4096
    v_add_u32 v40, s17, v40
    s_mov_b32 vcc_lo, 0x55555555
    s_mov_b32 vcc_hi, 0x55555555
    v_cndmask_b32_dpp v42, v57, v56, vcc quad_perm:[1,0,3,2] row_mask:0xf bank_mask:0xf
    s_not_b64 vcc, vcc
    v_cndmask_b32_dpp v43, v56, v57, vcc quad_perm:[1,0,3,2] row_mask:0xf bank_mask:0xf
ploopL_20_nx:
    v_readfirstlane_b32 s21, v60
    s_lshr_b32 s29, s29, 1
    s_cmp_ge_u32 s21, s58
    s_cselect_b32 s21, 2, 0
    s_or_b32 s29, s29, s21
    s_cmp_eq_u32 s3, 3
    s_cselect_b32 s20, s21, 0
    s_add_u32 s21, s16, 4
    s_min_u32 s21, s21, 63
    s_cmp_ge_u32 s21, 16
    s_cselect_b32 s58, 12, 8
    s_and_b32 s33, s21, 4
    s_lshr_b32 s21, s21, 3
    s_lshl_b32 s21, s21, 8
    s_add_u32 s33, s33, s21
    s_add_u32 s33, s33, s35
    s_setprio 3
ploopL_20_fs:
    ds_read_b128 v[32:35], v58 offset:0
    s_waitcnt lgkmcnt(0)
    v_min3_i32 v32, v32, v33, v34
    v_min_i32 v32, v32, v35
    s_nop 0
    v_readfirstlane_b32 s18, v32
    s_cmp_ge_i32 s18, s16
    s_cbranch_scc1 ploopL_20_fsok
    s_sleep 1
    s_branch ploopL_20_fs
ploopL_20_fsok:
    s_setprio 1
    s_sleep 4
ploopL_20_nofd:
    s_cmp_eq_u32 s20, 0
    s_cbranch_scc1 ploopL_20_nt
    s_cmp_ge_u32 s16, 13
    s_cselect_b32 exec_hi, 0xffff, 0
    buffer_load_dword v60, v0, s[4:7], s31 offen sc1
    s_mov_b32 exec_hi, -1
ploopL_20_nt:
    s_cmp_eq_u32 s59, 0
    s_cbranch_scc1 ofl_23
    s_lshl_b32 s17, s16, 18
    s_add_u32 s17, s17, s60
    buffer_store_dwordx4 v[40:43], v1, s[4:7], s17 offen sc1
    s_mov_b32 s59, 0
ofl_23:
    s_lshr_b32 s17, s34, 3
    s_xor_b32 s17, s17, s16
    s_andn2_b32 s59, 1, s17
    s_cmp_ge_u32 s16, 16
    s_cselect_b32 s59, s59, 0
    s_cbranch_scc1 ploopL_20_nx2
    s_cmp_eq_u32 s3, 3
    s_cbranch_scc1 ploopL_20_nx2
    buffer_store_dwordx2 v[42:43], v40, s[4:7], s55 offen sc1
ploopL_20_nx2:
    s_add_u32 s55, s55, 262144
    s_or_b32 s17, s13, s3
    s_cmp_lg_u32 s17, 0
    s_cbranch_scc1 ploopL_20_npg
    s_sub_u32 s21, s16, 1
    s_cbranch_scc1 ploopL_20_npg
    s_sub_u32 s17, s21, 1
    s_and_b32 s17, s17, 3
    s_cmp_ge_u32 s16, 58
    s_cselect_b32 s17, 0, s17
    s_cmp_lg_u32 s17, 0
    s_cbranch_scc1 ploopL_20_npg
    s_lshl_b32 s17, s12, 7
    s_add_u32 s17, s17, 218112000
    v_mov_b32 v9, s21
    s_mov_b64 exec, 1
    buffer_store_dword v9, off, s[4:7], s17 sc1
    s_mov_b64 exec, -1
ploopL_20_npg:
    s_barrier
    buffer_load_dword v60, off, s[4:7], s33 sc1
    s_add_u32 s16, s16, 1
    v_mov_b32 v59, s16
    s_add_u32 s41, s41, 262144
    s_add_u32 s31, s31, 262144
    s_setprio 3
    s_sleep 13
ploopL_20_pagain:
    buffer_load_dwordx4 v[16:19], v1, s[4:7], s28 offen offset:0 sc1
    buffer_load_dwordx4 v[20:23], v1, s[4:7], s28 offen offset:1024 sc1
    s_waitcnt vmcnt(1)
    v_mfma_f32_16x16x32_bf16 v[32:35], v[12:15], v[16:19], 0
    s_waitcnt vmcnt(0)
    v_mfma_f32_16x16x32_bf16 v[32:35], v[48:51], v[20:23], v[32:35]
    v_max_u32 v9, v16, v20
    v_cmp_eq_u32 vcc, -1, v9
    s_cbranch_vccnz ploopL_20_rp
ploopL_20_pgo:
    s_cmp_lt_u32 s16, 48
    s_nop 3
    v_add_f32_dpp v36, v32, v32 row_ror:8 row_mask:0xf bank_mask:0xf
    v_add_f32_dpp v37, v33, v33 row_ror:8 row_mask:0xf bank_mask:0xf
    v_add_f32_dpp v38, v34, v34 row_ror:8 row_mask:0xf bank_mask:0xf
    v_add_f32_dpp v39, v35, v35 row_ror:8 row_mask:0xf bank_mask:0xf
    v_cvt_pk_bf16_f32 v52, v36, v37
    v_cvt_pk_bf16_f32 v53, v38, v39
    s_nop 0
    v_permlane16_swap_b32 v52, v54
    v_permlane16_swap_b32 v53, v55
    s_mov_b64 exec, s[56:57]
    v_min_u32 v52, -2, v52
    buffer_store_dwordx4 v[52:55], v5, s[4:7], s24 offen
    s_mov_b64 exec, -1
    ds_write_b32 v63, v59 offset:16
    s_cbranch_scc1 ploopL_20
    s_branch ploopH_19
ploopL_20_rm_0:
    s_sub_u32 s22, s22, 1
    s_cbranch_scc1 ploopL_20_rm_0_g
    buffer_load_dwordx4 v[16:19], v1, s[4:7], s23 offen offset:0 sc1
    buffer_load_dwordx4 v[20:23], v1, s[4:7], s23 offen offset:1024 sc1
    buffer_load_dwordx4 v[24:27], v1, s[4:7], s23 offen offset:2048 sc1
    buffer_load_dwordx4 v[28:31], v1, s[4:7], s23 offen offset:3072 sc1
    s_waitcnt vmcnt(3)
    v_cmp_eq_u32 vcc, -1, v16
    s_cbranch_vccnz ploopL_20_rm_0
    s_branch ploopL_20_rm_0ok
ploopL_20_rm_0_g:
    s_mov_b32 s22, 0
    s_waitcnt vmcnt(0)
    s_branch ploopL_20_rm_0ok
ploopL_20_rm_1:
    s_sub_u32 s22, s22, 1
    s_cbranch_scc1 ploopL_20_rm_1_g
    buffer_load_dwordx4 v[20:23], v1, s[4:7], s23 offen offset:1024 sc1
    buffer_load_dwordx4 v[24:27], v1, s[4:7], s23 offen offset:2048 sc1
    buffer_load_dwordx4 v[28:31], v1, s[4:7], s23 offen offset:3072 sc1
    s_waitcnt vmcnt(2)
    v_cmp_eq_u32 vcc, -1, v20
    s_cbranch_vccnz ploopL_20_rm_1
    s_branch ploopL_20_rm_1ok
ploopL_20_rm_1_g:
    s_mov_b32 s22, 0
    s_waitcnt vmcnt(0)
    s_branch ploopL_20_rm_1ok
ploopL_20_rm_2:
    s_sub_u32 s22, s22, 1
    s_cbranch_scc1 ploopL_20_rm_2_g
    buffer_load_dwordx4 v[24:27], v1, s[4:7], s23 offen offset:2048 sc1
    buffer_load_dwordx4 v[28:31], v1, s[4:7], s23 offen offset:3072 sc1
    s_waitcnt vmcnt(1)
    v_cmp_eq_u32 vcc, -1, v24
    s_cbranch_vccnz ploopL_20_rm_2
    s_branch ploopL_20_rm_2ok
ploopL_20_rm_2_g:
    s_mov_b32 s22, 0
    s_waitcnt vmcnt(0)
    s_branch ploopL_20_rm_2ok
ploopL_20_rm_3:
    s_sub_u32 s22, s22, 1
    s_cbranch_scc1 ploopL_20_rm_3_g
    buffer_load_dwordx4 v[28:31], v1, s[4:7], s23 offen offset:3072 sc1
    s_waitcnt vmcnt(0)
    v_cmp_eq_u32 vcc, -1, v28
    s_cbranch_vccnz ploopL_20_rm_3
    s_branch ploopL_20_rm_3ok
ploopL_20_rm_3_g:
    s_mov_b32 s22, 0
    s_waitcnt vmcnt(0)
    s_branch ploopL_20_rm_3ok
ploopL_20_rp:
    s_sub_u32 s22, s22, 1
    s_cbranch_scc0 ploopL_20_pagain
    s_mov_b32 s22, 0
    s_branch ploopL_20_pgo
.p2align 6
    s_nop 0
    s_nop 0
    s_nop 0
    s_nop 0
    s_nop 0
    s_nop 0
    s_nop 0
    s_nop 0
    s_nop 0
    s_nop 0
    s_nop 0
ploopH_19:
    v_mov_b32 v32, 0
    v_mov_b32 v33, 0
    v_mov_b32 v34, 0
    v_mov_b32 v35, 0
    v_mov_b32 v36, 0
    v_mov_b32 v37, 0
    v_mov_b32 v38, 0
    v_mov_b32 v39, 0
    v_mov_b32 v40, 0
    v_mov_b32 v41, 0
    v_mov_b32 v42, 0
    v_mov_b32 v43, 0
    v_mov_b32 v44, 0
    v_mov_b32 v45, 0
    v_mov_b32 v46, 0
    v_mov_b32 v47, 0
    v_mov_b32 v48, 0
    v_mov_b32 v49, 0
    v_mov_b32 v50, 0
    v_mov_b32 v51, 0
    v_mov_b32 v52, 0
    v_mov_b32 v53, 0
    v_mov_b32 v54, 0
    v_mov_b32 v55, 0
    s_sleep 1
    buffer_load_dwordx4 v[16:19], v1, s[4:7], s23 offen offset:0 sc1
    buffer_load_dwordx4 v[20:23], v1, s[4:7], s23 offen offset:1024 sc1
    buffer_load_dwordx4 v[24:27], v1, s[4:7], s23 offen offset:2048 sc1
    buffer_load_dwordx4 v[28:31], v1, s[4:7], s23 offen offset:3072 sc1
    s_waitcnt vmcnt(3)
    v_cmp_eq_u32 vcc, -1, v16
    s_cbranch_vccnz ploopH_19_rm_0
ploopH_19_rm_0ok:
    v_smfmac_f32_16x16x64_bf16 v[32:35], v[16:19], v[64:71], v8
    v_smfmac_f32_16x16x64_bf16 v[36:39], v[16:19], v[72:79], v8
    s_waitcnt vmcnt(2)
    v_cmp_eq_u32 vcc, -1, v20
    v_smfmac_f32_16x16x64_bf16 v[40:43], v[16:19], v[80:87], v8
    v_smfmac_f32_16x16x64_bf16 v[44:47], v[16:19], v[88:95], v8
    v_smfmac_f32_16x16x64_bf16 v[48:51], v[16:19], v[96:103], v8
    v_smfmac_f32_16x16x64_bf16 v[52:55], v[16:19], v[104:111], v8
    s_cbranch_vccnz ploopH_19_rm_1
ploopH_19_rm_1ok:
    v_smfmac_f32_16x16x64_bf16 v[32:35], v[20:23], v[112:119], v8
    v_smfmac_f32_16x16x64_bf16 v[36:39], v[20:23], v[120:127], v8
    s_waitcnt vmcnt(1)
    v_cmp_eq_u32 vcc, -1, v24
    v_smfmac_f32_16x16x64_bf16 v[40:43], v[20:23], v[128:135], v8
    v_smfmac_f32_16x16x64_bf16 v[44:47], v[20:23], v[136:143], v8
    v_smfmac_f32_16x16x64_bf16 v[48:51], v[20:23], v[144:151], v8
    v_smfmac_f32_16x16x64_bf16 v[52:55], v[20:23], v[152:159], v8
    s_cbranch_vccnz ploopH_19_rm_2
ploopH_19_rm_2ok:
    v_smfmac_f32_16x16x64_bf16 v[32:35], v[24:27], v[160:167], v8
    v_smfmac_f32_16x16x64_bf16 v[36:39], v[24:27], v[168:175], v8
    s_waitcnt vmcnt(0)
    v_cmp_eq_u32 vcc, -1, v28
    v_smfmac_f32_16x16x64_bf16 v[40:43], v[24:27], v[176:183], v8
    v_smfmac_f32_16x16x64_bf16 v[44:47], v[24:27], v[184:191], v8
    v_smfmac_f32_16x16x64_bf16 v[48:51], v[24:27], v[192:199], v8
    v_smfmac_f32_16x16x64_bf16 v[52:55], v[24:27], v[200:207], v8
    s_cbranch_vccnz ploopH_19_rm_3
ploopH_19_rm_3ok:
    v_smfmac_f32_16x16x64_bf16 v[32:35], v[28:31], v[208:215], v8
    ds_write_b32 v63, v59 offset:32
    v_smfmac_f32_16x16x64_bf16 v[36:39], v[28:31], v[216:223], v8
    v_smfmac_f32_16x16x64_bf16 v[40:43], v[28:31], v[224:231], v8
    v_smfmac_f32_16x16x64_bf16 v[44:47], v[28:31], v[232:239], v8
    v_smfmac_f32_16x16x64_bf16 v[48:51], v[28:31], v[240:247], v8
    v_smfmac_f32_16x16x64_bf16 v[52:55], v[28:31], v[248:255], v8
    s_cmp_eq_u32 s3, 3
    s_nop 1
    v_add_f32 v32, v32, v34
    v_add_f32 v33, v33, v35
    ds_write2_b32 v3, v32, v33 offset0:0 offset1:40
    v_add_f32 v36, v36, v38
    v_add_f32 v37, v37, v39
    ds_write2_b32 v3, v36, v37 offset0:16 offset1:56
    v_add_f32 v40, v40, v42
    v_add_f32 v41, v41, v43
    ds_write2_b32 v61, v40, v41 offset0:0 offset1:40
    v_add_f32 v44, v44, v46
    v_add_f32 v45, v45, v47
    ds_write2_b32 v61, v44, v45 offset0:16 offset1:56
    v_add_f32 v48, v48, v50
    v_add_f32 v49, v49, v51
    ds_write2_b32 v62, v48, v49 offset0:0 offset1:40
    v_add_f32 v52, v52, v54
    v_add_f32 v53, v53, v55
    ds_write2_b32 v62, v52, v53 offset0:16 offset1:56
    s_waitcnt lgkmcnt(0)
    s_barrier
    s_cbranch_scc1 ploopH_19_sk1
    ds_read_b128 v[32:35], v4 offset:0
    ds_read_b128 v[36:39], v4 offset:3840
    ds_read_b128 v[40:43], v4 offset:7680
    ds_read_b128 v[44:47], v4 offset:11520
    s_waitcnt lgkmcnt(2)
    v_add_f32 v32, v32, v36
    v_add_f32 v33, v33, v37
    v_add_f32 v34, v34, v38
    v_add_f32 v35, v35, v39
    s_waitcnt lgkmcnt(0)
    v_add_f32 v40, v40, v44
    v_add_f32 v41, v41, v45
    v_add_f32 v42, v42, v46
    v_add_f32 v43, v43, v47
    v_add_f32 v32, v32, v40
    v_add_f32 v33, v33, v41
    v_add_f32 v34, v34, v42
    v_add_f32 v35, v35, v43
    v_cvt_pk_bf16_f32 v56, v32, v33
    v_cvt_pk_bf16_f32 v57, v34, v35
    v_min_u32 v56, -2, v56
    buffer_store_dwordx2 v[56:57], v2, s[4:7], s26 offen
    s_add_u32 s27, s16, 2
    s_and_b32 s27, s27, 3
    s_lshl_b32 s27, s27, 18
    s_add_u32 s27, s27, s38
    buffer_store_dwordx2 v[10:11], v2, s[4:7], s27 offen
ploopH_19_sk1:
    s_setprio 0
    s_add_u32 s25, s16, 3
    s_and_b32 s25, s25, 3
    s_lshl_b32 s25, s25, 16
    s_add_u32 s25, s25, s37
    v_mov_b32 v44, -1
    v_mov_b32 v45, -1
    v_mov_b32 v46, -1
    v_mov_b32 v47, -1
    s_mov_b64 exec, s[56:57]
    buffer_store_dwordx4 v[44:47], v5, s[4:7], s25 offen
    s_mov_b64 exec, -1
    v_mov_b32_dpp v48, v12 row_ror:8 row_mask:0xf bank_mask:0xf
    v_mov_b32_dpp v49, v13 row_ror:8 row_mask:0xf bank_mask:0xf
    v_mov_b32_dpp v50, v14 row_ror:8 row_mask:0xf bank_mask:0xf
    v_mov_b32_dpp v51, v15 row_ror:8 row_mask:0xf bank_mask:0xf
    s_and_b32 s28, s16, 3
    s_lshl_b32 s28, s28, 18
    s_add_u32 s28, s28, s39
    s_add_u32 s24, s16, 1
    s_and_b32 s24, s24, 3
    s_lshl_b32 s24, s24, 16
    s_add_u32 s24, s24, s37
    s_add_u32 s23, s16, 1
    s_and_b32 s23, s23, 3
    s_lshl_b32 s23, s23, 16
    s_add_u32 s23, s23, s36
    s_add_u32 s26, s16, 1
    s_and_b32 s26, s26, 3
    s_lshl_b32 s26, s26, 18
    s_add_u32 s26, s26, s38
    s_cmp_eq_u32 s59, 0
    s_cbranch_scc1 ofl_24
    s_lshl_b32 s17, s3, 10
    v_add_u32 v39, s17, v1
    ds_read_b128 v[40:43], v39 offset:32768
ofl_24:
    s_cmp_eq_u32 s16, 63
    s_cbranch_scc1 ploopH_19_tail
    s_cmp_eq_u32 s30, s54
    s_cbranch_scc1 pnoseg_25
    ds_read_b128 v[16:19], v6 offset:0
    ds_read_b128 v[20:23], v6 offset:256
    ds_read_b128 v[24:27], v6 offset:512
    ds_read_b128 v[28:31], v6 offset:768
    v_xor_b32 v6, 0x4000, v6
    s_waitcnt lgkmcnt(2)
    v_mfma_f32_16x16x32_bf16 v[40:43], v[12:15], v[16:19], 0
    v_mfma_f32_16x16x32_bf16 v[40:43], v[48:51], v[20:23], v[40:43]
    s_waitcnt lgkmcnt(0)
    v_mfma_f32_16x16x32_bf16 v[44:47], v[12:15], v[24:27], 0
    v_mfma_f32_16x16x32_bf16 v[44:47], v[48:51], v[28:31], v[44:47]
    s_nop 7
    v_cvt_pk_bf16_f32 v40, v40, v41
    v_cvt_pk_bf16_f32 v41, v42, v43
    v_cvt_pk_bf16_f32 v42, v44, v45
    v_cvt_pk_bf16_f32 v43, v46, v47
    s_nop 1
    v_permlane16_swap_b32 v40, v42
    v_permlane16_swap_b32 v41, v43
    s_nop 1
    v_min_u32 v40, -2, v40
pnoseg_25:
    s_bitcmp1_b32 s29, 0
    s_cbranch_scc1 gate_26_ok
    s_add_u32 s21, s16, 1
    s_min_u32 s21, s21, 63
    s_cmp_ge_u32 s21, 16
    s_cselect_b32 s19, 12, 8
    s_and_b32 s32, s21, 4
    s_lshr_b32 s21, s21, 3
    s_lshl_b32 s21, s21, 8
    s_add_u32 s32, s32, s21
    s_add_u32 s32, s32, s35
gate_26:
    buffer_load_dword v9, off, s[4:7], s32 sc1
    s_waitcnt vmcnt(0)
    v_readfirstlane_b32 s21, v9
    s_cmp_ge_u32 s21, s19
    s_cbranch_scc1 gate_26_set
    s_sleep 8
    s_sub_u32 s22, s22, 1
    s_cbranch_scc0 gate_26
    s_mov_b32 s22, 0
gate_26_set:
    s_bitset1_b32 s29, 0
gate_26_ok:
    v_readfirstlane_b32 s21, v60
    s_lshr_b32 s29, s29, 1
    s_cmp_ge_u32 s21, s58
    s_cselect_b32 s21, 2, 0
    s_or_b32 s29, s29, s21
    s_cmp_eq_u32 s3, 3
    s_cselect_b32 s20, s21, 0
    s_add_u32 s21, s16, 4
    s_min_u32 s21, s21, 63
    s_cmp_ge_u32 s21, 16
    s_cselect_b32 s58, 12, 8
    s_and_b32 s33, s21, 4
    s_lshr_b32 s21, s21, 3
    s_lshl_b32 s21, s21, 8
    s_add_u32 s33, s33, s21
    s_add_u32 s33, s33, s35
    s_setprio 3
ploopH_19_fs:
    ds_read_b128 v[32:35], v58 offset:0
    s_waitcnt lgkmcnt(0)
    v_min3_i32 v32, v32, v33, v34
    v_min_i32 v32, v32, v35
    s_nop 0
    v_readfirstlane_b32 s18, v32
    s_cmp_ge_i32 s18, s16
    s_cbranch_scc1 ploopH_19_fsok
    s_sleep 1
    s_branch ploopH_19_fs
ploopH_19_fsok:
    s_setprio 1
    s_add_u32 m0, s42, 8192
    s_add_u32 s17, s41, 37748736
    buffer_load_dwordx4 v1, s[4:7], s17 offen offset:0 sc1 lds
    buffer_load_dwordx4 v1, s[4:7], s17 offen offset:1024 sc1 lds
    buffer_load_dwordx4 v1, s[4:7], s17 offen offset:2048 sc1 lds
    buffer_load_dwordx4 v1, s[4:7], s17 offen offset:3072 sc1 lds
    s_add_u32 m0, s42, 12288
    s_add_u32 s17, s41, 37879808
    buffer_load_dwordx4 v1, s[4:7], s17 offen offset:0 sc1 lds
    buffer_load_dwordx4 v1, s[4:7], s17 offen offset:1024 sc1 lds
    buffer_load_dwordx4 v1, s[4:7], s17 offen offset:2048 sc1 lds
    buffer_load_dwordx4 v1, s[4:7], s17 offen offset:3072 sc1 lds
    s_cmp_eq_u32 s20, 0
    s_cbranch_scc1 ploopH_19_nt
    s_mov_b32 exec_hi, 0xffff
    buffer_load_dword v60, v0, s[4:7], s31 offen sc1
    s_mov_b32 exec_hi, -1
ploopH_19_nt:
    s_cmp_eq_u32 s59, 0
    s_cbranch_scc1 ofl_27
    s_lshl_b32 s17, s16, 18
    s_add_u32 s17, s17, s60
    buffer_store_dwordx4 v[40:43], v1, s[4:7], s17 offen sc1
    s_mov_b32 s59, 0
ofl_27:
    s_cmp_eq_u32 s30, s54
    s_cbranch_scc1 pnoseg_28
    buffer_store_dwordx4 v[40:43], v7, s[4:7], s30 offen sc1
    s_add_u32 s30, s30, 65536
pnoseg_28:
    s_or_b32 s17, s13, s3
    s_cmp_lg_u32 s17, 0
    s_cbranch_scc1 ploopH_19_npg
    s_sub_u32 s21, s16, 1
    s_cbranch_scc1 ploopH_19_npg
    s_sub_u32 s17, s21, 1
    s_and_b32 s17, s17, 3
    s_cmp_ge_u32 s16, 58
    s_cselect_b32 s17, 0, s17
    s_cmp_lg_u32 s17, 0
    s_cbranch_scc1 ploopH_19_npg
    s_lshl_b32 s17, s12, 7
    s_add_u32 s17, s17, 218112000
    v_mov_b32 v9, s21
    s_mov_b64 exec, 1
    buffer_store_dword v9, off, s[4:7], s17 sc1
    s_mov_b64 exec, -1
ploopH_19_npg:
    s_barrier
    buffer_load_dword v60, off, s[4:7], s33 sc1
    s_add_u32 s16, s16, 1
    v_mov_b32 v59, s16
    s_add_u32 s41, s41, 262144
    s_add_u32 s31, s31, 262144
    s_mov_b32 s54, 0
    s_setprio 3
    s_sleep 13
ploopH_19_pagain:
    buffer_load_dwordx4 v[16:19], v1, s[4:7], s28 offen offset:0 sc1
    buffer_load_dwordx4 v[20:23], v1, s[4:7], s28 offen offset:1024 sc1
    s_waitcnt vmcnt(1)
    v_mfma_f32_16x16x32_bf16 v[32:35], v[12:15], v[16:19], 0
    s_waitcnt vmcnt(0)
    v_mfma_f32_16x16x32_bf16 v[32:35], v[48:51], v[20:23], v[32:35]
    v_max_u32 v9, v16, v20
    v_cmp_eq_u32 vcc, -1, v9
    s_cbranch_vccnz ploopH_19_rp
ploopH_19_pgo:
    s_nop 4
    v_add_f32_dpp v36, v32, v32 row_ror:8 row_mask:0xf bank_mask:0xf
    v_add_f32_dpp v37, v33, v33 row_ror:8 row_mask:0xf bank_mask:0xf
    v_add_f32_dpp v38, v34, v34 row_ror:8 row_mask:0xf bank_mask:0xf
    v_add_f32_dpp v39, v35, v35 row_ror:8 row_mask:0xf bank_mask:0xf
    v_cvt_pk_bf16_f32 v52, v36, v37
    v_cvt_pk_bf16_f32 v53, v38, v39
    s_nop 0
    v_permlane16_swap_b32 v52, v54
    v_permlane16_swap_b32 v53, v55
    s_mov_b64 exec, s[56:57]
    v_min_u32 v52, -2, v52
    buffer_store_dwordx4 v[52:55], v5, s[4:7], s24 offen
    s_mov_b64 exec, -1
    ds_write_b32 v63, v59 offset:16
    s_branch ploopH_19
ploopH_19_rm_0:
    s_sub_u32 s22, s22, 1
    s_cbranch_scc1 ploopH_19_rm_0_g
    buffer_load_dwordx4 v[16:19], v1, s[4:7], s23 offen offset:0 sc1
    buffer_load_dwordx4 v[20:23], v1, s[4:7], s23 offen offset:1024 sc1
    buffer_load_dwordx4 v[24:27], v1, s[4:7], s23 offen offset:2048 sc1
    buffer_load_dwordx4 v[28:31], v1, s[4:7], s23 offen offset:3072 sc1
    s_waitcnt vmcnt(3)
    v_cmp_eq_u32 vcc, -1, v16
    s_cbranch_vccnz ploopH_19_rm_0
    s_branch ploopH_19_rm_0ok
ploopH_19_rm_0_g:
    s_mov_b32 s22, 0
    s_waitcnt vmcnt(0)
    s_branch ploopH_19_rm_0ok
ploopH_19_rm_1:
    s_sub_u32 s22, s22, 1
    s_cbranch_scc1 ploopH_19_rm_1_g
    buffer_load_dwordx4 v[20:23], v1, s[4:7], s23 offen offset:1024 sc1
    buffer_load_dwordx4 v[24:27], v1, s[4:7], s23 offen offset:2048 sc1
    buffer_load_dwordx4 v[28:31], v1, s[4:7], s23 offen offset:3072 sc1
    s_waitcnt vmcnt(2)
    v_cmp_eq_u32 vcc, -1, v20
    s_cbranch_vccnz ploopH_19_rm_1
    s_branch ploopH_19_rm_1ok
ploopH_19_rm_1_g:
    s_mov_b32 s22, 0
    s_waitcnt vmcnt(0)
    s_branch ploopH_19_rm_1ok
ploopH_19_rm_2:
    s_sub_u32 s22, s22, 1
    s_cbranch_scc1 ploopH_19_rm_2_g
    buffer_load_dwordx4 v[24:27], v1, s[4:7], s23 offen offset:2048 sc1
    buffer_load_dwordx4 v[28:31], v1, s[4:7], s23 offen offset:3072 sc1
    s_waitcnt vmcnt(1)
    v_cmp_eq_u32 vcc, -1, v24
    s_cbranch_vccnz ploopH_19_rm_2
    s_branch ploopH_19_rm_2ok
ploopH_19_rm_2_g:
    s_mov_b32 s22, 0
    s_waitcnt vmcnt(0)
    s_branch ploopH_19_rm_2ok
ploopH_19_rm_3:
    s_sub_u32 s22, s22, 1
    s_cbranch_scc1 ploopH_19_rm_3_g
    buffer_load_dwordx4 v[28:31], v1, s[4:7], s23 offen offset:3072 sc1
    s_waitcnt vmcnt(0)
    v_cmp_eq_u32 vcc, -1, v28
    s_cbranch_vccnz ploopH_19_rm_3
    s_branch ploopH_19_rm_3ok
ploopH_19_rm_3_g:
    s_mov_b32 s22, 0
    s_waitcnt vmcnt(0)
    s_branch ploopH_19_rm_3ok
ploopH_19_rp:
    s_sub_u32 s22, s22, 1
    s_cbranch_scc0 ploopH_19_pagain
    s_mov_b32 s22, 0
    s_branch ploopH_19_pgo
ploopH_19_tail:
    ds_read_b128 v[16:19], v6 offset:0
    ds_read_b128 v[20:23], v6 offset:256
    ds_read_b128 v[24:27], v6 offset:512
    ds_read_b128 v[28:31], v6 offset:768
    v_xor_b32 v6, 0x4000, v6
    s_waitcnt lgkmcnt(2)
    v_mfma_f32_16x16x32_bf16 v[40:43], v[12:15], v[16:19], 0
    v_mfma_f32_16x16x32_bf16 v[40:43], v[48:51], v[20:23], v[40:43]
    s_waitcnt lgkmcnt(0)
    v_mfma_f32_16x16x32_bf16 v[44:47], v[12:15], v[24:27], 0
    v_mfma_f32_16x16x32_bf16 v[44:47], v[48:51], v[28:31], v[44:47]
    s_nop 7
    v_cvt_pk_bf16_f32 v40, v40, v41
    v_cvt_pk_bf16_f32 v41, v42, v43
    v_cvt_pk_bf16_f32 v42, v44, v45
    v_cvt_pk_bf16_f32 v43, v46, v47
    s_nop 1
    v_permlane16_swap_b32 v40, v42
    v_permlane16_swap_b32 v41, v43
    s_nop 1
    v_min_u32 v40, -2, v40
    buffer_store_dwordx4 v[40:43], v7, s[4:7], s30 offen sc1
    s_add_u32 s30, s30, 65536
    s_barrier
    ds_read_b128 v[16:19], v6 offset:0
    ds_read_b128 v[20:23], v6 offset:256
    ds_read_b128 v[24:27], v6 offset:512
    ds_read_b128 v[28:31], v6 offset:768
    v_xor_b32 v6, 0x4000, v6
    s_waitcnt lgkmcnt(2)
    v_mfma_f32_16x16x32_bf16 v[40:43], v[12:15], v[16:19], 0
    v_mfma_f32_16x16x32_bf16 v[40:43], v[48:51], v[20:23], v[40:43]
    s_waitcnt lgkmcnt(0)
    v_mfma_f32_16x16x32_bf16 v[44:47], v[12:15], v[24:27], 0
    v_mfma_f32_16x16x32_bf16 v[44:47], v[48:51], v[28:31], v[44:47]
    s_nop 7
    v_cvt_pk_bf16_f32 v40, v40, v41
    v_cvt_pk_bf16_f32 v41, v42, v43
    v_cvt_pk_bf16_f32 v42, v44, v45
    v_cvt_pk_bf16_f32 v43, v46, v47
    s_nop 1
    v_permlane16_swap_b32 v40, v42
    v_permlane16_swap_b32 v41, v43
    s_nop 1
    v_min_u32 v40, -2, v40
    buffer_store_dwordx4 v[40:43], v7, s[4:7], s30 offen sc1
    s_add_u32 s30, s30, 65536
    s_branch k_end
ch_p_slow:
    v_mov_b32 v32, 0
    v_mov_b32 v33, 0
    v_mov_b32 v34, 0
    v_mov_b32 v35, 0
    v_mov_b32 v36, 0
    v_mov_b32 v37, 0
    v_mov_b32 v38, 0
    v_mov_b32 v39, 0
    v_mov_b32 v40, 0
    v_mov_b32 v41, 0
    v_mov_b32 v42, 0
    v_mov_b32 v43, 0
    v_mov_b32 v44, 0
    v_mov_b32 v45, 0
    v_mov_b32 v46, 0
    v_mov_b32 v47, 0
    v_mov_b32 v48, 0
    v_mov_b32 v49, 0
    v_mov_b32 v50, 0
    v_mov_b32 v51, 0
    v_mov_b32 v52, 0
    v_mov_b32 v53, 0
    v_mov_b32 v54, 0
    v_mov_b32 v55, 0
    v_mov_b32 v59, 0
    s_nop 1
    s_branch ploopL_30_nc
.p2align 6
    s_nop 0
    s_nop 0
    s_nop 0
    s_nop 0
    s_nop 0
    s_nop 0
    s_nop 0
    s_nop 0
    s_nop 0
    s_nop 0
    s_nop 0
ploopL_30:
    v_mov_b32 v32, 0
    v_mov_b32 v33, 0
    v_mov_b32 v34, 0
    v_mov_b32 v35, 0
    v_mov_b32 v36, 0
    v_mov_b32 v37, 0
    v_mov_b32 v38, 0
    v_mov_b32 v39, 0
    v_mov_b32 v40, 0
    v_mov_b32 v41, 0
    v_mov_b32 v42, 0
    v_mov_b32 v43, 0
    v_mov_b32 v44, 0
    v_mov_b32 v45, 0
    v_mov_b32 v46, 0
    v_mov_b32 v47, 0
    v_mov_b32 v48, 0
    v_mov_b32 v49, 0
    v_mov_b32 v50, 0
    v_mov_b32 v51, 0
    v_mov_b32 v52, 0
    v_mov_b32 v53, 0
    v_mov_b32 v54, 0
    v_mov_b32 v55, 0
    s_bitcmp1_b32 s29, 0
    s_cbranch_scc1 gate_31_ok
    s_add_u32 s21, s16, 1
    s_min_u32 s21, s21, 63
    s_cmp_ge_u32 s21, 16
    s_cselect_b32 s19, 12, 8
    s_and_b32 s32, s21, 4
    s_lshr_b32 s21, s21, 3
    s_lshl_b32 s21, s21, 8
    s_add_u32 s32, s32, s21
    s_add_u32 s32, s32, s35
gate_31:
    buffer_load_dword v9, off, s[4:7], s32 sc1
    s_waitcnt vmcnt(0)
    v_readfirstlane_b32 s21, v9
    s_cmp_ge_u32 s21, s19
    s_cbranch_scc1 gate_31_set
    s_sleep 8
    s_sub_u32 s22, s22, 1
    s_cbranch_scc0 gate_31
    s_mov_b32 s22, 0
gate_31_set:
    s_bitset1_b32 s29, 0
gate_31_ok:
    s_sleep 1
    buffer_load_dwordx4 v[16:19], v1, s[4:7], s23 offen offset:0 sc1
    buffer_load_dwordx4 v[20:23], v1, s[4:7], s23 offen offset:1024 sc1
    buffer_load_dwordx4 v[24:27], v1, s[4:7], s23 offen offset:2048 sc1
    buffer_load_dwordx4 v[28:31], v1, s[4:7], s23 offen offset:3072 sc1
    s_waitcnt vmcnt(3)
    v_cmp_eq_u32 vcc, -1, v16
    s_cbranch_vccnz ploopL_30_rm_0
ploopL_30_rm_0ok:
    v_smfmac_f32_16x16x64_bf16 v[32:35], v[16:19], v[64:71], v8
    v_smfmac_f32_16x16x64_bf16 v[36:39], v[16:19], v[72:79], v8
    s_waitcnt vmcnt(2)
    v_cmp_eq_u32 vcc, -1, v20
    v_smfmac_f32_16x16x64_bf16 v[40:43], v[16:19], v[80:87], v8
    v_smfmac_f32_16x16x64_bf16 v[44:47], v[16:19], v[88:95], v8
    v_smfmac_f32_16x16x64_bf16 v[48:51], v[16:19], v[96:103], v8
    v_smfmac_f32_16x16x64_bf16 v[52:55], v[16:19], v[104:111], v8
    s_cbranch_vccnz ploopL_30_rm_1
ploopL_30_rm_1ok:
    v_smfmac_f32_16x16x64_bf16 v[32:35], v[20:23], v[112:119], v8
    v_smfmac_f32_16x16x64_bf16 v[36:39], v[20:23], v[120:127], v8
    s_waitcnt vmcnt(1)
    v_cmp_eq_u32 vcc, -1, v24
    v_smfmac_f32_16x16x64_bf16 v[40:43], v[20:23], v[128:135], v8
    v_smfmac_f32_16x16x64_bf16 v[44:47], v[20:23], v[136:143], v8
    v_smfmac_f32_16x16x64_bf16 v[48:51], v[20:23], v[144:151], v8
    v_smfmac_f32_16x16x64_bf16 v[52:55], v[20:23], v[152:159], v8
    s_cbranch_vccnz ploopL_30_rm_2
ploopL_30_rm_2ok:
    v_smfmac_f32_16x16x64_bf16 v[32:35], v[24:27], v[160:167], v8
    v_smfmac_f32_16x16x64_bf16 v[36:39], v[24:27], v[168:175], v8
    s_waitcnt vmcnt(0)
    v_cmp_eq_u32 vcc, -1, v28
    v_smfmac_f32_16x16x64_bf16 v[40:43], v[24:27], v[176:183], v8
    v_smfmac_f32_16x16x64_bf16 v[44:47], v[24:27], v[184:191], v8
    v_smfmac_f32_16x16x64_bf16 v[48:51], v[24:27], v[192:199], v8
    v_smfmac_f32_16x16x64_bf16 v[52:55], v[24:27], v[200:207], v8
    s_cbranch_vccnz ploopL_30_rm_3
ploopL_30_rm_3ok:
    v_smfmac_f32_16x16x64_bf16 v[32:35], v[28:31], v[208:215], v8
    ds_write_b32 v63, v59 offset:32
    v_smfmac_f32_16x16x64_bf16 v[36:39], v[28:31], v[216:223], v8
    v_smfmac_f32_16x16x64_bf16 v[40:43], v[28:31], v[224:231], v8
    v_smfmac_f32_16x16x64_bf16 v[44:47], v[28:31], v[232:239], v8
    v_smfmac_f32_16x16x64_bf16 v[48:51], v[28:31], v[240:247], v8
    v_smfmac_f32_16x16x64_bf16 v[52:55], v[28:31], v[248:255], v8
    s_branch ploopL_30_mmd
ploopL_30_nc:
    v_smfmac_f32_16x16x64_bf16 v[32:35], v[16:19], v[64:71], v8
    v_smfmac_f32_16x16x64_bf16 v[36:39], v[16:19], v[72:79], v8
    v_smfmac_f32_16x16x64_bf16 v[40:43], v[16:19], v[80:87], v8
    v_smfmac_f32_16x16x64_bf16 v[44:47], v[16:19], v[88:95], v8
    v_smfmac_f32_16x16x64_bf16 v[48:51], v[16:19], v[96:103], v8
    v_smfmac_f32_16x16x64_bf16 v[52:55], v[16:19], v[104:111], v8
    v_smfmac_f32_16x16x64_bf16 v[32:35], v[20:23], v[112:119], v8
    v_smfmac_f32_16x16x64_bf16 v[36:39], v[20:23], v[120:127], v8
    v_smfmac_f32_16x16x64_bf16 v[40:43], v[20:23], v[128:135], v8
    v_smfmac_f32_16x16x64_bf16 v[44:47], v[20:23], v[136:143], v8
    v_smfmac_f32_16x16x64_bf16 v[48:51], v[20:23], v[144:151], v8
    v_smfmac_f32_16x16x64_bf16 v[52:55], v[20:23], v[152:159], v8
    v_smfmac_f32_16x16x64_bf16 v[32:35], v[24:27], v[160:167], v8
    v_smfmac_f32_16x16x64_bf16 v[36:39], v[24:27], v[168:175], v8
    v_smfmac_f32_16x16x64_bf16 v[40:43], v[24:27], v[176:183], v8
    v_smfmac_f32_16x16x64_bf16 v[44:47], v[24:27], v[184:191], v8
    v_smfmac_f32_16x16x64_bf16 v[48:51], v[24:27], v[192:199], v8
    v_smfmac_f32_16x16x64_bf16 v[52:55], v[24:27], v[200:207], v8
    v_smfmac_f32_16x16x64_bf16 v[32:35], v[28:31], v[208:215], v8
    ds_write_b32 v63, v59 offset:32
    v_smfmac_f32_16x16x64_bf16 v[36:39], v[28:31], v[216:223], v8
    v_smfmac_f32_16x16x64_bf16 v[40:43], v[28:31], v[224:231], v8
    v_smfmac_f32_16x16x64_bf16 v[44:47], v[28:31], v[232:239], v8
    v_smfmac_f32_16x16x64_bf16 v[48:51], v[28:31], v[240:247], v8
    v_smfmac_f32_16x16x64_bf16 v[52:55], v[28:31], v[248:255], v8
ploopL_30_mmd:
    s_cmp_eq_u32 s3, 3
    s_nop 1
    v_add_f32 v32, v32, v34
    v_add_f32 v33, v33, v35
    ds_write2_b32 v3, v32, v33 offset0:0 offset1:40
    v_add_f32 v36, v36, v38
    v_add_f32 v37, v37, v39
    ds_write2_b32 v3, v36, v37 offset0:16 offset1:56
    v_add_f32 v40, v40, v42
    v_add_f32 v41, v41, v43
    ds_write2_b32 v61, v40, v41 offset0:0 offset1:40
    v_add_f32 v44, v44, v46
    v_add_f32 v45, v45, v47
    ds_write2_b32 v61, v44, v45 offset0:16 offset1:56
    v_add_f32 v48, v48, v50
    v_add_f32 v49, v49, v51
    ds_write2_b32 v62, v48, v49 offset0:0 offset1:40
    v_add_f32 v52, v52, v54
    v_add_f32 v53, v53, v55
    ds_write2_b32 v62, v52, v53 offset0:16 offset1:56
    s_waitcnt lgkmcnt(0)
    s_barrier
    s_cbranch_scc1 ploopL_30_sk1
    ds_read_b128 v[32:35], v4 offset:0
    ds_read_b128 v[36:39], v4 offset:3840
    ds_read_b128 v[40:43], v4 offset:7680
    ds_read_b128 v[44:47], v4 offset:11520
    s_waitcnt lgkmcnt(2)
    v_add_f32 v32, v32, v36
    v_add_f32 v33, v33, v37
    v_add_f32 v34, v34, v38
    v_add_f32 v35, v35, v39
    s_waitcnt lgkmcnt(0)
    v_add_f32 v40, v40, v44
    v_add_f32 v41, v41, v45
    v_add_f32 v42, v42, v46
    v_add_f32 v43, v43, v47
    v_add_f32 v32, v32, v40
    v_add_f32 v33, v33, v41
    v_add_f32 v34, v34, v42
    v_add_f32 v35, v35, v43
    v_cvt_pk_bf16_f32 v56, v32, v33
    v_cvt_pk_bf16_f32 v57, v34, v35
    v_min_u32 v56, -2, v56
    buffer_store_dwordx2 v[56:57], v2, s[4:7], s26 offen sc1
    s_add_u32 s27, s16, 2
    s_and_b32 s27, s27, 3
    s_lshl_b32 s27, s27, 18
    s_add_u32 s27, s27, s38
    buffer_store_dwordx2 v[10:11], v2, s[4:7], s27 offen sc1
ploopL_30_sk1:
    s_setprio 0
    s_add_u32 s25, s16, 3
    s_and_b32 s25, s25, 3
    s_lshl_b32 s25, s25, 16
    s_add_u32 s25, s25, s37
    v_mov_b32 v44, -1
    v_mov_b32 v45, -1
    v_mov_b32 v46, -1
    v_mov_b32 v47, -1
    s_mov_b64 exec, s[56:57]
    buffer_store_dwordx4 v[44:47], v5, s[4:7], s25 offen sc1
    s_mov_b64 exec, -1
    v_mov_b32_dpp v48, v12 row_ror:8 row_mask:0xf bank_mask:0xf
    v_mov_b32_dpp v49, v13 row_ror:8 row_mask:0xf bank_mask:0xf
    v_mov_b32_dpp v50, v14 row_ror:8 row_mask:0xf bank_mask:0xf
    v_mov_b32_dpp v51, v15 row_ror:8 row_mask:0xf bank_mask:0xf
    s_and_b32 s28, s16, 3
    s_lshl_b32 s28, s28, 18
    s_add_u32 s28, s28, s39
    s_add_u32 s24, s16, 1
    s_and_b32 s24, s24, 3
    s_lshl_b32 s24, s24, 16
    s_add_u32 s24, s24, s37
    s_add_u32 s23, s16, 1
    s_and_b32 s23, s23, 3
    s_lshl_b32 s23, s23, 16
    s_add_u32 s23, s23, s36
    s_add_u32 s26, s16, 1
    s_and_b32 s26, s26, 3
    s_lshl_b32 s26, s26, 18
    s_add_u32 s26, s26, s38
    s_cmp_eq_u32 s59, 0
    s_cbranch_scc1 ofl_32
    s_lshl_b32 s17, s3, 10
    v_add_u32 v39, s17, v1
    ds_read_b128 v[40:43], v39 offset:32768
ofl_32:
    s_cmp_ge_u32 s16, 16
    s_cbranch_scc1 ploopL_30_nx
    v_mov_b32 v40, v2
    v_mov_b32 v42, v56
    v_mov_b32 v43, v57
    s_cmp_lg_u32 s3, 2
    s_cbranch_scc1 ploopL_30_nx
    v_and_b32 v40, 0x60, v1
    v_lshlrev_b32 v40, 2, v40
    v_lshrrev_b32 v41, 3, v1
    v_and_b32 v41, 0x70, v41
    v_or_b32 v40, v40, v41
    v_bfe_u32 v41, v1, 4, 1
    v_lshl_or_b32 v40, v41, 3, v40
    s_lshl_b32 s17, s53, 9
    s_add_u32 s17, s17, 4096
    v_add_u32 v40, s17, v40
    s_mov_b32 vcc_lo, 0x55555555
    s_mov_b32 vcc_hi, 0x55555555
    v_cndmask_b32_dpp v42, v57, v56, vcc quad_perm:[1,0,3,2] row_mask:0xf bank_mask:0xf
    s_not_b64 vcc, vcc
    v_cndmask_b32_dpp v43, v56, v57, vcc quad_perm:[1,0,3,2] row_mask:0xf bank_mask:0xf
ploopL_30_nx:
    v_readfirstlane_b32 s21, v60
    s_lshr_b32 s29, s29, 1
    s_cmp_ge_u32 s21, s58
    s_cselect_b32 s21, 2, 0
    s_or_b32 s29, s29, s21
    s_cmp_eq_u32 s3, 3
    s_cselect_b32 s20, s21, 0
    s_add_u32 s21, s16, 4
    s_min_u32 s21, s21, 63
    s_cmp_ge_u32 s21, 16
    s_cselect_b32 s58, 12, 8
    s_and_b32 s33, s21, 4
    s_lshr_b32 s21, s21, 3
    s_lshl_b32 s21, s21, 8
    s_add_u32 s33, s33, s21
    s_add_u32 s33, s33, s35
    s_setprio 3
ploopL_30_fs:
    ds_read_b128 v[32:35], v58 offset:0
    s_waitcnt lgkmcnt(0)
    v_min3_i32 v32, v32, v33, v34
    v_min_i32 v32, v32, v35
    s_nop 0
    v_readfirstlane_b32 s18, v32
    s_cmp_ge_i32 s18, s16
    s_cbranch_scc1 ploopL_30_fsok
    s_sleep 1
    s_branch ploopL_30_fs
ploopL_30_fsok:
    s_setprio 1
    s_sleep 4
ploopL_30_nofd:
    s_cmp_eq_u32 s20, 0
    s_cbranch_scc1 ploopL_30_nt
    s_cmp_ge_u32 s16, 13
    s_cselect_b32 exec_hi, 0xffff, 0
    buffer_load_dword v60, v0, s[4:7], s31 offen sc1
    s_mov_b32 exec_hi, -1
ploopL_30_nt:
    s_cmp_eq_u32 s59, 0
    s_cbranch_scc1 ofl_33
    s_lshl_b32 s17, s16, 18
    s_add_u32 s17, s17, s60
    buffer_store_dwordx4 v[40:43], v1, s[4:7], s17 offen sc1
    s_mov_b32 s59, 0
ofl_33:
    s_lshr_b32 s17, s34, 3
    s_xor_b32 s17, s17, s16
    s_andn2_b32 s59, 1, s17
    s_cmp_ge_u32 s16, 16
    s_cselect_b32 s59, s59, 0
    s_cbranch_scc1 ploopL_30_nx2
    s_cmp_eq_u32 s3, 3
    s_cbranch_scc1 ploopL_30_nx2
    buffer_store_dwordx2 v[42:43], v40, s[4:7], s55 offen sc1
ploopL_30_nx2:
    s_add_u32 s55, s55, 262144
    s_or_b32 s17, s13, s3
    s_cmp_lg_u32 s17, 0
    s_cbranch_scc1 ploopL_30_npg
    s_sub_u32 s21, s16, 1
    s_cbranch_scc1 ploopL_30_npg
    s_sub_u32 s17, s21, 1
    s_and_b32 s17, s17, 3
    s_cmp_ge_u32 s16, 58
    s_cselect_b32 s17, 0, s17
    s_cmp_lg_u32 s17, 0
    s_cbranch_scc1 ploopL_30_npg
    s_lshl_b32 s17, s12, 7
    s_add_u32 s17, s17, 218112000
    v_mov_b32 v9, s21
    s_mov_b64 exec, 1
    buffer_store_dword v9, off, s[4:7], s17 sc1
    s_mov_b64 exec, -1
ploopL_30_npg:
    s_barrier
    buffer_load_dword v60, off, s[4:7], s33 sc1
    s_add_u32 s16, s16, 1
    v_mov_b32 v59, s16
    s_add_u32 s41, s41, 262144
    s_add_u32 s31, s31, 262144
    s_setprio 3
    s_sleep 13
ploopL_30_pagain:
    buffer_load_dwordx4 v[16:19], v1, s[4:7], s28 offen offset:0 sc1
    buffer_load_dwordx4 v[20:23], v1, s[4:7], s28 offen offset:1024 sc1
    s_waitcnt vmcnt(1)
    v_mfma_f32_16x16x32_bf16 v[32:35], v[12:15], v[16:19], 0
    s_waitcnt vmcnt(0)
    v_mfma_f32_16x16x32_bf16 v[32:35], v[48:51], v[20:23], v[32:35]
    v_max_u32 v9, v16, v20
    v_cmp_eq_u32 vcc, -1, v9
    s_cbranch_vccnz ploopL_30_rp
ploopL_30_pgo:
    s_cmp_lt_u32 s16, 48
    s_nop 3
    v_add_f32_dpp v36, v32, v32 row_ror:8 row_mask:0xf bank_mask:0xf
    v_add_f32_dpp v37, v33, v33 row_ror:8 row_mask:0xf bank_mask:0xf
    v_add_f32_dpp v38, v34, v34 row_ror:8 row_mask:0xf bank_mask:0xf
    v_add_f32_dpp v39, v35, v35 row_ror:8 row_mask:0xf bank_mask:0xf
    v_cvt_pk_bf16_f32 v52, v36, v37
    v_cvt_pk_bf16_f32 v53, v38, v39
    s_nop 0
    v_permlane16_swap_b32 v52, v54
    v_permlane16_swap_b32 v53, v55
    s_mov_b64 exec, s[56:57]
    v_min_u32 v52, -2, v52
    buffer_store_dwordx4 v[52:55], v5, s[4:7], s24 offen sc1
    s_mov_b64 exec, -1
    ds_write_b32 v63, v59 offset:16
    s_cbranch_scc1 ploopL_30
    s_branch ploopH_29
ploopL_30_rm_0:
    s_sub_u32 s22, s22, 1
    s_cbranch_scc1 ploopL_30_rm_0_g
    buffer_load_dwordx4 v[16:19], v1, s[4:7], s23 offen offset:0 sc1
    buffer_load_dwordx4 v[20:23], v1, s[4:7], s23 offen offset:1024 sc1
    buffer_load_dwordx4 v[24:27], v1, s[4:7], s23 offen offset:2048 sc1
    buffer_load_dwordx4 v[28:31], v1, s[4:7], s23 offen offset:3072 sc1
    s_waitcnt vmcnt(3)
    v_cmp_eq_u32 vcc, -1, v16
    s_cbranch_vccnz ploopL_30_rm_0
    s_branch ploopL_30_rm_0ok
ploopL_30_rm_0_g:
    s_mov_b32 s22, 0
    s_waitcnt vmcnt(0)
    s_branch ploopL_30_rm_0ok
ploopL_30_rm_1:
    s_sub_u32 s22, s22, 1
    s_cbranch_scc1 ploopL_30_rm_1_g
    buffer_load_dwordx4 v[20:23], v1, s[4:7], s23 offen offset:1024 sc1
    buffer_load_dwordx4 v[24:27], v1, s[4:7], s23 offen offset:2048 sc1
    buffer_load_dwordx4 v[28:31], v1, s[4:7], s23 offen offset:3072 sc1
    s_waitcnt vmcnt(2)
    v_cmp_eq_u32 vcc, -1, v20
    s_cbranch_vccnz ploopL_30_rm_1
    s_branch ploopL_30_rm_1ok
ploopL_30_rm_1_g:
    s_mov_b32 s22, 0
    s_waitcnt vmcnt(0)
    s_branch ploopL_30_rm_1ok
ploopL_30_rm_2:
    s_sub_u32 s22, s22, 1
    s_cbranch_scc1 ploopL_30_rm_2_g
    buffer_load_dwordx4 v[24:27], v1, s[4:7], s23 offen offset:2048 sc1
    buffer_load_dwordx4 v[28:31], v1, s[4:7], s23 offen offset:3072 sc1
    s_waitcnt vmcnt(1)
    v_cmp_eq_u32 vcc, -1, v24
    s_cbranch_vccnz ploopL_30_rm_2
    s_branch ploopL_30_rm_2ok
ploopL_30_rm_2_g:
    s_mov_b32 s22, 0
    s_waitcnt vmcnt(0)
    s_branch ploopL_30_rm_2ok
ploopL_30_rm_3:
    s_sub_u32 s22, s22, 1
    s_cbranch_scc1 ploopL_30_rm_3_g
    buffer_load_dwordx4 v[28:31], v1, s[4:7], s23 offen offset:3072 sc1
    s_waitcnt vmcnt(0)
    v_cmp_eq_u32 vcc, -1, v28
    s_cbranch_vccnz ploopL_30_rm_3
    s_branch ploopL_30_rm_3ok
ploopL_30_rm_3_g:
    s_mov_b32 s22, 0
    s_waitcnt vmcnt(0)
    s_branch ploopL_30_rm_3ok
ploopL_30_rp:
    s_sub_u32 s22, s22, 1
    s_cbranch_scc0 ploopL_30_pagain
    s_mov_b32 s22, 0
    s_branch ploopL_30_pgo
.p2align 6
    s_nop 0
    s_nop 0
    s_nop 0
    s_nop 0
    s_nop 0
    s_nop 0
    s_nop 0
    s_nop 0
    s_nop 0
    s_nop 0
    s_nop 0
ploopH_29:
    v_mov_b32 v32, 0
    v_mov_b32 v33, 0
    v_mov_b32 v34, 0
    v_mov_b32 v35, 0
    v_mov_b32 v36, 0
    v_mov_b32 v37, 0
    v_mov_b32 v38, 0
    v_mov_b32 v39, 0
    v_mov_b32 v40, 0
    v_mov_b32 v41, 0
    v_mov_b32 v42, 0
    v_mov_b32 v43, 0
    v_mov_b32 v44, 0
    v_mov_b32 v45, 0
    v_mov_b32 v46, 0
    v_mov_b32 v47, 0
    v_mov_b32 v48, 0
    v_mov_b32 v49, 0
    v_mov_b32 v50, 0
    v_mov_b32 v51, 0
    v_mov_b32 v52, 0
    v_mov_b32 v53, 0
    v_mov_b32 v54, 0
    v_mov_b32 v55, 0
    s_sleep 1
    buffer_load_dwordx4 v[16:19], v1, s[4:7], s23 offen offset:0 sc1
    buffer_load_dwordx4 v[20:23], v1, s[4:7], s23 offen offset:1024 sc1
    buffer_load_dwordx4 v[24:27], v1, s[4:7], s23 offen offset:2048 sc1
    buffer_load_dwordx4 v[28:31], v1, s[4:7], s23 offen offset:3072 sc1
    s_waitcnt vmcnt(3)
    v_cmp_eq_u32 vcc, -1, v16
    s_cbranch_vccnz ploopH_29_rm_0
ploopH_29_rm_0ok:
    v_smfmac_f32_16x16x64_bf16 v[32:35], v[16:19], v[64:71], v8
    v_smfmac_f32_16x16x64_bf16 v[36:39], v[16:19], v[72:79], v8
    s_waitcnt vmcnt(2)
    v_cmp_eq_u32 vcc, -1, v20
    v_smfmac_f32_16x16x64_bf16 v[40:43], v[16:19], v[80:87], v8
    v_smfmac_f32_16x16x64_bf16 v[44:47], v[16:19], v[88:95], v8
    v_smfmac_f32_16x16x64_bf16 v[48:51], v[16:19], v[96:103], v8
    v_smfmac_f32_16x16x64_bf16 v[52:55], v[16:19], v[104:111], v8
    s_cbranch_vccnz ploopH_29_rm_1
ploopH_29_rm_1ok:
    v_smfmac_f32_16x16x64_bf16 v[32:35], v[20:23], v[112:119], v8
    v_smfmac_f32_16x16x64_bf16 v[36:39], v[20:23], v[120:127], v8
    s_waitcnt vmcnt(1)
    v_cmp_eq_u32 vcc, -1, v24
    v_smfmac_f32_16x16x64_bf16 v[40:43], v[20:23], v[128:135], v8
    v_smfmac_f32_16x16x64_bf16 v[44:47], v[20:23], v[136:143], v8
    v_smfmac_f32_16x16x64_bf16 v[48:51], v[20:23], v[144:151], v8
    v_smfmac_f32_16x16x64_bf16 v[52:55], v[20:23], v[152:159], v8
    s_cbranch_vccnz ploopH_29_rm_2
ploopH_29_rm_2ok:
    v_smfmac_f32_16x16x64_bf16 v[32:35], v[24:27], v[160:167], v8
    v_smfmac_f32_16x16x64_bf16 v[36:39], v[24:27], v[168:175], v8
    s_waitcnt vmcnt(0)
    v_cmp_eq_u32 vcc, -1, v28
    v_smfmac_f32_16x16x64_bf16 v[40:43], v[24:27], v[176:183], v8
    v_smfmac_f32_16x16x64_bf16 v[44:47], v[24:27], v[184:191], v8
    v_smfmac_f32_16x16x64_bf16 v[48:51], v[24:27], v[192:199], v8
    v_smfmac_f32_16x16x64_bf16 v[52:55], v[24:27], v[200:207], v8
    s_cbranch_vccnz ploopH_29_rm_3
ploopH_29_rm_3ok:
    v_smfmac_f32_16x16x64_bf16 v[32:35], v[28:31], v[208:215], v8
    ds_write_b32 v63, v59 offset:32
    v_smfmac_f32_16x16x64_bf16 v[36:39], v[28:31], v[216:223], v8
    v_smfmac_f32_16x16x64_bf16 v[40:43], v[28:31], v[224:231], v8
    v_smfmac_f32_16x16x64_bf16 v[44:47], v[28:31], v[232:239], v8
    v_smfmac_f32_16x16x64_bf16 v[48:51], v[28:31], v[240:247], v8
    v_smfmac_f32_16x16x64_bf16 v[52:55], v[28:31], v[248:255], v8
    s_cmp_eq_u32 s3, 3
    s_nop 1
    v_add_f32 v32, v32, v34
    v_add_f32 v33, v33, v35
    ds_write2_b32 v3, v32, v33 offset0:0 offset1:40
    v_add_f32 v36, v36, v38
    v_add_f32 v37, v37, v39
    ds_write2_b32 v3, v36, v37 offset0:16 offset1:56
    v_add_f32 v40, v40, v42
    v_add_f32 v41, v41, v43
    ds_write2_b32 v61, v40, v41 offset0:0 offset1:40
    v_add_f32 v44, v44, v46
    v_add_f32 v45, v45, v47
    ds_write2_b32 v61, v44, v45 offset0:16 offset1:56
    v_add_f32 v48, v48, v50
    v_add_f32 v49, v49, v51
    ds_write2_b32 v62, v48, v49 offset0:0 offset1:40
    v_add_f32 v52, v52, v54
    v_add_f32 v53, v53, v55
    ds_write2_b32 v62, v52, v53 offset0:16 offset1:56
    s_waitcnt lgkmcnt(0)
    s_barrier
    s_cbranch_scc1 ploopH_29_sk1
    ds_read_b128 v[32:35], v4 offset:0
    ds_read_b128 v[36:39], v4 offset:3840
    ds_read_b128 v[40:43], v4 offset:7680
    ds_read_b128 v[44:47], v4 offset:11520
    s_waitcnt lgkmcnt(2)
    v_add_f32 v32, v32, v36
    v_add_f32 v33, v33, v37
    v_add_f32 v34, v34, v38
    v_add_f32 v35, v35, v39
    s_waitcnt lgkmcnt(0)
    v_add_f32 v40, v40, v44
    v_add_f32 v41, v41, v45
    v_add_f32 v42, v42, v46
    v_add_f32 v43, v43, v47
    v_add_f32 v32, v32, v40
    v_add_f32 v33, v33, v41
    v_add_f32 v34, v34, v42
    v_add_f32 v35, v35, v43
    v_cvt_pk_bf16_f32 v56, v32, v33
    v_cvt_pk_bf16_f32 v57, v34, v35
    v_min_u32 v56, -2, v56
    buffer_store_dwordx2 v[56:57], v2, s[4:7], s26 offen sc1
    s_add_u32 s27, s16, 2
    s_and_b32 s27, s27, 3
    s_lshl_b32 s27, s27, 18
    s_add_u32 s27, s27, s38
    buffer_store_dwordx2 v[10:11], v2, s[4:7], s27 offen sc1
ploopH_29_sk1:
    s_setprio 0
    s_add_u32 s25, s16, 3
    s_and_b32 s25, s25, 3
    s_lshl_b32 s25, s25, 16
    s_add_u32 s25, s25, s37
    v_mov_b32 v44, -1
    v_mov_b32 v45, -1
    v_mov_b32 v46, -1
    v_mov_b32 v47, -1
    s_mov_b64 exec, s[56:57]
    buffer_store_dwordx4 v[44:47], v5, s[4:7], s25 offen sc1
    s_mov_b64 exec, -1
    v_mov_b32_dpp v48, v12 row_ror:8 row_mask:0xf bank_mask:0xf
    v_mov_b32_dpp v49, v13 row_ror:8 row_mask:0xf bank_mask:0xf
    v_mov_b32_dpp v50, v14 row_ror:8 row_mask:0xf bank_mask:0xf
    v_mov_b32_dpp v51, v15 row_ror:8 row_mask:0xf bank_mask:0xf
    s_and_b32 s28, s16, 3
    s_lshl_b32 s28, s28, 18
    s_add_u32 s28, s28, s39
    s_add_u32 s24, s16, 1
    s_and_b32 s24, s24, 3
    s_lshl_b32 s24, s24, 16
    s_add_u32 s24, s24, s37
    s_add_u32 s23, s16, 1
    s_and_b32 s23, s23, 3
    s_lshl_b32 s23, s23, 16
    s_add_u32 s23, s23, s36
    s_add_u32 s26, s16, 1
    s_and_b32 s26, s26, 3
    s_lshl_b32 s26, s26, 18
    s_add_u32 s26, s26, s38
    s_cmp_eq_u32 s59, 0
    s_cbranch_scc1 ofl_34
    s_lshl_b32 s17, s3, 10
    v_add_u32 v39, s17, v1
    ds_read_b128 v[40:43], v39 offset:32768
ofl_34:
    s_cmp_eq_u32 s16, 63
    s_cbranch_scc1 ploopH_29_tail
    s_cmp_eq_u32 s30, s54
    s_cbranch_scc1 pnoseg_35
    ds_read_b128 v[16:19], v6 offset:0
    ds_read_b128 v[20:23], v6 offset:256
    ds_read_b128 v[24:27], v6 offset:512
    ds_read_b128 v[28:31], v6 offset:768
    v_xor_b32 v6, 0x4000, v6
    s_waitcnt lgkmcnt(2)
    v_mfma_f32_16x16x32_bf16 v[40:43], v[12:15], v[16:19], 0
    v_mfma_f32_16x16x32_bf16 v[40:43], v[48:51], v[20:23], v[40:43]
    s_waitcnt lgkmcnt(0)
    v_mfma_f32_16x16x32_bf16 v[44:47], v[12:15], v[24:27], 0
    v_mfma_f32_16x16x32_bf16 v[44:47], v[48:51], v[28:31], v[44:47]
    s_nop 7
    v_cvt_pk_bf16_f32 v40, v40, v41
    v_cvt_pk_bf16_f32 v41, v42, v43
    v_cvt_pk_bf16_f32 v42, v44, v45
    v_cvt_pk_bf16_f32 v43, v46, v47
    s_nop 1
    v_permlane16_swap_b32 v40, v42
    v_permlane16_swap_b32 v41, v43
    s_nop 1
    v_min_u32 v40, -2, v40
pnoseg_35:
    s_bitcmp1_b32 s29, 0
    s_cbranch_scc1 gate_36_ok
    s_add_u32 s21, s16, 1
    s_min_u32 s21, s21, 63
    s_cmp_ge_u32 s21, 16
    s_cselect_b32 s19, 12, 8
    s_and_b32 s32, s21, 4
    s_lshr_b32 s21, s21, 3
    s_lshl_b32 s21, s21, 8
    s_add_u32 s32, s32, s21
    s_add_u32 s32, s32, s35
gate_36:
    buffer_load_dword v9, off, s[4:7], s32 sc1
    s_waitcnt vmcnt(0)
    v_readfirstlane_b32 s21, v9
    s_cmp_ge_u32 s21, s19
    s_cbranch_scc1 gate_36_set
    s_sleep 8
    s_sub_u32 s22, s22, 1
    s_cbranch_scc0 gate_36
    s_mov_b32 s22, 0
gate_36_set:
    s_bitset1_b32 s29, 0
gate_36_ok:
    v_readfirstlane_b32 s21, v60
    s_lshr_b32 s29, s29, 1
    s_cmp_ge_u32 s21, s58
    s_cselect_b32 s21, 2, 0
    s_or_b32 s29, s29, s21
    s_cmp_eq_u32 s3, 3
    s_cselect_b32 s20, s21, 0
    s_add_u32 s21, s16, 4
    s_min_u32 s21, s21, 63
    s_cmp_ge_u32 s21, 16
    s_cselect_b32 s58, 12, 8
    s_and_b32 s33, s21, 4
    s_lshr_b32 s21, s21, 3
    s_lshl_b32 s21, s21, 8
    s_add_u32 s33, s33, s21
    s_add_u32 s33, s33, s35
    s_setprio 3
ploopH_29_fs:
    ds_read_b128 v[32:35], v58 offset:0
    s_waitcnt lgkmcnt(0)
    v_min3_i32 v32, v32, v33, v34
    v_min_i32 v32, v32, v35
    s_nop 0
    v_readfirstlane_b32 s18, v32
    s_cmp_ge_i32 s18, s16
    s_cbranch_scc1 ploopH_29_fsok
    s_sleep 1
    s_branch ploopH_29_fs
ploopH_29_fsok:
    s_setprio 1
    s_add_u32 m0, s42, 8192
    s_add_u32 s17, s41, 37748736
    buffer_load_dwordx4 v1, s[4:7], s17 offen offset:0 sc1 lds
    buffer_load_dwordx4 v1, s[4:7], s17 offen offset:1024 sc1 lds
    buffer_load_dwordx4 v1, s[4:7], s17 offen offset:2048 sc1 lds
    buffer_load_dwordx4 v1, s[4:7], s17 offen offset:3072 sc1 lds
    s_add_u32 m0, s42, 12288
    s_add_u32 s17, s41, 37879808
    buffer_load_dwordx4 v1, s[4:7], s17 offen offset:0 sc1 lds
    buffer_load_dwordx4 v1, s[4:7], s17 offen offset:1024 sc1 lds
    buffer_load_dwordx4 v1, s[4:7], s17 offen offset:2048 sc1 lds
    buffer_load_dwordx4 v1, s[4:7], s17 offen offset:3072 sc1 lds
    s_cmp_eq_u32 s20, 0
    s_cbranch_scc1 ploopH_29_nt
    s_mov_b32 exec_hi, 0xffff
    buffer_load_dword v60, v0, s[4:7], s31 offen sc1
    s_mov_b32 exec_hi, -1
ploopH_29_nt:
    s_cmp_eq_u32 s59, 0
    s_cbranch_scc1 ofl_37
    s_lshl_b32 s17, s16, 18
    s_add_u32 s17, s17, s60
    buffer_store_dwordx4 v[40:43], v1, s[4:7], s17 offen sc1
    s_mov_b32 s59, 0
ofl_37:
    s_cmp_eq_u32 s30, s54
    s_cbranch_scc1 pnoseg_38
    buffer_store_dwordx4 v[40:43], v7, s[4:7], s30 offen sc1
    s_add_u32 s30, s30, 65536
pnoseg_38:
    s_or_b32 s17, s13, s3
    s_cmp_lg_u32 s17, 0
    s_cbranch_scc1 ploopH_29_npg
    s_sub_u32 s21, s16, 1
    s_cbranch_scc1 ploopH_29_npg
    s_sub_u32 s17, s21, 1
    s_and_b32 s17, s17, 3
    s_cmp_ge_u32 s16, 58
    s_cselect_b32 s17, 0, s17
    s_cmp_lg_u32 s17, 0
    s_cbranch_scc1 ploopH_29_npg
    s_lshl_b32 s17, s12, 7
    s_add_u32 s17, s17, 218112000
    v_mov_b32 v9, s21
    s_mov_b64 exec, 1
    buffer_store_dword v9, off, s[4:7], s17 sc1
    s_mov_b64 exec, -1
ploopH_29_npg:
    s_barrier
    buffer_load_dword v60, off, s[4:7], s33 sc1
    s_add_u32 s16, s16, 1
    v_mov_b32 v59, s16
    s_add_u32 s41, s41, 262144
    s_add_u32 s31, s31, 262144
    s_mov_b32 s54, 0
    s_setprio 3
    s_sleep 13
ploopH_29_pagain:
    buffer_load_dwordx4 v[16:19], v1, s[4:7], s28 offen offset:0 sc1
    buffer_load_dwordx4 v[20:23], v1, s[4:7], s28 offen offset:1024 sc1
    s_waitcnt vmcnt(1)
    v_mfma_f32_16x16x32_bf16 v[32:35], v[12:15], v[16:19], 0
    s_waitcnt vmcnt(0)
    v_mfma_f32_16x16x32_bf16 v[32:35], v[48:51], v[20:23], v[32:35]
    v_max_u32 v9, v16, v20
    v_cmp_eq_u32 vcc, -1, v9
    s_cbranch_vccnz ploopH_29_rp
ploopH_29_pgo:
    s_nop 4
    v_add_f32_dpp v36, v32, v32 row_ror:8 row_mask:0xf bank_mask:0xf
    v_add_f32_dpp v37, v33, v33 row_ror:8 row_mask:0xf bank_mask:0xf
    v_add_f32_dpp v38, v34, v34 row_ror:8 row_mask:0xf bank_mask:0xf
    v_add_f32_dpp v39, v35, v35 row_ror:8 row_mask:0xf bank_mask:0xf
    v_cvt_pk_bf16_f32 v52, v36, v37
    v_cvt_pk_bf16_f32 v53, v38, v39
    s_nop 0
    v_permlane16_swap_b32 v52, v54
    v_permlane16_swap_b32 v53, v55
    s_mov_b64 exec, s[56:57]
    v_min_u32 v52, -2, v52
    buffer_store_dwordx4 v[52:55], v5, s[4:7], s24 offen sc1
    s_mov_b64 exec, -1
    ds_write_b32 v63, v59 offset:16
    s_branch ploopH_29
ploopH_29_rm_0:
    s_sub_u32 s22, s22, 1
    s_cbranch_scc1 ploopH_29_rm_0_g
    buffer_load_dwordx4 v[16:19], v1, s[4:7], s23 offen offset:0 sc1
    buffer_load_dwordx4 v[20:23], v1, s[4:7], s23 offen offset:1024 sc1
    buffer_load_dwordx4 v[24:27], v1, s[4:7], s23 offen offset:2048 sc1
    buffer_load_dwordx4 v[28:31], v1, s[4:7], s23 offen offset:3072 sc1
    s_waitcnt vmcnt(3)
    v_cmp_eq_u32 vcc, -1, v16
    s_cbranch_vccnz ploopH_29_rm_0
    s_branch ploopH_29_rm_0ok
ploopH_29_rm_0_g:
    s_mov_b32 s22, 0
    s_waitcnt vmcnt(0)
    s_branch ploopH_29_rm_0ok
ploopH_29_rm_1:
    s_sub_u32 s22, s22, 1
    s_cbranch_scc1 ploopH_29_rm_1_g
    buffer_load_dwordx4 v[20:23], v1, s[4:7], s23 offen offset:1024 sc1
    buffer_load_dwordx4 v[24:27], v1, s[4:7], s23 offen offset:2048 sc1
    buffer_load_dwordx4 v[28:31], v1, s[4:7], s23 offen offset:3072 sc1
    s_waitcnt vmcnt(2)
    v_cmp_eq_u32 vcc, -1, v20
    s_cbranch_vccnz ploopH_29_rm_1
    s_branch ploopH_29_rm_1ok
ploopH_29_rm_1_g:
    s_mov_b32 s22, 0
    s_waitcnt vmcnt(0)
    s_branch ploopH_29_rm_1ok
ploopH_29_rm_2:
    s_sub_u32 s22, s22, 1
    s_cbranch_scc1 ploopH_29_rm_2_g
    buffer_load_dwordx4 v[24:27], v1, s[4:7], s23 offen offset:2048 sc1
    buffer_load_dwordx4 v[28:31], v1, s[4:7], s23 offen offset:3072 sc1
    s_waitcnt vmcnt(1)
    v_cmp_eq_u32 vcc, -1, v24
    s_cbranch_vccnz ploopH_29_rm_2
    s_branch ploopH_29_rm_2ok
ploopH_29_rm_2_g:
    s_mov_b32 s22, 0
    s_waitcnt vmcnt(0)
    s_branch ploopH_29_rm_2ok
ploopH_29_rm_3:
    s_sub_u32 s22, s22, 1
    s_cbranch_scc1 ploopH_29_rm_3_g
    buffer_load_dwordx4 v[28:31], v1, s[4:7], s23 offen offset:3072 sc1
    s_waitcnt vmcnt(0)
    v_cmp_eq_u32 vcc, -1, v28
    s_cbranch_vccnz ploopH_29_rm_3
    s_branch ploopH_29_rm_3ok
ploopH_29_rm_3_g:
    s_mov_b32 s22, 0
    s_waitcnt vmcnt(0)
    s_branch ploopH_29_rm_3ok
ploopH_29_rp:
    s_sub_u32 s22, s22, 1
    s_cbranch_scc0 ploopH_29_pagain
    s_mov_b32 s22, 0
    s_branch ploopH_29_pgo
ploopH_29_tail:
    ds_read_b128 v[16:19], v6 offset:0
    ds_read_b128 v[20:23], v6 offset:256
    ds_read_b128 v[24:27], v6 offset:512
    ds_read_b128 v[28:31], v6 offset:768
    v_xor_b32 v6, 0x4000, v6
    s_waitcnt lgkmcnt(2)
    v_mfma_f32_16x16x32_bf16 v[40:43], v[12:15], v[16:19], 0
    v_mfma_f32_16x16x32_bf16 v[40:43], v[48:51], v[20:23], v[40:43]
    s_waitcnt lgkmcnt(0)
    v_mfma_f32_16x16x32_bf16 v[44:47], v[12:15], v[24:27], 0
    v_mfma_f32_16x16x32_bf16 v[44:47], v[48:51], v[28:31], v[44:47]
    s_nop 7
    v_cvt_pk_bf16_f32 v40, v40, v41
    v_cvt_pk_bf16_f32 v41, v42, v43
    v_cvt_pk_bf16_f32 v42, v44, v45
    v_cvt_pk_bf16_f32 v43, v46, v47
    s_nop 1
    v_permlane16_swap_b32 v40, v42
    v_permlane16_swap_b32 v41, v43
    s_nop 1
    v_min_u32 v40, -2, v40
    buffer_store_dwordx4 v[40:43], v7, s[4:7], s30 offen sc1
    s_add_u32 s30, s30, 65536
    s_barrier
    ds_read_b128 v[16:19], v6 offset:0
    ds_read_b128 v[20:23], v6 offset:256
    ds_read_b128 v[24:27], v6 offset:512
    ds_read_b128 v[28:31], v6 offset:768
    v_xor_b32 v6, 0x4000, v6
    s_waitcnt lgkmcnt(2)
    v_mfma_f32_16x16x32_bf16 v[40:43], v[12:15], v[16:19], 0
    v_mfma_f32_16x16x32_bf16 v[40:43], v[48:51], v[20:23], v[40:43]
    s_waitcnt lgkmcnt(0)
    v_mfma_f32_16x16x32_bf16 v[44:47], v[12:15], v[24:27], 0
    v_mfma_f32_16x16x32_bf16 v[44:47], v[48:51], v[28:31], v[44:47]
    s_nop 7
    v_cvt_pk_bf16_f32 v40, v40, v41
    v_cvt_pk_bf16_f32 v41, v42, v43
    v_cvt_pk_bf16_f32 v42, v44, v45
    v_cvt_pk_bf16_f32 v43, v46, v47
    s_nop 1
    v_permlane16_swap_b32 v40, v42
    v_permlane16_swap_b32 v41, v43
    s_nop 1
    v_min_u32 v40, -2, v40
    buffer_store_dwordx4 v[40:43], v7, s[4:7], s30 offen sc1
    s_add_u32 s30, s30, 65536
    s_branch k_end
ch_a_pro:
    s_sub_u32 s21, s3, 4
    s_lshl_b32 s15, s14, 2
    s_add_u32 s15, s15, s21
    s_lshl_b32 s38, s15, 13
    s_add_u32 s38, s38, 214958080
    s_cmp_lg_u32 s3, 7
    s_cbranch_scc1 ch_nrp
    s_mov_b32 s95, 0x10000
rp_39:
    buffer_load_dword v28, off, s[64:67], 0 offset:224 sc1
    s_waitcnt vmcnt(0)
    v_readfirstlane_b32 s96, v28
    s_cmp_lg_u32 s96, 0
    s_cbranch_scc1 rp_39_ok
    s_sleep 2
    s_sub_u32 s95, s95, 1
    s_cbranch_scc0 rp_39
    s_add_u32 s96, s97, 1
rp_39_ok:
    s_sub_u32 s96, s96, 1
    v_mov_b32 v27, 131136
    v_mov_b32 v28, s96
    ds_write_b32 v27, v28
    s_waitcnt lgkmcnt(0)
ch_nrp:
    s_barrier
    v_mov_b32 v27, 131136
    ds_read_b32 v27, v27
    s_mov_b32 s96, s97
    s_waitcnt lgkmcnt(0)
    v_readfirstlane_b32 s97, v27
    s_cmp_lg_u32 s96, s97
    s_cbranch_scc1 k_restart
    s_min_u32 s20, s21, 2
    s_lshl_b32 s18, s20, 3
    s_add_u32 s18, s18, 16
    s_load_dwordx2 s[8:9], s[0:1], s18
    s_mov_b32 s10, 8388608
    s_mov_b32 s11, 131072
    v_and_b32 v20, 63, v0
    v_lshlrev_b32 v21, 13, v20
    s_lshl_b32 s17, s34, 19
    s_lshl_b32 s18, s14, 10
    s_add_u32 s17, s17, s18
    s_waitcnt lgkmcnt(0)
    buffer_load_dword v26, v21, s[8:11], s17 offen offset:384
    v_and_b32 v20, 63, v0
    v_lshrrev_b32 v21, 4, v20
    v_bfe_u32 v22, v20, 1, 1
    v_xor_b32 v22, 1, v22
    v_lshl_add_u32 v23, v22, 2, v21
    v_bfe_u32 v22, v20, 2, 2
    v_and_b32 v24, 1, v20
    v_lshl_add_u32 v22, v22, 1, v24
    v_lshl_add_u32 v23, v23, 3, v22
    v_and_b32 v22, 7, v20
    v_lshlrev_b32 v23, 4, v23
    s_lshl_b32 s17, s21, 10
    s_add_u32 s17, s17, 16384
    v_add_u32 v160, s17, v23
    v_and_b32 v24, 15, v20
    v_lshlrev_b32 v24, 4, v24
    v_lshl_add_u32 v23, v21, 10, v24
    s_lshl_b32 s17, s21, 8
    s_add_u32 s17, s17, 16384
    v_add_u32 v161, s17, v23
    v_lshl_add_u32 v23, v21, 9, v24
    s_lshl_b32 s17, s21, 12
    s_add_u32 s17, s17, 32768
    v_add_u32 v162, s17, v23
    v_bfe_u32 v23, v20, 3, 1
    v_lshlrev_b32 v23, 10, v23
    v_lshl_add_u32 v23, v22, 4, v23
    v_mov_b32 v1, v23
    s_lshl_b32 s39, s34, 14
    s_lshl_b32 s17, s21, 11
    s_add_u32 s39, s39, s17
    s_lshl_b32 s17, s14, 7
    s_add_u32 s39, s39, s17
    s_add_u32 s39, s39, 209715200
    v_mov_b32 v176, -1
    v_mov_b32 v177, -1
    v_mov_b32 v178, -1
    v_mov_b32 v179, -1
    v_lshlrev_b32 v24, 4, v0
    s_lshl_b32 s17, s52, 13
    s_add_u32 s19, s17, 209711104
    s_add_u32 s17, s17, 214953984
    s_lshl_b32 s18, s52, 12
    s_add_u32 s18, s18, 213905408
    buffer_store_dwordx4 v[176:179], v24, s[4:7], s19 offen sc1
    s_add_u32 s19, s19, 4096
    buffer_store_dwordx4 v[176:179], v24, s[4:7], s19 offen sc1
    buffer_store_dwordx4 v[176:179], v24, s[4:7], s17 offen sc1
    s_add_u32 s17, s17, 4096
    buffer_store_dwordx4 v[176:179], v24, s[4:7], s17 offen sc1
    buffer_store_dwordx4 v[176:179], v24, s[4:7], s18 offen sc1
    s_and_b32 s17, s13, 7
    s_sub_u32 s18, s21, 1
    s_cmp_lt_u32 s18, 2
    s_cselect_b32 s54, s17, 1
    s_lshr_b32 s19, s52, 3
    s_lshl_b32 s19, s19, 8
    s_lshl_b32 s18, s18, 7
    s_add_u32 s19, s19, s18
    s_add_u32 s55, s19, 210763776
    s_cmp_lg_u32 s54, 0
    s_cbranch_scc1 ch_nv0
    v_lshlrev_b32 v24, 13, v20
    s_mov_b64 exec, 0xffff
    buffer_store_dword v176, v24, s[4:7], s55 offen sc1
    s_mov_b64 exec, -1
ch_nv0:
    v_mov_b32 v2, s40
    s_lshl_b32 s17, s12, 2
    s_add_u32 s17, s17, 128
    s_waitcnt vmcnt(0)
    s_barrier
    s_cmp_lg_u32 s3, 4
    s_cbranch_scc1 ch_nox
    s_mov_b64 exec, 1
    buffer_atomic_add v2, off, s[64:67], s17 sc1
    s_mov_b64 exec, -1
ch_nox:
    v_and_b32 v20, 63, v0
    v_lshlrev_b32 v0, 4, v20
    s_lshl_b32 s17, s15, 18
    s_lshl_b32 s18, s34, 7
    s_add_u32 s17, s17, s18
    s_lshl_b32 s19, s21, 13
    s_add_u32 s19, s19, 131072
    s_load_dwordx2 s[8:9], s[0:1], 40
    s_mov_b32 s10, 8388608
    s_mov_b32 s11, 131072
    v_lshrrev_b32 v21, 3, v20
    v_and_b32 v22, 7, v20
    v_lshlrev_b32 v21, 11, v21
    v_lshl_add_u32 v21, v22, 4, v21
    v_lshrrev_b32 v28, 4, v20
    v_and_b32 v29, 1, v28
    v_xor_b32 v29, 0, v29
    v_lshlrev_b32 v29, 2, v29
    v_lshl_add_u32 v29, v28, 3, v29
    v_bfe_u32 v28, v20, 2, 2
    v_add_u32 v29, v29, v28
    v_lshlrev_b32 v29, 7, v29
    v_and_b32 v28, 3, v20
    v_lshl_add_u32 v29, v28, 4, v29
    v_and_b32 v28, 1, v28
    v_xor_b32 v28, 0, v28
    v_lshl_add_u32 v24, v28, 3, v29
    v_add_u32 v24, s19, v24
    v_lshrrev_b32 v28, 4, v20
    v_and_b32 v29, 1, v28
    v_xor_b32 v29, 1, v29
    v_lshlrev_b32 v29, 2, v29
    v_lshl_add_u32 v29, v28, 3, v29
    v_bfe_u32 v28, v20, 2, 2
    v_add_u32 v29, v29, v28
    v_lshlrev_b32 v29, 7, v29
    v_and_b32 v28, 3, v20
    v_lshl_add_u32 v29, v28, 4, v29
    v_and_b32 v28, 1, v28
    v_xor_b32 v28, 0, v28
    v_lshl_add_u32 v25, v28, 3, v29
    v_add_u32 v25, s19, v25
    v_lshrrev_b32 v28, 4, v20
    v_and_b32 v29, 1, v28
    v_xor_b32 v29, 0, v29
    v_lshlrev_b32 v29, 2, v29
    v_lshl_add_u32 v29, v28, 3, v29
    v_bfe_u32 v28, v20, 2, 2
    v_add_u32 v29, v29, v28
    v_lshlrev_b32 v29, 7, v29
    v_and_b32 v28, 3, v20
    v_lshl_add_u32 v29, v28, 4, v29
    v_and_b32 v28, 1, v28
    v_xor_b32 v28, 1, v28
    v_lshl_add_u32 v26, v28, 3, v29
    v_add_u32 v26, s19, v26
    v_lshrrev_b32 v28, 4, v20
    v_and_b32 v29, 1, v28
    v_xor_b32 v29, 1, v29
    v_lshlrev_b32 v29, 2, v29
    v_lshl_add_u32 v29, v28, 3, v29
    v_bfe_u32 v28, v20, 2, 2
    v_add_u32 v29, v29, v28
    v_lshlrev_b32 v29, 7, v29
    v_and_b32 v28, 3, v20
    v_lshl_add_u32 v29, v28, 4, v29
    v_and_b32 v28, 1, v28
    v_xor_b32 v28, 1, v28
    v_lshl_add_u32 v27, v28, 3, v29
    v_add_u32 v27, s19, v27
    s_waitcnt lgkmcnt(0)
    s_add_u32 m0, s19, 0
    s_nop 0
    buffer_load_dwordx4 v21, s[8:11], s17 offen lds
    s_add_u32 s17, s17, 16384
    s_add_u32 m0, s19, 1024
    s_nop 0
    buffer_load_dwordx4 v21, s[8:11], s17 offen lds
    s_add_u32 s17, s17, 16384
    s_add_u32 m0, s19, 2048
    s_nop 0
    buffer_load_dwordx4 v21, s[8:11], s17 offen lds
    s_add_u32 s17, s17, 16384
    s_add_u32 m0, s19, 3072
    s_nop 0
    buffer_load_dwordx4 v21, s[8:11], s17 offen lds
    s_add_u32 s17, s17, 16384
    s_add_u32 m0, s19, 4096
    s_nop 0
    buffer_load_dwordx4 v21, s[8:11], s17 offen lds
    s_add_u32 s17, s17, 16384
    s_add_u32 m0, s19, 5120
    s_nop 0
    buffer_load_dwordx4 v21, s[8:11], s17 offen lds
    s_add_u32 s17, s17, 16384
    s_add_u32 m0, s19, 6144
    s_nop 0
    buffer_load_dwordx4 v21, s[8:11], s17 offen lds
    s_add_u32 s17, s17, 16384
    s_add_u32 m0, s19, 7168
    s_nop 0
    buffer_load_dwordx4 v21, s[8:11], s17 offen lds
    s_add_u32 s17, s17, 16384
    buffer_load_dwordx4 v[96:99], v21, s[8:11], s17 offen
    s_add_u32 s17, s17, 16384
    buffer_load_dwordx4 v[100:103], v21, s[8:11], s17 offen
    s_add_u32 s17, s17, 16384
    buffer_load_dwordx4 v[104:107], v21, s[8:11], s17 offen
    s_add_u32 s17, s17, 16384
    buffer_load_dwordx4 v[108:111], v21, s[8:11], s17 offen
    s_add_u32 s17, s17, 16384
    buffer_load_dwordx4 v[112:115], v21, s[8:11], s17 offen
    s_add_u32 s17, s17, 16384
    buffer_load_dwordx4 v[116:119], v21, s[8:11], s17 offen
    s_add_u32 s17, s17, 16384
    buffer_load_dwordx4 v[120:123], v21, s[8:11], s17 offen
    s_add_u32 s17, s17, 16384
    buffer_load_dwordx4 v[124:127], v21, s[8:11], s17 offen
    s_add_u32 s17, s17, 16384
    s_cmp_lg_u32 s54, 0
    s_cbranch_scc1 ch_nv1
    s_mov_b32 s58, -1
    s_mov_b32 s59, -1
    s_memtime s[60:61]
    s_add_u32 s56, s55, 0
    s_waitcnt lgkmcnt(0)
    s_load_dword s57, s[4:5], s56 glc
    s_waitcnt lgkmcnt(0)
    s_memtime s[62:63]
    s_waitcnt lgkmcnt(0)
    s_sub_u32 s57, s62, s60
    s_min_u32 s58, s58, s57
    s_memtime s[60:61]
    s_add_u32 s56, s55, 8192
    s_waitcnt lgkmcnt(0)
    s_load_dword s57, s[4:5], s56 glc
    s_waitcnt lgkmcnt(0)
    s_memtime s[62:63]
    s_waitcnt lgkmcnt(0)
    s_sub_u32 s57, s62, s60
    s_min_u32 s59, s59, s57
    s_memtime s[60:61]
    s_add_u32 s56, s55, 16384
    s_waitcnt lgkmcnt(0)
    s_load_dword s57, s[4:5], s56 glc
    s_waitcnt lgkmcnt(0)
    s_memtime s[62:63]
    s_waitcnt lgkmcnt(0)
    s_sub_u32 s57, s62, s60
    s_min_u32 s58, s58, s57
    s_memtime s[60:61]
    s_add_u32 s56, s55, 24576
    s_waitcnt lgkmcnt(0)
    s_load_dword s57, s[4:5], s56 glc
    s_waitcnt lgkmcnt(0)
    s_memtime s[62:63]
    s_waitcnt lgkmcnt(0)
    s_sub_u32 s57, s62, s60
    s_min_u32 s59, s59, s57
    s_memtime s[60:61]
    s_add_u32 s56, s55, 32768
    s_waitcnt lgkmcnt(0)
    s_load_dword s57, s[4:5], s56 glc
    s_waitcnt lgkmcnt(0)
    s_memtime s[62:63]
    s_waitcnt lgkmcnt(0)
    s_sub_u32 s57, s62, s60
    s_min_u32 s58, s58, s57
    s_memtime s[60:61]
    s_add_u32 s56, s55, 40960
    s_waitcnt lgkmcnt(0)
    s_load_dword s57, s[4:5], s56 glc
    s_waitcnt lgkmcnt(0)
    s_memtime s[62:63]
    s_waitcnt lgkmcnt(0)
    s_sub_u32 s57, s62, s60
    s_min_u32 s59, s59, s57
    s_memtime s[60:61]
    s_add_u32 s56, s55, 49152
    s_waitcnt lgkmcnt(0)
    s_load_dword s57, s[4:5], s56 glc
    s_waitcnt lgkmcnt(0)
    s_memtime s[62:63]
    s_waitcnt lgkmcnt(0)
    s_sub_u32 s57, s62, s60
    s_min_u32 s58, s58, s57
    s_memtime s[60:61]
    s_add_u32 s56, s55, 57344
    s_waitcnt lgkmcnt(0)
    s_load_dword s57, s[4:5], s56 glc
    s_waitcnt lgkmcnt(0)
    s_memtime s[62:63]
    s_waitcnt lgkmcnt(0)
    s_sub_u32 s57, s62, s60
    s_min_u32 s59, s59, s57
    s_memtime s[60:61]
    s_add_u32 s56, s55, 65536
    s_waitcnt lgkmcnt(0)
    s_load_dword s57, s[4:5], s56 glc
    s_waitcnt lgkmcnt(0)
    s_memtime s[62:63]
    s_waitcnt lgkmcnt(0)
    s_sub_u32 s57, s62, s60
    s_min_u32 s58, s58, s57
    s_memtime s[60:61]
    s_add_u32 s56, s55, 73728
    s_waitcnt lgkmcnt(0)
    s_load_dword s57, s[4:5], s56 glc
    s_waitcnt lgkmcnt(0)
    s_memtime s[62:63]
    s_waitcnt lgkmcnt(0)
    s_sub_u32 s57, s62, s60
    s_min_u32 s59, s59, s57
    s_memtime s[60:61]
    s_add_u32 s56, s55, 81920
    s_waitcnt lgkmcnt(0)
    s_load_dword s57, s[4:5], s56 glc
    s_waitcnt lgkmcnt(0)
    s_memtime s[62:63]
    s_waitcnt lgkmcnt(0)
    s_sub_u32 s57, s62, s60
    s_min_u32 s58, s58, s57
    s_memtime s[60:61]
    s_add_u32 s56, s55, 90112
    s_waitcnt lgkmcnt(0)
    s_load_dword s57, s[4:5], s56 glc
    s_waitcnt lgkmcnt(0)
    s_memtime s[62:63]
    s_waitcnt lgkmcnt(0)
    s_sub_u32 s57, s62, s60
    s_min_u32 s59, s59, s57
    s_memtime s[60:61]
    s_add_u32 s56, s55, 98304
    s_waitcnt lgkmcnt(0)
    s_load_dword s57, s[4:5], s56 glc
    s_waitcnt lgkmcnt(0)
    s_memtime s[62:63]
    s_waitcnt lgkmcnt(0)
    s_sub_u32 s57, s62, s60
    s_min_u32 s58, s58, s57
    s_memtime s[60:61]
    s_add_u32 s56, s55, 106496
    s_waitcnt lgkmcnt(0)
    s_load_dword s57, s[4:5], s56 glc
    s_waitcnt lgkmcnt(0)
    s_memtime s[62:63]
    s_waitcnt lgkmcnt(0)
    s_sub_u32 s57, s62, s60
    s_min_u32 s59, s59, s57
    s_memtime s[60:61]
    s_add_u32 s56, s55, 114688
    s_waitcnt lgkmcnt(0)
    s_load_dword s57, s[4:5], s56 glc
    s_waitcnt lgkmcnt(0)
    s_memtime s[62:63]
    s_waitcnt lgkmcnt(0)
    s_sub_u32 s57, s62, s60
    s_min_u32 s58, s58, s57
    s_memtime s[60:61]
    s_add_u32 s56, s55, 122880
    s_waitcnt lgkmcnt(0)
    s_load_dword s57, s[4:5], s56 glc
    s_waitcnt lgkmcnt(0)
    s_memtime s[62:63]
    s_waitcnt lgkmcnt(0)
    s_sub_u32 s57, s62, s60
    s_min_u32 s59, s59, s57
    s_sub_i32 s57, s58, s59
    s_min_i32 s57, s57, 400
    s_max_i32 s57, s57, -400
    s_add_u32 s57, s57, 16777616
    s_getreg_b32 s56, hwreg(HW_REG_XCC_ID)
    s_and_b32 s56, s56, 0
    v_mov_b32 v2, s57
    s_mov_b64 exec, 1
    buffer_atomic_add v2, off, s[64:67], s56 offset:160 sc1
    s_mov_b64 exec, -1
    s_waitcnt vmcnt(0)
ch_nv1:
    s_lshl_b32 s19, s21, 13
    s_add_u32 s19, s19, 131072
    v_add_u32 v30, s19, v0
    s_waitcnt vmcnt(8)
    ds_read_b64_tr_b16 v[192:193], v24 offset:0
    ds_read_b64_tr_b16 v[194:195], v25 offset:0
    ds_read_b64_tr_b16 v[208:209], v26 offset:0
    ds_read_b64_tr_b16 v[210:211], v27 offset:0
    ds_read_b64_tr_b16 v[224:225], v24 offset:64
    ds_read_b64_tr_b16 v[226:227], v25 offset:64
    ds_read_b64_tr_b16 v[240:241], v26 offset:64
    ds_read_b64_tr_b16 v[242:243], v27 offset:64
    s_waitcnt lgkmcnt(0)
    ds_read_b64_tr_b16 v[196:197], v24 offset:4096
    ds_read_b64_tr_b16 v[198:199], v25 offset:4096
    ds_read_b64_tr_b16 v[212:213], v26 offset:4096
    ds_read_b64_tr_b16 v[214:215], v27 offset:4096
    ds_read_b64_tr_b16 v[228:229], v24 offset:4160
    ds_read_b64_tr_b16 v[230:231], v25 offset:4160
    ds_read_b64_tr_b16 v[244:245], v26 offset:4160
    ds_read_b64_tr_b16 v[246:247], v27 offset:4160
    s_waitcnt lgkmcnt(0)
    s_waitcnt vmcnt(0)
    ds_write_b128 v30, v[96:99] offset:0
    ds_write_b128 v30, v[100:103] offset:1024
    ds_write_b128 v30, v[104:107] offset:2048
    ds_write_b128 v30, v[108:111] offset:3072
    ds_write_b128 v30, v[112:115] offset:4096
    ds_write_b128 v30, v[116:119] offset:5120
    ds_write_b128 v30, v[120:123] offset:6144
    ds_write_b128 v30, v[124:127] offset:7168
    s_waitcnt lgkmcnt(0)
    ds_read_b64_tr_b16 v[200:201], v24 offset:0
    ds_read_b64_tr_b16 v[202:203], v25 offset:0
    ds_read_b64_tr_b16 v[216:217], v26 offset:0
    ds_read_b64_tr_b16 v[218:219], v27 offset:0
    ds_read_b64_tr_b16 v[232:233], v24 offset:64
    ds_read_b64_tr_b16 v[234:235], v25 offset:64
    ds_read_b64_tr_b16 v[248:249], v26 offset:64
    ds_read_b64_tr_b16 v[250:251], v27 offset:64
    s_waitcnt lgkmcnt(0)
    ds_read_b64_tr_b16 v[204:205], v24 offset:4096
    ds_read_b64_tr_b16 v[206:207], v25 offset:4096
    ds_read_b64_tr_b16 v[220:221], v26 offset:4096
    ds_read_b64_tr_b16 v[222:223], v27 offset:4096
    ds_read_b64_tr_b16 v[236:237], v24 offset:4160
    ds_read_b64_tr_b16 v[238:239], v25 offset:4160
    ds_read_b64_tr_b16 v[252:253], v26 offset:4160
    ds_read_b64_tr_b16 v[254:255], v27 offset:4160
    s_waitcnt lgkmcnt(0)
    v_lshrrev_b32 v21, 4, v20
    v_and_b32 v22, 2, v20
    v_cmp_eq_u32 s[56:57], 2, v22
    v_and_b32 v23, 15, v20
    v_lshlrev_b32 v21, 2, v21
    v_mov_b32 v8, 0x44444444
    v_mov_b32 v9, 0xeeeeeeee
    v_cndmask_b32 v166, v8, v9, s[56:57]
    v_mov_b32 v8, 0x3f803f80
    v_mov_b32 v9, 0
    v_mov_b32 v10, 0
    v_mov_b32 v11, 0
    v_mov_b32 v4, 0x3f803f80
    v_mov_b32 v5, 0x3f803f80
    v_mov_b32 v6, 0x3f803f80
    v_mov_b32 v7, 0x3f803f80
    s_mov_b32 s29, 0x3e0293ee
    s_lshl_b32 s27, s13, 2
    s_add_u32 s27, s27, s21
    s_lshl_b32 s28, s12, 7
    s_add_u32 s28, s28, 218112000
    v_add_u32 v163, s42, v0
    s_lshl_b32 s17, s21, 2
    s_add_u32 s17, s17, 15872
    v_mov_b32 v164, s17
    v_mov_b32 v167, 15872
    v_and_b32 v24, 15, v20
    v_and_b32 v25, 1, v24
    v_lshlrev_b32 v25, 4, v25
    v_mov_b32 v184, 0x3f80
    v_lshlrev_b32 v25, v25, v184
    v_lshrrev_b32 v24, 1, v24
    v_cmp_eq_u32 vcc, 0, v24
    s_nop 1
    v_cndmask_b32 v184, 0, v25, vcc
    v_cmp_eq_u32 vcc, 1, v24
    s_nop 1
    v_cndmask_b32 v185, 0, v25, vcc
    v_cmp_eq_u32 vcc, 2, v24
    s_nop 1
    v_cndmask_b32 v186, 0, v25, vcc
    v_cmp_eq_u32 vcc, 3, v24
    s_nop 1
    v_cndmask_b32 v187, 0, v25, vcc
    v_lshrrev_b32 v24, 4, v20
    v_bfe_u32 v25, v20, 2, 2
    v_and_b32 v26, 1, v20
    v_lshl_add_u32 v26, v25, 1, v26
    v_lshlrev_b32 v26, 4, v26
    v_lshl_add_u32 v26, v24, 8, v26
    v_bfe_u32 v27, v20, 1, 1
    v_lshl_add_u32 v26, v27, 2, v26
    s_add_u32 s17, s42, 20480
    v_add_u32 v180, s17, v26
    v_and_b32 v26, 3, v20
    v_lshl_add_u32 v27, v24, 2, v25
    v_lshl_add_u32 v27, v26, 4, v27
    v_lshlrev_b32 v27, 4, v27
    v_add_u32 v181, s42, v27
    v_and_b32 v25, 1, v25
    v_lshl_add_u32 v25, v24, 1, v25
    v_lshl_add_u32 v25, v26, 3, v25
    v_lshlrev_b32 v25, 4, v25
    v_add_u32 v182, s17, v25
    s_bfe_u32 s17, s34, 0x20001
    s_lshr_b32 s30, s34, 3
    s_cmp_eq_u32 s17, s21
    s_cselect_b32 s30, s30, 2
    s_and_b32 s33, s34, 1
    s_lshl_b32 s33, s33, 17
    s_mov_b32 s32, 0
    v_add_u32 v24, 0, v21
    v_cmp_gt_u32 s[44:45], v24, v23
    v_add_u32 v24, 1, v21
    v_cmp_gt_u32 s[46:47], v24, v23
    v_add_u32 v24, 2, v21
    v_cmp_gt_u32 s[48:49], v24, v23
    v_add_u32 v24, 3, v21
    v_cmp_gt_u32 s[50:51], v24, v23
    s_cmp_lg_u32 s3, 4
    s_cbranch_scc1 ch_xcc_skip
    v_lshrrev_b32 v56, 2, v0
    v_add_u32 v56, 128, v56
    v_writelane_b32 v56, 0, 10
    v_mov_b32 v59, 63
    v_mov_b32 v60, 32
    v_writelane_b32 v59, 0, 8
    v_writelane_b32 v60, 0, 8
    v_writelane_b32 v59, 0, 9
    v_writelane_b32 v60, 0, 9
    v_writelane_b32 v59, -1, 10
    s_movk_i32 s17, 128
    v_writelane_b32 v60, s17, 10
    s_mov_b64 exec, 0x70f
ch_xcc:
    buffer_load_dword v57, v56, s[64:67], 0 offen sc1
    s_waitcnt vmcnt(0)
    v_and_b32 v62, v59, v57
    v_cmp_ne_u32 vcc, v62, v60
    v_readlane_b32 s18, v57, 8
    v_readlane_b32 s19, v57, 9
    s_add_u32 s17, s18, s19
    s_lshr_b32 s17, s17, 24
    s_cmp_lg_u32 s17, 32
    s_cbranch_scc1 ch_xcc_w
    s_cbranch_vccz ch_xcc_ok
ch_xcc_w:
    s_sleep 16
    s_sub_u32 s22, s22, 1
    s_cbranch_scc0 ch_xcc
    s_mov_b32 s22, 0
ch_xcc_ok:
    s_getreg_b32 s17, hwreg(HW_REG_XCC_ID)
    s_bitcmp1_b32 s17, 2
    s_cselect_b32 s18, s18, s18
    v_readlane_b32 s17, v57, s12
    s_mov_b64 exec, -1
    s_lshr_b32 s19, s18, 24
    s_mul_i32 s19, s19, 400
    s_and_b32 s18, s18, 0xffffff
    s_cmp_gt_u32 s18, s19
    s_cselect_b32 s18, 8192, 0
    v_mov_b32 v58, 15968
    v_mov_b32 v60, s17
    v_mov_b32 v61, s18
    s_barrier
    ds_write_b64 v58, v[60:61]
    s_waitcnt lgkmcnt(0)
    s_branch ch_xcc_b3
ch_xcc_skip:
    s_barrier
ch_xcc_b3:
    s_barrier
    v_mov_b32 v58, 15968
    ds_read_b64 v[60:61], v58
    v_and_b32 v23, 7, v20
    v_lshlrev_b32 v23, 7, v23
    v_bfe_u32 v24, v20, 3, 1
    v_lshl_add_u32 v23, v24, 17, v23
    v_lshrrev_b32 v24, 4, v20
    v_lshl_add_u32 v23, v24, 24, v23
    s_lshl_b32 s19, s14, 14
    s_lshl_b32 s18, s34, 10
    s_add_u32 s19, s19, s18
    s_and_b32 s18, s21, 1
    s_lshl_b32 s18, s18, 18
    s_add_u32 s19, s19, s18
    s_add_u32 s19, s19, 4456448
    s_waitcnt lgkmcnt(0)
    v_readfirstlane_b32 s17, v61
    s_add_u32 s39, s39, s17
ch_g0:
    buffer_load_dword v57, off, s[4:7], s35 sc1
    s_waitcnt vmcnt(0)
    v_readfirstlane_b32 s17, v57
    s_cmp_ge_u32 s17, 8
    s_cbranch_scc1 ch_g0b
    s_sleep 3
    s_sub_u32 s22, s22, 1
    s_cbranch_scc0 ch_g0
    s_mov_b32 s22, 0
ch_g0b:
    s_add_u32 s23, s41, 37748736
    buffer_load_dwordx4 v[128:131], v0, s[4:7], s23 offen offset:0 sc1
    buffer_load_dwordx4 v[132:135], v0, s[4:7], s23 offen offset:1024 sc1
    buffer_load_dwordx4 v[136:139], v0, s[4:7], s23 offen offset:2048 sc1
    buffer_load_dwordx4 v[140:143], v0, s[4:7], s23 offen offset:3072 sc1
    s_add_u32 s24, s41, 37879808
    buffer_load_dwordx4 v[144:147], v0, s[4:7], s24 offen offset:0 sc1
    buffer_load_dwordx4 v[148:151], v0, s[4:7], s24 offen offset:1024 sc1
    buffer_load_dwordx4 v[152:155], v0, s[4:7], s24 offen offset:2048 sc1
    buffer_load_dwordx4 v[156:159], v0, s[4:7], s24 offen offset:3072 sc1
    s_add_u32 s23, s41, 20971520
    buffer_load_dwordx4 v[96:99], v0, s[4:7], s23 offen offset:0 sc1
    buffer_load_dwordx4 v[100:103], v0, s[4:7], s23 offen offset:1024 sc1
    buffer_load_dwordx4 v[104:107], v0, s[4:7], s23 offen offset:2048 sc1
    buffer_load_dwordx4 v[108:111], v0, s[4:7], s23 offen offset:3072 sc1
    s_add_u32 s24, s41, 21102592
    buffer_load_dwordx4 v[112:115], v0, s[4:7], s24 offen offset:0 sc1
    buffer_load_dwordx4 v[116:119], v0, s[4:7], s24 offen offset:1024 sc1
    buffer_load_dwordx4 v[120:123], v0, s[4:7], s24 offen offset:2048 sc1
    buffer_load_dwordx4 v[124:127], v0, s[4:7], s24 offen offset:3072 sc1
    s_mov_b32 exec_hi, 0xffff
    buffer_load_dword v175, v23, s[4:7], s19 offen sc1
    s_mov_b32 exec_hi, -1
    v_mov_b32 v165, 0
    s_waitcnt vmcnt(1)
    ds_write_b32 v164, v165 offset:16
.p2align 6
aloopL_41:
    s_and_b32 s23, s16, 3
    s_lshl_b32 s23, s23, 18
    s_add_u32 s23, s23, s38
    s_add_u32 s24, s23, 4096
    s_and_b32 s25, s16, 3
    s_lshl_b32 s25, s25, 18
    s_add_u32 s25, s25, s39
    s_add_u32 s26, s16, 2
    s_and_b32 s26, s26, 3
    s_lshl_b32 s26, s26, 18
    s_add_u32 s26, s26, s39
    v_mov_b32 v165, s16
    s_waitcnt vmcnt(8)
    s_and_b32 s31, s16, 1
    s_cmp_lt_u32 s16, 16
    s_cselect_b32 s31, 3, s31
    s_cmp_lg_u32 s31, s30
    s_cbranch_scc1 aloopL_41_nd0
    ds_write_b128 v163, v[128:131] offset:0
    ds_write_b128 v163, v[132:135] offset:1024
    ds_write_b128 v163, v[136:139] offset:2048
    ds_write_b128 v163, v[140:143] offset:3072
    ds_write_b128 v163, v[144:147] offset:4096
    ds_write_b128 v163, v[148:151] offset:5120
    ds_write_b128 v163, v[152:155] offset:6144
    ds_write_b128 v163, v[156:159] offset:7168
aloopL_41_nd0:
    v_mfma_f32_16x16x32_bf16 v[48:51], v[128:131], v[192:195], 0
    v_mfma_f32_16x16x32_bf16 v[52:55], v[128:131], v[208:211], 0
    v_mfma_f32_16x16x32_bf16 v[56:59], v[128:131], v[224:227], 0
    v_mfma_f32_16x16x32_bf16 v[60:63], v[128:131], v[240:243], 0
    v_mfma_f32_16x16x32_bf16 v[64:67], v[144:147], v[192:195], 0
    v_mfma_f32_16x16x32_bf16 v[68:71], v[144:147], v[208:211], 0
    v_mfma_f32_16x16x32_bf16 v[72:75], v[144:147], v[224:227], 0
    v_mfma_f32_16x16x32_bf16 v[76:79], v[144:147], v[240:243], 0
    v_mfma_f32_16x16x32_bf16 v[48:51], v[132:135], v[196:199], v[48:51]
    v_mfma_f32_16x16x32_bf16 v[52:55], v[132:135], v[212:215], v[52:55]
    v_mfma_f32_16x16x32_bf16 v[56:59], v[132:135], v[228:231], v[56:59]
    v_mfma_f32_16x16x32_bf16 v[60:63], v[132:135], v[244:247], v[60:63]
    v_mfma_f32_16x16x32_bf16 v[64:67], v[148:151], v[196:199], v[64:67]
    v_mfma_f32_16x16x32_bf16 v[68:71], v[148:151], v[212:215], v[68:71]
    v_mfma_f32_16x16x32_bf16 v[72:75], v[148:151], v[228:231], v[72:75]
    v_mfma_f32_16x16x32_bf16 v[76:79], v[148:151], v[244:247], v[76:79]
    v_mfma_f32_16x16x32_bf16 v[48:51], v[136:139], v[200:203], v[48:51]
    v_mfma_f32_16x16x32_bf16 v[52:55], v[136:139], v[216:219], v[52:55]
    v_mfma_f32_16x16x32_bf16 v[56:59], v[136:139], v[232:235], v[56:59]
    v_mfma_f32_16x16x32_bf16 v[60:63], v[136:139], v[248:251], v[60:63]
    v_mfma_f32_16x16x32_bf16 v[64:67], v[152:155], v[200:203], v[64:67]
    v_mfma_f32_16x16x32_bf16 v[68:71], v[152:155], v[216:219], v[68:71]
    v_mfma_f32_16x16x32_bf16 v[72:75], v[152:155], v[232:235], v[72:75]
    v_mfma_f32_16x16x32_bf16 v[76:79], v[152:155], v[248:251], v[76:79]
    v_mfma_f32_16x16x32_bf16 v[48:51], v[140:143], v[204:207], v[48:51]
    v_mfma_f32_16x16x32_bf16 v[52:55], v[140:143], v[220:223], v[52:55]
    v_mfma_f32_16x16x32_bf16 v[56:59], v[140:143], v[236:239], v[56:59]
    v_mfma_f32_16x16x32_bf16 v[60:63], v[140:143], v[252:255], v[60:63]
    v_mfma_f32_16x16x32_bf16 v[64:67], v[156:159], v[204:207], v[64:67]
    v_mfma_f32_16x16x32_bf16 v[68:71], v[156:159], v[220:223], v[68:71]
    v_mfma_f32_16x16x32_bf16 v[72:75], v[156:159], v[236:239], v[72:75]
    v_mfma_f32_16x16x32_bf16 v[76:79], v[156:159], v[252:255], v[76:79]
    s_nop 2
    v_cvt_pk_bf16_f32 v80, v48, v49
    v_cvt_pk_bf16_f32 v81, v50, v51
    v_cvt_pk_bf16_f32 v82, v64, v65
    v_cvt_pk_bf16_f32 v83, v66, v67
    v_cvt_pk_bf16_f32 v84, v52, v53
    v_cvt_pk_bf16_f32 v85, v54, v55
    v_cvt_pk_bf16_f32 v86, v68, v69
    v_cvt_pk_bf16_f32 v87, v70, v71
    v_cvt_pk_bf16_f32 v88, v56, v57
    v_cvt_pk_bf16_f32 v89, v58, v59
    v_cvt_pk_bf16_f32 v90, v72, v73
    v_cvt_pk_bf16_f32 v91, v74, v75
    v_cvt_pk_bf16_f32 v92, v60, v61
    v_cvt_pk_bf16_f32 v93, v62, v63
    v_cvt_pk_bf16_f32 v94, v76, v77
    v_cvt_pk_bf16_f32 v95, v78, v79
    v_mov_b32 v24, 0
    v_mov_b32 v25, 0
    v_mov_b32 v26, 0
    v_mov_b32 v27, 0
    v_mov_b32 v28, 0
    v_mov_b32 v29, 0
    v_mov_b32 v30, 0
    v_mov_b32 v31, 0
    v_mov_b32 v32, 0
    v_mov_b32 v33, 0
    v_mov_b32 v34, 0
    v_mov_b32 v35, 0
    v_mov_b32 v36, 0
    v_mov_b32 v37, 0
    v_mov_b32 v38, 0
    v_mov_b32 v39, 0
    s_setprio 2
    s_cmp_lg_u32 s31, s30
    s_cbranch_scc1 aloopL_41_nd1
    s_add_u32 m0, s42, 16384
    s_add_u32 s17, s41, s33
    s_add_u32 s17, s17, 4194304
    buffer_load_dwordx4 v0, s[4:7], s17 offen offset:0 sc1 lds
    buffer_load_dwordx4 v0, s[4:7], s17 offen offset:1024 sc1 lds
    buffer_load_dwordx4 v0, s[4:7], s17 offen offset:2048 sc1 lds
    buffer_load_dwordx4 v0, s[4:7], s17 offen offset:3072 sc1 lds
aloopL_41_nd1:
    s_add_u32 s41, s41, 262144
    s_waitcnt lgkmcnt(0)
    s_barrier
    s_sleep 9
    s_waitcnt lgkmcnt(0)
    buffer_load_dwordx4 v[48:51], v0, s[4:7], s23 offen offset:0 sc1
    buffer_load_dwordx4 v[52:55], v0, s[4:7], s23 offen offset:1024 sc1
    buffer_load_dwordx4 v[56:59], v0, s[4:7], s23 offen offset:2048 sc1
    buffer_load_dwordx4 v[60:63], v0, s[4:7], s23 offen offset:3072 sc1
    s_sleep 2
    buffer_load_dwordx4 v[64:67], v0, s[4:7], s24 offen offset:0 sc1
    buffer_load_dwordx4 v[68:71], v0, s[4:7], s24 offen offset:1024 sc1
    s_waitcnt vmcnt(5)
    v_mfma_f32_16x16x32_bf16 v[12:15], v[96:99], v[48:51], 0
    v_mfma_f32_16x16x32_bf16 v[16:19], v[112:115], v[48:51], 0
    v_max_u32 v3, v48, v50
    v_cmp_eq_u32 vcc, -1, v3
    v_mfma_f32_16x16x32_bf16 v[20:23], v[48:51], v[48:51], 0
    s_cbranch_vccnz aloopL_41_rq_0
    s_waitcnt vmcnt(4)
    v_mfma_f32_16x16x32_bf16 v[12:15], v[100:103], v[52:55], v[12:15]
    v_mfma_f32_16x16x32_bf16 v[16:19], v[116:119], v[52:55], v[16:19]
    v_max_u32 v3, v52, v54
    v_cmp_eq_u32 vcc, -1, v3
    v_mfma_f32_16x16x32_bf16 v[20:23], v[52:55], v[52:55], v[20:23]
    s_cbranch_vccnz aloopL_41_rq_1
    s_waitcnt vmcnt(3)
    v_mfma_f32_16x16x32_bf16 v[12:15], v[104:107], v[56:59], v[12:15]
    v_mfma_f32_16x16x32_bf16 v[16:19], v[120:123], v[56:59], v[16:19]
    v_max_u32 v3, v56, v58
    v_cmp_eq_u32 vcc, -1, v3
    v_mfma_f32_16x16x32_bf16 v[20:23], v[56:59], v[56:59], v[20:23]
    s_cbranch_vccnz aloopL_41_rq_2
    s_waitcnt vmcnt(2)
    v_mfma_f32_16x16x32_bf16 v[12:15], v[108:111], v[60:63], v[12:15]
    v_mfma_f32_16x16x32_bf16 v[16:19], v[124:127], v[60:63], v[16:19]
    v_max_u32 v3, v60, v62
    v_cmp_eq_u32 vcc, -1, v3
    v_mfma_f32_16x16x32_bf16 v[20:23], v[60:63], v[60:63], v[20:23]
    s_cbranch_vccnz aloopL_41_rq_3
aloopL_41_sdone:
    s_nop 1
    ds_write_b32 v164, v165
    s_nop 0
    v_max3_f32 v2, v12, v13, v14
    v_max3_f32 v3, v15, v16, v17
    v_max3_f32 v2, v2, v18, v19
    v_max3_f32 v3, v3, v20, v21
    v_max_f32 v2, v2, v3
    v_mov_b32 v3, v2
    s_nop 1
    v_permlane16_swap_b32 v3, v2
    v_max_f32 v2, v2, v3
    v_mov_b32 v3, v2
    s_waitcnt vmcnt(0)
    v_max3_u32 v188, v64, v66, v68
    v_permlane32_swap_b32 v3, v2
    v_max_f32 v2, v2, v3
    v_max_u32 v188, v188, v70
    v_mul_f32 v2, s29, v2
    v_cmp_eq_u32 vcc, -1, v188
    v_fma_f32 v12, v12, s29, -v2
    v_fma_f32 v13, v13, s29, -v2
    s_cbranch_vccnz aloopL_41_rq_v
aloopL_41_vok:
    v_smfmac_f32_16x16x64_bf16 v[24:27], v[64:67], v[192:199], v166
    v_fma_f32 v14, v14, s29, -v2
    v_exp_f32 v12, v12
    v_smfmac_f32_16x16x64_bf16 v[32:35], v[64:67], v[224:231], v166
    s_add_u32 s17, s41, 37748736
    buffer_load_dwordx4 v[128:131], v0, s[4:7], s17 offen offset:0 sc1
    v_fma_f32 v15, v15, s29, -v2
    v_exp_f32 v13, v13
    v_smfmac_f32_16x16x64_bf16 v[28:31], v[64:67], v[208:215], v166
    buffer_load_dwordx4 v[132:135], v0, s[4:7], s17 offen offset:1024 sc1
    v_fma_f32 v16, v16, s29, -v2
    v_exp_f32 v14, v14
    v_smfmac_f32_16x16x64_bf16 v[36:39], v[64:67], v[240:247], v166
    buffer_load_dwordx4 v[136:139], v0, s[4:7], s17 offen offset:2048 sc1
    v_fma_f32 v17, v17, s29, -v2
    v_exp_f32 v15, v15
    v_smfmac_f32_16x16x64_bf16 v[24:27], v[68:71], v[200:207], v166
    buffer_load_dwordx4 v[140:143], v0, s[4:7], s17 offen offset:3072 sc1
    v_fma_f32 v18, v18, s29, -v2
    v_exp_f32 v16, v16
    v_smfmac_f32_16x16x64_bf16 v[32:35], v[68:71], v[232:239], v166
    s_add_u32 s18, s41, 37879808
    buffer_load_dwordx4 v[144:147], v0, s[4:7], s18 offen offset:0 sc1
    v_fma_f32 v19, v19, s29, -v2
    v_exp_f32 v17, v17
    v_smfmac_f32_16x16x64_bf16 v[28:31], v[68:71], v[216:223], v166
    buffer_load_dwordx4 v[148:151], v0, s[4:7], s18 offen offset:1024 sc1
    v_fma_f32 v20, v20, s29, -v2
    v_exp_f32 v18, v18
    v_smfmac_f32_16x16x64_bf16 v[36:39], v[68:71], v[248:255], v166
    buffer_load_dwordx4 v[152:155], v0, s[4:7], s18 offen offset:2048 sc1
    v_fma_f32 v21, v21, s29, -v2
    v_exp_f32 v19, v19
    buffer_load_dwordx4 v[156:159], v0, s[4:7], s18 offen offset:3072 sc1
    v_exp_f32 v20, v20
    v_exp_f32 v21, v21
    v_cvt_pk_bf16_f32 v12, v12, v13
    v_cvt_pk_bf16_f32 v13, v14, v15
    v_cvt_pk_bf16_f32 v14, v16, v17
    v_cvt_pk_bf16_f32 v15, v18, v19
    v_cvt_pk_bf16_f32 v20, v20, v21
    v_mov_b32 v22, 0
    v_mfma_f32_16x16x32_bf16 v[16:19], v[4:7], v[12:15], 0
    v_mov_b32 v21, v20
    v_mov_b32 v23, 0
    v_cvt_pk_bf16_f32 v40, v24, v25
    v_cvt_pk_bf16_f32 v41, v26, v27
    v_mfma_f32_16x16x32_bf16 v[16:19], v[8:11], v[20:23], v[16:19]
    v_mfma_f32_16x16x32_bf16 v[24:27], v[80:83], v[12:15], 0
    v_cvt_pk_bf16_f32 v44, v32, v33
    v_cvt_pk_bf16_f32 v45, v34, v35
    v_mfma_f32_16x16x32_bf16 v[32:35], v[88:91], v[12:15], 0
    v_cvt_pk_bf16_f32 v42, v28, v29
    v_cvt_pk_bf16_f32 v43, v30, v31
    v_mfma_f32_16x16x32_bf16 v[28:31], v[84:87], v[12:15], 0
    v_cvt_pk_bf16_f32 v46, v36, v37
    v_cvt_pk_bf16_f32 v47, v38, v39
    v_mfma_f32_16x16x32_bf16 v[36:39], v[92:95], v[12:15], 0
aloopL_41_midE:
    s_mov_b64 vcc, s[56:57]
    v_rcp_f32 v3, v16
    v_mfma_f32_16x16x32_bf16 v[24:27], v[40:43], v[20:23], v[24:27]
    v_mfma_f32_16x16x32_bf16 v[32:35], v[44:47], v[20:23], v[32:35]
    v_mfma_f32_16x16x32_bf16 v[28:31], v[42:45], v[20:23], v[28:31]
    v_mfma_f32_16x16x32_bf16 v[36:39], v[46:49], v[20:23], v[36:39]
    v_mov_b32_dpp v3, v3 quad_perm:[2,3,2,3] row_mask:0xf bank_mask:0xf
    s_nop 4
    v_cndmask_b32_dpp v24, v32, v24, vcc quad_perm:[2,3,2,3] row_mask:0xf bank_mask:0xf
    v_cndmask_b32_dpp v25, v33, v25, vcc quad_perm:[2,3,2,3] row_mask:0xf bank_mask:0xf
    v_cndmask_b32_dpp v26, v34, v26, vcc quad_perm:[2,3,2,3] row_mask:0xf bank_mask:0xf
    v_cndmask_b32_dpp v27, v35, v27, vcc quad_perm:[2,3,2,3] row_mask:0xf bank_mask:0xf
    v_cndmask_b32_dpp v28, v36, v28, vcc quad_perm:[2,3,2,3] row_mask:0xf bank_mask:0xf
    v_cndmask_b32_dpp v29, v37, v29, vcc quad_perm:[2,3,2,3] row_mask:0xf bank_mask:0xf
    v_cndmask_b32_dpp v30, v38, v30, vcc quad_perm:[2,3,2,3] row_mask:0xf bank_mask:0xf
    v_cndmask_b32_dpp v31, v39, v31, vcc quad_perm:[2,3,2,3] row_mask:0xf bank_mask:0xf
    v_mul_f32 v24, v24, v3
    v_mul_f32 v25, v25, v3
    v_mul_f32 v26, v26, v3
    v_mul_f32 v27, v27, v3
    v_mul_f32 v28, v28, v3
    v_mul_f32 v29, v29, v3
    v_mul_f32 v30, v30, v3
    v_mul_f32 v31, v31, v3
    v_cvt_pk_bf16_f32 v168, v24, v25
    v_cvt_pk_bf16_f32 v169, v26, v27
    v_cvt_pk_bf16_f32 v170, v28, v29
    v_cvt_pk_bf16_f32 v171, v30, v31
    ds_write_b128 v160, v[168:171]
    s_waitcnt lgkmcnt(0)
    s_barrier
    ds_read_b128 v[172:175], v161
    s_waitcnt lgkmcnt(0)
    v_mfma_f32_16x16x32_bf16 v[24:27], v[184:187], v[172:175], 0
    s_nop 7
    v_cvt_pk_bf16_f32 v168, v24, v25
    v_cvt_pk_bf16_f32 v169, v26, v27
    s_nop 0
    v_permlane16_swap_b32 v168, v170
    v_permlane16_swap_b32 v169, v171
    s_mov_b64 exec, 0xffff
    v_min_u32 v168, -2, v168
    buffer_store_dwordx4 v[168:171], v1, s[4:7], s25 offen sc1
    s_setprio 0
    buffer_store_dwordx4 v[176:179], v1, s[4:7], s26 offen sc1
    s_mov_b64 exec, -1
    s_branch pg_42
    s_cmp_lg_u32 s27, 0
    s_cbranch_scc1 pg_42
    s_sub_u32 s21, s16, 1
    s_cbranch_scc1 pg_42
    s_sub_u32 s17, s21, 1
    s_and_b32 s17, s17, 3
    s_cmp_ge_u32 s16, 58
    s_cselect_b32 s17, 0, s17
    s_cmp_lg_u32 s17, 0
    s_cbranch_scc1 pg_42
    v_mov_b32 v3, s21
    s_mov_b64 exec, 1
    buffer_store_dword v3, off, s[4:7], s28 sc1
    s_mov_b64 exec, -1
pg_42:
    s_cmp_lg_u32 s31, s30
    s_cbranch_scc1 aloopL_41_nd2
    ds_read_b128 v[24:27], v163 offset:16384
    ds_read_b128 v[28:31], v163 offset:17408
    ds_read_b128 v[32:35], v163 offset:18432
    ds_read_b128 v[36:39], v163 offset:19456
    ds_write_b32 v180, v64 offset:0
    ds_write_b32 v180, v65 offset:8
    ds_write_b32 v180, v66 offset:128
    ds_write_b32 v180, v67 offset:136
    ds_write_b32 v180, v68 offset:1024
    ds_write_b32 v180, v69 offset:1032
    ds_write_b32 v180, v70 offset:1152
    ds_write_b32 v180, v71 offset:1160
    s_mov_b32 s32, 1
    s_waitcnt lgkmcnt(11)
    v_mfma_f32_16x16x32_bf16 v[12:15], v[96:99], v[24:27], 0
    v_mfma_f32_16x16x32_bf16 v[16:19], v[112:115], v[24:27], 0
    v_mfma_f32_16x16x32_bf16 v[20:23], v[48:51], v[24:27], 0
    s_waitcnt lgkmcnt(10)
    v_mfma_f32_16x16x32_bf16 v[12:15], v[100:103], v[28:31], v[12:15]
    v_mfma_f32_16x16x32_bf16 v[16:19], v[116:119], v[28:31], v[16:19]
    v_mfma_f32_16x16x32_bf16 v[20:23], v[52:55], v[28:31], v[20:23]
    s_waitcnt lgkmcnt(9)
    v_mfma_f32_16x16x32_bf16 v[12:15], v[104:107], v[32:35], v[12:15]
    v_mfma_f32_16x16x32_bf16 v[16:19], v[120:123], v[32:35], v[16:19]
    v_mfma_f32_16x16x32_bf16 v[20:23], v[56:59], v[32:35], v[20:23]
    s_waitcnt lgkmcnt(8)
    v_mfma_f32_16x16x32_bf16 v[12:15], v[108:111], v[36:39], v[12:15]
    v_mfma_f32_16x16x32_bf16 v[16:19], v[124:127], v[36:39], v[16:19]
    v_mfma_f32_16x16x32_bf16 v[20:23], v[60:63], v[36:39], v[20:23]
    s_waitcnt lgkmcnt(0)
    s_nop 3
    s_nop 3
    s_cmp_eq_u32 s32, 0
    s_cbranch_scc1 aloopL_41_p2e
    s_mov_b32 s32, 0
    ds_read_b64_tr_b16 v[96:97], v181 offset:0
    ds_read_b64_tr_b16 v[98:99], v181 offset:4096
    ds_read_b64_tr_b16 v[64:65], v182 offset:0
    ds_read_b64_tr_b16 v[100:101], v181 offset:8
    ds_read_b64_tr_b16 v[102:103], v181 offset:4104
    ds_read_b64_tr_b16 v[66:67], v182 offset:8
    ds_read_b64_tr_b16 v[104:105], v181 offset:1024
    ds_read_b64_tr_b16 v[106:107], v181 offset:5120
    ds_read_b64_tr_b16 v[68:69], v182 offset:512
    ds_read_b64_tr_b16 v[108:109], v181 offset:1032
    ds_read_b64_tr_b16 v[110:111], v181 offset:5128
    ds_read_b64_tr_b16 v[70:71], v182 offset:520
    ds_read_b64_tr_b16 v[112:113], v181 offset:2048
    ds_read_b64_tr_b16 v[114:115], v181 offset:6144
    ds_read_b64_tr_b16 v[72:73], v182 offset:1024
    ds_read_b64_tr_b16 v[116:117], v181 offset:2056
    ds_read_b64_tr_b16 v[118:119], v181 offset:6152
    ds_read_b64_tr_b16 v[74:75], v182 offset:1032
    ds_read_b64_tr_b16 v[120:121], v181 offset:3072
    ds_read_b64_tr_b16 v[122:123], v181 offset:7168
    ds_read_b64_tr_b16 v[76:77], v182 offset:1536
    ds_read_b64_tr_b16 v[124:125], v181 offset:3080
    ds_read_b64_tr_b16 v[126:127], v181 offset:7176
    ds_read_b64_tr_b16 v[78:79], v182 offset:1544
    v_mov_b32 v188, 0xff61b1e6
    s_cmp_eq_u32 s33, 0
    s_cselect_b64 vcc, s[44:45], 0
    v_cndmask_b32 v12, v12, v188, vcc
    s_cselect_b64 vcc, -1, s[44:45]
    v_cndmask_b32 v16, v16, v188, vcc
    s_cselect_b64 vcc, s[46:47], 0
    v_cndmask_b32 v13, v13, v188, vcc
    s_cselect_b64 vcc, -1, s[46:47]
    v_cndmask_b32 v17, v17, v188, vcc
    s_cselect_b64 vcc, s[48:49], 0
    v_cndmask_b32 v14, v14, v188, vcc
    s_cselect_b64 vcc, -1, s[48:49]
    v_cndmask_b32 v18, v18, v188, vcc
    s_cselect_b64 vcc, s[50:51], 0
    v_cndmask_b32 v15, v15, v188, vcc
    s_cselect_b64 vcc, -1, s[50:51]
    v_cndmask_b32 v19, v19, v188, vcc
    v_max3_f32 v2, v12, v13, v14
    v_max3_f32 v3, v15, v16, v17
    v_max3_f32 v2, v2, v18, v19
    v_max3_f32 v3, v3, v20, v21
    v_max_f32 v2, v2, v3
    v_mov_b32 v3, v2
    s_nop 1
    v_permlane16_swap_b32 v3, v2
    v_max_f32 v2, v2, v3
    v_mov_b32 v3, v2
    s_nop 1
    v_permlane32_swap_b32 v3, v2
    v_max_f32 v2, v2, v3
    v_mul_f32 v2, s29, v2
    v_fma_f32 v12, v12, s29, -v2
    v_fma_f32 v13, v13, s29, -v2
    v_fma_f32 v14, v14, s29, -v2
    v_exp_f32 v12, v12
    v_fma_f32 v15, v15, s29, -v2
    v_exp_f32 v13, v13
    v_fma_f32 v16, v16, s29, -v2
    v_exp_f32 v14, v14
    v_fma_f32 v17, v17, s29, -v2
    v_exp_f32 v15, v15
    v_fma_f32 v18, v18, s29, -v2
    v_exp_f32 v16, v16
    v_fma_f32 v19, v19, s29, -v2
    v_exp_f32 v17, v17
    v_fma_f32 v20, v20, s29, -v2
    v_exp_f32 v18, v18
    v_fma_f32 v21, v21, s29, -v2
    v_exp_f32 v19, v19
    v_exp_f32 v20, v20
    v_exp_f32 v21, v21
    v_cvt_pk_bf16_f32 v12, v12, v13
    v_cvt_pk_bf16_f32 v13, v14, v15
    v_cvt_pk_bf16_f32 v14, v16, v17
    v_cvt_pk_bf16_f32 v15, v18, v19
    v_cvt_pk_bf16_f32 v20, v20, v21
    v_mov_b32 v22, 0
    v_mov_b32 v21, 0
    v_mov_b32 v23, 0
    s_waitcnt lgkmcnt(0)
    s_nop 0
    v_mfma_f32_16x16x32_bf16 v[16:19], v[4:7], v[12:15], 0
    v_mfma_f32_16x16x32_bf16 v[16:19], v[4:7], v[20:23], v[16:19]
    v_mfma_f32_16x16x32_bf16 v[24:27], v[96:99], v[12:15], 0
    v_mfma_f32_16x16x32_bf16 v[24:27], v[64:67], v[20:23], v[24:27]
    v_mfma_f32_16x16x32_bf16 v[28:31], v[100:103], v[12:15], 0
    v_mfma_f32_16x16x32_bf16 v[28:31], v[66:69], v[20:23], v[28:31]
    v_mfma_f32_16x16x32_bf16 v[32:35], v[104:107], v[12:15], 0
    v_mfma_f32_16x16x32_bf16 v[32:35], v[68:71], v[20:23], v[32:35]
    v_mfma_f32_16x16x32_bf16 v[36:39], v[108:111], v[12:15], 0
    v_mfma_f32_16x16x32_bf16 v[36:39], v[70:73], v[20:23], v[36:39]
    v_mfma_f32_16x16x32_bf16 v[48:51], v[112:115], v[12:15], 0
    v_mfma_f32_16x16x32_bf16 v[48:51], v[72:75], v[20:23], v[48:51]
    v_mfma_f32_16x16x32_bf16 v[52:55], v[116:119], v[12:15], 0
    v_mfma_f32_16x16x32_bf16 v[52:55], v[74:77], v[20:23], v[52:55]
    v_mfma_f32_16x16x32_bf16 v[56:59], v[120:123], v[12:15], 0
    v_mfma_f32_16x16x32_bf16 v[56:59], v[76:79], v[20:23], v[56:59]
    v_mfma_f32_16x16x32_bf16 v[60:63], v[124:127], v[12:15], 0
    v_mfma_f32_16x16x32_bf16 v[60:63], v[78:81], v[20:23], v[60:63]
    v_rcp_f32 v3, v16
    s_nop 0
    v_mul_f32 v24, v24, v3
    v_mul_f32 v25, v25, v3
    v_mul_f32 v26, v26, v3
    v_mul_f32 v27, v27, v3
    v_mul_f32 v28, v28, v3
    v_mul_f32 v29, v29, v3
    v_mul_f32 v30, v30, v3
    v_mul_f32 v31, v31, v3
    v_cvt_pk_bf16_f32 v24, v24, v25
    v_cvt_pk_bf16_f32 v25, v26, v27
    v_cvt_pk_bf16_f32 v26, v28, v29
    v_cvt_pk_bf16_f32 v27, v30, v31
    ds_write_b128 v0, v[24:27] offset:32768
    v_mul_f32 v32, v32, v3
    v_mul_f32 v33, v33, v3
    v_mul_f32 v34, v34, v3
    v_mul_f32 v35, v35, v3
    v_mul_f32 v36, v36, v3
    v_mul_f32 v37, v37, v3
    v_mul_f32 v38, v38, v3
    v_mul_f32 v39, v39, v3
    v_cvt_pk_bf16_f32 v32, v32, v33
    v_cvt_pk_bf16_f32 v33, v34, v35
    v_cvt_pk_bf16_f32 v34, v36, v37
    v_cvt_pk_bf16_f32 v35, v38, v39
    ds_write_b128 v0, v[32:35] offset:33792
    v_mul_f32 v48, v48, v3
    v_mul_f32 v49, v49, v3
    v_mul_f32 v50, v50, v3
    v_mul_f32 v51, v51, v3
    v_mul_f32 v52, v52, v3
    v_mul_f32 v53, v53, v3
    v_mul_f32 v54, v54, v3
    v_mul_f32 v55, v55, v3
    v_cvt_pk_bf16_f32 v48, v48, v49
    v_cvt_pk_bf16_f32 v49, v50, v51
    v_cvt_pk_bf16_f32 v50, v52, v53
    v_cvt_pk_bf16_f32 v51, v54, v55
    ds_write_b128 v0, v[48:51] offset:34816
    v_mul_f32 v56, v56, v3
    v_mul_f32 v57, v57, v3
    v_mul_f32 v58, v58, v3
    v_mul_f32 v59, v59, v3
    v_mul_f32 v60, v60, v3
    v_mul_f32 v61, v61, v3
    v_mul_f32 v62, v62, v3
    v_mul_f32 v63, v63, v3
    v_cvt_pk_bf16_f32 v56, v56, v57
    v_cvt_pk_bf16_f32 v57, v58, v59
    v_cvt_pk_bf16_f32 v58, v60, v61
    v_cvt_pk_bf16_f32 v59, v62, v63
    ds_write_b128 v0, v[56:59] offset:35840
aloopL_41_p2e:
    s_nop 3
aloopL_41_nd2:
    s_add_u32 s19, s41, 20971520
    buffer_load_dwordx4 v[96:99], v0, s[4:7], s19 offen offset:0 sc1
    buffer_load_dwordx4 v[100:103], v0, s[4:7], s19 offen offset:1024 sc1
    buffer_load_dwordx4 v[104:107], v0, s[4:7], s19 offen offset:2048 sc1
    buffer_load_dwordx4 v[108:111], v0, s[4:7], s19 offen offset:3072 sc1
    s_add_u32 s20, s41, 21102592
    buffer_load_dwordx4 v[112:115], v0, s[4:7], s20 offen offset:0 sc1
    buffer_load_dwordx4 v[116:119], v0, s[4:7], s20 offen offset:1024 sc1
    buffer_load_dwordx4 v[120:123], v0, s[4:7], s20 offen offset:2048 sc1
    buffer_load_dwordx4 v[124:127], v0, s[4:7], s20 offen offset:3072 sc1
    s_add_u32 s16, s16, 1
    s_cmp_lt_u32 s16, 48
    s_cbranch_scc1 aloopL_41
    s_waitcnt vmcnt(0)
    ds_write_b128 v163, v[128:131] offset:8192
    ds_write_b128 v163, v[132:135] offset:9216
    ds_write_b128 v163, v[136:139] offset:10240
    ds_write_b128 v163, v[140:143] offset:11264
    ds_write_b128 v163, v[144:147] offset:12288
    ds_write_b128 v163, v[148:151] offset:13312
    ds_write_b128 v163, v[152:155] offset:14336
    ds_write_b128 v163, v[156:159] offset:15360
    s_waitcnt lgkmcnt(0)
    s_branch aloopH_40
aloopL_41_rq_0:
    s_sub_u32 s22, s22, 1
    s_cbranch_scc1 aloopL_41_rq_0_g
    buffer_load_dwordx4 v[48:51], v0, s[4:7], s23 offen offset:0 sc1
    buffer_load_dwordx4 v[52:55], v0, s[4:7], s23 offen offset:1024 sc1
    buffer_load_dwordx4 v[56:59], v0, s[4:7], s23 offen offset:2048 sc1
    buffer_load_dwordx4 v[60:63], v0, s[4:7], s23 offen offset:3072 sc1
    buffer_load_dwordx4 v[64:67], v0, s[4:7], s24 offen offset:0 sc1
    buffer_load_dwordx4 v[68:71], v0, s[4:7], s24 offen offset:1024 sc1
    s_waitcnt vmcnt(5)
    v_max_u32 v3, v48, v50
    v_cmp_eq_u32 vcc, -1, v3
    s_cbranch_vccnz aloopL_41_rq_0
    s_branch aloopL_41_again
aloopL_41_rq_0_g:
    s_mov_b32 s22, 0
    s_waitcnt vmcnt(0)
    s_branch aloopL_41_nochk
aloopL_41_rq_1:
    s_sub_u32 s22, s22, 1
    s_cbranch_scc1 aloopL_41_rq_1_g
    buffer_load_dwordx4 v[52:55], v0, s[4:7], s23 offen offset:1024 sc1
    buffer_load_dwordx4 v[56:59], v0, s[4:7], s23 offen offset:2048 sc1
    buffer_load_dwordx4 v[60:63], v0, s[4:7], s23 offen offset:3072 sc1
    buffer_load_dwordx4 v[64:67], v0, s[4:7], s24 offen offset:0 sc1
    buffer_load_dwordx4 v[68:71], v0, s[4:7], s24 offen offset:1024 sc1
    s_waitcnt vmcnt(4)
    v_max_u32 v3, v52, v54
    v_cmp_eq_u32 vcc, -1, v3
    s_cbranch_vccnz aloopL_41_rq_1
    s_branch aloopL_41_again
aloopL_41_rq_1_g:
    s_mov_b32 s22, 0
    s_waitcnt vmcnt(0)
    s_branch aloopL_41_nochk
aloopL_41_rq_2:
    s_sub_u32 s22, s22, 1
    s_cbranch_scc1 aloopL_41_rq_2_g
    buffer_load_dwordx4 v[56:59], v0, s[4:7], s23 offen offset:2048 sc1
    buffer_load_dwordx4 v[60:63], v0, s[4:7], s23 offen offset:3072 sc1
    buffer_load_dwordx4 v[64:67], v0, s[4:7], s24 offen offset:0 sc1
    buffer_load_dwordx4 v[68:71], v0, s[4:7], s24 offen offset:1024 sc1
    s_waitcnt vmcnt(3)
    v_max_u32 v3, v56, v58
    v_cmp_eq_u32 vcc, -1, v3
    s_cbranch_vccnz aloopL_41_rq_2
    s_branch aloopL_41_again
aloopL_41_rq_2_g:
    s_mov_b32 s22, 0
    s_waitcnt vmcnt(0)
    s_branch aloopL_41_nochk
aloopL_41_rq_3:
    s_sub_u32 s22, s22, 1
    s_cbranch_scc1 aloopL_41_rq_3_g
    buffer_load_dwordx4 v[60:63], v0, s[4:7], s23 offen offset:3072 sc1
    buffer_load_dwordx4 v[64:67], v0, s[4:7], s24 offen offset:0 sc1
    buffer_load_dwordx4 v[68:71], v0, s[4:7], s24 offen offset:1024 sc1
    s_waitcnt vmcnt(2)
    v_max_u32 v3, v60, v62
    v_cmp_eq_u32 vcc, -1, v3
    s_cbranch_vccnz aloopL_41_rq_3
    s_branch aloopL_41_again
aloopL_41_rq_3_g:
    s_mov_b32 s22, 0
    s_waitcnt vmcnt(0)
    s_branch aloopL_41_nochk
aloopL_41_again:
    s_waitcnt vmcnt(5)
    v_mfma_f32_16x16x32_bf16 v[12:15], v[96:99], v[48:51], 0
    v_mfma_f32_16x16x32_bf16 v[16:19], v[112:115], v[48:51], 0
    v_max_u32 v3, v48, v50
    v_cmp_eq_u32 vcc, -1, v3
    v_mfma_f32_16x16x32_bf16 v[20:23], v[48:51], v[48:51], 0
    s_cbranch_vccnz aloopL_41_rq_0
    s_waitcnt vmcnt(4)
    v_mfma_f32_16x16x32_bf16 v[12:15], v[100:103], v[52:55], v[12:15]
    v_mfma_f32_16x16x32_bf16 v[16:19], v[116:119], v[52:55], v[16:19]
    v_max_u32 v3, v52, v54
    v_cmp_eq_u32 vcc, -1, v3
    v_mfma_f32_16x16x32_bf16 v[20:23], v[52:55], v[52:55], v[20:23]
    s_cbranch_vccnz aloopL_41_rq_1
    s_waitcnt vmcnt(3)
    v_mfma_f32_16x16x32_bf16 v[12:15], v[104:107], v[56:59], v[12:15]
    v_mfma_f32_16x16x32_bf16 v[16:19], v[120:123], v[56:59], v[16:19]
    v_max_u32 v3, v56, v58
    v_cmp_eq_u32 vcc, -1, v3
    v_mfma_f32_16x16x32_bf16 v[20:23], v[56:59], v[56:59], v[20:23]
    s_cbranch_vccnz aloopL_41_rq_2
    s_waitcnt vmcnt(2)
    v_mfma_f32_16x16x32_bf16 v[12:15], v[108:111], v[60:63], v[12:15]
    v_mfma_f32_16x16x32_bf16 v[16:19], v[124:127], v[60:63], v[16:19]
    v_max_u32 v3, v60, v62
    v_cmp_eq_u32 vcc, -1, v3
    v_mfma_f32_16x16x32_bf16 v[20:23], v[60:63], v[60:63], v[20:23]
    s_cbranch_vccnz aloopL_41_rq_3
    s_branch aloopL_41_sdone
aloopL_41_rq_v:
    s_sub_u32 s22, s22, 1
    s_cbranch_scc1 aloopL_41_rq_vg
    buffer_load_dwordx4 v[64:67], v0, s[4:7], s24 offen offset:0 sc1
    buffer_load_dwordx4 v[68:71], v0, s[4:7], s24 offen offset:1024 sc1
    s_waitcnt vmcnt(0)
    v_max3_u32 v188, v64, v66, v68
    v_max_u32 v188, v188, v70
    v_cmp_eq_u32 vcc, -1, v188
    s_cbranch_vccnz aloopL_41_rq_v
    s_branch aloopL_41_vok
aloopL_41_rq_vg:
    s_mov_b32 s22, 0
    s_branch aloopL_41_vok
aloopL_41_nochk:
    v_mfma_f32_16x16x32_bf16 v[12:15], v[96:99], v[48:51], 0
    v_mfma_f32_16x16x32_bf16 v[16:19], v[112:115], v[48:51], 0
    v_mfma_f32_16x16x32_bf16 v[20:23], v[48:51], v[48:51], 0
    v_mfma_f32_16x16x32_bf16 v[12:15], v[100:103], v[52:55], v[12:15]
    v_mfma_f32_16x16x32_bf16 v[16:19], v[116:119], v[52:55], v[16:19]
    v_mfma_f32_16x16x32_bf16 v[20:23], v[52:55], v[52:55], v[20:23]
    v_mfma_f32_16x16x32_bf16 v[12:15], v[104:107], v[56:59], v[12:15]
    v_mfma_f32_16x16x32_bf16 v[16:19], v[120:123], v[56:59], v[16:19]
    v_mfma_f32_16x16x32_bf16 v[20:23], v[56:59], v[56:59], v[20:23]
    v_mfma_f32_16x16x32_bf16 v[12:15], v[108:111], v[60:63], v[12:15]
    v_mfma_f32_16x16x32_bf16 v[16:19], v[124:127], v[60:63], v[16:19]
    v_mfma_f32_16x16x32_bf16 v[20:23], v[60:63], v[60:63], v[20:23]
    s_nop 1
    s_branch aloopL_41_sdone
ct_aH:
.p2align 6
aloopH_40:
    s_and_b32 s23, s16, 3
    s_lshl_b32 s23, s23, 18
    s_add_u32 s23, s23, s38
    s_add_u32 s24, s23, 4096
    s_and_b32 s25, s16, 3
    s_lshl_b32 s25, s25, 18
    s_add_u32 s25, s25, s39
    s_add_u32 s26, s16, 2
    s_and_b32 s26, s26, 3
    s_lshl_b32 s26, s26, 18
    s_add_u32 s26, s26, s39
    v_mov_b32 v165, s16
aloopH_40_wkv:
    ds_read_b32 v188, v164 offset:16
    s_waitcnt lgkmcnt(0)
    v_readfirstlane_b32 s19, v188
    s_cmp_ge_i32 s19, s16
    s_cbranch_scc1 aloopH_40_wkvok
    s_sleep 1
    s_branch aloopH_40_wkv
aloopH_40_wkvok:
    ds_read_b128 v[128:131], v163 offset:8192
    ds_read_b128 v[144:147], v163 offset:12288
    ds_read_b128 v[132:135], v163 offset:9216
    ds_read_b128 v[148:151], v163 offset:13312
    ds_read_b128 v[136:139], v163 offset:10240
    ds_read_b128 v[152:155], v163 offset:14336
    ds_read_b128 v[140:143], v163 offset:11264
    ds_read_b128 v[156:159], v163 offset:15360
    s_waitcnt lgkmcnt(6)
    v_mfma_f32_16x16x32_bf16 v[48:51], v[128:131], v[192:195], 0
    v_mfma_f32_16x16x32_bf16 v[52:55], v[128:131], v[208:211], 0
    v_mfma_f32_16x16x32_bf16 v[56:59], v[128:131], v[224:227], 0
    v_mfma_f32_16x16x32_bf16 v[60:63], v[128:131], v[240:243], 0
    v_mfma_f32_16x16x32_bf16 v[64:67], v[144:147], v[192:195], 0
    v_mfma_f32_16x16x32_bf16 v[68:71], v[144:147], v[208:211], 0
    v_mfma_f32_16x16x32_bf16 v[72:75], v[144:147], v[224:227], 0
    v_mfma_f32_16x16x32_bf16 v[76:79], v[144:147], v[240:243], 0
    s_setprio 2
aloopH_40_wm:
    ds_read_b32 v188, v164 offset:32
    s_waitcnt lgkmcnt(0)
    v_readfirstlane_b32 s19, v188
    s_cmp_ge_i32 s19, s16
    s_cbranch_scc1 aloopH_40_wmok
    s_sleep 1
    s_branch aloopH_40_wm
aloopH_40_wmok:
    s_add_u32 m0, s42, 16384
    s_add_u32 s17, s41, 4194304
    buffer_load_dwordx4 v0, s[4:7], s17 offen offset:0 sc1 lds
    buffer_load_dwordx4 v0, s[4:7], s17 offen offset:1024 sc1 lds
    buffer_load_dwordx4 v0, s[4:7], s17 offen offset:2048 sc1 lds
    buffer_load_dwordx4 v0, s[4:7], s17 offen offset:3072 sc1 lds
    s_add_u32 m0, s42, 20480
    s_add_u32 s17, s41, 4325376
    buffer_load_dwordx4 v0, s[4:7], s17 offen offset:0 sc1 lds
    buffer_load_dwordx4 v0, s[4:7], s17 offen offset:1024 sc1 lds
    buffer_load_dwordx4 v0, s[4:7], s17 offen offset:2048 sc1 lds
    buffer_load_dwordx4 v0, s[4:7], s17 offen offset:3072 sc1 lds
    s_add_u32 s41, s41, 262144
    s_barrier
    s_waitcnt lgkmcnt(4)
    v_mfma_f32_16x16x32_bf16 v[48:51], v[132:135], v[196:199], v[48:51]
    v_mfma_f32_16x16x32_bf16 v[52:55], v[132:135], v[212:215], v[52:55]
    v_mfma_f32_16x16x32_bf16 v[56:59], v[132:135], v[228:231], v[56:59]
    v_mfma_f32_16x16x32_bf16 v[60:63], v[132:135], v[244:247], v[60:63]
    v_mfma_f32_16x16x32_bf16 v[64:67], v[148:151], v[196:199], v[64:67]
    v_mfma_f32_16x16x32_bf16 v[68:71], v[148:151], v[212:215], v[68:71]
    v_mfma_f32_16x16x32_bf16 v[72:75], v[148:151], v[228:231], v[72:75]
    v_mfma_f32_16x16x32_bf16 v[76:79], v[148:151], v[244:247], v[76:79]
    s_waitcnt lgkmcnt(2)
    v_mfma_f32_16x16x32_bf16 v[48:51], v[136:139], v[200:203], v[48:51]
    v_mfma_f32_16x16x32_bf16 v[52:55], v[136:139], v[216:219], v[52:55]
    v_mfma_f32_16x16x32_bf16 v[56:59], v[136:139], v[232:235], v[56:59]
    v_mfma_f32_16x16x32_bf16 v[60:63], v[136:139], v[248:251], v[60:63]
    v_mfma_f32_16x16x32_bf16 v[64:67], v[152:155], v[200:203], v[64:67]
    v_mfma_f32_16x16x32_bf16 v[68:71], v[152:155], v[216:219], v[68:71]
    v_mfma_f32_16x16x32_bf16 v[72:75], v[152:155], v[232:235], v[72:75]
    v_mfma_f32_16x16x32_bf16 v[76:79], v[152:155], v[248:251], v[76:79]
    s_waitcnt lgkmcnt(0)
    v_mfma_f32_16x16x32_bf16 v[48:51], v[140:143], v[204:207], v[48:51]
    v_mfma_f32_16x16x32_bf16 v[52:55], v[140:143], v[220:223], v[52:55]
    v_mfma_f32_16x16x32_bf16 v[56:59], v[140:143], v[236:239], v[56:59]
    v_mfma_f32_16x16x32_bf16 v[60:63], v[140:143], v[252:255], v[60:63]
    v_mfma_f32_16x16x32_bf16 v[64:67], v[156:159], v[204:207], v[64:67]
    v_mfma_f32_16x16x32_bf16 v[68:71], v[156:159], v[220:223], v[68:71]
    v_mfma_f32_16x16x32_bf16 v[72:75], v[156:159], v[236:239], v[72:75]
    v_mfma_f32_16x16x32_bf16 v[76:79], v[156:159], v[252:255], v[76:79]
    s_nop 2
    v_cvt_pk_bf16_f32 v80, v48, v49
    v_cvt_pk_bf16_f32 v81, v50, v51
    v_cvt_pk_bf16_f32 v82, v64, v65
    v_cvt_pk_bf16_f32 v83, v66, v67
    v_cvt_pk_bf16_f32 v84, v52, v53
    v_cvt_pk_bf16_f32 v85, v54, v55
    v_cvt_pk_bf16_f32 v86, v68, v69
    v_cvt_pk_bf16_f32 v87, v70, v71
    v_cvt_pk_bf16_f32 v88, v56, v57
    v_cvt_pk_bf16_f32 v89, v58, v59
    v_cvt_pk_bf16_f32 v90, v72, v73
    v_cvt_pk_bf16_f32 v91, v74, v75
    v_cvt_pk_bf16_f32 v92, v60, v61
    v_cvt_pk_bf16_f32 v93, v62, v63
    v_cvt_pk_bf16_f32 v94, v76, v77
    v_cvt_pk_bf16_f32 v95, v78, v79
    v_mov_b32 v24, 0
    v_mov_b32 v25, 0
    v_mov_b32 v26, 0
    v_mov_b32 v27, 0
    v_mov_b32 v28, 0
    v_mov_b32 v29, 0
    v_mov_b32 v30, 0
    v_mov_b32 v31, 0
    v_mov_b32 v32, 0
    v_mov_b32 v33, 0
    v_mov_b32 v34, 0
    v_mov_b32 v35, 0
    v_mov_b32 v36, 0
    v_mov_b32 v37, 0
    v_mov_b32 v38, 0
    v_mov_b32 v39, 0
    s_waitcnt lgkmcnt(0)
    buffer_load_dwordx4 v[48:51], v0, s[4:7], s23 offen offset:0 sc1
    buffer_load_dwordx4 v[52:55], v0, s[4:7], s23 offen offset:1024 sc1
    buffer_load_dwordx4 v[56:59], v0, s[4:7], s23 offen offset:2048 sc1
    buffer_load_dwordx4 v[60:63], v0, s[4:7], s23 offen offset:3072 sc1
    s_sleep 2
    buffer_load_dwordx4 v[64:67], v0, s[4:7], s24 offen offset:0 sc1
    buffer_load_dwordx4 v[68:71], v0, s[4:7], s24 offen offset:1024 sc1
    s_waitcnt vmcnt(5)
    v_mfma_f32_16x16x32_bf16 v[12:15], v[96:99], v[48:51], 0
    v_mfma_f32_16x16x32_bf16 v[16:19], v[112:115], v[48:51], 0
    v_max_u32 v3, v48, v50
    v_cmp_eq_u32 vcc, -1, v3
    v_mfma_f32_16x16x32_bf16 v[20:23], v[48:51], v[48:51], 0
    s_cbranch_vccnz aloopH_40_rq_0
    s_waitcnt vmcnt(4)
    v_mfma_f32_16x16x32_bf16 v[12:15], v[100:103], v[52:55], v[12:15]
    v_mfma_f32_16x16x32_bf16 v[16:19], v[116:119], v[52:55], v[16:19]
    v_max_u32 v3, v52, v54
    v_cmp_eq_u32 vcc, -1, v3
    v_mfma_f32_16x16x32_bf16 v[20:23], v[52:55], v[52:55], v[20:23]
    s_cbranch_vccnz aloopH_40_rq_1
    s_waitcnt vmcnt(3)
    v_mfma_f32_16x16x32_bf16 v[12:15], v[104:107], v[56:59], v[12:15]
    v_mfma_f32_16x16x32_bf16 v[16:19], v[120:123], v[56:59], v[16:19]
    v_max_u32 v3, v56, v58
    v_cmp_eq_u32 vcc, -1, v3
    v_mfma_f32_16x16x32_bf16 v[20:23], v[56:59], v[56:59], v[20:23]
    s_cbranch_vccnz aloopH_40_rq_2
    s_waitcnt vmcnt(2)
    v_mfma_f32_16x16x32_bf16 v[12:15], v[108:111], v[60:63], v[12:15]
    v_mfma_f32_16x16x32_bf16 v[16:19], v[124:127], v[60:63], v[16:19]
    v_max_u32 v3, v60, v62
    v_cmp_eq_u32 vcc, -1, v3
    v_mfma_f32_16x16x32_bf16 v[20:23], v[60:63], v[60:63], v[20:23]
    s_cbranch_vccnz aloopH_40_rq_3
aloopH_40_sdone:
    s_cmp_eq_u32 s16, 63
    s_cbranch_scc1 aloopH_40_lsk
    ds_write_b32 v164, v165
    s_nop 0
    v_max3_f32 v2, v12, v13, v14
    v_max3_f32 v3, v15, v16, v17
    v_max3_f32 v2, v2, v18, v19
    v_max3_f32 v3, v3, v20, v21
    v_max_f32 v2, v2, v3
    v_mov_b32 v3, v2
    s_nop 1
    v_permlane16_swap_b32 v3, v2
    v_max_f32 v2, v2, v3
    v_mov_b32 v3, v2
    s_waitcnt vmcnt(0)
    v_max3_u32 v188, v64, v66, v68
    v_permlane32_swap_b32 v3, v2
    v_max_f32 v2, v2, v3
    v_max_u32 v188, v188, v70
    v_mul_f32 v2, s29, v2
    v_cmp_eq_u32 vcc, -1, v188
    v_fma_f32 v12, v12, s29, -v2
    v_fma_f32 v13, v13, s29, -v2
    s_cbranch_vccnz aloopH_40_rq_v
aloopH_40_vok:
    v_smfmac_f32_16x16x64_bf16 v[24:27], v[64:67], v[192:199], v166
    v_fma_f32 v14, v14, s29, -v2
    v_exp_f32 v12, v12
    v_smfmac_f32_16x16x64_bf16 v[32:35], v[64:67], v[224:231], v166
    v_fma_f32 v15, v15, s29, -v2
    v_exp_f32 v13, v13
    v_smfmac_f32_16x16x64_bf16 v[28:31], v[64:67], v[208:215], v166
    v_fma_f32 v16, v16, s29, -v2
    v_exp_f32 v14, v14
    v_smfmac_f32_16x16x64_bf16 v[36:39], v[64:67], v[240:247], v166
    v_fma_f32 v17, v17, s29, -v2
    v_exp_f32 v15, v15
    v_smfmac_f32_16x16x64_bf16 v[24:27], v[68:71], v[200:207], v166
    v_fma_f32 v18, v18, s29, -v2
    v_exp_f32 v16, v16
    v_smfmac_f32_16x16x64_bf16 v[32:35], v[68:71], v[232:239], v166
    v_fma_f32 v19, v19, s29, -v2
    v_exp_f32 v17, v17
    v_smfmac_f32_16x16x64_bf16 v[28:31], v[68:71], v[216:223], v166
    v_fma_f32 v20, v20, s29, -v2
    v_exp_f32 v18, v18
    v_smfmac_f32_16x16x64_bf16 v[36:39], v[68:71], v[248:255], v166
    v_fma_f32 v21, v21, s29, -v2
    v_exp_f32 v19, v19
    v_exp_f32 v20, v20
    v_exp_f32 v21, v21
    v_cvt_pk_bf16_f32 v12, v12, v13
    v_cvt_pk_bf16_f32 v13, v14, v15
    v_cvt_pk_bf16_f32 v14, v16, v17
    v_cvt_pk_bf16_f32 v15, v18, v19
    v_cvt_pk_bf16_f32 v20, v20, v21
    v_mov_b32 v22, 0
    v_mfma_f32_16x16x32_bf16 v[16:19], v[4:7], v[12:15], 0
    v_mov_b32 v21, v20
    v_mov_b32 v23, 0
    v_cvt_pk_bf16_f32 v40, v24, v25
    v_cvt_pk_bf16_f32 v41, v26, v27
    v_mfma_f32_16x16x32_bf16 v[16:19], v[8:11], v[20:23], v[16:19]
    v_mfma_f32_16x16x32_bf16 v[24:27], v[80:83], v[12:15], 0
    v_cvt_pk_bf16_f32 v44, v32, v33
    v_cvt_pk_bf16_f32 v45, v34, v35
    v_mfma_f32_16x16x32_bf16 v[32:35], v[88:91], v[12:15], 0
    v_cvt_pk_bf16_f32 v42, v28, v29
    v_cvt_pk_bf16_f32 v43, v30, v31
    v_mfma_f32_16x16x32_bf16 v[28:31], v[84:87], v[12:15], 0
    v_cvt_pk_bf16_f32 v46, v36, v37
    v_cvt_pk_bf16_f32 v47, v38, v39
    v_mfma_f32_16x16x32_bf16 v[36:39], v[92:95], v[12:15], 0
aloopH_40_midE:
    s_mov_b64 vcc, s[56:57]
    v_rcp_f32 v3, v16
    v_mfma_f32_16x16x32_bf16 v[24:27], v[40:43], v[20:23], v[24:27]
    v_mfma_f32_16x16x32_bf16 v[32:35], v[44:47], v[20:23], v[32:35]
    v_mfma_f32_16x16x32_bf16 v[28:31], v[42:45], v[20:23], v[28:31]
    v_mfma_f32_16x16x32_bf16 v[36:39], v[46:49], v[20:23], v[36:39]
    v_mov_b32_dpp v3, v3 quad_perm:[2,3,2,3] row_mask:0xf bank_mask:0xf
    s_nop 4
    v_cndmask_b32_dpp v24, v32, v24, vcc quad_perm:[2,3,2,3] row_mask:0xf bank_mask:0xf
    v_cndmask_b32_dpp v25, v33, v25, vcc quad_perm:[2,3,2,3] row_mask:0xf bank_mask:0xf
    v_cndmask_b32_dpp v26, v34, v26, vcc quad_perm:[2,3,2,3] row_mask:0xf bank_mask:0xf
    v_cndmask_b32_dpp v27, v35, v27, vcc quad_perm:[2,3,2,3] row_mask:0xf bank_mask:0xf
    v_cndmask_b32_dpp v28, v36, v28, vcc quad_perm:[2,3,2,3] row_mask:0xf bank_mask:0xf
    v_cndmask_b32_dpp v29, v37, v29, vcc quad_perm:[2,3,2,3] row_mask:0xf bank_mask:0xf
    v_cndmask_b32_dpp v30, v38, v30, vcc quad_perm:[2,3,2,3] row_mask:0xf bank_mask:0xf
    v_cndmask_b32_dpp v31, v39, v31, vcc quad_perm:[2,3,2,3] row_mask:0xf bank_mask:0xf
    v_mul_f32 v24, v24, v3
    v_mul_f32 v25, v25, v3
    v_mul_f32 v26, v26, v3
    v_mul_f32 v27, v27, v3
    v_mul_f32 v28, v28, v3
    v_mul_f32 v29, v29, v3
    v_mul_f32 v30, v30, v3
    v_mul_f32 v31, v31, v3
    v_cvt_pk_bf16_f32 v168, v24, v25
    v_cvt_pk_bf16_f32 v169, v26, v27
    v_cvt_pk_bf16_f32 v170, v28, v29
    v_cvt_pk_bf16_f32 v171, v30, v31
    ds_write_b128 v160, v[168:171]
    s_waitcnt lgkmcnt(0)
    s_barrier
    ds_read_b128 v[172:175], v161
    s_waitcnt lgkmcnt(0)
    v_mfma_f32_16x16x32_bf16 v[24:27], v[184:187], v[172:175], 0
    s_nop 7
    v_cvt_pk_bf16_f32 v168, v24, v25
    v_cvt_pk_bf16_f32 v169, v26, v27
    s_nop 0
    v_permlane16_swap_b32 v168, v170
    v_permlane16_swap_b32 v169, v171
    s_mov_b64 exec, 0xffff
    v_min_u32 v168, -2, v168
    buffer_store_dwordx4 v[168:171], v1, s[4:7], s25 offen sc1
    s_setprio 0
    buffer_store_dwordx4 v[176:179], v1, s[4:7], s26 offen sc1
    s_mov_b64 exec, -1
    s_branch pg_43
    s_cmp_lg_u32 s27, 0
    s_cbranch_scc1 pg_43
    s_sub_u32 s21, s16, 1
    s_cbranch_scc1 pg_43
    s_sub_u32 s17, s21, 1
    s_and_b32 s17, s17, 3
    s_cmp_ge_u32 s16, 58
    s_cselect_b32 s17, 0, s17
    s_cmp_lg_u32 s17, 0
    s_cbranch_scc1 pg_43
    v_mov_b32 v3, s21
    s_mov_b64 exec, 1
    buffer_store_dword v3, off, s[4:7], s28 sc1
    s_mov_b64 exec, -1
pg_43:
aloopH_40_lskb:
    v_mov_b32 v64, 0xff61b1e6
    ds_read_b128 v[128:131], v163 offset:16384
    ds_read_b128 v[132:135], v163 offset:17408
    ds_read_b128 v[136:139], v163 offset:18432
    ds_read_b128 v[140:143], v163 offset:19456
    ds_read_b128 v[144:147], v163 offset:20480
    ds_read_b128 v[148:151], v163 offset:21504
    ds_read_b128 v[152:155], v163 offset:22528
    ds_read_b128 v[156:159], v163 offset:23552
    s_waitcnt lgkmcnt(4)
    v_mfma_f32_16x16x32_bf16 v[12:15], v[96:99], v[128:131], 0
    v_mfma_f32_16x16x32_bf16 v[20:23], v[48:51], v[128:131], 0
    v_mfma_f32_16x16x32_bf16 v[12:15], v[100:103], v[132:135], v[12:15]
    v_mfma_f32_16x16x32_bf16 v[20:23], v[52:55], v[132:135], v[20:23]
    v_mfma_f32_16x16x32_bf16 v[12:15], v[104:107], v[136:139], v[12:15]
    v_mfma_f32_16x16x32_bf16 v[20:23], v[56:59], v[136:139], v[20:23]
    v_mfma_f32_16x16x32_bf16 v[12:15], v[108:111], v[140:143], v[12:15]
    v_mfma_f32_16x16x32_bf16 v[20:23], v[60:63], v[140:143], v[20:23]
    s_waitcnt lgkmcnt(0)
    v_mfma_f32_16x16x32_bf16 v[68:71], v[96:99], v[144:147], 0
    v_mfma_f32_16x16x32_bf16 v[72:75], v[112:115], v[144:147], 0
    v_mfma_f32_16x16x32_bf16 v[76:79], v[48:51], v[144:147], 0
    v_mfma_f32_16x16x32_bf16 v[68:71], v[100:103], v[148:151], v[68:71]
    v_mfma_f32_16x16x32_bf16 v[72:75], v[116:119], v[148:151], v[72:75]
    v_mfma_f32_16x16x32_bf16 v[76:79], v[52:55], v[148:151], v[76:79]
    v_mfma_f32_16x16x32_bf16 v[68:71], v[104:107], v[152:155], v[68:71]
    v_mfma_f32_16x16x32_bf16 v[72:75], v[120:123], v[152:155], v[72:75]
    v_mfma_f32_16x16x32_bf16 v[76:79], v[56:59], v[152:155], v[76:79]
    v_mfma_f32_16x16x32_bf16 v[68:71], v[108:111], v[156:159], v[68:71]
    v_mfma_f32_16x16x32_bf16 v[72:75], v[124:127], v[156:159], v[72:75]
    v_mfma_f32_16x16x32_bf16 v[76:79], v[60:63], v[156:159], v[76:79]
    v_cndmask_b32 v12, v12, v64, s[44:45]
    v_cndmask_b32 v13, v13, v64, s[46:47]
    v_cndmask_b32 v14, v14, v64, s[48:49]
    v_cndmask_b32 v15, v15, v64, s[50:51]
    s_add_u32 s17, s41, 20971520
    buffer_load_dwordx4 v[96:99], v0, s[4:7], s17 offen offset:0 sc1
    v_max3_f32 v2, v12, v13, v14
    buffer_load_dwordx4 v[100:103], v0, s[4:7], s17 offen offset:1024 sc1
    v_max3_f32 v3, v15, v20, v21
    buffer_load_dwordx4 v[104:107], v0, s[4:7], s17 offen offset:2048 sc1
    v_max_f32 v2, v2, v3
    buffer_load_dwordx4 v[108:111], v0, s[4:7], s17 offen offset:3072 sc1
    v_mov_b32 v3, v2
    s_add_u32 s18, s41, 21102592
    buffer_load_dwordx4 v[112:115], v0, s[4:7], s18 offen offset:0 sc1
    s_nop 1
    buffer_load_dwordx4 v[116:119], v0, s[4:7], s18 offen offset:1024 sc1
    v_permlane16_swap_b32 v3, v2
    buffer_load_dwordx4 v[120:123], v0, s[4:7], s18 offen offset:2048 sc1
    v_max_f32 v2, v2, v3
    buffer_load_dwordx4 v[124:127], v0, s[4:7], s18 offen offset:3072 sc1
    v_mov_b32 v3, v2
    s_nop 1
    v_permlane32_swap_b32 v3, v2
    v_max_f32 v2, v2, v3
    v_mul_f32 v2, s29, v2
    v_fma_f32 v12, v12, s29, -v2
    v_fma_f32 v13, v13, s29, -v2
    v_fma_f32 v14, v14, s29, -v2
    v_exp_f32 v12, v12
    v_fma_f32 v15, v15, s29, -v2
    v_exp_f32 v13, v13
    v_fma_f32 v20, v20, s29, -v2
    v_exp_f32 v14, v14
    v_fma_f32 v21, v21, s29, -v2
    v_exp_f32 v15, v15
    v_exp_f32 v20, v20
    v_exp_f32 v21, v21
    v_cvt_pk_bf16_f32 v12, v12, v13
    v_cvt_pk_bf16_f32 v13, v14, v15
    v_mov_b32 v14, 0
    v_mov_b32 v15, 0
    v_cvt_pk_bf16_f32 v20, v20, v21
    v_mov_b32 v22, 0
    v_mov_b32 v21, v20
    v_mov_b32 v23, 0
    s_nop 1
    v_cndmask_b32 v72, v72, v64, s[44:45]
    v_mfma_f32_16x16x32_bf16 v[16:19], v[4:7], v[12:15], 0
    v_cndmask_b32 v73, v73, v64, s[46:47]
    v_cndmask_b32 v74, v74, v64, s[48:49]
    v_mfma_f32_16x16x32_bf16 v[16:19], v[8:11], v[20:23], v[16:19]
    v_cndmask_b32 v75, v75, v64, s[50:51]
    v_max3_f32 v2, v68, v69, v70
    v_mfma_f32_16x16x32_bf16 v[24:27], v[80:83], v[12:15], 0
    v_max3_f32 v3, v71, v72, v73
    v_max3_f32 v2, v2, v74, v75
    v_mfma_f32_16x16x32_bf16 v[24:27], v[40:43], v[20:23], v[24:27]
    v_max3_f32 v3, v3, v76, v77
    v_max_f32 v2, v2, v3
    v_mfma_f32_16x16x32_bf16 v[28:31], v[84:87], v[12:15], 0
    v_mov_b32 v3, v2
    s_nop 1
    v_mfma_f32_16x16x32_bf16 v[28:31], v[42:45], v[20:23], v[28:31]
    v_permlane16_swap_b32 v3, v2
    v_max_f32 v2, v2, v3
    v_mfma_f32_16x16x32_bf16 v[32:35], v[88:91], v[12:15], 0
    v_mov_b32 v3, v2
    s_nop 1
    v_mfma_f32_16x16x32_bf16 v[32:35], v[44:47], v[20:23], v[32:35]
    v_permlane32_swap_b32 v3, v2
    v_max_f32 v2, v2, v3
    v_mfma_f32_16x16x32_bf16 v[36:39], v[92:95], v[12:15], 0
    v_mul_f32 v2, s29, v2
    v_fma_f32 v68, v68, s29, -v2
    v_mfma_f32_16x16x32_bf16 v[36:39], v[46:49], v[20:23], v[36:39]
    v_fma_f32 v69, v69, s29, -v2
    v_fma_f32 v70, v70, s29, -v2
    v_exp_f32 v68, v68
    v_fma_f32 v71, v71, s29, -v2
    v_exp_f32 v69, v69
    v_fma_f32 v72, v72, s29, -v2
    v_exp_f32 v70, v70
    v_fma_f32 v73, v73, s29, -v2
    v_exp_f32 v71, v71
    v_fma_f32 v74, v74, s29, -v2
    v_exp_f32 v72, v72
    v_fma_f32 v75, v75, s29, -v2
    v_exp_f32 v73, v73
    v_fma_f32 v76, v76, s29, -v2
    v_exp_f32 v74, v74
    v_fma_f32 v77, v77, s29, -v2
    v_exp_f32 v75, v75
    v_exp_f32 v76, v76
    v_exp_f32 v77, v77
    v_cvt_pk_bf16_f32 v68, v68, v69
    v_cvt_pk_bf16_f32 v69, v70, v71
    v_cvt_pk_bf16_f32 v70, v72, v73
    v_cvt_pk_bf16_f32 v71, v74, v75
    v_cvt_pk_bf16_f32 v76, v76, v77
    v_mov_b32 v78, 0
    v_mov_b32 v77, v76
    v_mov_b32 v79, 0
    v_rcp_f32 v66, v16
    s_nop 0
    v_mul_f32 v24, v24, v66
    v_mul_f32 v25, v25, v66
    v_mul_f32 v26, v26, v66
    v_mul_f32 v27, v27, v66
    v_cvt_pk_bf16_f32 v168, v24, v25
    v_cvt_pk_bf16_f32 v169, v26, v27
    v_mul_f32 v28, v28, v66
    v_mul_f32 v29, v29, v66
    v_mul_f32 v30, v30, v66
    v_mul_f32 v31, v31, v66
    v_cvt_pk_bf16_f32 v170, v28, v29
    v_cvt_pk_bf16_f32 v171, v30, v31
    v_mul_f32 v32, v32, v66
    v_mul_f32 v33, v33, v66
    v_mul_f32 v34, v34, v66
    v_mul_f32 v35, v35, v66
    v_cvt_pk_bf16_f32 v172, v32, v33
    v_cvt_pk_bf16_f32 v173, v34, v35
    v_mul_f32 v36, v36, v66
    v_mul_f32 v37, v37, v66
    v_mul_f32 v38, v38, v66
    v_mul_f32 v39, v39, v66
    v_cvt_pk_bf16_f32 v174, v36, v37
    v_cvt_pk_bf16_f32 v175, v38, v39
    ds_write_b128 v162, v[168:171] offset:0
    ds_write_b128 v162, v[172:175] offset:2048
    v_mfma_f32_16x16x32_bf16 v[72:75], v[4:7], v[68:71], 0
    v_mfma_f32_16x16x32_bf16 v[72:75], v[8:11], v[76:79], v[72:75]
    v_mfma_f32_16x16x32_bf16 v[24:27], v[80:83], v[68:71], 0
    v_mfma_f32_16x16x32_bf16 v[24:27], v[40:43], v[76:79], v[24:27]
    v_mfma_f32_16x16x32_bf16 v[28:31], v[84:87], v[68:71], 0
    v_mfma_f32_16x16x32_bf16 v[28:31], v[42:45], v[76:79], v[28:31]
    v_mfma_f32_16x16x32_bf16 v[32:35], v[88:91], v[68:71], 0
    v_mfma_f32_16x16x32_bf16 v[32:35], v[44:47], v[76:79], v[32:35]
    v_mfma_f32_16x16x32_bf16 v[36:39], v[92:95], v[68:71], 0
    v_mfma_f32_16x16x32_bf16 v[36:39], v[46:49], v[76:79], v[36:39]
    v_rcp_f32 v3, v72
    s_nop 0
    v_mul_f32 v24, v24, v3
    v_mul_f32 v25, v25, v3
    v_mul_f32 v26, v26, v3
    v_mul_f32 v27, v27, v3
    v_cvt_pk_bf16_f32 v168, v24, v25
    v_cvt_pk_bf16_f32 v169, v26, v27
    v_mul_f32 v28, v28, v3
    v_mul_f32 v29, v29, v3
    v_mul_f32 v30, v30, v3
    v_mul_f32 v31, v31, v3
    v_cvt_pk_bf16_f32 v170, v28, v29
    v_cvt_pk_bf16_f32 v171, v30, v31
    v_mul_f32 v32, v32, v3
    v_mul_f32 v33, v33, v3
    v_mul_f32 v34, v34, v3
    v_mul_f32 v35, v35, v3
    v_cvt_pk_bf16_f32 v172, v32, v33
    v_cvt_pk_bf16_f32 v173, v34, v35
    v_mul_f32 v36, v36, v3
    v_mul_f32 v37, v37, v3
    v_mul_f32 v38, v38, v3
    v_mul_f32 v39, v39, v3
    v_cvt_pk_bf16_f32 v174, v36, v37
    v_cvt_pk_bf16_f32 v175, v38, v39
    ds_write_b128 v162, v[168:171] offset:256
    ds_write_b128 v162, v[172:175] offset:2304
    v_xor_b32 v162, 0x4000, v162
    s_add_u32 s16, s16, 1
    s_cmp_le_u32 s16, 63
    s_cbranch_scc1 aloopH_40
    s_waitcnt lgkmcnt(0)
    s_barrier
    s_waitcnt vmcnt(0)
    s_branch k_end
aloopH_40_rq_0:
    s_sub_u32 s22, s22, 1
    s_cbranch_scc1 aloopH_40_rq_0_g
    buffer_load_dwordx4 v[48:51], v0, s[4:7], s23 offen offset:0 sc1
    buffer_load_dwordx4 v[52:55], v0, s[4:7], s23 offen offset:1024 sc1
    buffer_load_dwordx4 v[56:59], v0, s[4:7], s23 offen offset:2048 sc1
    buffer_load_dwordx4 v[60:63], v0, s[4:7], s23 offen offset:3072 sc1
    buffer_load_dwordx4 v[64:67], v0, s[4:7], s24 offen offset:0 sc1
    buffer_load_dwordx4 v[68:71], v0, s[4:7], s24 offen offset:1024 sc1
    s_waitcnt vmcnt(5)
    v_max_u32 v3, v48, v50
    v_cmp_eq_u32 vcc, -1, v3
    s_cbranch_vccnz aloopH_40_rq_0
    s_branch aloopH_40_again
aloopH_40_rq_0_g:
    s_mov_b32 s22, 0
    s_waitcnt vmcnt(0)
    s_branch aloopH_40_nochk
aloopH_40_rq_1:
    s_sub_u32 s22, s22, 1
    s_cbranch_scc1 aloopH_40_rq_1_g
    buffer_load_dwordx4 v[52:55], v0, s[4:7], s23 offen offset:1024 sc1
    buffer_load_dwordx4 v[56:59], v0, s[4:7], s23 offen offset:2048 sc1
    buffer_load_dwordx4 v[60:63], v0, s[4:7], s23 offen offset:3072 sc1
    buffer_load_dwordx4 v[64:67], v0, s[4:7], s24 offen offset:0 sc1
    buffer_load_dwordx4 v[68:71], v0, s[4:7], s24 offen offset:1024 sc1
    s_waitcnt vmcnt(4)
    v_max_u32 v3, v52, v54
    v_cmp_eq_u32 vcc, -1, v3
    s_cbranch_vccnz aloopH_40_rq_1
    s_branch aloopH_40_again
aloopH_40_rq_1_g:
    s_mov_b32 s22, 0
    s_waitcnt vmcnt(0)
    s_branch aloopH_40_nochk
aloopH_40_rq_2:
    s_sub_u32 s22, s22, 1
    s_cbranch_scc1 aloopH_40_rq_2_g
    buffer_load_dwordx4 v[56:59], v0, s[4:7], s23 offen offset:2048 sc1
    buffer_load_dwordx4 v[60:63], v0, s[4:7], s23 offen offset:3072 sc1
    buffer_load_dwordx4 v[64:67], v0, s[4:7], s24 offen offset:0 sc1
    buffer_load_dwordx4 v[68:71], v0, s[4:7], s24 offen offset:1024 sc1
    s_waitcnt vmcnt(3)
    v_max_u32 v3, v56, v58
    v_cmp_eq_u32 vcc, -1, v3
    s_cbranch_vccnz aloopH_40_rq_2
    s_branch aloopH_40_again
aloopH_40_rq_2_g:
    s_mov_b32 s22, 0
    s_waitcnt vmcnt(0)
    s_branch aloopH_40_nochk
aloopH_40_rq_3:
    s_sub_u32 s22, s22, 1
    s_cbranch_scc1 aloopH_40_rq_3_g
    buffer_load_dwordx4 v[60:63], v0, s[4:7], s23 offen offset:3072 sc1
    buffer_load_dwordx4 v[64:67], v0, s[4:7], s24 offen offset:0 sc1
    buffer_load_dwordx4 v[68:71], v0, s[4:7], s24 offen offset:1024 sc1
    s_waitcnt vmcnt(2)
    v_max_u32 v3, v60, v62
    v_cmp_eq_u32 vcc, -1, v3
    s_cbranch_vccnz aloopH_40_rq_3
    s_branch aloopH_40_again
aloopH_40_rq_3_g:
    s_mov_b32 s22, 0
    s_waitcnt vmcnt(0)
    s_branch aloopH_40_nochk
aloopH_40_again:
    s_waitcnt vmcnt(5)
    v_mfma_f32_16x16x32_bf16 v[12:15], v[96:99], v[48:51], 0
    v_mfma_f32_16x16x32_bf16 v[16:19], v[112:115], v[48:51], 0
    v_max_u32 v3, v48, v50
    v_cmp_eq_u32 vcc, -1, v3
    v_mfma_f32_16x16x32_bf16 v[20:23], v[48:51], v[48:51], 0
    s_cbranch_vccnz aloopH_40_rq_0
    s_waitcnt vmcnt(4)
    v_mfma_f32_16x16x32_bf16 v[12:15], v[100:103], v[52:55], v[12:15]
    v_mfma_f32_16x16x32_bf16 v[16:19], v[116:119], v[52:55], v[16:19]
    v_max_u32 v3, v52, v54
    v_cmp_eq_u32 vcc, -1, v3
    v_mfma_f32_16x16x32_bf16 v[20:23], v[52:55], v[52:55], v[20:23]
    s_cbranch_vccnz aloopH_40_rq_1
    s_waitcnt vmcnt(3)
    v_mfma_f32_16x16x32_bf16 v[12:15], v[104:107], v[56:59], v[12:15]
    v_mfma_f32_16x16x32_bf16 v[16:19], v[120:123], v[56:59], v[16:19]
    v_max_u32 v3, v56, v58
    v_cmp_eq_u32 vcc, -1, v3
    v_mfma_f32_16x16x32_bf16 v[20:23], v[56:59], v[56:59], v[20:23]
    s_cbranch_vccnz aloopH_40_rq_2
    s_waitcnt vmcnt(2)
    v_mfma_f32_16x16x32_bf16 v[12:15], v[108:111], v[60:63], v[12:15]
    v_mfma_f32_16x16x32_bf16 v[16:19], v[124:127], v[60:63], v[16:19]
    v_max_u32 v3, v60, v62
    v_cmp_eq_u32 vcc, -1, v3
    v_mfma_f32_16x16x32_bf16 v[20:23], v[60:63], v[60:63], v[20:23]
    s_cbranch_vccnz aloopH_40_rq_3
    s_branch aloopH_40_sdone
aloopH_40_rq_v:
    s_sub_u32 s22, s22, 1
    s_cbranch_scc1 aloopH_40_rq_vg
    buffer_load_dwordx4 v[64:67], v0, s[4:7], s24 offen offset:0 sc1
    buffer_load_dwordx4 v[68:71], v0, s[4:7], s24 offen offset:1024 sc1
    s_waitcnt vmcnt(0)
    v_max3_u32 v188, v64, v66, v68
    v_max_u32 v188, v188, v70
    v_cmp_eq_u32 vcc, -1, v188
    s_cbranch_vccnz aloopH_40_rq_v
    s_branch aloopH_40_vok
aloopH_40_rq_vg:
    s_mov_b32 s22, 0
    s_branch aloopH_40_vok
aloopH_40_nochk:
    v_mfma_f32_16x16x32_bf16 v[12:15], v[96:99], v[48:51], 0
    v_mfma_f32_16x16x32_bf16 v[16:19], v[112:115], v[48:51], 0
    v_mfma_f32_16x16x32_bf16 v[20:23], v[48:51], v[48:51], 0
    v_mfma_f32_16x16x32_bf16 v[12:15], v[100:103], v[52:55], v[12:15]
    v_mfma_f32_16x16x32_bf16 v[16:19], v[116:119], v[52:55], v[16:19]
    v_mfma_f32_16x16x32_bf16 v[20:23], v[52:55], v[52:55], v[20:23]
    v_mfma_f32_16x16x32_bf16 v[12:15], v[104:107], v[56:59], v[12:15]
    v_mfma_f32_16x16x32_bf16 v[16:19], v[120:123], v[56:59], v[16:19]
    v_mfma_f32_16x16x32_bf16 v[20:23], v[56:59], v[56:59], v[20:23]
    v_mfma_f32_16x16x32_bf16 v[12:15], v[108:111], v[60:63], v[12:15]
    v_mfma_f32_16x16x32_bf16 v[16:19], v[124:127], v[60:63], v[16:19]
    v_mfma_f32_16x16x32_bf16 v[20:23], v[60:63], v[60:63], v[20:23]
    s_nop 1
    s_branch aloopH_40_sdone
aloopH_40_rq_v2:
    s_sub_u32 s22, s22, 1
    s_cbranch_scc1 aloopH_40_rq_v2g
    buffer_load_dwordx4 v[64:67], v0, s[4:7], s24 offen offset:0 sc1
    buffer_load_dwordx4 v[68:71], v0, s[4:7], s24 offen offset:1024 sc1
    s_waitcnt vmcnt(0)
    v_max3_u32 v188, v64, v66, v68
    v_max_u32 v188, v188, v70
    v_cmp_eq_u32 vcc, -1, v188
    s_cbranch_vccnz aloopH_40_rq_v2
    s_branch aloopH_40_lsk3
aloopH_40_rq_v2g:
    s_mov_b32 s22, 0
    s_branch aloopH_40_lsk3
ct_tail:
aloopH_40_lsk:
    s_cmp_lg_u32 s27, 0
    s_cbranch_scc1 aloopH_40_lsk2
    v_mov_b32 v3, 62
    s_mov_b64 exec, 1
    buffer_store_dword v3, off, s[4:7], s28 sc1
    s_mov_b64 exec, -1
aloopH_40_lsk2:
    s_waitcnt vmcnt(0)
    v_max3_u32 v188, v64, v66, v68
    v_max_u32 v188, v188, v70
    v_cmp_eq_u32 vcc, -1, v188
    s_cbranch_vccnz aloopH_40_rq_v2
aloopH_40_lsk3:
    v_smfmac_f32_16x16x64_bf16 v[24:27], v[64:67], v[192:199], v166
    v_smfmac_f32_16x16x64_bf16 v[32:35], v[64:67], v[224:231], v166
    v_smfmac_f32_16x16x64_bf16 v[28:31], v[64:67], v[208:215], v166
    v_smfmac_f32_16x16x64_bf16 v[36:39], v[64:67], v[240:247], v166
    v_smfmac_f32_16x16x64_bf16 v[24:27], v[68:71], v[200:207], v166
    v_smfmac_f32_16x16x64_bf16 v[32:35], v[68:71], v[232:239], v166
    v_smfmac_f32_16x16x64_bf16 v[28:31], v[68:71], v[216:223], v166
    v_smfmac_f32_16x16x64_bf16 v[36:39], v[68:71], v[248:255], v166
    s_nop 7
    s_nop 1
    v_cvt_pk_bf16_f32 v40, v24, v25
    v_cvt_pk_bf16_f32 v41, v26, v27
    v_cvt_pk_bf16_f32 v42, v28, v29
    v_cvt_pk_bf16_f32 v43, v30, v31
    v_cvt_pk_bf16_f32 v44, v32, v33
    v_cvt_pk_bf16_f32 v45, v34, v35
    v_cvt_pk_bf16_f32 v46, v36, v37
    v_cvt_pk_bf16_f32 v47, v38, v39
    s_waitcnt lgkmcnt(0)
    s_branch aloopH_40_lskb
k_end:
k_exit:
    s_endpgm
.section .rodata,"a"
.p2align 6
jobtab:
    .long 4, 24, 24, 8192, 0, 262144, 8388608, 0, 32768, 4, 20971520, 131072, 0, 0, 218104321, 0
    .long 4, 24, 24, 8192, 256, 262400, 8388608, 0, 32768, 4, 20975616, 131072, 0, 0, 218104321, 0
    .long 4, 24, 24, 8192, 512, 262656, 8388608, 0, 32768, 4, 20979712, 131072, 0, 0, 218104321, 0
    .long 4, 24, 24, 8192, 768, 262912, 8388608, 0, 32768, 4, 20983808, 131072, 0, 0, 218104321, 0
    .long 4, 24, 24, 8192, 1024, 263168, 8388608, 0, 32768, 4, 20987904, 131072, 0, 0, 218104337, 0
    .long 4, 24, 24, 8192, 1280, 263424, 8388608, 0, 32768, 4, 20992000, 131072, 0, 0, 218104337, 0
    .long 4, 24, 24, 8192, 1536, 263680, 8388608, 0, 32768, 4, 20996096, 131072, 0, 0, 218104337, 0
    .long 4, 24, 24, 8192, 1792, 263936, 8388608, 0, 32768, 4, 21000192, 131072, 0, 0, 218104337, 0
    .long 4, 32, 32, 8192, 0, 262144, 8388608, 0, 32768, 4, 37748736, 131072, 0, 0, 218104321, 0
    .long 4, 32, 32, 8192, 256, 262400, 8388608, 0, 32768, 4, 37752832, 131072, 0, 0, 218104321, 0
    .long 4, 32, 32, 8192, 512, 262656, 8388608, 0, 32768, 4, 37756928, 131072, 0, 0, 218104321, 0
    .long 4, 32, 32, 8192, 768, 262912, 8388608, 0, 32768, 4, 37761024, 131072, 0, 0, 218104321, 0
    .long 4, 32, 32, 8192, 1024, 263168, 8388608, 0, 32768, 4, 37765120, 131072, 0, 0, 218104337, 0
    .long 4, 32, 32, 8192, 1280, 263424, 8388608, 0, 32768, 4, 37769216, 131072, 0, 0, 218104337, 0
    .long 4, 32, 32, 8192, 1536, 263680, 8388608, 0, 32768, 4, 37773312, 131072, 0, 0, 218104337, 0
    .long 4, 32, 32, 8192, 1792, 263936, 8388608, 0, 32768, 4, 37777408, 131072, 0, 0, 218104337, 0
    .long 4, 24, 24, 8192, 0, 262144, 8388608, 262144, 32768, 4, 22020096, 131072, 0, 0, 218104324, 0
    .long 4, 24, 24, 8192, 256, 262400, 8388608, 262144, 32768, 4, 22024192, 131072, 0, 0, 218104324, 0
    .long 4, 24, 24, 8192, 512, 262656, 8388608, 262144, 32768, 4, 22028288, 131072, 0, 0, 218104324, 0
    .long 4, 24, 24, 8192, 768, 262912, 8388608, 262144, 32768, 4, 22032384, 131072, 0, 0, 218104324, 0
    .long 4, 24, 24, 8192, 1024, 263168, 8388608, 262144, 32768, 4, 22036480, 131072, 0, 0, 218104340, 0
    .long 4, 24, 24, 8192, 1280, 263424, 8388608, 262144, 32768, 4, 22040576, 131072, 0, 0, 218104340, 0
    .long 4, 24, 24, 8192, 1536, 263680, 8388608, 262144, 32768, 4, 22044672, 131072, 0, 0, 218104340, 0
    .long 4, 24, 24, 8192, 1792, 263936, 8388608, 262144, 32768, 4, 22048768, 131072, 0, 0, 218104340, 0
    .long 4, 32, 32, 8192, 0, 262144, 8388608, 262144, 32768, 4, 38797312, 131072, 0, 0, 218104324, 0
    .long 4, 32, 32, 8192, 256, 262400, 8388608, 262144, 32768, 4, 38801408, 131072, 0, 0, 218104324, 0
    .long 4, 32, 32, 8192, 512, 262656, 8388608, 262144, 32768, 4, 38805504, 131072, 0, 0, 218104324, 0
    .long 4, 32, 32, 8192, 768, 262912, 8388608, 262144, 32768, 4, 38809600, 131072, 0, 0, 218104324, 0
    .long 4, 32, 32, 8192, 1024, 263168, 8388608, 262144, 32768, 4, 38813696, 131072, 0, 0, 218104340, 0
    .long 4, 32, 32, 8192, 1280, 263424, 8388608, 262144, 32768, 4, 38817792, 131072, 0, 0, 218104340, 0
    .long 4, 32, 32, 8192, 1536, 263680, 8388608, 262144, 32768, 4, 38821888, 131072, 0, 0, 218104340, 0
    .long 4, 32, 32, 8192, 1792, 263936, 8388608, 262144, 32768, 4, 38825984, 131072, 0, 0, 218104340, 0
    .long 4, 32, 32, 8192, 512, 262656, 8388608, 786432, 32768, 4, 40902656, 131072, 0, 0, 218104580, 0
    .long 4, 32, 32, 8192, 1536, 263680, 8388608, 786432, 32768, 4, 40919040, 131072, 0, 0, 218104596, 0
    .long 4, 32, 32, 8192, 1792, 263936, 8388608, 524288, 32768, 4, 39874560, 131072, 0, 0, 218104593, 0
    .long 4, 24, 24, 8192, 512, 262656, 8388608, 786432, 32768, 4, 24125440, 131072, 0, 0, 218104580, 0
    .long 4, 32, 32, 8192, 512, 262656, 8388608, 524288, 32768, 4, 39854080, 131072, 0, 0, 218104577, 0
    .long 4, 32, 32, 8192, 1792, 263936, 8388608, 786432, 32768, 4, 40923136, 131072, 0, 0, 218104596, 0
    .long 4, 24, 24, 8192, 1536, 263680, 8388608, 786432, 32768, 4, 24141824, 131072, 0, 0, 218104596, 0
    .long 4, 24, 24, 8192, 256, 262400, 8388608, 524288, 32768, 4, 23072768, 131072, 0, 0, 218104577, 0
    .long 4, 24, 24, 8192, 768, 262912, 8388608, 524288, 32768, 4, 23080960, 131072, 0, 0, 218104577, 0
    .long 4, 24, 24, 8192, 1280, 263424, 8388608, 524288, 32768, 4, 23089152, 131072, 0, 0, 218104593, 0
    .long 4, 24, 24, 8192, 768, 262912, 8388608, 786432, 32768, 4, 24129536, 131072, 0, 0, 218104580, 0
    .long 4, 32, 32, 8192, 256, 262400, 8388608, 524288, 32768, 4, 39849984, 131072, 0, 0, 218104577, 0
    .long 4, 32, 32, 8192, 1024, 263168, 8388608, 524288, 32768, 4, 39862272, 131072, 0, 0, 218104593, 0
    .long 4, 24, 24, 8192, 1536, 263680, 8388608, 524288, 32768, 4, 23093248, 131072, 0, 0, 218104593, 0
    .long 4, 32, 32, 8192, 768, 262912, 8388608, 524288, 32768, 4, 39858176, 131072, 0, 0, 218104577, 0
    .long 4, 24, 24, 8192, 0, 262144, 8388608, 524288, 32768, 4, 23068672, 131072, 0, 0, 218104577, 0
    .long 4, 32, 32, 8192, 1024, 263168, 8388608, 786432, 32768, 4, 40910848, 131072, 0, 0, 218104596, 0
    .long 4, 24, 24, 8192, 1792, 263936, 8388608, 786432, 32768, 4, 24145920, 131072, 0, 0, 218104596, 0
    .long 4, 32, 32, 8192, 0, 262144, 8388608, 524288, 32768, 4, 39845888, 131072, 0, 0, 218104577, 0
    .long 4, 24, 24, 8192, 1280, 263424, 8388608, 786432, 32768, 4, 24137728, 131072, 0, 0, 218104596, 0
    .long 4, 32, 32, 8192, 256, 262400, 8388608, 786432, 32768, 4, 40898560, 131072, 0, 0, 218104580, 0
    .long 4, 24, 24, 8192, 1024, 263168, 8388608, 786432, 32768, 4, 24133632, 131072, 0, 0, 218104596, 0
    .long 4, 24, 24, 8192, 512, 262656, 8388608, 524288, 32768, 4, 23076864, 131072, 0, 0, 218104577, 0
    .long 4, 24, 24, 8192, 256, 262400, 8388608, 786432, 32768, 4, 24121344, 131072, 0, 0, 218104580, 0
    .long 4, 32, 32, 8192, 1280, 263424, 8388608, 786432, 32768, 4, 40914944, 131072, 0, 0, 218104596, 0
    .long 4, 24, 24, 8192, 0, 262144, 8388608, 786432, 32768, 4, 24117248, 131072, 0, 0, 218104580, 0
    .long 4, 32, 32, 8192, 1536, 263680, 8388608, 524288, 32768, 4, 39870464, 131072, 0, 0, 218104593, 0
    .long 4, 32, 32, 8192, 768, 262912, 8388608, 786432, 32768, 4, 40906752, 131072, 0, 0, 218104580, 0
    .long 4, 32, 32, 8192, 1280, 263424, 8388608, 524288, 32768, 4, 39866368, 131072, 0, 0, 218104593, 0
    .long 4, 24, 24, 8192, 1024, 263168, 8388608, 524288, 32768, 4, 23085056, 131072, 0, 0, 218104593, 0
    .long 4, 24, 24, 8192, 1792, 263936, 8388608, 524288, 32768, 4, 23097344, 131072, 0, 0, 218104593, 0
    .long 4, 32, 32, 8192, 0, 262144, 8388608, 786432, 32768, 4, 40894464, 131072, 0, 0, 218104580, 0
    .long 1, 16, 16, 8192, 0, 256, 8388608, 1572864, 32768, 8, 10485760, 131072, 0, 0, 218105098, 0
    .long 1, 32, 32, 8192, 512, 768, 8388608, 1048576, 32768, 8, 41951232, 131072, 0, 0, 218104842, 0
    .long 1, 32, 32, 8192, 512, 768, 8388608, 1572864, 32768, 8, 44048384, 131072, 0, 0, 218105098, 0
    .long 1, 24, 24, 8192, 512, 768, 8388608, 1048576, 32768, 8, 25174016, 131072, 0, 0, 218104842, 0
    .long 1, 16, 16, 8192, 1024, 1280, 8388608, 1048576, 32768, 8, 8404992, 131072, 0, 0, 218104858, 0
    .long 1, 16, 16, 8192, 1536, 1792, 8388608, 1048576, 32768, 8, 8413184, 131072, 0, 0, 218104858, 0
    .long 1, 32, 32, 8192, 1536, 1792, 8388608, 1048576, 32768, 8, 41967616, 131072, 0, 0, 218104858, 0
    .long 1, 24, 24, 8192, 1024, 1280, 8388608, 1048576, 32768, 8, 25182208, 131072, 0, 0, 218104858, 0
    .long 1, 24, 24, 8192, 1536, 1792, 8388608, 2097152, 32768, 8, 29384704, 131072, 0, 0, 218105370, 0
    .long 1, 24, 24, 8192, 1536, 1792, 8388608, 1048576, 32768, 8, 25190400, 131072, 0, 0, 218104858, 0
    .long 1, 32, 32, 8192, 1024, 1280, 8388608, 1048576, 32768, 8, 41959424, 131072, 0, 0, 218104858, 0
    .long 1, 24, 24, 8192, 1024, 1280, 8388608, 2097152, 32768, 8, 29376512, 131072, 0, 0, 218105370, 0
    .long 1, 24, 24, 8192, 0, 256, 8388608, 1572864, 32768, 8, 27262976, 131072, 0, 0, 218105098, 0
    .long 1, 32, 32, 8192, 0, 256, 8388608, 1572864, 32768, 8, 44040192, 131072, 0, 0, 218105098, 0
    .long 1, 24, 24, 8192, 1024, 1280, 8388608, 1572864, 32768, 8, 27279360, 131072, 0, 0, 218105114, 0
    .long 1, 16, 16, 8192, 0, 256, 8388608, 1048576, 32768, 8, 8388608, 131072, 0, 0, 218104842, 0
    .long 1, 24, 24, 8192, 512, 768, 8388608, 1572864, 32768, 8, 27271168, 131072, 0, 0, 218105098, 0
    .long 1, 16, 16, 8192, 512, 768, 8388608, 1572864, 32768, 8, 10493952, 131072, 0, 0, 218105098, 0
    .long 1, 32, 32, 8192, 1024, 1280, 8388608, 1572864, 32768, 8, 44056576, 131072, 0, 0, 218105114, 0
    .long 1, 16, 16, 8192, 1024, 1280, 8388608, 1572864, 32768, 8, 10502144, 131072, 0, 0, 218105114, 0
    .long 1, 32, 32, 8192, 1536, 1792, 8388608, 2097152, 32768, 8, 46161920, 131072, 0, 0, 218105370, 0
    .long 1, 24, 24, 8192, 0, 256, 8388608, 1048576, 32768, 8, 25165824, 131072, 0, 0, 218104842, 0
    .long 1, 24, 24, 8192, 0, 256, 8388608, 2097152, 32768, 8, 29360128, 131072, 0, 0, 218105354, 0
    .long 1, 16, 16, 8192, 1536, 1792, 8388608, 1572864, 32768, 8, 10510336, 131072, 0, 0, 218105114, 0
    .long 2, 64, 72, 7168, 768, 768, 7340032, 1572864, 32768, 8, 60043264, 114688, 0, 0, 218104001, 0
    .long 1, 32, 32, 8192, 0, 256, 8388608, 2097152, 32768, 8, 46137344, 131072, 0, 0, 218105354, 0
    .long 1, 32, 32, 8192, 0, 256, 8388608, 1048576, 32768, 8, 41943040, 131072, 0, 0, 218104842, 0
    .long 1, 32, 32, 8192, 512, 768, 8388608, 2097152, 32768, 8, 46145536, 131072, 0, 0, 218105354, 0
    .long 1, 24, 24, 8192, 1536, 1792, 8388608, 1572864, 32768, 8, 27287552, 131072, 0, 0, 218105114, 0
    .long 1, 32, 32, 8192, 1536, 1792, 8388608, 1572864, 32768, 8, 44064768, 131072, 0, 0, 218105114, 0
    .long 1, 16, 16, 8192, 512, 768, 8388608, 1048576, 32768, 8, 8396800, 131072, 0, 0, 218104842, 0
    .long 1, 32, 32, 8192, 1024, 1280, 8388608, 2097152, 32768, 8, 46153728, 131072, 0, 0, 218105370, 0
    .long 1, 16, 16, 8192, 512, 768, 8388608, 0, 32768, 8, 4202496, 131072, 0, 0, 218107914, 0
    .long 2, 64, 72, 7168, 768, 768, 7340032, 2097152, 32768, 8, 61878272, 114688, 0, 0, 218104065, 0
    .long 1, 16, 16, 8192, 1536, 1792, 8388608, 2097152, 32768, 8, 12607488, 131072, 0, 0, 218105370, 0
    .long 1, 16, 16, 8192, 512, 768, 8388608, 524288, 32768, 8, 6299648, 131072, 0, 0, 218108170, 0
    .long 1, 16, 16, 8192, 1536, 1792, 8388608, 3145728, 32768, 8, 16801792, 131072, 0, 0, 218105882, 0
    .long 1, 32, 32, 8192, 1536, 1792, 8388608, 2621440, 32768, 8, 48259072, 131072, 0, 0, 218105626, 0
    .long 1, 16, 16, 8192, 1024, 1280, 8388608, 0, 32768, 8, 4210688, 131072, 0, 0, 218107930, 0
    .long 1, 16, 16, 8192, 0, 256, 8388608, 2097152, 32768, 8, 12582912, 131072, 0, 0, 218105354, 0
    .long 1, 16, 16, 8192, 1536, 1792, 8388608, 0, 32768, 8, 4218880, 131072, 0, 0, 218107930, 0
    .long 1, 16, 16, 8192, 0, 256, 8388608, 524288, 32768, 8, 6291456, 131072, 0, 0, 218108170, 0
    .long 1, 24, 24, 8192, 1024, 1280, 8388608, 3145728, 32768, 8, 33570816, 131072, 0, 0, 218105882, 0
    .long 1, 24, 24, 8192, 512, 768, 8388608, 2621440, 32768, 8, 31465472, 131072, 0, 0, 218105610, 0
    .long 1, 16, 16, 8192, 512, 768, 8388608, 2621440, 32768, 8, 14688256, 131072, 0, 0, 218105610, 0
    .long 1, 16, 16, 8192, 1024, 1280, 8388608, 524288, 32768, 8, 6307840, 131072, 0, 0, 218108186, 0
    .long 2, 64, 72, 7168, 1280, 1280, 7340032, 0, 32768, 8, 54546432, 114688, 0, 0, 218103809, 0
    .long 2, 64, 72, 7168, 768, 768, 7340032, 0, 32768, 8, 54538240, 114688, 0, 0, 218103809, 0
    .long 2, 64, 72, 7168, 1280, 1280, 7340032, 1048576, 32768, 8, 58216448, 114688, 0, 0, 218103937, 0
    .long 1, 16, 16, 8192, 0, 256, 8388608, 0, 32768, 8, 4194304, 131072, 0, 0, 218107914, 0
    .long 1, 16, 16, 8192, 1536, 1792, 8388608, 524288, 32768, 8, 6316032, 131072, 0, 0, 218108186, 0
    .long 1, 24, 24, 8192, 1024, 1280, 8388608, 2621440, 32768, 8, 31473664, 131072, 0, 0, 218105626, 0
    .long 1, 16, 16, 8192, 1536, 1792, 8388608, 2621440, 32768, 8, 14704640, 131072, 0, 0, 218105626, 0
    .long 1, 24, 24, 8192, 512, 768, 8388608, 2097152, 32768, 8, 29368320, 131072, 0, 0, 218105354, 0
    .long 2, 64, 72, 7168, 1280, 1280, 7340032, 2097152, 32768, 8, 61886464, 114688, 0, 0, 218104065, 0
    .long 1, 16, 16, 8192, 512, 768, 8388608, 3145728, 32768, 8, 16785408, 131072, 0, 0, 218105866, 0
    .long 1, 16, 16, 8192, 512, 768, 8388608, 2097152, 32768, 8, 12591104, 131072, 0, 0, 218105354, 0
    .long 2, 64, 72, 7168, 768, 768, 7340032, 3670016, 32768, 8, 67383296, 114688, 0, 0, 218104257, 0
    .long 1, 24, 24, 8192, 512, 768, 8388608, 3145728, 32768, 8, 33562624, 131072, 0, 0, 218105866, 0
    .long 2, 64, 72, 7168, 512, 512, 7340032, 2097152, 32768, 8, 61874176, 114688, 0, 0, 218104065, 0
    .long 1, 16, 16, 8192, 1024, 1280, 8388608, 2097152, 32768, 8, 12599296, 131072, 0, 0, 218105370, 0
    .long 2, 64, 72, 7168, 1280, 1280, 7340032, 2621440, 32768, 8, 63721472, 114688, 0, 0, 218104129, 0
    .long 1, 32, 32, 8192, 1536, 1792, 8388608, 3145728, 32768, 8, 50356224, 131072, 0, 0, 218105882, 0
    .long 1, 24, 24, 8192, 0, 256, 8388608, 2621440, 32768, 8, 31457280, 131072, 0, 0, 218105610, 0
    .long 2, 64, 72, 7168, 0, 0, 7340032, 1048576, 32768, 8, 58195968, 114688, 0, 0, 218103937, 0
    .long 1, 32, 32, 8192, 1024, 1280, 8388608, 3145728, 32768, 8, 50348032, 131072, 0, 0, 218105882, 0
    .long 2, 64, 72, 7168, 768, 768, 7340032, 3145728, 32768, 8, 65548288, 114688, 0, 0, 218104193, 0
    .long 1, 16, 16, 8192, 0, 256, 8388608, 3145728, 32768, 8, 16777216, 131072, 0, 0, 218105866, 0
    .long 2, 64, 72, 7168, 1536, 1536, 7340032, 1048576, 32768, 8, 58220544, 114688, 0, 0, 218103937, 0
    .long 2, 64, 72, 7168, 0, 0, 7340032, 3145728, 32768, 8, 65536000, 114688, 0, 0, 218104193, 0
    .long 2, 64, 72, 7168, 768, 768, 7340032, 2621440, 32768, 8, 63713280, 114688, 0, 0, 218104129, 0
    .long 2, 64, 72, 7168, 256, 256, 7340032, 1048576, 32768, 8, 58200064, 114688, 0, 0, 218103937, 0
    .long 2, 64, 72, 7168, 1024, 1024, 7340032, 3145728, 32768, 8, 65552384, 114688, 0, 0, 218104193, 0
    .long 1, 16, 16, 8192, 1024, 1280, 8388608, 2621440, 32768, 8, 14696448, 131072, 0, 0, 218105626, 0
    .long 1, 32, 32, 8192, 0, 256, 8388608, 2621440, 32768, 8, 48234496, 131072, 0, 0, 218105610, 0
    .long 1, 16, 16, 8192, 0, 256, 8388608, 2621440, 32768, 8, 14680064, 131072, 0, 0, 218105610, 0
    .long 5, 218108160, 0, 0, 0, 0, 0, 8, 0, 0, 0, 0, 218112000, 12, 218106945, 0
    .long 2, 64, 72, 7168, 256, 256, 7340032, 524288, 32768, 8, 56365056, 114688, 0, 0, 218103873, 0
    .long 2, 64, 72, 7168, 1024, 1024, 7340032, 0, 32768, 8, 54542336, 114688, 0, 0, 218103809, 0
    .long 1, 24, 24, 8192, 0, 256, 8388608, 3145728, 32768, 8, 33554432, 131072, 0, 0, 218105866, 0
    .long 2, 64, 72, 7168, 1536, 1536, 7340032, 0, 32768, 8, 54550528, 114688, 0, 0, 218103809, 0
    .long 5, 218107904, 0, 0, 0, 0, 0, 0, 0, 0, 0, 0, 218112000, 4, 218106881, 0
    .long 1, 32, 32, 8192, 512, 768, 8388608, 3145728, 32768, 8, 50339840, 131072, 0, 0, 218105866, 0
    .long 5, 218108176, 0, 0, 4, 0, 0, 8, 0, 0, 0, 0, 218112000, 12, 218106945, 0
    .long 1, 24, 24, 8192, 1536, 1792, 8388608, 2621440, 32768, 8, 31481856, 131072, 0, 0, 218105626, 0
    .long 1, 32, 32, 8192, 1024, 1280, 8388608, 2621440, 32768, 8, 48250880, 131072, 0, 0, 218105626, 0
    .long 2, 64, 72, 7168, 768, 768, 7340032, 1048576, 32768, 8, 58208256, 114688, 0, 0, 218103937, 0
    .long 2, 64, 72, 7168, 768, 768, 7340032, 524288, 32768, 8, 56373248, 114688, 0, 0, 218103873, 0
    .long 2, 64, 72, 7168, 512, 512, 7340032, 524288, 32768, 8, 56369152, 114688, 0, 0, 218103873, 0
    .long 2, 64, 72, 7168, 1024, 1024, 7340032, 1048576, 32768, 8, 58212352, 114688, 0, 0, 218103937, 0
    .long 1, 32, 32, 8192, 512, 768, 8388608, 2621440, 32768, 8, 48242688, 131072, 0, 0, 218105610, 0
    .long 2, 64, 72, 7168, 512, 512, 7340032, 1048576, 32768, 8, 58204160, 114688, 0, 0, 218103937, 0
    .long 1, 16, 16, 8192, 1024, 1280, 8388608, 3670016, 32768, 8, 18890752, 131072, 0, 0, 218106138, 0
    .long 2, 64, 72, 7168, 1024, 1024, 7340032, 524288, 32768, 8, 56377344, 114688, 0, 0, 218103873, 0
    .long 1, 16, 16, 8192, 1024, 1280, 8388608, 3145728, 32768, 8, 16793600, 131072, 0, 0, 218105882, 0
    .long 5, 218107920, 0, 0, 4, 0, 0, 0, 0, 0, 0, 0, 218112000, 4, 218106881, 0
    .long 5, 218107920, 0, 0, 4, 0, 0, 4, 0, 0, 0, 0, 218112000, 8, 218106881, 0
    .long 5, 218108176, 0, 0, 4, 0, 0, 12, 0, 0, 0, 0, 218112000, 16, 218106945, 0
    .long 5, 218108160, 0, 0, 0, 0, 0, 12, 0, 0, 0, 0, 218112000, 16, 218106945, 0
    .long 5, 218107904, 0, 0, 0, 0, 0, 4, 0, 0, 0, 0, 218112000, 8, 218106881, 0
    .long 1, 32, 32, 8192, 0, 256, 8388608, 3145728, 32768, 8, 50331648, 131072, 0, 0, 218105866, 0
    .long 2, 64, 72, 7168, 512, 512, 7340032, 1572864, 32768, 8, 60039168, 114688, 0, 0, 218104001, 0
    .long 2, 64, 72, 7168, 0, 0, 7340032, 1572864, 32768, 8, 60030976, 114688, 0, 0, 218104001, 0
    .long 2, 64, 72, 7168, 256, 256, 7340032, 0, 32768, 8, 54530048, 114688, 0, 0, 218103809, 0
    .long 1, 24, 24, 8192, 1536, 1792, 8388608, 3145728, 32768, 8, 33579008, 131072, 0, 0, 218105882, 0
    .long 2, 64, 72, 7168, 1536, 1536, 7340032, 3145728, 32768, 8, 65560576, 114688, 0, 0, 218104193, 0
    .long 2, 64, 72, 7168, 0, 0, 7340032, 2621440, 32768, 8, 63700992, 114688, 0, 0, 218104129, 0
    .long 2, 64, 72, 7168, 512, 512, 7340032, 0, 32768, 8, 54534144, 114688, 0, 0, 218103809, 0
    .long 2, 64, 72, 7168, 1024, 1024, 7340032, 2097152, 32768, 8, 61882368, 114688, 0, 0, 218104065, 0
    .long 2, 64, 72, 7168, 1536, 1536, 7340032, 524288, 32768, 8, 56385536, 114688, 0, 0, 218103873, 0
    .long 2, 64, 72, 7168, 256, 256, 7340032, 2097152, 32768, 8, 61870080, 114688, 0, 0, 218104065, 0
    .long 2, 64, 72, 7168, 1536, 1536, 7340032, 1572864, 32768, 8, 60055552, 114688, 0, 0, 218104001, 0
    .long 2, 64, 72, 7168, 0, 0, 7340032, 0, 32768, 8, 54525952, 114688, 0, 0, 218103809, 0
    .long 2, 64, 72, 7168, 1024, 1024, 7340032, 3670016, 32768, 8, 67387392, 114688, 0, 0, 218104257, 0
    .long 2, 64, 72, 7168, 0, 0, 7340032, 524288, 32768, 8, 56360960, 114688, 0, 0, 218103873, 0
    .long 2, 64, 72, 7168, 1280, 1280, 7340032, 524288, 32768, 8, 56381440, 114688, 0, 0, 218103873, 0
    .long 2, 64, 72, 7168, 1536, 1536, 7340032, 2097152, 32768, 8, 61890560, 114688, 0, 0, 218104065, 0
    .long 1, 24, 24, 8192, 1536, 1792, 8388608, 3670016, 32768, 8, 35676160, 131072, 0, 0, 218106138, 0
    .long 2, 64, 72, 7168, 512, 512, 7340032, 2621440, 32768, 8, 63709184, 114688, 0, 0, 218104129, 0
    .long 2, 64, 72, 7168, 1024, 1024, 7340032, 1572864, 32768, 8, 60047360, 114688, 0, 0, 218104001, 0
    .long 2, 64, 72, 7168, 0, 0, 7340032, 2097152, 32768, 8, 61865984, 114688, 0, 0, 218104065, 0
    .long 2, 64, 72, 7168, 1280, 1280, 7340032, 3145728, 32768, 8, 65556480, 114688, 0, 0, 218104193, 0
    .long 2, 64, 72, 7168, 256, 256, 7340032, 1572864, 32768, 8, 60035072, 114688, 0, 0, 218104001, 0
    .long 2, 64, 72, 7168, 256, 256, 7340032, 2621440, 32768, 8, 63705088, 114688, 0, 0, 218104129, 0
    .long 1, 24, 24, 8192, 0, 256, 8388608, 3670016, 32768, 8, 35651584, 131072, 0, 0, 218106122, 0
    .long 2, 64, 72, 7168, 1536, 1536, 7340032, 2621440, 32768, 8, 63725568, 114688, 0, 0, 218104129, 0
    .long 2, 64, 72, 7168, 1024, 1024, 7340032, 2621440, 32768, 8, 63717376, 114688, 0, 0, 218104129, 0
    .long 2, 64, 72, 7168, 1280, 1280, 7340032, 3670016, 32768, 8, 67391488, 114688, 0, 0, 218104257, 0
    .long 2, 64, 72, 7168, 1280, 1280, 7340032, 1572864, 32768, 8, 60051456, 114688, 0, 0, 218104001, 0
    .long 1, 40, 40, 2048, 512, 768, 8388608, 180355072, 131072, 16, 76554240, 32768, 218112000, 25, 218106504, 0
    .long 1, 80, 80, 2048, 0, 256, 7340032, 58195968, 114688, 14, 118489088, 32768, 218103936, 14, 218106498, 0
    .long 1, 24, 24, 8192, 1024, 1280, 8388608, 3670016, 32768, 8, 35667968, 131072, 0, 0, 218106138, 0
    .long 1, 40, 40, 2048, 0, 256, 8388608, 180355072, 131072, 16, 76546048, 32768, 218112000, 25, 218106504, 0
    .long 1, 40, 40, 2048, 0, 256, 8388608, 178257920, 131072, 16, 76021760, 32768, 218106944, 8, 218106440, 0
    .long 2, 64, 72, 7168, 512, 512, 7340032, 3145728, 32768, 8, 65544192, 114688, 0, 0, 218104193, 0
    .long 1, 40, 40, 2048, 512, 768, 8388608, 178257920, 131072, 16, 76029952, 32768, 218106944, 8, 218106440, 0
    .long 1, 80, 80, 2048, 512, 768, 7340032, 58195968, 114688, 14, 118497280, 32768, 218103936, 14, 218106498, 0
    .long 2, 64, 72, 7168, 256, 256, 7340032, 3145728, 32768, 8, 65540096, 114688, 0, 0, 218104193, 0
    .long 1, 32, 32, 8192, 512, 768, 8388608, 3670016, 32768, 8, 52436992, 131072, 0, 0, 218106122, 0
    .long 1, 16, 16, 8192, 512, 768, 8388608, 3670016, 32768, 8, 18882560, 131072, 0, 0, 218106122, 0
    .long 1, 40, 40, 2048, 512, 768, 8388608, 176160768, 131072, 16, 75505664, 32768, 218106880, 8, 218106376, 0
    .long 1, 40, 40, 2048, 0, 256, 8388608, 176160768, 131072, 16, 75497472, 32768, 218106880, 8, 218106376, 0
    .long 1, 32, 32, 8192, 0, 256, 8388608, 3670016, 32768, 8, 52428800, 131072, 0, 0, 218106122, 0
    .long 1, 24, 24, 8192, 512, 768, 8388608, 3670016, 32768, 8, 35659776, 131072, 0, 0, 218106122, 0
    .long 1, 16, 16, 8192, 0, 256, 8388608, 3670016, 32768, 8, 18874368, 131072, 0, 0, 218106122, 0
    .long 1, 32, 32, 8192, 1024, 1280, 8388608, 3670016, 32768, 8, 52445184, 131072, 0, 0, 218106138, 0
    .long 1, 32, 32, 8192, 1536, 1792, 8388608, 3670016, 32768, 8, 52453376, 131072, 0, 0, 218106138, 0
    .long 2, 64, 72, 7168, 512, 512, 7340032, 3670016, 32768, 8, 67379200, 114688, 0, 0, 218104257, 0
    .long 2, 64, 72, 7168, 0, 0, 7340032, 3670016, 32768, 8, 67371008, 114688, 0, 0, 218104257, 0
    .long 1, 16, 16, 8192, 1536, 1792, 8388608, 3670016, 32768, 8, 18898944, 131072, 0, 0, 218106138, 0
    .long 2, 64, 72, 7168, 1536, 1536, 7340032, 3670016, 32768, 8, 67395584, 114688, 0, 0, 218104257, 0
    .long 1, 80, 80, 2048, 512, 768, 7340032, 56360960, 114688, 14, 117972992, 32768, 218103872, 14, 218106434, 0
    .long 1, 80, 80, 2048, 0, 256, 7340032, 54525952, 114688, 14, 117440512, 32768, 218103808, 14, 218106370, 0
    .long 1, 80, 80, 2048, 0, 256, 7340032, 61865984, 114688, 14, 119537664, 32768, 218104064, 14, 218106626, 0
    .long 1, 80, 80, 2048, 0, 256, 7340032, 56360960, 114688, 14, 117964800, 32768, 218103872, 14, 218106434, 0
    .long 2, 64, 72, 7168, 256, 256, 7340032, 3670016, 32768, 8, 67375104, 114688, 0, 0, 218104257, 0
    .long 1, 40, 40, 2048, 0, 256, 8388608, 182452224, 131072, 16, 77070336, 32768, 218112000, 33, 218106568, 0
    .long 1, 40, 40, 2048, 512, 768, 8388608, 182452224, 131072, 16, 77078528, 32768, 218112000, 33, 218106568, 0
    .long 1, 80, 80, 2048, 512, 768, 7340032, 61865984, 114688, 14, 119545856, 32768, 218104064, 14, 218106626, 0
    .long 1, 80, 80, 2048, 512, 768, 7340032, 54525952, 114688, 14, 117448704, 32768, 218103808, 14, 218106370, 0
    .long 1, 80, 80, 2048, 512, 768, 7340032, 60030976, 114688, 14, 119021568, 32768, 218104000, 14, 218106562, 0
    .long 1, 80, 80, 2048, 0, 256, 7340032, 60030976, 114688, 14, 119013376, 32768, 218104000, 14, 218106562, 0
    .long 1, 40, 40, 2048, 512, 768, 8388608, 184549376, 131072, 8, 77602816, 32768, 218112000, 41, 218106628, 0
    .long 1, 40, 40, 2048, 0, 256, 8388608, 184549376, 131072, 8, 77594624, 32768, 218112000, 41, 218106628, 0
    .long 1, 40, 40, 2048, 1536, 1792, 8388608, 184549376, 131072, 8, 77619200, 32768, 218112000, 41, 218106628, 0
    .long 1, 40, 40, 2048, 1024, 1280, 8388608, 184549376, 131072, 8, 77611008, 32768, 218112000, 41, 218106628, 0
    .long 1, 80, 80, 2048, 1536, 1792, 7340032, 63700992, 114688, 7, 120086528, 32768, 218104128, 7, 218106689, 0
    .long 1, 80, 80, 2048, 1024, 1280, 7340032, 63700992, 114688, 7, 120078336, 32768, 218104128, 7, 218106689, 0
    .long 1, 80, 80, 2048, 0, 256, 7340032, 63700992, 114688, 7, 120061952, 32768, 218104128, 7, 218106689, 0
    .long 1, 80, 80, 2048, 512, 768, 7340032, 63700992, 114688, 7, 120070144, 32768, 218104128, 7, 218106689, 0
    .long 1, 80, 80, 2048, 512, 768, 7340032, 65536000, 114688, 7, 120594432, 32768, 218104192, 7, 218106753, 0
    .long 1, 80, 80, 2048, 0, 256, 7340032, 65536000, 114688, 7, 120586240, 32768, 218104192, 7, 218106753, 0
    .long 1, 80, 80, 2048, 1536, 1792, 7340032, 65536000, 114688, 7, 120610816, 32768, 218104192, 7, 218106753, 0
    .long 1, 40, 40, 2048, 512, 768, 8388608, 186646528, 131072, 8, 78127104, 32768, 218112000, 49, 218106692, 0
    .long 1, 80, 80, 2048, 1024, 1280, 7340032, 65536000, 114688, 7, 120602624, 32768, 218104192, 7, 218106753, 0
    .long 1, 40, 40, 2048, 1024, 1280, 8388608, 186646528, 131072, 8, 78135296, 32768, 218112000, 49, 218106692, 0
    .long 1, 40, 40, 2048, 1536, 1792, 8388608, 186646528, 131072, 8, 78143488, 32768, 218112000, 49, 218106692, 0
    .long 1, 40, 40, 2048, 0, 256, 8388608, 186646528, 131072, 8, 78118912, 32768, 218112000, 49, 218106692, 0
    .long 1, 80, 80, 2048, 1536, 1792, 7340032, 67371008, 114688, 7, 121135104, 32768, 218104256, 7, 218106817, 0
    .long 1, 80, 80, 2048, 512, 768, 7340032, 67371008, 114688, 7, 121118720, 32768, 218104256, 7, 218106817, 0
    .long 1, 80, 80, 2048, 1024, 1280, 7340032, 67371008, 114688, 7, 121126912, 32768, 218104256, 7, 218106817, 0
    .long 1, 80, 80, 2048, 0, 256, 7340032, 67371008, 114688, 7, 121110528, 32768, 218104256, 7, 218106817, 0
    .long 6, 1, 0, 2, 0, 16, 0, 23, 0, 0, 0, 0, 0, 0, 0, 0
    .long 6, 1, 0, 2, 0, 16, 0, 17, 0, 0, 0, 0, 0, 0, 0, 0
    .long 6, 1, 0, 2, 0, 16, 0, 20, 0, 0, 0, 0, 0, 0, 0, 0
    .long 6, 1, 0, 2, 0, 16, 0, 10, 0, 0, 0, 0, 0, 0, 0, 0
    .long 6, 1, 0, 2, 0, 16, 0, 6, 0, 0, 0, 0, 0, 0, 0, 0
    .long 6, 1, 0, 2, 0, 16, 0, 13, 0, 0, 0, 0, 0, 0, 0, 0
    .long 6, 1, 0, 1, 0, 16, 0, 38, 0, 0, 0, 0, 0, 0, 0, 0
    .long 6, 1, 0, 2, 0, 16, 0, 18, 0, 0, 0, 0, 0, 0, 0, 0
    .long 6, 1, 0, 2, 0, 16, 0, 9, 0, 0, 0, 0, 0, 0, 0, 0
    .long 6, 1, 0, 2, 0, 16, 0, 2, 0, 0, 0, 0, 0, 0, 0, 0
    .long 6, 1, 0, 2, 0, 16, 0, 5, 0, 0, 0, 0, 0, 0, 0, 0
    .long 6, 1, 0, 1, 0, 16, 0, 34, 0, 0, 0, 0, 0, 0, 0, 0
    .long 6, 1, 0, 2, 0, 16, 0, 7, 0, 0, 0, 0, 0, 0, 0, 0
    .long 6, 1, 0, 2, 0, 16, 0, 1, 0, 0, 0, 0, 0, 0, 0, 0
    .long 6, 1, 0, 2, 0, 16, 0, 12, 0, 0, 0, 0, 0, 0, 0, 0
    .long 6, 1, 0, 2, 0, 16, 0, 14, 0, 0, 0, 0, 0, 0, 0, 0
    .long 6, 1, 0, 2, 0, 16, 0, 0, 0, 0, 0, 0, 0, 0, 0, 0
    .long 6, 1, 0, 2, 0, 16, 0, 3, 0, 0, 0, 0, 0, 0, 0, 0
    .long 6, 1, 0, 2, 0, 16, 0, 22, 0, 0, 0, 0, 0, 0, 0, 0
    .long 6, 1, 0, 2, 0, 16, 0, 21, 0, 0, 0, 0, 0, 0, 0, 0
    .long 6, 1, 0, 2, 0, 16, 0, 8, 0, 0, 0, 0, 0, 0, 0, 0
    .long 6, 1, 0, 2, 0, 16, 0, 15, 0, 0, 0, 0, 0, 0, 0, 0
    .long 6, 1, 0, 2, 0, 16, 0, 19, 0, 0, 0, 0, 0, 0, 0, 0
    .long 6, 1, 0, 2, 0, 16, 0, 11, 0, 0, 0, 0, 0, 0, 0, 0
    .long 6, 1, 0, 2, 0, 16, 0, 16, 0, 0, 0, 0, 0, 0, 0, 0
    .long 6, 1, 0, 2, 0, 16, 0, 4, 0, 0, 0, 0, 0, 0, 0, 0
    .long 6, 0, 0, 0, 0, 0, 0, 54, 0, 0, 0, 0, 0, 0, 0, 0
    .long 6, 0, 0, 0, 0, 0, 0, 51, 0, 0, 0, 0, 0, 0, 0, 0
    .long 6, 0, 0, 0, 0, 0, 0, 48, 0, 0, 0, 0, 0, 0, 0, 0
    .long 6, 0, 0, 0, 0, 0, 0, 49, 0, 0, 0, 0, 0, 0, 0, 0
    .long 6, 0, 0, 0, 0, 0, 0, 50, 0, 0, 0, 0, 0, 0, 0, 0
    .long 6, 0, 0, 0, 0, 0, 0, 52, 0, 0, 0, 0, 0, 0, 0, 0
    .long 6, 0, 0, 0, 0, 0, 0, 53, 0, 0, 0, 0, 0, 0, 0, 0
    .long 6, 0, 0, 0, 0, 0, 0, 55, 0, 0, 0, 0, 0, 0, 0, 0
    .long 6, 1, 0, 1, 0, 16, 0, 32, 0, 0, 0, 0, 0, 0, 0, 0
    .long 6, 1, 0, 1, 0, 16, 0, 33, 0, 0, 0, 0, 0, 0, 0, 0
    .long 6, 1, 0, 1, 0, 16, 0, 35, 0, 0, 0, 0, 0, 0, 0, 0
    .long 6, 1, 0, 1, 0, 16, 0, 36, 0, 0, 0, 0, 0, 0, 0, 0
    .long 6, 1, 0, 1, 0, 16, 0, 37, 0, 0, 0, 0, 0, 0, 0, 0
    .long 6, 1, 0, 1, 0, 16, 0, 39, 0, 0, 0, 0, 0, 0, 0, 0
    .long 6, 1, 0, 2, 0, 16, 0, 24, 0, 0, 0, 0, 0, 0, 0, 0
    .long 6, 1, 0, 2, 0, 16, 0, 26, 0, 0, 0, 0, 0, 0, 0, 0
    .long 6, 1, 0, 2, 0, 16, 0, 27, 0, 0, 0, 0, 0, 0, 0, 0
    .long 6, 1, 0, 2, 0, 16, 0, 28, 0, 0, 0, 0, 0, 0, 0, 0
    .long 6, 1, 0, 2, 0, 16, 0, 29, 0, 0, 0, 0, 0, 0, 0, 0
    .long 6, 1, 0, 2, 0, 16, 0, 30, 0, 0, 0, 0, 0, 0, 0, 0
    .long 6, 1, 0, 2, 0, 16, 0, 31, 0, 0, 0, 0, 0, 0, 0, 0
    .long 6, 1, 0, 2, 0, 16, 0, 25, 0, 0, 0, 0, 0, 0, 0, 0
    .long 6, 0, 0, 1, 0, 16, 0, 40, 0, 0, 0, 0, 0, 0, 0, 0
    .long 6, 0, 0, 1, 0, 16, 0, 41, 0, 0, 0, 0, 0, 0, 0, 0
    .long 6, 0, 0, 1, 0, 16, 0, 42, 0, 0, 0, 0, 0, 0, 0, 0
    .long 6, 0, 0, 1, 0, 16, 0, 43, 0, 0, 0, 0, 0, 0, 0, 0
    .long 6, 0, 0, 1, 0, 16, 0, 44, 0, 0, 0, 0, 0, 0, 0, 0
    .long 6, 0, 0, 1, 0, 16, 0, 47, 0, 0, 0, 0, 0, 0, 0, 0
    .long 6, 0, 0, 1, 0, 16, 0, 46, 0, 0, 0, 0, 0, 0, 0, 0
    .long 6, 0, 0, 1, 0, 16, 0, 45, 0, 0, 0, 0, 0, 0, 0, 0
    .long 6, 0, 0, 0, 0, 0, 0, 56, 0, 0, 0, 0, 0, 0, 0, 0
    .long 6, 0, 0, 0, 0, 0, 0, 57, 0, 0, 0, 0, 0, 0, 0, 0
    .long 6, 0, 0, 0, 0, 0, 0, 58, 0, 0, 0, 0, 0, 0, 0, 0
    .long 6, 0, 0, 0, 0, 0, 0, 59, 0, 0, 0, 0, 0, 0, 0, 0
    .long 6, 0, 0, 0, 0, 0, 0, 60, 0, 0, 0, 0, 0, 0, 0, 0
    .long 7, 0, 0, 0, 0, 0, 0, 61, 0, 0, 0, 0, 0, 0, 0, 0
    .long 7, 0, 0, 0, 1, 0, 0, 61, 0, 0, 0, 0, 0, 0, 0, 0
    .long 7, 0, 0, 0, 2, 0, 0, 61, 0, 0, 0, 0, 0, 0, 0, 0
    .long 7, 0, 0, 0, 3, 0, 0, 61, 0, 0, 0, 0, 0, 0, 0, 0
    .long 7, 0, 0, 0, 0, 0, 0, 62, 0, 0, 0, 0, 0, 0, 0, 0
    .long 7, 0, 0, 0, 1, 0, 0, 62, 0, 0, 0, 0, 0, 0, 0, 0
    .long 7, 0, 0, 0, 2, 0, 0, 62, 0, 0, 0, 0, 0, 0, 0, 0
    .long 7, 0, 0, 0, 3, 0, 0, 62, 0, 0, 0, 0, 0, 0, 0, 0
    .long 7, 0, 0, 0, 0, 0, 0, 63, 0, 0, 0, 0, 0, 0, 0, 0
    .long 7, 0, 0, 0, 1, 0, 0, 63, 0, 0, 0, 0, 0, 0, 0, 0
    .long 7, 0, 0, 0, 2, 0, 0, 63, 0, 0, 0, 0, 0, 0, 0, 0
    .long 7, 0, 0, 0, 3, 0, 0, 63, 0, 0, 0, 0, 0, 0, 0, 0
    .long 0, 0, 0, 0, 0, 0, 0, 0, 0, 0, 0, 0, 0, 0, 0, 0
    .long 4, 24, 24, 8192, 2048, 264192, 8388608, 0, 32768, 4, 21004288, 131072, 0, 0, 218104353, 0
    .long 4, 24, 24, 8192, 2304, 264448, 8388608, 0, 32768, 4, 21008384, 131072, 0, 0, 218104353, 0
    .long 4, 24, 24, 8192, 2560, 264704, 8388608, 0, 32768, 4, 21012480, 131072, 0, 0, 218104353, 0
    .long 4, 24, 24, 8192, 2816, 264960, 8388608, 0, 32768, 4, 21016576, 131072, 0, 0, 218104353, 0
    .long 4, 24, 24, 8192, 3072, 265216, 8388608, 0, 32768, 4, 21020672, 131072, 0, 0, 218104369, 0
    .long 4, 24, 24, 8192, 3328, 265472, 8388608, 0, 32768, 4, 21024768, 131072, 0, 0, 218104369, 0
    .long 4, 24, 24, 8192, 3584, 265728, 8388608, 0, 32768, 4, 21028864, 131072, 0, 0, 218104369, 0
    .long 4, 24, 24, 8192, 3840, 265984, 8388608, 0, 32768, 4, 21032960, 131072, 0, 0, 218104369, 0
    .long 4, 32, 32, 8192, 2048, 264192, 8388608, 0, 32768, 4, 37781504, 131072, 0, 0, 218104353, 0
    .long 4, 32, 32, 8192, 2304, 264448, 8388608, 0, 32768, 4, 37785600, 131072, 0, 0, 218104353, 0
    .long 4, 32, 32, 8192, 2560, 264704, 8388608, 0, 32768, 4, 37789696, 131072, 0, 0, 218104353, 0
    .long 4, 32, 32, 8192, 2816, 264960, 8388608, 0, 32768, 4, 37793792, 131072, 0, 0, 218104353, 0
    .long 4, 32, 32, 8192, 3072, 265216, 8388608, 0, 32768, 4, 37797888, 131072, 0, 0, 218104369, 0
    .long 4, 32, 32, 8192, 3328, 265472, 8388608, 0, 32768, 4, 37801984, 131072, 0, 0, 218104369, 0
    .long 4, 32, 32, 8192, 3584, 265728, 8388608, 0, 32768, 4, 37806080, 131072, 0, 0, 218104369, 0
    .long 4, 32, 32, 8192, 3840, 265984, 8388608, 0, 32768, 4, 37810176, 131072, 0, 0, 218104369, 0
    .long 4, 24, 24, 8192, 2048, 264192, 8388608, 262144, 32768, 4, 22052864, 131072, 0, 0, 218104356, 0
    .long 4, 24, 24, 8192, 2304, 264448, 8388608, 262144, 32768, 4, 22056960, 131072, 0, 0, 218104356, 0
    .long 4, 24, 24, 8192, 2560, 264704, 8388608, 262144, 32768, 4, 22061056, 131072, 0, 0, 218104356, 0
    .long 4, 24, 24, 8192, 2816, 264960, 8388608, 262144, 32768, 4, 22065152, 131072, 0, 0, 218104356, 0
    .long 4, 24, 24, 8192, 3072, 265216, 8388608, 262144, 32768, 4, 22069248, 131072, 0, 0, 218104372, 0
    .long 4, 24, 24, 8192, 3328, 265472, 8388608, 262144, 32768, 4, 22073344, 131072, 0, 0, 218104372, 0
    .long 4, 24, 24, 8192, 3584, 265728, 8388608, 262144, 32768, 4, 22077440, 131072, 0, 0, 218104372, 0
    .long 4, 24, 24, 8192, 3840, 265984, 8388608, 262144, 32768, 4, 22081536, 131072, 0, 0, 218104372, 0
    .long 4, 32, 32, 8192, 2048, 264192, 8388608, 262144, 32768, 4, 38830080, 131072, 0, 0, 218104356, 0
    .long 4, 32, 32, 8192, 2304, 264448, 8388608, 262144, 32768, 4, 38834176, 131072, 0, 0, 218104356, 0
    .long 4, 32, 32, 8192, 2560, 264704, 8388608, 262144, 32768, 4, 38838272, 131072, 0, 0, 218104356, 0
    .long 4, 32, 32, 8192, 2816, 264960, 8388608, 262144, 32768, 4, 38842368, 131072, 0, 0, 218104356, 0
    .long 4, 32, 32, 8192, 3072, 265216, 8388608, 262144, 32768, 4, 38846464, 131072, 0, 0, 218104372, 0
    .long 4, 32, 32, 8192, 3328, 265472, 8388608, 262144, 32768, 4, 38850560, 131072, 0, 0, 218104372, 0
    .long 4, 32, 32, 8192, 3584, 265728, 8388608, 262144, 32768, 4, 38854656, 131072, 0, 0, 218104372, 0
    .long 4, 32, 32, 8192, 3840, 265984, 8388608, 262144, 32768, 4, 38858752, 131072, 0, 0, 218104372, 0
    .long 4, 32, 32, 8192, 2560, 264704, 8388608, 786432, 32768, 4, 40935424, 131072, 0, 0, 218104612, 0
    .long 4, 32, 32, 8192, 3584, 265728, 8388608, 786432, 32768, 4, 40951808, 131072, 0, 0, 218104628, 0
    .long 4, 32, 32, 8192, 3840, 265984, 8388608, 524288, 32768, 4, 39907328, 131072, 0, 0, 218104625, 0
    .long 4, 24, 24, 8192, 2560, 264704, 8388608, 786432, 32768, 4, 24158208, 131072, 0, 0, 218104612, 0
    .long 4, 32, 32, 8192, 2560, 264704, 8388608, 524288, 32768, 4, 39886848, 131072, 0, 0, 218104609, 0
    .long 4, 32, 32, 8192, 3840, 265984, 8388608, 786432, 32768, 4, 40955904, 131072, 0, 0, 218104628, 0
    .long 4, 24, 24, 8192, 3584, 265728, 8388608, 786432, 32768, 4, 24174592, 131072, 0, 0, 218104628, 0
    .long 4, 24, 24, 8192, 2304, 264448, 8388608, 524288, 32768, 4, 23105536, 131072, 0, 0, 218104609, 0
    .long 4, 24, 24, 8192, 2816, 264960, 8388608, 524288, 32768, 4, 23113728, 131072, 0, 0, 218104609, 0
    .long 4, 24, 24, 8192, 3328, 265472, 8388608, 524288, 32768, 4, 23121920, 131072, 0, 0, 218104625, 0
    .long 4, 24, 24, 8192, 2816, 264960, 8388608, 786432, 32768, 4, 24162304, 131072, 0, 0, 218104612, 0
    .long 4, 32, 32, 8192, 2304, 264448, 8388608, 524288, 32768, 4, 39882752, 131072, 0, 0, 218104609, 0
    .long 4, 32, 32, 8192, 3072, 265216, 8388608, 524288, 32768, 4, 39895040, 131072, 0, 0, 218104625, 0
    .long 4, 24, 24, 8192, 3584, 265728, 8388608, 524288, 32768, 4, 23126016, 131072, 0, 0, 218104625, 0
    .long 4, 32, 32, 8192, 2816, 264960, 8388608, 524288, 32768, 4, 39890944, 131072, 0, 0, 218104609, 0
    .long 4, 24, 24, 8192, 2048, 264192, 8388608, 524288, 32768, 4, 23101440, 131072, 0, 0, 218104609, 0
    .long 4, 32, 32, 8192, 3072, 265216, 8388608, 786432, 32768, 4, 40943616, 131072, 0, 0, 218104628, 0
    .long 4, 24, 24, 8192, 3840, 265984, 8388608, 786432, 32768, 4, 24178688, 131072, 0, 0, 218104628, 0
    .long 4, 32, 32, 8192, 2048, 264192, 8388608, 524288, 32768, 4, 39878656, 131072, 0, 0, 218104609, 0
    .long 4, 24, 24, 8192, 3328, 265472, 8388608, 786432, 32768, 4, 24170496, 131072, 0, 0, 218104628, 0
    .long 4, 32, 32, 8192, 2304, 264448, 8388608, 786432, 32768, 4, 40931328, 131072, 0, 0, 218104612, 0
    .long 4, 24, 24, 8192, 3072, 265216, 8388608, 786432, 32768, 4, 24166400, 131072, 0, 0, 218104628, 0
    .long 4, 24, 24, 8192, 2560, 264704, 8388608, 524288, 32768, 4, 23109632, 131072, 0, 0, 218104609, 0
    .long 4, 24, 24, 8192, 2304, 264448, 8388608, 786432, 32768, 4, 24154112, 131072, 0, 0, 218104612, 0
    .long 4, 32, 32, 8192, 3328, 265472, 8388608, 786432, 32768, 4, 40947712, 131072, 0, 0, 218104628, 0
    .long 4, 24, 24, 8192, 2048, 264192, 8388608, 786432, 32768, 4, 24150016, 131072, 0, 0, 218104612, 0
    .long 4, 32, 32, 8192, 3584, 265728, 8388608, 524288, 32768, 4, 39903232, 131072, 0, 0, 218104625, 0
    .long 4, 32, 32, 8192, 2816, 264960, 8388608, 786432, 32768, 4, 40939520, 131072, 0, 0, 218104612, 0
    .long 4, 32, 32, 8192, 3328, 265472, 8388608, 524288, 32768, 4, 39899136, 131072, 0, 0, 218104625, 0
    .long 4, 24, 24, 8192, 3072, 265216, 8388608, 524288, 32768, 4, 23117824, 131072, 0, 0, 218104625, 0
    .long 4, 24, 24, 8192, 3840, 265984, 8388608, 524288, 32768, 4, 23130112, 131072, 0, 0, 218104625, 0
    .long 4, 32, 32, 8192, 2048, 264192, 8388608, 786432, 32768, 4, 40927232, 131072, 0, 0, 218104612, 0
    .long 1, 16, 16, 8192, 2048, 2304, 8388608, 1572864, 32768, 8, 10518528, 131072, 0, 0, 218105130, 0
    .long 1, 32, 32, 8192, 2560, 2816, 8388608, 1048576, 32768, 8, 41984000, 131072, 0, 0, 218104874, 0
    .long 1, 32, 32, 8192, 2560, 2816, 8388608, 1572864, 32768, 8, 44081152, 131072, 0, 0, 218105130, 0
    .long 1, 24, 24, 8192, 2560, 2816, 8388608, 1048576, 32768, 8, 25206784, 131072, 0, 0, 218104874, 0
    .long 1, 16, 16, 8192, 3072, 3328, 8388608, 1048576, 32768, 8, 8437760, 131072, 0, 0, 218104890, 0
    .long 1, 16, 16, 8192, 3584, 3840, 8388608, 1048576, 32768, 8, 8445952, 131072, 0, 0, 218104890, 0
    .long 1, 32, 32, 8192, 3584, 3840, 8388608, 1048576, 32768, 8, 42000384, 131072, 0, 0, 218104890, 0
    .long 1, 24, 24, 8192, 3072, 3328, 8388608, 1048576, 32768, 8, 25214976, 131072, 0, 0, 218104890, 0
    .long 1, 24, 24, 8192, 3584, 3840, 8388608, 2097152, 32768, 8, 29417472, 131072, 0, 0, 218105402, 0
    .long 1, 24, 24, 8192, 3584, 3840, 8388608, 1048576, 32768, 8, 25223168, 131072, 0, 0, 218104890, 0
    .long 1, 32, 32, 8192, 3072, 3328, 8388608, 1048576, 32768, 8, 41992192, 131072, 0, 0, 218104890, 0
    .long 1, 24, 24, 8192, 3072, 3328, 8388608, 2097152, 32768, 8, 29409280, 131072, 0, 0, 218105402, 0
    .long 1, 24, 24, 8192, 2048, 2304, 8388608, 1572864, 32768, 8, 27295744, 131072, 0, 0, 218105130, 0
    .long 1, 32, 32, 8192, 2048, 2304, 8388608, 1572864, 32768, 8, 44072960, 131072, 0, 0, 218105130, 0
    .long 1, 24, 24, 8192, 3072, 3328, 8388608, 1572864, 32768, 8, 27312128, 131072, 0, 0, 218105146, 0
    .long 1, 16, 16, 8192, 2048, 2304, 8388608, 1048576, 32768, 8, 8421376, 131072, 0, 0, 218104874, 0
    .long 1, 24, 24, 8192, 2560, 2816, 8388608, 1572864, 32768, 8, 27303936, 131072, 0, 0, 218105130, 0
    .long 1, 16, 16, 8192, 2560, 2816, 8388608, 1572864, 32768, 8, 10526720, 131072, 0, 0, 218105130, 0
    .long 1, 32, 32, 8192, 3072, 3328, 8388608, 1572864, 32768, 8, 44089344, 131072, 0, 0, 218105146, 0
    .long 1, 16, 16, 8192, 3072, 3328, 8388608, 1572864, 32768, 8, 10534912, 131072, 0, 0, 218105146, 0
    .long 1, 32, 32, 8192, 3584, 3840, 8388608, 2097152, 32768, 8, 46194688, 131072, 0, 0, 218105402, 0
    .long 1, 24, 24, 8192, 2048, 2304, 8388608, 1048576, 32768, 8, 25198592, 131072, 0, 0, 218104874, 0
    .long 1, 24, 24, 8192, 2048, 2304, 8388608, 2097152, 32768, 8, 29392896, 131072, 0, 0, 218105386, 0
    .long 1, 16, 16, 8192, 3584, 3840, 8388608, 1572864, 32768, 8, 10543104, 131072, 0, 0, 218105146, 0
    .long 2, 64, 72, 7168, 2560, 2560, 7340032, 1572864, 32768, 8, 60071936, 114688, 0, 0, 218104001, 0
    .long 1, 32, 32, 8192, 2048, 2304, 8388608, 2097152, 32768, 8, 46170112, 131072, 0, 0, 218105386, 0
    .long 1, 32, 32, 8192, 2048, 2304, 8388608, 1048576, 32768, 8, 41975808, 131072, 0, 0, 218104874, 0
    .long 1, 32, 32, 8192, 2560, 2816, 8388608, 2097152, 32768, 8, 46178304, 131072, 0, 0, 218105386, 0
    .long 1, 24, 24, 8192, 3584, 3840, 8388608, 1572864, 32768, 8, 27320320, 131072, 0, 0, 218105146, 0
    .long 1, 32, 32, 8192, 3584, 3840, 8388608, 1572864, 32768, 8, 44097536, 131072, 0, 0, 218105146, 0
    .long 1, 16, 16, 8192, 2560, 2816, 8388608, 1048576, 32768, 8, 8429568, 131072, 0, 0, 218104874, 0
    .long 1, 32, 32, 8192, 3072, 3328, 8388608, 2097152, 32768, 8, 46186496, 131072, 0, 0, 218105402, 0
    .long 1, 16, 16, 8192, 2560, 2816, 8388608, 0, 32768, 8, 4235264, 131072, 0, 0, 218107946, 0
    .long 2, 64, 72, 7168, 2560, 2560, 7340032, 2097152, 32768, 8, 61906944, 114688, 0, 0, 218104065, 0
    .long 1, 16, 16, 8192, 3584, 3840, 8388608, 2097152, 32768, 8, 12640256, 131072, 0, 0, 218105402, 0
    .long 1, 16, 16, 8192, 2560, 2816, 8388608, 524288, 32768, 8, 6332416, 131072, 0, 0, 218108202, 0
    .long 1, 16, 16, 8192, 3584, 3840, 8388608, 3145728, 32768, 8, 16834560, 131072, 0, 0, 218105914, 0
    .long 1, 32, 32, 8192, 3584, 3840, 8388608, 2621440, 32768, 8, 48291840, 131072, 0, 0, 218105658, 0
    .long 1, 16, 16, 8192, 3072, 3328, 8388608, 0, 32768, 8, 4243456, 131072, 0, 0, 218107962, 0
    .long 1, 16, 16, 8192, 2048, 2304, 8388608, 2097152, 32768, 8, 12615680, 131072, 0, 0, 218105386, 0
    .long 1, 16, 16, 8192, 3584, 3840, 8388608, 0, 32768, 8, 4251648, 131072, 0, 0, 218107962, 0
    .long 1, 16, 16, 8192, 2048, 2304, 8388608, 524288, 32768, 8, 6324224, 131072, 0, 0, 218108202, 0
    .long 1, 24, 24, 8192, 3072, 3328, 8388608, 3145728, 32768, 8, 33603584, 131072, 0, 0, 218105914, 0
    .long 1, 24, 24, 8192, 2560, 2816, 8388608, 2621440, 32768, 8, 31498240, 131072, 0, 0, 218105642, 0
    .long 1, 16, 16, 8192, 2560, 2816, 8388608, 2621440, 32768, 8, 14721024, 131072, 0, 0, 218105642, 0
    .long 1, 16, 16, 8192, 3072, 3328, 8388608, 524288, 32768, 8, 6340608, 131072, 0, 0, 218108218, 0
    .long 2, 64, 72, 7168, 3072, 3072, 7340032, 0, 32768, 8, 54575104, 114688, 0, 0, 218103809, 0
    .long 2, 64, 72, 7168, 2560, 2560, 7340032, 0, 32768, 8, 54566912, 114688, 0, 0, 218103809, 0
    .long 2, 64, 72, 7168, 3072, 3072, 7340032, 1048576, 32768, 8, 58245120, 114688, 0, 0, 218103937, 0
    .long 1, 16, 16, 8192, 2048, 2304, 8388608, 0, 32768, 8, 4227072, 131072, 0, 0, 218107946, 0
    .long 1, 16, 16, 8192, 3584, 3840, 8388608, 524288, 32768, 8, 6348800, 131072, 0, 0, 218108218, 0
    .long 1, 24, 24, 8192, 3072, 3328, 8388608, 2621440, 32768, 8, 31506432, 131072, 0, 0, 218105658, 0
    .long 1, 16, 16, 8192, 3584, 3840, 8388608, 2621440, 32768, 8, 14737408, 131072, 0, 0, 218105658, 0
    .long 1, 24, 24, 8192, 2560, 2816, 8388608, 2097152, 32768, 8, 29401088, 131072, 0, 0, 218105386, 0
    .long 2, 64, 72, 7168, 3072, 3072, 7340032, 2097152, 32768, 8, 61915136, 114688, 0, 0, 218104065, 0
    .long 1, 16, 16, 8192, 2560, 2816, 8388608, 3145728, 32768, 8, 16818176, 131072, 0, 0, 218105898, 0
    .long 1, 16, 16, 8192, 2560, 2816, 8388608, 2097152, 32768, 8, 12623872, 131072, 0, 0, 218105386, 0
    .long 2, 64, 72, 7168, 2560, 2560, 7340032, 3670016, 32768, 8, 67411968, 114688, 0, 0, 218104260, 0
    .long 1, 24, 24, 8192, 2560, 2816, 8388608, 3145728, 32768, 8, 33595392, 131072, 0, 0, 218105898, 0
    .long 2, 64, 72, 7168, 2304, 2304, 7340032, 2097152, 32768, 8, 61902848, 114688, 0, 0, 218104065, 0
    .long 1, 16, 16, 8192, 3072, 3328, 8388608, 2097152, 32768, 8, 12632064, 131072, 0, 0, 218105402, 0
    .long 2, 64, 72, 7168, 3072, 3072, 7340032, 2621440, 32768, 8, 63750144, 114688, 0, 0, 218104132, 0
    .long 1, 32, 32, 8192, 3584, 3840, 8388608, 3145728, 32768, 8, 50388992, 131072, 0, 0, 218105914, 0
    .long 1, 24, 24, 8192, 2048, 2304, 8388608, 2621440, 32768, 8, 31490048, 131072, 0, 0, 218105642, 0
    .long 2, 64, 72, 7168, 1792, 1792, 7340032, 1048576, 32768, 8, 58224640, 114688, 0, 0, 218103937, 0
    .long 1, 32, 32, 8192, 3072, 3328, 8388608, 3145728, 32768, 8, 50380800, 131072, 0, 0, 218105914, 0
    .long 2, 64, 72, 7168, 2560, 2560, 7340032, 3145728, 32768, 8, 65576960, 114688, 0, 0, 218104196, 0
    .long 1, 16, 16, 8192, 2048, 2304, 8388608, 3145728, 32768, 8, 16809984, 131072, 0, 0, 218105898, 0
    .long 2, 64, 72, 7168, 3328, 3328, 7340032, 1048576, 32768, 8, 58249216, 114688, 0, 0, 218103937, 0
    .long 2, 64, 72, 7168, 1792, 1792, 7340032, 3145728, 32768, 8, 65564672, 114688, 0, 0, 218104196, 0
    .long 2, 64, 72, 7168, 2560, 2560, 7340032, 2621440, 32768, 8, 63741952, 114688, 0, 0, 218104132, 0
    .long 2, 64, 72, 7168, 2048, 2048, 7340032, 1048576, 32768, 8, 58228736, 114688, 0, 0, 218103937, 0
    .long 2, 64, 72, 7168, 2816, 2816, 7340032, 3145728, 32768, 8, 65581056, 114688, 0, 0, 218104196, 0
    .long 1, 16, 16, 8192, 3072, 3328, 8388608, 2621440, 32768, 8, 14729216, 131072, 0, 0, 218105658, 0
    .long 1, 32, 32, 8192, 2048, 2304, 8388608, 2621440, 32768, 8, 48267264, 131072, 0, 0, 218105642, 0
    .long 1, 16, 16, 8192, 2048, 2304, 8388608, 2621440, 32768, 8, 14712832, 131072, 0, 0, 218105642, 0
    .long 5, 218108192, 0, 0, 8, 0, 0, 8, 0, 0, 0, 0, 218112128, 12, 218106945, 0
    .long 2, 64, 72, 7168, 2048, 2048, 7340032, 524288, 32768, 8, 56393728, 114688, 0, 0, 218103873, 0
    .long 2, 64, 72, 7168, 2816, 2816, 7340032, 0, 32768, 8, 54571008, 114688, 0, 0, 218103809, 0
    .long 1, 24, 24, 8192, 2048, 2304, 8388608, 3145728, 32768, 8, 33587200, 131072, 0, 0, 218105898, 0
    .long 2, 64, 72, 7168, 3328, 3328, 7340032, 0, 32768, 8, 54579200, 114688, 0, 0, 218103809, 0
    .long 5, 218107936, 0, 0, 8, 0, 0, 0, 0, 0, 0, 0, 218112128, 4, 218106881, 0
    .long 1, 32, 32, 8192, 2560, 2816, 8388608, 3145728, 32768, 8, 50372608, 131072, 0, 0, 218105898, 0
    .long 5, 218108208, 0, 0, 12, 0, 0, 8, 0, 0, 0, 0, 218112128, 12, 218106945, 0
    .long 1, 24, 24, 8192, 3584, 3840, 8388608, 2621440, 32768, 8, 31514624, 131072, 0, 0, 218105658, 0
    .long 1, 32, 32, 8192, 3072, 3328, 8388608, 2621440, 32768, 8, 48283648, 131072, 0, 0, 218105658, 0
    .long 2, 64, 72, 7168, 2560, 2560, 7340032, 1048576, 32768, 8, 58236928, 114688, 0, 0, 218103937, 0
    .long 2, 64, 72, 7168, 2560, 2560, 7340032, 524288, 32768, 8, 56401920, 114688, 0, 0, 218103873, 0
    .long 2, 64, 72, 7168, 2304, 2304, 7340032, 524288, 32768, 8, 56397824, 114688, 0, 0, 218103873, 0
    .long 2, 64, 72, 7168, 2816, 2816, 7340032, 1048576, 32768, 8, 58241024, 114688, 0, 0, 218103937, 0
    .long 1, 32, 32, 8192, 2560, 2816, 8388608, 2621440, 32768, 8, 48275456, 131072, 0, 0, 218105642, 0
    .long 2, 64, 72, 7168, 2304, 2304, 7340032, 1048576, 32768, 8, 58232832, 114688, 0, 0, 218103937, 0
    .long 1, 16, 16, 8192, 3072, 3328, 8388608, 3670016, 32768, 8, 18923520, 131072, 0, 0, 218106170, 0
    .long 2, 64, 72, 7168, 2816, 2816, 7340032, 524288, 32768, 8, 56406016, 114688, 0, 0, 218103873, 0
    .long 1, 16, 16, 8192, 3072, 3328, 8388608, 3145728, 32768, 8, 16826368, 131072, 0, 0, 218105914, 0
    .long 5, 218107952, 0, 0, 12, 0, 0, 0, 0, 0, 0, 0, 218112128, 4, 218106881, 0
    .long 5, 218107952, 0, 0, 12, 0, 0, 4, 0, 0, 0, 0, 218112128, 8, 218106881, 0
    .long 5, 218108208, 0, 0, 12, 0, 0, 12, 0, 0, 0, 0, 218112128, 16, 218106945, 0
    .long 5, 218108192, 0, 0, 8, 0, 0, 12, 0, 0, 0, 0, 218112128, 16, 218106945, 0
    .long 5, 218107936, 0, 0, 8, 0, 0, 4, 0, 0, 0, 0, 218112128, 8, 218106881, 0
    .long 1, 32, 32, 8192, 2048, 2304, 8388608, 3145728, 32768, 8, 50364416, 131072, 0, 0, 218105898, 0
    .long 2, 64, 72, 7168, 2304, 2304, 7340032, 1572864, 32768, 8, 60067840, 114688, 0, 0, 218104001, 0
    .long 2, 64, 72, 7168, 1792, 1792, 7340032, 1572864, 32768, 8, 60059648, 114688, 0, 0, 218104001, 0
    .long 2, 64, 72, 7168, 2048, 2048, 7340032, 0, 32768, 8, 54558720, 114688, 0, 0, 218103809, 0
    .long 1, 24, 24, 8192, 3584, 3840, 8388608, 3145728, 32768, 8, 33611776, 131072, 0, 0, 218105914, 0
    .long 2, 64, 72, 7168, 3328, 3328, 7340032, 3145728, 32768, 8, 65589248, 114688, 0, 0, 218104196, 0
    .long 2, 64, 72, 7168, 1792, 1792, 7340032, 2621440, 32768, 8, 63729664, 114688, 0, 0, 218104132, 0
    .long 2, 64, 72, 7168, 2304, 2304, 7340032, 0, 32768, 8, 54562816, 114688, 0, 0, 218103809, 0
    .long 2, 64, 72, 7168, 2816, 2816, 7340032, 2097152, 32768, 8, 61911040, 114688, 0, 0, 218104065, 0
    .long 2, 64, 72, 7168, 3328, 3328, 7340032, 524288, 32768, 8, 56414208, 114688, 0, 0, 218103873, 0
    .long 2, 64, 72, 7168, 2048, 2048, 7340032, 2097152, 32768, 8, 61898752, 114688, 0, 0, 218104065, 0
    .long 2, 64, 72, 7168, 3328, 3328, 7340032, 1572864, 32768, 8, 60084224, 114688, 0, 0, 218104001, 0
    .long 2, 64, 72, 7168, 1792, 1792, 7340032, 0, 32768, 8, 54554624, 114688, 0, 0, 218103809, 0
    .long 2, 64, 72, 7168, 2816, 2816, 7340032, 3670016, 32768, 8, 67416064, 114688, 0, 0, 218104260, 0
    .long 2, 64, 72, 7168, 1792, 1792, 7340032, 524288, 32768, 8, 56389632, 114688, 0, 0, 218103873, 0
    .long 2, 64, 72, 7168, 3072, 3072, 7340032, 524288, 32768, 8, 56410112, 114688, 0, 0, 218103873, 0
    .long 2, 64, 72, 7168, 3328, 3328, 7340032, 2097152, 32768, 8, 61919232, 114688, 0, 0, 218104065, 0
    .long 1, 24, 24, 8192, 3584, 3840, 8388608, 3670016, 32768, 8, 35708928, 131072, 0, 0, 218106170, 0
    .long 2, 64, 72, 7168, 2304, 2304, 7340032, 2621440, 32768, 8, 63737856, 114688, 0, 0, 218104132, 0
    .long 2, 64, 72, 7168, 2816, 2816, 7340032, 1572864, 32768, 8, 60076032, 114688, 0, 0, 218104001, 0
    .long 2, 64, 72, 7168, 1792, 1792, 7340032, 2097152, 32768, 8, 61894656, 114688, 0, 0, 218104065, 0
    .long 2, 64, 72, 7168, 3072, 3072, 7340032, 3145728, 32768, 8, 65585152, 114688, 0, 0, 218104196, 0
    .long 2, 64, 72, 7168, 2048, 2048, 7340032, 1572864, 32768, 8, 60063744, 114688, 0, 0, 218104001, 0
    .long 2, 64, 72, 7168, 2048, 2048, 7340032, 2621440, 32768, 8, 63733760, 114688, 0, 0, 218104132, 0
    .long 1, 24, 24, 8192, 2048, 2304, 8388608, 3670016, 32768, 8, 35684352, 131072, 0, 0, 218106154, 0
    .long 2, 64, 72, 7168, 3328, 3328, 7340032, 2621440, 32768, 8, 63754240, 114688, 0, 0, 218104132, 0
    .long 2, 64, 72, 7168, 2816, 2816, 7340032, 2621440, 32768, 8, 63746048, 114688, 0, 0, 218104132, 0
    .long 2, 64, 72, 7168, 3072, 3072, 7340032, 3670016, 32768, 8, 67420160, 114688, 0, 0, 218104260, 0
    .long 2, 64, 72, 7168, 3072, 3072, 7340032, 1572864, 32768, 8, 60080128, 114688, 0, 0, 218104001, 0
    .long 1, 40, 40, 2048, 1536, 1792, 8388608, 180355072, 131072, 16, 76570624, 32768, 218112128, 25, 218106504, 0
    .long 1, 80, 80, 2048, 1024, 1280, 7340032, 58195968, 114688, 14, 118505472, 32768, 218103936, 14, 218106498, 0
    .long 1, 24, 24, 8192, 3072, 3328, 8388608, 3670016, 32768, 8, 35700736, 131072, 0, 0, 218106170, 0
    .long 1, 40, 40, 2048, 1024, 1280, 8388608, 180355072, 131072, 16, 76562432, 32768, 218112128, 25, 218106504, 0
    .long 1, 40, 40, 2048, 1024, 1280, 8388608, 178257920, 131072, 16, 76038144, 32768, 218106944, 8, 218106440, 0
    .long 2, 64, 72, 7168, 2304, 2304, 7340032, 3145728, 32768, 8, 65572864, 114688, 0, 0, 218104196, 0
    .long 1, 40, 40, 2048, 1536, 1792, 8388608, 178257920, 131072, 16, 76046336, 32768, 218106944, 8, 218106440, 0
    .long 1, 80, 80, 2048, 1536, 1792, 7340032, 58195968, 114688, 14, 118513664, 32768, 218103936, 14, 218106498, 0
    .long 2, 64, 72, 7168, 2048, 2048, 7340032, 3145728, 32768, 8, 65568768, 114688, 0, 0, 218104196, 0
    .long 1, 32, 32, 8192, 2560, 2816, 8388608, 3670016, 32768, 8, 52469760, 131072, 0, 0, 218106154, 0
    .long 1, 16, 16, 8192, 2560, 2816, 8388608, 3670016, 32768, 8, 18915328, 131072, 0, 0, 218106154, 0
    .long 1, 40, 40, 2048, 1536, 1792, 8388608, 176160768, 131072, 16, 75522048, 32768, 218106880, 8, 218106376, 0
    .long 1, 40, 40, 2048, 1024, 1280, 8388608, 176160768, 131072, 16, 75513856, 32768, 218106880, 8, 218106376, 0
    .long 1, 32, 32, 8192, 2048, 2304, 8388608, 3670016, 32768, 8, 52461568, 131072, 0, 0, 218106154, 0
    .long 1, 24, 24, 8192, 2560, 2816, 8388608, 3670016, 32768, 8, 35692544, 131072, 0, 0, 218106154, 0
    .long 1, 16, 16, 8192, 2048, 2304, 8388608, 3670016, 32768, 8, 18907136, 131072, 0, 0, 218106154, 0
    .long 1, 32, 32, 8192, 3072, 3328, 8388608, 3670016, 32768, 8, 52477952, 131072, 0, 0, 218106170, 0
    .long 1, 32, 32, 8192, 3584, 3840, 8388608, 3670016, 32768, 8, 52486144, 131072, 0, 0, 218106170, 0
    .long 2, 64, 72, 7168, 2304, 2304, 7340032, 3670016, 32768, 8, 67407872, 114688, 0, 0, 218104260, 0
    .long 2, 64, 72, 7168, 1792, 1792, 7340032, 3670016, 32768, 8, 67399680, 114688, 0, 0, 218104260, 0
    .long 1, 16, 16, 8192, 3584, 3840, 8388608, 3670016, 32768, 8, 18931712, 131072, 0, 0, 218106170, 0
    .long 2, 64, 72, 7168, 3328, 3328, 7340032, 3670016, 32768, 8, 67424256, 114688, 0, 0, 218104260, 0
    .long 1, 80, 80, 2048, 1536, 1792, 7340032, 56360960, 114688, 14, 117989376, 32768, 218103872, 14, 218106434, 0
    .long 1, 80, 80, 2048, 1024, 1280, 7340032, 54525952, 114688, 14, 117456896, 32768, 218103808, 14, 218106370, 0
    .long 1, 80, 80, 2048, 1024, 1280, 7340032, 61865984, 114688, 14, 119554048, 32768, 218104064, 14, 218106626, 0
    .long 1, 80, 80, 2048, 1024, 1280, 7340032, 56360960, 114688, 14, 117981184, 32768, 218103872, 14, 218106434, 0
    .long 2, 64, 72, 7168, 2048, 2048, 7340032, 3670016, 32768, 8, 67403776, 114688, 0, 0, 218104260, 0
    .long 1, 40, 40, 2048, 1024, 1280, 8388608, 182452224, 131072, 16, 77086720, 32768, 218112128, 33, 218106568, 0
    .long 1, 40, 40, 2048, 1536, 1792, 8388608, 182452224, 131072, 16, 77094912, 32768, 218112128, 33, 218106568, 0
    .long 1, 80, 80, 2048, 1536, 1792, 7340032, 61865984, 114688, 14, 119562240, 32768, 218104064, 14, 218106626, 0
    .long 1, 80, 80, 2048, 1536, 1792, 7340032, 54525952, 114688, 14, 117465088, 32768, 218103808, 14, 218106370, 0
    .long 1, 80, 80, 2048, 1536, 1792, 7340032, 60030976, 114688, 14, 119037952, 32768, 218104000, 14, 218106562, 0
    .long 1, 80, 80, 2048, 1024, 1280, 7340032, 60030976, 114688, 14, 119029760, 32768, 218104000, 14, 218106562, 0
    .long 1, 40, 40, 2048, 2097664, 2097920, 8388608, 184582144, 131072, 8, 81797120, 32768, 218112128, 41, 218106628, 0
    .long 1, 40, 40, 2048, 2097152, 2097408, 8388608, 184582144, 131072, 8, 81788928, 32768, 218112128, 41, 218106628, 0
    .long 1, 40, 40, 2048, 2098688, 2098944, 8388608, 184582144, 131072, 8, 81813504, 32768, 218112128, 41, 218106628, 0
    .long 1, 40, 40, 2048, 2098176, 2098432, 8388608, 184582144, 131072, 8, 81805312, 32768, 218112128, 41, 218106628, 0
    .long 1, 80, 80, 2048, 1836544, 1836800, 7340032, 63729664, 114688, 7, 124280832, 32768, 218104132, 7, 218106689, 0
    .long 1, 80, 80, 2048, 1836032, 1836288, 7340032, 63729664, 114688, 7, 124272640, 32768, 218104132, 7, 218106689, 0
    .long 1, 80, 80, 2048, 1835008, 1835264, 7340032, 63729664, 114688, 7, 124256256, 32768, 218104132, 7, 218106689, 0
    .long 1, 80, 80, 2048, 1835520, 1835776, 7340032, 63729664, 114688, 7, 124264448, 32768, 218104132, 7, 218106689, 0
    .long 1, 80, 80, 2048, 1835520, 1835776, 7340032, 65564672, 114688, 7, 124788736, 32768, 218104196, 7, 218106753, 0
    .long 1, 80, 80, 2048, 1835008, 1835264, 7340032, 65564672, 114688, 7, 124780544, 32768, 218104196, 7, 218106753, 0
    .long 1, 80, 80, 2048, 1836544, 1836800, 7340032, 65564672, 114688, 7, 124805120, 32768, 218104196, 7, 218106753, 0
    .long 1, 40, 40, 2048, 2097664, 2097920, 8388608, 186679296, 131072, 8, 82321408, 32768, 218112128, 49, 218106692, 0
    .long 1, 80, 80, 2048, 1836032, 1836288, 7340032, 65564672, 114688, 7, 124796928, 32768, 218104196, 7, 218106753, 0
    .long 1, 40, 40, 2048, 2098176, 2098432, 8388608, 186679296, 131072, 8, 82329600, 32768, 218112128, 49, 218106692, 0
    .long 1, 40, 40, 2048, 2098688, 2098944, 8388608, 186679296, 131072, 8, 82337792, 32768, 218112128, 49, 218106692, 0
    .long 1, 40, 40, 2048, 2097152, 2097408, 8388608, 186679296, 131072, 8, 82313216, 32768, 218112128, 49, 218106692, 0
    .long 1, 80, 80, 2048, 1836544, 1836800, 7340032, 67399680, 114688, 7, 125329408, 32768, 218104260, 7, 218106817, 0
    .long 1, 80, 80, 2048, 1835520, 1835776, 7340032, 67399680, 114688, 7, 125313024, 32768, 218104260, 7, 218106817, 0
    .long 1, 80, 80, 2048, 1836032, 1836288, 7340032, 67399680, 114688, 7, 125321216, 32768, 218104260, 7, 218106817, 0
    .long 1, 80, 80, 2048, 1835008, 1835264, 7340032, 67399680, 114688, 7, 125304832, 32768, 218104260, 7, 218106817, 0
    .long 6, 1, 0, 2, 1, 16, 0, 23, 0, 0, 0, 0, 0, 0, 0, 0
    .long 6, 1, 0, 2, 1, 16, 0, 17, 0, 0, 0, 0, 0, 0, 0, 0
    .long 6, 1, 0, 2, 1, 16, 0, 20, 0, 0, 0, 0, 0, 0, 0, 0
    .long 6, 1, 0, 2, 1, 16, 0, 10, 0, 0, 0, 0, 0, 0, 0, 0
    .long 6, 1, 0, 2, 1, 16, 0, 6, 0, 0, 0, 0, 0, 0, 0, 0
    .long 6, 1, 0, 2, 1, 16, 0, 13, 0, 0, 0, 0, 0, 0, 0, 0
    .long 6, 1, 0, 1, 1, 16, 0, 38, 0, 0, 0, 0, 0, 0, 0, 0
    .long 6, 1, 0, 2, 1, 16, 0, 18, 0, 0, 0, 0, 0, 0, 0, 0
    .long 6, 1, 0, 2, 1, 16, 0, 9, 0, 0, 0, 0, 0, 0, 0, 0
    .long 6, 1, 0, 2, 1, 16, 0, 2, 0, 0, 0, 0, 0, 0, 0, 0
    .long 6, 1, 0, 2, 1, 16, 0, 5, 0, 0, 0, 0, 0, 0, 0, 0
    .long 6, 1, 0, 1, 1, 16, 0, 34, 0, 0, 0, 0, 0, 0, 0, 0
    .long 6, 1, 0, 2, 1, 16, 0, 7, 0, 0, 0, 0, 0, 0, 0, 0
    .long 6, 1, 0, 2, 1, 16, 0, 1, 0, 0, 0, 0, 0, 0, 0, 0
    .long 6, 1, 0, 2, 1, 16, 0, 12, 0, 0, 0, 0, 0, 0, 0, 0
    .long 6, 1, 0, 2, 1, 16, 0, 14, 0, 0, 0, 0, 0, 0, 0, 0
    .long 6, 1, 0, 2, 1, 16, 0, 0, 0, 0, 0, 0, 0, 0, 0, 0
    .long 6, 1, 0, 2, 1, 16, 0, 3, 0, 0, 0, 0, 0, 0, 0, 0
    .long 6, 1, 0, 2, 1, 16, 0, 22, 0, 0, 0, 0, 0, 0, 0, 0
    .long 6, 1, 0, 2, 1, 16, 0, 21, 0, 0, 0, 0, 0, 0, 0, 0
    .long 6, 1, 0, 2, 1, 16, 0, 8, 0, 0, 0, 0, 0, 0, 0, 0
    .long 6, 1, 0, 2, 1, 16, 0, 15, 0, 0, 0, 0, 0, 0, 0, 0
    .long 6, 1, 0, 2, 1, 16, 0, 19, 0, 0, 0, 0, 0, 0, 0, 0
    .long 6, 1, 0, 2, 1, 16, 0, 11, 0, 0, 0, 0, 0, 0, 0, 0
    .long 6, 1, 0, 2, 1, 16, 0, 16, 0, 0, 0, 0, 0, 0, 0, 0
    .long 6, 1, 0, 2, 1, 16, 0, 4, 0, 0, 0, 0, 0, 0, 0, 0
    .long 6, 0, 0, 0, 1, 0, 0, 54, 0, 0, 0, 0, 0, 0, 0, 0
    .long 6, 0, 0, 0, 1, 0, 0, 51, 0, 0, 0, 0, 0, 0, 0, 0
    .long 6, 0, 0, 0, 1, 0, 0, 48, 0, 0, 0, 0, 0, 0, 0, 0
    .long 6, 0, 0, 0, 1, 0, 0, 49, 0, 0, 0, 0, 0, 0, 0, 0
    .long 6, 0, 0, 0, 1, 0, 0, 50, 0, 0, 0, 0, 0, 0, 0, 0
    .long 6, 0, 0, 0, 1, 0, 0, 52, 0, 0, 0, 0, 0, 0, 0, 0
    .long 6, 0, 0, 0, 1, 0, 0, 53, 0, 0, 0, 0, 0, 0, 0, 0
    .long 6, 0, 0, 0, 1, 0, 0, 55, 0, 0, 0, 0, 0, 0, 0, 0
    .long 6, 1, 0, 1, 1, 16, 0, 32, 0, 0, 0, 0, 0, 0, 0, 0
    .long 6, 1, 0, 1, 1, 16, 0, 33, 0, 0, 0, 0, 0, 0, 0, 0
    .long 6, 1, 0, 1, 1, 16, 0, 35, 0, 0, 0, 0, 0, 0, 0, 0
    .long 6, 1, 0, 1, 1, 16, 0, 36, 0, 0, 0, 0, 0, 0, 0, 0
    .long 6, 1, 0, 1, 1, 16, 0, 37, 0, 0, 0, 0, 0, 0, 0, 0
    .long 6, 1, 0, 1, 1, 16, 0, 39, 0, 0, 0, 0, 0, 0, 0, 0
    .long 6, 1, 0, 2, 1, 16, 0, 24, 0, 0, 0, 0, 0, 0, 0, 0
    .long 6, 1, 0, 2, 1, 16, 0, 26, 0, 0, 0, 0, 0, 0, 0, 0
    .long 6, 1, 0, 2, 1, 16, 0, 27, 0, 0, 0, 0, 0, 0, 0, 0
    .long 6, 1, 0, 2, 1, 16, 0, 28, 0, 0, 0, 0, 0, 0, 0, 0
    .long 6, 1, 0, 2, 1, 16, 0, 29, 0, 0, 0, 0, 0, 0, 0, 0
    .long 6, 1, 0, 2, 1, 16, 0, 30, 0, 0, 0, 0, 0, 0, 0, 0
    .long 6, 1, 0, 2, 1, 16, 0, 31, 0, 0, 0, 0, 0, 0, 0, 0
    .long 6, 1, 0, 2, 1, 16, 0, 25, 0, 0, 0, 0, 0, 0, 0, 0
    .long 6, 0, 0, 1, 1, 16, 0, 40, 0, 0, 0, 0, 0, 0, 0, 0
    .long 6, 0, 0, 1, 1, 16, 0, 41, 0, 0, 0, 0, 0, 0, 0, 0
    .long 6, 0, 0, 1, 1, 16, 0, 42, 0, 0, 0, 0, 0, 0, 0, 0
    .long 6, 0, 0, 1, 1, 16, 0, 43, 0, 0, 0, 0, 0, 0, 0, 0
    .long 6, 0, 0, 1, 1, 16, 0, 44, 0, 0, 0, 0, 0, 0, 0, 0
    .long 6, 0, 0, 1, 1, 16, 0, 47, 0, 0, 0, 0, 0, 0, 0, 0
    .long 6, 0, 0, 1, 1, 16, 0, 46, 0, 0, 0, 0, 0, 0, 0, 0
    .long 6, 0, 0, 1, 1, 16, 0, 45, 0, 0, 0, 0, 0, 0, 0, 0
    .long 6, 0, 0, 0, 1, 0, 0, 56, 0, 0, 0, 0, 0, 0, 0, 0
    .long 6, 0, 0, 0, 1, 0, 0, 57, 0, 0, 0, 0, 0, 0, 0, 0
    .long 6, 0, 0, 0, 1, 0, 0, 58, 0, 0, 0, 0, 0, 0, 0, 0
    .long 6, 0, 0, 0, 1, 0, 0, 59, 0, 0, 0, 0, 0, 0, 0, 0
    .long 6, 0, 0, 0, 1, 0, 0, 60, 0, 0, 0, 0, 0, 0, 0, 0
    .long 7, 0, 0, 0, 4, 0, 0, 61, 0, 0, 0, 0, 0, 0, 0, 0
    .long 7, 0, 0, 0, 5, 0, 0, 61, 0, 0, 0, 0, 0, 0, 0, 0
    .long 7, 0, 0, 0, 6, 0, 0, 61, 0, 0, 0, 0, 0, 0, 0, 0
    .long 7, 0, 0, 0, 7, 0, 0, 61, 0, 0, 0, 0, 0, 0, 0, 0
    .long 7, 0, 0, 0, 4, 0, 0, 62, 0, 0, 0, 0, 0, 0, 0, 0
    .long 7, 0, 0, 0, 5, 0, 0, 62, 0, 0, 0, 0, 0, 0, 0, 0
    .long 7, 0, 0, 0, 6, 0, 0, 62, 0, 0, 0, 0, 0, 0, 0, 0
    .long 7, 0, 0, 0, 7, 0, 0, 62, 0, 0, 0, 0, 0, 0, 0, 0
    .long 7, 0, 0, 0, 4, 0, 0, 63, 0, 0, 0, 0, 0, 0, 0, 0
    .long 7, 0, 0, 0, 5, 0, 0, 63, 0, 0, 0, 0, 0, 0, 0, 0
    .long 7, 0, 0, 0, 6, 0, 0, 63, 0, 0, 0, 0, 0, 0, 0, 0
    .long 7, 0, 0, 0, 7, 0, 0, 63, 0, 0, 0, 0, 0, 0, 0, 0
    .long 0, 0, 0, 0, 0, 0, 0, 0, 0, 0, 0, 0, 0, 0, 0, 0
    .long 4, 24, 24, 8192, 4096, 266240, 8388608, 0, 32768, 4, 21037056, 131072, 0, 0, 218104385, 0
    .long 4, 24, 24, 8192, 4352, 266496, 8388608, 0, 32768, 4, 21041152, 131072, 0, 0, 218104385, 0
    .long 4, 24, 24, 8192, 4608, 266752, 8388608, 0, 32768, 4, 21045248, 131072, 0, 0, 218104385, 0
    .long 4, 24, 24, 8192, 4864, 267008, 8388608, 0, 32768, 4, 21049344, 131072, 0, 0, 218104385, 0
    .long 4, 24, 24, 8192, 5120, 267264, 8388608, 0, 32768, 4, 21053440, 131072, 0, 0, 218104401, 0
    .long 4, 24, 24, 8192, 5376, 267520, 8388608, 0, 32768, 4, 21057536, 131072, 0, 0, 218104401, 0
    .long 4, 24, 24, 8192, 5632, 267776, 8388608, 0, 32768, 4, 21061632, 131072, 0, 0, 218104401, 0
    .long 4, 24, 24, 8192, 5888, 268032, 8388608, 0, 32768, 4, 21065728, 131072, 0, 0, 218104401, 0
    .long 4, 32, 32, 8192, 4096, 266240, 8388608, 0, 32768, 4, 37814272, 131072, 0, 0, 218104385, 0
    .long 4, 32, 32, 8192, 4352, 266496, 8388608, 0, 32768, 4, 37818368, 131072, 0, 0, 218104385, 0
    .long 4, 32, 32, 8192, 4608, 266752, 8388608, 0, 32768, 4, 37822464, 131072, 0, 0, 218104385, 0
    .long 4, 32, 32, 8192, 4864, 267008, 8388608, 0, 32768, 4, 37826560, 131072, 0, 0, 218104385, 0
    .long 4, 32, 32, 8192, 5120, 267264, 8388608, 0, 32768, 4, 37830656, 131072, 0, 0, 218104401, 0
    .long 4, 32, 32, 8192, 5376, 267520, 8388608, 0, 32768, 4, 37834752, 131072, 0, 0, 218104401, 0
    .long 4, 32, 32, 8192, 5632, 267776, 8388608, 0, 32768, 4, 37838848, 131072, 0, 0, 218104401, 0
    .long 4, 32, 32, 8192, 5888, 268032, 8388608, 0, 32768, 4, 37842944, 131072, 0, 0, 218104401, 0
    .long 4, 24, 24, 8192, 4096, 266240, 8388608, 262144, 32768, 4, 22085632, 131072, 0, 0, 218104388, 0
    .long 4, 24, 24, 8192, 4352, 266496, 8388608, 262144, 32768, 4, 22089728, 131072, 0, 0, 218104388, 0
    .long 4, 24, 24, 8192, 4608, 266752, 8388608, 262144, 32768, 4, 22093824, 131072, 0, 0, 218104388, 0
    .long 4, 24, 24, 8192, 4864, 267008, 8388608, 262144, 32768, 4, 22097920, 131072, 0, 0, 218104388, 0
    .long 4, 24, 24, 8192, 5120, 267264, 8388608, 262144, 32768, 4, 22102016, 131072, 0, 0, 218104404, 0
    .long 4, 24, 24, 8192, 5376, 267520, 8388608, 262144, 32768, 4, 22106112, 131072, 0, 0, 218104404, 0
    .long 4, 24, 24, 8192, 5632, 267776, 8388608, 262144, 32768, 4, 22110208, 131072, 0, 0, 218104404, 0
    .long 4, 24, 24, 8192, 5888, 268032, 8388608, 262144, 32768, 4, 22114304, 131072, 0, 0, 218104404, 0
    .long 4, 32, 32, 8192, 4096, 266240, 8388608, 262144, 32768, 4, 38862848, 131072, 0, 0, 218104388, 0
    .long 4, 32, 32, 8192, 4352, 266496, 8388608, 262144, 32768, 4, 38866944, 131072, 0, 0, 218104388, 0
    .long 4, 32, 32, 8192, 4608, 266752, 8388608, 262144, 32768, 4, 38871040, 131072, 0, 0, 218104388, 0
    .long 4, 32, 32, 8192, 4864, 267008, 8388608, 262144, 32768, 4, 38875136, 131072, 0, 0, 218104388, 0
    .long 4, 32, 32, 8192, 5120, 267264, 8388608, 262144, 32768, 4, 38879232, 131072, 0, 0, 218104404, 0
    .long 4, 32, 32, 8192, 5376, 267520, 8388608, 262144, 32768, 4, 38883328, 131072, 0, 0, 218104404, 0
    .long 4, 32, 32, 8192, 5632, 267776, 8388608, 262144, 32768, 4, 38887424, 131072, 0, 0, 218104404, 0
    .long 4, 32, 32, 8192, 5888, 268032, 8388608, 262144, 32768, 4, 38891520, 131072, 0, 0, 218104404, 0
    .long 4, 32, 32, 8192, 4608, 266752, 8388608, 786432, 32768, 4, 40968192, 131072, 0, 0, 218104644, 0
    .long 4, 32, 32, 8192, 5632, 267776, 8388608, 786432, 32768, 4, 40984576, 131072, 0, 0, 218104660, 0
    .long 4, 32, 32, 8192, 5888, 268032, 8388608, 524288, 32768, 4, 39940096, 131072, 0, 0, 218104657, 0
    .long 4, 24, 24, 8192, 4608, 266752, 8388608, 786432, 32768, 4, 24190976, 131072, 0, 0, 218104644, 0
    .long 4, 32, 32, 8192, 4608, 266752, 8388608, 524288, 32768, 4, 39919616, 131072, 0, 0, 218104641, 0
    .long 4, 32, 32, 8192, 5888, 268032, 8388608, 786432, 32768, 4, 40988672, 131072, 0, 0, 218104660, 0
    .long 4, 24, 24, 8192, 5632, 267776, 8388608, 786432, 32768, 4, 24207360, 131072, 0, 0, 218104660, 0
    .long 4, 24, 24, 8192, 4352, 266496, 8388608, 524288, 32768, 4, 23138304, 131072, 0, 0, 218104641, 0
    .long 4, 24, 24, 8192, 4864, 267008, 8388608, 524288, 32768, 4, 23146496, 131072, 0, 0, 218104641, 0
    .long 4, 24, 24, 8192, 5376, 267520, 8388608, 524288, 32768, 4, 23154688, 131072, 0, 0, 218104657, 0
    .long 4, 24, 24, 8192, 4864, 267008, 8388608, 786432, 32768, 4, 24195072, 131072, 0, 0, 218104644, 0
    .long 4, 32, 32, 8192, 4352, 266496, 8388608, 524288, 32768, 4, 39915520, 131072, 0, 0, 218104641, 0
    .long 4, 32, 32, 8192, 5120, 267264, 8388608, 524288, 32768, 4, 39927808, 131072, 0, 0, 218104657, 0
    .long 4, 24, 24, 8192, 5632, 267776, 8388608, 524288, 32768, 4, 23158784, 131072, 0, 0, 218104657, 0
    .long 4, 32, 32, 8192, 4864, 267008, 8388608, 524288, 32768, 4, 39923712, 131072, 0, 0, 218104641, 0
    .long 4, 24, 24, 8192, 4096, 266240, 8388608, 524288, 32768, 4, 23134208, 131072, 0, 0, 218104641, 0
    .long 4, 32, 32, 8192, 5120, 267264, 8388608, 786432, 32768, 4, 40976384, 131072, 0, 0, 218104660, 0
    .long 4, 24, 24, 8192, 5888, 268032, 8388608, 786432, 32768, 4, 24211456, 131072, 0, 0, 218104660, 0
    .long 4, 32, 32, 8192, 4096, 266240, 8388608, 524288, 32768, 4, 39911424, 131072, 0, 0, 218104641, 0
    .long 4, 24, 24, 8192, 5376, 267520, 8388608, 786432, 32768, 4, 24203264, 131072, 0, 0, 218104660, 0
    .long 4, 32, 32, 8192, 4352, 266496, 8388608, 786432, 32768, 4, 40964096, 131072, 0, 0, 218104644, 0
    .long 4, 24, 24, 8192, 5120, 267264, 8388608, 786432, 32768, 4, 24199168, 131072, 0, 0, 218104660, 0
    .long 4, 24, 24, 8192, 4608, 266752, 8388608, 524288, 32768, 4, 23142400, 131072, 0, 0, 218104641, 0
    .long 4, 24, 24, 8192, 4352, 266496, 8388608, 786432, 32768, 4, 24186880, 131072, 0, 0, 218104644, 0
    .long 4, 32, 32, 8192, 5376, 267520, 8388608, 786432, 32768, 4, 40980480, 131072, 0, 0, 218104660, 0
    .long 4, 24, 24, 8192, 4096, 266240, 8388608, 786432, 32768, 4, 24182784, 131072, 0, 0, 218104644, 0
    .long 4, 32, 32, 8192, 5632, 267776, 8388608, 524288, 32768, 4, 39936000, 131072, 0, 0, 218104657, 0
    .long 4, 32, 32, 8192, 4864, 267008, 8388608, 786432, 32768, 4, 40972288, 131072, 0, 0, 218104644, 0
    .long 4, 32, 32, 8192, 5376, 267520, 8388608, 524288, 32768, 4, 39931904, 131072, 0, 0, 218104657, 0
    .long 4, 24, 24, 8192, 5120, 267264, 8388608, 524288, 32768, 4, 23150592, 131072, 0, 0, 218104657, 0
    .long 4, 24, 24, 8192, 5888, 268032, 8388608, 524288, 32768, 4, 23162880, 131072, 0, 0, 218104657, 0
    .long 4, 32, 32, 8192, 4096, 266240, 8388608, 786432, 32768, 4, 40960000, 131072, 0, 0, 218104644, 0
    .long 1, 16, 16, 8192, 4096, 4352, 8388608, 1572864, 32768, 8, 10551296, 131072, 0, 0, 218105162, 0
    .long 1, 32, 32, 8192, 4608, 4864, 8388608, 1048576, 32768, 8, 42016768, 131072, 0, 0, 218104906, 0
    .long 1, 32, 32, 8192, 4608, 4864, 8388608, 1572864, 32768, 8, 44113920, 131072, 0, 0, 218105162, 0
    .long 1, 24, 24, 8192, 4608, 4864, 8388608, 1048576, 32768, 8, 25239552, 131072, 0, 0, 218104906, 0
    .long 1, 16, 16, 8192, 5120, 5376, 8388608, 1048576, 32768, 8, 8470528, 131072, 0, 0, 218104922, 0
    .long 1, 16, 16, 8192, 5632, 5888, 8388608, 1048576, 32768, 8, 8478720, 131072, 0, 0, 218104922, 0
    .long 1, 32, 32, 8192, 5632, 5888, 8388608, 1048576, 32768, 8, 42033152, 131072, 0, 0, 218104922, 0
    .long 1, 24, 24, 8192, 5120, 5376, 8388608, 1048576, 32768, 8, 25247744, 131072, 0, 0, 218104922, 0
    .long 1, 24, 24, 8192, 5632, 5888, 8388608, 2097152, 32768, 8, 29450240, 131072, 0, 0, 218105434, 0
    .long 1, 24, 24, 8192, 5632, 5888, 8388608, 1048576, 32768, 8, 25255936, 131072, 0, 0, 218104922, 0
    .long 1, 32, 32, 8192, 5120, 5376, 8388608, 1048576, 32768, 8, 42024960, 131072, 0, 0, 218104922, 0
    .long 1, 24, 24, 8192, 5120, 5376, 8388608, 2097152, 32768, 8, 29442048, 131072, 0, 0, 218105434, 0
    .long 1, 24, 24, 8192, 4096, 4352, 8388608, 1572864, 32768, 8, 27328512, 131072, 0, 0, 218105162, 0
    .long 1, 32, 32, 8192, 4096, 4352, 8388608, 1572864, 32768, 8, 44105728, 131072, 0, 0, 218105162, 0
    .long 1, 24, 24, 8192, 5120, 5376, 8388608, 1572864, 32768, 8, 27344896, 131072, 0, 0, 218105178, 0
    .long 1, 16, 16, 8192, 4096, 4352, 8388608, 1048576, 32768, 8, 8454144, 131072, 0, 0, 218104906, 0
    .long 1, 24, 24, 8192, 4608, 4864, 8388608, 1572864, 32768, 8, 27336704, 131072, 0, 0, 218105162, 0
    .long 1, 16, 16, 8192, 4608, 4864, 8388608, 1572864, 32768, 8, 10559488, 131072, 0, 0, 218105162, 0
    .long 1, 32, 32, 8192, 5120, 5376, 8388608, 1572864, 32768, 8, 44122112, 131072, 0, 0, 218105178, 0
    .long 1, 16, 16, 8192, 5120, 5376, 8388608, 1572864, 32768, 8, 10567680, 131072, 0, 0, 218105178, 0
    .long 1, 32, 32, 8192, 5632, 5888, 8388608, 2097152, 32768, 8, 46227456, 131072, 0, 0, 218105434, 0
    .long 1, 24, 24, 8192, 4096, 4352, 8388608, 1048576, 32768, 8, 25231360, 131072, 0, 0, 218104906, 0
    .long 1, 24, 24, 8192, 4096, 4352, 8388608, 2097152, 32768, 8, 29425664, 131072, 0, 0, 218105418, 0
    .long 1, 16, 16, 8192, 5632, 5888, 8388608, 1572864, 32768, 8, 10575872, 131072, 0, 0, 218105178, 0
    .long 2, 64, 72, 7168, 4352, 4352, 7340032, 1572864, 32768, 8, 60100608, 114688, 0, 0, 218104017, 0
    .long 1, 32, 32, 8192, 4096, 4352, 8388608, 2097152, 32768, 8, 46202880, 131072, 0, 0, 218105418, 0
    .long 1, 32, 32, 8192, 4096, 4352, 8388608, 1048576, 32768, 8, 42008576, 131072, 0, 0, 218104906, 0
    .long 1, 32, 32, 8192, 4608, 4864, 8388608, 2097152, 32768, 8, 46211072, 131072, 0, 0, 218105418, 0
    .long 1, 24, 24, 8192, 5632, 5888, 8388608, 1572864, 32768, 8, 27353088, 131072, 0, 0, 218105178, 0
    .long 1, 32, 32, 8192, 5632, 5888, 8388608, 1572864, 32768, 8, 44130304, 131072, 0, 0, 218105178, 0
    .long 1, 16, 16, 8192, 4608, 4864, 8388608, 1048576, 32768, 8, 8462336, 131072, 0, 0, 218104906, 0
    .long 1, 32, 32, 8192, 5120, 5376, 8388608, 2097152, 32768, 8, 46219264, 131072, 0, 0, 218105434, 0
    .long 1, 16, 16, 8192, 4608, 4864, 8388608, 0, 32768, 8, 4268032, 131072, 0, 0, 218107978, 0
    .long 2, 64, 72, 7168, 4352, 4352, 7340032, 2097152, 32768, 8, 61935616, 114688, 0, 0, 218104081, 0
    .long 1, 16, 16, 8192, 5632, 5888, 8388608, 2097152, 32768, 8, 12673024, 131072, 0, 0, 218105434, 0
    .long 1, 16, 16, 8192, 4608, 4864, 8388608, 524288, 32768, 8, 6365184, 131072, 0, 0, 218108234, 0
    .long 1, 16, 16, 8192, 5632, 5888, 8388608, 3145728, 32768, 8, 16867328, 131072, 0, 0, 218105946, 0
    .long 1, 32, 32, 8192, 5632, 5888, 8388608, 2621440, 32768, 8, 48324608, 131072, 0, 0, 218105690, 0
    .long 1, 16, 16, 8192, 5120, 5376, 8388608, 0, 32768, 8, 4276224, 131072, 0, 0, 218107994, 0
    .long 1, 16, 16, 8192, 4096, 4352, 8388608, 2097152, 32768, 8, 12648448, 131072, 0, 0, 218105418, 0
    .long 1, 16, 16, 8192, 5632, 5888, 8388608, 0, 32768, 8, 4284416, 131072, 0, 0, 218107994, 0
    .long 1, 16, 16, 8192, 4096, 4352, 8388608, 524288, 32768, 8, 6356992, 131072, 0, 0, 218108234, 0
    .long 1, 24, 24, 8192, 5120, 5376, 8388608, 3145728, 32768, 8, 33636352, 131072, 0, 0, 218105946, 0
    .long 1, 24, 24, 8192, 4608, 4864, 8388608, 2621440, 32768, 8, 31531008, 131072, 0, 0, 218105674, 0
    .long 1, 16, 16, 8192, 4608, 4864, 8388608, 2621440, 32768, 8, 14753792, 131072, 0, 0, 218105674, 0
    .long 1, 16, 16, 8192, 5120, 5376, 8388608, 524288, 32768, 8, 6373376, 131072, 0, 0, 218108250, 0
    .long 2, 64, 72, 7168, 4864, 4864, 7340032, 0, 32768, 8, 54603776, 114688, 0, 0, 218103825, 0
    .long 2, 64, 72, 7168, 4352, 4352, 7340032, 0, 32768, 8, 54595584, 114688, 0, 0, 218103825, 0
    .long 2, 64, 72, 7168, 4864, 4864, 7340032, 1048576, 32768, 8, 58273792, 114688, 0, 0, 218103953, 0
    .long 1, 16, 16, 8192, 4096, 4352, 8388608, 0, 32768, 8, 4259840, 131072, 0, 0, 218107978, 0
    .long 1, 16, 16, 8192, 5632, 5888, 8388608, 524288, 32768, 8, 6381568, 131072, 0, 0, 218108250, 0
    .long 1, 24, 24, 8192, 5120, 5376, 8388608, 2621440, 32768, 8, 31539200, 131072, 0, 0, 218105690, 0
    .long 1, 16, 16, 8192, 5632, 5888, 8388608, 2621440, 32768, 8, 14770176, 131072, 0, 0, 218105690, 0
    .long 1, 24, 24, 8192, 4608, 4864, 8388608, 2097152, 32768, 8, 29433856, 131072, 0, 0, 218105418, 0
    .long 2, 64, 72, 7168, 4864, 4864, 7340032, 2097152, 32768, 8, 61943808, 114688, 0, 0, 218104081, 0
    .long 1, 16, 16, 8192, 4608, 4864, 8388608, 3145728, 32768, 8, 16850944, 131072, 0, 0, 218105930, 0
    .long 1, 16, 16, 8192, 4608, 4864, 8388608, 2097152, 32768, 8, 12656640, 131072, 0, 0, 218105418, 0
    .long 2, 64, 72, 7168, 4352, 4352, 7340032, 3670016, 32768, 8, 67440640, 114688, 0, 0, 218104273, 0
    .long 1, 24, 24, 8192, 4608, 4864, 8388608, 3145728, 32768, 8, 33628160, 131072, 0, 0, 218105930, 0
    .long 2, 64, 72, 7168, 4096, 4096, 7340032, 2097152, 32768, 8, 61931520, 114688, 0, 0, 218104081, 0
    .long 1, 16, 16, 8192, 5120, 5376, 8388608, 2097152, 32768, 8, 12664832, 131072, 0, 0, 218105434, 0
    .long 2, 64, 72, 7168, 4864, 4864, 7340032, 2621440, 32768, 8, 63778816, 114688, 0, 0, 218104145, 0
    .long 1, 32, 32, 8192, 5632, 5888, 8388608, 3145728, 32768, 8, 50421760, 131072, 0, 0, 218105946, 0
    .long 1, 24, 24, 8192, 4096, 4352, 8388608, 2621440, 32768, 8, 31522816, 131072, 0, 0, 218105674, 0
    .long 2, 64, 72, 7168, 3584, 3584, 7340032, 1048576, 32768, 8, 58253312, 114688, 0, 0, 218103953, 0
    .long 1, 32, 32, 8192, 5120, 5376, 8388608, 3145728, 32768, 8, 50413568, 131072, 0, 0, 218105946, 0
    .long 2, 64, 72, 7168, 4352, 4352, 7340032, 3145728, 32768, 8, 65605632, 114688, 0, 0, 218104209, 0
    .long 1, 16, 16, 8192, 4096, 4352, 8388608, 3145728, 32768, 8, 16842752, 131072, 0, 0, 218105930, 0
    .long 2, 64, 72, 7168, 5120, 5120, 7340032, 1048576, 32768, 8, 58277888, 114688, 0, 0, 218103953, 0
    .long 2, 64, 72, 7168, 3584, 3584, 7340032, 3145728, 32768, 8, 65593344, 114688, 0, 0, 218104209, 0
    .long 2, 64, 72, 7168, 4352, 4352, 7340032, 2621440, 32768, 8, 63770624, 114688, 0, 0, 218104145, 0
    .long 2, 64, 72, 7168, 3840, 3840, 7340032, 1048576, 32768, 8, 58257408, 114688, 0, 0, 218103953, 0
    .long 2, 64, 72, 7168, 4608, 4608, 7340032, 3145728, 32768, 8, 65609728, 114688, 0, 0, 218104209, 0
    .long 1, 16, 16, 8192, 5120, 5376, 8388608, 2621440, 32768, 8, 14761984, 131072, 0, 0, 218105690, 0
    .long 1, 32, 32, 8192, 4096, 4352, 8388608, 2621440, 32768, 8, 48300032, 131072, 0, 0, 218105674, 0
    .long 1, 16, 16, 8192, 4096, 4352, 8388608, 2621440, 32768, 8, 14745600, 131072, 0, 0, 218105674, 0
    .long 5, 218108224, 0, 0, 16, 0, 0, 8, 0, 0, 0, 0, 218112256, 12, 218106961, 0
    .long 2, 64, 72, 7168, 3840, 3840, 7340032, 524288, 32768, 8, 56422400, 114688, 0, 0, 218103889, 0
    .long 2, 64, 72, 7168, 4608, 4608, 7340032, 0, 32768, 8, 54599680, 114688, 0, 0, 218103825, 0
    .long 1, 24, 24, 8192, 4096, 4352, 8388608, 3145728, 32768, 8, 33619968, 131072, 0, 0, 218105930, 0
    .long 2, 64, 72, 7168, 5120, 5120, 7340032, 0, 32768, 8, 54607872, 114688, 0, 0, 218103825, 0
    .long 5, 218107968, 0, 0, 16, 0, 0, 0, 0, 0, 0, 0, 218112256, 4, 218106897, 0
    .long 1, 32, 32, 8192, 4608, 4864, 8388608, 3145728, 32768, 8, 50405376, 131072, 0, 0, 218105930, 0
    .long 5, 218108240, 0, 0, 20, 0, 0, 8, 0, 0, 0, 0, 218112256, 12, 218106961, 0
    .long 1, 24, 24, 8192, 5632, 5888, 8388608, 2621440, 32768, 8, 31547392, 131072, 0, 0, 218105690, 0
    .long 1, 32, 32, 8192, 5120, 5376, 8388608, 2621440, 32768, 8, 48316416, 131072, 0, 0, 218105690, 0
    .long 2, 64, 72, 7168, 4352, 4352, 7340032, 1048576, 32768, 8, 58265600, 114688, 0, 0, 218103953, 0
    .long 2, 64, 72, 7168, 4352, 4352, 7340032, 524288, 32768, 8, 56430592, 114688, 0, 0, 218103889, 0
    .long 2, 64, 72, 7168, 4096, 4096, 7340032, 524288, 32768, 8, 56426496, 114688, 0, 0, 218103889, 0
    .long 2, 64, 72, 7168, 4608, 4608, 7340032, 1048576, 32768, 8, 58269696, 114688, 0, 0, 218103953, 0
    .long 1, 32, 32, 8192, 4608, 4864, 8388608, 2621440, 32768, 8, 48308224, 131072, 0, 0, 218105674, 0
    .long 2, 64, 72, 7168, 4096, 4096, 7340032, 1048576, 32768, 8, 58261504, 114688, 0, 0, 218103953, 0
    .long 1, 16, 16, 8192, 5120, 5376, 8388608, 3670016, 32768, 8, 18956288, 131072, 0, 0, 218106202, 0
    .long 2, 64, 72, 7168, 4608, 4608, 7340032, 524288, 32768, 8, 56434688, 114688, 0, 0, 218103889, 0
    .long 1, 16, 16, 8192, 5120, 5376, 8388608, 3145728, 32768, 8, 16859136, 131072, 0, 0, 218105946, 0
    .long 5, 218107984, 0, 0, 20, 0, 0, 0, 0, 0, 0, 0, 218112256, 4, 218106897, 0
    .long 5, 218107984, 0, 0, 20, 0, 0, 4, 0, 0, 0, 0, 218112256, 8, 218106897, 0
    .long 5, 218108240, 0, 0, 20, 0, 0, 12, 0, 0, 0, 0, 218112256, 16, 218106961, 0
    .long 5, 218108224, 0, 0, 16, 0, 0, 12, 0, 0, 0, 0, 218112256, 16, 218106961, 0
    .long 5, 218107968, 0, 0, 16, 0, 0, 4, 0, 0, 0, 0, 218112256, 8, 218106897, 0
    .long 1, 32, 32, 8192, 4096, 4352, 8388608, 3145728, 32768, 8, 50397184, 131072, 0, 0, 218105930, 0
    .long 2, 64, 72, 7168, 4096, 4096, 7340032, 1572864, 32768, 8, 60096512, 114688, 0, 0, 218104017, 0
    .long 2, 64, 72, 7168, 3584, 3584, 7340032, 1572864, 32768, 8, 60088320, 114688, 0, 0, 218104017, 0
    .long 2, 64, 72, 7168, 3840, 3840, 7340032, 0, 32768, 8, 54587392, 114688, 0, 0, 218103825, 0
    .long 1, 24, 24, 8192, 5632, 5888, 8388608, 3145728, 32768, 8, 33644544, 131072, 0, 0, 218105946, 0
    .long 2, 64, 72, 7168, 5120, 5120, 7340032, 3145728, 32768, 8, 65617920, 114688, 0, 0, 218104209, 0
    .long 2, 64, 72, 7168, 3584, 3584, 7340032, 2621440, 32768, 8, 63758336, 114688, 0, 0, 218104145, 0
    .long 2, 64, 72, 7168, 4096, 4096, 7340032, 0, 32768, 8, 54591488, 114688, 0, 0, 218103825, 0
    .long 2, 64, 72, 7168, 4608, 4608, 7340032, 2097152, 32768, 8, 61939712, 114688, 0, 0, 218104081, 0
    .long 2, 64, 72, 7168, 5120, 5120, 7340032, 524288, 32768, 8, 56442880, 114688, 0, 0, 218103889, 0
    .long 2, 64, 72, 7168, 3840, 3840, 7340032, 2097152, 32768, 8, 61927424, 114688, 0, 0, 218104081, 0
    .long 2, 64, 72, 7168, 5120, 5120, 7340032, 1572864, 32768, 8, 60112896, 114688, 0, 0, 218104017, 0
    .long 2, 64, 72, 7168, 3584, 3584, 7340032, 0, 32768, 8, 54583296, 114688, 0, 0, 218103825, 0
    .long 2, 64, 72, 7168, 4608, 4608, 7340032, 3670016, 32768, 8, 67444736, 114688, 0, 0, 218104273, 0
    .long 2, 64, 72, 7168, 3584, 3584, 7340032, 524288, 32768, 8, 56418304, 114688, 0, 0, 218103889, 0
    .long 2, 64, 72, 7168, 4864, 4864, 7340032, 524288, 32768, 8, 56438784, 114688, 0, 0, 218103889, 0
    .long 2, 64, 72, 7168, 5120, 5120, 7340032, 2097152, 32768, 8, 61947904, 114688, 0, 0, 218104081, 0
    .long 1, 24, 24, 8192, 5632, 5888, 8388608, 3670016, 32768, 8, 35741696, 131072, 0, 0, 218106202, 0
    .long 2, 64, 72, 7168, 4096, 4096, 7340032, 2621440, 32768, 8, 63766528, 114688, 0, 0, 218104145, 0
    .long 2, 64, 72, 7168, 4608, 4608, 7340032, 1572864, 32768, 8, 60104704, 114688, 0, 0, 218104017, 0
    .long 2, 64, 72, 7168, 3584, 3584, 7340032, 2097152, 32768, 8, 61923328, 114688, 0, 0, 218104081, 0
    .long 2, 64, 72, 7168, 4864, 4864, 7340032, 3145728, 32768, 8, 65613824, 114688, 0, 0, 218104209, 0
    .long 2, 64, 72, 7168, 3840, 3840, 7340032, 1572864, 32768, 8, 60092416, 114688, 0, 0, 218104017, 0
    .long 2, 64, 72, 7168, 3840, 3840, 7340032, 2621440, 32768, 8, 63762432, 114688, 0, 0, 218104145, 0
    .long 1, 24, 24, 8192, 4096, 4352, 8388608, 3670016, 32768, 8, 35717120, 131072, 0, 0, 218106186, 0
    .long 2, 64, 72, 7168, 5120, 5120, 7340032, 2621440, 32768, 8, 63782912, 114688, 0, 0, 218104145, 0
    .long 2, 64, 72, 7168, 4608, 4608, 7340032, 2621440, 32768, 8, 63774720, 114688, 0, 0, 218104145, 0
    .long 2, 64, 72, 7168, 4864, 4864, 7340032, 3670016, 32768, 8, 67448832, 114688, 0, 0, 218104273, 0
    .long 2, 64, 72, 7168, 4864, 4864, 7340032, 1572864, 32768, 8, 60108800, 114688, 0, 0, 218104017, 0
    .long 1, 40, 40, 2048, 4194816, 4195072, 8388608, 180420608, 131072, 16, 80748544, 32768, 218112256, 25, 218106504, 0
    .long 1, 80, 80, 2048, 3670016, 3670272, 7340032, 58253312, 114688, 14, 122683392, 32768, 218103952, 14, 218106498, 0
    .long 1, 24, 24, 8192, 5120, 5376, 8388608, 3670016, 32768, 8, 35733504, 131072, 0, 0, 218106202, 0
    .long 1, 40, 40, 2048, 4194304, 4194560, 8388608, 180420608, 131072, 16, 80740352, 32768, 218112256, 25, 218106504, 0
    .long 1, 40, 40, 2048, 4194304, 4194560, 8388608, 178323456, 131072, 16, 80216064, 32768, 218106960, 8, 218106440, 0
    .long 2, 64, 72, 7168, 4096, 4096, 7340032, 3145728, 32768, 8, 65601536, 114688, 0, 0, 218104209, 0
    .long 1, 40, 40, 2048, 4194816, 4195072, 8388608, 178323456, 131072, 16, 80224256, 32768, 218106960, 8, 218106440, 0
    .long 1, 80, 80, 2048, 3670528, 3670784, 7340032, 58253312, 114688, 14, 122691584, 32768, 218103952, 14, 218106498, 0
    .long 2, 64, 72, 7168, 3840, 3840, 7340032, 3145728, 32768, 8, 65597440, 114688, 0, 0, 218104209, 0
    .long 1, 32, 32, 8192, 4608, 4864, 8388608, 3670016, 32768, 8, 52502528, 131072, 0, 0, 218106186, 0
    .long 1, 16, 16, 8192, 4608, 4864, 8388608, 3670016, 32768, 8, 18948096, 131072, 0, 0, 218106186, 0
    .long 1, 40, 40, 2048, 4194816, 4195072, 8388608, 176226304, 131072, 16, 79699968, 32768, 218106896, 8, 218106376, 0
    .long 1, 40, 40, 2048, 4194304, 4194560, 8388608, 176226304, 131072, 16, 79691776, 32768, 218106896, 8, 218106376, 0
    .long 1, 32, 32, 8192, 4096, 4352, 8388608, 3670016, 32768, 8, 52494336, 131072, 0, 0, 218106186, 0
    .long 1, 24, 24, 8192, 4608, 4864, 8388608, 3670016, 32768, 8, 35725312, 131072, 0, 0, 218106186, 0
    .long 1, 16, 16, 8192, 4096, 4352, 8388608, 3670016, 32768, 8, 18939904, 131072, 0, 0, 218106186, 0
    .long 1, 32, 32, 8192, 5120, 5376, 8388608, 3670016, 32768, 8, 52510720, 131072, 0, 0, 218106202, 0
    .long 1, 32, 32, 8192, 5632, 5888, 8388608, 3670016, 32768, 8, 52518912, 131072, 0, 0, 218106202, 0
    .long 2, 64, 72, 7168, 4096, 4096, 7340032, 3670016, 32768, 8, 67436544, 114688, 0, 0, 218104273, 0
    .long 2, 64, 72, 7168, 3584, 3584, 7340032, 3670016, 32768, 8, 67428352, 114688, 0, 0, 218104273, 0
    .long 1, 16, 16, 8192, 5632, 5888, 8388608, 3670016, 32768, 8, 18964480, 131072, 0, 0, 218106202, 0
    .long 2, 64, 72, 7168, 5120, 5120, 7340032, 3670016, 32768, 8, 67452928, 114688, 0, 0, 218104273, 0
    .long 1, 80, 80, 2048, 3670528, 3670784, 7340032, 56418304, 114688, 14, 122167296, 32768, 218103888, 14, 218106434, 0
    .long 1, 80, 80, 2048, 3670016, 3670272, 7340032, 54583296, 114688, 14, 121634816, 32768, 218103824, 14, 218106370, 0
    .long 1, 80, 80, 2048, 3670016, 3670272, 7340032, 61923328, 114688, 14, 123731968, 32768, 218104080, 14, 218106626, 0
    .long 1, 80, 80, 2048, 3670016, 3670272, 7340032, 56418304, 114688, 14, 122159104, 32768, 218103888, 14, 218106434, 0
    .long 2, 64, 72, 7168, 3840, 3840, 7340032, 3670016, 32768, 8, 67432448, 114688, 0, 0, 218104273, 0
    .long 1, 40, 40, 2048, 4194304, 4194560, 8388608, 182517760, 131072, 16, 81264640, 32768, 218112256, 33, 218106568, 0
    .long 1, 40, 40, 2048, 4194816, 4195072, 8388608, 182517760, 131072, 16, 81272832, 32768, 218112256, 33, 218106568, 0
    .long 1, 80, 80, 2048, 3670528, 3670784, 7340032, 61923328, 114688, 14, 123740160, 32768, 218104080, 14, 218106626, 0
    .long 1, 80, 80, 2048, 3670528, 3670784, 7340032, 54583296, 114688, 14, 121643008, 32768, 218103824, 14, 218106370, 0
    .long 1, 80, 80, 2048, 3670528, 3670784, 7340032, 60088320, 114688, 14, 123215872, 32768, 218104016, 14, 218106562, 0
    .long 1, 80, 80, 2048, 3670016, 3670272, 7340032, 60088320, 114688, 14, 123207680, 32768, 218104016, 14, 218106562, 0
    .long 1, 40, 40, 2048, 4194816, 4195072, 8388608, 184614912, 131072, 8, 85991424, 32768, 218112256, 41, 218106628, 0
    .long 1, 40, 40, 2048, 4194304, 4194560, 8388608, 184614912, 131072, 8, 85983232, 32768, 218112256, 41, 218106628, 0
    .long 1, 40, 40, 2048, 4195840, 4196096, 8388608, 184614912, 131072, 8, 86007808, 32768, 218112256, 41, 218106628, 0
    .long 1, 40, 40, 2048, 4195328, 4195584, 8388608, 184614912, 131072, 8, 85999616, 32768, 218112256, 41, 218106628, 0
    .long 1, 80, 80, 2048, 3671552, 3671808, 7340032, 63758336, 114688, 7, 128475136, 32768, 218104144, 7, 218106689, 0
    .long 1, 80, 80, 2048, 3671040, 3671296, 7340032, 63758336, 114688, 7, 128466944, 32768, 218104144, 7, 218106689, 0
    .long 1, 80, 80, 2048, 3670016, 3670272, 7340032, 63758336, 114688, 7, 128450560, 32768, 218104144, 7, 218106689, 0
    .long 1, 80, 80, 2048, 3670528, 3670784, 7340032, 63758336, 114688, 7, 128458752, 32768, 218104144, 7, 218106689, 0
    .long 1, 80, 80, 2048, 3670528, 3670784, 7340032, 65593344, 114688, 7, 128983040, 32768, 218104208, 7, 218106753, 0
    .long 1, 80, 80, 2048, 3670016, 3670272, 7340032, 65593344, 114688, 7, 128974848, 32768, 218104208, 7, 218106753, 0
    .long 1, 80, 80, 2048, 3671552, 3671808, 7340032, 65593344, 114688, 7, 128999424, 32768, 218104208, 7, 218106753, 0
    .long 1, 40, 40, 2048, 4194816, 4195072, 8388608, 186712064, 131072, 8, 86515712, 32768, 218112256, 49, 218106692, 0
    .long 1, 80, 80, 2048, 3671040, 3671296, 7340032, 65593344, 114688, 7, 128991232, 32768, 218104208, 7, 218106753, 0
    .long 1, 40, 40, 2048, 4195328, 4195584, 8388608, 186712064, 131072, 8, 86523904, 32768, 218112256, 49, 218106692, 0
    .long 1, 40, 40, 2048, 4195840, 4196096, 8388608, 186712064, 131072, 8, 86532096, 32768, 218112256, 49, 218106692, 0
    .long 1, 40, 40, 2048, 4194304, 4194560, 8388608, 186712064, 131072, 8, 86507520, 32768, 218112256, 49, 218106692, 0
    .long 1, 80, 80, 2048, 3671552, 3671808, 7340032, 67428352, 114688, 7, 129523712, 32768, 218104272, 7, 218106817, 0
    .long 1, 80, 80, 2048, 3670528, 3670784, 7340032, 67428352, 114688, 7, 129507328, 32768, 218104272, 7, 218106817, 0
    .long 1, 80, 80, 2048, 3671040, 3671296, 7340032, 67428352, 114688, 7, 129515520, 32768, 218104272, 7, 218106817, 0
    .long 1, 80, 80, 2048, 3670016, 3670272, 7340032, 67428352, 114688, 7, 129499136, 32768, 218104272, 7, 218106817, 0
    .long 6, 1, 0, 2, 2, 16, 0, 23, 0, 0, 0, 0, 0, 0, 0, 0
    .long 6, 1, 0, 2, 2, 16, 0, 17, 0, 0, 0, 0, 0, 0, 0, 0
    .long 6, 1, 0, 2, 2, 16, 0, 20, 0, 0, 0, 0, 0, 0, 0, 0
    .long 6, 1, 0, 2, 2, 16, 0, 10, 0, 0, 0, 0, 0, 0, 0, 0
    .long 6, 1, 0, 2, 2, 16, 0, 6, 0, 0, 0, 0, 0, 0, 0, 0
    .long 6, 1, 0, 2, 2, 16, 0, 13, 0, 0, 0, 0, 0, 0, 0, 0
    .long 6, 1, 0, 1, 2, 16, 0, 38, 0, 0, 0, 0, 0, 0, 0, 0
    .long 6, 1, 0, 2, 2, 16, 0, 18, 0, 0, 0, 0, 0, 0, 0, 0
    .long 6, 1, 0, 2, 2, 16, 0, 9, 0, 0, 0, 0, 0, 0, 0, 0
    .long 6, 1, 0, 2, 2, 16, 0, 2, 0, 0, 0, 0, 0, 0, 0, 0
    .long 6, 1, 0, 2, 2, 16, 0, 5, 0, 0, 0, 0, 0, 0, 0, 0
    .long 6, 1, 0, 1, 2, 16, 0, 34, 0, 0, 0, 0, 0, 0, 0, 0
    .long 6, 1, 0, 2, 2, 16, 0, 7, 0, 0, 0, 0, 0, 0, 0, 0
    .long 6, 1, 0, 2, 2, 16, 0, 1, 0, 0, 0, 0, 0, 0, 0, 0
    .long 6, 1, 0, 2, 2, 16, 0, 12, 0, 0, 0, 0, 0, 0, 0, 0
    .long 6, 1, 0, 2, 2, 16, 0, 14, 0, 0, 0, 0, 0, 0, 0, 0
    .long 6, 1, 0, 2, 2, 16, 0, 0, 0, 0, 0, 0, 0, 0, 0, 0
    .long 6, 1, 0, 2, 2, 16, 0, 3, 0, 0, 0, 0, 0, 0, 0, 0
    .long 6, 1, 0, 2, 2, 16, 0, 22, 0, 0, 0, 0, 0, 0, 0, 0
    .long 6, 1, 0, 2, 2, 16, 0, 21, 0, 0, 0, 0, 0, 0, 0, 0
    .long 6, 1, 0, 2, 2, 16, 0, 8, 0, 0, 0, 0, 0, 0, 0, 0
    .long 6, 1, 0, 2, 2, 16, 0, 15, 0, 0, 0, 0, 0, 0, 0, 0
    .long 6, 1, 0, 2, 2, 16, 0, 19, 0, 0, 0, 0, 0, 0, 0, 0
    .long 6, 1, 0, 2, 2, 16, 0, 11, 0, 0, 0, 0, 0, 0, 0, 0
    .long 6, 1, 0, 2, 2, 16, 0, 16, 0, 0, 0, 0, 0, 0, 0, 0
    .long 6, 1, 0, 2, 2, 16, 0, 4, 0, 0, 0, 0, 0, 0, 0, 0
    .long 6, 0, 0, 0, 2, 0, 0, 54, 0, 0, 0, 0, 0, 0, 0, 0
    .long 6, 0, 0, 0, 2, 0, 0, 51, 0, 0, 0, 0, 0, 0, 0, 0
    .long 6, 0, 0, 0, 2, 0, 0, 48, 0, 0, 0, 0, 0, 0, 0, 0
    .long 6, 0, 0, 0, 2, 0, 0, 49, 0, 0, 0, 0, 0, 0, 0, 0
    .long 6, 0, 0, 0, 2, 0, 0, 50, 0, 0, 0, 0, 0, 0, 0, 0
    .long 6, 0, 0, 0, 2, 0, 0, 52, 0, 0, 0, 0, 0, 0, 0, 0
    .long 6, 0, 0, 0, 2, 0, 0, 53, 0, 0, 0, 0, 0, 0, 0, 0
    .long 6, 0, 0, 0, 2, 0, 0, 55, 0, 0, 0, 0, 0, 0, 0, 0
    .long 6, 1, 0, 1, 2, 16, 0, 32, 0, 0, 0, 0, 0, 0, 0, 0
    .long 6, 1, 0, 1, 2, 16, 0, 33, 0, 0, 0, 0, 0, 0, 0, 0
    .long 6, 1, 0, 1, 2, 16, 0, 35, 0, 0, 0, 0, 0, 0, 0, 0
    .long 6, 1, 0, 1, 2, 16, 0, 36, 0, 0, 0, 0, 0, 0, 0, 0
    .long 6, 1, 0, 1, 2, 16, 0, 37, 0, 0, 0, 0, 0, 0, 0, 0
    .long 6, 1, 0, 1, 2, 16, 0, 39, 0, 0, 0, 0, 0, 0, 0, 0
    .long 6, 1, 0, 2, 2, 16, 0, 24, 0, 0, 0, 0, 0, 0, 0, 0
    .long 6, 1, 0, 2, 2, 16, 0, 26, 0, 0, 0, 0, 0, 0, 0, 0
    .long 6, 1, 0, 2, 2, 16, 0, 27, 0, 0, 0, 0, 0, 0, 0, 0
    .long 6, 1, 0, 2, 2, 16, 0, 28, 0, 0, 0, 0, 0, 0, 0, 0
    .long 6, 1, 0, 2, 2, 16, 0, 29, 0, 0, 0, 0, 0, 0, 0, 0
    .long 6, 1, 0, 2, 2, 16, 0, 30, 0, 0, 0, 0, 0, 0, 0, 0
    .long 6, 1, 0, 2, 2, 16, 0, 31, 0, 0, 0, 0, 0, 0, 0, 0
    .long 6, 1, 0, 2, 2, 16, 0, 25, 0, 0, 0, 0, 0, 0, 0, 0
    .long 6, 0, 0, 1, 2, 16, 0, 40, 0, 0, 0, 0, 0, 0, 0, 0
    .long 6, 0, 0, 1, 2, 16, 0, 41, 0, 0, 0, 0, 0, 0, 0, 0
    .long 6, 0, 0, 1, 2, 16, 0, 42, 0, 0, 0, 0, 0, 0, 0, 0
    .long 6, 0, 0, 1, 2, 16, 0, 43, 0, 0, 0, 0, 0, 0, 0, 0
    .long 6, 0, 0, 1, 2, 16, 0, 44, 0, 0, 0, 0, 0, 0, 0, 0
    .long 6, 0, 0, 1, 2, 16, 0, 47, 0, 0, 0, 0, 0, 0, 0, 0
    .long 6, 0, 0, 1, 2, 16, 0, 46, 0, 0, 0, 0, 0, 0, 0, 0
    .long 6, 0, 0, 1, 2, 16, 0, 45, 0, 0, 0, 0, 0, 0, 0, 0
    .long 6, 0, 0, 0, 2, 0, 0, 56, 0, 0, 0, 0, 0, 0, 0, 0
    .long 6, 0, 0, 0, 2, 0, 0, 57, 0, 0, 0, 0, 0, 0, 0, 0
    .long 6, 0, 0, 0, 2, 0, 0, 58, 0, 0, 0, 0, 0, 0, 0, 0
    .long 6, 0, 0, 0, 2, 0, 0, 59, 0, 0, 0, 0, 0, 0, 0, 0
    .long 6, 0, 0, 0, 2, 0, 0, 60, 0, 0, 0, 0, 0, 0, 0, 0
    .long 7, 0, 0, 0, 8, 0, 0, 61, 0, 0, 0, 0, 0, 0, 0, 0
    .long 7, 0, 0, 0, 9, 0, 0, 61, 0, 0, 0, 0, 0, 0, 0, 0
    .long 7, 0, 0, 0, 10, 0, 0, 61, 0, 0, 0, 0, 0, 0, 0, 0
    .long 7, 0, 0, 0, 11, 0, 0, 61, 0, 0, 0, 0, 0, 0, 0, 0
    .long 7, 0, 0, 0, 8, 0, 0, 62, 0, 0, 0, 0, 0, 0, 0, 0
    .long 7, 0, 0, 0, 9, 0, 0, 62, 0, 0, 0, 0, 0, 0, 0, 0
    .long 7, 0, 0, 0, 10, 0, 0, 62, 0, 0, 0, 0, 0, 0, 0, 0
    .long 7, 0, 0, 0, 11, 0, 0, 62, 0, 0, 0, 0, 0, 0, 0, 0
    .long 7, 0, 0, 0, 8, 0, 0, 63, 0, 0, 0, 0, 0, 0, 0, 0
    .long 7, 0, 0, 0, 9, 0, 0, 63, 0, 0, 0, 0, 0, 0, 0, 0
    .long 7, 0, 0, 0, 10, 0, 0, 63, 0, 0, 0, 0, 0, 0, 0, 0
    .long 7, 0, 0, 0, 11, 0, 0, 63, 0, 0, 0, 0, 0, 0, 0, 0
    .long 0, 0, 0, 0, 0, 0, 0, 0, 0, 0, 0, 0, 0, 0, 0, 0
    .long 4, 24, 24, 8192, 6144, 268288, 8388608, 0, 32768, 4, 21069824, 131072, 0, 0, 218104417, 0
    .long 4, 24, 24, 8192, 6400, 268544, 8388608, 0, 32768, 4, 21073920, 131072, 0, 0, 218104417, 0
    .long 4, 24, 24, 8192, 6656, 268800, 8388608, 0, 32768, 4, 21078016, 131072, 0, 0, 218104417, 0
    .long 4, 24, 24, 8192, 6912, 269056, 8388608, 0, 32768, 4, 21082112, 131072, 0, 0, 218104417, 0
    .long 4, 24, 24, 8192, 7168, 269312, 8388608, 0, 32768, 4, 21086208, 131072, 0, 0, 218104433, 0
    .long 4, 24, 24, 8192, 7424, 269568, 8388608, 0, 32768, 4, 21090304, 131072, 0, 0, 218104433, 0
    .long 4, 24, 24, 8192, 7680, 269824, 8388608, 0, 32768, 4, 21094400, 131072, 0, 0, 218104433, 0
    .long 4, 24, 24, 8192, 7936, 270080, 8388608, 0, 32768, 4, 21098496, 131072, 0, 0, 218104433, 0
    .long 4, 32, 32, 8192, 6144, 268288, 8388608, 0, 32768, 4, 37847040, 131072, 0, 0, 218104417, 0
    .long 4, 32, 32, 8192, 6400, 268544, 8388608, 0, 32768, 4, 37851136, 131072, 0, 0, 218104417, 0
    .long 4, 32, 32, 8192, 6656, 268800, 8388608, 0, 32768, 4, 37855232, 131072, 0, 0, 218104417, 0
    .long 4, 32, 32, 8192, 6912, 269056, 8388608, 0, 32768, 4, 37859328, 131072, 0, 0, 218104417, 0
    .long 4, 32, 32, 8192, 7168, 269312, 8388608, 0, 32768, 4, 37863424, 131072, 0, 0, 218104433, 0
    .long 4, 32, 32, 8192, 7424, 269568, 8388608, 0, 32768, 4, 37867520, 131072, 0, 0, 218104433, 0
    .long 4, 32, 32, 8192, 7680, 269824, 8388608, 0, 32768, 4, 37871616, 131072, 0, 0, 218104433, 0
    .long 4, 32, 32, 8192, 7936, 270080, 8388608, 0, 32768, 4, 37875712, 131072, 0, 0, 218104433, 0
    .long 4, 24, 24, 8192, 6144, 268288, 8388608, 262144, 32768, 4, 22118400, 131072, 0, 0, 218104420, 0
    .long 4, 24, 24, 8192, 6400, 268544, 8388608, 262144, 32768, 4, 22122496, 131072, 0, 0, 218104420, 0
    .long 4, 24, 24, 8192, 6656, 268800, 8388608, 262144, 32768, 4, 22126592, 131072, 0, 0, 218104420, 0
    .long 4, 24, 24, 8192, 6912, 269056, 8388608, 262144, 32768, 4, 22130688, 131072, 0, 0, 218104420, 0
    .long 4, 24, 24, 8192, 7168, 269312, 8388608, 262144, 32768, 4, 22134784, 131072, 0, 0, 218104436, 0
    .long 4, 24, 24, 8192, 7424, 269568, 8388608, 262144, 32768, 4, 22138880, 131072, 0, 0, 218104436, 0
    .long 4, 24, 24, 8192, 7680, 269824, 8388608, 262144, 32768, 4, 22142976, 131072, 0, 0, 218104436, 0
    .long 4, 24, 24, 8192, 7936, 270080, 8388608, 262144, 32768, 4, 22147072, 131072, 0, 0, 218104436, 0
    .long 4, 32, 32, 8192, 6144, 268288, 8388608, 262144, 32768, 4, 38895616, 131072, 0, 0, 218104420, 0
    .long 4, 32, 32, 8192, 6400, 268544, 8388608, 262144, 32768, 4, 38899712, 131072, 0, 0, 218104420, 0
    .long 4, 32, 32, 8192, 6656, 268800, 8388608, 262144, 32768, 4, 38903808, 131072, 0, 0, 218104420, 0
    .long 4, 32, 32, 8192, 6912, 269056, 8388608, 262144, 32768, 4, 38907904, 131072, 0, 0, 218104420, 0
    .long 4, 32, 32, 8192, 7168, 269312, 8388608, 262144, 32768, 4, 38912000, 131072, 0, 0, 218104436, 0
    .long 4, 32, 32, 8192, 7424, 269568, 8388608, 262144, 32768, 4, 38916096, 131072, 0, 0, 218104436, 0
    .long 4, 32, 32, 8192, 7680, 269824, 8388608, 262144, 32768, 4, 38920192, 131072, 0, 0, 218104436, 0
    .long 4, 32, 32, 8192, 7936, 270080, 8388608, 262144, 32768, 4, 38924288, 131072, 0, 0, 218104436, 0
    .long 4, 32, 32, 8192, 6656, 268800, 8388608, 786432, 32768, 4, 41000960, 131072, 0, 0, 218104676, 0
    .long 4, 32, 32, 8192, 7680, 269824, 8388608, 786432, 32768, 4, 41017344, 131072, 0, 0, 218104692, 0
    .long 4, 32, 32, 8192, 7936, 270080, 8388608, 524288, 32768, 4, 39972864, 131072, 0, 0, 218104689, 0
    .long 4, 24, 24, 8192, 6656, 268800, 8388608, 786432, 32768, 4, 24223744, 131072, 0, 0, 218104676, 0
    .long 4, 32, 32, 8192, 6656, 268800, 8388608, 524288, 32768, 4, 39952384, 131072, 0, 0, 218104673, 0
    .long 4, 32, 32, 8192, 7936, 270080, 8388608, 786432, 32768, 4, 41021440, 131072, 0, 0, 218104692, 0
    .long 4, 24, 24, 8192, 7680, 269824, 8388608, 786432, 32768, 4, 24240128, 131072, 0, 0, 218104692, 0
    .long 4, 24, 24, 8192, 6400, 268544, 8388608, 524288, 32768, 4, 23171072, 131072, 0, 0, 218104673, 0
    .long 4, 24, 24, 8192, 6912, 269056, 8388608, 524288, 32768, 4, 23179264, 131072, 0, 0, 218104673, 0
    .long 4, 24, 24, 8192, 7424, 269568, 8388608, 524288, 32768, 4, 23187456, 131072, 0, 0, 218104689, 0
    .long 4, 24, 24, 8192, 6912, 269056, 8388608, 786432, 32768, 4, 24227840, 131072, 0, 0, 218104676, 0
    .long 4, 32, 32, 8192, 6400, 268544, 8388608, 524288, 32768, 4, 39948288, 131072, 0, 0, 218104673, 0
    .long 4, 32, 32, 8192, 7168, 269312, 8388608, 524288, 32768, 4, 39960576, 131072, 0, 0, 218104689, 0
    .long 4, 24, 24, 8192, 7680, 269824, 8388608, 524288, 32768, 4, 23191552, 131072, 0, 0, 218104689, 0
    .long 4, 32, 32, 8192, 6912, 269056, 8388608, 524288, 32768, 4, 39956480, 131072, 0, 0, 218104673, 0
    .long 4, 24, 24, 8192, 6144, 268288, 8388608, 524288, 32768, 4, 23166976, 131072, 0, 0, 218104673, 0
    .long 4, 32, 32, 8192, 7168, 269312, 8388608, 786432, 32768, 4, 41009152, 131072, 0, 0, 218104692, 0
    .long 4, 24, 24, 8192, 7936, 270080, 8388608, 786432, 32768, 4, 24244224, 131072, 0, 0, 218104692, 0
    .long 4, 32, 32, 8192, 6144, 268288, 8388608, 524288, 32768, 4, 39944192, 131072, 0, 0, 218104673, 0
    .long 4, 24, 24, 8192, 7424, 269568, 8388608, 786432, 32768, 4, 24236032, 131072, 0, 0, 218104692, 0
    .long 4, 32, 32, 8192, 6400, 268544, 8388608, 786432, 32768, 4, 40996864, 131072, 0, 0, 218104676, 0
    .long 4, 24, 24, 8192, 7168, 269312, 8388608, 786432, 32768, 4, 24231936, 131072, 0, 0, 218104692, 0
    .long 4, 24, 24, 8192, 6656, 268800, 8388608, 524288, 32768, 4, 23175168, 131072, 0, 0, 218104673, 0
    .long 4, 24, 24, 8192, 6400, 268544, 8388608, 786432, 32768, 4, 24219648, 131072, 0, 0, 218104676, 0
    .long 4, 32, 32, 8192, 7424, 269568, 8388608, 786432, 32768, 4, 41013248, 131072, 0, 0, 218104692, 0
    .long 4, 24, 24, 8192, 6144, 268288, 8388608, 786432, 32768, 4, 24215552, 131072, 0, 0, 218104676, 0
    .long 4, 32, 32, 8192, 7680, 269824, 8388608, 524288, 32768, 4, 39968768, 131072, 0, 0, 218104689, 0
    .long 4, 32, 32, 8192, 6912, 269056, 8388608, 786432, 32768, 4, 41005056, 131072, 0, 0, 218104676, 0
    .long 4, 32, 32, 8192, 7424, 269568, 8388608, 524288, 32768, 4, 39964672, 131072, 0, 0, 218104689, 0
    .long 4, 24, 24, 8192, 7168, 269312, 8388608, 524288, 32768, 4, 23183360, 131072, 0, 0, 218104689, 0
    .long 4, 24, 24, 8192, 7936, 270080, 8388608, 524288, 32768, 4, 23195648, 131072, 0, 0, 218104689, 0
    .long 4, 32, 32, 8192, 6144, 268288, 8388608, 786432, 32768, 4, 40992768, 131072, 0, 0, 218104676, 0
    .long 1, 16, 16, 8192, 6144, 6400, 8388608, 1572864, 32768, 8, 10584064, 131072, 0, 0, 218105194, 0
    .long 1, 32, 32, 8192, 6656, 6912, 8388608, 1048576, 32768, 8, 42049536, 131072, 0, 0, 218104938, 0
    .long 1, 32, 32, 8192, 6656, 6912, 8388608, 1572864, 32768, 8, 44146688, 131072, 0, 0, 218105194, 0
    .long 1, 24, 24, 8192, 6656, 6912, 8388608, 1048576, 32768, 8, 25272320, 131072, 0, 0, 218104938, 0
    .long 1, 16, 16, 8192, 7168, 7424, 8388608, 1048576, 32768, 8, 8503296, 131072, 0, 0, 218104954, 0
    .long 1, 16, 16, 8192, 7680, 7936, 8388608, 1048576, 32768, 8, 8511488, 131072, 0, 0, 218104954, 0
    .long 1, 32, 32, 8192, 7680, 7936, 8388608, 1048576, 32768, 8, 42065920, 131072, 0, 0, 218104954, 0
    .long 1, 24, 24, 8192, 7168, 7424, 8388608, 1048576, 32768, 8, 25280512, 131072, 0, 0, 218104954, 0
    .long 1, 24, 24, 8192, 7680, 7936, 8388608, 2097152, 32768, 8, 29483008, 131072, 0, 0, 218105466, 0
    .long 1, 24, 24, 8192, 7680, 7936, 8388608, 1048576, 32768, 8, 25288704, 131072, 0, 0, 218104954, 0
    .long 1, 32, 32, 8192, 7168, 7424, 8388608, 1048576, 32768, 8, 42057728, 131072, 0, 0, 218104954, 0
    .long 1, 24, 24, 8192, 7168, 7424, 8388608, 2097152, 32768, 8, 29474816, 131072, 0, 0, 218105466, 0
    .long 1, 24, 24, 8192, 6144, 6400, 8388608, 1572864, 32768, 8, 27361280, 131072, 0, 0, 218105194, 0
    .long 1, 32, 32, 8192, 6144, 6400, 8388608, 1572864, 32768, 8, 44138496, 131072, 0, 0, 218105194, 0
    .long 1, 24, 24, 8192, 7168, 7424, 8388608, 1572864, 32768, 8, 27377664, 131072, 0, 0, 218105210, 0
    .long 1, 16, 16, 8192, 6144, 6400, 8388608, 1048576, 32768, 8, 8486912, 131072, 0, 0, 218104938, 0
    .long 1, 24, 24, 8192, 6656, 6912, 8388608, 1572864, 32768, 8, 27369472, 131072, 0, 0, 218105194, 0
    .long 1, 16, 16, 8192, 6656, 6912, 8388608, 1572864, 32768, 8, 10592256, 131072, 0, 0, 218105194, 0
    .long 1, 32, 32, 8192, 7168, 7424, 8388608, 1572864, 32768, 8, 44154880, 131072, 0, 0, 218105210, 0
    .long 1, 16, 16, 8192, 7168, 7424, 8388608, 1572864, 32768, 8, 10600448, 131072, 0, 0, 218105210, 0
    .long 1, 32, 32, 8192, 7680, 7936, 8388608, 2097152, 32768, 8, 46260224, 131072, 0, 0, 218105466, 0
    .long 1, 24, 24, 8192, 6144, 6400, 8388608, 1048576, 32768, 8, 25264128, 131072, 0, 0, 218104938, 0
    .long 1, 24, 24, 8192, 6144, 6400, 8388608, 2097152, 32768, 8, 29458432, 131072, 0, 0, 218105450, 0
    .long 1, 16, 16, 8192, 7680, 7936, 8388608, 1572864, 32768, 8, 10608640, 131072, 0, 0, 218105210, 0
    .long 2, 64, 72, 7168, 6144, 6144, 7340032, 1572864, 32768, 8, 60129280, 114688, 0, 0, 218104017, 0
    .long 1, 32, 32, 8192, 6144, 6400, 8388608, 2097152, 32768, 8, 46235648, 131072, 0, 0, 218105450, 0
    .long 1, 32, 32, 8192, 6144, 6400, 8388608, 1048576, 32768, 8, 42041344, 131072, 0, 0, 218104938, 0
    .long 1, 32, 32, 8192, 6656, 6912, 8388608, 2097152, 32768, 8, 46243840, 131072, 0, 0, 218105450, 0
    .long 1, 24, 24, 8192, 7680, 7936, 8388608, 1572864, 32768, 8, 27385856, 131072, 0, 0, 218105210, 0
    .long 1, 32, 32, 8192, 7680, 7936, 8388608, 1572864, 32768, 8, 44163072, 131072, 0, 0, 218105210, 0
    .long 1, 16, 16, 8192, 6656, 6912, 8388608, 1048576, 32768, 8, 8495104, 131072, 0, 0, 218104938, 0
    .long 1, 32, 32, 8192, 7168, 7424, 8388608, 2097152, 32768, 8, 46252032, 131072, 0, 0, 218105466, 0
    .long 1, 16, 16, 8192, 6656, 6912, 8388608, 0, 32768, 8, 4300800, 131072, 0, 0, 218108010, 0
    .long 2, 64, 72, 7168, 6144, 6144, 7340032, 2097152, 32768, 8, 61964288, 114688, 0, 0, 218104081, 0
    .long 1, 16, 16, 8192, 7680, 7936, 8388608, 2097152, 32768, 8, 12705792, 131072, 0, 0, 218105466, 0
    .long 1, 16, 16, 8192, 6656, 6912, 8388608, 524288, 32768, 8, 6397952, 131072, 0, 0, 218108266, 0
    .long 1, 16, 16, 8192, 7680, 7936, 8388608, 3145728, 32768, 8, 16900096, 131072, 0, 0, 218105978, 0
    .long 1, 32, 32, 8192, 7680, 7936, 8388608, 2621440, 32768, 8, 48357376, 131072, 0, 0, 218105722, 0
    .long 1, 16, 16, 8192, 7168, 7424, 8388608, 0, 32768, 8, 4308992, 131072, 0, 0, 218108026, 0
    .long 1, 16, 16, 8192, 6144, 6400, 8388608, 2097152, 32768, 8, 12681216, 131072, 0, 0, 218105450, 0
    .long 1, 16, 16, 8192, 7680, 7936, 8388608, 0, 32768, 8, 4317184, 131072, 0, 0, 218108026, 0
    .long 1, 16, 16, 8192, 6144, 6400, 8388608, 524288, 32768, 8, 6389760, 131072, 0, 0, 218108266, 0
    .long 1, 24, 24, 8192, 7168, 7424, 8388608, 3145728, 32768, 8, 33669120, 131072, 0, 0, 218105978, 0
    .long 1, 24, 24, 8192, 6656, 6912, 8388608, 2621440, 32768, 8, 31563776, 131072, 0, 0, 218105706, 0
    .long 1, 16, 16, 8192, 6656, 6912, 8388608, 2621440, 32768, 8, 14786560, 131072, 0, 0, 218105706, 0
    .long 1, 16, 16, 8192, 7168, 7424, 8388608, 524288, 32768, 8, 6406144, 131072, 0, 0, 218108282, 0
    .long 2, 64, 72, 7168, 6656, 6656, 7340032, 0, 32768, 8, 54632448, 114688, 0, 0, 218103825, 0
    .long 2, 64, 72, 7168, 6144, 6144, 7340032, 0, 32768, 8, 54624256, 114688, 0, 0, 218103825, 0
    .long 2, 64, 72, 7168, 6656, 6656, 7340032, 1048576, 32768, 8, 58302464, 114688, 0, 0, 218103953, 0
    .long 1, 16, 16, 8192, 6144, 6400, 8388608, 0, 32768, 8, 4292608, 131072, 0, 0, 218108010, 0
    .long 1, 16, 16, 8192, 7680, 7936, 8388608, 524288, 32768, 8, 6414336, 131072, 0, 0, 218108282, 0
    .long 1, 24, 24, 8192, 7168, 7424, 8388608, 2621440, 32768, 8, 31571968, 131072, 0, 0, 218105722, 0
    .long 1, 16, 16, 8192, 7680, 7936, 8388608, 2621440, 32768, 8, 14802944, 131072, 0, 0, 218105722, 0
    .long 1, 24, 24, 8192, 6656, 6912, 8388608, 2097152, 32768, 8, 29466624, 131072, 0, 0, 218105450, 0
    .long 2, 64, 72, 7168, 6656, 6656, 7340032, 2097152, 32768, 8, 61972480, 114688, 0, 0, 218104081, 0
    .long 1, 16, 16, 8192, 6656, 6912, 8388608, 3145728, 32768, 8, 16883712, 131072, 0, 0, 218105962, 0
    .long 1, 16, 16, 8192, 6656, 6912, 8388608, 2097152, 32768, 8, 12689408, 131072, 0, 0, 218105450, 0
    .long 2, 64, 72, 7168, 6144, 6144, 7340032, 3670016, 32768, 8, 67469312, 114688, 0, 0, 218104276, 0
    .long 1, 24, 24, 8192, 6656, 6912, 8388608, 3145728, 32768, 8, 33660928, 131072, 0, 0, 218105962, 0
    .long 2, 64, 72, 7168, 5888, 5888, 7340032, 2097152, 32768, 8, 61960192, 114688, 0, 0, 218104081, 0
    .long 1, 16, 16, 8192, 7168, 7424, 8388608, 2097152, 32768, 8, 12697600, 131072, 0, 0, 218105466, 0
    .long 2, 64, 72, 7168, 6656, 6656, 7340032, 2621440, 32768, 8, 63807488, 114688, 0, 0, 218104148, 0
    .long 1, 32, 32, 8192, 7680, 7936, 8388608, 3145728, 32768, 8, 50454528, 131072, 0, 0, 218105978, 0
    .long 1, 24, 24, 8192, 6144, 6400, 8388608, 2621440, 32768, 8, 31555584, 131072, 0, 0, 218105706, 0
    .long 2, 64, 72, 7168, 5376, 5376, 7340032, 1048576, 32768, 8, 58281984, 114688, 0, 0, 218103953, 0
    .long 1, 32, 32, 8192, 7168, 7424, 8388608, 3145728, 32768, 8, 50446336, 131072, 0, 0, 218105978, 0
    .long 2, 64, 72, 7168, 6144, 6144, 7340032, 3145728, 32768, 8, 65634304, 114688, 0, 0, 218104212, 0
    .long 1, 16, 16, 8192, 6144, 6400, 8388608, 3145728, 32768, 8, 16875520, 131072, 0, 0, 218105962, 0
    .long 2, 64, 72, 7168, 6912, 6912, 7340032, 1048576, 32768, 8, 58306560, 114688, 0, 0, 218103953, 0
    .long 2, 64, 72, 7168, 5376, 5376, 7340032, 3145728, 32768, 8, 65622016, 114688, 0, 0, 218104212, 0
    .long 2, 64, 72, 7168, 6144, 6144, 7340032, 2621440, 32768, 8, 63799296, 114688, 0, 0, 218104148, 0
    .long 2, 64, 72, 7168, 5632, 5632, 7340032, 1048576, 32768, 8, 58286080, 114688, 0, 0, 218103953, 0
    .long 2, 64, 72, 7168, 6400, 6400, 7340032, 3145728, 32768, 8, 65638400, 114688, 0, 0, 218104212, 0
    .long 1, 16, 16, 8192, 7168, 7424, 8388608, 2621440, 32768, 8, 14794752, 131072, 0, 0, 218105722, 0
    .long 1, 32, 32, 8192, 6144, 6400, 8388608, 2621440, 32768, 8, 48332800, 131072, 0, 0, 218105706, 0
    .long 1, 16, 16, 8192, 6144, 6400, 8388608, 2621440, 32768, 8, 14778368, 131072, 0, 0, 218105706, 0
    .long 5, 218108256, 0, 0, 24, 0, 0, 8, 0, 0, 0, 0, 218112384, 12, 218106961, 0
    .long 2, 64, 72, 7168, 5632, 5632, 7340032, 524288, 32768, 8, 56451072, 114688, 0, 0, 218103889, 0
    .long 2, 64, 72, 7168, 6400, 6400, 7340032, 0, 32768, 8, 54628352, 114688, 0, 0, 218103825, 0
    .long 1, 24, 24, 8192, 6144, 6400, 8388608, 3145728, 32768, 8, 33652736, 131072, 0, 0, 218105962, 0
    .long 2, 64, 72, 7168, 6912, 6912, 7340032, 0, 32768, 8, 54636544, 114688, 0, 0, 218103825, 0
    .long 5, 218108000, 0, 0, 24, 0, 0, 0, 0, 0, 0, 0, 218112384, 4, 218106897, 0
    .long 1, 32, 32, 8192, 6656, 6912, 8388608, 3145728, 32768, 8, 50438144, 131072, 0, 0, 218105962, 0
    .long 5, 218108272, 0, 0, 28, 0, 0, 8, 0, 0, 0, 0, 218112384, 12, 218106961, 0
    .long 1, 24, 24, 8192, 7680, 7936, 8388608, 2621440, 32768, 8, 31580160, 131072, 0, 0, 218105722, 0
    .long 1, 32, 32, 8192, 7168, 7424, 8388608, 2621440, 32768, 8, 48349184, 131072, 0, 0, 218105722, 0
    .long 2, 64, 72, 7168, 6144, 6144, 7340032, 1048576, 32768, 8, 58294272, 114688, 0, 0, 218103953, 0
    .long 2, 64, 72, 7168, 6144, 6144, 7340032, 524288, 32768, 8, 56459264, 114688, 0, 0, 218103889, 0
    .long 2, 64, 72, 7168, 5888, 5888, 7340032, 524288, 32768, 8, 56455168, 114688, 0, 0, 218103889, 0
    .long 2, 64, 72, 7168, 6400, 6400, 7340032, 1048576, 32768, 8, 58298368, 114688, 0, 0, 218103953, 0
    .long 1, 32, 32, 8192, 6656, 6912, 8388608, 2621440, 32768, 8, 48340992, 131072, 0, 0, 218105706, 0
    .long 2, 64, 72, 7168, 5888, 5888, 7340032, 1048576, 32768, 8, 58290176, 114688, 0, 0, 218103953, 0
    .long 1, 16, 16, 8192, 7168, 7424, 8388608, 3670016, 32768, 8, 18989056, 131072, 0, 0, 218106234, 0
    .long 2, 64, 72, 7168, 6400, 6400, 7340032, 524288, 32768, 8, 56463360, 114688, 0, 0, 218103889, 0
    .long 1, 16, 16, 8192, 7168, 7424, 8388608, 3145728, 32768, 8, 16891904, 131072, 0, 0, 218105978, 0
    .long 5, 218108016, 0, 0, 28, 0, 0, 0, 0, 0, 0, 0, 218112384, 4, 218106897, 0
    .long 5, 218108016, 0, 0, 28, 0, 0, 4, 0, 0, 0, 0, 218112384, 8, 218106897, 0
    .long 5, 218108272, 0, 0, 28, 0, 0, 12, 0, 0, 0, 0, 218112384, 16, 218106961, 0
    .long 5, 218108256, 0, 0, 24, 0, 0, 12, 0, 0, 0, 0, 218112384, 16, 218106961, 0
    .long 5, 218108000, 0, 0, 24, 0, 0, 4, 0, 0, 0, 0, 218112384, 8, 218106897, 0
    .long 1, 32, 32, 8192, 6144, 6400, 8388608, 3145728, 32768, 8, 50429952, 131072, 0, 0, 218105962, 0
    .long 2, 64, 72, 7168, 5888, 5888, 7340032, 1572864, 32768, 8, 60125184, 114688, 0, 0, 218104017, 0
    .long 2, 64, 72, 7168, 5376, 5376, 7340032, 1572864, 32768, 8, 60116992, 114688, 0, 0, 218104017, 0
    .long 2, 64, 72, 7168, 5632, 5632, 7340032, 0, 32768, 8, 54616064, 114688, 0, 0, 218103825, 0
    .long 1, 24, 24, 8192, 7680, 7936, 8388608, 3145728, 32768, 8, 33677312, 131072, 0, 0, 218105978, 0
    .long 2, 64, 72, 7168, 6912, 6912, 7340032, 3145728, 32768, 8, 65646592, 114688, 0, 0, 218104212, 0
    .long 2, 64, 72, 7168, 5376, 5376, 7340032, 2621440, 32768, 8, 63787008, 114688, 0, 0, 218104148, 0
    .long 2, 64, 72, 7168, 5888, 5888, 7340032, 0, 32768, 8, 54620160, 114688, 0, 0, 218103825, 0
    .long 2, 64, 72, 7168, 6400, 6400, 7340032, 2097152, 32768, 8, 61968384, 114688, 0, 0, 218104081, 0
    .long 2, 64, 72, 7168, 6912, 6912, 7340032, 524288, 32768, 8, 56471552, 114688, 0, 0, 218103889, 0
    .long 2, 64, 72, 7168, 5632, 5632, 7340032, 2097152, 32768, 8, 61956096, 114688, 0, 0, 218104081, 0
    .long 2, 64, 72, 7168, 6912, 6912, 7340032, 1572864, 32768, 8, 60141568, 114688, 0, 0, 218104017, 0
    .long 2, 64, 72, 7168, 5376, 5376, 7340032, 0, 32768, 8, 54611968, 114688, 0, 0, 218103825, 0
    .long 2, 64, 72, 7168, 6400, 6400, 7340032, 3670016, 32768, 8, 67473408, 114688, 0, 0, 218104276, 0
    .long 2, 64, 72, 7168, 5376, 5376, 7340032, 524288, 32768, 8, 56446976, 114688, 0, 0, 218103889, 0
    .long 2, 64, 72, 7168, 6656, 6656, 7340032, 524288, 32768, 8, 56467456, 114688, 0, 0, 218103889, 0
    .long 2, 64, 72, 7168, 6912, 6912, 7340032, 2097152, 32768, 8, 61976576, 114688, 0, 0, 218104081, 0
    .long 1, 24, 24, 8192, 7680, 7936, 8388608, 3670016, 32768, 8, 35774464, 131072, 0, 0, 218106234, 0
    .long 2, 64, 72, 7168, 5888, 5888, 7340032, 2621440, 32768, 8, 63795200, 114688, 0, 0, 218104148, 0
    .long 2, 64, 72, 7168, 6400, 6400, 7340032, 1572864, 32768, 8, 60133376, 114688, 0, 0, 218104017, 0
    .long 2, 64, 72, 7168, 5376, 5376, 7340032, 2097152, 32768, 8, 61952000, 114688, 0, 0, 218104081, 0
    .long 2, 64, 72, 7168, 6656, 6656, 7340032, 3145728, 32768, 8, 65642496, 114688, 0, 0, 218104212, 0
    .long 2, 64, 72, 7168, 5632, 5632, 7340032, 1572864, 32768, 8, 60121088, 114688, 0, 0, 218104017, 0
    .long 2, 64, 72, 7168, 5632, 5632, 7340032, 2621440, 32768, 8, 63791104, 114688, 0, 0, 218104148, 0
    .long 1, 24, 24, 8192, 6144, 6400, 8388608, 3670016, 32768, 8, 35749888, 131072, 0, 0, 218106218, 0
    .long 2, 64, 72, 7168, 6912, 6912, 7340032, 2621440, 32768, 8, 63811584, 114688, 0, 0, 218104148, 0
    .long 2, 64, 72, 7168, 6400, 6400, 7340032, 2621440, 32768, 8, 63803392, 114688, 0, 0, 218104148, 0
    .long 2, 64, 72, 7168, 6656, 6656, 7340032, 3670016, 32768, 8, 67477504, 114688, 0, 0, 218104276, 0
    .long 2, 64, 72, 7168, 6656, 6656, 7340032, 1572864, 32768, 8, 60137472, 114688, 0, 0, 218104017, 0
    .long 1, 40, 40, 2048, 4195840, 4196096, 8388608, 180420608, 131072, 16, 80764928, 32768, 218112384, 25, 218106504, 0
    .long 1, 80, 80, 2048, 3671040, 3671296, 7340032, 58253312, 114688, 14, 122699776, 32768, 218103952, 14, 218106498, 0
    .long 1, 24, 24, 8192, 7168, 7424, 8388608, 3670016, 32768, 8, 35766272, 131072, 0, 0, 218106234, 0
    .long 1, 40, 40, 2048, 4195328, 4195584, 8388608, 180420608, 131072, 16, 80756736, 32768, 218112384, 25, 218106504, 0
    .long 1, 40, 40, 2048, 4195328, 4195584, 8388608, 178323456, 131072, 16, 80232448, 32768, 218106960, 8, 218106440, 0
    .long 2, 64, 72, 7168, 5888, 5888, 7340032, 3145728, 32768, 8, 65630208, 114688, 0, 0, 218104212, 0
    .long 1, 40, 40, 2048, 4195840, 4196096, 8388608, 178323456, 131072, 16, 80240640, 32768, 218106960, 8, 218106440, 0
    .long 1, 80, 80, 2048, 3671552, 3671808, 7340032, 58253312, 114688, 14, 122707968, 32768, 218103952, 14, 218106498, 0
    .long 2, 64, 72, 7168, 5632, 5632, 7340032, 3145728, 32768, 8, 65626112, 114688, 0, 0, 218104212, 0
    .long 1, 32, 32, 8192, 6656, 6912, 8388608, 3670016, 32768, 8, 52535296, 131072, 0, 0, 218106218, 0
    .long 1, 16, 16, 8192, 6656, 6912, 8388608, 3670016, 32768, 8, 18980864, 131072, 0, 0, 218106218, 0
    .long 1, 40, 40, 2048, 4195840, 4196096, 8388608, 176226304, 131072, 16, 79716352, 32768, 218106896, 8, 218106376, 0
    .long 1, 40, 40, 2048, 4195328, 4195584, 8388608, 176226304, 131072, 16, 79708160, 32768, 218106896, 8, 218106376, 0
    .long 1, 32, 32, 8192, 6144, 6400, 8388608, 3670016, 32768, 8, 52527104, 131072, 0, 0, 218106218, 0
    .long 1, 24, 24, 8192, 6656, 6912, 8388608, 3670016, 32768, 8, 35758080, 131072, 0, 0, 218106218, 0
    .long 1, 16, 16, 8192, 6144, 6400, 8388608, 3670016, 32768, 8, 18972672, 131072, 0, 0, 218106218, 0
    .long 1, 32, 32, 8192, 7168, 7424, 8388608, 3670016, 32768, 8, 52543488, 131072, 0, 0, 218106234, 0
    .long 1, 32, 32, 8192, 7680, 7936, 8388608, 3670016, 32768, 8, 52551680, 131072, 0, 0, 218106234, 0
    .long 2, 64, 72, 7168, 5888, 5888, 7340032, 3670016, 32768, 8, 67465216, 114688, 0, 0, 218104276, 0
    .long 2, 64, 72, 7168, 5376, 5376, 7340032, 3670016, 32768, 8, 67457024, 114688, 0, 0, 218104276, 0
    .long 1, 16, 16, 8192, 7680, 7936, 8388608, 3670016, 32768, 8, 18997248, 131072, 0, 0, 218106234, 0
    .long 2, 64, 72, 7168, 6912, 6912, 7340032, 3670016, 32768, 8, 67481600, 114688, 0, 0, 218104276, 0
    .long 1, 80, 80, 2048, 3671552, 3671808, 7340032, 56418304, 114688, 14, 122183680, 32768, 218103888, 14, 218106434, 0
    .long 1, 80, 80, 2048, 3671040, 3671296, 7340032, 54583296, 114688, 14, 121651200, 32768, 218103824, 14, 218106370, 0
    .long 1, 80, 80, 2048, 3671040, 3671296, 7340032, 61923328, 114688, 14, 123748352, 32768, 218104080, 14, 218106626, 0
    .long 1, 80, 80, 2048, 3671040, 3671296, 7340032, 56418304, 114688, 14, 122175488, 32768, 218103888, 14, 218106434, 0
    .long 2, 64, 72, 7168, 5632, 5632, 7340032, 3670016, 32768, 8, 67461120, 114688, 0, 0, 218104276, 0
    .long 1, 40, 40, 2048, 4195328, 4195584, 8388608, 182517760, 131072, 16, 81281024, 32768, 218112384, 33, 218106568, 0
    .long 1, 40, 40, 2048, 4195840, 4196096, 8388608, 182517760, 131072, 16, 81289216, 32768, 218112384, 33, 218106568, 0
    .long 1, 80, 80, 2048, 3671552, 3671808, 7340032, 61923328, 114688, 14, 123756544, 32768, 218104080, 14, 218106626, 0
    .long 1, 80, 80, 2048, 3671552, 3671808, 7340032, 54583296, 114688, 14, 121659392, 32768, 218103824, 14, 218106370, 0
    .long 1, 80, 80, 2048, 3671552, 3671808, 7340032, 60088320, 114688, 14, 123232256, 32768, 218104016, 14, 218106562, 0
    .long 1, 80, 80, 2048, 3671040, 3671296, 7340032, 60088320, 114688, 14, 123224064, 32768, 218104016, 14, 218106562, 0
    .long 1, 40, 40, 2048, 6291968, 6292224, 8388608, 184647680, 131072, 8, 90185728, 32768, 218112384, 41, 218106628, 0
    .long 1, 40, 40, 2048, 6291456, 6291712, 8388608, 184647680, 131072, 8, 90177536, 32768, 218112384, 41, 218106628, 0
    .long 1, 40, 40, 2048, 6292992, 6293248, 8388608, 184647680, 131072, 8, 90202112, 32768, 218112384, 41, 218106628, 0
    .long 1, 40, 40, 2048, 6292480, 6292736, 8388608, 184647680, 131072, 8, 90193920, 32768, 218112384, 41, 218106628, 0
    .long 1, 80, 80, 2048, 5506560, 5506816, 7340032, 63787008, 114688, 7, 132669440, 32768, 218104148, 7, 218106689, 0
    .long 1, 80, 80, 2048, 5506048, 5506304, 7340032, 63787008, 114688, 7, 132661248, 32768, 218104148, 7, 218106689, 0
    .long 1, 80, 80, 2048, 5505024, 5505280, 7340032, 63787008, 114688, 7, 132644864, 32768, 218104148, 7, 218106689, 0
    .long 1, 80, 80, 2048, 5505536, 5505792, 7340032, 63787008, 114688, 7, 132653056, 32768, 218104148, 7, 218106689, 0
    .long 1, 80, 80, 2048, 5505536, 5505792, 7340032, 65622016, 114688, 7, 133177344, 32768, 218104212, 7, 218106753, 0
    .long 1, 80, 80, 2048, 5505024, 5505280, 7340032, 65622016, 114688, 7, 133169152, 32768, 218104212, 7, 218106753, 0
    .long 1, 80, 80, 2048, 5506560, 5506816, 7340032, 65622016, 114688, 7, 133193728, 32768, 218104212, 7, 218106753, 0
    .long 1, 40, 40, 2048, 6291968, 6292224, 8388608, 186744832, 131072, 8, 90710016, 32768, 218112384, 49, 218106692, 0
    .long 1, 80, 80, 2048, 5506048, 5506304, 7340032, 65622016, 114688, 7, 133185536, 32768, 218104212, 7, 218106753, 0
    .long 1, 40, 40, 2048, 6292480, 6292736, 8388608, 186744832, 131072, 8, 90718208, 32768, 218112384, 49, 218106692, 0
    .long 1, 40, 40, 2048, 6292992, 6293248, 8388608, 186744832, 131072, 8, 90726400, 32768, 218112384, 49, 218106692, 0
    .long 1, 40, 40, 2048, 6291456, 6291712, 8388608, 186744832, 131072, 8, 90701824, 32768, 218112384, 49, 218106692, 0
    .long 1, 80, 80, 2048, 5506560, 5506816, 7340032, 67457024, 114688, 7, 133718016, 32768, 218104276, 7, 218106817, 0
    .long 1, 80, 80, 2048, 5505536, 5505792, 7340032, 67457024, 114688, 7, 133701632, 32768, 218104276, 7, 218106817, 0
    .long 1, 80, 80, 2048, 5506048, 5506304, 7340032, 67457024, 114688, 7, 133709824, 32768, 218104276, 7, 218106817, 0
    .long 1, 80, 80, 2048, 5505024, 5505280, 7340032, 67457024, 114688, 7, 133693440, 32768, 218104276, 7, 218106817, 0
    .long 6, 1, 0, 2, 3, 16, 0, 23, 0, 0, 0, 0, 0, 0, 0, 0
    .long 6, 1, 0, 2, 3, 16, 0, 17, 0, 0, 0, 0, 0, 0, 0, 0
    .long 6, 1, 0, 2, 3, 16, 0, 20, 0, 0, 0, 0, 0, 0, 0, 0
    .long 6, 1, 0, 2, 3, 16, 0, 10, 0, 0, 0, 0, 0, 0, 0, 0
    .long 6, 1, 0, 2, 3, 16, 0, 6, 0, 0, 0, 0, 0, 0, 0, 0
    .long 6, 1, 0, 2, 3, 16, 0, 13, 0, 0, 0, 0, 0, 0, 0, 0
    .long 6, 1, 0, 1, 3, 16, 0, 38, 0, 0, 0, 0, 0, 0, 0, 0
    .long 6, 1, 0, 2, 3, 16, 0, 18, 0, 0, 0, 0, 0, 0, 0, 0
    .long 6, 1, 0, 2, 3, 16, 0, 9, 0, 0, 0, 0, 0, 0, 0, 0
    .long 6, 1, 0, 2, 3, 16, 0, 2, 0, 0, 0, 0, 0, 0, 0, 0
    .long 6, 1, 0, 2, 3, 16, 0, 5, 0, 0, 0, 0, 0, 0, 0, 0
    .long 6, 1, 0, 1, 3, 16, 0, 34, 0, 0, 0, 0, 0, 0, 0, 0
    .long 6, 1, 0, 2, 3, 16, 0, 7, 0, 0, 0, 0, 0, 0, 0, 0
    .long 6, 1, 0, 2, 3, 16, 0, 1, 0, 0, 0, 0, 0, 0, 0, 0
    .long 6, 1, 0, 2, 3, 16, 0, 12, 0, 0, 0, 0, 0, 0, 0, 0
    .long 6, 1, 0, 2, 3, 16, 0, 14, 0, 0, 0, 0, 0, 0, 0, 0
    .long 6, 1, 0, 2, 3, 16, 0, 0, 0, 0, 0, 0, 0, 0, 0, 0
    .long 6, 1, 0, 2, 3, 16, 0, 3, 0, 0, 0, 0, 0, 0, 0, 0
    .long 6, 1, 0, 2, 3, 16, 0, 22, 0, 0, 0, 0, 0, 0, 0, 0
    .long 6, 1, 0, 2, 3, 16, 0, 21, 0, 0, 0, 0, 0, 0, 0, 0
    .long 6, 1, 0, 2, 3, 16, 0, 8, 0, 0, 0, 0, 0, 0, 0, 0
    .long 6, 1, 0, 2, 3, 16, 0, 15, 0, 0, 0, 0, 0, 0, 0, 0
    .long 6, 1, 0, 2, 3, 16, 0, 19, 0, 0, 0, 0, 0, 0, 0, 0
    .long 6, 1, 0, 2, 3, 16, 0, 11, 0, 0, 0, 0, 0, 0, 0, 0
    .long 6, 1, 0, 2, 3, 16, 0, 16, 0, 0, 0, 0, 0, 0, 0, 0
    .long 6, 1, 0, 2, 3, 16, 0, 4, 0, 0, 0, 0, 0, 0, 0, 0
    .long 6, 0, 0, 0, 3, 0, 0, 54, 0, 0, 0, 0, 0, 0, 0, 0
    .long 6, 0, 0, 0, 3, 0, 0, 51, 0, 0, 0, 0, 0, 0, 0, 0
    .long 6, 0, 0, 0, 3, 0, 0, 48, 0, 0, 0, 0, 0, 0, 0, 0
    .long 6, 0, 0, 0, 3, 0, 0, 49, 0, 0, 0, 0, 0, 0, 0, 0
    .long 6, 0, 0, 0, 3, 0, 0, 50, 0, 0, 0, 0, 0, 0, 0, 0
    .long 6, 0, 0, 0, 3, 0, 0, 52, 0, 0, 0, 0, 0, 0, 0, 0
    .long 6, 0, 0, 0, 3, 0, 0, 53, 0, 0, 0, 0, 0, 0, 0, 0
    .long 6, 0, 0, 0, 3, 0, 0, 55, 0, 0, 0, 0, 0, 0, 0, 0
    .long 6, 1, 0, 1, 3, 16, 0, 32, 0, 0, 0, 0, 0, 0, 0, 0
    .long 6, 1, 0, 1, 3, 16, 0, 33, 0, 0, 0, 0, 0, 0, 0, 0
    .long 6, 1, 0, 1, 3, 16, 0, 35, 0, 0, 0, 0, 0, 0, 0, 0
    .long 6, 1, 0, 1, 3, 16, 0, 36, 0, 0, 0, 0, 0, 0, 0, 0
    .long 6, 1, 0, 1, 3, 16, 0, 37, 0, 0, 0, 0, 0, 0, 0, 0
    .long 6, 1, 0, 1, 3, 16, 0, 39, 0, 0, 0, 0, 0, 0, 0, 0
    .long 6, 1, 0, 2, 3, 16, 0, 24, 0, 0, 0, 0, 0, 0, 0, 0
    .long 6, 1, 0, 2, 3, 16, 0, 26, 0, 0, 0, 0, 0, 0, 0, 0
    .long 6, 1, 0, 2, 3, 16, 0, 27, 0, 0, 0, 0, 0, 0, 0, 0
    .long 6, 1, 0, 2, 3, 16, 0, 28, 0, 0, 0, 0, 0, 0, 0, 0
    .long 6, 1, 0, 2, 3, 16, 0, 29, 0, 0, 0, 0, 0, 0, 0, 0
    .long 6, 1, 0, 2, 3, 16, 0, 30, 0, 0, 0, 0, 0, 0, 0, 0
    .long 6, 1, 0, 2, 3, 16, 0, 31, 0, 0, 0, 0, 0, 0, 0, 0
    .long 6, 1, 0, 2, 3, 16, 0, 25, 0, 0, 0, 0, 0, 0, 0, 0
    .long 6, 0, 0, 1, 3, 16, 0, 40, 0, 0, 0, 0, 0, 0, 0, 0
    .long 6, 0, 0, 1, 3, 16, 0, 41, 0, 0, 0, 0, 0, 0, 0, 0
    .long 6, 0, 0, 1, 3, 16, 0, 42, 0, 0, 0, 0, 0, 0, 0, 0
    .long 6, 0, 0, 1, 3, 16, 0, 43, 0, 0, 0, 0, 0, 0, 0, 0
    .long 6, 0, 0, 1, 3, 16, 0, 44, 0, 0, 0, 0, 0, 0, 0, 0
    .long 6, 0, 0, 1, 3, 16, 0, 47, 0, 0, 0, 0, 0, 0, 0, 0
    .long 6, 0, 0, 1, 3, 16, 0, 46, 0, 0, 0, 0, 0, 0, 0, 0
    .long 6, 0, 0, 1, 3, 16, 0, 45, 0, 0, 0, 0, 0, 0, 0, 0
    .long 6, 0, 0, 0, 3, 0, 0, 56, 0, 0, 0, 0, 0, 0, 0, 0
    .long 6, 0, 0, 0, 3, 0, 0, 57, 0, 0, 0, 0, 0, 0, 0, 0
    .long 6, 0, 0, 0, 3, 0, 0, 58, 0, 0, 0, 0, 0, 0, 0, 0
    .long 6, 0, 0, 0, 3, 0, 0, 59, 0, 0, 0, 0, 0, 0, 0, 0
    .long 6, 0, 0, 0, 3, 0, 0, 60, 0, 0, 0, 0, 0, 0, 0, 0
    .long 7, 0, 0, 0, 12, 0, 0, 61, 0, 0, 0, 0, 0, 0, 0, 0
    .long 7, 0, 0, 0, 13, 0, 0, 61, 0, 0, 0, 0, 0, 0, 0, 0
    .long 7, 0, 0, 0, 14, 0, 0, 61, 0, 0, 0, 0, 0, 0, 0, 0
    .long 7, 0, 0, 0, 15, 0, 0, 61, 0, 0, 0, 0, 0, 0, 0, 0
    .long 7, 0, 0, 0, 12, 0, 0, 62, 0, 0, 0, 0, 0, 0, 0, 0
    .long 7, 0, 0, 0, 13, 0, 0, 62, 0, 0, 0, 0, 0, 0, 0, 0
    .long 7, 0, 0, 0, 14, 0, 0, 62, 0, 0, 0, 0, 0, 0, 0, 0
    .long 7, 0, 0, 0, 15, 0, 0, 62, 0, 0, 0, 0, 0, 0, 0, 0
    .long 7, 0, 0, 0, 12, 0, 0, 63, 0, 0, 0, 0, 0, 0, 0, 0
    .long 7, 0, 0, 0, 13, 0, 0, 63, 0, 0, 0, 0, 0, 0, 0, 0
    .long 7, 0, 0, 0, 14, 0, 0, 63, 0, 0, 0, 0, 0, 0, 0, 0
    .long 7, 0, 0, 0, 15, 0, 0, 63, 0, 0, 0, 0, 0, 0, 0, 0
    .long 0, 0, 0, 0, 0, 0, 0, 0, 0, 0, 0, 0, 0, 0, 0, 0
.p2align 6
.amdhsa_kernel recurrent_scan__memory_aug_recurrent_mem_tr__glu_gated_glu__prompt_kernel
  .amdhsa_next_free_vgpr 256
  .amdhsa_next_free_sgpr 102
  .amdhsa_accum_offset 256
  .amdhsa_group_segment_fixed_size 0
  .amdhsa_kernarg_size 112
  .amdhsa_user_sgpr_count 2
  .amdhsa_user_sgpr_kernarg_segment_ptr 1
  .amdhsa_system_sgpr_workgroup_id_x 1
  .amdhsa_float_denorm_mode_32 3
.end_amdhsa_kernel
```

```asm
; @launch grid=(256,1,1) block=(512,1,1) lds=163840
.amdgcn_target "amdgcn-amd-amdhsa--gfx950"
.text
.globl recurrent_scan__memory_aug_recurrent_mem_tr__glu_gated_glu__prompt_kernel
.p2align 8
.type recurrent_scan__memory_aug_recurrent_mem_tr__glu_gated_glu__prompt_kernel,@function
recurrent_scan__memory_aug_recurrent_mem_tr__glu_gated_glu__prompt_kernel:
    s_cmp_ge_u32 s2, 256
    s_cbranch_scc1 k_exit
    s_mov_b32 s99, s2
    s_load_dwordx2 s[4:5], s[0:1], 104
    s_load_dwordx2 s[64:65], s[0:1], 96
    v_lshrrev_b32 v2, 6, v0
    s_mov_b32 s6, 268435456
    s_mov_b32 s7, 131072
    s_mov_b32 s66, 256
    s_mov_b32 s67, 131072
    v_readfirstlane_b32 s3, v2
    s_getreg_b32 s14, hwreg(HW_REG_XCC_ID)
    s_waitcnt lgkmcnt(0)
    s_mov_b32 s98, s2
    s_sub_u32 s97, s14, s2
    s_and_b32 s97, s97, 7
    s_or_b32 s15, s2, s3
    s_cmp_lg_u32 s15, 0
    s_cbranch_scc1 k_disp
    s_add_u32 s14, s97, 1
    v_mov_b32 v2, s14
    s_mov_b64 exec, 1
    buffer_store_dword v2, off, s[64:67], 0 offset:224 sc1
    s_mov_b64 exec, -1
    s_branch k_disp
k_restart:
    s_waitcnt vmcnt(0) lgkmcnt(0)
    s_barrier
k_disp:
    s_add_u32 s14, s97, s98
    s_and_b32 s14, s14, 7
    s_andn2_b32 s2, s98, 7
    s_or_b32 s2, s2, s14
    s_mov_b32 s99, s2
    s_lshr_b32 s13, s2, 3
    s_and_b32 s12, s2, 3
    s_waitcnt lgkmcnt(0)
    s_bitcmp0_b32 s2, 2
    s_cbranch_scc1 chain_map
    s_lshl_b32 s63, s13, 2
    s_add_u32 s63, s63, s12
    s_mov_b32 s17, s63
    s_mov_b32 s19, s3
    s_mov_b32 s18, 0
    s_cmp_ge_u32 s3, 4
    s_cbranch_scc1 ln_touch
    s_load_dwordx2 s[8:9], s[0:1], 0
    v_and_b32 v1, 63, v0
    s_mov_b32 s10, 4194304
    s_mov_b32 s11, 131072
    v_and_b32 v3, 15, v1
    v_lshrrev_b32 v4, 4, v1
    v_lshlrev_b32 v5, 11, v3
    v_lshl_add_u32 v5, v4, 4, v5
    s_lshl_b32 s12, s17, 15
    s_lshl_b32 s13, s19, 9
    s_add_u32 s12, s12, s13
    s_waitcnt lgkmcnt(0)
    buffer_load_dwordx4 v[16:19], v5, s[8:11], s12 offen offset:0
    buffer_load_dwordx4 v[20:23], v5, s[8:11], s12 offen offset:64
    buffer_load_dwordx4 v[24:27], v5, s[8:11], s12 offen offset:128
    buffer_load_dwordx4 v[28:31], v5, s[8:11], s12 offen offset:192
    buffer_load_dwordx4 v[32:35], v5, s[8:11], s12 offen offset:256
    buffer_load_dwordx4 v[36:39], v5, s[8:11], s12 offen offset:320
    buffer_load_dwordx4 v[40:43], v5, s[8:11], s12 offen offset:384
    buffer_load_dwordx4 v[44:47], v5, s[8:11], s12 offen offset:448
    v_mov_b32 v14, 0
    s_lshl_b32 s13, s63, 7
    s_add_u32 s13, s13, 218103808
    v_lshlrev_b32 v13, 2, v0
    v_lshlrev_b32 v6, 4, v3
    s_lshl_b32 s14, s18, 10
    v_add_u32 v6, s14, v6
    s_lshl_b32 s14, s19, 2
    v_add_u32 v7, s14, v6
    v_lshlrev_b32 v8, 4, v1
    s_lshl_b32 s15, s17, 15
    s_lshl_b32 s16, s19, 13
    s_add_u32 s15, s15, s16
    s_add_u32 s16, s15, 4096
    v_and_b32 v9, 1, v4
    v_cmp_eq_u32 s[20:21], 1, v9
    s_waitcnt vmcnt(0)
    v_lshlrev_b32 v48, 16, v16
    v_and_b32 v49, 0xffff0000, v16
    v_lshlrev_b32 v50, 16, v17
    v_and_b32 v51, 0xffff0000, v17
    v_lshlrev_b32 v52, 16, v18
    v_and_b32 v53, 0xffff0000, v18
    v_lshlrev_b32 v54, 16, v19
    v_and_b32 v55, 0xffff0000, v19
    v_lshlrev_b32 v56, 16, v20
    v_and_b32 v57, 0xffff0000, v20
    v_lshlrev_b32 v58, 16, v21
    v_and_b32 v59, 0xffff0000, v21
    v_lshlrev_b32 v60, 16, v22
    v_and_b32 v61, 0xffff0000, v22
    v_lshlrev_b32 v62, 16, v23
    v_and_b32 v63, 0xffff0000, v23
    v_lshlrev_b32 v64, 16, v24
    v_and_b32 v65, 0xffff0000, v24
    v_lshlrev_b32 v66, 16, v25
    v_and_b32 v67, 0xffff0000, v25
    v_lshlrev_b32 v68, 16, v26
    v_and_b32 v69, 0xffff0000, v26
    v_lshlrev_b32 v70, 16, v27
    v_and_b32 v71, 0xffff0000, v27
    v_lshlrev_b32 v72, 16, v28
    v_and_b32 v73, 0xffff0000, v28
    v_lshlrev_b32 v74, 16, v29
    v_and_b32 v75, 0xffff0000, v29
    v_lshlrev_b32 v76, 16, v30
    v_and_b32 v77, 0xffff0000, v30
    v_lshlrev_b32 v78, 16, v31
    v_and_b32 v79, 0xffff0000, v31
    v_lshlrev_b32 v80, 16, v32
    v_and_b32 v81, 0xffff0000, v32
    v_lshlrev_b32 v82, 16, v33
    v_and_b32 v83, 0xffff0000, v33
    v_lshlrev_b32 v84, 16, v34
    v_and_b32 v85, 0xffff0000, v34
    v_lshlrev_b32 v86, 16, v35
    v_and_b32 v87, 0xffff0000, v35
    v_lshlrev_b32 v88, 16, v36
    v_and_b32 v89, 0xffff0000, v36
    v_lshlrev_b32 v90, 16, v37
    v_and_b32 v91, 0xffff0000, v37
    v_lshlrev_b32 v92, 16, v38
    v_and_b32 v93, 0xffff0000, v38
    v_lshlrev_b32 v94, 16, v39
    v_and_b32 v95, 0xffff0000, v39
    v_lshlrev_b32 v96, 16, v40
    v_and_b32 v97, 0xffff0000, v40
    v_lshlrev_b32 v98, 16, v41
    v_and_b32 v99, 0xffff0000, v41
    v_lshlrev_b32 v100, 16, v42
    v_and_b32 v101, 0xffff0000, v42
    v_lshlrev_b32 v102, 16, v43
    v_and_b32 v103, 0xffff0000, v43
    v_lshlrev_b32 v104, 16, v44
    v_and_b32 v105, 0xffff0000, v44
    v_lshlrev_b32 v106, 16, v45
    v_and_b32 v107, 0xffff0000, v45
    v_lshlrev_b32 v108, 16, v46
    v_and_b32 v109, 0xffff0000, v46
    v_lshlrev_b32 v110, 16, v47
    v_and_b32 v111, 0xffff0000, v47
    v_add_f32 v112, v48, v80
    v_add_f32 v113, v49, v81
    v_add_f32 v114, v50, v82
    v_add_f32 v115, v51, v83
    v_add_f32 v116, v52, v84
    v_add_f32 v117, v53, v85
    v_add_f32 v118, v54, v86
    v_add_f32 v119, v55, v87
    v_add_f32 v120, v56, v88
    v_add_f32 v121, v57, v89
    v_add_f32 v122, v58, v90
    v_add_f32 v123, v59, v91
    v_add_f32 v124, v60, v92
    v_add_f32 v125, v61, v93
    v_add_f32 v126, v62, v94
    v_add_f32 v127, v63, v95
    v_add_f32 v128, v64, v96
    v_add_f32 v129, v65, v97
    v_add_f32 v130, v66, v98
    v_add_f32 v131, v67, v99
    v_add_f32 v132, v68, v100
    v_add_f32 v133, v69, v101
    v_add_f32 v134, v70, v102
    v_add_f32 v135, v71, v103
    v_add_f32 v136, v72, v104
    v_add_f32 v137, v73, v105
    v_add_f32 v138, v74, v106
    v_add_f32 v139, v75, v107
    v_add_f32 v140, v76, v108
    v_add_f32 v141, v77, v109
    v_add_f32 v142, v78, v110
    v_add_f32 v143, v79, v111
    v_add_f32 v112, v112, v128
    v_add_f32 v113, v113, v129
    v_add_f32 v114, v114, v130
    v_add_f32 v115, v115, v131
    v_add_f32 v116, v116, v132
    v_add_f32 v117, v117, v133
    v_add_f32 v118, v118, v134
    v_add_f32 v119, v119, v135
    v_add_f32 v120, v120, v136
    v_add_f32 v121, v121, v137
    v_add_f32 v122, v122, v138
    v_add_f32 v123, v123, v139
    v_add_f32 v124, v124, v140
    v_add_f32 v125, v125, v141
    v_add_f32 v126, v126, v142
    v_add_f32 v127, v127, v143
    v_add_f32 v112, v112, v120
    v_add_f32 v113, v113, v121
    v_add_f32 v114, v114, v122
    v_add_f32 v115, v115, v123
    v_add_f32 v116, v116, v124
    v_add_f32 v117, v117, v125
    v_add_f32 v118, v118, v126
    v_add_f32 v119, v119, v127
    v_add_f32 v112, v112, v116
    v_add_f32 v113, v113, v117
    v_add_f32 v114, v114, v118
    v_add_f32 v115, v115, v119
    v_add_f32 v112, v112, v114
    v_add_f32 v113, v113, v115
    v_add_f32 v112, v112, v113
    v_mov_b32 v113, v112
    s_nop 1
    v_permlane16_swap_b32 v113, v112
    v_add_f32 v112, v112, v113
    v_mov_b32 v113, v112
    s_nop 1
    v_permlane32_swap_b32 v113, v112
    v_add_f32 v112, v112, v113
    ds_write_b32 v7, v112
    s_waitcnt lgkmcnt(0)
    s_barrier
    ds_read_b128 v[112:115], v6
    s_waitcnt lgkmcnt(0)
    v_add_f32 v112, v112, v114
    v_add_f32 v113, v113, v115
    v_add_f32 v112, v112, v113
    v_mul_f32 v10, 0x3a800000, v112
    v_sub_f32 v176, v48, v10
    v_sub_f32 v177, v49, v10
    v_sub_f32 v178, v50, v10
    v_sub_f32 v179, v51, v10
    v_sub_f32 v180, v52, v10
    v_sub_f32 v181, v53, v10
    v_sub_f32 v182, v54, v10
    v_sub_f32 v183, v55, v10
    v_sub_f32 v184, v56, v10
    v_sub_f32 v185, v57, v10
    v_sub_f32 v186, v58, v10
    v_sub_f32 v187, v59, v10
    v_sub_f32 v188, v60, v10
    v_sub_f32 v189, v61, v10
    v_sub_f32 v190, v62, v10
    v_sub_f32 v191, v63, v10
    v_sub_f32 v192, v64, v10
    v_sub_f32 v193, v65, v10
    v_sub_f32 v194, v66, v10
    v_sub_f32 v195, v67, v10
    v_sub_f32 v196, v68, v10
    v_sub_f32 v197, v69, v10
    v_sub_f32 v198, v70, v10
    v_sub_f32 v199, v71, v10
    v_sub_f32 v200, v72, v10
    v_sub_f32 v201, v73, v10
    v_sub_f32 v202, v74, v10
    v_sub_f32 v203, v75, v10
    v_sub_f32 v204, v76, v10
    v_sub_f32 v205, v77, v10
    v_sub_f32 v206, v78, v10
    v_sub_f32 v207, v79, v10
    v_sub_f32 v208, v80, v10
    v_sub_f32 v209, v81, v10
    v_sub_f32 v210, v82, v10
    v_sub_f32 v211, v83, v10
    v_sub_f32 v212, v84, v10
    v_sub_f32 v213, v85, v10
    v_sub_f32 v214, v86, v10
    v_sub_f32 v215, v87, v10
    v_sub_f32 v216, v88, v10
    v_sub_f32 v217, v89, v10
    v_sub_f32 v218, v90, v10
    v_sub_f32 v219, v91, v10
    v_sub_f32 v220, v92, v10
    v_sub_f32 v221, v93, v10
    v_sub_f32 v222, v94, v10
    v_sub_f32 v223, v95, v10
    v_sub_f32 v224, v96, v10
    v_sub_f32 v225, v97, v10
    v_sub_f32 v226, v98, v10
    v_sub_f32 v227, v99, v10
    v_sub_f32 v228, v100, v10
    v_sub_f32 v229, v101, v10
    v_sub_f32 v230, v102, v10
    v_sub_f32 v231, v103, v10
    v_sub_f32 v232, v104, v10
    v_sub_f32 v233, v105, v10
    v_sub_f32 v234, v106, v10
    v_sub_f32 v235, v107, v10
    v_sub_f32 v236, v108, v10
    v_sub_f32 v237, v109, v10
    v_sub_f32 v238, v110, v10
    v_sub_f32 v239, v111, v10
    v_mul_f32 v112, v176, v176
    v_fmac_f32 v112, v208, v208
    v_mul_f32 v113, v177, v177
    v_fmac_f32 v113, v209, v209
    v_mul_f32 v114, v178, v178
    v_fmac_f32 v114, v210, v210
    v_mul_f32 v115, v179, v179
    v_fmac_f32 v115, v211, v211
    v_mul_f32 v116, v180, v180
    v_fmac_f32 v116, v212, v212
    v_mul_f32 v117, v181, v181
    v_fmac_f32 v117, v213, v213
    v_mul_f32 v118, v182, v182
    v_fmac_f32 v118, v214, v214
    v_mul_f32 v119, v183, v183
    v_fmac_f32 v119, v215, v215
    v_mul_f32 v120, v184, v184
    v_fmac_f32 v120, v216, v216
    v_mul_f32 v121, v185, v185
    v_fmac_f32 v121, v217, v217
    v_mul_f32 v122, v186, v186
    v_fmac_f32 v122, v218, v218
    v_mul_f32 v123, v187, v187
    v_fmac_f32 v123, v219, v219
    v_mul_f32 v124, v188, v188
    v_fmac_f32 v124, v220, v220
    v_mul_f32 v125, v189, v189
    v_fmac_f32 v125, v221, v221
    v_mul_f32 v126, v190, v190
    v_fmac_f32 v126, v222, v222
    v_mul_f32 v127, v191, v191
    v_fmac_f32 v127, v223, v223
    v_mul_f32 v128, v192, v192
    v_fmac_f32 v128, v224, v224
    v_mul_f32 v129, v193, v193
    v_fmac_f32 v129, v225, v225
    v_mul_f32 v130, v194, v194
    v_fmac_f32 v130, v226, v226
    v_mul_f32 v131, v195, v195
    v_fmac_f32 v131, v227, v227
    v_mul_f32 v132, v196, v196
    v_fmac_f32 v132, v228, v228
    v_mul_f32 v133, v197, v197
    v_fmac_f32 v133, v229, v229
    v_mul_f32 v134, v198, v198
    v_fmac_f32 v134, v230, v230
    v_mul_f32 v135, v199, v199
    v_fmac_f32 v135, v231, v231
    v_mul_f32 v136, v200, v200
    v_fmac_f32 v136, v232, v232
    v_mul_f32 v137, v201, v201
    v_fmac_f32 v137, v233, v233
    v_mul_f32 v138, v202, v202
    v_fmac_f32 v138, v234, v234
    v_mul_f32 v139, v203, v203
    v_fmac_f32 v139, v235, v235
    v_mul_f32 v140, v204, v204
    v_fmac_f32 v140, v236, v236
    v_mul_f32 v141, v205, v205
    v_fmac_f32 v141, v237, v237
    v_mul_f32 v142, v206, v206
    v_fmac_f32 v142, v238, v238
    v_mul_f32 v143, v207, v207
    v_fmac_f32 v143, v239, v239
    v_add_f32 v112, v112, v128
    v_add_f32 v113, v113, v129
    v_add_f32 v114, v114, v130
    v_add_f32 v115, v115, v131
    v_add_f32 v116, v116, v132
    v_add_f32 v117, v117, v133
    v_add_f32 v118, v118, v134
    v_add_f32 v119, v119, v135
    v_add_f32 v120, v120, v136
    v_add_f32 v121, v121, v137
    v_add_f32 v122, v122, v138
    v_add_f32 v123, v123, v139
    v_add_f32 v124, v124, v140
    v_add_f32 v125, v125, v141
    v_add_f32 v126, v126, v142
    v_add_f32 v127, v127, v143
    v_add_f32 v112, v112, v120
    v_add_f32 v113, v113, v121
    v_add_f32 v114, v114, v122
    v_add_f32 v115, v115, v123
    v_add_f32 v116, v116, v124
    v_add_f32 v117, v117, v125
    v_add_f32 v118, v118, v126
    v_add_f32 v119, v119, v127
    v_add_f32 v112, v112, v116
    v_add_f32 v113, v113, v117
    v_add_f32 v114, v114, v118
    v_add_f32 v115, v115, v119
    v_add_f32 v112, v112, v114
    v_add_f32 v113, v113, v115
    v_add_f32 v112, v112, v113
    v_mov_b32 v113, v112
    s_nop 1
    v_permlane16_swap_b32 v113, v112
    v_add_f32 v112, v112, v113
    v_mov_b32 v113, v112
    s_nop 1
    v_permlane32_swap_b32 v113, v112
    v_add_f32 v112, v112, v113
    ds_write_b32 v7, v112 offset:512
    s_waitcnt lgkmcnt(0)
    s_barrier
    ds_read_b128 v[112:115], v6 offset:512
    v_mov_b32 v12, 2048
    ds_read_b32 v12, v12
    s_mov_b32 s96, s97
    s_waitcnt lgkmcnt(0)
    v_readfirstlane_b32 s97, v12
    s_cmp_lg_u32 s96, s97
    s_cbranch_scc1 k_restart
    s_waitcnt lgkmcnt(0)
    v_cmp_gt_u32 vcc, 32, v0
    s_and_saveexec_b64 s[22:23], vcc
    s_cbranch_execz ln_nz
    buffer_store_dword v14, v13, s[4:7], s13 offen sc1
ln_nz:
    s_mov_b64 exec, -1
    v_add_f32 v112, v112, v114
    v_add_f32 v113, v113, v115
    v_add_f32 v112, v112, v113
    v_mul_f32 v11, 0x3a800000, v112
    v_cvt_pk_bf16_f32 v10, v10, v10
    v_lshlrev_b32 v10, 16, v10
    v_cvt_pk_bf16_f32 v11, v11, v11
    v_lshlrev_b32 v11, 16, v11
    v_add_f32 v11, 0x3727c5ac, v11
    v_cvt_pk_bf16_f32 v11, v11, v11
    v_lshlrev_b32 v11, 16, v11
    v_sqrt_f32 v11, v11
    s_nop 0
    v_cvt_pk_bf16_f32 v11, v11, v11
    v_lshlrev_b32 v11, 16, v11
    v_rcp_f32 v11, v11
    s_nop 0
    v_sub_f32 v48, v48, v10
    v_sub_f32 v49, v49, v10
    v_cvt_pk_bf16_f32 v16, v48, v49
    v_lshlrev_b32 v48, 16, v16
    v_and_b32 v49, 0xffff0000, v16
    v_mul_f32 v48, v48, v11
    v_mul_f32 v49, v49, v11
    v_cvt_pk_bf16_f32 v16, v48, v49
    v_sub_f32 v50, v50, v10
    v_sub_f32 v51, v51, v10
    v_cvt_pk_bf16_f32 v17, v50, v51
    v_lshlrev_b32 v50, 16, v17
    v_and_b32 v51, 0xffff0000, v17
    v_mul_f32 v50, v50, v11
    v_mul_f32 v51, v51, v11
    v_cvt_pk_bf16_f32 v17, v50, v51
    v_sub_f32 v52, v52, v10
    v_sub_f32 v53, v53, v10
    v_cvt_pk_bf16_f32 v18, v52, v53
    v_lshlrev_b32 v52, 16, v18
    v_and_b32 v53, 0xffff0000, v18
    v_mul_f32 v52, v52, v11
    v_mul_f32 v53, v53, v11
    v_cvt_pk_bf16_f32 v18, v52, v53
    v_sub_f32 v54, v54, v10
    v_sub_f32 v55, v55, v10
    v_cvt_pk_bf16_f32 v19, v54, v55
    v_lshlrev_b32 v54, 16, v19
    v_and_b32 v55, 0xffff0000, v19
    v_mul_f32 v54, v54, v11
    v_mul_f32 v55, v55, v11
    v_cvt_pk_bf16_f32 v19, v54, v55
    v_cndmask_b32 v112, v16, v18, s[20:21]
    v_cndmask_b32 v113, v17, v19, s[20:21]
    v_cndmask_b32 v114, v18, v16, s[20:21]
    v_cndmask_b32 v115, v19, v17, s[20:21]
    buffer_store_dwordx4 v[112:115], v8, s[4:7], s15 offen offset:0 sc1
    v_sub_f32 v56, v56, v10
    v_sub_f32 v57, v57, v10
    v_cvt_pk_bf16_f32 v20, v56, v57
    v_lshlrev_b32 v56, 16, v20
    v_and_b32 v57, 0xffff0000, v20
    v_mul_f32 v56, v56, v11
    v_mul_f32 v57, v57, v11
    v_cvt_pk_bf16_f32 v20, v56, v57
    v_sub_f32 v58, v58, v10
    v_sub_f32 v59, v59, v10
    v_cvt_pk_bf16_f32 v21, v58, v59
    v_lshlrev_b32 v58, 16, v21
    v_and_b32 v59, 0xffff0000, v21
    v_mul_f32 v58, v58, v11
    v_mul_f32 v59, v59, v11
    v_cvt_pk_bf16_f32 v21, v58, v59
    v_sub_f32 v60, v60, v10
    v_sub_f32 v61, v61, v10
    v_cvt_pk_bf16_f32 v22, v60, v61
    v_lshlrev_b32 v60, 16, v22
    v_and_b32 v61, 0xffff0000, v22
    v_mul_f32 v60, v60, v11
    v_mul_f32 v61, v61, v11
    v_cvt_pk_bf16_f32 v22, v60, v61
    v_sub_f32 v62, v62, v10
    v_sub_f32 v63, v63, v10
    v_cvt_pk_bf16_f32 v23, v62, v63
    v_lshlrev_b32 v62, 16, v23
    v_and_b32 v63, 0xffff0000, v23
    v_mul_f32 v62, v62, v11
    v_mul_f32 v63, v63, v11
    v_cvt_pk_bf16_f32 v23, v62, v63
    v_cndmask_b32 v116, v20, v22, s[20:21]
    v_cndmask_b32 v117, v21, v23, s[20:21]
    v_cndmask_b32 v118, v22, v20, s[20:21]
    v_cndmask_b32 v119, v23, v21, s[20:21]
    buffer_store_dwordx4 v[116:119], v8, s[4:7], s15 offen offset:1024 sc1
    v_sub_f32 v64, v64, v10
    v_sub_f32 v65, v65, v10
    v_cvt_pk_bf16_f32 v24, v64, v65
    v_lshlrev_b32 v64, 16, v24
    v_and_b32 v65, 0xffff0000, v24
    v_mul_f32 v64, v64, v11
    v_mul_f32 v65, v65, v11
    v_cvt_pk_bf16_f32 v24, v64, v65
    v_sub_f32 v66, v66, v10
    v_sub_f32 v67, v67, v10
    v_cvt_pk_bf16_f32 v25, v66, v67
    v_lshlrev_b32 v66, 16, v25
    v_and_b32 v67, 0xffff0000, v25
    v_mul_f32 v66, v66, v11
    v_mul_f32 v67, v67, v11
    v_cvt_pk_bf16_f32 v25, v66, v67
    v_sub_f32 v68, v68, v10
    v_sub_f32 v69, v69, v10
    v_cvt_pk_bf16_f32 v26, v68, v69
    v_lshlrev_b32 v68, 16, v26
    v_and_b32 v69, 0xffff0000, v26
    v_mul_f32 v68, v68, v11
    v_mul_f32 v69, v69, v11
    v_cvt_pk_bf16_f32 v26, v68, v69
    v_sub_f32 v70, v70, v10
    v_sub_f32 v71, v71, v10
    v_cvt_pk_bf16_f32 v27, v70, v71
    v_lshlrev_b32 v70, 16, v27
    v_and_b32 v71, 0xffff0000, v27
    v_mul_f32 v70, v70, v11
    v_mul_f32 v71, v71, v11
    v_cvt_pk_bf16_f32 v27, v70, v71
    v_cndmask_b32 v120, v24, v26, s[20:21]
    v_cndmask_b32 v121, v25, v27, s[20:21]
    v_cndmask_b32 v122, v26, v24, s[20:21]
    v_cndmask_b32 v123, v27, v25, s[20:21]
    buffer_store_dwordx4 v[120:123], v8, s[4:7], s15 offen offset:2048 sc1
    v_sub_f32 v72, v72, v10
    v_sub_f32 v73, v73, v10
    v_cvt_pk_bf16_f32 v28, v72, v73
    v_lshlrev_b32 v72, 16, v28
    v_and_b32 v73, 0xffff0000, v28
    v_mul_f32 v72, v72, v11
    v_mul_f32 v73, v73, v11
    v_cvt_pk_bf16_f32 v28, v72, v73
    v_sub_f32 v74, v74, v10
    v_sub_f32 v75, v75, v10
    v_cvt_pk_bf16_f32 v29, v74, v75
    v_lshlrev_b32 v74, 16, v29
    v_and_b32 v75, 0xffff0000, v29
    v_mul_f32 v74, v74, v11
    v_mul_f32 v75, v75, v11
    v_cvt_pk_bf16_f32 v29, v74, v75
    v_sub_f32 v76, v76, v10
    v_sub_f32 v77, v77, v10
    v_cvt_pk_bf16_f32 v30, v76, v77
    v_lshlrev_b32 v76, 16, v30
    v_and_b32 v77, 0xffff0000, v30
    v_mul_f32 v76, v76, v11
    v_mul_f32 v77, v77, v11
    v_cvt_pk_bf16_f32 v30, v76, v77
    v_sub_f32 v78, v78, v10
    v_sub_f32 v79, v79, v10
    v_cvt_pk_bf16_f32 v31, v78, v79
    v_lshlrev_b32 v78, 16, v31
    v_and_b32 v79, 0xffff0000, v31
    v_mul_f32 v78, v78, v11
    v_mul_f32 v79, v79, v11
    v_cvt_pk_bf16_f32 v31, v78, v79
    v_cndmask_b32 v124, v28, v30, s[20:21]
    v_cndmask_b32 v125, v29, v31, s[20:21]
    v_cndmask_b32 v126, v30, v28, s[20:21]
    v_cndmask_b32 v127, v31, v29, s[20:21]
    buffer_store_dwordx4 v[124:127], v8, s[4:7], s15 offen offset:3072 sc1
    v_sub_f32 v80, v80, v10
    v_sub_f32 v81, v81, v10
    v_cvt_pk_bf16_f32 v32, v80, v81
    v_lshlrev_b32 v80, 16, v32
    v_and_b32 v81, 0xffff0000, v32
    v_mul_f32 v80, v80, v11
    v_mul_f32 v81, v81, v11
    v_cvt_pk_bf16_f32 v32, v80, v81
    v_sub_f32 v82, v82, v10
    v_sub_f32 v83, v83, v10
    v_cvt_pk_bf16_f32 v33, v82, v83
    v_lshlrev_b32 v82, 16, v33
    v_and_b32 v83, 0xffff0000, v33
    v_mul_f32 v82, v82, v11
    v_mul_f32 v83, v83, v11
    v_cvt_pk_bf16_f32 v33, v82, v83
    v_sub_f32 v84, v84, v10
    v_sub_f32 v85, v85, v10
    v_cvt_pk_bf16_f32 v34, v84, v85
    v_lshlrev_b32 v84, 16, v34
    v_and_b32 v85, 0xffff0000, v34
    v_mul_f32 v84, v84, v11
    v_mul_f32 v85, v85, v11
    v_cvt_pk_bf16_f32 v34, v84, v85
    v_sub_f32 v86, v86, v10
    v_sub_f32 v87, v87, v10
    v_cvt_pk_bf16_f32 v35, v86, v87
    v_lshlrev_b32 v86, 16, v35
    v_and_b32 v87, 0xffff0000, v35
    v_mul_f32 v86, v86, v11
    v_mul_f32 v87, v87, v11
    v_cvt_pk_bf16_f32 v35, v86, v87
    v_cndmask_b32 v128, v32, v34, s[20:21]
    v_cndmask_b32 v129, v33, v35, s[20:21]
    v_cndmask_b32 v130, v34, v32, s[20:21]
    v_cndmask_b32 v131, v35, v33, s[20:21]
    buffer_store_dwordx4 v[128:131], v8, s[4:7], s16 offen offset:0 sc1
    v_sub_f32 v88, v88, v10
    v_sub_f32 v89, v89, v10
    v_cvt_pk_bf16_f32 v36, v88, v89
    v_lshlrev_b32 v88, 16, v36
    v_and_b32 v89, 0xffff0000, v36
    v_mul_f32 v88, v88, v11
    v_mul_f32 v89, v89, v11
    v_cvt_pk_bf16_f32 v36, v88, v89
    v_sub_f32 v90, v90, v10
    v_sub_f32 v91, v91, v10
    v_cvt_pk_bf16_f32 v37, v90, v91
    v_lshlrev_b32 v90, 16, v37
    v_and_b32 v91, 0xffff0000, v37
    v_mul_f32 v90, v90, v11
    v_mul_f32 v91, v91, v11
    v_cvt_pk_bf16_f32 v37, v90, v91
    v_sub_f32 v92, v92, v10
    v_sub_f32 v93, v93, v10
    v_cvt_pk_bf16_f32 v38, v92, v93
    v_lshlrev_b32 v92, 16, v38
    v_and_b32 v93, 0xffff0000, v38
    v_mul_f32 v92, v92, v11
    v_mul_f32 v93, v93, v11
    v_cvt_pk_bf16_f32 v38, v92, v93
    v_sub_f32 v94, v94, v10
    v_sub_f32 v95, v95, v10
    v_cvt_pk_bf16_f32 v39, v94, v95
    v_lshlrev_b32 v94, 16, v39
    v_and_b32 v95, 0xffff0000, v39
    v_mul_f32 v94, v94, v11
    v_mul_f32 v95, v95, v11
    v_cvt_pk_bf16_f32 v39, v94, v95
    v_cndmask_b32 v132, v36, v38, s[20:21]
    v_cndmask_b32 v133, v37, v39, s[20:21]
    v_cndmask_b32 v134, v38, v36, s[20:21]
    v_cndmask_b32 v135, v39, v37, s[20:21]
    buffer_store_dwordx4 v[132:135], v8, s[4:7], s16 offen offset:1024 sc1
    v_sub_f32 v96, v96, v10
    v_sub_f32 v97, v97, v10
    v_cvt_pk_bf16_f32 v40, v96, v97
    v_lshlrev_b32 v96, 16, v40
    v_and_b32 v97, 0xffff0000, v40
    v_mul_f32 v96, v96, v11
    v_mul_f32 v97, v97, v11
    v_cvt_pk_bf16_f32 v40, v96, v97
    v_sub_f32 v98, v98, v10
    v_sub_f32 v99, v99, v10
    v_cvt_pk_bf16_f32 v41, v98, v99
    v_lshlrev_b32 v98, 16, v41
    v_and_b32 v99, 0xffff0000, v41
    v_mul_f32 v98, v98, v11
    v_mul_f32 v99, v99, v11
    v_cvt_pk_bf16_f32 v41, v98, v99
    v_sub_f32 v100, v100, v10
    v_sub_f32 v101, v101, v10
    v_cvt_pk_bf16_f32 v42, v100, v101
    v_lshlrev_b32 v100, 16, v42
    v_and_b32 v101, 0xffff0000, v42
    v_mul_f32 v100, v100, v11
    v_mul_f32 v101, v101, v11
    v_cvt_pk_bf16_f32 v42, v100, v101
    v_sub_f32 v102, v102, v10
    v_sub_f32 v103, v103, v10
    v_cvt_pk_bf16_f32 v43, v102, v103
    v_lshlrev_b32 v102, 16, v43
    v_and_b32 v103, 0xffff0000, v43
    v_mul_f32 v102, v102, v11
    v_mul_f32 v103, v103, v11
    v_cvt_pk_bf16_f32 v43, v102, v103
    v_cndmask_b32 v136, v40, v42, s[20:21]
    v_cndmask_b32 v137, v41, v43, s[20:21]
    v_cndmask_b32 v138, v42, v40, s[20:21]
    v_cndmask_b32 v139, v43, v41, s[20:21]
    buffer_store_dwordx4 v[136:139], v8, s[4:7], s16 offen offset:2048 sc1
    v_sub_f32 v104, v104, v10
    v_sub_f32 v105, v105, v10
    v_cvt_pk_bf16_f32 v44, v104, v105
    v_lshlrev_b32 v104, 16, v44
    v_and_b32 v105, 0xffff0000, v44
    v_mul_f32 v104, v104, v11
    v_mul_f32 v105, v105, v11
    v_cvt_pk_bf16_f32 v44, v104, v105
    v_sub_f32 v106, v106, v10
    v_sub_f32 v107, v107, v10
    v_cvt_pk_bf16_f32 v45, v106, v107
    v_lshlrev_b32 v106, 16, v45
    v_and_b32 v107, 0xffff0000, v45
    v_mul_f32 v106, v106, v11
    v_mul_f32 v107, v107, v11
    v_cvt_pk_bf16_f32 v45, v106, v107
    v_sub_f32 v108, v108, v10
    v_sub_f32 v109, v109, v10
    v_cvt_pk_bf16_f32 v46, v108, v109
    v_lshlrev_b32 v108, 16, v46
    v_and_b32 v109, 0xffff0000, v46
    v_mul_f32 v108, v108, v11
    v_mul_f32 v109, v109, v11
    v_cvt_pk_bf16_f32 v46, v108, v109
    v_sub_f32 v110, v110, v10
    v_sub_f32 v111, v111, v10
    v_cvt_pk_bf16_f32 v47, v110, v111
    v_lshlrev_b32 v110, 16, v47
    v_and_b32 v111, 0xffff0000, v47
    v_mul_f32 v110, v110, v11
    v_mul_f32 v111, v111, v11
    v_cvt_pk_bf16_f32 v47, v110, v111
    v_cndmask_b32 v140, v44, v46, s[20:21]
    v_cndmask_b32 v141, v45, v47, s[20:21]
    v_cndmask_b32 v142, v46, v44, s[20:21]
    v_cndmask_b32 v143, v47, v45, s[20:21]
    buffer_store_dwordx4 v[140:143], v8, s[4:7], s16 offen offset:3072 sc1
    s_waitcnt vmcnt(0)
    s_barrier
    s_cmp_lg_u32 s3, 0
    s_cbranch_scc1 ln_sig
    v_mov_b32 v2, 1
    s_mov_b64 exec, 1
    s_cmp_ge_u32 s63, 8
    s_cbranch_scc1 ln_sb
    buffer_atomic_add v2, off, s[64:67], 0 offset:192 sc1
ln_sb:
    buffer_atomic_add v2, off, s[64:67], 0 offset:0 sc1
    s_mov_b64 exec, -1
    s_branch ln_sig
ln_touch:
    s_getpc_b64 s[24:25]
    s_add_u32 s24, s24, jobtab@rel32@lo+4
    s_addc_u32 s25, s25, jobtab@rel32@hi+12
    s_and_b32 s30, s63, 3
    s_mul_i32 s30, s30, 323
    s_lshr_b32 s31, s63, 2
    s_add_u32 s30, s30, s31
    s_lshl_b32 s30, s30, 6
    s_add_u32 s24, s24, s30
    s_addc_u32 s25, s25, 0
    s_load_dwordx16 s[32:47], s[24:25], 0
    s_mov_b32 s11, 131072
    v_and_b32 v20, 63, v0
    s_waitcnt lgkmcnt(0)
    s_load_dwordx2 s[8:9], s[0:1], s33
    s_mov_b32 s10, s38
    s_lshl_b32 s30, s35, 4
    v_mul_lo_u32 v21, s30, v20
    v_and_b32 v22, 15, v20
    v_mul_lo_u32 v22, s43, v22
    s_waitcnt lgkmcnt(0)
    s_cmp_eq_u32 s3, 4
    s_cbranch_scc0 tlb_1_1
    buffer_load_dword v23, v21, s[8:11], s36 offen
    s_branch tlb_1
tlb_1_1:
    s_cmp_eq_u32 s3, 5
    s_cbranch_scc0 tlb_1
    buffer_load_dword v23, v22, s[4:7], s42 offen
    buffer_load_dword v23, off, s[4:7], s46
tlb_1:
    s_cmp_lg_u32 s3, 7
    s_cbranch_scc1 ln_nrp
    s_mov_b32 s95, 0x10000
rp_2:
    buffer_load_dword v13, off, s[64:67], 0 offset:224 sc1
    s_waitcnt vmcnt(0)
    v_readfirstlane_b32 s96, v13
    s_cmp_lg_u32 s96, 0
    s_cbranch_scc1 rp_2_ok
    s_sleep 2
    s_sub_u32 s95, s95, 1
    s_cbranch_scc0 rp_2
    s_add_u32 s96, s97, 1
rp_2_ok:
    s_sub_u32 s96, s96, 1
    v_mov_b32 v12, 2048
    v_mov_b32 v13, s96
    ds_write_b32 v12, v13
    s_waitcnt lgkmcnt(0)
ln_nrp:
    s_barrier
    s_barrier
    v_mov_b32 v12, 2048
    ds_read_b32 v12, v12
    s_mov_b32 s96, s97
    s_waitcnt lgkmcnt(0)
    v_readfirstlane_b32 s97, v12
    s_cmp_lg_u32 s96, s97
    s_cbranch_scc1 k_restart
    s_barrier
ln_sig:
    s_mov_b32 s29, s63
    v_and_b32 v20, 63, v0
    v_lshlrev_b32 v1, 4, v20
    v_add_u32 v19, 0x1000, v1
    v_lshrrev_b32 v4, 4, v20
    v_mov_b32 v17, 0
    v_mov_b32 v18, 1
    s_lshr_b32 s26, s3, 2
    s_and_b32 s27, s3, 3
    s_lshl_b32 s21, s3, 11
    s_lshl_b32 s22, s3, 10
    s_add_u32 s22, s22, 16384
    s_mov_b32 s11, 131072
    s_mov_b32 s15, 131072
    s_mov_b32 s28, 0
    v_and_b32 v21, 15, v20
    v_lshlrev_b32 v22, 2, v4
    v_xor_b32 v21, v21, v22
    s_lshr_b32 s30, s3, 1
    s_and_b32 s30, s30, 1
    v_xor_b32 v21, s30, v21
    v_lshlrev_b32 v3, 4, v21
    s_lshl_b32 s30, s26, 13
    v_add_u32 v5, s30, v1
    v_add_u32 v6, 0x10000, v5
    v_bfe_u32 v21, v20, 2, 2
    v_and_b32 v22, 3, v20
    v_and_b32 v23, 1, v4
    v_xor_b32 v24, s27, v21
    v_xor_b32 v25, v22, v23
    v_lshl_add_u32 v24, v24, 2, v25
    v_lshlrev_b32 v24, 4, v24
    v_lshl_add_u32 v25, v4, 3, v21
    v_lshl_add_u32 v24, v25, 8, v24
    v_and_b32 v22, 1, v22
    v_xor_b32 v25, 0, v23
    v_lshl_add_u32 v8, v25, 10, v24
    v_xor_b32 v25, 0, v22
    v_lshl_add_u32 v8, v25, 3, v8
    v_add_u32 v12, 0x10000, v8
    v_xor_b32 v25, 1, v23
    v_lshl_add_u32 v9, v25, 10, v24
    v_xor_b32 v25, 0, v22
    v_lshl_add_u32 v9, v25, 3, v9
    v_add_u32 v13, 0x10000, v9
    v_xor_b32 v25, 0, v23
    v_lshl_add_u32 v10, v25, 10, v24
    v_xor_b32 v25, 1, v22
    v_lshl_add_u32 v10, v25, 3, v10
    v_add_u32 v14, 0x10000, v10
    v_xor_b32 v25, 1, v23
    v_lshl_add_u32 v11, v25, 10, v24
    v_xor_b32 v25, 1, v22
    v_lshl_add_u32 v11, v25, 3, v11
    v_add_u32 v15, 0x10000, v11
    s_lshl_b32 s30, s3, 2
    s_add_u32 s30, s30, 131072
    v_mov_b32 v7, s30
    s_cmp_ge_u32 s3, 4
    s_cbranch_scc0 w_np
    s_setprio 1
w_np:
    s_getpc_b64 s[24:25]
    s_add_u32 s24, s24, jobtab@rel32@lo+4
    s_addc_u32 s25, s25, jobtab@rel32@hi+12
    s_and_b32 s31, s29, 3
    s_mul_i32 s30, s31, 20672
    s_add_u32 s24, s24, s30
    s_addc_u32 s25, s25, 0
    s_lshl_b32 s71, s31, 2
    s_add_u32 s71, s71, 64
    s_lshr_b32 s59, s29, 2
    s_lshl_b32 s30, s59, 6
    s_load_dwordx16 s[32:47], s[24:25], s30
    s_waitcnt lgkmcnt(0)
    s_cmp_lg_u32 s32, 4
    s_cbranch_scc1 w_nopre
    s_load_dwordx2 s[8:9], s[0:1], s33
    s_load_dwordx2 s[12:13], s[0:1], s34
    s_mov_b32 s10, s38
    s_mov_b32 s14, s38
    s_cmp_eq_u32 s32, 4
    s_cselect_b32 s31, 0, 1
    s_lshl_b32 s30, s3, s31
    s_mul_i32 s30, s30, s40
    s_add_u32 s16, s39, s30
    s_cmp_eq_u32 s32, 4
    s_cselect_b32 s30, 1024, s40
    s_cselect_b32 s31, 6, 5
    s_lshl_b32 s62, 32, s31
    s_add_u32 s17, s16, s30
    s_lshl_b32 s30, s3, 2
    s_mul_i32 s30, s30, s35
    s_add_u32 s18, s36, s30
    s_add_u32 s19, s37, s30
    s_lshl_b32 s20, s35, s31
    v_mul_u32_u24 v2, s35, v4
    v_add_u32 v2, v2, v3
    s_waitcnt lgkmcnt(0)
    s_add_u32 m0, s22, 0
    s_nop 0
    buffer_load_dwordx4 v2, s[8:11], s18 offen lds
    s_add_u32 s18, s18, s20
    s_add_u32 m0, s22, 8192
    s_nop 0
    buffer_load_dwordx4 v2, s[12:15], s19 offen lds
    s_add_u32 s19, s19, s20
    s_add_u32 m0, s22, 32768
    s_nop 0
    buffer_load_dwordx4 v2, s[8:11], s18 offen lds
    s_add_u32 s18, s18, s20
    s_add_u32 m0, s22, 40960
    s_nop 0
    buffer_load_dwordx4 v2, s[12:15], s19 offen lds
    s_add_u32 s19, s19, s20
    s_add_u32 m0, s22, 65536
    s_nop 0
    buffer_load_dwordx4 v2, s[8:11], s18 offen lds
    s_add_u32 s18, s18, s20
    s_add_u32 m0, s22, 73728
    s_nop 0
    buffer_load_dwordx4 v2, s[12:15], s19 offen lds
    s_add_u32 s19, s19, s20
    s_add_u32 m0, s22, 98304
    s_nop 0
    buffer_load_dwordx4 v2, s[8:11], s18 offen lds
    s_add_u32 s18, s18, s20
    s_add_u32 m0, s22, 106496
    s_nop 0
    buffer_load_dwordx4 v2, s[12:15], s19 offen lds
    s_add_u32 s19, s19, s20
    s_cmp_eq_u32 s32, 4
    s_cselect_b32 s70, 1, 0
    s_cmp_eq_u32 s39, 0
    s_cselect_b32 s70, s70, 0
    s_cmp_lg_u32 s3, 0
    s_cbranch_scc1 lnwp_ok
    s_cmp_eq_u32 s70, 0
    s_cbranch_scc1 lnwp_full
    s_mov_b32 s69, 65536
lnwap:
    buffer_load_dword v20, off, s[64:67], 0 offset:192 sc1
    s_waitcnt vmcnt(0)
    v_readfirstlane_b32 s68, v20
    s_cmp_ge_u32 s68, 8
    s_cbranch_scc1 lnwap_ok
    s_sleep 8
    s_sub_u32 s69, s69, 1
    s_cbranch_scc0 lnwap
lnwap_ok:
    s_branch lnwp_ok
lnwp_full:
    s_mov_b32 s69, 65536
lnwp:
    buffer_load_dword v20, off, s[64:67], 0 offset:0 sc1
    s_waitcnt vmcnt(0)
    v_readfirstlane_b32 s68, v20
    s_cmp_ge_u32 s68, 128
    s_cbranch_scc1 lnwp_ok
    s_sleep 8
    s_sub_u32 s69, s69, 1
    s_cbranch_scc0 lnwp
lnwp_ok:
    s_barrier
    s_add_u32 m0, s21, 0
    s_nop 0
    buffer_load_dwordx4 v1, s[4:7], s16 offen sc1 lds
    s_add_u32 s16, s16, s62
    s_add_u32 m0, s21, 1024
    s_nop 0
    buffer_load_dwordx4 v1, s[4:7], s17 offen sc1 lds
    s_add_u32 s17, s17, s62
    s_add_u32 m0, s21, 32768
    s_nop 0
    buffer_load_dwordx4 v1, s[4:7], s16 offen sc1 lds
    s_add_u32 s16, s16, s62
    s_add_u32 m0, s21, 33792
    s_nop 0
    buffer_load_dwordx4 v1, s[4:7], s17 offen sc1 lds
    s_add_u32 s17, s17, s62
    s_add_u32 m0, s21, 65536
    s_nop 0
    buffer_load_dwordx4 v1, s[4:7], s16 offen sc1 lds
    s_add_u32 s16, s16, s62
    s_add_u32 m0, s21, 66560
    s_nop 0
    buffer_load_dwordx4 v1, s[4:7], s17 offen sc1 lds
    s_add_u32 s17, s17, s62
    s_add_u32 m0, s21, 98304
    s_nop 0
    buffer_load_dwordx4 v1, s[4:7], s16 offen sc1 lds
    s_add_u32 s16, s16, s62
    s_add_u32 m0, s21, 99328
    s_nop 0
    buffer_load_dwordx4 v1, s[4:7], s17 offen sc1 lds
    s_add_u32 s17, s17, s62
    s_branch w_adopt
w_nopre:
    s_cmp_eq_u32 s32, 4
    s_cselect_b32 s70, 1, 0
    s_cmp_eq_u32 s39, 0
    s_cselect_b32 s70, s70, 0
    s_cmp_lg_u32 s3, 0
    s_cbranch_scc1 lnw_ok
    s_cmp_eq_u32 s70, 0
    s_cbranch_scc1 lnw_full
    s_mov_b32 s69, 65536
lnwa:
    buffer_load_dword v20, off, s[64:67], 0 offset:192 sc1
    s_waitcnt vmcnt(0)
    v_readfirstlane_b32 s68, v20
    s_cmp_ge_u32 s68, 8
    s_cbranch_scc1 lnwa_ok
    s_sleep 8
    s_sub_u32 s69, s69, 1
    s_cbranch_scc0 lnwa
lnwa_ok:
    s_branch lnw_ok
lnw_full:
    s_mov_b32 s69, 65536
lnw:
    buffer_load_dword v20, off, s[64:67], 0 offset:0 sc1
    s_waitcnt vmcnt(0)
    v_readfirstlane_b32 s68, v20
    s_cmp_ge_u32 s68, 128
    s_cbranch_scc1 lnw_ok
    s_sleep 8
    s_sub_u32 s69, s69, 1
    s_cbranch_scc0 lnw
lnw_ok:
    s_barrier
w_cold:
    s_cmp_eq_u32 s32, 0
    s_cbranch_scc1 k_end
    s_cmp_ge_u32 s32, 6
    s_cbranch_scc1 w_fin
    s_cmp_lg_u32 s3, 0
    s_cbranch_scc1 w_depok
    s_cmp_eq_u32 s45, 0
    s_cbranch_scc1 w_depok
    s_mov_b32 s31, 0x40000
w_waitdep:
    buffer_load_dword v16, v17, s[4:7], s44 offen sc1
    s_waitcnt vmcnt(0)
    v_readfirstlane_b32 s30, v16
    s_cmp_ge_u32 s30, s45
    s_cbranch_scc1 w_depok
    s_sleep 16
    s_sub_u32 s31, s31, 1
    s_cbranch_scc0 w_waitdep
w_depok:
    s_cmp_eq_u32 s32, 5
    s_cbranch_scc1 w_att
    s_load_dwordx2 s[8:9], s[0:1], s33
    s_load_dwordx2 s[12:13], s[0:1], s34
    s_mov_b32 s10, s38
    s_mov_b32 s14, s38
    s_cmp_eq_u32 s32, 4
    s_cselect_b32 s31, 0, 1
    s_lshl_b32 s30, s3, s31
    s_mul_i32 s30, s30, s40
    s_add_u32 s16, s39, s30
    s_cmp_eq_u32 s32, 4
    s_cselect_b32 s30, 1024, s40
    s_cselect_b32 s31, 6, 5
    s_lshl_b32 s62, 32, s31
    s_add_u32 s17, s16, s30
    s_lshl_b32 s30, s3, 2
    s_mul_i32 s30, s30, s35
    s_add_u32 s18, s36, s30
    s_add_u32 s19, s37, s30
    s_lshl_b32 s20, s35, s31
    v_mul_u32_u24 v2, s35, v4
    v_add_u32 v2, v2, v3
    s_waitcnt lgkmcnt(0)
    s_barrier
    s_add_u32 m0, s21, 0
    s_nop 0
    buffer_load_dwordx4 v1, s[4:7], s16 offen sc1 lds
    s_add_u32 s16, s16, s62
    s_add_u32 m0, s21, 1024
    s_nop 0
    buffer_load_dwordx4 v1, s[4:7], s17 offen sc1 lds
    s_add_u32 s17, s17, s62
    s_add_u32 m0, s22, 0
    s_nop 0
    buffer_load_dwordx4 v2, s[8:11], s18 offen lds
    s_add_u32 s18, s18, s20
    s_add_u32 m0, s22, 8192
    s_nop 0
    buffer_load_dwordx4 v2, s[12:15], s19 offen lds
    s_add_u32 s19, s19, s20
    s_add_u32 m0, s21, 32768
    s_nop 0
    buffer_load_dwordx4 v1, s[4:7], s16 offen sc1 lds
    s_add_u32 s16, s16, s62
    s_add_u32 m0, s21, 33792
    s_nop 0
    buffer_load_dwordx4 v1, s[4:7], s17 offen sc1 lds
    s_add_u32 s17, s17, s62
    s_add_u32 m0, s22, 32768
    s_nop 0
    buffer_load_dwordx4 v2, s[8:11], s18 offen lds
    s_add_u32 s18, s18, s20
    s_add_u32 m0, s22, 40960
    s_nop 0
    buffer_load_dwordx4 v2, s[12:15], s19 offen lds
    s_add_u32 s19, s19, s20
    s_add_u32 m0, s21, 65536
    s_nop 0
    buffer_load_dwordx4 v1, s[4:7], s16 offen sc1 lds
    s_add_u32 s16, s16, s62
    s_add_u32 m0, s21, 66560
    s_nop 0
    buffer_load_dwordx4 v1, s[4:7], s17 offen sc1 lds
    s_add_u32 s17, s17, s62
    s_add_u32 m0, s22, 65536
    s_nop 0
    buffer_load_dwordx4 v2, s[8:11], s18 offen lds
    s_add_u32 s18, s18, s20
    s_add_u32 m0, s22, 73728
    s_nop 0
    buffer_load_dwordx4 v2, s[12:15], s19 offen lds
    s_add_u32 s19, s19, s20
    s_add_u32 m0, s21, 98304
    s_nop 0
    buffer_load_dwordx4 v1, s[4:7], s16 offen sc1 lds
    s_add_u32 s16, s16, s62
    s_add_u32 m0, s21, 99328
    s_nop 0
    buffer_load_dwordx4 v1, s[4:7], s17 offen sc1 lds
    s_add_u32 s17, s17, s62
    s_add_u32 m0, s22, 98304
    s_nop 0
    buffer_load_dwordx4 v2, s[8:11], s18 offen lds
    s_add_u32 s18, s18, s20
    s_add_u32 m0, s22, 106496
    s_nop 0
    buffer_load_dwordx4 v2, s[12:15], s19 offen lds
    s_add_u32 s19, s19, s20
w_adopt:
    s_mov_b32 s48, s32
    s_cmp_eq_u32 s32, 4
    s_cselect_b32 s30, 2, 3
    s_lshl_b32 s30, s26, s30
    s_mul_i32 s30, s30, s43
    s_add_u32 s49, s42, s30
    s_mov_b32 s50, s43
    s_mov_b32 s51, s46
    s_mov_b32 s23, s41
    s_mov_b32 s53, s41
    s_waitcnt vmcnt(0)
    s_barrier
    ds_read_b64_tr_b16 v[64:65], v8 offset:16384
    ds_read_b64_tr_b16 v[66:67], v9 offset:16384
    ds_read_b64_tr_b16 v[68:69], v10 offset:16384
    ds_read_b64_tr_b16 v[70:71], v11 offset:16384
    ds_read_b64_tr_b16 v[72:73], v8 offset:24576
    ds_read_b64_tr_b16 v[74:75], v9 offset:24576
    ds_read_b64_tr_b16 v[76:77], v10 offset:24576
    ds_read_b64_tr_b16 v[78:79], v11 offset:24576
    ds_read_b128 v[32:35], v5 offset:0
    ds_read_b128 v[36:39], v5 offset:1024
    ds_read_b128 v[40:43], v5 offset:2048
    ds_read_b128 v[44:47], v5 offset:3072
    ds_read_b128 v[48:51], v5 offset:4096
    ds_read_b128 v[52:55], v5 offset:5120
    ds_read_b128 v[56:59], v5 offset:6144
    ds_read_b128 v[60:63], v5 offset:7168
    s_waitcnt lgkmcnt(0)
    s_cmp_eq_u32 s48, 4
    s_cbranch_scc1 w_firstH
    s_branch w_first16
w_first4:
    s_waitcnt vmcnt(12)
    s_barrier
    v_mfma_f32_16x16x32_bf16 v[128:131], v[64:67], v[32:35], 0
    s_add_u32 m0, s21, 0
    s_nop 0
    buffer_load_dwordx4 v1, s[4:7], s16 offen sc1 lds
    s_add_u32 s16, s16, s62
    v_mfma_f32_16x16x32_bf16 v[132:135], v[68:71], v[32:35], 0
    ds_read_b64_tr_b16 v[112:113], v8 offset:49152
    v_mfma_f32_16x16x32_bf16 v[136:139], v[72:75], v[32:35], 0
    ds_read_b64_tr_b16 v[114:115], v9 offset:49152
    v_mfma_f32_16x16x32_bf16 v[140:143], v[76:79], v[32:35], 0
    ds_read_b64_tr_b16 v[116:117], v10 offset:49152
    v_mfma_f32_16x16x32_bf16 v[144:147], v[64:67], v[36:39], 0
    s_add_u32 m0, s21, 1024
    s_nop 0
    buffer_load_dwordx4 v1, s[4:7], s17 offen sc1 lds
    s_add_u32 s17, s17, s62
    v_mfma_f32_16x16x32_bf16 v[148:151], v[68:71], v[36:39], 0
    ds_read_b64_tr_b16 v[118:119], v11 offset:49152
    v_mfma_f32_16x16x32_bf16 v[152:155], v[72:75], v[36:39], 0
    ds_read_b64_tr_b16 v[120:121], v8 offset:57344
    v_mfma_f32_16x16x32_bf16 v[156:159], v[76:79], v[36:39], 0
    ds_read_b64_tr_b16 v[122:123], v9 offset:57344
    v_mfma_f32_16x16x32_bf16 v[160:163], v[64:67], v[40:43], 0
    s_add_u32 m0, s22, 0
    s_nop 0
    buffer_load_dwordx4 v2, s[8:11], s18 offen lds
    s_add_u32 s18, s18, s20
    v_mfma_f32_16x16x32_bf16 v[164:167], v[68:71], v[40:43], 0
    ds_read_b64_tr_b16 v[124:125], v10 offset:57344
    v_mfma_f32_16x16x32_bf16 v[168:171], v[72:75], v[40:43], 0
    ds_read_b64_tr_b16 v[126:127], v11 offset:57344
    v_mfma_f32_16x16x32_bf16 v[172:175], v[76:79], v[40:43], 0
    ds_read_b128 v[80:83], v5 offset:32768
    v_mfma_f32_16x16x32_bf16 v[176:179], v[64:67], v[44:47], 0
    s_add_u32 m0, s22, 8192
    s_nop 0
    buffer_load_dwordx4 v2, s[12:15], s19 offen lds
    s_add_u32 s19, s19, s20
    v_mfma_f32_16x16x32_bf16 v[180:183], v[68:71], v[44:47], 0
    ds_read_b128 v[84:87], v5 offset:33792
    v_mfma_f32_16x16x32_bf16 v[184:187], v[72:75], v[44:47], 0
    ds_read_b128 v[88:91], v5 offset:34816
    v_mfma_f32_16x16x32_bf16 v[188:191], v[76:79], v[44:47], 0
    ds_read_b128 v[92:95], v5 offset:35840
    v_mfma_f32_16x16x32_bf16 v[192:195], v[64:67], v[48:51], 0
    ds_read_b128 v[96:99], v5 offset:36864
    v_mfma_f32_16x16x32_bf16 v[196:199], v[68:71], v[48:51], 0
    ds_read_b128 v[100:103], v5 offset:37888
    v_mfma_f32_16x16x32_bf16 v[200:203], v[72:75], v[48:51], 0
    ds_read_b128 v[104:107], v5 offset:38912
    v_mfma_f32_16x16x32_bf16 v[204:207], v[76:79], v[48:51], 0
    ds_read_b128 v[108:111], v5 offset:39936
    v_mfma_f32_16x16x32_bf16 v[208:211], v[64:67], v[52:55], 0
    v_mfma_f32_16x16x32_bf16 v[212:215], v[68:71], v[52:55], 0
    v_mfma_f32_16x16x32_bf16 v[216:219], v[72:75], v[52:55], 0
    v_mfma_f32_16x16x32_bf16 v[220:223], v[76:79], v[52:55], 0
    v_mfma_f32_16x16x32_bf16 v[224:227], v[64:67], v[56:59], 0
    v_mfma_f32_16x16x32_bf16 v[228:231], v[68:71], v[56:59], 0
    v_mfma_f32_16x16x32_bf16 v[232:235], v[72:75], v[56:59], 0
    v_mfma_f32_16x16x32_bf16 v[236:239], v[76:79], v[56:59], 0
    v_mfma_f32_16x16x32_bf16 v[240:243], v[64:67], v[60:63], 0
    v_mfma_f32_16x16x32_bf16 v[244:247], v[68:71], v[60:63], 0
    v_mfma_f32_16x16x32_bf16 v[248:251], v[72:75], v[60:63], 0
    v_mfma_f32_16x16x32_bf16 v[252:255], v[76:79], v[60:63], 0
    s_waitcnt lgkmcnt(0)
w_first4_q1:
    s_waitcnt vmcnt(12)
    s_barrier
    v_mfma_f32_16x16x32_bf16 v[128:131], v[112:115], v[80:83], v[128:131]
    s_add_u32 m0, s21, 32768
    s_nop 0
    buffer_load_dwordx4 v1, s[4:7], s16 offen sc1 lds
    s_add_u32 s16, s16, s62
    v_mfma_f32_16x16x32_bf16 v[132:135], v[116:119], v[80:83], v[132:135]
    ds_read_b64_tr_b16 v[64:65], v12 offset:16384
    v_mfma_f32_16x16x32_bf16 v[136:139], v[120:123], v[80:83], v[136:139]
    ds_read_b64_tr_b16 v[66:67], v13 offset:16384
    v_mfma_f32_16x16x32_bf16 v[140:143], v[124:127], v[80:83], v[140:143]
    ds_read_b64_tr_b16 v[68:69], v14 offset:16384
    v_mfma_f32_16x16x32_bf16 v[144:147], v[112:115], v[84:87], v[144:147]
    s_add_u32 m0, s21, 33792
    s_nop 0
    buffer_load_dwordx4 v1, s[4:7], s17 offen sc1 lds
    s_add_u32 s17, s17, s62
    v_mfma_f32_16x16x32_bf16 v[148:151], v[116:119], v[84:87], v[148:151]
    ds_read_b64_tr_b16 v[70:71], v15 offset:16384
    v_mfma_f32_16x16x32_bf16 v[152:155], v[120:123], v[84:87], v[152:155]
    ds_read_b64_tr_b16 v[72:73], v12 offset:24576
    v_mfma_f32_16x16x32_bf16 v[156:159], v[124:127], v[84:87], v[156:159]
    ds_read_b64_tr_b16 v[74:75], v13 offset:24576
    v_mfma_f32_16x16x32_bf16 v[160:163], v[112:115], v[88:91], v[160:163]
    s_add_u32 m0, s22, 32768
    s_nop 0
    buffer_load_dwordx4 v2, s[8:11], s18 offen lds
    s_add_u32 s18, s18, s20
    v_mfma_f32_16x16x32_bf16 v[164:167], v[116:119], v[88:91], v[164:167]
    ds_read_b64_tr_b16 v[76:77], v14 offset:24576
    v_mfma_f32_16x16x32_bf16 v[168:171], v[120:123], v[88:91], v[168:171]
    ds_read_b64_tr_b16 v[78:79], v15 offset:24576
    v_mfma_f32_16x16x32_bf16 v[172:175], v[124:127], v[88:91], v[172:175]
    ds_read_b128 v[32:35], v6 offset:0
    v_mfma_f32_16x16x32_bf16 v[176:179], v[112:115], v[92:95], v[176:179]
    s_add_u32 m0, s22, 40960
    s_nop 0
    buffer_load_dwordx4 v2, s[12:15], s19 offen lds
    s_add_u32 s19, s19, s20
    v_mfma_f32_16x16x32_bf16 v[180:183], v[116:119], v[92:95], v[180:183]
    ds_read_b128 v[36:39], v6 offset:1024
    v_mfma_f32_16x16x32_bf16 v[184:187], v[120:123], v[92:95], v[184:187]
    ds_read_b128 v[40:43], v6 offset:2048
    v_mfma_f32_16x16x32_bf16 v[188:191], v[124:127], v[92:95], v[188:191]
    ds_read_b128 v[44:47], v6 offset:3072
    v_mfma_f32_16x16x32_bf16 v[192:195], v[112:115], v[96:99], v[192:195]
    ds_read_b128 v[48:51], v6 offset:4096
    v_mfma_f32_16x16x32_bf16 v[196:199], v[116:119], v[96:99], v[196:199]
    ds_read_b128 v[52:55], v6 offset:5120
    v_mfma_f32_16x16x32_bf16 v[200:203], v[120:123], v[96:99], v[200:203]
    ds_read_b128 v[56:59], v6 offset:6144
    v_mfma_f32_16x16x32_bf16 v[204:207], v[124:127], v[96:99], v[204:207]
    ds_read_b128 v[60:63], v6 offset:7168
    v_mfma_f32_16x16x32_bf16 v[208:211], v[112:115], v[100:103], v[208:211]
    v_mfma_f32_16x16x32_bf16 v[212:215], v[116:119], v[100:103], v[212:215]
    v_mfma_f32_16x16x32_bf16 v[216:219], v[120:123], v[100:103], v[216:219]
    v_mfma_f32_16x16x32_bf16 v[220:223], v[124:127], v[100:103], v[220:223]
    v_mfma_f32_16x16x32_bf16 v[224:227], v[112:115], v[104:107], v[224:227]
    v_mfma_f32_16x16x32_bf16 v[228:231], v[116:119], v[104:107], v[228:231]
    v_mfma_f32_16x16x32_bf16 v[232:235], v[120:123], v[104:107], v[232:235]
    v_mfma_f32_16x16x32_bf16 v[236:239], v[124:127], v[104:107], v[236:239]
    v_mfma_f32_16x16x32_bf16 v[240:243], v[112:115], v[108:111], v[240:243]
    v_mfma_f32_16x16x32_bf16 v[244:247], v[116:119], v[108:111], v[244:247]
    v_mfma_f32_16x16x32_bf16 v[248:251], v[120:123], v[108:111], v[248:251]
    v_mfma_f32_16x16x32_bf16 v[252:255], v[124:127], v[108:111], v[252:255]
    s_waitcnt lgkmcnt(0)
    s_waitcnt vmcnt(12)
    s_barrier
    v_mfma_f32_16x16x32_bf16 v[128:131], v[64:67], v[32:35], v[128:131]
    s_add_u32 m0, s21, 65536
    s_nop 0
    buffer_load_dwordx4 v1, s[4:7], s16 offen sc1 lds
    s_add_u32 s16, s16, s62
    v_mfma_f32_16x16x32_bf16 v[132:135], v[68:71], v[32:35], v[132:135]
    ds_read_b64_tr_b16 v[112:113], v12 offset:49152
    v_mfma_f32_16x16x32_bf16 v[136:139], v[72:75], v[32:35], v[136:139]
    ds_read_b64_tr_b16 v[114:115], v13 offset:49152
    v_mfma_f32_16x16x32_bf16 v[140:143], v[76:79], v[32:35], v[140:143]
    ds_read_b64_tr_b16 v[116:117], v14 offset:49152
    v_mfma_f32_16x16x32_bf16 v[144:147], v[64:67], v[36:39], v[144:147]
    s_add_u32 m0, s21, 66560
    s_nop 0
    buffer_load_dwordx4 v1, s[4:7], s17 offen sc1 lds
    s_add_u32 s17, s17, s62
    v_mfma_f32_16x16x32_bf16 v[148:151], v[68:71], v[36:39], v[148:151]
    ds_read_b64_tr_b16 v[118:119], v15 offset:49152
    v_mfma_f32_16x16x32_bf16 v[152:155], v[72:75], v[36:39], v[152:155]
    ds_read_b64_tr_b16 v[120:121], v12 offset:57344
    v_mfma_f32_16x16x32_bf16 v[156:159], v[76:79], v[36:39], v[156:159]
    ds_read_b64_tr_b16 v[122:123], v13 offset:57344
    v_mfma_f32_16x16x32_bf16 v[160:163], v[64:67], v[40:43], v[160:163]
    s_add_u32 m0, s22, 65536
    s_nop 0
    buffer_load_dwordx4 v2, s[8:11], s18 offen lds
    s_add_u32 s18, s18, s20
    v_mfma_f32_16x16x32_bf16 v[164:167], v[68:71], v[40:43], v[164:167]
    ds_read_b64_tr_b16 v[124:125], v14 offset:57344
    v_mfma_f32_16x16x32_bf16 v[168:171], v[72:75], v[40:43], v[168:171]
    ds_read_b64_tr_b16 v[126:127], v15 offset:57344
    v_mfma_f32_16x16x32_bf16 v[172:175], v[76:79], v[40:43], v[172:175]
    ds_read_b128 v[80:83], v6 offset:32768
    v_mfma_f32_16x16x32_bf16 v[176:179], v[64:67], v[44:47], v[176:179]
    s_add_u32 m0, s22, 73728
    s_nop 0
    buffer_load_dwordx4 v2, s[12:15], s19 offen lds
    s_add_u32 s19, s19, s20
    v_mfma_f32_16x16x32_bf16 v[180:183], v[68:71], v[44:47], v[180:183]
    ds_read_b128 v[84:87], v6 offset:33792
    v_mfma_f32_16x16x32_bf16 v[184:187], v[72:75], v[44:47], v[184:187]
    ds_read_b128 v[88:91], v6 offset:34816
    v_mfma_f32_16x16x32_bf16 v[188:191], v[76:79], v[44:47], v[188:191]
    ds_read_b128 v[92:95], v6 offset:35840
    v_mfma_f32_16x16x32_bf16 v[192:195], v[64:67], v[48:51], v[192:195]
    ds_read_b128 v[96:99], v6 offset:36864
    v_mfma_f32_16x16x32_bf16 v[196:199], v[68:71], v[48:51], v[196:199]
    ds_read_b128 v[100:103], v6 offset:37888
    v_mfma_f32_16x16x32_bf16 v[200:203], v[72:75], v[48:51], v[200:203]
    ds_read_b128 v[104:107], v6 offset:38912
    v_mfma_f32_16x16x32_bf16 v[204:207], v[76:79], v[48:51], v[204:207]
    ds_read_b128 v[108:111], v6 offset:39936
    v_mfma_f32_16x16x32_bf16 v[208:211], v[64:67], v[52:55], v[208:211]
    v_mfma_f32_16x16x32_bf16 v[212:215], v[68:71], v[52:55], v[212:215]
    v_mfma_f32_16x16x32_bf16 v[216:219], v[72:75], v[52:55], v[216:219]
    v_mfma_f32_16x16x32_bf16 v[220:223], v[76:79], v[52:55], v[220:223]
    v_mfma_f32_16x16x32_bf16 v[224:227], v[64:67], v[56:59], v[224:227]
    v_mfma_f32_16x16x32_bf16 v[228:231], v[68:71], v[56:59], v[228:231]
    v_mfma_f32_16x16x32_bf16 v[232:235], v[72:75], v[56:59], v[232:235]
    v_mfma_f32_16x16x32_bf16 v[236:239], v[76:79], v[56:59], v[236:239]
    v_mfma_f32_16x16x32_bf16 v[240:243], v[64:67], v[60:63], v[240:243]
    v_mfma_f32_16x16x32_bf16 v[244:247], v[68:71], v[60:63], v[244:247]
    v_mfma_f32_16x16x32_bf16 v[248:251], v[72:75], v[60:63], v[248:251]
    v_mfma_f32_16x16x32_bf16 v[252:255], v[76:79], v[60:63], v[252:255]
    s_waitcnt lgkmcnt(0)
    s_waitcnt vmcnt(8)
    s_barrier
    s_cmp_eq_u32 s28, 0
    s_cbranch_scc1 sig_3
    s_cmp_lg_u32 s3, 0
    s_cbranch_scc1 sig_3
    s_and_b32 s57, s28, 3
    v_mov_b32 v24, s57
    s_bfe_u32 s57, s28, 0x20002
    v_mov_b32 v25, s57
    s_andn2_b32 s28, s28, 15
    s_mov_b64 exec, 1
    buffer_atomic_add_x2 v[24:25], v17, s[4:7], s28 offen sc1
    s_mov_b64 exec, -1
sig_3:
    s_mov_b32 s28, 0
    v_mfma_f32_16x16x32_bf16 v[128:131], v[112:115], v[80:83], v[128:131]
    s_add_u32 m0, s21, 98304
    s_nop 0
    buffer_load_dwordx4 v1, s[4:7], s16 offen sc1 lds
    s_add_u32 s16, s16, s62
    v_mfma_f32_16x16x32_bf16 v[132:135], v[116:119], v[80:83], v[132:135]
    ds_read_b64_tr_b16 v[64:65], v8 offset:16384
    v_mfma_f32_16x16x32_bf16 v[136:139], v[120:123], v[80:83], v[136:139]
    ds_read_b64_tr_b16 v[66:67], v9 offset:16384
    v_mfma_f32_16x16x32_bf16 v[140:143], v[124:127], v[80:83], v[140:143]
    ds_read_b64_tr_b16 v[68:69], v10 offset:16384
    v_mfma_f32_16x16x32_bf16 v[144:147], v[112:115], v[84:87], v[144:147]
    s_add_u32 m0, s21, 99328
    s_nop 0
    buffer_load_dwordx4 v1, s[4:7], s17 offen sc1 lds
    s_add_u32 s17, s17, s62
    v_mfma_f32_16x16x32_bf16 v[148:151], v[116:119], v[84:87], v[148:151]
    ds_read_b64_tr_b16 v[70:71], v11 offset:16384
    v_mfma_f32_16x16x32_bf16 v[152:155], v[120:123], v[84:87], v[152:155]
    ds_read_b64_tr_b16 v[72:73], v8 offset:24576
    v_mfma_f32_16x16x32_bf16 v[156:159], v[124:127], v[84:87], v[156:159]
    ds_read_b64_tr_b16 v[74:75], v9 offset:24576
    v_mfma_f32_16x16x32_bf16 v[160:163], v[112:115], v[88:91], v[160:163]
    s_add_u32 m0, s22, 98304
    s_nop 0
    buffer_load_dwordx4 v2, s[8:11], s18 offen lds
    s_add_u32 s18, s18, s20
    v_mfma_f32_16x16x32_bf16 v[164:167], v[116:119], v[88:91], v[164:167]
    ds_read_b64_tr_b16 v[76:77], v10 offset:24576
    v_mfma_f32_16x16x32_bf16 v[168:171], v[120:123], v[88:91], v[168:171]
    ds_read_b64_tr_b16 v[78:79], v11 offset:24576
    v_mfma_f32_16x16x32_bf16 v[172:175], v[124:127], v[88:91], v[172:175]
    ds_read_b128 v[32:35], v5 offset:0
    v_mfma_f32_16x16x32_bf16 v[176:179], v[112:115], v[92:95], v[176:179]
    s_add_u32 m0, s22, 106496
    s_nop 0
    buffer_load_dwordx4 v2, s[12:15], s19 offen lds
    s_add_u32 s19, s19, s20
    v_mfma_f32_16x16x32_bf16 v[180:183], v[116:119], v[92:95], v[180:183]
    ds_read_b128 v[36:39], v5 offset:1024
    v_mfma_f32_16x16x32_bf16 v[184:187], v[120:123], v[92:95], v[184:187]
    ds_read_b128 v[40:43], v5 offset:2048
    v_mfma_f32_16x16x32_bf16 v[188:191], v[124:127], v[92:95], v[188:191]
    ds_read_b128 v[44:47], v5 offset:3072
    v_mfma_f32_16x16x32_bf16 v[192:195], v[112:115], v[96:99], v[192:195]
    ds_read_b128 v[48:51], v5 offset:4096
    v_mfma_f32_16x16x32_bf16 v[196:199], v[116:119], v[96:99], v[196:199]
    ds_read_b128 v[52:55], v5 offset:5120
    v_mfma_f32_16x16x32_bf16 v[200:203], v[120:123], v[96:99], v[200:203]
    ds_read_b128 v[56:59], v5 offset:6144
    v_mfma_f32_16x16x32_bf16 v[204:207], v[124:127], v[96:99], v[204:207]
    ds_read_b128 v[60:63], v5 offset:7168
    v_mfma_f32_16x16x32_bf16 v[208:211], v[112:115], v[100:103], v[208:211]
    v_mfma_f32_16x16x32_bf16 v[212:215], v[116:119], v[100:103], v[212:215]
    v_mfma_f32_16x16x32_bf16 v[216:219], v[120:123], v[100:103], v[216:219]
    v_mfma_f32_16x16x32_bf16 v[220:223], v[124:127], v[100:103], v[220:223]
    v_mfma_f32_16x16x32_bf16 v[224:227], v[112:115], v[104:107], v[224:227]
    v_mfma_f32_16x16x32_bf16 v[228:231], v[116:119], v[104:107], v[228:231]
    v_mfma_f32_16x16x32_bf16 v[232:235], v[120:123], v[104:107], v[232:235]
    v_mfma_f32_16x16x32_bf16 v[236:239], v[124:127], v[104:107], v[236:239]
    v_mfma_f32_16x16x32_bf16 v[240:243], v[112:115], v[108:111], v[240:243]
    v_mfma_f32_16x16x32_bf16 v[244:247], v[116:119], v[108:111], v[244:247]
    v_mfma_f32_16x16x32_bf16 v[248:251], v[120:123], v[108:111], v[248:251]
    v_mfma_f32_16x16x32_bf16 v[252:255], v[124:127], v[108:111], v[252:255]
    s_waitcnt lgkmcnt(0)
    s_branch w_loop_chk
w_first8:
    s_waitcnt vmcnt(16)
    s_barrier
    v_mfma_f32_16x16x32_bf16 v[128:131], v[64:67], v[32:35], 0
    s_add_u32 m0, s21, 0
    s_nop 0
    buffer_load_dwordx4 v1, s[4:7], s16 offen sc1 lds
    s_add_u32 s16, s16, s62
    v_mfma_f32_16x16x32_bf16 v[132:135], v[68:71], v[32:35], 0
    ds_read_b64_tr_b16 v[112:113], v8 offset:49152
    v_mfma_f32_16x16x32_bf16 v[136:139], v[72:75], v[32:35], 0
    ds_read_b64_tr_b16 v[114:115], v9 offset:49152
    v_mfma_f32_16x16x32_bf16 v[140:143], v[76:79], v[32:35], 0
    ds_read_b64_tr_b16 v[116:117], v10 offset:49152
    v_mfma_f32_16x16x32_bf16 v[144:147], v[64:67], v[36:39], 0
    s_add_u32 m0, s21, 1024
    s_nop 0
    buffer_load_dwordx4 v1, s[4:7], s17 offen sc1 lds
    s_add_u32 s17, s17, s62
    v_mfma_f32_16x16x32_bf16 v[148:151], v[68:71], v[36:39], 0
    ds_read_b64_tr_b16 v[118:119], v11 offset:49152
    v_mfma_f32_16x16x32_bf16 v[152:155], v[72:75], v[36:39], 0
    ds_read_b64_tr_b16 v[120:121], v8 offset:57344
    v_mfma_f32_16x16x32_bf16 v[156:159], v[76:79], v[36:39], 0
    ds_read_b64_tr_b16 v[122:123], v9 offset:57344
    v_mfma_f32_16x16x32_bf16 v[160:163], v[64:67], v[40:43], 0
    s_add_u32 m0, s22, 0
    s_nop 0
    buffer_load_dwordx4 v2, s[8:11], s18 offen lds
    s_add_u32 s18, s18, s20
    v_mfma_f32_16x16x32_bf16 v[164:167], v[68:71], v[40:43], 0
    ds_read_b64_tr_b16 v[124:125], v10 offset:57344
    v_mfma_f32_16x16x32_bf16 v[168:171], v[72:75], v[40:43], 0
    ds_read_b64_tr_b16 v[126:127], v11 offset:57344
    v_mfma_f32_16x16x32_bf16 v[172:175], v[76:79], v[40:43], 0
    ds_read_b128 v[80:83], v5 offset:32768
    v_mfma_f32_16x16x32_bf16 v[176:179], v[64:67], v[44:47], 0
    s_add_u32 m0, s22, 8192
    s_nop 0
    buffer_load_dwordx4 v2, s[12:15], s19 offen lds
    s_add_u32 s19, s19, s20
    v_mfma_f32_16x16x32_bf16 v[180:183], v[68:71], v[44:47], 0
    ds_read_b128 v[84:87], v5 offset:33792
    v_mfma_f32_16x16x32_bf16 v[184:187], v[72:75], v[44:47], 0
    ds_read_b128 v[88:91], v5 offset:34816
    v_mfma_f32_16x16x32_bf16 v[188:191], v[76:79], v[44:47], 0
    ds_read_b128 v[92:95], v5 offset:35840
    v_mfma_f32_16x16x32_bf16 v[192:195], v[64:67], v[48:51], 0
    ds_read_b128 v[96:99], v5 offset:36864
    v_mfma_f32_16x16x32_bf16 v[196:199], v[68:71], v[48:51], 0
    ds_read_b128 v[100:103], v5 offset:37888
    v_mfma_f32_16x16x32_bf16 v[200:203], v[72:75], v[48:51], 0
    ds_read_b128 v[104:107], v5 offset:38912
    v_mfma_f32_16x16x32_bf16 v[204:207], v[76:79], v[48:51], 0
    ds_read_b128 v[108:111], v5 offset:39936
    v_mfma_f32_16x16x32_bf16 v[208:211], v[64:67], v[52:55], 0
    v_mfma_f32_16x16x32_bf16 v[212:215], v[68:71], v[52:55], 0
    v_mfma_f32_16x16x32_bf16 v[216:219], v[72:75], v[52:55], 0
    v_mfma_f32_16x16x32_bf16 v[220:223], v[76:79], v[52:55], 0
    v_mfma_f32_16x16x32_bf16 v[224:227], v[64:67], v[56:59], 0
    v_mfma_f32_16x16x32_bf16 v[228:231], v[68:71], v[56:59], 0
    v_mfma_f32_16x16x32_bf16 v[232:235], v[72:75], v[56:59], 0
    v_mfma_f32_16x16x32_bf16 v[236:239], v[76:79], v[56:59], 0
    v_mfma_f32_16x16x32_bf16 v[240:243], v[64:67], v[60:63], 0
    v_mfma_f32_16x16x32_bf16 v[244:247], v[68:71], v[60:63], 0
    v_mfma_f32_16x16x32_bf16 v[248:251], v[72:75], v[60:63], 0
    v_mfma_f32_16x16x32_bf16 v[252:255], v[76:79], v[60:63], 0
    s_waitcnt lgkmcnt(0)
w_first8_q1:
    s_waitcnt vmcnt(16)
    s_barrier
    v_mfma_f32_16x16x32_bf16 v[128:131], v[112:115], v[80:83], v[128:131]
    s_add_u32 m0, s21, 32768
    s_nop 0
    buffer_load_dwordx4 v1, s[4:7], s16 offen sc1 lds
    s_add_u32 s16, s16, s62
    v_mfma_f32_16x16x32_bf16 v[132:135], v[116:119], v[80:83], v[132:135]
    ds_read_b64_tr_b16 v[64:65], v12 offset:16384
    v_mfma_f32_16x16x32_bf16 v[136:139], v[120:123], v[80:83], v[136:139]
    ds_read_b64_tr_b16 v[66:67], v13 offset:16384
    v_mfma_f32_16x16x32_bf16 v[140:143], v[124:127], v[80:83], v[140:143]
    ds_read_b64_tr_b16 v[68:69], v14 offset:16384
    v_mfma_f32_16x16x32_bf16 v[144:147], v[112:115], v[84:87], v[144:147]
    s_add_u32 m0, s21, 33792
    s_nop 0
    buffer_load_dwordx4 v1, s[4:7], s17 offen sc1 lds
    s_add_u32 s17, s17, s62
    v_mfma_f32_16x16x32_bf16 v[148:151], v[116:119], v[84:87], v[148:151]
    ds_read_b64_tr_b16 v[70:71], v15 offset:16384
    v_mfma_f32_16x16x32_bf16 v[152:155], v[120:123], v[84:87], v[152:155]
    ds_read_b64_tr_b16 v[72:73], v12 offset:24576
    v_mfma_f32_16x16x32_bf16 v[156:159], v[124:127], v[84:87], v[156:159]
    ds_read_b64_tr_b16 v[74:75], v13 offset:24576
    v_mfma_f32_16x16x32_bf16 v[160:163], v[112:115], v[88:91], v[160:163]
    s_add_u32 m0, s22, 32768
    s_nop 0
    buffer_load_dwordx4 v2, s[8:11], s18 offen lds
    s_add_u32 s18, s18, s20
    v_mfma_f32_16x16x32_bf16 v[164:167], v[116:119], v[88:91], v[164:167]
    ds_read_b64_tr_b16 v[76:77], v14 offset:24576
    v_mfma_f32_16x16x32_bf16 v[168:171], v[120:123], v[88:91], v[168:171]
    ds_read_b64_tr_b16 v[78:79], v15 offset:24576
    v_mfma_f32_16x16x32_bf16 v[172:175], v[124:127], v[88:91], v[172:175]
    ds_read_b128 v[32:35], v6 offset:0
    v_mfma_f32_16x16x32_bf16 v[176:179], v[112:115], v[92:95], v[176:179]
    s_add_u32 m0, s22, 40960
    s_nop 0
    buffer_load_dwordx4 v2, s[12:15], s19 offen lds
    s_add_u32 s19, s19, s20
    v_mfma_f32_16x16x32_bf16 v[180:183], v[116:119], v[92:95], v[180:183]
    ds_read_b128 v[36:39], v6 offset:1024
    v_mfma_f32_16x16x32_bf16 v[184:187], v[120:123], v[92:95], v[184:187]
    ds_read_b128 v[40:43], v6 offset:2048
    v_mfma_f32_16x16x32_bf16 v[188:191], v[124:127], v[92:95], v[188:191]
    ds_read_b128 v[44:47], v6 offset:3072
    v_mfma_f32_16x16x32_bf16 v[192:195], v[112:115], v[96:99], v[192:195]
    ds_read_b128 v[48:51], v6 offset:4096
    v_mfma_f32_16x16x32_bf16 v[196:199], v[116:119], v[96:99], v[196:199]
    ds_read_b128 v[52:55], v6 offset:5120
    v_mfma_f32_16x16x32_bf16 v[200:203], v[120:123], v[96:99], v[200:203]
    ds_read_b128 v[56:59], v6 offset:6144
    v_mfma_f32_16x16x32_bf16 v[204:207], v[124:127], v[96:99], v[204:207]
    ds_read_b128 v[60:63], v6 offset:7168
    v_mfma_f32_16x16x32_bf16 v[208:211], v[112:115], v[100:103], v[208:211]
    v_mfma_f32_16x16x32_bf16 v[212:215], v[116:119], v[100:103], v[212:215]
    v_mfma_f32_16x16x32_bf16 v[216:219], v[120:123], v[100:103], v[216:219]
    v_mfma_f32_16x16x32_bf16 v[220:223], v[124:127], v[100:103], v[220:223]
    v_mfma_f32_16x16x32_bf16 v[224:227], v[112:115], v[104:107], v[224:227]
    v_mfma_f32_16x16x32_bf16 v[228:231], v[116:119], v[104:107], v[228:231]
    v_mfma_f32_16x16x32_bf16 v[232:235], v[120:123], v[104:107], v[232:235]
    v_mfma_f32_16x16x32_bf16 v[236:239], v[124:127], v[104:107], v[236:239]
    v_mfma_f32_16x16x32_bf16 v[240:243], v[112:115], v[108:111], v[240:243]
    v_mfma_f32_16x16x32_bf16 v[244:247], v[116:119], v[108:111], v[244:247]
    v_mfma_f32_16x16x32_bf16 v[248:251], v[120:123], v[108:111], v[248:251]
    v_mfma_f32_16x16x32_bf16 v[252:255], v[124:127], v[108:111], v[252:255]
    s_waitcnt lgkmcnt(0)
    s_waitcnt vmcnt(16)
    s_barrier
    v_mfma_f32_16x16x32_bf16 v[128:131], v[64:67], v[32:35], v[128:131]
    s_add_u32 m0, s21, 65536
    s_nop 0
    buffer_load_dwordx4 v1, s[4:7], s16 offen sc1 lds
    s_add_u32 s16, s16, s62
    v_mfma_f32_16x16x32_bf16 v[132:135], v[68:71], v[32:35], v[132:135]
    ds_read_b64_tr_b16 v[112:113], v12 offset:49152
    v_mfma_f32_16x16x32_bf16 v[136:139], v[72:75], v[32:35], v[136:139]
    ds_read_b64_tr_b16 v[114:115], v13 offset:49152
    v_mfma_f32_16x16x32_bf16 v[140:143], v[76:79], v[32:35], v[140:143]
    ds_read_b64_tr_b16 v[116:117], v14 offset:49152
    v_mfma_f32_16x16x32_bf16 v[144:147], v[64:67], v[36:39], v[144:147]
    s_add_u32 m0, s21, 66560
    s_nop 0
    buffer_load_dwordx4 v1, s[4:7], s17 offen sc1 lds
    s_add_u32 s17, s17, s62
    v_mfma_f32_16x16x32_bf16 v[148:151], v[68:71], v[36:39], v[148:151]
    ds_read_b64_tr_b16 v[118:119], v15 offset:49152
    v_mfma_f32_16x16x32_bf16 v[152:155], v[72:75], v[36:39], v[152:155]
    ds_read_b64_tr_b16 v[120:121], v12 offset:57344
    v_mfma_f32_16x16x32_bf16 v[156:159], v[76:79], v[36:39], v[156:159]
    ds_read_b64_tr_b16 v[122:123], v13 offset:57344
    v_mfma_f32_16x16x32_bf16 v[160:163], v[64:67], v[40:43], v[160:163]
    s_add_u32 m0, s22, 65536
    s_nop 0
    buffer_load_dwordx4 v2, s[8:11], s18 offen lds
    s_add_u32 s18, s18, s20
    v_mfma_f32_16x16x32_bf16 v[164:167], v[68:71], v[40:43], v[164:167]
    ds_read_b64_tr_b16 v[124:125], v14 offset:57344
    v_mfma_f32_16x16x32_bf16 v[168:171], v[72:75], v[40:43], v[168:171]
    ds_read_b64_tr_b16 v[126:127], v15 offset:57344
    v_mfma_f32_16x16x32_bf16 v[172:175], v[76:79], v[40:43], v[172:175]
    ds_read_b128 v[80:83], v6 offset:32768
    v_mfma_f32_16x16x32_bf16 v[176:179], v[64:67], v[44:47], v[176:179]
    s_add_u32 m0, s22, 73728
    s_nop 0
    buffer_load_dwordx4 v2, s[12:15], s19 offen lds
    s_add_u32 s19, s19, s20
    v_mfma_f32_16x16x32_bf16 v[180:183], v[68:71], v[44:47], v[180:183]
    ds_read_b128 v[84:87], v6 offset:33792
    v_mfma_f32_16x16x32_bf16 v[184:187], v[72:75], v[44:47], v[184:187]
    ds_read_b128 v[88:91], v6 offset:34816
    v_mfma_f32_16x16x32_bf16 v[188:191], v[76:79], v[44:47], v[188:191]
    ds_read_b128 v[92:95], v6 offset:35840
    v_mfma_f32_16x16x32_bf16 v[192:195], v[64:67], v[48:51], v[192:195]
    ds_read_b128 v[96:99], v6 offset:36864
    v_mfma_f32_16x16x32_bf16 v[196:199], v[68:71], v[48:51], v[196:199]
    ds_read_b128 v[100:103], v6 offset:37888
    v_mfma_f32_16x16x32_bf16 v[200:203], v[72:75], v[48:51], v[200:203]
    ds_read_b128 v[104:107], v6 offset:38912
    v_mfma_f32_16x16x32_bf16 v[204:207], v[76:79], v[48:51], v[204:207]
    ds_read_b128 v[108:111], v6 offset:39936
    v_mfma_f32_16x16x32_bf16 v[208:211], v[64:67], v[52:55], v[208:211]
    v_mfma_f32_16x16x32_bf16 v[212:215], v[68:71], v[52:55], v[212:215]
    v_mfma_f32_16x16x32_bf16 v[216:219], v[72:75], v[52:55], v[216:219]
    v_mfma_f32_16x16x32_bf16 v[220:223], v[76:79], v[52:55], v[220:223]
    v_mfma_f32_16x16x32_bf16 v[224:227], v[64:67], v[56:59], v[224:227]
    v_mfma_f32_16x16x32_bf16 v[228:231], v[68:71], v[56:59], v[228:231]
    v_mfma_f32_16x16x32_bf16 v[232:235], v[72:75], v[56:59], v[232:235]
    v_mfma_f32_16x16x32_bf16 v[236:239], v[76:79], v[56:59], v[236:239]
    v_mfma_f32_16x16x32_bf16 v[240:243], v[64:67], v[60:63], v[240:243]
    v_mfma_f32_16x16x32_bf16 v[244:247], v[68:71], v[60:63], v[244:247]
    v_mfma_f32_16x16x32_bf16 v[248:251], v[72:75], v[60:63], v[248:251]
    v_mfma_f32_16x16x32_bf16 v[252:255], v[76:79], v[60:63], v[252:255]
    s_waitcnt lgkmcnt(0)
    s_waitcnt vmcnt(8)
    s_barrier
    s_cmp_eq_u32 s28, 0
    s_cbranch_scc1 sig_4
    s_cmp_lg_u32 s3, 0
    s_cbranch_scc1 sig_4
    s_and_b32 s57, s28, 3
    v_mov_b32 v24, s57
    s_bfe_u32 s57, s28, 0x20002
    v_mov_b32 v25, s57
    s_andn2_b32 s28, s28, 15
    s_mov_b64 exec, 1
    buffer_atomic_add_x2 v[24:25], v17, s[4:7], s28 offen sc1
    s_mov_b64 exec, -1
sig_4:
    s_mov_b32 s28, 0
    v_mfma_f32_16x16x32_bf16 v[128:131], v[112:115], v[80:83], v[128:131]
    s_add_u32 m0, s21, 98304
    s_nop 0
    buffer_load_dwordx4 v1, s[4:7], s16 offen sc1 lds
    s_add_u32 s16, s16, s62
    v_mfma_f32_16x16x32_bf16 v[132:135], v[116:119], v[80:83], v[132:135]
    ds_read_b64_tr_b16 v[64:65], v8 offset:16384
    v_mfma_f32_16x16x32_bf16 v[136:139], v[120:123], v[80:83], v[136:139]
    ds_read_b64_tr_b16 v[66:67], v9 offset:16384
    v_mfma_f32_16x16x32_bf16 v[140:143], v[124:127], v[80:83], v[140:143]
    ds_read_b64_tr_b16 v[68:69], v10 offset:16384
    v_mfma_f32_16x16x32_bf16 v[144:147], v[112:115], v[84:87], v[144:147]
    s_add_u32 m0, s21, 99328
    s_nop 0
    buffer_load_dwordx4 v1, s[4:7], s17 offen sc1 lds
    s_add_u32 s17, s17, s62
    v_mfma_f32_16x16x32_bf16 v[148:151], v[116:119], v[84:87], v[148:151]
    ds_read_b64_tr_b16 v[70:71], v11 offset:16384
    v_mfma_f32_16x16x32_bf16 v[152:155], v[120:123], v[84:87], v[152:155]
    ds_read_b64_tr_b16 v[72:73], v8 offset:24576
    v_mfma_f32_16x16x32_bf16 v[156:159], v[124:127], v[84:87], v[156:159]
    ds_read_b64_tr_b16 v[74:75], v9 offset:24576
    v_mfma_f32_16x16x32_bf16 v[160:163], v[112:115], v[88:91], v[160:163]
    s_add_u32 m0, s22, 98304
    s_nop 0
    buffer_load_dwordx4 v2, s[8:11], s18 offen lds
    s_add_u32 s18, s18, s20
    v_mfma_f32_16x16x32_bf16 v[164:167], v[116:119], v[88:91], v[164:167]
    ds_read_b64_tr_b16 v[76:77], v10 offset:24576
    v_mfma_f32_16x16x32_bf16 v[168:171], v[120:123], v[88:91], v[168:171]
    ds_read_b64_tr_b16 v[78:79], v11 offset:24576
    v_mfma_f32_16x16x32_bf16 v[172:175], v[124:127], v[88:91], v[172:175]
    ds_read_b128 v[32:35], v5 offset:0
    v_mfma_f32_16x16x32_bf16 v[176:179], v[112:115], v[92:95], v[176:179]
    s_add_u32 m0, s22, 106496
    s_nop 0
    buffer_load_dwordx4 v2, s[12:15], s19 offen lds
    s_add_u32 s19, s19, s20
    v_mfma_f32_16x16x32_bf16 v[180:183], v[116:119], v[92:95], v[180:183]
    ds_read_b128 v[36:39], v5 offset:1024
    v_mfma_f32_16x16x32_bf16 v[184:187], v[120:123], v[92:95], v[184:187]
    ds_read_b128 v[40:43], v5 offset:2048
    v_mfma_f32_16x16x32_bf16 v[188:191], v[124:127], v[92:95], v[188:191]
    ds_read_b128 v[44:47], v5 offset:3072
    v_mfma_f32_16x16x32_bf16 v[192:195], v[112:115], v[96:99], v[192:195]
    ds_read_b128 v[48:51], v5 offset:4096
    v_mfma_f32_16x16x32_bf16 v[196:199], v[116:119], v[96:99], v[196:199]
    ds_read_b128 v[52:55], v5 offset:5120
    v_mfma_f32_16x16x32_bf16 v[200:203], v[120:123], v[96:99], v[200:203]
    ds_read_b128 v[56:59], v5 offset:6144
    v_mfma_f32_16x16x32_bf16 v[204:207], v[124:127], v[96:99], v[204:207]
    ds_read_b128 v[60:63], v5 offset:7168
    v_mfma_f32_16x16x32_bf16 v[208:211], v[112:115], v[100:103], v[208:211]
    v_mfma_f32_16x16x32_bf16 v[212:215], v[116:119], v[100:103], v[212:215]
    v_mfma_f32_16x16x32_bf16 v[216:219], v[120:123], v[100:103], v[216:219]
    v_mfma_f32_16x16x32_bf16 v[220:223], v[124:127], v[100:103], v[220:223]
    v_mfma_f32_16x16x32_bf16 v[224:227], v[112:115], v[104:107], v[224:227]
    v_mfma_f32_16x16x32_bf16 v[228:231], v[116:119], v[104:107], v[228:231]
    v_mfma_f32_16x16x32_bf16 v[232:235], v[120:123], v[104:107], v[232:235]
    v_mfma_f32_16x16x32_bf16 v[236:239], v[124:127], v[104:107], v[236:239]
    v_mfma_f32_16x16x32_bf16 v[240:243], v[112:115], v[108:111], v[240:243]
    v_mfma_f32_16x16x32_bf16 v[244:247], v[116:119], v[108:111], v[244:247]
    v_mfma_f32_16x16x32_bf16 v[248:251], v[120:123], v[108:111], v[248:251]
    v_mfma_f32_16x16x32_bf16 v[252:255], v[124:127], v[108:111], v[252:255]
    s_waitcnt lgkmcnt(0)
    s_branch w_loop_chk
w_first16:
    s_waitcnt vmcnt(24)
    s_barrier
    v_mfma_f32_16x16x32_bf16 v[128:131], v[64:67], v[32:35], 0
    s_add_u32 m0, s21, 0
    s_nop 0
    buffer_load_dwordx4 v1, s[4:7], s16 offen sc1 lds
    s_add_u32 s16, s16, s62
    v_mfma_f32_16x16x32_bf16 v[132:135], v[68:71], v[32:35], 0
    ds_read_b64_tr_b16 v[112:113], v8 offset:49152
    v_mfma_f32_16x16x32_bf16 v[136:139], v[72:75], v[32:35], 0
    ds_read_b64_tr_b16 v[114:115], v9 offset:49152
    v_mfma_f32_16x16x32_bf16 v[140:143], v[76:79], v[32:35], 0
    ds_read_b64_tr_b16 v[116:117], v10 offset:49152
    v_mfma_f32_16x16x32_bf16 v[144:147], v[64:67], v[36:39], 0
    s_add_u32 m0, s21, 1024
    s_nop 0
    buffer_load_dwordx4 v1, s[4:7], s17 offen sc1 lds
    s_add_u32 s17, s17, s62
    v_mfma_f32_16x16x32_bf16 v[148:151], v[68:71], v[36:39], 0
    ds_read_b64_tr_b16 v[118:119], v11 offset:49152
    v_mfma_f32_16x16x32_bf16 v[152:155], v[72:75], v[36:39], 0
    ds_read_b64_tr_b16 v[120:121], v8 offset:57344
    v_mfma_f32_16x16x32_bf16 v[156:159], v[76:79], v[36:39], 0
    ds_read_b64_tr_b16 v[122:123], v9 offset:57344
    v_mfma_f32_16x16x32_bf16 v[160:163], v[64:67], v[40:43], 0
    s_add_u32 m0, s22, 0
    s_nop 0
    buffer_load_dwordx4 v2, s[8:11], s18 offen lds
    s_add_u32 s18, s18, s20
    v_mfma_f32_16x16x32_bf16 v[164:167], v[68:71], v[40:43], 0
    ds_read_b64_tr_b16 v[124:125], v10 offset:57344
    v_mfma_f32_16x16x32_bf16 v[168:171], v[72:75], v[40:43], 0
    ds_read_b64_tr_b16 v[126:127], v11 offset:57344
    v_mfma_f32_16x16x32_bf16 v[172:175], v[76:79], v[40:43], 0
    ds_read_b128 v[80:83], v5 offset:32768
    v_mfma_f32_16x16x32_bf16 v[176:179], v[64:67], v[44:47], 0
    s_add_u32 m0, s22, 8192
    s_nop 0
    buffer_load_dwordx4 v2, s[12:15], s19 offen lds
    s_add_u32 s19, s19, s20
    v_mfma_f32_16x16x32_bf16 v[180:183], v[68:71], v[44:47], 0
    ds_read_b128 v[84:87], v5 offset:33792
    v_mfma_f32_16x16x32_bf16 v[184:187], v[72:75], v[44:47], 0
    ds_read_b128 v[88:91], v5 offset:34816
    v_mfma_f32_16x16x32_bf16 v[188:191], v[76:79], v[44:47], 0
    ds_read_b128 v[92:95], v5 offset:35840
    v_mfma_f32_16x16x32_bf16 v[192:195], v[64:67], v[48:51], 0
    ds_read_b128 v[96:99], v5 offset:36864
    v_mfma_f32_16x16x32_bf16 v[196:199], v[68:71], v[48:51], 0
    ds_read_b128 v[100:103], v5 offset:37888
    v_mfma_f32_16x16x32_bf16 v[200:203], v[72:75], v[48:51], 0
    ds_read_b128 v[104:107], v5 offset:38912
    v_mfma_f32_16x16x32_bf16 v[204:207], v[76:79], v[48:51], 0
    ds_read_b128 v[108:111], v5 offset:39936
    v_mfma_f32_16x16x32_bf16 v[208:211], v[64:67], v[52:55], 0
    v_mfma_f32_16x16x32_bf16 v[212:215], v[68:71], v[52:55], 0
    v_mfma_f32_16x16x32_bf16 v[216:219], v[72:75], v[52:55], 0
    v_mfma_f32_16x16x32_bf16 v[220:223], v[76:79], v[52:55], 0
    v_mfma_f32_16x16x32_bf16 v[224:227], v[64:67], v[56:59], 0
    v_mfma_f32_16x16x32_bf16 v[228:231], v[68:71], v[56:59], 0
    v_mfma_f32_16x16x32_bf16 v[232:235], v[72:75], v[56:59], 0
    v_mfma_f32_16x16x32_bf16 v[236:239], v[76:79], v[56:59], 0
    v_mfma_f32_16x16x32_bf16 v[240:243], v[64:67], v[60:63], 0
    v_mfma_f32_16x16x32_bf16 v[244:247], v[68:71], v[60:63], 0
    v_mfma_f32_16x16x32_bf16 v[248:251], v[72:75], v[60:63], 0
    v_mfma_f32_16x16x32_bf16 v[252:255], v[76:79], v[60:63], 0
    s_waitcnt lgkmcnt(0)
w_first16_q1:
    s_waitcnt vmcnt(24)
    s_barrier
    v_mfma_f32_16x16x32_bf16 v[128:131], v[112:115], v[80:83], v[128:131]
    s_add_u32 m0, s21, 32768
    s_nop 0
    buffer_load_dwordx4 v1, s[4:7], s16 offen sc1 lds
    s_add_u32 s16, s16, s62
    v_mfma_f32_16x16x32_bf16 v[132:135], v[116:119], v[80:83], v[132:135]
    ds_read_b64_tr_b16 v[64:65], v12 offset:16384
    v_mfma_f32_16x16x32_bf16 v[136:139], v[120:123], v[80:83], v[136:139]
    ds_read_b64_tr_b16 v[66:67], v13 offset:16384
    v_mfma_f32_16x16x32_bf16 v[140:143], v[124:127], v[80:83], v[140:143]
    ds_read_b64_tr_b16 v[68:69], v14 offset:16384
    v_mfma_f32_16x16x32_bf16 v[144:147], v[112:115], v[84:87], v[144:147]
    s_add_u32 m0, s21, 33792
    s_nop 0
    buffer_load_dwordx4 v1, s[4:7], s17 offen sc1 lds
    s_add_u32 s17, s17, s62
    v_mfma_f32_16x16x32_bf16 v[148:151], v[116:119], v[84:87], v[148:151]
    ds_read_b64_tr_b16 v[70:71], v15 offset:16384
    v_mfma_f32_16x16x32_bf16 v[152:155], v[120:123], v[84:87], v[152:155]
    ds_read_b64_tr_b16 v[72:73], v12 offset:24576
    v_mfma_f32_16x16x32_bf16 v[156:159], v[124:127], v[84:87], v[156:159]
    ds_read_b64_tr_b16 v[74:75], v13 offset:24576
    v_mfma_f32_16x16x32_bf16 v[160:163], v[112:115], v[88:91], v[160:163]
    s_add_u32 m0, s22, 32768
    s_nop 0
    buffer_load_dwordx4 v2, s[8:11], s18 offen lds
    s_add_u32 s18, s18, s20
    v_mfma_f32_16x16x32_bf16 v[164:167], v[116:119], v[88:91], v[164:167]
    ds_read_b64_tr_b16 v[76:77], v14 offset:24576
    v_mfma_f32_16x16x32_bf16 v[168:171], v[120:123], v[88:91], v[168:171]
    ds_read_b64_tr_b16 v[78:79], v15 offset:24576
    v_mfma_f32_16x16x32_bf16 v[172:175], v[124:127], v[88:91], v[172:175]
    ds_read_b128 v[32:35], v6 offset:0
    v_mfma_f32_16x16x32_bf16 v[176:179], v[112:115], v[92:95], v[176:179]
    s_add_u32 m0, s22, 40960
    s_nop 0
    buffer_load_dwordx4 v2, s[12:15], s19 offen lds
    s_add_u32 s19, s19, s20
    v_mfma_f32_16x16x32_bf16 v[180:183], v[116:119], v[92:95], v[180:183]
    ds_read_b128 v[36:39], v6 offset:1024
    v_mfma_f32_16x16x32_bf16 v[184:187], v[120:123], v[92:95], v[184:187]
    ds_read_b128 v[40:43], v6 offset:2048
    v_mfma_f32_16x16x32_bf16 v[188:191], v[124:127], v[92:95], v[188:191]
    ds_read_b128 v[44:47], v6 offset:3072
    v_mfma_f32_16x16x32_bf16 v[192:195], v[112:115], v[96:99], v[192:195]
    ds_read_b128 v[48:51], v6 offset:4096
    v_mfma_f32_16x16x32_bf16 v[196:199], v[116:119], v[96:99], v[196:199]
    ds_read_b128 v[52:55], v6 offset:5120
    v_mfma_f32_16x16x32_bf16 v[200:203], v[120:123], v[96:99], v[200:203]
    ds_read_b128 v[56:59], v6 offset:6144
    v_mfma_f32_16x16x32_bf16 v[204:207], v[124:127], v[96:99], v[204:207]
    ds_read_b128 v[60:63], v6 offset:7168
    v_mfma_f32_16x16x32_bf16 v[208:211], v[112:115], v[100:103], v[208:211]
    v_mfma_f32_16x16x32_bf16 v[212:215], v[116:119], v[100:103], v[212:215]
    v_mfma_f32_16x16x32_bf16 v[216:219], v[120:123], v[100:103], v[216:219]
    v_mfma_f32_16x16x32_bf16 v[220:223], v[124:127], v[100:103], v[220:223]
    v_mfma_f32_16x16x32_bf16 v[224:227], v[112:115], v[104:107], v[224:227]
    v_mfma_f32_16x16x32_bf16 v[228:231], v[116:119], v[104:107], v[228:231]
    v_mfma_f32_16x16x32_bf16 v[232:235], v[120:123], v[104:107], v[232:235]
    v_mfma_f32_16x16x32_bf16 v[236:239], v[124:127], v[104:107], v[236:239]
    v_mfma_f32_16x16x32_bf16 v[240:243], v[112:115], v[108:111], v[240:243]
    v_mfma_f32_16x16x32_bf16 v[244:247], v[116:119], v[108:111], v[244:247]
    v_mfma_f32_16x16x32_bf16 v[248:251], v[120:123], v[108:111], v[248:251]
    v_mfma_f32_16x16x32_bf16 v[252:255], v[124:127], v[108:111], v[252:255]
    s_waitcnt lgkmcnt(0)
    s_waitcnt vmcnt(24)
    s_barrier
    v_mfma_f32_16x16x32_bf16 v[128:131], v[64:67], v[32:35], v[128:131]
    s_add_u32 m0, s21, 65536
    s_nop 0
    buffer_load_dwordx4 v1, s[4:7], s16 offen sc1 lds
    s_add_u32 s16, s16, s62
    v_mfma_f32_16x16x32_bf16 v[132:135], v[68:71], v[32:35], v[132:135]
    ds_read_b64_tr_b16 v[112:113], v12 offset:49152
    v_mfma_f32_16x16x32_bf16 v[136:139], v[72:75], v[32:35], v[136:139]
    ds_read_b64_tr_b16 v[114:115], v13 offset:49152
    v_mfma_f32_16x16x32_bf16 v[140:143], v[76:79], v[32:35], v[140:143]
    ds_read_b64_tr_b16 v[116:117], v14 offset:49152
    v_mfma_f32_16x16x32_bf16 v[144:147], v[64:67], v[36:39], v[144:147]
    s_add_u32 m0, s21, 66560
    s_nop 0
    buffer_load_dwordx4 v1, s[4:7], s17 offen sc1 lds
    s_add_u32 s17, s17, s62
    v_mfma_f32_16x16x32_bf16 v[148:151], v[68:71], v[36:39], v[148:151]
    ds_read_b64_tr_b16 v[118:119], v15 offset:49152
    v_mfma_f32_16x16x32_bf16 v[152:155], v[72:75], v[36:39], v[152:155]
    ds_read_b64_tr_b16 v[120:121], v12 offset:57344
    v_mfma_f32_16x16x32_bf16 v[156:159], v[76:79], v[36:39], v[156:159]
    ds_read_b64_tr_b16 v[122:123], v13 offset:57344
    v_mfma_f32_16x16x32_bf16 v[160:163], v[64:67], v[40:43], v[160:163]
    s_add_u32 m0, s22, 65536
    s_nop 0
    buffer_load_dwordx4 v2, s[8:11], s18 offen lds
    s_add_u32 s18, s18, s20
    v_mfma_f32_16x16x32_bf16 v[164:167], v[68:71], v[40:43], v[164:167]
    ds_read_b64_tr_b16 v[124:125], v14 offset:57344
    v_mfma_f32_16x16x32_bf16 v[168:171], v[72:75], v[40:43], v[168:171]
    ds_read_b64_tr_b16 v[126:127], v15 offset:57344
    v_mfma_f32_16x16x32_bf16 v[172:175], v[76:79], v[40:43], v[172:175]
    ds_read_b128 v[80:83], v6 offset:32768
    v_mfma_f32_16x16x32_bf16 v[176:179], v[64:67], v[44:47], v[176:179]
    s_add_u32 m0, s22, 73728
    s_nop 0
    buffer_load_dwordx4 v2, s[12:15], s19 offen lds
    s_add_u32 s19, s19, s20
    v_mfma_f32_16x16x32_bf16 v[180:183], v[68:71], v[44:47], v[180:183]
    ds_read_b128 v[84:87], v6 offset:33792
    v_mfma_f32_16x16x32_bf16 v[184:187], v[72:75], v[44:47], v[184:187]
    ds_read_b128 v[88:91], v6 offset:34816
    v_mfma_f32_16x16x32_bf16 v[188:191], v[76:79], v[44:47], v[188:191]
    ds_read_b128 v[92:95], v6 offset:35840
    v_mfma_f32_16x16x32_bf16 v[192:195], v[64:67], v[48:51], v[192:195]
    ds_read_b128 v[96:99], v6 offset:36864
    v_mfma_f32_16x16x32_bf16 v[196:199], v[68:71], v[48:51], v[196:199]
    ds_read_b128 v[100:103], v6 offset:37888
    v_mfma_f32_16x16x32_bf16 v[200:203], v[72:75], v[48:51], v[200:203]
    ds_read_b128 v[104:107], v6 offset:38912
    v_mfma_f32_16x16x32_bf16 v[204:207], v[76:79], v[48:51], v[204:207]
    ds_read_b128 v[108:111], v6 offset:39936
    v_mfma_f32_16x16x32_bf16 v[208:211], v[64:67], v[52:55], v[208:211]
    v_mfma_f32_16x16x32_bf16 v[212:215], v[68:71], v[52:55], v[212:215]
    v_mfma_f32_16x16x32_bf16 v[216:219], v[72:75], v[52:55], v[216:219]
    v_mfma_f32_16x16x32_bf16 v[220:223], v[76:79], v[52:55], v[220:223]
    v_mfma_f32_16x16x32_bf16 v[224:227], v[64:67], v[56:59], v[224:227]
    v_mfma_f32_16x16x32_bf16 v[228:231], v[68:71], v[56:59], v[228:231]
    v_mfma_f32_16x16x32_bf16 v[232:235], v[72:75], v[56:59], v[232:235]
    v_mfma_f32_16x16x32_bf16 v[236:239], v[76:79], v[56:59], v[236:239]
    v_mfma_f32_16x16x32_bf16 v[240:243], v[64:67], v[60:63], v[240:243]
    v_mfma_f32_16x16x32_bf16 v[244:247], v[68:71], v[60:63], v[244:247]
    v_mfma_f32_16x16x32_bf16 v[248:251], v[72:75], v[60:63], v[248:251]
    v_mfma_f32_16x16x32_bf16 v[252:255], v[76:79], v[60:63], v[252:255]
    s_waitcnt lgkmcnt(0)
    s_waitcnt vmcnt(8)
    s_barrier
    s_cmp_eq_u32 s28, 0
    s_cbranch_scc1 sig_5
    s_cmp_lg_u32 s3, 0
    s_cbranch_scc1 sig_5
    s_and_b32 s57, s28, 3
    v_mov_b32 v24, s57
    s_bfe_u32 s57, s28, 0x20002
    v_mov_b32 v25, s57
    s_andn2_b32 s28, s28, 15
    s_mov_b64 exec, 1
    buffer_atomic_add_x2 v[24:25], v17, s[4:7], s28 offen sc1
    s_mov_b64 exec, -1
sig_5:
    s_mov_b32 s28, 0
    v_mfma_f32_16x16x32_bf16 v[128:131], v[112:115], v[80:83], v[128:131]
    s_add_u32 m0, s21, 98304
    s_nop 0
    buffer_load_dwordx4 v1, s[4:7], s16 offen sc1 lds
    s_add_u32 s16, s16, s62
    v_mfma_f32_16x16x32_bf16 v[132:135], v[116:119], v[80:83], v[132:135]
    ds_read_b64_tr_b16 v[64:65], v8 offset:16384
    v_mfma_f32_16x16x32_bf16 v[136:139], v[120:123], v[80:83], v[136:139]
    ds_read_b64_tr_b16 v[66:67], v9 offset:16384
    v_mfma_f32_16x16x32_bf16 v[140:143], v[124:127], v[80:83], v[140:143]
    ds_read_b64_tr_b16 v[68:69], v10 offset:16384
    v_mfma_f32_16x16x32_bf16 v[144:147], v[112:115], v[84:87], v[144:147]
    s_add_u32 m0, s21, 99328
    s_nop 0
    buffer_load_dwordx4 v1, s[4:7], s17 offen sc1 lds
    s_add_u32 s17, s17, s62
    v_mfma_f32_16x16x32_bf16 v[148:151], v[116:119], v[84:87], v[148:151]
    ds_read_b64_tr_b16 v[70:71], v11 offset:16384
    v_mfma_f32_16x16x32_bf16 v[152:155], v[120:123], v[84:87], v[152:155]
    ds_read_b64_tr_b16 v[72:73], v8 offset:24576
    v_mfma_f32_16x16x32_bf16 v[156:159], v[124:127], v[84:87], v[156:159]
    ds_read_b64_tr_b16 v[74:75], v9 offset:24576
    v_mfma_f32_16x16x32_bf16 v[160:163], v[112:115], v[88:91], v[160:163]
    s_add_u32 m0, s22, 98304
    s_nop 0
    buffer_load_dwordx4 v2, s[8:11], s18 offen lds
    s_add_u32 s18, s18, s20
    v_mfma_f32_16x16x32_bf16 v[164:167], v[116:119], v[88:91], v[164:167]
    ds_read_b64_tr_b16 v[76:77], v10 offset:24576
    v_mfma_f32_16x16x32_bf16 v[168:171], v[120:123], v[88:91], v[168:171]
    ds_read_b64_tr_b16 v[78:79], v11 offset:24576
    v_mfma_f32_16x16x32_bf16 v[172:175], v[124:127], v[88:91], v[172:175]
    ds_read_b128 v[32:35], v5 offset:0
    v_mfma_f32_16x16x32_bf16 v[176:179], v[112:115], v[92:95], v[176:179]
    s_add_u32 m0, s22, 106496
    s_nop 0
    buffer_load_dwordx4 v2, s[12:15], s19 offen lds
    s_add_u32 s19, s19, s20
    v_mfma_f32_16x16x32_bf16 v[180:183], v[116:119], v[92:95], v[180:183]
    ds_read_b128 v[36:39], v5 offset:1024
    v_mfma_f32_16x16x32_bf16 v[184:187], v[120:123], v[92:95], v[184:187]
    ds_read_b128 v[40:43], v5 offset:2048
    v_mfma_f32_16x16x32_bf16 v[188:191], v[124:127], v[92:95], v[188:191]
    ds_read_b128 v[44:47], v5 offset:3072
    v_mfma_f32_16x16x32_bf16 v[192:195], v[112:115], v[96:99], v[192:195]
    ds_read_b128 v[48:51], v5 offset:4096
    v_mfma_f32_16x16x32_bf16 v[196:199], v[116:119], v[96:99], v[196:199]
    ds_read_b128 v[52:55], v5 offset:5120
    v_mfma_f32_16x16x32_bf16 v[200:203], v[120:123], v[96:99], v[200:203]
    ds_read_b128 v[56:59], v5 offset:6144
    v_mfma_f32_16x16x32_bf16 v[204:207], v[124:127], v[96:99], v[204:207]
    ds_read_b128 v[60:63], v5 offset:7168
    v_mfma_f32_16x16x32_bf16 v[208:211], v[112:115], v[100:103], v[208:211]
    v_mfma_f32_16x16x32_bf16 v[212:215], v[116:119], v[100:103], v[212:215]
    v_mfma_f32_16x16x32_bf16 v[216:219], v[120:123], v[100:103], v[216:219]
    v_mfma_f32_16x16x32_bf16 v[220:223], v[124:127], v[100:103], v[220:223]
    v_mfma_f32_16x16x32_bf16 v[224:227], v[112:115], v[104:107], v[224:227]
    v_mfma_f32_16x16x32_bf16 v[228:231], v[116:119], v[104:107], v[228:231]
    v_mfma_f32_16x16x32_bf16 v[232:235], v[120:123], v[104:107], v[232:235]
    v_mfma_f32_16x16x32_bf16 v[236:239], v[124:127], v[104:107], v[236:239]
    v_mfma_f32_16x16x32_bf16 v[240:243], v[112:115], v[108:111], v[240:243]
    v_mfma_f32_16x16x32_bf16 v[244:247], v[116:119], v[108:111], v[244:247]
    v_mfma_f32_16x16x32_bf16 v[248:251], v[120:123], v[108:111], v[248:251]
    v_mfma_f32_16x16x32_bf16 v[252:255], v[124:127], v[108:111], v[252:255]
    s_waitcnt lgkmcnt(0)
w_loop_chk:
    s_sub_u32 s23, s23, 1
w_loop:
    s_cmp_gt_u32 s23, 3
    s_cbranch_scc1 w_body
    s_cmp_lg_u32 s23, 3
    s_cbranch_scc1 w_l2
    s_cmp_lg_u32 s3, 0
    s_cbranch_scc1 clm_6
    v_mov_b32 v26, 1
    s_mov_b64 exec, 1
    buffer_atomic_add v26, off, s[64:67], s71 sc0 sc1
    s_mov_b64 exec, -1
clm_6:
    s_branch w_body
w_l2:
    s_cmp_lg_u32 s23, 2
    s_cbranch_scc1 w_l1
    s_cmp_lg_u32 s3, 0
    s_cbranch_scc1 pub_7
    v_mov_b32 v20, 131136
    s_mov_b64 exec, 1
    ds_write_b32 v20, v26
    s_mov_b64 exec, -1
    s_waitcnt lgkmcnt(0)
pub_7:
    s_branch w_body
w_l1:
    s_waitcnt vmcnt(8)
    v_readfirstlane_b32 s30, v16
    s_cmp_ge_u32 s30, s45
    s_cselect_b32 s30, 0, 1
    s_or_b32 s30, s30, s70
    s_cmp_eq_u32 s32, 4
    s_cselect_b32 s30, 1, s30
    s_sub_u32 s57, s32, 1
    s_cmp_ge_u32 s57, 4
    s_cselect_b32 s30, 1, s30
    v_mov_b32 v20, s30
    ds_write_b32 v7, v20
    s_cbranch_scc1 w_body
    s_load_dwordx2 s[8:9], s[0:1], s33
    s_load_dwordx2 s[12:13], s[0:1], s34
    s_mov_b32 s10, s38
    s_mov_b32 s14, s38
    s_cmp_eq_u32 s32, 4
    s_cselect_b32 s31, 0, 1
    s_lshl_b32 s30, s3, s31
    s_mul_i32 s30, s30, s40
    s_add_u32 s16, s39, s30
    s_cmp_eq_u32 s32, 4
    s_cselect_b32 s30, 1024, s40
    s_cselect_b32 s31, 6, 5
    s_lshl_b32 s62, 32, s31
    s_add_u32 s17, s16, s30
    s_lshl_b32 s30, s3, 2
    s_mul_i32 s30, s30, s35
    s_add_u32 s18, s36, s30
    s_add_u32 s19, s37, s30
    s_lshl_b32 s20, s35, s31
    v_mul_u32_u24 v2, s35, v4
    v_add_u32 v2, v2, v3
    s_waitcnt lgkmcnt(0)
w_body:
    s_waitcnt vmcnt(8)
    s_barrier
    s_cmp_lg_u32 s23, 2
    s_cbranch_scc1 w_nf
    v_mov_b32 v20, 131136
    ds_read_b32 v20, v20
    s_waitcnt lgkmcnt(0)
    v_readfirstlane_b32 s59, v20
    s_add_u32 s59, s59, 32
    s_min_u32 s59, s59, 322
    s_lshl_b32 s57, s59, 6
    s_load_dwordx16 s[32:47], s[24:25], s57
w_nf:
    v_mfma_f32_16x16x32_bf16 v[128:131], v[64:67], v[32:35], v[128:131]
    s_add_u32 m0, s21, 0
    s_nop 0
    buffer_load_dwordx4 v1, s[4:7], s16 offen sc1 lds
    s_add_u32 s16, s16, s62
    v_mfma_f32_16x16x32_bf16 v[132:135], v[68:71], v[32:35], v[132:135]
    ds_read_b64_tr_b16 v[112:113], v8 offset:49152
    v_mfma_f32_16x16x32_bf16 v[136:139], v[72:75], v[32:35], v[136:139]
    ds_read_b64_tr_b16 v[114:115], v9 offset:49152
    v_mfma_f32_16x16x32_bf16 v[140:143], v[76:79], v[32:35], v[140:143]
    ds_read_b64_tr_b16 v[116:117], v10 offset:49152
    v_mfma_f32_16x16x32_bf16 v[144:147], v[64:67], v[36:39], v[144:147]
    s_add_u32 m0, s21, 1024
    s_nop 0
    buffer_load_dwordx4 v1, s[4:7], s17 offen sc1 lds
    s_add_u32 s17, s17, s62
    v_mfma_f32_16x16x32_bf16 v[148:151], v[68:71], v[36:39], v[148:151]
    ds_read_b64_tr_b16 v[118:119], v11 offset:49152
    v_mfma_f32_16x16x32_bf16 v[152:155], v[72:75], v[36:39], v[152:155]
    ds_read_b64_tr_b16 v[120:121], v8 offset:57344
    v_mfma_f32_16x16x32_bf16 v[156:159], v[76:79], v[36:39], v[156:159]
    ds_read_b64_tr_b16 v[122:123], v9 offset:57344
    v_mfma_f32_16x16x32_bf16 v[160:163], v[64:67], v[40:43], v[160:163]
    s_add_u32 m0, s22, 0
    s_nop 0
    buffer_load_dwordx4 v2, s[8:11], s18 offen lds
    s_add_u32 s18, s18, s20
    v_mfma_f32_16x16x32_bf16 v[164:167], v[68:71], v[40:43], v[164:167]
    ds_read_b64_tr_b16 v[124:125], v10 offset:57344
    v_mfma_f32_16x16x32_bf16 v[168:171], v[72:75], v[40:43], v[168:171]
    ds_read_b64_tr_b16 v[126:127], v11 offset:57344
    v_mfma_f32_16x16x32_bf16 v[172:175], v[76:79], v[40:43], v[172:175]
    ds_read_b128 v[80:83], v5 offset:32768
    v_mfma_f32_16x16x32_bf16 v[176:179], v[64:67], v[44:47], v[176:179]
    s_add_u32 m0, s22, 8192
    s_nop 0
    buffer_load_dwordx4 v2, s[12:15], s19 offen lds
    s_add_u32 s19, s19, s20
    v_mfma_f32_16x16x32_bf16 v[180:183], v[68:71], v[44:47], v[180:183]
    ds_read_b128 v[84:87], v5 offset:33792
    v_mfma_f32_16x16x32_bf16 v[184:187], v[72:75], v[44:47], v[184:187]
    ds_read_b128 v[88:91], v5 offset:34816
    v_mfma_f32_16x16x32_bf16 v[188:191], v[76:79], v[44:47], v[188:191]
    ds_read_b128 v[92:95], v5 offset:35840
    v_mfma_f32_16x16x32_bf16 v[192:195], v[64:67], v[48:51], v[192:195]
    ds_read_b128 v[96:99], v5 offset:36864
    v_mfma_f32_16x16x32_bf16 v[196:199], v[68:71], v[48:51], v[196:199]
    ds_read_b128 v[100:103], v5 offset:37888
    v_mfma_f32_16x16x32_bf16 v[200:203], v[72:75], v[48:51], v[200:203]
    ds_read_b128 v[104:107], v5 offset:38912
    v_mfma_f32_16x16x32_bf16 v[204:207], v[76:79], v[48:51], v[204:207]
    ds_read_b128 v[108:111], v5 offset:39936
    v_mfma_f32_16x16x32_bf16 v[208:211], v[64:67], v[52:55], v[208:211]
    v_mfma_f32_16x16x32_bf16 v[212:215], v[68:71], v[52:55], v[212:215]
    v_mfma_f32_16x16x32_bf16 v[216:219], v[72:75], v[52:55], v[216:219]
    v_mfma_f32_16x16x32_bf16 v[220:223], v[76:79], v[52:55], v[220:223]
    v_mfma_f32_16x16x32_bf16 v[224:227], v[64:67], v[56:59], v[224:227]
    v_mfma_f32_16x16x32_bf16 v[228:231], v[68:71], v[56:59], v[228:231]
    v_mfma_f32_16x16x32_bf16 v[232:235], v[72:75], v[56:59], v[232:235]
    v_mfma_f32_16x16x32_bf16 v[236:239], v[76:79], v[56:59], v[236:239]
    v_mfma_f32_16x16x32_bf16 v[240:243], v[64:67], v[60:63], v[240:243]
    v_mfma_f32_16x16x32_bf16 v[244:247], v[68:71], v[60:63], v[244:247]
    v_mfma_f32_16x16x32_bf16 v[248:251], v[72:75], v[60:63], v[248:251]
    v_mfma_f32_16x16x32_bf16 v[252:255], v[76:79], v[60:63], v[252:255]
    s_waitcnt lgkmcnt(0)
    s_waitcnt vmcnt(8)
    s_barrier
    buffer_load_dword v16, v17, s[4:7], s44 offen sc1
    v_mfma_f32_16x16x32_bf16 v[128:131], v[112:115], v[80:83], v[128:131]
    s_add_u32 m0, s21, 32768
    s_nop 0
    buffer_load_dwordx4 v1, s[4:7], s16 offen sc1 lds
    s_add_u32 s16, s16, s62
    v_mfma_f32_16x16x32_bf16 v[132:135], v[116:119], v[80:83], v[132:135]
    ds_read_b64_tr_b16 v[64:65], v12 offset:16384
    v_mfma_f32_16x16x32_bf16 v[136:139], v[120:123], v[80:83], v[136:139]
    ds_read_b64_tr_b16 v[66:67], v13 offset:16384
    v_mfma_f32_16x16x32_bf16 v[140:143], v[124:127], v[80:83], v[140:143]
    ds_read_b64_tr_b16 v[68:69], v14 offset:16384
    v_mfma_f32_16x16x32_bf16 v[144:147], v[112:115], v[84:87], v[144:147]
    s_add_u32 m0, s21, 33792
    s_nop 0
    buffer_load_dwordx4 v1, s[4:7], s17 offen sc1 lds
    s_add_u32 s17, s17, s62
    v_mfma_f32_16x16x32_bf16 v[148:151], v[116:119], v[84:87], v[148:151]
    ds_read_b64_tr_b16 v[70:71], v15 offset:16384
    v_mfma_f32_16x16x32_bf16 v[152:155], v[120:123], v[84:87], v[152:155]
    ds_read_b64_tr_b16 v[72:73], v12 offset:24576
    v_mfma_f32_16x16x32_bf16 v[156:159], v[124:127], v[84:87], v[156:159]
    ds_read_b64_tr_b16 v[74:75], v13 offset:24576
    v_mfma_f32_16x16x32_bf16 v[160:163], v[112:115], v[88:91], v[160:163]
    s_add_u32 m0, s22, 32768
    s_nop 0
    buffer_load_dwordx4 v2, s[8:11], s18 offen lds
    s_add_u32 s18, s18, s20
    v_mfma_f32_16x16x32_bf16 v[164:167], v[116:119], v[88:91], v[164:167]
    ds_read_b64_tr_b16 v[76:77], v14 offset:24576
    v_mfma_f32_16x16x32_bf16 v[168:171], v[120:123], v[88:91], v[168:171]
    ds_read_b64_tr_b16 v[78:79], v15 offset:24576
    v_mfma_f32_16x16x32_bf16 v[172:175], v[124:127], v[88:91], v[172:175]
    ds_read_b128 v[32:35], v6 offset:0
    v_mfma_f32_16x16x32_bf16 v[176:179], v[112:115], v[92:95], v[176:179]
    s_add_u32 m0, s22, 40960
    s_nop 0
    buffer_load_dwordx4 v2, s[12:15], s19 offen lds
    s_add_u32 s19, s19, s20
    v_mfma_f32_16x16x32_bf16 v[180:183], v[116:119], v[92:95], v[180:183]
    ds_read_b128 v[36:39], v6 offset:1024
    v_mfma_f32_16x16x32_bf16 v[184:187], v[120:123], v[92:95], v[184:187]
    ds_read_b128 v[40:43], v6 offset:2048
    v_mfma_f32_16x16x32_bf16 v[188:191], v[124:127], v[92:95], v[188:191]
    ds_read_b128 v[44:47], v6 offset:3072
    v_mfma_f32_16x16x32_bf16 v[192:195], v[112:115], v[96:99], v[192:195]
    ds_read_b128 v[48:51], v6 offset:4096
    v_mfma_f32_16x16x32_bf16 v[196:199], v[116:119], v[96:99], v[196:199]
    ds_read_b128 v[52:55], v6 offset:5120
    v_mfma_f32_16x16x32_bf16 v[200:203], v[120:123], v[96:99], v[200:203]
    ds_read_b128 v[56:59], v6 offset:6144
    v_mfma_f32_16x16x32_bf16 v[204:207], v[124:127], v[96:99], v[204:207]
    ds_read_b128 v[60:63], v6 offset:7168
    v_mfma_f32_16x16x32_bf16 v[208:211], v[112:115], v[100:103], v[208:211]
    v_mfma_f32_16x16x32_bf16 v[212:215], v[116:119], v[100:103], v[212:215]
    v_mfma_f32_16x16x32_bf16 v[216:219], v[120:123], v[100:103], v[216:219]
    v_mfma_f32_16x16x32_bf16 v[220:223], v[124:127], v[100:103], v[220:223]
    v_mfma_f32_16x16x32_bf16 v[224:227], v[112:115], v[104:107], v[224:227]
    v_mfma_f32_16x16x32_bf16 v[228:231], v[116:119], v[104:107], v[228:231]
    v_mfma_f32_16x16x32_bf16 v[232:235], v[120:123], v[104:107], v[232:235]
    v_mfma_f32_16x16x32_bf16 v[236:239], v[124:127], v[104:107], v[236:239]
    v_mfma_f32_16x16x32_bf16 v[240:243], v[112:115], v[108:111], v[240:243]
    v_mfma_f32_16x16x32_bf16 v[244:247], v[116:119], v[108:111], v[244:247]
    v_mfma_f32_16x16x32_bf16 v[248:251], v[120:123], v[108:111], v[248:251]
    v_mfma_f32_16x16x32_bf16 v[252:255], v[124:127], v[108:111], v[252:255]
    s_waitcnt lgkmcnt(0)
    s_waitcnt vmcnt(8)
    s_barrier
    v_mfma_f32_16x16x32_bf16 v[128:131], v[64:67], v[32:35], v[128:131]
    s_add_u32 m0, s21, 65536
    s_nop 0
    buffer_load_dwordx4 v1, s[4:7], s16 offen sc1 lds
    s_add_u32 s16, s16, s62
    v_mfma_f32_16x16x32_bf16 v[132:135], v[68:71], v[32:35], v[132:135]
    ds_read_b64_tr_b16 v[112:113], v12 offset:49152
    v_mfma_f32_16x16x32_bf16 v[136:139], v[72:75], v[32:35], v[136:139]
    ds_read_b64_tr_b16 v[114:115], v13 offset:49152
    v_mfma_f32_16x16x32_bf16 v[140:143], v[76:79], v[32:35], v[140:143]
    ds_read_b64_tr_b16 v[116:117], v14 offset:49152
    v_mfma_f32_16x16x32_bf16 v[144:147], v[64:67], v[36:39], v[144:147]
    s_add_u32 m0, s21, 66560
    s_nop 0
    buffer_load_dwordx4 v1, s[4:7], s17 offen sc1 lds
    s_add_u32 s17, s17, s62
    v_mfma_f32_16x16x32_bf16 v[148:151], v[68:71], v[36:39], v[148:151]
    ds_read_b64_tr_b16 v[118:119], v15 offset:49152
    v_mfma_f32_16x16x32_bf16 v[152:155], v[72:75], v[36:39], v[152:155]
    ds_read_b64_tr_b16 v[120:121], v12 offset:57344
    v_mfma_f32_16x16x32_bf16 v[156:159], v[76:79], v[36:39], v[156:159]
    ds_read_b64_tr_b16 v[122:123], v13 offset:57344
    v_mfma_f32_16x16x32_bf16 v[160:163], v[64:67], v[40:43], v[160:163]
    s_add_u32 m0, s22, 65536
    s_nop 0
    buffer_load_dwordx4 v2, s[8:11], s18 offen lds
    s_add_u32 s18, s18, s20
    v_mfma_f32_16x16x32_bf16 v[164:167], v[68:71], v[40:43], v[164:167]
    ds_read_b64_tr_b16 v[124:125], v14 offset:57344
    v_mfma_f32_16x16x32_bf16 v[168:171], v[72:75], v[40:43], v[168:171]
    ds_read_b64_tr_b16 v[126:127], v15 offset:57344
    v_mfma_f32_16x16x32_bf16 v[172:175], v[76:79], v[40:43], v[172:175]
    ds_read_b128 v[80:83], v6 offset:32768
    v_mfma_f32_16x16x32_bf16 v[176:179], v[64:67], v[44:47], v[176:179]
    s_add_u32 m0, s22, 73728
    s_nop 0
    buffer_load_dwordx4 v2, s[12:15], s19 offen lds
    s_add_u32 s19, s19, s20
    v_mfma_f32_16x16x32_bf16 v[180:183], v[68:71], v[44:47], v[180:183]
    ds_read_b128 v[84:87], v6 offset:33792
    v_mfma_f32_16x16x32_bf16 v[184:187], v[72:75], v[44:47], v[184:187]
    ds_read_b128 v[88:91], v6 offset:34816
    v_mfma_f32_16x16x32_bf16 v[188:191], v[76:79], v[44:47], v[188:191]
    ds_read_b128 v[92:95], v6 offset:35840
    v_mfma_f32_16x16x32_bf16 v[192:195], v[64:67], v[48:51], v[192:195]
    ds_read_b128 v[96:99], v6 offset:36864
    v_mfma_f32_16x16x32_bf16 v[196:199], v[68:71], v[48:51], v[196:199]
    ds_read_b128 v[100:103], v6 offset:37888
    v_mfma_f32_16x16x32_bf16 v[200:203], v[72:75], v[48:51], v[200:203]
    ds_read_b128 v[104:107], v6 offset:38912
    v_mfma_f32_16x16x32_bf16 v[204:207], v[76:79], v[48:51], v[204:207]
    ds_read_b128 v[108:111], v6 offset:39936
    v_mfma_f32_16x16x32_bf16 v[208:211], v[64:67], v[52:55], v[208:211]
    v_mfma_f32_16x16x32_bf16 v[212:215], v[68:71], v[52:55], v[212:215]
    v_mfma_f32_16x16x32_bf16 v[216:219], v[72:75], v[52:55], v[216:219]
    v_mfma_f32_16x16x32_bf16 v[220:223], v[76:79], v[52:55], v[220:223]
    v_mfma_f32_16x16x32_bf16 v[224:227], v[64:67], v[56:59], v[224:227]
    v_mfma_f32_16x16x32_bf16 v[228:231], v[68:71], v[56:59], v[228:231]
    v_mfma_f32_16x16x32_bf16 v[232:235], v[72:75], v[56:59], v[232:235]
    v_mfma_f32_16x16x32_bf16 v[236:239], v[76:79], v[56:59], v[236:239]
    v_mfma_f32_16x16x32_bf16 v[240:243], v[64:67], v[60:63], v[240:243]
    v_mfma_f32_16x16x32_bf16 v[244:247], v[68:71], v[60:63], v[244:247]
    v_mfma_f32_16x16x32_bf16 v[248:251], v[72:75], v[60:63], v[248:251]
    v_mfma_f32_16x16x32_bf16 v[252:255], v[76:79], v[60:63], v[252:255]
    s_waitcnt lgkmcnt(0)
    s_waitcnt vmcnt(8)
    s_barrier
    v_mfma_f32_16x16x32_bf16 v[128:131], v[112:115], v[80:83], v[128:131]
    s_add_u32 m0, s21, 98304
    s_nop 0
    buffer_load_dwordx4 v1, s[4:7], s16 offen sc1 lds
    s_add_u32 s16, s16, s62
    v_mfma_f32_16x16x32_bf16 v[132:135], v[116:119], v[80:83], v[132:135]
    ds_read_b64_tr_b16 v[64:65], v8 offset:16384
    v_mfma_f32_16x16x32_bf16 v[136:139], v[120:123], v[80:83], v[136:139]
    ds_read_b64_tr_b16 v[66:67], v9 offset:16384
    v_mfma_f32_16x16x32_bf16 v[140:143], v[124:127], v[80:83], v[140:143]
    ds_read_b64_tr_b16 v[68:69], v10 offset:16384
    v_mfma_f32_16x16x32_bf16 v[144:147], v[112:115], v[84:87], v[144:147]
    s_add_u32 m0, s21, 99328
    s_nop 0
    buffer_load_dwordx4 v1, s[4:7], s17 offen sc1 lds
    s_add_u32 s17, s17, s62
    v_mfma_f32_16x16x32_bf16 v[148:151], v[116:119], v[84:87], v[148:151]
    ds_read_b64_tr_b16 v[70:71], v11 offset:16384
    v_mfma_f32_16x16x32_bf16 v[152:155], v[120:123], v[84:87], v[152:155]
    ds_read_b64_tr_b16 v[72:73], v8 offset:24576
    v_mfma_f32_16x16x32_bf16 v[156:159], v[124:127], v[84:87], v[156:159]
    ds_read_b64_tr_b16 v[74:75], v9 offset:24576
    v_mfma_f32_16x16x32_bf16 v[160:163], v[112:115], v[88:91], v[160:163]
    s_add_u32 m0, s22, 98304
    s_nop 0
    buffer_load_dwordx4 v2, s[8:11], s18 offen lds
    s_add_u32 s18, s18, s20
    v_mfma_f32_16x16x32_bf16 v[164:167], v[116:119], v[88:91], v[164:167]
    ds_read_b64_tr_b16 v[76:77], v10 offset:24576
    v_mfma_f32_16x16x32_bf16 v[168:171], v[120:123], v[88:91], v[168:171]
    ds_read_b64_tr_b16 v[78:79], v11 offset:24576
    v_mfma_f32_16x16x32_bf16 v[172:175], v[124:127], v[88:91], v[172:175]
    ds_read_b128 v[32:35], v5 offset:0
    v_mfma_f32_16x16x32_bf16 v[176:179], v[112:115], v[92:95], v[176:179]
    s_add_u32 m0, s22, 106496
    s_nop 0
    buffer_load_dwordx4 v2, s[12:15], s19 offen lds
    s_add_u32 s19, s19, s20
    v_mfma_f32_16x16x32_bf16 v[180:183], v[116:119], v[92:95], v[180:183]
    ds_read_b128 v[36:39], v5 offset:1024
    v_mfma_f32_16x16x32_bf16 v[184:187], v[120:123], v[92:95], v[184:187]
    ds_read_b128 v[40:43], v5 offset:2048
    v_mfma_f32_16x16x32_bf16 v[188:191], v[124:127], v[92:95], v[188:191]
    ds_read_b128 v[44:47], v5 offset:3072
    v_mfma_f32_16x16x32_bf16 v[192:195], v[112:115], v[96:99], v[192:195]
    ds_read_b128 v[48:51], v5 offset:4096
    v_mfma_f32_16x16x32_bf16 v[196:199], v[116:119], v[96:99], v[196:199]
    ds_read_b128 v[52:55], v5 offset:5120
    v_mfma_f32_16x16x32_bf16 v[200:203], v[120:123], v[96:99], v[200:203]
    ds_read_b128 v[56:59], v5 offset:6144
    v_mfma_f32_16x16x32_bf16 v[204:207], v[124:127], v[96:99], v[204:207]
    ds_read_b128 v[60:63], v5 offset:7168
    v_mfma_f32_16x16x32_bf16 v[208:211], v[112:115], v[100:103], v[208:211]
    v_mfma_f32_16x16x32_bf16 v[212:215], v[116:119], v[100:103], v[212:215]
    v_mfma_f32_16x16x32_bf16 v[216:219], v[120:123], v[100:103], v[216:219]
    v_mfma_f32_16x16x32_bf16 v[220:223], v[124:127], v[100:103], v[220:223]
    v_mfma_f32_16x16x32_bf16 v[224:227], v[112:115], v[104:107], v[224:227]
    v_mfma_f32_16x16x32_bf16 v[228:231], v[116:119], v[104:107], v[228:231]
    v_mfma_f32_16x16x32_bf16 v[232:235], v[120:123], v[104:107], v[232:235]
    v_mfma_f32_16x16x32_bf16 v[236:239], v[124:127], v[104:107], v[236:239]
    v_mfma_f32_16x16x32_bf16 v[240:243], v[112:115], v[108:111], v[240:243]
    v_mfma_f32_16x16x32_bf16 v[244:247], v[116:119], v[108:111], v[244:247]
    v_mfma_f32_16x16x32_bf16 v[248:251], v[120:123], v[108:111], v[248:251]
    v_mfma_f32_16x16x32_bf16 v[252:255], v[124:127], v[108:111], v[252:255]
    s_waitcnt lgkmcnt(0)
    s_sub_u32 s23, s23, 1
    s_cmp_lg_u32 s23, 0
    s_cbranch_scc1 w_loop
    v_mov_b32 v20, 131072
    ds_read_b128 v[24:27], v20
    ds_read_b128 v[28:31], v20 offset:16
    s_cmp_eq_u32 s48, 2
    s_cbranch_scc1 w_epi_glu
    s_lshl_b32 s30, s27, 10
    s_add_u32 s30, s30, s49
    s_nop 7
    v_cvt_pk_bf16_f32 v80, v128, v129
    v_cvt_pk_bf16_f32 v81, v130, v131
    v_cvt_pk_bf16_f32 v82, v132, v133
    v_cvt_pk_bf16_f32 v83, v134, v135
    buffer_store_dwordx4 v[80:83], v1, s[4:7], s30 offen sc1
    v_cvt_pk_bf16_f32 v84, v136, v137
    v_cvt_pk_bf16_f32 v85, v138, v139
    v_cvt_pk_bf16_f32 v86, v140, v141
    v_cvt_pk_bf16_f32 v87, v142, v143
    buffer_store_dwordx4 v[84:87], v19, s[4:7], s30 offen sc1
    s_add_u32 s30, s30, s50
    v_cvt_pk_bf16_f32 v88, v144, v145
    v_cvt_pk_bf16_f32 v89, v146, v147
    v_cvt_pk_bf16_f32 v90, v148, v149
    v_cvt_pk_bf16_f32 v91, v150, v151
    buffer_store_dwordx4 v[88:91], v1, s[4:7], s30 offen sc1
    v_cvt_pk_bf16_f32 v92, v152, v153
    v_cvt_pk_bf16_f32 v93, v154, v155
    v_cvt_pk_bf16_f32 v94, v156, v157
    v_cvt_pk_bf16_f32 v95, v158, v159
    buffer_store_dwordx4 v[92:95], v19, s[4:7], s30 offen sc1
    s_add_u32 s30, s30, s50
    v_cvt_pk_bf16_f32 v80, v160, v161
    v_cvt_pk_bf16_f32 v81, v162, v163
    v_cvt_pk_bf16_f32 v82, v164, v165
    v_cvt_pk_bf16_f32 v83, v166, v167
    buffer_store_dwordx4 v[80:83], v1, s[4:7], s30 offen sc1
    v_cvt_pk_bf16_f32 v84, v168, v169
    v_cvt_pk_bf16_f32 v85, v170, v171
    v_cvt_pk_bf16_f32 v86, v172, v173
    v_cvt_pk_bf16_f32 v87, v174, v175
    buffer_store_dwordx4 v[84:87], v19, s[4:7], s30 offen sc1
    s_add_u32 s30, s30, s50
    v_cvt_pk_bf16_f32 v88, v176, v177
    v_cvt_pk_bf16_f32 v89, v178, v179
    v_cvt_pk_bf16_f32 v90, v180, v181
    v_cvt_pk_bf16_f32 v91, v182, v183
    buffer_store_dwordx4 v[88:91], v1, s[4:7], s30 offen sc1
    v_cvt_pk_bf16_f32 v92, v184, v185
    v_cvt_pk_bf16_f32 v93, v186, v187
    v_cvt_pk_bf16_f32 v94, v188, v189
    v_cvt_pk_bf16_f32 v95, v190, v191
    buffer_store_dwordx4 v[92:95], v19, s[4:7], s30 offen sc1
    s_add_u32 s30, s30, s50
    v_cvt_pk_bf16_f32 v80, v192, v193
    v_cvt_pk_bf16_f32 v81, v194, v195
    v_cvt_pk_bf16_f32 v82, v196, v197
    v_cvt_pk_bf16_f32 v83, v198, v199
    buffer_store_dwordx4 v[80:83], v1, s[4:7], s30 offen sc1
    v_cvt_pk_bf16_f32 v84, v200, v201
    v_cvt_pk_bf16_f32 v85, v202, v203
    v_cvt_pk_bf16_f32 v86, v204, v205
    v_cvt_pk_bf16_f32 v87, v206, v207
    buffer_store_dwordx4 v[84:87], v19, s[4:7], s30 offen sc1
    s_add_u32 s30, s30, s50
    v_cvt_pk_bf16_f32 v88, v208, v209
    v_cvt_pk_bf16_f32 v89, v210, v211
    v_cvt_pk_bf16_f32 v90, v212, v213
    v_cvt_pk_bf16_f32 v91, v214, v215
    buffer_store_dwordx4 v[88:91], v1, s[4:7], s30 offen sc1
    v_cvt_pk_bf16_f32 v92, v216, v217
    v_cvt_pk_bf16_f32 v93, v218, v219
    v_cvt_pk_bf16_f32 v94, v220, v221
    v_cvt_pk_bf16_f32 v95, v222, v223
    buffer_store_dwordx4 v[92:95], v19, s[4:7], s30 offen sc1
    s_add_u32 s30, s30, s50
    v_cvt_pk_bf16_f32 v80, v224, v225
    v_cvt_pk_bf16_f32 v81, v226, v227
    v_cvt_pk_bf16_f32 v82, v228, v229
    v_cvt_pk_bf16_f32 v83, v230, v231
    buffer_store_dwordx4 v[80:83], v1, s[4:7], s30 offen sc1
    v_cvt_pk_bf16_f32 v84, v232, v233
    v_cvt_pk_bf16_f32 v85, v234, v235
    v_cvt_pk_bf16_f32 v86, v236, v237
    v_cvt_pk_bf16_f32 v87, v238, v239
    buffer_store_dwordx4 v[84:87], v19, s[4:7], s30 offen sc1
    s_add_u32 s30, s30, s50
    v_cvt_pk_bf16_f32 v88, v240, v241
    v_cvt_pk_bf16_f32 v89, v242, v243
    v_cvt_pk_bf16_f32 v90, v244, v245
    v_cvt_pk_bf16_f32 v91, v246, v247
    buffer_store_dwordx4 v[88:91], v1, s[4:7], s30 offen sc1
    v_cvt_pk_bf16_f32 v92, v248, v249
    v_cvt_pk_bf16_f32 v93, v250, v251
    v_cvt_pk_bf16_f32 v94, v252, v253
    v_cvt_pk_bf16_f32 v95, v254, v255
    buffer_store_dwordx4 v[92:95], v19, s[4:7], s30 offen sc1
    s_waitcnt lgkmcnt(0)
    v_or3_b32 v24, v24, v25, v26
    v_or3_b32 v28, v28, v29, v30
    v_or3_b32 v24, v24, v27, v31
    v_or_b32 v24, v24, v28
    s_mov_b32 s28, s51
    v_readfirstlane_b32 s30, v24
    s_cmp_lg_u32 s30, 0
    s_cbranch_scc1 w_drain
    s_mov_b32 s48, s32
    s_cmp_eq_u32 s32, 4
    s_cselect_b32 s30, 2, 3
    s_lshl_b32 s30, s26, s30
    s_mul_i32 s30, s30, s43
    s_add_u32 s49, s42, s30
    s_mov_b32 s50, s43
    s_mov_b32 s51, s46
    s_mov_b32 s23, s41
    s_mov_b32 s53, s41
    s_branch w_first16
w_epi_glu:
    s_lshl_b32 s30, s27, 10
    s_add_u32 s30, s30, s49
    s_mov_b32 s54, 0xbfb8aa3b
    s_nop 7
    v_cvt_pk_bf16_f32 v80, v128, v129
    v_cvt_pk_bf16_f32 v81, v130, v131
    v_cvt_pk_bf16_f32 v82, v132, v133
    v_cvt_pk_bf16_f32 v83, v134, v135
    v_lshlrev_b32 v96, 16, v80
    v_and_b32 v97, 0xffff0000, v80
    v_lshlrev_b32 v98, 16, v81
    v_and_b32 v99, 0xffff0000, v81
    v_lshlrev_b32 v100, 16, v82
    v_and_b32 v101, 0xffff0000, v82
    v_lshlrev_b32 v102, 16, v83
    v_and_b32 v103, 0xffff0000, v83
    v_mul_f32 v96, s54, v96
    v_mul_f32 v97, s54, v97
    v_mul_f32 v98, s54, v98
    v_mul_f32 v99, s54, v99
    v_mul_f32 v100, s54, v100
    v_mul_f32 v101, s54, v101
    v_mul_f32 v102, s54, v102
    v_mul_f32 v103, s54, v103
    v_exp_f32 v96, v96
    v_exp_f32 v97, v97
    v_exp_f32 v98, v98
    v_exp_f32 v99, v99
    v_exp_f32 v100, v100
    v_exp_f32 v101, v101
    v_exp_f32 v102, v102
    v_exp_f32 v103, v103
    v_add_f32 v96, 1.0, v96
    v_add_f32 v97, 1.0, v97
    v_add_f32 v98, 1.0, v98
    v_add_f32 v99, 1.0, v99
    v_add_f32 v100, 1.0, v100
    v_add_f32 v101, 1.0, v101
    v_add_f32 v102, 1.0, v102
    v_add_f32 v103, 1.0, v103
    v_rcp_f32 v96, v96
    v_rcp_f32 v97, v97
    v_rcp_f32 v98, v98
    v_rcp_f32 v99, v99
    v_rcp_f32 v100, v100
    v_rcp_f32 v101, v101
    v_rcp_f32 v102, v102
    v_rcp_f32 v103, v103
    v_mul_f32 v96, v96, v136
    v_mul_f32 v97, v97, v137
    v_mul_f32 v98, v98, v138
    v_mul_f32 v99, v99, v139
    v_mul_f32 v100, v100, v140
    v_mul_f32 v101, v101, v141
    v_mul_f32 v102, v102, v142
    v_mul_f32 v103, v103, v143
    v_cvt_pk_bf16_f32 v80, v96, v97
    v_cvt_pk_bf16_f32 v81, v98, v99
    v_cvt_pk_bf16_f32 v82, v100, v101
    v_cvt_pk_bf16_f32 v83, v102, v103
    buffer_store_dwordx4 v[80:83], v1, s[4:7], s30 offen sc1
    s_add_u32 s30, s30, s50
    v_cvt_pk_bf16_f32 v84, v144, v145
    v_cvt_pk_bf16_f32 v85, v146, v147
    v_cvt_pk_bf16_f32 v86, v148, v149
    v_cvt_pk_bf16_f32 v87, v150, v151
    v_lshlrev_b32 v104, 16, v84
    v_and_b32 v105, 0xffff0000, v84
    v_lshlrev_b32 v106, 16, v85
    v_and_b32 v107, 0xffff0000, v85
    v_lshlrev_b32 v108, 16, v86
    v_and_b32 v109, 0xffff0000, v86
    v_lshlrev_b32 v110, 16, v87
    v_and_b32 v111, 0xffff0000, v87
    v_mul_f32 v104, s54, v104
    v_mul_f32 v105, s54, v105
    v_mul_f32 v106, s54, v106
    v_mul_f32 v107, s54, v107
    v_mul_f32 v108, s54, v108
    v_mul_f32 v109, s54, v109
    v_mul_f32 v110, s54, v110
    v_mul_f32 v111, s54, v111
    v_exp_f32 v104, v104
    v_exp_f32 v105, v105
    v_exp_f32 v106, v106
    v_exp_f32 v107, v107
    v_exp_f32 v108, v108
    v_exp_f32 v109, v109
    v_exp_f32 v110, v110
    v_exp_f32 v111, v111
    v_add_f32 v104, 1.0, v104
    v_add_f32 v105, 1.0, v105
    v_add_f32 v106, 1.0, v106
    v_add_f32 v107, 1.0, v107
    v_add_f32 v108, 1.0, v108
    v_add_f32 v109, 1.0, v109
    v_add_f32 v110, 1.0, v110
    v_add_f32 v111, 1.0, v111
    v_rcp_f32 v104, v104
    v_rcp_f32 v105, v105
    v_rcp_f32 v106, v106
    v_rcp_f32 v107, v107
    v_rcp_f32 v108, v108
    v_rcp_f32 v109, v109
    v_rcp_f32 v110, v110
    v_rcp_f32 v111, v111
    v_mul_f32 v104, v104, v152
    v_mul_f32 v105, v105, v153
    v_mul_f32 v106, v106, v154
    v_mul_f32 v107, v107, v155
    v_mul_f32 v108, v108, v156
    v_mul_f32 v109, v109, v157
    v_mul_f32 v110, v110, v158
    v_mul_f32 v111, v111, v159
    v_cvt_pk_bf16_f32 v84, v104, v105
    v_cvt_pk_bf16_f32 v85, v106, v107
    v_cvt_pk_bf16_f32 v86, v108, v109
    v_cvt_pk_bf16_f32 v87, v110, v111
    buffer_store_dwordx4 v[84:87], v1, s[4:7], s30 offen sc1
    s_add_u32 s30, s30, s50
    v_cvt_pk_bf16_f32 v88, v160, v161
    v_cvt_pk_bf16_f32 v89, v162, v163
    v_cvt_pk_bf16_f32 v90, v164, v165
    v_cvt_pk_bf16_f32 v91, v166, v167
    v_lshlrev_b32 v96, 16, v88
    v_and_b32 v97, 0xffff0000, v88
    v_lshlrev_b32 v98, 16, v89
    v_and_b32 v99, 0xffff0000, v89
    v_lshlrev_b32 v100, 16, v90
    v_and_b32 v101, 0xffff0000, v90
    v_lshlrev_b32 v102, 16, v91
    v_and_b32 v103, 0xffff0000, v91
    v_mul_f32 v96, s54, v96
    v_mul_f32 v97, s54, v97
    v_mul_f32 v98, s54, v98
    v_mul_f32 v99, s54, v99
    v_mul_f32 v100, s54, v100
    v_mul_f32 v101, s54, v101
    v_mul_f32 v102, s54, v102
    v_mul_f32 v103, s54, v103
    v_exp_f32 v96, v96
    v_exp_f32 v97, v97
    v_exp_f32 v98, v98
    v_exp_f32 v99, v99
    v_exp_f32 v100, v100
    v_exp_f32 v101, v101
    v_exp_f32 v102, v102
    v_exp_f32 v103, v103
    v_add_f32 v96, 1.0, v96
    v_add_f32 v97, 1.0, v97
    v_add_f32 v98, 1.0, v98
    v_add_f32 v99, 1.0, v99
    v_add_f32 v100, 1.0, v100
    v_add_f32 v101, 1.0, v101
    v_add_f32 v102, 1.0, v102
    v_add_f32 v103, 1.0, v103
    v_rcp_f32 v96, v96
    v_rcp_f32 v97, v97
    v_rcp_f32 v98, v98
    v_rcp_f32 v99, v99
    v_rcp_f32 v100, v100
    v_rcp_f32 v101, v101
    v_rcp_f32 v102, v102
    v_rcp_f32 v103, v103
    v_mul_f32 v96, v96, v168
    v_mul_f32 v97, v97, v169
    v_mul_f32 v98, v98, v170
    v_mul_f32 v99, v99, v171
    v_mul_f32 v100, v100, v172
    v_mul_f32 v101, v101, v173
    v_mul_f32 v102, v102, v174
    v_mul_f32 v103, v103, v175
    v_cvt_pk_bf16_f32 v88, v96, v97
    v_cvt_pk_bf16_f32 v89, v98, v99
    v_cvt_pk_bf16_f32 v90, v100, v101
    v_cvt_pk_bf16_f32 v91, v102, v103
    buffer_store_dwordx4 v[88:91], v1, s[4:7], s30 offen sc1
    s_add_u32 s30, s30, s50
    v_cvt_pk_bf16_f32 v92, v176, v177
    v_cvt_pk_bf16_f32 v93, v178, v179
    v_cvt_pk_bf16_f32 v94, v180, v181
    v_cvt_pk_bf16_f32 v95, v182, v183
    v_lshlrev_b32 v104, 16, v92
    v_and_b32 v105, 0xffff0000, v92
    v_lshlrev_b32 v106, 16, v93
    v_and_b32 v107, 0xffff0000, v93
    v_lshlrev_b32 v108, 16, v94
    v_and_b32 v109, 0xffff0000, v94
    v_lshlrev_b32 v110, 16, v95
    v_and_b32 v111, 0xffff0000, v95
    v_mul_f32 v104, s54, v104
    v_mul_f32 v105, s54, v105
    v_mul_f32 v106, s54, v106
    v_mul_f32 v107, s54, v107
    v_mul_f32 v108, s54, v108
    v_mul_f32 v109, s54, v109
    v_mul_f32 v110, s54, v110
    v_mul_f32 v111, s54, v111
    v_exp_f32 v104, v104
    v_exp_f32 v105, v105
    v_exp_f32 v106, v106
    v_exp_f32 v107, v107
    v_exp_f32 v108, v108
    v_exp_f32 v109, v109
    v_exp_f32 v110, v110
    v_exp_f32 v111, v111
    v_add_f32 v104, 1.0, v104
    v_add_f32 v105, 1.0, v105
    v_add_f32 v106, 1.0, v106
    v_add_f32 v107, 1.0, v107
    v_add_f32 v108, 1.0, v108
    v_add_f32 v109, 1.0, v109
    v_add_f32 v110, 1.0, v110
    v_add_f32 v111, 1.0, v111
    v_rcp_f32 v104, v104
    v_rcp_f32 v105, v105
    v_rcp_f32 v106, v106
    v_rcp_f32 v107, v107
    v_rcp_f32 v108, v108
    v_rcp_f32 v109, v109
    v_rcp_f32 v110, v110
    v_rcp_f32 v111, v111
    v_mul_f32 v104, v104, v184
    v_mul_f32 v105, v105, v185
    v_mul_f32 v106, v106, v186
    v_mul_f32 v107, v107, v187
    v_mul_f32 v108, v108, v188
    v_mul_f32 v109, v109, v189
    v_mul_f32 v110, v110, v190
    v_mul_f32 v111, v111, v191
    v_cvt_pk_bf16_f32 v92, v104, v105
    v_cvt_pk_bf16_f32 v93, v106, v107
    v_cvt_pk_bf16_f32 v94, v108, v109
    v_cvt_pk_bf16_f32 v95, v110, v111
    buffer_store_dwordx4 v[92:95], v1, s[4:7], s30 offen sc1
    s_add_u32 s30, s30, s50
    v_cvt_pk_bf16_f32 v80, v192, v193
    v_cvt_pk_bf16_f32 v81, v194, v195
    v_cvt_pk_bf16_f32 v82, v196, v197
    v_cvt_pk_bf16_f32 v83, v198, v199
    v_lshlrev_b32 v96, 16, v80
    v_and_b32 v97, 0xffff0000, v80
    v_lshlrev_b32 v98, 16, v81
    v_and_b32 v99, 0xffff0000, v81
    v_lshlrev_b32 v100, 16, v82
    v_and_b32 v101, 0xffff0000, v82
    v_lshlrev_b32 v102, 16, v83
    v_and_b32 v103, 0xffff0000, v83
    v_mul_f32 v96, s54, v96
    v_mul_f32 v97, s54, v97
    v_mul_f32 v98, s54, v98
    v_mul_f32 v99, s54, v99
    v_mul_f32 v100, s54, v100
    v_mul_f32 v101, s54, v101
    v_mul_f32 v102, s54, v102
    v_mul_f32 v103, s54, v103
    v_exp_f32 v96, v96
    v_exp_f32 v97, v97
    v_exp_f32 v98, v98
    v_exp_f32 v99, v99
    v_exp_f32 v100, v100
    v_exp_f32 v101, v101
    v_exp_f32 v102, v102
    v_exp_f32 v103, v103
    v_add_f32 v96, 1.0, v96
    v_add_f32 v97, 1.0, v97
    v_add_f32 v98, 1.0, v98
    v_add_f32 v99, 1.0, v99
    v_add_f32 v100, 1.0, v100
    v_add_f32 v101, 1.0, v101
    v_add_f32 v102, 1.0, v102
    v_add_f32 v103, 1.0, v103
    v_rcp_f32 v96, v96
    v_rcp_f32 v97, v97
    v_rcp_f32 v98, v98
    v_rcp_f32 v99, v99
    v_rcp_f32 v100, v100
    v_rcp_f32 v101, v101
    v_rcp_f32 v102, v102
    v_rcp_f32 v103, v103
    v_mul_f32 v96, v96, v200
    v_mul_f32 v97, v97, v201
    v_mul_f32 v98, v98, v202
    v_mul_f32 v99, v99, v203
    v_mul_f32 v100, v100, v204
    v_mul_f32 v101, v101, v205
    v_mul_f32 v102, v102, v206
    v_mul_f32 v103, v103, v207
    v_cvt_pk_bf16_f32 v80, v96, v97
    v_cvt_pk_bf16_f32 v81, v98, v99
    v_cvt_pk_bf16_f32 v82, v100, v101
    v_cvt_pk_bf16_f32 v83, v102, v103
    buffer_store_dwordx4 v[80:83], v1, s[4:7], s30 offen sc1
    s_add_u32 s30, s30, s50
    v_cvt_pk_bf16_f32 v84, v208, v209
    v_cvt_pk_bf16_f32 v85, v210, v211
    v_cvt_pk_bf16_f32 v86, v212, v213
    v_cvt_pk_bf16_f32 v87, v214, v215
    v_lshlrev_b32 v104, 16, v84
    v_and_b32 v105, 0xffff0000, v84
    v_lshlrev_b32 v106, 16, v85
    v_and_b32 v107, 0xffff0000, v85
    v_lshlrev_b32 v108, 16, v86
    v_and_b32 v109, 0xffff0000, v86
    v_lshlrev_b32 v110, 16, v87
    v_and_b32 v111, 0xffff0000, v87
    v_mul_f32 v104, s54, v104
    v_mul_f32 v105, s54, v105
    v_mul_f32 v106, s54, v106
    v_mul_f32 v107, s54, v107
    v_mul_f32 v108, s54, v108
    v_mul_f32 v109, s54, v109
    v_mul_f32 v110, s54, v110
    v_mul_f32 v111, s54, v111
    v_exp_f32 v104, v104
    v_exp_f32 v105, v105
    v_exp_f32 v106, v106
    v_exp_f32 v107, v107
    v_exp_f32 v108, v108
    v_exp_f32 v109, v109
    v_exp_f32 v110, v110
    v_exp_f32 v111, v111
    v_add_f32 v104, 1.0, v104
    v_add_f32 v105, 1.0, v105
    v_add_f32 v106, 1.0, v106
    v_add_f32 v107, 1.0, v107
    v_add_f32 v108, 1.0, v108
    v_add_f32 v109, 1.0, v109
    v_add_f32 v110, 1.0, v110
    v_add_f32 v111, 1.0, v111
    v_rcp_f32 v104, v104
    v_rcp_f32 v105, v105
    v_rcp_f32 v106, v106
    v_rcp_f32 v107, v107
    v_rcp_f32 v108, v108
    v_rcp_f32 v109, v109
    v_rcp_f32 v110, v110
    v_rcp_f32 v111, v111
    v_mul_f32 v104, v104, v216
    v_mul_f32 v105, v105, v217
    v_mul_f32 v106, v106, v218
    v_mul_f32 v107, v107, v219
    v_mul_f32 v108, v108, v220
    v_mul_f32 v109, v109, v221
    v_mul_f32 v110, v110, v222
    v_mul_f32 v111, v111, v223
    v_cvt_pk_bf16_f32 v84, v104, v105
    v_cvt_pk_bf16_f32 v85, v106, v107
    v_cvt_pk_bf16_f32 v86, v108, v109
    v_cvt_pk_bf16_f32 v87, v110, v111
    buffer_store_dwordx4 v[84:87], v1, s[4:7], s30 offen sc1
    s_add_u32 s30, s30, s50
    v_cvt_pk_bf16_f32 v88, v224, v225
    v_cvt_pk_bf16_f32 v89, v226, v227
    v_cvt_pk_bf16_f32 v90, v228, v229
    v_cvt_pk_bf16_f32 v91, v230, v231
    v_lshlrev_b32 v96, 16, v88
    v_and_b32 v97, 0xffff0000, v88
    v_lshlrev_b32 v98, 16, v89
    v_and_b32 v99, 0xffff0000, v89
    v_lshlrev_b32 v100, 16, v90
    v_and_b32 v101, 0xffff0000, v90
    v_lshlrev_b32 v102, 16, v91
    v_and_b32 v103, 0xffff0000, v91
    v_mul_f32 v96, s54, v96
    v_mul_f32 v97, s54, v97
    v_mul_f32 v98, s54, v98
    v_mul_f32 v99, s54, v99
    v_mul_f32 v100, s54, v100
    v_mul_f32 v101, s54, v101
    v_mul_f32 v102, s54, v102
    v_mul_f32 v103, s54, v103
    v_exp_f32 v96, v96
    v_exp_f32 v97, v97
    v_exp_f32 v98, v98
    v_exp_f32 v99, v99
    v_exp_f32 v100, v100
    v_exp_f32 v101, v101
    v_exp_f32 v102, v102
    v_exp_f32 v103, v103
    v_add_f32 v96, 1.0, v96
    v_add_f32 v97, 1.0, v97
    v_add_f32 v98, 1.0, v98
    v_add_f32 v99, 1.0, v99
    v_add_f32 v100, 1.0, v100
    v_add_f32 v101, 1.0, v101
    v_add_f32 v102, 1.0, v102
    v_add_f32 v103, 1.0, v103
    v_rcp_f32 v96, v96
    v_rcp_f32 v97, v97
    v_rcp_f32 v98, v98
    v_rcp_f32 v99, v99
    v_rcp_f32 v100, v100
    v_rcp_f32 v101, v101
    v_rcp_f32 v102, v102
    v_rcp_f32 v103, v103
    v_mul_f32 v96, v96, v232
    v_mul_f32 v97, v97, v233
    v_mul_f32 v98, v98, v234
    v_mul_f32 v99, v99, v235
    v_mul_f32 v100, v100, v236
    v_mul_f32 v101, v101, v237
    v_mul_f32 v102, v102, v238
    v_mul_f32 v103, v103, v239
    v_cvt_pk_bf16_f32 v88, v96, v97
    v_cvt_pk_bf16_f32 v89, v98, v99
    v_cvt_pk_bf16_f32 v90, v100, v101
    v_cvt_pk_bf16_f32 v91, v102, v103
    buffer_store_dwordx4 v[88:91], v1, s[4:7], s30 offen sc1
    s_add_u32 s30, s30, s50
    v_cvt_pk_bf16_f32 v92, v240, v241
    v_cvt_pk_bf16_f32 v93, v242, v243
    v_cvt_pk_bf16_f32 v94, v244, v245
    v_cvt_pk_bf16_f32 v95, v246, v247
    v_lshlrev_b32 v104, 16, v92
    v_and_b32 v105, 0xffff0000, v92
    v_lshlrev_b32 v106, 16, v93
    v_and_b32 v107, 0xffff0000, v93
    v_lshlrev_b32 v108, 16, v94
    v_and_b32 v109, 0xffff0000, v94
    v_lshlrev_b32 v110, 16, v95
    v_and_b32 v111, 0xffff0000, v95
    v_mul_f32 v104, s54, v104
    v_mul_f32 v105, s54, v105
    v_mul_f32 v106, s54, v106
    v_mul_f32 v107, s54, v107
    v_mul_f32 v108, s54, v108
    v_mul_f32 v109, s54, v109
    v_mul_f32 v110, s54, v110
    v_mul_f32 v111, s54, v111
    v_exp_f32 v104, v104
    v_exp_f32 v105, v105
    v_exp_f32 v106, v106
    v_exp_f32 v107, v107
    v_exp_f32 v108, v108
    v_exp_f32 v109, v109
    v_exp_f32 v110, v110
    v_exp_f32 v111, v111
    v_add_f32 v104, 1.0, v104
    v_add_f32 v105, 1.0, v105
    v_add_f32 v106, 1.0, v106
    v_add_f32 v107, 1.0, v107
    v_add_f32 v108, 1.0, v108
    v_add_f32 v109, 1.0, v109
    v_add_f32 v110, 1.0, v110
    v_add_f32 v111, 1.0, v111
    v_rcp_f32 v104, v104
    v_rcp_f32 v105, v105
    v_rcp_f32 v106, v106
    v_rcp_f32 v107, v107
    v_rcp_f32 v108, v108
    v_rcp_f32 v109, v109
    v_rcp_f32 v110, v110
    v_rcp_f32 v111, v111
    v_mul_f32 v104, v104, v248
    v_mul_f32 v105, v105, v249
    v_mul_f32 v106, v106, v250
    v_mul_f32 v107, v107, v251
    v_mul_f32 v108, v108, v252
    v_mul_f32 v109, v109, v253
    v_mul_f32 v110, v110, v254
    v_mul_f32 v111, v111, v255
    v_cvt_pk_bf16_f32 v92, v104, v105
    v_cvt_pk_bf16_f32 v93, v106, v107
    v_cvt_pk_bf16_f32 v94, v108, v109
    v_cvt_pk_bf16_f32 v95, v110, v111
    buffer_store_dwordx4 v[92:95], v1, s[4:7], s30 offen sc1
    s_waitcnt lgkmcnt(0)
    v_or3_b32 v24, v24, v25, v26
    v_or3_b32 v28, v28, v29, v30
    v_or3_b32 v24, v24, v27, v31
    v_or_b32 v24, v24, v28
    s_mov_b32 s28, s51
    v_readfirstlane_b32 s30, v24
    s_cmp_lg_u32 s30, 0
    s_cbranch_scc1 w_drain
    s_mov_b32 s48, s32
    s_cmp_eq_u32 s32, 4
    s_cselect_b32 s30, 2, 3
    s_lshl_b32 s30, s26, s30
    s_mul_i32 s30, s30, s43
    s_add_u32 s49, s42, s30
    s_mov_b32 s50, s43
    s_mov_b32 s51, s46
    s_mov_b32 s23, s41
    s_mov_b32 s53, s41
    s_branch w_first8
w_firstH:
    s_waitcnt vmcnt(8)
    s_barrier
    s_add_u32 m0, s21, 0
    s_nop 0
    buffer_load_dwordx4 v1, s[4:7], s16 offen sc1 lds
    s_add_u32 s16, s16, s62
    s_add_u32 m0, s21, 1024
    s_nop 0
    buffer_load_dwordx4 v1, s[4:7], s17 offen sc1 lds
    s_add_u32 s17, s17, s62
    s_add_u32 m0, s22, 0
    s_nop 0
    buffer_load_dwordx4 v2, s[8:11], s18 offen lds
    s_add_u32 s18, s18, s20
    s_add_u32 m0, s22, 8192
    s_nop 0
    buffer_load_dwordx4 v2, s[12:15], s19 offen lds
    s_add_u32 s19, s19, s20
    v_mfma_f32_16x16x32_bf16 v[128:131], v[64:67], v[32:35], 0
    ds_read_b64_tr_b16 v[112:113], v8 offset:49152
    v_mfma_f32_16x16x32_bf16 v[132:135], v[68:71], v[32:35], 0
    ds_read_b64_tr_b16 v[114:115], v9 offset:49152
    v_mfma_f32_16x16x32_bf16 v[144:147], v[64:67], v[40:43], 0
    ds_read_b64_tr_b16 v[116:117], v10 offset:49152
    v_mfma_f32_16x16x32_bf16 v[148:151], v[68:71], v[40:43], 0
    ds_read_b64_tr_b16 v[118:119], v11 offset:49152
    v_mfma_f32_16x16x32_bf16 v[160:163], v[64:67], v[48:51], 0
    ds_read_b64_tr_b16 v[120:121], v8 offset:57344
    v_mfma_f32_16x16x32_bf16 v[164:167], v[68:71], v[48:51], 0
    ds_read_b64_tr_b16 v[122:123], v9 offset:57344
    v_mfma_f32_16x16x32_bf16 v[176:179], v[64:67], v[56:59], 0
    ds_read_b64_tr_b16 v[124:125], v10 offset:57344
    v_mfma_f32_16x16x32_bf16 v[180:183], v[68:71], v[56:59], 0
    ds_read_b64_tr_b16 v[126:127], v11 offset:57344
    v_mfma_f32_16x16x32_bf16 v[128:131], v[72:75], v[36:39], v[128:131]
    ds_read_b128 v[80:83], v5 offset:32768
    v_mfma_f32_16x16x32_bf16 v[132:135], v[76:79], v[36:39], v[132:135]
    ds_read_b128 v[84:87], v5 offset:33792
    v_mfma_f32_16x16x32_bf16 v[144:147], v[72:75], v[44:47], v[144:147]
    ds_read_b128 v[88:91], v5 offset:34816
    v_mfma_f32_16x16x32_bf16 v[148:151], v[76:79], v[44:47], v[148:151]
    ds_read_b128 v[92:95], v5 offset:35840
    v_mfma_f32_16x16x32_bf16 v[160:163], v[72:75], v[52:55], v[160:163]
    ds_read_b128 v[96:99], v5 offset:36864
    v_mfma_f32_16x16x32_bf16 v[164:167], v[76:79], v[52:55], v[164:167]
    ds_read_b128 v[100:103], v5 offset:37888
    v_mfma_f32_16x16x32_bf16 v[176:179], v[72:75], v[60:63], v[176:179]
    ds_read_b128 v[104:107], v5 offset:38912
    v_mfma_f32_16x16x32_bf16 v[180:183], v[76:79], v[60:63], v[180:183]
    ds_read_b128 v[108:111], v5 offset:39936
    s_waitcnt lgkmcnt(0)
    s_waitcnt vmcnt(8)
    s_barrier
    s_add_u32 m0, s21, 32768
    s_nop 0
    buffer_load_dwordx4 v1, s[4:7], s16 offen sc1 lds
    s_add_u32 s16, s16, s62
    s_add_u32 m0, s21, 33792
    s_nop 0
    buffer_load_dwordx4 v1, s[4:7], s17 offen sc1 lds
    s_add_u32 s17, s17, s62
    s_add_u32 m0, s22, 32768
    s_nop 0
    buffer_load_dwordx4 v2, s[8:11], s18 offen lds
    s_add_u32 s18, s18, s20
    s_add_u32 m0, s22, 40960
    s_nop 0
    buffer_load_dwordx4 v2, s[12:15], s19 offen lds
    s_add_u32 s19, s19, s20
    v_mfma_f32_16x16x32_bf16 v[128:131], v[112:115], v[80:83], v[128:131]
    ds_read_b64_tr_b16 v[64:65], v12 offset:16384
    v_mfma_f32_16x16x32_bf16 v[132:135], v[116:119], v[80:83], v[132:135]
    ds_read_b64_tr_b16 v[66:67], v13 offset:16384
    v_mfma_f32_16x16x32_bf16 v[144:147], v[112:115], v[88:91], v[144:147]
    ds_read_b64_tr_b16 v[68:69], v14 offset:16384
    v_mfma_f32_16x16x32_bf16 v[148:151], v[116:119], v[88:91], v[148:151]
    ds_read_b64_tr_b16 v[70:71], v15 offset:16384
    v_mfma_f32_16x16x32_bf16 v[160:163], v[112:115], v[96:99], v[160:163]
    ds_read_b64_tr_b16 v[72:73], v12 offset:24576
    v_mfma_f32_16x16x32_bf16 v[164:167], v[116:119], v[96:99], v[164:167]
    ds_read_b64_tr_b16 v[74:75], v13 offset:24576
    v_mfma_f32_16x16x32_bf16 v[176:179], v[112:115], v[104:107], v[176:179]
    ds_read_b64_tr_b16 v[76:77], v14 offset:24576
    v_mfma_f32_16x16x32_bf16 v[180:183], v[116:119], v[104:107], v[180:183]
    ds_read_b64_tr_b16 v[78:79], v15 offset:24576
    v_mfma_f32_16x16x32_bf16 v[128:131], v[120:123], v[84:87], v[128:131]
    ds_read_b128 v[32:35], v6 offset:0
    v_mfma_f32_16x16x32_bf16 v[132:135], v[124:127], v[84:87], v[132:135]
    ds_read_b128 v[36:39], v6 offset:1024
    v_mfma_f32_16x16x32_bf16 v[144:147], v[120:123], v[92:95], v[144:147]
    ds_read_b128 v[40:43], v6 offset:2048
    v_mfma_f32_16x16x32_bf16 v[148:151], v[124:127], v[92:95], v[148:151]
    ds_read_b128 v[44:47], v6 offset:3072
    v_mfma_f32_16x16x32_bf16 v[160:163], v[120:123], v[100:103], v[160:163]
    ds_read_b128 v[48:51], v6 offset:4096
    v_mfma_f32_16x16x32_bf16 v[164:167], v[124:127], v[100:103], v[164:167]
    ds_read_b128 v[52:55], v6 offset:5120
    v_mfma_f32_16x16x32_bf16 v[176:179], v[120:123], v[108:111], v[176:179]
    ds_read_b128 v[56:59], v6 offset:6144
    v_mfma_f32_16x16x32_bf16 v[180:183], v[124:127], v[108:111], v[180:183]
    ds_read_b128 v[60:63], v6 offset:7168
    s_waitcnt lgkmcnt(0)
    s_waitcnt vmcnt(8)
    s_barrier
    s_add_u32 m0, s21, 65536
    s_nop 0
    buffer_load_dwordx4 v1, s[4:7], s16 offen sc1 lds
    s_add_u32 s16, s16, s62
    s_add_u32 m0, s21, 66560
    s_nop 0
    buffer_load_dwordx4 v1, s[4:7], s17 offen sc1 lds
    s_add_u32 s17, s17, s62
    s_add_u32 m0, s22, 65536
    s_nop 0
    buffer_load_dwordx4 v2, s[8:11], s18 offen lds
    s_add_u32 s18, s18, s20
    s_add_u32 m0, s22, 73728
    s_nop 0
    buffer_load_dwordx4 v2, s[12:15], s19 offen lds
    s_add_u32 s19, s19, s20
    v_mfma_f32_16x16x32_bf16 v[128:131], v[64:67], v[32:35], v[128:131]
    ds_read_b64_tr_b16 v[112:113], v12 offset:49152
    v_mfma_f32_16x16x32_bf16 v[132:135], v[68:71], v[32:35], v[132:135]
    ds_read_b64_tr_b16 v[114:115], v13 offset:49152
    v_mfma_f32_16x16x32_bf16 v[144:147], v[64:67], v[40:43], v[144:147]
    ds_read_b64_tr_b16 v[116:117], v14 offset:49152
    v_mfma_f32_16x16x32_bf16 v[148:151], v[68:71], v[40:43], v[148:151]
    ds_read_b64_tr_b16 v[118:119], v15 offset:49152
    v_mfma_f32_16x16x32_bf16 v[160:163], v[64:67], v[48:51], v[160:163]
    ds_read_b64_tr_b16 v[120:121], v12 offset:57344
    v_mfma_f32_16x16x32_bf16 v[164:167], v[68:71], v[48:51], v[164:167]
    ds_read_b64_tr_b16 v[122:123], v13 offset:57344
    v_mfma_f32_16x16x32_bf16 v[176:179], v[64:67], v[56:59], v[176:179]
    ds_read_b64_tr_b16 v[124:125], v14 offset:57344
    v_mfma_f32_16x16x32_bf16 v[180:183], v[68:71], v[56:59], v[180:183]
    ds_read_b64_tr_b16 v[126:127], v15 offset:57344
    v_mfma_f32_16x16x32_bf16 v[128:131], v[72:75], v[36:39], v[128:131]
    ds_read_b128 v[80:83], v6 offset:32768
    v_mfma_f32_16x16x32_bf16 v[132:135], v[76:79], v[36:39], v[132:135]
    ds_read_b128 v[84:87], v6 offset:33792
    v_mfma_f32_16x16x32_bf16 v[144:147], v[72:75], v[44:47], v[144:147]
    ds_read_b128 v[88:91], v6 offset:34816
    v_mfma_f32_16x16x32_bf16 v[148:151], v[76:79], v[44:47], v[148:151]
    ds_read_b128 v[92:95], v6 offset:35840
    v_mfma_f32_16x16x32_bf16 v[160:163], v[72:75], v[52:55], v[160:163]
    ds_read_b128 v[96:99], v6 offset:36864
    v_mfma_f32_16x16x32_bf16 v[164:167], v[76:79], v[52:55], v[164:167]
    ds_read_b128 v[100:103], v6 offset:37888
    v_mfma_f32_16x16x32_bf16 v[176:179], v[72:75], v[60:63], v[176:179]
    ds_read_b128 v[104:107], v6 offset:38912
    v_mfma_f32_16x16x32_bf16 v[180:183], v[76:79], v[60:63], v[180:183]
    ds_read_b128 v[108:111], v6 offset:39936
    s_waitcnt lgkmcnt(0)
    s_waitcnt vmcnt(8)
    s_barrier
    s_add_u32 m0, s21, 98304
    s_nop 0
    buffer_load_dwordx4 v1, s[4:7], s16 offen sc1 lds
    s_add_u32 s16, s16, s62
    s_add_u32 m0, s21, 99328
    s_nop 0
    buffer_load_dwordx4 v1, s[4:7], s17 offen sc1 lds
    s_add_u32 s17, s17, s62
    s_add_u32 m0, s22, 98304
    s_nop 0
    buffer_load_dwordx4 v2, s[8:11], s18 offen lds
    s_add_u32 s18, s18, s20
    s_add_u32 m0, s22, 106496
    s_nop 0
    buffer_load_dwordx4 v2, s[12:15], s19 offen lds
    s_add_u32 s19, s19, s20
    v_mfma_f32_16x16x32_bf16 v[128:131], v[112:115], v[80:83], v[128:131]
    ds_read_b64_tr_b16 v[64:65], v8 offset:16384
    v_mfma_f32_16x16x32_bf16 v[132:135], v[116:119], v[80:83], v[132:135]
    ds_read_b64_tr_b16 v[66:67], v9 offset:16384
    v_mfma_f32_16x16x32_bf16 v[144:147], v[112:115], v[88:91], v[144:147]
    ds_read_b64_tr_b16 v[68:69], v10 offset:16384
    v_mfma_f32_16x16x32_bf16 v[148:151], v[116:119], v[88:91], v[148:151]
    ds_read_b64_tr_b16 v[70:71], v11 offset:16384
    v_mfma_f32_16x16x32_bf16 v[160:163], v[112:115], v[96:99], v[160:163]
    ds_read_b64_tr_b16 v[72:73], v8 offset:24576
    v_mfma_f32_16x16x32_bf16 v[164:167], v[116:119], v[96:99], v[164:167]
    ds_read_b64_tr_b16 v[74:75], v9 offset:24576
    v_mfma_f32_16x16x32_bf16 v[176:179], v[112:115], v[104:107], v[176:179]
    ds_read_b64_tr_b16 v[76:77], v10 offset:24576
    v_mfma_f32_16x16x32_bf16 v[180:183], v[116:119], v[104:107], v[180:183]
    ds_read_b64_tr_b16 v[78:79], v11 offset:24576
    v_mfma_f32_16x16x32_bf16 v[128:131], v[120:123], v[84:87], v[128:131]
    ds_read_b128 v[32:35], v5 offset:0
    v_mfma_f32_16x16x32_bf16 v[132:135], v[124:127], v[84:87], v[132:135]
    ds_read_b128 v[36:39], v5 offset:1024
    v_mfma_f32_16x16x32_bf16 v[144:147], v[120:123], v[92:95], v[144:147]
    ds_read_b128 v[40:43], v5 offset:2048
    v_mfma_f32_16x16x32_bf16 v[148:151], v[124:127], v[92:95], v[148:151]
    ds_read_b128 v[44:47], v5 offset:3072
    v_mfma_f32_16x16x32_bf16 v[160:163], v[120:123], v[100:103], v[160:163]
    ds_read_b128 v[48:51], v5 offset:4096
    v_mfma_f32_16x16x32_bf16 v[164:167], v[124:127], v[100:103], v[164:167]
    ds_read_b128 v[52:55], v5 offset:5120
    v_mfma_f32_16x16x32_bf16 v[176:179], v[120:123], v[108:111], v[176:179]
    ds_read_b128 v[56:59], v5 offset:6144
    v_mfma_f32_16x16x32_bf16 v[180:183], v[124:127], v[108:111], v[180:183]
    ds_read_b128 v[60:63], v5 offset:7168
    s_waitcnt lgkmcnt(0)
w_loop_chkH:
    s_sub_u32 s23, s23, 1
w_loopH:
    s_cmp_gt_u32 s23, 3
    s_cbranch_scc1 w_bodyH
    s_cmp_lg_u32 s23, 3
    s_cbranch_scc1 w_l2H
    s_cmp_lg_u32 s3, 0
    s_cbranch_scc1 clm_8
    v_mov_b32 v26, 1
    s_mov_b64 exec, 1
    buffer_atomic_add v26, off, s[64:67], s71 sc0 sc1
    s_mov_b64 exec, -1
clm_8:
    s_branch w_bodyH
w_l2H:
    s_cmp_lg_u32 s23, 2
    s_cbranch_scc1 w_l1H
    s_cmp_lg_u32 s3, 0
    s_cbranch_scc1 pub_9
    v_mov_b32 v20, 131136
    s_mov_b64 exec, 1
    ds_write_b32 v20, v26
    s_mov_b64 exec, -1
    s_waitcnt lgkmcnt(0)
pub_9:
    s_branch w_bodyH
w_l1H:
    s_waitcnt vmcnt(8)
    buffer_load_dword v22, off, s[64:67], 0 sc1
    v_readfirstlane_b32 s30, v16
    s_cmp_ge_u32 s30, s45
    s_cselect_b32 s30, 0, 1
    s_or_b32 s30, s30, s70
    s_cmp_eq_u32 s32, 4
    s_cselect_b32 s30, 1, s30
    s_sub_u32 s57, s32, 1
    s_cmp_ge_u32 s57, 4
    s_cselect_b32 s30, 1, s30
    v_mov_b32 v20, s30
    ds_write_b32 v7, v20
    s_cbranch_scc1 w_bodyH
    s_load_dwordx2 s[8:9], s[0:1], s33
    s_load_dwordx2 s[12:13], s[0:1], s34
    s_mov_b32 s10, s38
    s_mov_b32 s14, s38
    s_cmp_eq_u32 s32, 4
    s_cselect_b32 s31, 0, 1
    s_lshl_b32 s30, s3, s31
    s_mul_i32 s30, s30, s40
    s_add_u32 s16, s39, s30
    s_cmp_eq_u32 s32, 4
    s_cselect_b32 s30, 1024, s40
    s_cselect_b32 s31, 6, 5
    s_lshl_b32 s62, 32, s31
    s_add_u32 s17, s16, s30
    s_lshl_b32 s30, s3, 2
    s_mul_i32 s30, s30, s35
    s_add_u32 s18, s36, s30
    s_add_u32 s19, s37, s30
    s_lshl_b32 s20, s35, s31
    v_mul_u32_u24 v2, s35, v4
    v_add_u32 v2, v2, v3
    s_waitcnt lgkmcnt(0)
w_bodyH:
    s_waitcnt vmcnt(8)
    s_barrier
    s_cmp_lg_u32 s23, 2
    s_cbranch_scc1 w_nfH
    v_mov_b32 v20, 131136
    ds_read_b32 v20, v20
    s_waitcnt lgkmcnt(0)
    v_readfirstlane_b32 s59, v20
    s_add_u32 s59, s59, 32
    s_min_u32 s59, s59, 322
    s_lshl_b32 s57, s59, 6
    s_load_dwordx16 s[32:47], s[24:25], s57
w_nfH:
    s_add_u32 m0, s21, 0
    s_nop 0
    buffer_load_dwordx4 v1, s[4:7], s16 offen sc1 lds
    s_add_u32 s16, s16, s62
    s_add_u32 m0, s21, 1024
    s_nop 0
    buffer_load_dwordx4 v1, s[4:7], s17 offen sc1 lds
    s_add_u32 s17, s17, s62
    s_add_u32 m0, s22, 0
    s_nop 0
    buffer_load_dwordx4 v2, s[8:11], s18 offen lds
    s_add_u32 s18, s18, s20
    s_add_u32 m0, s22, 8192
    s_nop 0
    buffer_load_dwordx4 v2, s[12:15], s19 offen lds
    s_add_u32 s19, s19, s20
    v_mfma_f32_16x16x32_bf16 v[128:131], v[64:67], v[32:35], v[128:131]
    ds_read_b64_tr_b16 v[112:113], v8 offset:49152
    v_mfma_f32_16x16x32_bf16 v[132:135], v[68:71], v[32:35], v[132:135]
    ds_read_b64_tr_b16 v[114:115], v9 offset:49152
    v_mfma_f32_16x16x32_bf16 v[144:147], v[64:67], v[40:43], v[144:147]
    ds_read_b64_tr_b16 v[116:117], v10 offset:49152
    v_mfma_f32_16x16x32_bf16 v[148:151], v[68:71], v[40:43], v[148:151]
    ds_read_b64_tr_b16 v[118:119], v11 offset:49152
    v_mfma_f32_16x16x32_bf16 v[160:163], v[64:67], v[48:51], v[160:163]
    ds_read_b64_tr_b16 v[120:121], v8 offset:57344
    v_mfma_f32_16x16x32_bf16 v[164:167], v[68:71], v[48:51], v[164:167]
    ds_read_b64_tr_b16 v[122:123], v9 offset:57344
    v_mfma_f32_16x16x32_bf16 v[176:179], v[64:67], v[56:59], v[176:179]
    ds_read_b64_tr_b16 v[124:125], v10 offset:57344
    v_mfma_f32_16x16x32_bf16 v[180:183], v[68:71], v[56:59], v[180:183]
    ds_read_b64_tr_b16 v[126:127], v11 offset:57344
    v_mfma_f32_16x16x32_bf16 v[128:131], v[72:75], v[36:39], v[128:131]
    ds_read_b128 v[80:83], v5 offset:32768
    v_mfma_f32_16x16x32_bf16 v[132:135], v[76:79], v[36:39], v[132:135]
    ds_read_b128 v[84:87], v5 offset:33792
    v_mfma_f32_16x16x32_bf16 v[144:147], v[72:75], v[44:47], v[144:147]
    ds_read_b128 v[88:91], v5 offset:34816
    v_mfma_f32_16x16x32_bf16 v[148:151], v[76:79], v[44:47], v[148:151]
    ds_read_b128 v[92:95], v5 offset:35840
    v_mfma_f32_16x16x32_bf16 v[160:163], v[72:75], v[52:55], v[160:163]
    ds_read_b128 v[96:99], v5 offset:36864
    v_mfma_f32_16x16x32_bf16 v[164:167], v[76:79], v[52:55], v[164:167]
    ds_read_b128 v[100:103], v5 offset:37888
    v_mfma_f32_16x16x32_bf16 v[176:179], v[72:75], v[60:63], v[176:179]
    ds_read_b128 v[104:107], v5 offset:38912
    v_mfma_f32_16x16x32_bf16 v[180:183], v[76:79], v[60:63], v[180:183]
    ds_read_b128 v[108:111], v5 offset:39936
    s_waitcnt lgkmcnt(0)
    s_waitcnt vmcnt(8)
    s_barrier
    buffer_load_dword v16, v17, s[4:7], s44 offen sc1
    s_add_u32 m0, s21, 32768
    s_nop 0
    buffer_load_dwordx4 v1, s[4:7], s16 offen sc1 lds
    s_add_u32 s16, s16, s62
    s_add_u32 m0, s21, 33792
    s_nop 0
    buffer_load_dwordx4 v1, s[4:7], s17 offen sc1 lds
    s_add_u32 s17, s17, s62
    s_add_u32 m0, s22, 32768
    s_nop 0
    buffer_load_dwordx4 v2, s[8:11], s18 offen lds
    s_add_u32 s18, s18, s20
    s_add_u32 m0, s22, 40960
    s_nop 0
    buffer_load_dwordx4 v2, s[12:15], s19 offen lds
    s_add_u32 s19, s19, s20
    v_mfma_f32_16x16x32_bf16 v[128:131], v[112:115], v[80:83], v[128:131]
    ds_read_b64_tr_b16 v[64:65], v12 offset:16384
    v_mfma_f32_16x16x32_bf16 v[132:135], v[116:119], v[80:83], v[132:135]
    ds_read_b64_tr_b16 v[66:67], v13 offset:16384
    v_mfma_f32_16x16x32_bf16 v[144:147], v[112:115], v[88:91], v[144:147]
    ds_read_b64_tr_b16 v[68:69], v14 offset:16384
    v_mfma_f32_16x16x32_bf16 v[148:151], v[116:119], v[88:91], v[148:151]
    ds_read_b64_tr_b16 v[70:71], v15 offset:16384
    v_mfma_f32_16x16x32_bf16 v[160:163], v[112:115], v[96:99], v[160:163]
    ds_read_b64_tr_b16 v[72:73], v12 offset:24576
    v_mfma_f32_16x16x32_bf16 v[164:167], v[116:119], v[96:99], v[164:167]
    ds_read_b64_tr_b16 v[74:75], v13 offset:24576
    v_mfma_f32_16x16x32_bf16 v[176:179], v[112:115], v[104:107], v[176:179]
    ds_read_b64_tr_b16 v[76:77], v14 offset:24576
    v_mfma_f32_16x16x32_bf16 v[180:183], v[116:119], v[104:107], v[180:183]
    ds_read_b64_tr_b16 v[78:79], v15 offset:24576
    v_mfma_f32_16x16x32_bf16 v[128:131], v[120:123], v[84:87], v[128:131]
    ds_read_b128 v[32:35], v6 offset:0
    v_mfma_f32_16x16x32_bf16 v[132:135], v[124:127], v[84:87], v[132:135]
    ds_read_b128 v[36:39], v6 offset:1024
    v_mfma_f32_16x16x32_bf16 v[144:147], v[120:123], v[92:95], v[144:147]
    ds_read_b128 v[40:43], v6 offset:2048
    v_mfma_f32_16x16x32_bf16 v[148:151], v[124:127], v[92:95], v[148:151]
    ds_read_b128 v[44:47], v6 offset:3072
    v_mfma_f32_16x16x32_bf16 v[160:163], v[120:123], v[100:103], v[160:163]
    ds_read_b128 v[48:51], v6 offset:4096
    v_mfma_f32_16x16x32_bf16 v[164:167], v[124:127], v[100:103], v[164:167]
    ds_read_b128 v[52:55], v6 offset:5120
    v_mfma_f32_16x16x32_bf16 v[176:179], v[120:123], v[108:111], v[176:179]
    ds_read_b128 v[56:59], v6 offset:6144
    v_mfma_f32_16x16x32_bf16 v[180:183], v[124:127], v[108:111], v[180:183]
    ds_read_b128 v[60:63], v6 offset:7168
    s_waitcnt lgkmcnt(0)
    s_waitcnt vmcnt(8)
    s_barrier
    s_add_u32 m0, s21, 65536
    s_nop 0
    buffer_load_dwordx4 v1, s[4:7], s16 offen sc1 lds
    s_add_u32 s16, s16, s62
    s_add_u32 m0, s21, 66560
    s_nop 0
    buffer_load_dwordx4 v1, s[4:7], s17 offen sc1 lds
    s_add_u32 s17, s17, s62
    s_add_u32 m0, s22, 65536
    s_nop 0
    buffer_load_dwordx4 v2, s[8:11], s18 offen lds
    s_add_u32 s18, s18, s20
    s_add_u32 m0, s22, 73728
    s_nop 0
    buffer_load_dwordx4 v2, s[12:15], s19 offen lds
    s_add_u32 s19, s19, s20
    v_mfma_f32_16x16x32_bf16 v[128:131], v[64:67], v[32:35], v[128:131]
    ds_read_b64_tr_b16 v[112:113], v12 offset:49152
    v_mfma_f32_16x16x32_bf16 v[132:135], v[68:71], v[32:35], v[132:135]
    ds_read_b64_tr_b16 v[114:115], v13 offset:49152
    v_mfma_f32_16x16x32_bf16 v[144:147], v[64:67], v[40:43], v[144:147]
    ds_read_b64_tr_b16 v[116:117], v14 offset:49152
    v_mfma_f32_16x16x32_bf16 v[148:151], v[68:71], v[40:43], v[148:151]
    ds_read_b64_tr_b16 v[118:119], v15 offset:49152
    v_mfma_f32_16x16x32_bf16 v[160:163], v[64:67], v[48:51], v[160:163]
    ds_read_b64_tr_b16 v[120:121], v12 offset:57344
    v_mfma_f32_16x16x32_bf16 v[164:167], v[68:71], v[48:51], v[164:167]
    ds_read_b64_tr_b16 v[122:123], v13 offset:57344
    v_mfma_f32_16x16x32_bf16 v[176:179], v[64:67], v[56:59], v[176:179]
    ds_read_b64_tr_b16 v[124:125], v14 offset:57344
    v_mfma_f32_16x16x32_bf16 v[180:183], v[68:71], v[56:59], v[180:183]
    ds_read_b64_tr_b16 v[126:127], v15 offset:57344
    v_mfma_f32_16x16x32_bf16 v[128:131], v[72:75], v[36:39], v[128:131]
    ds_read_b128 v[80:83], v6 offset:32768
    v_mfma_f32_16x16x32_bf16 v[132:135], v[76:79], v[36:39], v[132:135]
    ds_read_b128 v[84:87], v6 offset:33792
    v_mfma_f32_16x16x32_bf16 v[144:147], v[72:75], v[44:47], v[144:147]
    ds_read_b128 v[88:91], v6 offset:34816
    v_mfma_f32_16x16x32_bf16 v[148:151], v[76:79], v[44:47], v[148:151]
    ds_read_b128 v[92:95], v6 offset:35840
    v_mfma_f32_16x16x32_bf16 v[160:163], v[72:75], v[52:55], v[160:163]
    ds_read_b128 v[96:99], v6 offset:36864
    v_mfma_f32_16x16x32_bf16 v[164:167], v[76:79], v[52:55], v[164:167]
    ds_read_b128 v[100:103], v6 offset:37888
    v_mfma_f32_16x16x32_bf16 v[176:179], v[72:75], v[60:63], v[176:179]
    ds_read_b128 v[104:107], v6 offset:38912
    v_mfma_f32_16x16x32_bf16 v[180:183], v[76:79], v[60:63], v[180:183]
    ds_read_b128 v[108:111], v6 offset:39936
    s_waitcnt lgkmcnt(0)
    s_waitcnt vmcnt(8)
    s_barrier
    s_add_u32 m0, s21, 98304
    s_nop 0
    buffer_load_dwordx4 v1, s[4:7], s16 offen sc1 lds
    s_add_u32 s16, s16, s62
    s_add_u32 m0, s21, 99328
    s_nop 0
    buffer_load_dwordx4 v1, s[4:7], s17 offen sc1 lds
    s_add_u32 s17, s17, s62
    s_add_u32 m0, s22, 98304
    s_nop 0
    buffer_load_dwordx4 v2, s[8:11], s18 offen lds
    s_add_u32 s18, s18, s20
    s_add_u32 m0, s22, 106496
    s_nop 0
    buffer_load_dwordx4 v2, s[12:15], s19 offen lds
    s_add_u32 s19, s19, s20
    v_mfma_f32_16x16x32_bf16 v[128:131], v[112:115], v[80:83], v[128:131]
    ds_read_b64_tr_b16 v[64:65], v8 offset:16384
    v_mfma_f32_16x16x32_bf16 v[132:135], v[116:119], v[80:83], v[132:135]
    ds_read_b64_tr_b16 v[66:67], v9 offset:16384
    v_mfma_f32_16x16x32_bf16 v[144:147], v[112:115], v[88:91], v[144:147]
    ds_read_b64_tr_b16 v[68:69], v10 offset:16384
    v_mfma_f32_16x16x32_bf16 v[148:151], v[116:119], v[88:91], v[148:151]
    ds_read_b64_tr_b16 v[70:71], v11 offset:16384
    v_mfma_f32_16x16x32_bf16 v[160:163], v[112:115], v[96:99], v[160:163]
    ds_read_b64_tr_b16 v[72:73], v8 offset:24576
    v_mfma_f32_16x16x32_bf16 v[164:167], v[116:119], v[96:99], v[164:167]
    ds_read_b64_tr_b16 v[74:75], v9 offset:24576
    v_mfma_f32_16x16x32_bf16 v[176:179], v[112:115], v[104:107], v[176:179]
    ds_read_b64_tr_b16 v[76:77], v10 offset:24576
    v_mfma_f32_16x16x32_bf16 v[180:183], v[116:119], v[104:107], v[180:183]
    ds_read_b64_tr_b16 v[78:79], v11 offset:24576
    v_mfma_f32_16x16x32_bf16 v[128:131], v[120:123], v[84:87], v[128:131]
    ds_read_b128 v[32:35], v5 offset:0
    v_mfma_f32_16x16x32_bf16 v[132:135], v[124:127], v[84:87], v[132:135]
    ds_read_b128 v[36:39], v5 offset:1024
    v_mfma_f32_16x16x32_bf16 v[144:147], v[120:123], v[92:95], v[144:147]
    ds_read_b128 v[40:43], v5 offset:2048
    v_mfma_f32_16x16x32_bf16 v[148:151], v[124:127], v[92:95], v[148:151]
    ds_read_b128 v[44:47], v5 offset:3072
    v_mfma_f32_16x16x32_bf16 v[160:163], v[120:123], v[100:103], v[160:163]
    ds_read_b128 v[48:51], v5 offset:4096
    v_mfma_f32_16x16x32_bf16 v[164:167], v[124:127], v[100:103], v[164:167]
    ds_read_b128 v[52:55], v5 offset:5120
    v_mfma_f32_16x16x32_bf16 v[176:179], v[120:123], v[108:111], v[176:179]
    ds_read_b128 v[56:59], v5 offset:6144
    v_mfma_f32_16x16x32_bf16 v[180:183], v[124:127], v[108:111], v[180:183]
    ds_read_b128 v[60:63], v5 offset:7168
    s_waitcnt lgkmcnt(0)
    s_sub_u32 s23, s23, 1
    s_cmp_lg_u32 s23, 0
    s_cbranch_scc1 w_loopH
    v_mov_b32 v20, 131072
    ds_read_b128 v[24:27], v20
    ds_read_b128 v[28:31], v20 offset:16
    s_lshl_b32 s30, s27, 10
    s_add_u32 s30, s30, s49
    s_nop 7
    v_cvt_pk_bf16_f32 v80, v128, v129
    v_cvt_pk_bf16_f32 v81, v130, v131
    v_cvt_pk_bf16_f32 v82, v132, v133
    v_cvt_pk_bf16_f32 v83, v134, v135
    buffer_store_dwordx4 v[80:83], v1, s[4:7], s30 offen sc1
    s_add_u32 s30, s30, s50
    v_cvt_pk_bf16_f32 v84, v144, v145
    v_cvt_pk_bf16_f32 v85, v146, v147
    v_cvt_pk_bf16_f32 v86, v148, v149
    v_cvt_pk_bf16_f32 v87, v150, v151
    buffer_store_dwordx4 v[84:87], v1, s[4:7], s30 offen sc1
    s_add_u32 s30, s30, s50
    v_cvt_pk_bf16_f32 v88, v160, v161
    v_cvt_pk_bf16_f32 v89, v162, v163
    v_cvt_pk_bf16_f32 v90, v164, v165
    v_cvt_pk_bf16_f32 v91, v166, v167
    buffer_store_dwordx4 v[88:91], v1, s[4:7], s30 offen sc1
    s_add_u32 s30, s30, s50
    v_cvt_pk_bf16_f32 v92, v176, v177
    v_cvt_pk_bf16_f32 v93, v178, v179
    v_cvt_pk_bf16_f32 v94, v180, v181
    v_cvt_pk_bf16_f32 v95, v182, v183
    buffer_store_dwordx4 v[92:95], v1, s[4:7], s30 offen sc1
    s_add_u32 s30, s30, s50
    s_waitcnt lgkmcnt(0)
    v_or3_b32 v24, v24, v25, v26
    v_or3_b32 v28, v28, v29, v30
    v_or3_b32 v24, v24, v27, v31
    v_or_b32 v24, v24, v28
    s_mov_b32 s28, s51
    v_readfirstlane_b32 s30, v24
    s_cmp_lg_u32 s30, 0
    s_cbranch_scc1 w_drain
    s_mov_b32 s48, s32
    s_cmp_eq_u32 s32, 4
    s_cselect_b32 s30, 2, 3
    s_lshl_b32 s30, s26, s30
    s_mul_i32 s30, s30, s43
    s_add_u32 s49, s42, s30
    s_mov_b32 s50, s43
    s_mov_b32 s51, s46
    s_mov_b32 s23, s41
    s_mov_b32 s53, s41
    s_branch w_first4
w_drain:
    s_waitcnt vmcnt(0)
    s_barrier
    s_cmp_eq_u32 s70, 0
    s_cbranch_scc1 drw_ok
    s_mov_b32 s70, 0
    s_cmp_lg_u32 s3, 0
    s_cbranch_scc1 drw_ok
    v_readfirstlane_b32 s68, v22
    s_cmp_ge_u32 s68, 128
    s_cbranch_scc1 drw_ok
    s_mov_b32 s69, 65536
drw:
    buffer_load_dword v20, off, s[64:67], 0 offset:0 sc1
    s_waitcnt vmcnt(0)
    v_readfirstlane_b32 s68, v20
    s_cmp_ge_u32 s68, 128
    s_cbranch_scc1 drw_ok
    s_sleep 8
    s_sub_u32 s69, s69, 1
    s_cbranch_scc0 drw
drw_ok:
    s_cmp_eq_u32 s28, 0
    s_cbranch_scc1 sig_10
    s_cmp_lg_u32 s3, 0
    s_cbranch_scc1 sig_10
    s_and_b32 s57, s28, 3
    v_mov_b32 v24, s57
    s_bfe_u32 s57, s28, 0x20002
    v_mov_b32 v25, s57
    s_andn2_b32 s28, s28, 15
    s_mov_b64 exec, 1
    buffer_atomic_add_x2 v[24:25], v17, s[4:7], s28 offen sc1
    s_mov_b64 exec, -1
sig_10:
    s_mov_b32 s28, 0
    s_cmp_ge_u32 s53, 4
    s_cbranch_scc1 w_cold
    s_cmp_lg_u32 s3, 0
    s_cbranch_scc1 clm_11
    v_mov_b32 v26, 1
    s_mov_b64 exec, 1
    buffer_atomic_add v26, off, s[64:67], s71 sc0 sc1
    s_mov_b64 exec, -1
clm_11:
    s_waitcnt vmcnt(0)
    s_cmp_lg_u32 s3, 0
    s_cbranch_scc1 pub_12
    v_mov_b32 v20, 131136
    s_mov_b64 exec, 1
    ds_write_b32 v20, v26
    s_mov_b64 exec, -1
    s_waitcnt lgkmcnt(0)
pub_12:
    s_barrier
    v_mov_b32 v20, 131136
    ds_read_b32 v20, v20
    s_waitcnt lgkmcnt(0)
    v_readfirstlane_b32 s59, v20
    s_add_u32 s59, s59, 32
    s_min_u32 s59, s59, 322
    s_lshl_b32 s57, s59, 6
    s_load_dwordx16 s[32:47], s[24:25], s57
    s_waitcnt lgkmcnt(0)
    s_barrier
    s_branch w_cold
w_att:
    s_cmp_lg_u32 s3, 0
    s_cbranch_scc1 w_att_go
    s_mov_b32 s31, 0x40000
w_att_w:
    buffer_load_dwordx2 v[20:21], off, s[4:7], s33 sc1
    s_waitcnt vmcnt(0)
    v_add_u32 v20, v20, v21
    s_nop 0
    v_readfirstlane_b32 s30, v20
    s_cmp_ge_u32 s30, 8
    s_cbranch_scc1 w_att_go
    s_sleep 16
    s_sub_u32 s31, s31, 1
    s_cbranch_scc0 w_att_w
w_att_go:
    s_cmp_lg_u32 s3, 0
    s_cbranch_scc1 clm_13
    v_mov_b32 v250, 1
    s_mov_b64 exec, 1
    buffer_atomic_add v250, off, s[64:67], s71 sc0 sc1
    s_mov_b64 exec, -1
clm_13:
    s_barrier
    v_lshrrev_b32 v20, 4, v1
    v_lshrrev_b32 v21, 4, v20
    v_and_b32 v22, 15, v20
    v_lshlrev_b32 v23, 2, v21
    v_add_u32 v24, 0, v23
    v_cmp_gt_u32 s[72:73], v24, v22
    v_add_u32 v24, 1, v23
    v_cmp_gt_u32 s[74:75], v24, v22
    v_add_u32 v24, 2, v23
    v_cmp_gt_u32 s[76:77], v24, v22
    v_add_u32 v24, 3, v23
    v_cmp_gt_u32 s[78:79], v24, v22
    s_mul_i32 s83, s3, 10240
    v_and_b32 v22, 3, v20
    v_bfe_u32 v24, v20, 2, 2
    v_add_u32 v23, v23, v24
    v_lshl_add_u32 v23, v22, 4, v23
    v_lshlrev_b32 v23, 4, v23
    v_add_u32 v25, s83, v23
    v_and_b32 v24, 1, v24
    v_lshl_add_u32 v24, v21, 1, v24
    v_lshl_add_u32 v24, v22, 3, v24
    v_lshlrev_b32 v24, 4, v24
    v_add_u32 v26, s83, v24
    v_mov_b32 v22, 0xff61b1e6
    v_mov_b32 v136, 0
    v_mov_b32 v137, 0
    v_mov_b32 v220, 0
    v_mov_b32 v221, 0
    s_mov_b32 s80, 0x3e0293ee
    s_lshr_b32 s85, s3, 2
    s_add_u32 s85, s85, s39
    s_lshl_b32 s81, s85, 18
    s_and_b32 s85, s3, 3
    s_add_u32 s85, s85, s36
    s_lshl_b32 s82, s85, 13
    s_add_u32 s82, s82, s81
    s_add_u32 s82, s82, 192937984
    s_lshl_b32 s85, s85, 12
    s_add_u32 s81, s81, s85
    v_mov_b32 v28, 0x3f803f80
    v_mov_b32 v29, 0x3f803f80
    v_mov_b32 v30, 0x3f803f80
    v_mov_b32 v31, 0x3f803f80
    s_add_u32 s86, s82, 0
    buffer_load_dwordx4 v[120:123], v1, s[4:7], s86 offen offset:0 sc1
    buffer_load_dwordx4 v[124:127], v1, s[4:7], s86 offen offset:1024 sc1
    buffer_load_dwordx4 v[128:131], v1, s[4:7], s86 offen offset:2048 sc1
    buffer_load_dwordx4 v[132:135], v1, s[4:7], s86 offen offset:3072 sc1
    s_add_u32 s85, s81, 4194304
    buffer_load_dwordx4 v[56:59], v1, s[4:7], s85 offen offset:0 sc1
    buffer_load_dwordx4 v[60:63], v1, s[4:7], s85 offen offset:1024 sc1
    buffer_load_dwordx4 v[64:67], v1, s[4:7], s85 offen offset:2048 sc1
    buffer_load_dwordx4 v[68:71], v1, s[4:7], s85 offen offset:3072 sc1
    s_add_u32 s85, s81, 4325376
    buffer_load_dwordx4 v[72:75], v1, s[4:7], s85 offen offset:0 sc1
    buffer_load_dwordx4 v[76:79], v1, s[4:7], s85 offen offset:1024 sc1
    buffer_load_dwordx4 v[80:83], v1, s[4:7], s85 offen offset:2048 sc1
    buffer_load_dwordx4 v[84:87], v1, s[4:7], s85 offen offset:3072 sc1
    s_add_u32 s85, s81, 20971520
    buffer_load_dwordx4 v[88:91], v1, s[4:7], s85 offen offset:0 sc1
    buffer_load_dwordx4 v[92:95], v1, s[4:7], s85 offen offset:1024 sc1
    buffer_load_dwordx4 v[96:99], v1, s[4:7], s85 offen offset:2048 sc1
    buffer_load_dwordx4 v[100:103], v1, s[4:7], s85 offen offset:3072 sc1
    s_add_u32 s85, s81, 21102592
    buffer_load_dwordx4 v[104:107], v1, s[4:7], s85 offen offset:0 sc1
    buffer_load_dwordx4 v[108:111], v1, s[4:7], s85 offen offset:1024 sc1
    buffer_load_dwordx4 v[112:115], v1, s[4:7], s85 offen offset:2048 sc1
    buffer_load_dwordx4 v[116:119], v1, s[4:7], s85 offen offset:3072 sc1
    s_add_u32 m0, s83, 0
    s_add_u32 s85, s81, 37748736
    buffer_load_dwordx4 v1, s[4:7], s85 offen offset:0 sc1 lds
    buffer_load_dwordx4 v1, s[4:7], s85 offen offset:1024 sc1 lds
    buffer_load_dwordx4 v1, s[4:7], s85 offen offset:2048 sc1 lds
    buffer_load_dwordx4 v1, s[4:7], s85 offen offset:3072 sc1 lds
    s_add_u32 m0, s83, 4096
    s_add_u32 s85, s81, 37879808
    buffer_load_dwordx4 v1, s[4:7], s85 offen offset:0 sc1 lds
    buffer_load_dwordx4 v1, s[4:7], s85 offen offset:1024 sc1 lds
    buffer_load_dwordx4 v1, s[4:7], s85 offen offset:2048 sc1 lds
    buffer_load_dwordx4 v1, s[4:7], s85 offen offset:3072 sc1 lds
    s_add_u32 m0, s83, 8192
    s_add_u32 s85, s82, 4096
    buffer_load_dwordx4 v1, s[4:7], s85 offen offset:0 sc1 lds
    buffer_load_dwordx4 v1, s[4:7], s85 offen offset:1024 sc1 lds
    s_add_u32 s86, s82, 524288
    buffer_load_dwordx4 v[204:207], v1, s[4:7], s86 offen offset:0 sc1
    buffer_load_dwordx4 v[208:211], v1, s[4:7], s86 offen offset:1024 sc1
    buffer_load_dwordx4 v[212:215], v1, s[4:7], s86 offen offset:2048 sc1
    buffer_load_dwordx4 v[216:219], v1, s[4:7], s86 offen offset:3072 sc1
    s_add_u32 s85, s81, 4718592
    buffer_load_dwordx4 v[140:143], v1, s[4:7], s85 offen offset:0 sc1
    buffer_load_dwordx4 v[144:147], v1, s[4:7], s85 offen offset:1024 sc1
    buffer_load_dwordx4 v[148:151], v1, s[4:7], s85 offen offset:2048 sc1
    buffer_load_dwordx4 v[152:155], v1, s[4:7], s85 offen offset:3072 sc1
    s_add_u32 s85, s81, 4849664
    buffer_load_dwordx4 v[156:159], v1, s[4:7], s85 offen offset:0 sc1
    buffer_load_dwordx4 v[160:163], v1, s[4:7], s85 offen offset:1024 sc1
    buffer_load_dwordx4 v[164:167], v1, s[4:7], s85 offen offset:2048 sc1
    buffer_load_dwordx4 v[168:171], v1, s[4:7], s85 offen offset:3072 sc1
    s_add_u32 s85, s81, 21495808
    buffer_load_dwordx4 v[172:175], v1, s[4:7], s85 offen offset:0 sc1
    buffer_load_dwordx4 v[176:179], v1, s[4:7], s85 offen offset:1024 sc1
    buffer_load_dwordx4 v[180:183], v1, s[4:7], s85 offen offset:2048 sc1
    buffer_load_dwordx4 v[184:187], v1, s[4:7], s85 offen offset:3072 sc1
    s_add_u32 s85, s81, 21626880
    buffer_load_dwordx4 v[188:191], v1, s[4:7], s85 offen offset:0 sc1
    buffer_load_dwordx4 v[192:195], v1, s[4:7], s85 offen offset:1024 sc1
    buffer_load_dwordx4 v[196:199], v1, s[4:7], s85 offen offset:2048 sc1
    buffer_load_dwordx4 v[200:203], v1, s[4:7], s85 offen offset:3072 sc1
    s_add_u32 m0, s83, 81920
    s_add_u32 s85, s81, 38273024
    buffer_load_dwordx4 v1, s[4:7], s85 offen offset:0 sc1 lds
    buffer_load_dwordx4 v1, s[4:7], s85 offen offset:1024 sc1 lds
    buffer_load_dwordx4 v1, s[4:7], s85 offen offset:2048 sc1 lds
    buffer_load_dwordx4 v1, s[4:7], s85 offen offset:3072 sc1 lds
    s_add_u32 m0, s83, 86016
    s_add_u32 s85, s81, 38404096
    buffer_load_dwordx4 v1, s[4:7], s85 offen offset:0 sc1 lds
    buffer_load_dwordx4 v1, s[4:7], s85 offen offset:1024 sc1 lds
    buffer_load_dwordx4 v1, s[4:7], s85 offen offset:2048 sc1 lds
    buffer_load_dwordx4 v1, s[4:7], s85 offen offset:3072 sc1 lds
    s_add_u32 m0, s83, 90112
    s_add_u32 s85, s82, 528384
    buffer_load_dwordx4 v1, s[4:7], s85 offen offset:0 sc1 lds
    buffer_load_dwordx4 v1, s[4:7], s85 offen offset:1024 sc1 lds
    s_waitcnt vmcnt(40)
    v_mfma_f32_16x16x32_bf16 v[32:35], v[88:91], v[56:59], 0
    v_mfma_f32_16x16x32_bf16 v[40:43], v[120:123], v[56:59], 0
    v_mfma_f32_16x16x32_bf16 v[32:35], v[92:95], v[60:63], v[32:35]
    v_mfma_f32_16x16x32_bf16 v[40:43], v[124:127], v[60:63], v[40:43]
    v_mfma_f32_16x16x32_bf16 v[32:35], v[96:99], v[64:67], v[32:35]
    v_mfma_f32_16x16x32_bf16 v[40:43], v[128:131], v[64:67], v[40:43]
    v_mfma_f32_16x16x32_bf16 v[32:35], v[100:103], v[68:71], v[32:35]
    v_mfma_f32_16x16x32_bf16 v[40:43], v[132:135], v[68:71], v[40:43]
    v_mfma_f32_16x16x32_bf16 v[44:47], v[88:91], v[72:75], 0
    v_mfma_f32_16x16x32_bf16 v[48:51], v[104:107], v[72:75], 0
    v_mfma_f32_16x16x32_bf16 v[52:55], v[120:123], v[72:75], 0
    v_mfma_f32_16x16x32_bf16 v[44:47], v[92:95], v[76:79], v[44:47]
    v_mfma_f32_16x16x32_bf16 v[48:51], v[108:111], v[76:79], v[48:51]
    v_mfma_f32_16x16x32_bf16 v[52:55], v[124:127], v[76:79], v[52:55]
    v_mfma_f32_16x16x32_bf16 v[44:47], v[96:99], v[80:83], v[44:47]
    v_mfma_f32_16x16x32_bf16 v[48:51], v[112:115], v[80:83], v[48:51]
    v_mfma_f32_16x16x32_bf16 v[52:55], v[128:131], v[80:83], v[52:55]
    v_mfma_f32_16x16x32_bf16 v[44:47], v[100:103], v[84:87], v[44:47]
    v_mfma_f32_16x16x32_bf16 v[48:51], v[116:119], v[84:87], v[48:51]
    v_mfma_f32_16x16x32_bf16 v[52:55], v[132:135], v[84:87], v[52:55]
    v_cndmask_b32 v32, v32, v22, s[72:73]
    v_cndmask_b32 v33, v33, v22, s[74:75]
    v_cndmask_b32 v34, v34, v22, s[76:77]
    v_cndmask_b32 v35, v35, v22, s[78:79]
    v_max3_f32 v20, v32, v33, v34
    v_max3_f32 v21, v35, v40, v41
    v_max_f32 v20, v20, v21
    v_mov_b32 v21, v20
    s_nop 1
    v_permlane16_swap_b32 v21, v20
    v_max_f32 v20, v20, v21
    v_mov_b32 v21, v20
    s_nop 1
    v_permlane32_swap_b32 v21, v20
    v_max_f32 v20, v20, v21
    v_mul_f32 v20, s80, v20
    v_fma_f32 v32, v32, s80, -v20
    v_fma_f32 v33, v33, s80, -v20
    v_fma_f32 v34, v34, s80, -v20
    v_fma_f32 v35, v35, s80, -v20
    v_fma_f32 v40, v40, s80, -v20
    v_fma_f32 v41, v41, s80, -v20
    v_exp_f32 v32, v32
    v_exp_f32 v33, v33
    v_exp_f32 v34, v34
    v_exp_f32 v35, v35
    v_exp_f32 v40, v40
    v_exp_f32 v41, v41
    s_nop 0
    v_cvt_pk_bf16_f32 v32, v32, v33
    v_cvt_pk_bf16_f32 v33, v34, v35
    v_mov_b32 v34, 0
    v_mov_b32 v35, 0
    v_cvt_pk_bf16_f32 v40, v40, v41
    v_mov_b32 v41, 0
    v_mov_b32 v42, 0
    v_mov_b32 v43, 0
    s_nop 1
    s_waitcnt vmcnt(30)
    ds_read_b64_tr_b16 v[56:57], v25 offset:0
    ds_read_b64_tr_b16 v[58:59], v25 offset:4096
    ds_read_b64_tr_b16 v[120:121], v26 offset:8192
    ds_read_b64_tr_b16 v[60:61], v25 offset:8
    ds_read_b64_tr_b16 v[62:63], v25 offset:4104
    ds_read_b64_tr_b16 v[122:123], v26 offset:8200
    ds_read_b64_tr_b16 v[64:65], v25 offset:1024
    ds_read_b64_tr_b16 v[66:67], v25 offset:5120
    ds_read_b64_tr_b16 v[124:125], v26 offset:8704
    ds_read_b64_tr_b16 v[68:69], v25 offset:1032
    ds_read_b64_tr_b16 v[70:71], v25 offset:5128
    ds_read_b64_tr_b16 v[126:127], v26 offset:8712
    ds_read_b64_tr_b16 v[72:73], v25 offset:2048
    ds_read_b64_tr_b16 v[74:75], v25 offset:6144
    ds_read_b64_tr_b16 v[128:129], v26 offset:9216
    ds_read_b64_tr_b16 v[76:77], v25 offset:2056
    ds_read_b64_tr_b16 v[78:79], v25 offset:6152
    ds_read_b64_tr_b16 v[130:131], v26 offset:9224
    ds_read_b64_tr_b16 v[80:81], v25 offset:3072
    ds_read_b64_tr_b16 v[82:83], v25 offset:7168
    ds_read_b64_tr_b16 v[132:133], v26 offset:9728
    ds_read_b64_tr_b16 v[84:85], v25 offset:3080
    ds_read_b64_tr_b16 v[86:87], v25 offset:7176
    ds_read_b64_tr_b16 v[134:135], v26 offset:9736
    v_cndmask_b32 v48, v48, v22, s[72:73]
    v_cndmask_b32 v49, v49, v22, s[74:75]
    v_cndmask_b32 v50, v50, v22, s[76:77]
    v_cndmask_b32 v51, v51, v22, s[78:79]
    v_max3_f32 v20, v44, v45, v46
    v_max3_f32 v21, v47, v48, v49
    v_max3_f32 v20, v20, v50, v51
    v_max3_f32 v21, v21, v52, v53
    v_max_f32 v20, v20, v21
    v_mov_b32 v21, v20
    s_nop 1
    v_permlane16_swap_b32 v21, v20
    v_max_f32 v20, v20, v21
    v_mov_b32 v21, v20
    s_nop 1
    v_permlane32_swap_b32 v21, v20
    v_max_f32 v20, v20, v21
    v_mul_f32 v20, s80, v20
    v_fma_f32 v44, v44, s80, -v20
    v_fma_f32 v45, v45, s80, -v20
    v_fma_f32 v46, v46, s80, -v20
    v_fma_f32 v47, v47, s80, -v20
    v_fma_f32 v48, v48, s80, -v20
    v_fma_f32 v49, v49, s80, -v20
    v_fma_f32 v50, v50, s80, -v20
    v_fma_f32 v51, v51, s80, -v20
    v_fma_f32 v52, v52, s80, -v20
    v_fma_f32 v53, v53, s80, -v20
    v_exp_f32 v44, v44
    v_exp_f32 v45, v45
    v_exp_f32 v46, v46
    v_exp_f32 v47, v47
    v_exp_f32 v48, v48
    v_exp_f32 v49, v49
    v_exp_f32 v50, v50
    v_exp_f32 v51, v51
    v_exp_f32 v52, v52
    v_exp_f32 v53, v53
    s_nop 0
    v_cvt_pk_bf16_f32 v44, v44, v45
    v_cvt_pk_bf16_f32 v45, v46, v47
    v_cvt_pk_bf16_f32 v46, v48, v49
    v_cvt_pk_bf16_f32 v47, v50, v51
    v_cvt_pk_bf16_f32 v52, v52, v53
    v_mov_b32 v53, 0
    v_mov_b32 v54, 0
    v_mov_b32 v55, 0
    s_nop 1
    s_waitcnt lgkmcnt(0)
    v_mfma_f32_16x16x32_bf16 v[36:39], v[28:31], v[32:35], 0
    v_mfma_f32_16x16x32_bf16 v[36:39], v[28:31], v[40:43], v[36:39]
    v_mfma_f32_16x16x32_bf16 v[88:91], v[56:59], v[32:35], 0
    v_mfma_f32_16x16x32_bf16 v[88:91], v[120:123], v[40:43], v[88:91]
    v_mfma_f32_16x16x32_bf16 v[92:95], v[60:63], v[32:35], 0
    v_mfma_f32_16x16x32_bf16 v[92:95], v[122:125], v[40:43], v[92:95]
    v_mfma_f32_16x16x32_bf16 v[96:99], v[64:67], v[32:35], 0
    v_mfma_f32_16x16x32_bf16 v[96:99], v[124:127], v[40:43], v[96:99]
    v_mfma_f32_16x16x32_bf16 v[100:103], v[68:71], v[32:35], 0
    v_mfma_f32_16x16x32_bf16 v[100:103], v[126:129], v[40:43], v[100:103]
    v_mfma_f32_16x16x32_bf16 v[104:107], v[72:75], v[32:35], 0
    v_mfma_f32_16x16x32_bf16 v[104:107], v[128:131], v[40:43], v[104:107]
    v_mfma_f32_16x16x32_bf16 v[108:111], v[76:79], v[32:35], 0
    v_mfma_f32_16x16x32_bf16 v[108:111], v[130:133], v[40:43], v[108:111]
    v_mfma_f32_16x16x32_bf16 v[112:115], v[80:83], v[32:35], 0
    v_mfma_f32_16x16x32_bf16 v[112:115], v[132:135], v[40:43], v[112:115]
    v_mfma_f32_16x16x32_bf16 v[116:119], v[84:87], v[32:35], 0
    v_mfma_f32_16x16x32_bf16 v[116:119], v[134:137], v[40:43], v[116:119]
    v_rcp_f32 v23, v36
    s_add_u32 s85, s81, 176160768
    v_mul_f32 v88, v88, v23
    v_mul_f32 v89, v89, v23
    v_mul_f32 v90, v90, v23
    v_mul_f32 v91, v91, v23
    v_mul_f32 v92, v92, v23
    v_mul_f32 v93, v93, v23
    v_mul_f32 v94, v94, v23
    v_mul_f32 v95, v95, v23
    v_cvt_pk_bf16_f32 v224, v88, v89
    v_cvt_pk_bf16_f32 v225, v90, v91
    v_cvt_pk_bf16_f32 v226, v92, v93
    v_cvt_pk_bf16_f32 v227, v94, v95
    buffer_store_dwordx4 v[224:227], v1, s[4:7], s85 offen offset:0 sc1
    v_mul_f32 v96, v96, v23
    v_mul_f32 v97, v97, v23
    v_mul_f32 v98, v98, v23
    v_mul_f32 v99, v99, v23
    v_mul_f32 v100, v100, v23
    v_mul_f32 v101, v101, v23
    v_mul_f32 v102, v102, v23
    v_mul_f32 v103, v103, v23
    v_cvt_pk_bf16_f32 v228, v96, v97
    v_cvt_pk_bf16_f32 v229, v98, v99
    v_cvt_pk_bf16_f32 v230, v100, v101
    v_cvt_pk_bf16_f32 v231, v102, v103
    buffer_store_dwordx4 v[228:231], v1, s[4:7], s85 offen offset:1024 sc1
    v_mul_f32 v104, v104, v23
    v_mul_f32 v105, v105, v23
    v_mul_f32 v106, v106, v23
    v_mul_f32 v107, v107, v23
    v_mul_f32 v108, v108, v23
    v_mul_f32 v109, v109, v23
    v_mul_f32 v110, v110, v23
    v_mul_f32 v111, v111, v23
    v_cvt_pk_bf16_f32 v232, v104, v105
    v_cvt_pk_bf16_f32 v233, v106, v107
    v_cvt_pk_bf16_f32 v234, v108, v109
    v_cvt_pk_bf16_f32 v235, v110, v111
    buffer_store_dwordx4 v[232:235], v1, s[4:7], s85 offen offset:2048 sc1
    v_mul_f32 v112, v112, v23
    v_mul_f32 v113, v113, v23
    v_mul_f32 v114, v114, v23
    v_mul_f32 v115, v115, v23
    v_mul_f32 v116, v116, v23
    v_mul_f32 v117, v117, v23
    v_mul_f32 v118, v118, v23
    v_mul_f32 v119, v119, v23
    v_cvt_pk_bf16_f32 v236, v112, v113
    v_cvt_pk_bf16_f32 v237, v114, v115
    v_cvt_pk_bf16_f32 v238, v116, v117
    v_cvt_pk_bf16_f32 v239, v118, v119
    buffer_store_dwordx4 v[236:239], v1, s[4:7], s85 offen offset:3072 sc1
    v_mfma_f32_16x16x32_bf16 v[48:51], v[28:31], v[44:47], 0
    v_mfma_f32_16x16x32_bf16 v[48:51], v[28:31], v[52:55], v[48:51]
    v_mfma_f32_16x16x32_bf16 v[88:91], v[56:59], v[44:47], 0
    v_mfma_f32_16x16x32_bf16 v[88:91], v[120:123], v[52:55], v[88:91]
    v_mfma_f32_16x16x32_bf16 v[92:95], v[60:63], v[44:47], 0
    v_mfma_f32_16x16x32_bf16 v[92:95], v[122:125], v[52:55], v[92:95]
    v_mfma_f32_16x16x32_bf16 v[96:99], v[64:67], v[44:47], 0
    v_mfma_f32_16x16x32_bf16 v[96:99], v[124:127], v[52:55], v[96:99]
    v_mfma_f32_16x16x32_bf16 v[100:103], v[68:71], v[44:47], 0
    v_mfma_f32_16x16x32_bf16 v[100:103], v[126:129], v[52:55], v[100:103]
    v_mfma_f32_16x16x32_bf16 v[104:107], v[72:75], v[44:47], 0
    v_mfma_f32_16x16x32_bf16 v[104:107], v[128:131], v[52:55], v[104:107]
    v_mfma_f32_16x16x32_bf16 v[108:111], v[76:79], v[44:47], 0
    v_mfma_f32_16x16x32_bf16 v[108:111], v[130:133], v[52:55], v[108:111]
    v_mfma_f32_16x16x32_bf16 v[112:115], v[80:83], v[44:47], 0
    v_mfma_f32_16x16x32_bf16 v[112:115], v[132:135], v[52:55], v[112:115]
    v_mfma_f32_16x16x32_bf16 v[116:119], v[84:87], v[44:47], 0
    v_mfma_f32_16x16x32_bf16 v[116:119], v[134:137], v[52:55], v[116:119]
    v_rcp_f32 v23, v48
    s_add_u32 s85, s81, 176291840
    v_mul_f32 v88, v88, v23
    v_mul_f32 v89, v89, v23
    v_mul_f32 v90, v90, v23
    v_mul_f32 v91, v91, v23
    v_mul_f32 v92, v92, v23
    v_mul_f32 v93, v93, v23
    v_mul_f32 v94, v94, v23
    v_mul_f32 v95, v95, v23
    v_cvt_pk_bf16_f32 v224, v88, v89
    v_cvt_pk_bf16_f32 v225, v90, v91
    v_cvt_pk_bf16_f32 v226, v92, v93
    v_cvt_pk_bf16_f32 v227, v94, v95
    buffer_store_dwordx4 v[224:227], v1, s[4:7], s85 offen offset:0 sc1
    v_mul_f32 v96, v96, v23
    v_mul_f32 v97, v97, v23
    v_mul_f32 v98, v98, v23
    v_mul_f32 v99, v99, v23
    v_mul_f32 v100, v100, v23
    v_mul_f32 v101, v101, v23
    v_mul_f32 v102, v102, v23
    v_mul_f32 v103, v103, v23
    v_cvt_pk_bf16_f32 v228, v96, v97
    v_cvt_pk_bf16_f32 v229, v98, v99
    v_cvt_pk_bf16_f32 v230, v100, v101
    v_cvt_pk_bf16_f32 v231, v102, v103
    buffer_store_dwordx4 v[228:231], v1, s[4:7], s85 offen offset:1024 sc1
    v_mul_f32 v104, v104, v23
    v_mul_f32 v105, v105, v23
    v_mul_f32 v106, v106, v23
    v_mul_f32 v107, v107, v23
    v_mul_f32 v108, v108, v23
    v_mul_f32 v109, v109, v23
    v_mul_f32 v110, v110, v23
    v_mul_f32 v111, v111, v23
    v_cvt_pk_bf16_f32 v232, v104, v105
    v_cvt_pk_bf16_f32 v233, v106, v107
    v_cvt_pk_bf16_f32 v234, v108, v109
    v_cvt_pk_bf16_f32 v235, v110, v111
    buffer_store_dwordx4 v[232:235], v1, s[4:7], s85 offen offset:2048 sc1
    v_mul_f32 v112, v112, v23
    v_mul_f32 v113, v113, v23
    v_mul_f32 v114, v114, v23
    v_mul_f32 v115, v115, v23
    v_mul_f32 v116, v116, v23
    v_mul_f32 v117, v117, v23
    v_mul_f32 v118, v118, v23
    v_mul_f32 v119, v119, v23
    v_cvt_pk_bf16_f32 v236, v112, v113
    v_cvt_pk_bf16_f32 v237, v114, v115
    v_cvt_pk_bf16_f32 v238, v116, v117
    v_cvt_pk_bf16_f32 v239, v118, v119
    buffer_store_dwordx4 v[236:239], v1, s[4:7], s85 offen offset:3072 sc1
    s_waitcnt vmcnt(18)
    v_mfma_f32_16x16x32_bf16 v[32:35], v[172:175], v[140:143], 0
    v_mfma_f32_16x16x32_bf16 v[40:43], v[204:207], v[140:143], 0
    v_mfma_f32_16x16x32_bf16 v[32:35], v[176:179], v[144:147], v[32:35]
    v_mfma_f32_16x16x32_bf16 v[40:43], v[208:211], v[144:147], v[40:43]
    v_mfma_f32_16x16x32_bf16 v[32:35], v[180:183], v[148:151], v[32:35]
    v_mfma_f32_16x16x32_bf16 v[40:43], v[212:215], v[148:151], v[40:43]
    v_mfma_f32_16x16x32_bf16 v[32:35], v[184:187], v[152:155], v[32:35]
    v_mfma_f32_16x16x32_bf16 v[40:43], v[216:219], v[152:155], v[40:43]
    v_mfma_f32_16x16x32_bf16 v[44:47], v[172:175], v[156:159], 0
    v_mfma_f32_16x16x32_bf16 v[48:51], v[188:191], v[156:159], 0
    v_mfma_f32_16x16x32_bf16 v[52:55], v[204:207], v[156:159], 0
    v_mfma_f32_16x16x32_bf16 v[44:47], v[176:179], v[160:163], v[44:47]
    v_mfma_f32_16x16x32_bf16 v[48:51], v[192:195], v[160:163], v[48:51]
    v_mfma_f32_16x16x32_bf16 v[52:55], v[208:211], v[160:163], v[52:55]
    v_mfma_f32_16x16x32_bf16 v[44:47], v[180:183], v[164:167], v[44:47]
    v_mfma_f32_16x16x32_bf16 v[48:51], v[196:199], v[164:167], v[48:51]
    v_mfma_f32_16x16x32_bf16 v[52:55], v[212:215], v[164:167], v[52:55]
    v_mfma_f32_16x16x32_bf16 v[44:47], v[184:187], v[168:171], v[44:47]
    v_mfma_f32_16x16x32_bf16 v[48:51], v[200:203], v[168:171], v[48:51]
    v_mfma_f32_16x16x32_bf16 v[52:55], v[216:219], v[168:171], v[52:55]
    v_cndmask_b32 v32, v32, v22, s[72:73]
    v_cndmask_b32 v33, v33, v22, s[74:75]
    v_cndmask_b32 v34, v34, v22, s[76:77]
    v_cndmask_b32 v35, v35, v22, s[78:79]
    v_max3_f32 v20, v32, v33, v34
    v_max3_f32 v21, v35, v40, v41
    v_max_f32 v20, v20, v21
    v_mov_b32 v21, v20
    s_nop 1
    v_permlane16_swap_b32 v21, v20
    v_max_f32 v20, v20, v21
    v_mov_b32 v21, v20
    s_nop 1
    v_permlane32_swap_b32 v21, v20
    v_max_f32 v20, v20, v21
    v_mul_f32 v20, s80, v20
    v_fma_f32 v32, v32, s80, -v20
    v_fma_f32 v33, v33, s80, -v20
    v_fma_f32 v34, v34, s80, -v20
    v_fma_f32 v35, v35, s80, -v20
    v_fma_f32 v40, v40, s80, -v20
    v_fma_f32 v41, v41, s80, -v20
    v_exp_f32 v32, v32
    v_exp_f32 v33, v33
    v_exp_f32 v34, v34
    v_exp_f32 v35, v35
    v_exp_f32 v40, v40
    v_exp_f32 v41, v41
    s_nop 0
    v_cvt_pk_bf16_f32 v32, v32, v33
    v_cvt_pk_bf16_f32 v33, v34, v35
    v_mov_b32 v34, 0
    v_mov_b32 v35, 0
    v_cvt_pk_bf16_f32 v40, v40, v41
    v_mov_b32 v41, 0
    v_mov_b32 v42, 0
    v_mov_b32 v43, 0
    s_nop 1
    s_waitcnt vmcnt(8)
    v_add_u32 v25, 81920, v25
    v_add_u32 v26, 81920, v26
    ds_read_b64_tr_b16 v[140:141], v25 offset:0
    ds_read_b64_tr_b16 v[142:143], v25 offset:4096
    ds_read_b64_tr_b16 v[204:205], v26 offset:8192
    ds_read_b64_tr_b16 v[144:145], v25 offset:8
    ds_read_b64_tr_b16 v[146:147], v25 offset:4104
    ds_read_b64_tr_b16 v[206:207], v26 offset:8200
    ds_read_b64_tr_b16 v[148:149], v25 offset:1024
    ds_read_b64_tr_b16 v[150:151], v25 offset:5120
    ds_read_b64_tr_b16 v[208:209], v26 offset:8704
    ds_read_b64_tr_b16 v[152:153], v25 offset:1032
    ds_read_b64_tr_b16 v[154:155], v25 offset:5128
    ds_read_b64_tr_b16 v[210:211], v26 offset:8712
    ds_read_b64_tr_b16 v[156:157], v25 offset:2048
    ds_read_b64_tr_b16 v[158:159], v25 offset:6144
    ds_read_b64_tr_b16 v[212:213], v26 offset:9216
    ds_read_b64_tr_b16 v[160:161], v25 offset:2056
    ds_read_b64_tr_b16 v[162:163], v25 offset:6152
    ds_read_b64_tr_b16 v[214:215], v26 offset:9224
    ds_read_b64_tr_b16 v[164:165], v25 offset:3072
    ds_read_b64_tr_b16 v[166:167], v25 offset:7168
    ds_read_b64_tr_b16 v[216:217], v26 offset:9728
    ds_read_b64_tr_b16 v[168:169], v25 offset:3080
    ds_read_b64_tr_b16 v[170:171], v25 offset:7176
    ds_read_b64_tr_b16 v[218:219], v26 offset:9736
    v_cndmask_b32 v48, v48, v22, s[72:73]
    v_cndmask_b32 v49, v49, v22, s[74:75]
    v_cndmask_b32 v50, v50, v22, s[76:77]
    v_cndmask_b32 v51, v51, v22, s[78:79]
    v_max3_f32 v20, v44, v45, v46
    v_max3_f32 v21, v47, v48, v49
    v_max3_f32 v20, v20, v50, v51
    v_max3_f32 v21, v21, v52, v53
    v_max_f32 v20, v20, v21
    v_mov_b32 v21, v20
    s_nop 1
    v_permlane16_swap_b32 v21, v20
    v_max_f32 v20, v20, v21
    v_mov_b32 v21, v20
    s_nop 1
    v_permlane32_swap_b32 v21, v20
    v_max_f32 v20, v20, v21
    v_mul_f32 v20, s80, v20
    v_fma_f32 v44, v44, s80, -v20
    v_fma_f32 v45, v45, s80, -v20
    v_fma_f32 v46, v46, s80, -v20
    v_fma_f32 v47, v47, s80, -v20
    v_fma_f32 v48, v48, s80, -v20
    v_fma_f32 v49, v49, s80, -v20
    v_fma_f32 v50, v50, s80, -v20
    v_fma_f32 v51, v51, s80, -v20
    v_fma_f32 v52, v52, s80, -v20
    v_fma_f32 v53, v53, s80, -v20
    v_exp_f32 v44, v44
    v_exp_f32 v45, v45
    v_exp_f32 v46, v46
    v_exp_f32 v47, v47
    v_exp_f32 v48, v48
    v_exp_f32 v49, v49
    v_exp_f32 v50, v50
    v_exp_f32 v51, v51
    v_exp_f32 v52, v52
    v_exp_f32 v53, v53
    s_nop 0
    v_cvt_pk_bf16_f32 v44, v44, v45
    v_cvt_pk_bf16_f32 v45, v46, v47
    v_cvt_pk_bf16_f32 v46, v48, v49
    v_cvt_pk_bf16_f32 v47, v50, v51
    v_cvt_pk_bf16_f32 v52, v52, v53
    v_mov_b32 v53, 0
    v_mov_b32 v54, 0
    v_mov_b32 v55, 0
    s_nop 1
    s_waitcnt lgkmcnt(0)
    v_mfma_f32_16x16x32_bf16 v[36:39], v[28:31], v[32:35], 0
    v_mfma_f32_16x16x32_bf16 v[36:39], v[28:31], v[40:43], v[36:39]
    v_mfma_f32_16x16x32_bf16 v[172:175], v[140:143], v[32:35], 0
    v_mfma_f32_16x16x32_bf16 v[172:175], v[204:207], v[40:43], v[172:175]
    v_mfma_f32_16x16x32_bf16 v[176:179], v[144:147], v[32:35], 0
    v_mfma_f32_16x16x32_bf16 v[176:179], v[206:209], v[40:43], v[176:179]
    v_mfma_f32_16x16x32_bf16 v[180:183], v[148:151], v[32:35], 0
    v_mfma_f32_16x16x32_bf16 v[180:183], v[208:211], v[40:43], v[180:183]
    v_mfma_f32_16x16x32_bf16 v[184:187], v[152:155], v[32:35], 0
    v_mfma_f32_16x16x32_bf16 v[184:187], v[210:213], v[40:43], v[184:187]
    v_mfma_f32_16x16x32_bf16 v[188:191], v[156:159], v[32:35], 0
    v_mfma_f32_16x16x32_bf16 v[188:191], v[212:215], v[40:43], v[188:191]
    v_mfma_f32_16x16x32_bf16 v[192:195], v[160:163], v[32:35], 0
    v_mfma_f32_16x16x32_bf16 v[192:195], v[214:217], v[40:43], v[192:195]
    v_mfma_f32_16x16x32_bf16 v[196:199], v[164:167], v[32:35], 0
    v_mfma_f32_16x16x32_bf16 v[196:199], v[216:219], v[40:43], v[196:199]
    v_mfma_f32_16x16x32_bf16 v[200:203], v[168:171], v[32:35], 0
    v_mfma_f32_16x16x32_bf16 v[200:203], v[218:221], v[40:43], v[200:203]
    v_rcp_f32 v23, v36
    s_add_u32 s85, s81, 176685056
    v_mul_f32 v172, v172, v23
    v_mul_f32 v173, v173, v23
    v_mul_f32 v174, v174, v23
    v_mul_f32 v175, v175, v23
    v_mul_f32 v176, v176, v23
    v_mul_f32 v177, v177, v23
    v_mul_f32 v178, v178, v23
    v_mul_f32 v179, v179, v23
    v_cvt_pk_bf16_f32 v224, v172, v173
    v_cvt_pk_bf16_f32 v225, v174, v175
    v_cvt_pk_bf16_f32 v226, v176, v177
    v_cvt_pk_bf16_f32 v227, v178, v179
    buffer_store_dwordx4 v[224:227], v1, s[4:7], s85 offen offset:0 sc1
    v_mul_f32 v180, v180, v23
    v_mul_f32 v181, v181, v23
    v_mul_f32 v182, v182, v23
    v_mul_f32 v183, v183, v23
    v_mul_f32 v184, v184, v23
    v_mul_f32 v185, v185, v23
    v_mul_f32 v186, v186, v23
    v_mul_f32 v187, v187, v23
    v_cvt_pk_bf16_f32 v228, v180, v181
    v_cvt_pk_bf16_f32 v229, v182, v183
    v_cvt_pk_bf16_f32 v230, v184, v185
    v_cvt_pk_bf16_f32 v231, v186, v187
    buffer_store_dwordx4 v[228:231], v1, s[4:7], s85 offen offset:1024 sc1
    v_mul_f32 v188, v188, v23
    v_mul_f32 v189, v189, v23
    v_mul_f32 v190, v190, v23
    v_mul_f32 v191, v191, v23
    v_mul_f32 v192, v192, v23
    v_mul_f32 v193, v193, v23
    v_mul_f32 v194, v194, v23
    v_mul_f32 v195, v195, v23
    v_cvt_pk_bf16_f32 v232, v188, v189
    v_cvt_pk_bf16_f32 v233, v190, v191
    v_cvt_pk_bf16_f32 v234, v192, v193
    v_cvt_pk_bf16_f32 v235, v194, v195
    buffer_store_dwordx4 v[232:235], v1, s[4:7], s85 offen offset:2048 sc1
    v_mul_f32 v196, v196, v23
    v_mul_f32 v197, v197, v23
    v_mul_f32 v198, v198, v23
    v_mul_f32 v199, v199, v23
    v_mul_f32 v200, v200, v23
    v_mul_f32 v201, v201, v23
    v_mul_f32 v202, v202, v23
    v_mul_f32 v203, v203, v23
    v_cvt_pk_bf16_f32 v236, v196, v197
    v_cvt_pk_bf16_f32 v237, v198, v199
    v_cvt_pk_bf16_f32 v238, v200, v201
    v_cvt_pk_bf16_f32 v239, v202, v203
    buffer_store_dwordx4 v[236:239], v1, s[4:7], s85 offen offset:3072 sc1
    v_mfma_f32_16x16x32_bf16 v[48:51], v[28:31], v[44:47], 0
    v_mfma_f32_16x16x32_bf16 v[48:51], v[28:31], v[52:55], v[48:51]
    v_mfma_f32_16x16x32_bf16 v[172:175], v[140:143], v[44:47], 0
    v_mfma_f32_16x16x32_bf16 v[172:175], v[204:207], v[52:55], v[172:175]
    v_mfma_f32_16x16x32_bf16 v[176:179], v[144:147], v[44:47], 0
    v_mfma_f32_16x16x32_bf16 v[176:179], v[206:209], v[52:55], v[176:179]
    v_mfma_f32_16x16x32_bf16 v[180:183], v[148:151], v[44:47], 0
    v_mfma_f32_16x16x32_bf16 v[180:183], v[208:211], v[52:55], v[180:183]
    v_mfma_f32_16x16x32_bf16 v[184:187], v[152:155], v[44:47], 0
    v_mfma_f32_16x16x32_bf16 v[184:187], v[210:213], v[52:55], v[184:187]
    v_mfma_f32_16x16x32_bf16 v[188:191], v[156:159], v[44:47], 0
    v_mfma_f32_16x16x32_bf16 v[188:191], v[212:215], v[52:55], v[188:191]
    v_mfma_f32_16x16x32_bf16 v[192:195], v[160:163], v[44:47], 0
    v_mfma_f32_16x16x32_bf16 v[192:195], v[214:217], v[52:55], v[192:195]
    v_mfma_f32_16x16x32_bf16 v[196:199], v[164:167], v[44:47], 0
    v_mfma_f32_16x16x32_bf16 v[196:199], v[216:219], v[52:55], v[196:199]
    v_mfma_f32_16x16x32_bf16 v[200:203], v[168:171], v[44:47], 0
    v_mfma_f32_16x16x32_bf16 v[200:203], v[218:221], v[52:55], v[200:203]
    v_rcp_f32 v23, v48
    s_add_u32 s85, s81, 176816128
    v_mul_f32 v172, v172, v23
    v_mul_f32 v173, v173, v23
    v_mul_f32 v174, v174, v23
    v_mul_f32 v175, v175, v23
    v_mul_f32 v176, v176, v23
    v_mul_f32 v177, v177, v23
    v_mul_f32 v178, v178, v23
    v_mul_f32 v179, v179, v23
    v_cvt_pk_bf16_f32 v224, v172, v173
    v_cvt_pk_bf16_f32 v225, v174, v175
    v_cvt_pk_bf16_f32 v226, v176, v177
    v_cvt_pk_bf16_f32 v227, v178, v179
    buffer_store_dwordx4 v[224:227], v1, s[4:7], s85 offen offset:0 sc1
    v_mul_f32 v180, v180, v23
    v_mul_f32 v181, v181, v23
    v_mul_f32 v182, v182, v23
    v_mul_f32 v183, v183, v23
    v_mul_f32 v184, v184, v23
    v_mul_f32 v185, v185, v23
    v_mul_f32 v186, v186, v23
    v_mul_f32 v187, v187, v23
    v_cvt_pk_bf16_f32 v228, v180, v181
    v_cvt_pk_bf16_f32 v229, v182, v183
    v_cvt_pk_bf16_f32 v230, v184, v185
    v_cvt_pk_bf16_f32 v231, v186, v187
    buffer_store_dwordx4 v[228:231], v1, s[4:7], s85 offen offset:1024 sc1
    v_mul_f32 v188, v188, v23
    v_mul_f32 v189, v189, v23
    v_mul_f32 v190, v190, v23
    v_mul_f32 v191, v191, v23
    v_mul_f32 v192, v192, v23
    v_mul_f32 v193, v193, v23
    v_mul_f32 v194, v194, v23
    v_mul_f32 v195, v195, v23
    v_cvt_pk_bf16_f32 v232, v188, v189
    v_cvt_pk_bf16_f32 v233, v190, v191
    v_cvt_pk_bf16_f32 v234, v192, v193
    v_cvt_pk_bf16_f32 v235, v194, v195
    buffer_store_dwordx4 v[232:235], v1, s[4:7], s85 offen offset:2048 sc1
    v_mul_f32 v196, v196, v23
    v_mul_f32 v197, v197, v23
    v_mul_f32 v198, v198, v23
    v_mul_f32 v199, v199, v23
    v_mul_f32 v200, v200, v23
    v_mul_f32 v201, v201, v23
    v_mul_f32 v202, v202, v23
    v_mul_f32 v203, v203, v23
    v_cvt_pk_bf16_f32 v236, v196, v197
    v_cvt_pk_bf16_f32 v237, v198, v199
    v_cvt_pk_bf16_f32 v238, v200, v201
    v_cvt_pk_bf16_f32 v239, v202, v203
    buffer_store_dwordx4 v[236:239], v1, s[4:7], s85 offen offset:3072 sc1
    s_mov_b32 s28, s46
    s_waitcnt vmcnt(0)
    s_barrier
    s_cmp_eq_u32 s28, 0
    s_cbranch_scc1 sig_14
    s_cmp_lg_u32 s3, 0
    s_cbranch_scc1 sig_14
    s_and_b32 s57, s28, 3
    v_mov_b32 v24, s57
    s_bfe_u32 s57, s28, 0x20002
    v_mov_b32 v25, s57
    s_andn2_b32 s28, s28, 15
    s_mov_b64 exec, 1
    buffer_atomic_add_x2 v[24:25], v17, s[4:7], s28 offen sc1
    s_mov_b64 exec, -1
sig_14:
    s_mov_b32 s28, 0
    s_cmp_lg_u32 s3, 0
    s_cbranch_scc1 pub_15
    v_mov_b32 v20, 131136
    s_mov_b64 exec, 1
    ds_write_b32 v20, v250
    s_mov_b64 exec, -1
    s_waitcnt lgkmcnt(0)
pub_15:
    s_barrier
    v_mov_b32 v20, 131136
    ds_read_b32 v20, v20
    s_waitcnt lgkmcnt(0)
    v_readfirstlane_b32 s59, v20
    s_add_u32 s59, s59, 32
    s_min_u32 s59, s59, 322
    s_lshl_b32 s57, s59, 6
    s_load_dwordx16 s[32:47], s[24:25], s57
    s_waitcnt lgkmcnt(0)
    s_branch w_cold
w_fin:
    s_load_dwordx2 s[8:9], s[0:1], 0
    s_load_dwordx2 s[12:13], s[0:1], 88
    v_mbcnt_lo_u32_b32 v1, -1, 0
    v_mbcnt_hi_u32_b32 v1, -1, v1
    s_mov_b32 s10, 4194304
    s_mov_b32 s11, 131072
    s_mov_b32 s14, 4194304
    s_mov_b32 s15, 131072
    s_mov_b32 s89, 0xbfb8aa3b
    v_lshlrev_b32 v3, 4, v1
    v_and_b32 v4, 15, v1
    v_lshrrev_b32 v5, 4, v1
    v_lshlrev_b32 v4, 11, v4
    v_lshl_add_u32 v4, v5, 4, v4
    v_and_b32 v5, 1, v5
    v_cmp_eq_u32 s[76:77], 1, v5
    v_and_b32 v6, 3, v1
    v_lshlrev_b32 v6, 7, v6
    s_mov_b32 s80, s39
    s_lshl_b32 s81, s36, 2
    s_and_b32 s82, s3, 3
    s_add_u32 s81, s81, s82
    s_lshr_b32 s82, s3, 2
    s_mov_b32 s84, 65536
    s_mov_b32 s85, 218112000
    s_waitcnt lgkmcnt(0)
    s_cmp_eq_u32 s32, 7
    s_cbranch_scc1 fin_tail
fin_job:
    s_lshl_b32 s72, s80, 1
    s_add_u32 s72, s72, s82
    s_lshl_b32 s74, s72, 15
    s_lshl_b32 s73, s81, 11
    s_add_u32 s73, s73, s74
    s_lshl_b32 s75, s81, 7
    s_add_u32 s74, s74, s75
    s_add_u32 s78, s73, 117440512
    s_add_u32 s79, s73, 75497472
    s_lshr_b32 s83, s80, 3
    s_lshl_b32 s83, s83, 6
    s_add_u32 s83, s83, 218106368
    s_add_u32 s87, s80, 2
    buffer_load_dwordx4 v[88:91], v4, s[8:11], s74 offen offset:0
    buffer_load_dwordx4 v[92:95], v4, s[8:11], s74 offen offset:64
    s_cmp_lg_u32 s3, 0
    s_cbranch_scc1 fin_ws_ok
fin_wd:
    buffer_load_dwordx2 v[8:9], off, s[4:7], s83 sc1
    s_waitcnt vmcnt(0)
    v_readfirstlane_b32 s86, v8
    v_readfirstlane_b32 s88, v9
    s_cmp_ge_u32 s88, s37
    s_cselect_b32 s86, s86, 0
    s_cmp_ge_u32 s86, 16
    s_cbranch_scc1 fin_wd2
    s_sleep 64
    s_sub_u32 s84, s84, 1
    s_cbranch_scc0 fin_wd
    s_mov_b32 s84, 0
fin_wd2:
    s_cmp_lg_u32 s37, 0
    s_cbranch_scc1 fin_ws_ok
fin_ws:
    buffer_load_dword v7, v6, s[4:7], s85 offen sc1
    s_waitcnt vmcnt(0)
    v_cmp_gt_u32 vcc, s87, v7
    s_cbranch_vccz fin_ws_ok
    s_sleep 12
    s_sub_u32 s86, s87, 2
    v_cmp_gt_i32 vcc, s86, v7
    s_cbranch_vccz fin_ws_f
    s_sleep 64
    s_sub_u32 s86, s87, 6
    v_cmp_gt_i32 vcc, s86, v7
    s_cbranch_vccz fin_ws_f
    s_sleep 127
    s_sleep 127
fin_ws_f:
    s_sub_u32 s84, s84, 1
    s_cbranch_scc0 fin_ws
    s_mov_b32 s84, 0
fin_ws_ok:
    s_cmp_lg_u32 s3, 0
    s_cbranch_scc1 clm_16
    v_mov_b32 v250, 1
    s_mov_b64 exec, 1
    buffer_atomic_add v250, off, s[64:67], s71 sc0 sc1
    s_mov_b64 exec, -1
clm_16:
    s_barrier
    buffer_load_dwordx4 v[136:139], v3, s[4:7], s78 offen offset:0 sc1
    buffer_load_dwordx4 v[140:143], v3, s[4:7], s78 offen offset:1024 sc1
    s_add_u32 s78, s78, 4194304
    buffer_load_dwordx4 v[144:147], v3, s[4:7], s78 offen offset:0 sc1
    buffer_load_dwordx4 v[148:151], v3, s[4:7], s78 offen offset:1024 sc1
    s_add_u32 s78, s78, 4194304
    s_cmp_lg_u32 s33, 0
    s_cbranch_scc1 fin_g2
    buffer_load_dwordx4 v[152:155], v3, s[4:7], s78 offen offset:0 sc1
    buffer_load_dwordx4 v[156:159], v3, s[4:7], s78 offen offset:1024 sc1
    s_add_u32 s78, s78, 4194304
    buffer_load_dwordx4 v[160:163], v3, s[4:7], s78 offen offset:0 sc1
    buffer_load_dwordx4 v[164:167], v3, s[4:7], s78 offen offset:1024 sc1
    s_add_u32 s78, s78, 4194304
    s_branch fin_g4
fin_g2:
    v_mov_b32 v152, 0
    v_mov_b32 v153, 0
    v_mov_b32 v154, 0
    v_mov_b32 v155, 0
    v_mov_b32 v156, 0
    v_mov_b32 v157, 0
    v_mov_b32 v158, 0
    v_mov_b32 v159, 0
    v_mov_b32 v160, 0
    v_mov_b32 v161, 0
    v_mov_b32 v162, 0
    v_mov_b32 v163, 0
    v_mov_b32 v164, 0
    v_mov_b32 v165, 0
    v_mov_b32 v166, 0
    v_mov_b32 v167, 0
fin_g4:
    buffer_load_dwordx4 v[16:19], v3, s[4:7], s79 offen offset:0 sc1
    buffer_load_dwordx4 v[48:51], v3, s[4:7], s79 offen offset:1024 sc1
    s_add_u32 s79, s79, 4194304
    buffer_load_dwordx4 v[20:23], v3, s[4:7], s79 offen offset:0 sc1
    buffer_load_dwordx4 v[52:55], v3, s[4:7], s79 offen offset:1024 sc1
    s_add_u32 s79, s79, 4194304
    s_cmp_ge_u32 s35, 2
    s_cbranch_scc1 fin_2p
    buffer_load_dwordx4 v[24:27], v3, s[4:7], s79 offen offset:0 sc1
    buffer_load_dwordx4 v[56:59], v3, s[4:7], s79 offen offset:1024 sc1
    s_add_u32 s79, s79, 4194304
    buffer_load_dwordx4 v[28:31], v3, s[4:7], s79 offen offset:0 sc1
    buffer_load_dwordx4 v[60:63], v3, s[4:7], s79 offen offset:1024 sc1
    s_add_u32 s79, s79, 4194304
    s_cmp_ge_u32 s35, 1
    s_cbranch_scc1 fin_4p
    buffer_load_dwordx4 v[32:35], v3, s[4:7], s79 offen offset:0 sc1
    buffer_load_dwordx4 v[64:67], v3, s[4:7], s79 offen offset:1024 sc1
    s_add_u32 s79, s79, 4194304
    buffer_load_dwordx4 v[36:39], v3, s[4:7], s79 offen offset:0 sc1
    buffer_load_dwordx4 v[68:71], v3, s[4:7], s79 offen offset:1024 sc1
    s_add_u32 s79, s79, 4194304
    buffer_load_dwordx4 v[40:43], v3, s[4:7], s79 offen offset:0 sc1
    buffer_load_dwordx4 v[72:75], v3, s[4:7], s79 offen offset:1024 sc1
    s_add_u32 s79, s79, 4194304
    buffer_load_dwordx4 v[44:47], v3, s[4:7], s79 offen offset:0 sc1
    buffer_load_dwordx4 v[76:79], v3, s[4:7], s79 offen offset:1024 sc1
    s_add_u32 s79, s79, 4194304
    s_waitcnt vmcnt(16)
    s_branch fin_8p
fin_2p:
    v_mov_b32 v24, 0
    v_mov_b32 v25, 0
    v_mov_b32 v26, 0
    v_mov_b32 v27, 0
    v_mov_b32 v28, 0
    v_mov_b32 v29, 0
    v_mov_b32 v30, 0
    v_mov_b32 v31, 0
    v_mov_b32 v32, 0
    v_mov_b32 v33, 0
    v_mov_b32 v34, 0
    v_mov_b32 v35, 0
    v_mov_b32 v36, 0
    v_mov_b32 v37, 0
    v_mov_b32 v38, 0
    v_mov_b32 v39, 0
    v_mov_b32 v40, 0
    v_mov_b32 v41, 0
    v_mov_b32 v42, 0
    v_mov_b32 v43, 0
    v_mov_b32 v44, 0
    v_mov_b32 v45, 0
    v_mov_b32 v46, 0
    v_mov_b32 v47, 0
    v_mov_b32 v56, 0
    v_mov_b32 v57, 0
    v_mov_b32 v58, 0
    v_mov_b32 v59, 0
    v_mov_b32 v60, 0
    v_mov_b32 v61, 0
    v_mov_b32 v62, 0
    v_mov_b32 v63, 0
    v_mov_b32 v64, 0
    v_mov_b32 v65, 0
    v_mov_b32 v66, 0
    v_mov_b32 v67, 0
    v_mov_b32 v68, 0
    v_mov_b32 v69, 0
    v_mov_b32 v70, 0
    v_mov_b32 v71, 0
    v_mov_b32 v72, 0
    v_mov_b32 v73, 0
    v_mov_b32 v74, 0
    v_mov_b32 v75, 0
    v_mov_b32 v76, 0
    v_mov_b32 v77, 0
    v_mov_b32 v78, 0
    v_mov_b32 v79, 0
    s_waitcnt vmcnt(4)
    s_branch fin_8p
fin_4p:
    v_mov_b32 v32, 0
    v_mov_b32 v33, 0
    v_mov_b32 v34, 0
    v_mov_b32 v35, 0
    v_mov_b32 v36, 0
    v_mov_b32 v37, 0
    v_mov_b32 v38, 0
    v_mov_b32 v39, 0
    v_mov_b32 v40, 0
    v_mov_b32 v41, 0
    v_mov_b32 v42, 0
    v_mov_b32 v43, 0
    v_mov_b32 v44, 0
    v_mov_b32 v45, 0
    v_mov_b32 v46, 0
    v_mov_b32 v47, 0
    v_mov_b32 v64, 0
    v_mov_b32 v65, 0
    v_mov_b32 v66, 0
    v_mov_b32 v67, 0
    v_mov_b32 v68, 0
    v_mov_b32 v69, 0
    v_mov_b32 v70, 0
    v_mov_b32 v71, 0
    v_mov_b32 v72, 0
    v_mov_b32 v73, 0
    v_mov_b32 v74, 0
    v_mov_b32 v75, 0
    v_mov_b32 v76, 0
    v_mov_b32 v77, 0
    v_mov_b32 v78, 0
    v_mov_b32 v79, 0
    s_waitcnt vmcnt(8)
fin_8p:
    v_lshlrev_b32 v120, 16, v136
    v_and_b32 v121, 0xffff0000, v136
    v_lshlrev_b32 v136, 16, v144
    v_and_b32 v144, 0xffff0000, v144
    v_add_f32 v120, v120, v136
    v_add_f32 v121, v121, v144
    v_lshlrev_b32 v136, 16, v152
    v_and_b32 v152, 0xffff0000, v152
    v_add_f32 v120, v120, v136
    v_add_f32 v121, v121, v152
    v_lshlrev_b32 v136, 16, v160
    v_and_b32 v160, 0xffff0000, v160
    v_add_f32 v120, v120, v136
    v_add_f32 v121, v121, v160
    v_cvt_pk_bf16_f32 v136, v120, v121
    v_lshlrev_b32 v120, 16, v136
    v_and_b32 v121, 0xffff0000, v136
    v_mul_f32 v136, s89, v120
    v_mul_f32 v144, s89, v121
    v_lshlrev_b32 v122, 16, v137
    v_and_b32 v123, 0xffff0000, v137
    v_lshlrev_b32 v137, 16, v145
    v_and_b32 v145, 0xffff0000, v145
    v_add_f32 v122, v122, v137
    v_add_f32 v123, v123, v145
    v_lshlrev_b32 v137, 16, v153
    v_and_b32 v153, 0xffff0000, v153
    v_add_f32 v122, v122, v137
    v_add_f32 v123, v123, v153
    v_lshlrev_b32 v137, 16, v161
    v_and_b32 v161, 0xffff0000, v161
    v_add_f32 v122, v122, v137
    v_add_f32 v123, v123, v161
    v_cvt_pk_bf16_f32 v137, v122, v123
    v_lshlrev_b32 v122, 16, v137
    v_and_b32 v123, 0xffff0000, v137
    v_mul_f32 v137, s89, v122
    v_mul_f32 v145, s89, v123
    v_lshlrev_b32 v124, 16, v138
    v_and_b32 v125, 0xffff0000, v138
    v_lshlrev_b32 v138, 16, v146
    v_and_b32 v146, 0xffff0000, v146
    v_add_f32 v124, v124, v138
    v_add_f32 v125, v125, v146
    v_lshlrev_b32 v138, 16, v154
    v_and_b32 v154, 0xffff0000, v154
    v_add_f32 v124, v124, v138
    v_add_f32 v125, v125, v154
    v_lshlrev_b32 v138, 16, v162
    v_and_b32 v162, 0xffff0000, v162
    v_add_f32 v124, v124, v138
    v_add_f32 v125, v125, v162
    v_cvt_pk_bf16_f32 v138, v124, v125
    v_lshlrev_b32 v124, 16, v138
    v_and_b32 v125, 0xffff0000, v138
    v_mul_f32 v138, s89, v124
    v_mul_f32 v146, s89, v125
    v_lshlrev_b32 v126, 16, v139
    v_and_b32 v127, 0xffff0000, v139
    v_lshlrev_b32 v139, 16, v147
    v_and_b32 v147, 0xffff0000, v147
    v_add_f32 v126, v126, v139
    v_add_f32 v127, v127, v147
    v_lshlrev_b32 v139, 16, v155
    v_and_b32 v155, 0xffff0000, v155
    v_add_f32 v126, v126, v139
    v_add_f32 v127, v127, v155
    v_lshlrev_b32 v139, 16, v163
    v_and_b32 v163, 0xffff0000, v163
    v_add_f32 v126, v126, v139
    v_add_f32 v127, v127, v163
    v_cvt_pk_bf16_f32 v139, v126, v127
    v_lshlrev_b32 v126, 16, v139
    v_and_b32 v127, 0xffff0000, v139
    v_mul_f32 v139, s89, v126
    v_mul_f32 v147, s89, v127
    v_exp_f32 v136, v136
    v_exp_f32 v144, v144
    v_exp_f32 v137, v137
    v_exp_f32 v145, v145
    v_exp_f32 v138, v138
    v_exp_f32 v146, v146
    v_exp_f32 v139, v139
    v_exp_f32 v147, v147
    s_nop 0
    v_add_f32 v136, 1.0, v136
    v_add_f32 v144, 1.0, v144
    v_add_f32 v137, 1.0, v137
    v_add_f32 v145, 1.0, v145
    v_add_f32 v138, 1.0, v138
    v_add_f32 v146, 1.0, v146
    v_add_f32 v139, 1.0, v139
    v_add_f32 v147, 1.0, v147
    v_rcp_f32 v136, v136
    v_rcp_f32 v144, v144
    v_rcp_f32 v137, v137
    v_rcp_f32 v145, v145
    v_rcp_f32 v138, v138
    v_rcp_f32 v146, v146
    v_rcp_f32 v139, v139
    v_rcp_f32 v147, v147
    s_nop 0
    v_mul_f32 v120, v120, v136
    v_mul_f32 v121, v121, v144
    v_cvt_pk_bf16_f32 v136, v120, v121
    v_mul_f32 v122, v122, v137
    v_mul_f32 v123, v123, v145
    v_cvt_pk_bf16_f32 v137, v122, v123
    v_mul_f32 v124, v124, v138
    v_mul_f32 v125, v125, v146
    v_cvt_pk_bf16_f32 v138, v124, v125
    v_mul_f32 v126, v126, v139
    v_mul_f32 v127, v127, v147
    v_cvt_pk_bf16_f32 v139, v126, v127
    v_lshlrev_b32 v120, 16, v140
    v_and_b32 v121, 0xffff0000, v140
    v_lshlrev_b32 v140, 16, v148
    v_and_b32 v148, 0xffff0000, v148
    v_add_f32 v120, v120, v140
    v_add_f32 v121, v121, v148
    v_lshlrev_b32 v140, 16, v156
    v_and_b32 v156, 0xffff0000, v156
    v_add_f32 v120, v120, v140
    v_add_f32 v121, v121, v156
    v_lshlrev_b32 v140, 16, v164
    v_and_b32 v164, 0xffff0000, v164
    v_add_f32 v120, v120, v140
    v_add_f32 v121, v121, v164
    v_cvt_pk_bf16_f32 v140, v120, v121
    v_lshlrev_b32 v120, 16, v140
    v_and_b32 v121, 0xffff0000, v140
    v_mul_f32 v140, s89, v120
    v_mul_f32 v148, s89, v121
    v_lshlrev_b32 v122, 16, v141
    v_and_b32 v123, 0xffff0000, v141
    v_lshlrev_b32 v141, 16, v149
    v_and_b32 v149, 0xffff0000, v149
    v_add_f32 v122, v122, v141
    v_add_f32 v123, v123, v149
    v_lshlrev_b32 v141, 16, v157
    v_and_b32 v157, 0xffff0000, v157
    v_add_f32 v122, v122, v141
    v_add_f32 v123, v123, v157
    v_lshlrev_b32 v141, 16, v165
    v_and_b32 v165, 0xffff0000, v165
    v_add_f32 v122, v122, v141
    v_add_f32 v123, v123, v165
    v_cvt_pk_bf16_f32 v141, v122, v123
    v_lshlrev_b32 v122, 16, v141
    v_and_b32 v123, 0xffff0000, v141
    v_mul_f32 v141, s89, v122
    v_mul_f32 v149, s89, v123
    v_lshlrev_b32 v124, 16, v142
    v_and_b32 v125, 0xffff0000, v142
    v_lshlrev_b32 v142, 16, v150
    v_and_b32 v150, 0xffff0000, v150
    v_add_f32 v124, v124, v142
    v_add_f32 v125, v125, v150
    v_lshlrev_b32 v142, 16, v158
    v_and_b32 v158, 0xffff0000, v158
    v_add_f32 v124, v124, v142
    v_add_f32 v125, v125, v158
    v_lshlrev_b32 v142, 16, v166
    v_and_b32 v166, 0xffff0000, v166
    v_add_f32 v124, v124, v142
    v_add_f32 v125, v125, v166
    v_cvt_pk_bf16_f32 v142, v124, v125
    v_lshlrev_b32 v124, 16, v142
    v_and_b32 v125, 0xffff0000, v142
    v_mul_f32 v142, s89, v124
    v_mul_f32 v150, s89, v125
    v_lshlrev_b32 v126, 16, v143
    v_and_b32 v127, 0xffff0000, v143
    v_lshlrev_b32 v143, 16, v151
    v_and_b32 v151, 0xffff0000, v151
    v_add_f32 v126, v126, v143
    v_add_f32 v127, v127, v151
    v_lshlrev_b32 v143, 16, v159
    v_and_b32 v159, 0xffff0000, v159
    v_add_f32 v126, v126, v143
    v_add_f32 v127, v127, v159
    v_lshlrev_b32 v143, 16, v167
    v_and_b32 v167, 0xffff0000, v167
    v_add_f32 v126, v126, v143
    v_add_f32 v127, v127, v167
    v_cvt_pk_bf16_f32 v143, v126, v127
    v_lshlrev_b32 v126, 16, v143
    v_and_b32 v127, 0xffff0000, v143
    v_mul_f32 v143, s89, v126
    v_mul_f32 v151, s89, v127
    v_exp_f32 v140, v140
    v_exp_f32 v148, v148
    v_exp_f32 v141, v141
    v_exp_f32 v149, v149
    v_exp_f32 v142, v142
    v_exp_f32 v150, v150
    v_exp_f32 v143, v143
    v_exp_f32 v151, v151
    s_nop 0
    v_add_f32 v140, 1.0, v140
    v_add_f32 v148, 1.0, v148
    v_add_f32 v141, 1.0, v141
    v_add_f32 v149, 1.0, v149
    v_add_f32 v142, 1.0, v142
    v_add_f32 v150, 1.0, v150
    v_add_f32 v143, 1.0, v143
    v_add_f32 v151, 1.0, v151
    v_rcp_f32 v140, v140
    v_rcp_f32 v148, v148
    v_rcp_f32 v141, v141
    v_rcp_f32 v149, v149
    v_rcp_f32 v142, v142
    v_rcp_f32 v150, v150
    v_rcp_f32 v143, v143
    v_rcp_f32 v151, v151
    s_nop 0
    v_mul_f32 v120, v120, v140
    v_mul_f32 v121, v121, v148
    v_cvt_pk_bf16_f32 v140, v120, v121
    v_mul_f32 v122, v122, v141
    v_mul_f32 v123, v123, v149
    v_cvt_pk_bf16_f32 v141, v122, v123
    v_mul_f32 v124, v124, v142
    v_mul_f32 v125, v125, v150
    v_cvt_pk_bf16_f32 v142, v124, v125
    v_mul_f32 v126, v126, v143
    v_mul_f32 v127, v127, v151
    v_cvt_pk_bf16_f32 v143, v126, v127
    s_waitcnt vmcnt(0)
    v_lshlrev_b32 v96, 16, v16
    v_and_b32 v97, 0xffff0000, v16
    v_lshlrev_b32 v98, 16, v17
    v_and_b32 v99, 0xffff0000, v17
    v_lshlrev_b32 v100, 16, v18
    v_and_b32 v101, 0xffff0000, v18
    v_lshlrev_b32 v102, 16, v19
    v_and_b32 v103, 0xffff0000, v19
    v_lshlrev_b32 v120, 16, v20
    v_and_b32 v121, 0xffff0000, v20
    v_lshlrev_b32 v122, 16, v21
    v_and_b32 v123, 0xffff0000, v21
    v_lshlrev_b32 v124, 16, v22
    v_and_b32 v125, 0xffff0000, v22
    v_lshlrev_b32 v126, 16, v23
    v_and_b32 v127, 0xffff0000, v23
    v_add_f32 v96, v96, v120
    v_add_f32 v97, v97, v121
    v_add_f32 v98, v98, v122
    v_add_f32 v99, v99, v123
    v_add_f32 v100, v100, v124
    v_add_f32 v101, v101, v125
    v_add_f32 v102, v102, v126
    v_add_f32 v103, v103, v127
    v_lshlrev_b32 v120, 16, v24
    v_and_b32 v121, 0xffff0000, v24
    v_lshlrev_b32 v122, 16, v25
    v_and_b32 v123, 0xffff0000, v25
    v_lshlrev_b32 v124, 16, v26
    v_and_b32 v125, 0xffff0000, v26
    v_lshlrev_b32 v126, 16, v27
    v_and_b32 v127, 0xffff0000, v27
    v_add_f32 v96, v96, v120
    v_add_f32 v97, v97, v121
    v_add_f32 v98, v98, v122
    v_add_f32 v99, v99, v123
    v_add_f32 v100, v100, v124
    v_add_f32 v101, v101, v125
    v_add_f32 v102, v102, v126
    v_add_f32 v103, v103, v127
    v_lshlrev_b32 v120, 16, v28
    v_and_b32 v121, 0xffff0000, v28
    v_lshlrev_b32 v122, 16, v29
    v_and_b32 v123, 0xffff0000, v29
    v_lshlrev_b32 v124, 16, v30
    v_and_b32 v125, 0xffff0000, v30
    v_lshlrev_b32 v126, 16, v31
    v_and_b32 v127, 0xffff0000, v31
    v_add_f32 v96, v96, v120
    v_add_f32 v97, v97, v121
    v_add_f32 v98, v98, v122
    v_add_f32 v99, v99, v123
    v_add_f32 v100, v100, v124
    v_add_f32 v101, v101, v125
    v_add_f32 v102, v102, v126
    v_add_f32 v103, v103, v127
    v_lshlrev_b32 v120, 16, v32
    v_and_b32 v121, 0xffff0000, v32
    v_lshlrev_b32 v122, 16, v33
    v_and_b32 v123, 0xffff0000, v33
    v_lshlrev_b32 v124, 16, v34
    v_and_b32 v125, 0xffff0000, v34
    v_lshlrev_b32 v126, 16, v35
    v_and_b32 v127, 0xffff0000, v35
    v_add_f32 v96, v96, v120
    v_add_f32 v97, v97, v121
    v_add_f32 v98, v98, v122
    v_add_f32 v99, v99, v123
    v_add_f32 v100, v100, v124
    v_add_f32 v101, v101, v125
    v_add_f32 v102, v102, v126
    v_add_f32 v103, v103, v127
    v_lshlrev_b32 v120, 16, v36
    v_and_b32 v121, 0xffff0000, v36
    v_lshlrev_b32 v122, 16, v37
    v_and_b32 v123, 0xffff0000, v37
    v_lshlrev_b32 v124, 16, v38
    v_and_b32 v125, 0xffff0000, v38
    v_lshlrev_b32 v126, 16, v39
    v_and_b32 v127, 0xffff0000, v39
    v_add_f32 v96, v96, v120
    v_add_f32 v97, v97, v121
    v_add_f32 v98, v98, v122
    v_add_f32 v99, v99, v123
    v_add_f32 v100, v100, v124
    v_add_f32 v101, v101, v125
    v_add_f32 v102, v102, v126
    v_add_f32 v103, v103, v127
    v_lshlrev_b32 v120, 16, v40
    v_and_b32 v121, 0xffff0000, v40
    v_lshlrev_b32 v122, 16, v41
    v_and_b32 v123, 0xffff0000, v41
    v_lshlrev_b32 v124, 16, v42
    v_and_b32 v125, 0xffff0000, v42
    v_lshlrev_b32 v126, 16, v43
    v_and_b32 v127, 0xffff0000, v43
    v_add_f32 v96, v96, v120
    v_add_f32 v97, v97, v121
    v_add_f32 v98, v98, v122
    v_add_f32 v99, v99, v123
    v_add_f32 v100, v100, v124
    v_add_f32 v101, v101, v125
    v_add_f32 v102, v102, v126
    v_add_f32 v103, v103, v127
    v_lshlrev_b32 v120, 16, v44
    v_and_b32 v121, 0xffff0000, v44
    v_lshlrev_b32 v122, 16, v45
    v_and_b32 v123, 0xffff0000, v45
    v_lshlrev_b32 v124, 16, v46
    v_and_b32 v125, 0xffff0000, v46
    v_lshlrev_b32 v126, 16, v47
    v_and_b32 v127, 0xffff0000, v47
    v_add_f32 v96, v96, v120
    v_add_f32 v97, v97, v121
    v_add_f32 v98, v98, v122
    v_add_f32 v99, v99, v123
    v_add_f32 v100, v100, v124
    v_add_f32 v101, v101, v125
    v_add_f32 v102, v102, v126
    v_add_f32 v103, v103, v127
    v_cndmask_b32 v108, v88, v90, s[76:77]
    v_cndmask_b32 v109, v89, v91, s[76:77]
    v_cndmask_b32 v110, v90, v88, s[76:77]
    v_cndmask_b32 v111, v91, v89, s[76:77]
    v_cvt_pk_bf16_f32 v104, v96, v97
    v_lshlrev_b32 v96, 16, v104
    v_and_b32 v97, 0xffff0000, v104
    v_lshlrev_b32 v104, 16, v136
    v_and_b32 v105, 0xffff0000, v136
    v_mul_f32 v96, v96, v104
    v_mul_f32 v97, v97, v105
    v_cvt_pk_bf16_f32 v104, v96, v97
    v_lshlrev_b32 v96, 16, v104
    v_and_b32 v97, 0xffff0000, v104
    v_lshlrev_b32 v104, 16, v108
    v_and_b32 v105, 0xffff0000, v108
    v_add_f32 v96, v96, v104
    v_add_f32 v97, v97, v105
    v_cvt_pk_bf16_f32 v112, v96, v97
    v_cvt_pk_bf16_f32 v104, v98, v99
    v_lshlrev_b32 v98, 16, v104
    v_and_b32 v99, 0xffff0000, v104
    v_lshlrev_b32 v104, 16, v137
    v_and_b32 v105, 0xffff0000, v137
    v_mul_f32 v98, v98, v104
    v_mul_f32 v99, v99, v105
    v_cvt_pk_bf16_f32 v104, v98, v99
    v_lshlrev_b32 v98, 16, v104
    v_and_b32 v99, 0xffff0000, v104
    v_lshlrev_b32 v104, 16, v109
    v_and_b32 v105, 0xffff0000, v109
    v_add_f32 v98, v98, v104
    v_add_f32 v99, v99, v105
    v_cvt_pk_bf16_f32 v113, v98, v99
    v_cvt_pk_bf16_f32 v104, v100, v101
    v_lshlrev_b32 v100, 16, v104
    v_and_b32 v101, 0xffff0000, v104
    v_lshlrev_b32 v104, 16, v138
    v_and_b32 v105, 0xffff0000, v138
    v_mul_f32 v100, v100, v104
    v_mul_f32 v101, v101, v105
    v_cvt_pk_bf16_f32 v104, v100, v101
    v_lshlrev_b32 v100, 16, v104
    v_and_b32 v101, 0xffff0000, v104
    v_lshlrev_b32 v104, 16, v110
    v_and_b32 v105, 0xffff0000, v110
    v_add_f32 v100, v100, v104
    v_add_f32 v101, v101, v105
    v_cvt_pk_bf16_f32 v114, v100, v101
    v_cvt_pk_bf16_f32 v104, v102, v103
    v_lshlrev_b32 v102, 16, v104
    v_and_b32 v103, 0xffff0000, v104
    v_lshlrev_b32 v104, 16, v139
    v_and_b32 v105, 0xffff0000, v139
    v_mul_f32 v102, v102, v104
    v_mul_f32 v103, v103, v105
    v_cvt_pk_bf16_f32 v104, v102, v103
    v_lshlrev_b32 v102, 16, v104
    v_and_b32 v103, 0xffff0000, v104
    v_lshlrev_b32 v104, 16, v111
    v_and_b32 v105, 0xffff0000, v111
    v_add_f32 v102, v102, v104
    v_add_f32 v103, v103, v105
    v_cvt_pk_bf16_f32 v115, v102, v103
    v_cndmask_b32 v128, v112, v114, s[76:77]
    v_cndmask_b32 v129, v113, v115, s[76:77]
    v_cndmask_b32 v130, v114, v112, s[76:77]
    v_cndmask_b32 v131, v115, v113, s[76:77]
    buffer_store_dwordx4 v[128:131], v4, s[12:15], s74 offen offset:0
    v_lshlrev_b32 v96, 16, v48
    v_and_b32 v97, 0xffff0000, v48
    v_lshlrev_b32 v98, 16, v49
    v_and_b32 v99, 0xffff0000, v49
    v_lshlrev_b32 v100, 16, v50
    v_and_b32 v101, 0xffff0000, v50
    v_lshlrev_b32 v102, 16, v51
    v_and_b32 v103, 0xffff0000, v51
    v_lshlrev_b32 v120, 16, v52
    v_and_b32 v121, 0xffff0000, v52
    v_lshlrev_b32 v122, 16, v53
    v_and_b32 v123, 0xffff0000, v53
    v_lshlrev_b32 v124, 16, v54
    v_and_b32 v125, 0xffff0000, v54
    v_lshlrev_b32 v126, 16, v55
    v_and_b32 v127, 0xffff0000, v55
    v_add_f32 v96, v96, v120
    v_add_f32 v97, v97, v121
    v_add_f32 v98, v98, v122
    v_add_f32 v99, v99, v123
    v_add_f32 v100, v100, v124
    v_add_f32 v101, v101, v125
    v_add_f32 v102, v102, v126
    v_add_f32 v103, v103, v127
    v_lshlrev_b32 v120, 16, v56
    v_and_b32 v121, 0xffff0000, v56
    v_lshlrev_b32 v122, 16, v57
    v_and_b32 v123, 0xffff0000, v57
    v_lshlrev_b32 v124, 16, v58
    v_and_b32 v125, 0xffff0000, v58
    v_lshlrev_b32 v126, 16, v59
    v_and_b32 v127, 0xffff0000, v59
    v_add_f32 v96, v96, v120
    v_add_f32 v97, v97, v121
    v_add_f32 v98, v98, v122
    v_add_f32 v99, v99, v123
    v_add_f32 v100, v100, v124
    v_add_f32 v101, v101, v125
    v_add_f32 v102, v102, v126
    v_add_f32 v103, v103, v127
    v_lshlrev_b32 v120, 16, v60
    v_and_b32 v121, 0xffff0000, v60
    v_lshlrev_b32 v122, 16, v61
    v_and_b32 v123, 0xffff0000, v61
    v_lshlrev_b32 v124, 16, v62
    v_and_b32 v125, 0xffff0000, v62
    v_lshlrev_b32 v126, 16, v63
    v_and_b32 v127, 0xffff0000, v63
    v_add_f32 v96, v96, v120
    v_add_f32 v97, v97, v121
    v_add_f32 v98, v98, v122
    v_add_f32 v99, v99, v123
    v_add_f32 v100, v100, v124
    v_add_f32 v101, v101, v125
    v_add_f32 v102, v102, v126
    v_add_f32 v103, v103, v127
    v_lshlrev_b32 v120, 16, v64
    v_and_b32 v121, 0xffff0000, v64
    v_lshlrev_b32 v122, 16, v65
    v_and_b32 v123, 0xffff0000, v65
    v_lshlrev_b32 v124, 16, v66
    v_and_b32 v125, 0xffff0000, v66
    v_lshlrev_b32 v126, 16, v67
    v_and_b32 v127, 0xffff0000, v67
    v_add_f32 v96, v96, v120
    v_add_f32 v97, v97, v121
    v_add_f32 v98, v98, v122
    v_add_f32 v99, v99, v123
    v_add_f32 v100, v100, v124
    v_add_f32 v101, v101, v125
    v_add_f32 v102, v102, v126
    v_add_f32 v103, v103, v127
    v_lshlrev_b32 v120, 16, v68
    v_and_b32 v121, 0xffff0000, v68
    v_lshlrev_b32 v122, 16, v69
    v_and_b32 v123, 0xffff0000, v69
    v_lshlrev_b32 v124, 16, v70
    v_and_b32 v125, 0xffff0000, v70
    v_lshlrev_b32 v126, 16, v71
    v_and_b32 v127, 0xffff0000, v71
    v_add_f32 v96, v96, v120
    v_add_f32 v97, v97, v121
    v_add_f32 v98, v98, v122
    v_add_f32 v99, v99, v123
    v_add_f32 v100, v100, v124
    v_add_f32 v101, v101, v125
    v_add_f32 v102, v102, v126
    v_add_f32 v103, v103, v127
    v_lshlrev_b32 v120, 16, v72
    v_and_b32 v121, 0xffff0000, v72
    v_lshlrev_b32 v122, 16, v73
    v_and_b32 v123, 0xffff0000, v73
    v_lshlrev_b32 v124, 16, v74
    v_and_b32 v125, 0xffff0000, v74
    v_lshlrev_b32 v126, 16, v75
    v_and_b32 v127, 0xffff0000, v75
    v_add_f32 v96, v96, v120
    v_add_f32 v97, v97, v121
    v_add_f32 v98, v98, v122
    v_add_f32 v99, v99, v123
    v_add_f32 v100, v100, v124
    v_add_f32 v101, v101, v125
    v_add_f32 v102, v102, v126
    v_add_f32 v103, v103, v127
    v_lshlrev_b32 v120, 16, v76
    v_and_b32 v121, 0xffff0000, v76
    v_lshlrev_b32 v122, 16, v77
    v_and_b32 v123, 0xffff0000, v77
    v_lshlrev_b32 v124, 16, v78
    v_and_b32 v125, 0xffff0000, v78
    v_lshlrev_b32 v126, 16, v79
    v_and_b32 v127, 0xffff0000, v79
    v_add_f32 v96, v96, v120
    v_add_f32 v97, v97, v121
    v_add_f32 v98, v98, v122
    v_add_f32 v99, v99, v123
    v_add_f32 v100, v100, v124
    v_add_f32 v101, v101, v125
    v_add_f32 v102, v102, v126
    v_add_f32 v103, v103, v127
    v_cndmask_b32 v108, v92, v94, s[76:77]
    v_cndmask_b32 v109, v93, v95, s[76:77]
    v_cndmask_b32 v110, v94, v92, s[76:77]
    v_cndmask_b32 v111, v95, v93, s[76:77]
    v_cvt_pk_bf16_f32 v104, v96, v97
    v_lshlrev_b32 v96, 16, v104
    v_and_b32 v97, 0xffff0000, v104
    v_lshlrev_b32 v104, 16, v140
    v_and_b32 v105, 0xffff0000, v140
    v_mul_f32 v96, v96, v104
    v_mul_f32 v97, v97, v105
    v_cvt_pk_bf16_f32 v104, v96, v97
    v_lshlrev_b32 v96, 16, v104
    v_and_b32 v97, 0xffff0000, v104
    v_lshlrev_b32 v104, 16, v108
    v_and_b32 v105, 0xffff0000, v108
    v_add_f32 v96, v96, v104
    v_add_f32 v97, v97, v105
    v_cvt_pk_bf16_f32 v112, v96, v97
    v_cvt_pk_bf16_f32 v104, v98, v99
    v_lshlrev_b32 v98, 16, v104
    v_and_b32 v99, 0xffff0000, v104
    v_lshlrev_b32 v104, 16, v141
    v_and_b32 v105, 0xffff0000, v141
    v_mul_f32 v98, v98, v104
    v_mul_f32 v99, v99, v105
    v_cvt_pk_bf16_f32 v104, v98, v99
    v_lshlrev_b32 v98, 16, v104
    v_and_b32 v99, 0xffff0000, v104
    v_lshlrev_b32 v104, 16, v109
    v_and_b32 v105, 0xffff0000, v109
    v_add_f32 v98, v98, v104
    v_add_f32 v99, v99, v105
    v_cvt_pk_bf16_f32 v113, v98, v99
    v_cvt_pk_bf16_f32 v104, v100, v101
    v_lshlrev_b32 v100, 16, v104
    v_and_b32 v101, 0xffff0000, v104
    v_lshlrev_b32 v104, 16, v142
    v_and_b32 v105, 0xffff0000, v142
    v_mul_f32 v100, v100, v104
    v_mul_f32 v101, v101, v105
    v_cvt_pk_bf16_f32 v104, v100, v101
    v_lshlrev_b32 v100, 16, v104
    v_and_b32 v101, 0xffff0000, v104
    v_lshlrev_b32 v104, 16, v110
    v_and_b32 v105, 0xffff0000, v110
    v_add_f32 v100, v100, v104
    v_add_f32 v101, v101, v105
    v_cvt_pk_bf16_f32 v114, v100, v101
    v_cvt_pk_bf16_f32 v104, v102, v103
    v_lshlrev_b32 v102, 16, v104
    v_and_b32 v103, 0xffff0000, v104
    v_lshlrev_b32 v104, 16, v143
    v_and_b32 v105, 0xffff0000, v143
    v_mul_f32 v102, v102, v104
    v_mul_f32 v103, v103, v105
    v_cvt_pk_bf16_f32 v104, v102, v103
    v_lshlrev_b32 v102, 16, v104
    v_and_b32 v103, 0xffff0000, v104
    v_lshlrev_b32 v104, 16, v111
    v_and_b32 v105, 0xffff0000, v111
    v_add_f32 v102, v102, v104
    v_add_f32 v103, v103, v105
    v_cvt_pk_bf16_f32 v115, v102, v103
    v_cndmask_b32 v132, v112, v114, s[76:77]
    v_cndmask_b32 v133, v113, v115, s[76:77]
    v_cndmask_b32 v134, v114, v112, s[76:77]
    v_cndmask_b32 v135, v115, v113, s[76:77]
    buffer_store_dwordx4 v[132:135], v4, s[12:15], s74 offen offset:64
    s_branch w_fin_done
fin_tail:
    s_mov_b32 s81, s36
    s_lshl_b32 s81, s81, 2
    s_and_b32 s82, s3, 3
    s_add_u32 s81, s81, s82
    s_lshr_b32 s82, s81, 5
    s_and_b32 s81, s81, 31
    s_lshl_b32 s72, s80, 1
    s_add_u32 s72, s72, s82
    s_lshl_b32 s74, s72, 15
    s_lshl_b32 s73, s81, 10
    s_add_u32 s73, s73, s74
    s_lshl_b32 s75, s81, 6
    s_add_u32 s74, s74, s75
    s_add_u32 s78, s73, 117440512
    s_add_u32 s79, s73, 75497472
    s_mov_b32 s83, 218106816
    s_mov_b32 s84, 65536
    s_min_u32 s87, s80, 62
    v_and_b32 v8, 7, v1
    v_lshlrev_b32 v8, 22, v8
    s_cmp_lg_u32 s3, 0
    s_cbranch_scc1 ft_ok
ft_wd:
    buffer_load_dword v7, off, s[4:7], s83 sc1
    s_waitcnt vmcnt(0)
    v_readfirstlane_b32 s86, v7
    s_cmp_ge_u32 s86, 16
    s_cbranch_scc1 ft_wdok
    s_sleep 32
    s_sub_u32 s84, s84, 1
    s_cbranch_scc0 ft_wd
    s_mov_b32 s84, 0
ft_wdok:
ft_ok:
    s_barrier
    s_cmp_ge_u32 s3, 4
    s_cbranch_scc1 w_fin_done
    buffer_load_dwordx4 v[88:91], v4, s[8:11], s74 offen
    buffer_load_dwordx4 v[136:139], v3, s[4:7], s78 offen sc1
    s_add_u32 s78, s78, 4194304
    buffer_load_dwordx4 v[144:147], v3, s[4:7], s78 offen sc1
    s_add_u32 s78, s78, 4194304
    buffer_load_dwordx4 v[152:155], v3, s[4:7], s78 offen sc1
    s_add_u32 s78, s78, 4194304
    buffer_load_dwordx4 v[160:163], v3, s[4:7], s78 offen sc1
    s_add_u32 s78, s78, 4194304
    s_waitcnt vmcnt(0)
    v_lshlrev_b32 v120, 16, v136
    v_and_b32 v121, 0xffff0000, v136
    v_lshlrev_b32 v136, 16, v144
    v_and_b32 v144, 0xffff0000, v144
    v_add_f32 v120, v120, v136
    v_add_f32 v121, v121, v144
    v_lshlrev_b32 v136, 16, v152
    v_and_b32 v152, 0xffff0000, v152
    v_add_f32 v120, v120, v136
    v_add_f32 v121, v121, v152
    v_lshlrev_b32 v136, 16, v160
    v_and_b32 v160, 0xffff0000, v160
    v_add_f32 v120, v120, v136
    v_add_f32 v121, v121, v160
    v_cvt_pk_bf16_f32 v136, v120, v121
    v_lshlrev_b32 v120, 16, v136
    v_and_b32 v121, 0xffff0000, v136
    v_mul_f32 v136, s89, v120
    v_mul_f32 v144, s89, v121
    v_lshlrev_b32 v122, 16, v137
    v_and_b32 v123, 0xffff0000, v137
    v_lshlrev_b32 v137, 16, v145
    v_and_b32 v145, 0xffff0000, v145
    v_add_f32 v122, v122, v137
    v_add_f32 v123, v123, v145
    v_lshlrev_b32 v137, 16, v153
    v_and_b32 v153, 0xffff0000, v153
    v_add_f32 v122, v122, v137
    v_add_f32 v123, v123, v153
    v_lshlrev_b32 v137, 16, v161
    v_and_b32 v161, 0xffff0000, v161
    v_add_f32 v122, v122, v137
    v_add_f32 v123, v123, v161
    v_cvt_pk_bf16_f32 v137, v122, v123
    v_lshlrev_b32 v122, 16, v137
    v_and_b32 v123, 0xffff0000, v137
    v_mul_f32 v137, s89, v122
    v_mul_f32 v145, s89, v123
    v_lshlrev_b32 v124, 16, v138
    v_and_b32 v125, 0xffff0000, v138
    v_lshlrev_b32 v138, 16, v146
    v_and_b32 v146, 0xffff0000, v146
    v_add_f32 v124, v124, v138
    v_add_f32 v125, v125, v146
    v_lshlrev_b32 v138, 16, v154
    v_and_b32 v154, 0xffff0000, v154
    v_add_f32 v124, v124, v138
    v_add_f32 v125, v125, v154
    v_lshlrev_b32 v138, 16, v162
    v_and_b32 v162, 0xffff0000, v162
    v_add_f32 v124, v124, v138
    v_add_f32 v125, v125, v162
    v_cvt_pk_bf16_f32 v138, v124, v125
    v_lshlrev_b32 v124, 16, v138
    v_and_b32 v125, 0xffff0000, v138
    v_mul_f32 v138, s89, v124
    v_mul_f32 v146, s89, v125
    v_lshlrev_b32 v126, 16, v139
    v_and_b32 v127, 0xffff0000, v139
    v_lshlrev_b32 v139, 16, v147
    v_and_b32 v147, 0xffff0000, v147
    v_add_f32 v126, v126, v139
    v_add_f32 v127, v127, v147
    v_lshlrev_b32 v139, 16, v155
    v_and_b32 v155, 0xffff0000, v155
    v_add_f32 v126, v126, v139
    v_add_f32 v127, v127, v155
    v_lshlrev_b32 v139, 16, v163
    v_and_b32 v163, 0xffff0000, v163
    v_add_f32 v126, v126, v139
    v_add_f32 v127, v127, v163
    v_cvt_pk_bf16_f32 v139, v126, v127
    v_lshlrev_b32 v126, 16, v139
    v_and_b32 v127, 0xffff0000, v139
    v_mul_f32 v139, s89, v126
    v_mul_f32 v147, s89, v127
    v_exp_f32 v136, v136
    v_exp_f32 v144, v144
    v_exp_f32 v137, v137
    v_exp_f32 v145, v145
    v_exp_f32 v138, v138
    v_exp_f32 v146, v146
    v_exp_f32 v139, v139
    v_exp_f32 v147, v147
    s_nop 0
    v_add_f32 v136, 1.0, v136
    v_add_f32 v144, 1.0, v144
    v_add_f32 v137, 1.0, v137
    v_add_f32 v145, 1.0, v145
    v_add_f32 v138, 1.0, v138
    v_add_f32 v146, 1.0, v146
    v_add_f32 v139, 1.0, v139
    v_add_f32 v147, 1.0, v147
    v_rcp_f32 v136, v136
    v_rcp_f32 v144, v144
    v_rcp_f32 v137, v137
    v_rcp_f32 v145, v145
    v_rcp_f32 v138, v138
    v_rcp_f32 v146, v146
    v_rcp_f32 v139, v139
    v_rcp_f32 v147, v147
    s_nop 0
    v_mul_f32 v120, v120, v136
    v_mul_f32 v121, v121, v144
    v_cvt_pk_bf16_f32 v136, v120, v121
    v_mul_f32 v122, v122, v137
    v_mul_f32 v123, v123, v145
    v_cvt_pk_bf16_f32 v137, v122, v123
    v_mul_f32 v124, v124, v138
    v_mul_f32 v125, v125, v146
    v_cvt_pk_bf16_f32 v138, v124, v125
    v_mul_f32 v126, v126, v139
    v_mul_f32 v127, v127, v147
    v_cvt_pk_bf16_f32 v139, v126, v127
ft_ws:
    buffer_load_dword v7, v6, s[4:7], s85 offen sc1
    s_waitcnt vmcnt(0)
    v_cmp_gt_u32 vcc, s87, v7
    s_cbranch_vccz ft_p
    s_sleep 12
    v_cmp_gt_u32 vcc, 59, v7
    s_cbranch_vccz ft_wsf
    s_sleep 64
    v_cmp_gt_u32 vcc, 56, v7
    s_cbranch_vccz ft_wsf
    s_sleep 127
    s_sleep 127
ft_wsf:
    s_sub_u32 s84, s84, 1
    s_cbranch_scc0 ft_ws
    s_mov_b32 s84, 0
ft_p:
    buffer_load_dword v7, v8, s[4:7], s79 offen offset:1008 sc1
    s_waitcnt vmcnt(0)
    v_cmp_eq_u32 vcc, -1, v7
    s_cbranch_vccz ft_l0
    s_sleep 4
    s_sub_u32 s84, s84, 1
    s_cbranch_scc0 ft_p
    s_mov_b32 s84, 0
ft_l0:
    s_cmp_lg_u32 s3, 0
    s_cbranch_scc1 clm_17
    v_mov_b32 v250, 1
    s_mov_b64 exec, 1
    buffer_atomic_add v250, off, s[64:67], s71 sc0 sc1
    s_mov_b64 exec, -1
clm_17:
ft_l:
    s_mov_b32 s86, s79
    buffer_load_dwordx4 v[16:19], v3, s[4:7], s86 offen sc1
    s_add_u32 s86, s86, 4194304
    buffer_load_dwordx4 v[20:23], v3, s[4:7], s86 offen sc1
    s_add_u32 s86, s86, 4194304
    buffer_load_dwordx4 v[24:27], v3, s[4:7], s86 offen sc1
    s_add_u32 s86, s86, 4194304
    buffer_load_dwordx4 v[28:31], v3, s[4:7], s86 offen sc1
    s_add_u32 s86, s86, 4194304
    buffer_load_dwordx4 v[32:35], v3, s[4:7], s86 offen sc1
    s_add_u32 s86, s86, 4194304
    buffer_load_dwordx4 v[36:39], v3, s[4:7], s86 offen sc1
    s_add_u32 s86, s86, 4194304
    buffer_load_dwordx4 v[40:43], v3, s[4:7], s86 offen sc1
    s_add_u32 s86, s86, 4194304
    buffer_load_dwordx4 v[44:47], v3, s[4:7], s86 offen sc1
    s_waitcnt vmcnt(0)
    v_max3_u32 v7, v16, v20, v24
    v_max3_u32 v7, v7, v28, v32
    v_max3_u32 v7, v7, v36, v40
    v_max_u32 v7, v7, v44
    v_cmp_eq_u32 vcc, -1, v7
    s_cbranch_vccz ft_go
    s_sleep 0
    s_sub_u32 s84, s84, 1
    s_cbranch_scc0 ft_l
ft_go:
    v_lshlrev_b32 v96, 16, v16
    v_and_b32 v97, 0xffff0000, v16
    v_lshlrev_b32 v98, 16, v17
    v_and_b32 v99, 0xffff0000, v17
    v_lshlrev_b32 v100, 16, v18
    v_and_b32 v101, 0xffff0000, v18
    v_lshlrev_b32 v102, 16, v19
    v_and_b32 v103, 0xffff0000, v19
    v_lshlrev_b32 v120, 16, v20
    v_and_b32 v121, 0xffff0000, v20
    v_lshlrev_b32 v122, 16, v21
    v_and_b32 v123, 0xffff0000, v21
    v_lshlrev_b32 v124, 16, v22
    v_and_b32 v125, 0xffff0000, v22
    v_lshlrev_b32 v126, 16, v23
    v_and_b32 v127, 0xffff0000, v23
    v_add_f32 v96, v96, v120
    v_add_f32 v97, v97, v121
    v_add_f32 v98, v98, v122
    v_add_f32 v99, v99, v123
    v_add_f32 v100, v100, v124
    v_add_f32 v101, v101, v125
    v_add_f32 v102, v102, v126
    v_add_f32 v103, v103, v127
    v_lshlrev_b32 v120, 16, v24
    v_and_b32 v121, 0xffff0000, v24
    v_lshlrev_b32 v122, 16, v25
    v_and_b32 v123, 0xffff0000, v25
    v_lshlrev_b32 v124, 16, v26
    v_and_b32 v125, 0xffff0000, v26
    v_lshlrev_b32 v126, 16, v27
    v_and_b32 v127, 0xffff0000, v27
    v_add_f32 v96, v96, v120
    v_add_f32 v97, v97, v121
    v_add_f32 v98, v98, v122
    v_add_f32 v99, v99, v123
    v_add_f32 v100, v100, v124
    v_add_f32 v101, v101, v125
    v_add_f32 v102, v102, v126
    v_add_f32 v103, v103, v127
    v_lshlrev_b32 v120, 16, v28
    v_and_b32 v121, 0xffff0000, v28
    v_lshlrev_b32 v122, 16, v29
    v_and_b32 v123, 0xffff0000, v29
    v_lshlrev_b32 v124, 16, v30
    v_and_b32 v125, 0xffff0000, v30
    v_lshlrev_b32 v126, 16, v31
    v_and_b32 v127, 0xffff0000, v31
    v_add_f32 v96, v96, v120
    v_add_f32 v97, v97, v121
    v_add_f32 v98, v98, v122
    v_add_f32 v99, v99, v123
    v_add_f32 v100, v100, v124
    v_add_f32 v101, v101, v125
    v_add_f32 v102, v102, v126
    v_add_f32 v103, v103, v127
    v_lshlrev_b32 v120, 16, v32
    v_and_b32 v121, 0xffff0000, v32
    v_lshlrev_b32 v122, 16, v33
    v_and_b32 v123, 0xffff0000, v33
    v_lshlrev_b32 v124, 16, v34
    v_and_b32 v125, 0xffff0000, v34
    v_lshlrev_b32 v126, 16, v35
    v_and_b32 v127, 0xffff0000, v35
    v_add_f32 v96, v96, v120
    v_add_f32 v97, v97, v121
    v_add_f32 v98, v98, v122
    v_add_f32 v99, v99, v123
    v_add_f32 v100, v100, v124
    v_add_f32 v101, v101, v125
    v_add_f32 v102, v102, v126
    v_add_f32 v103, v103, v127
    v_lshlrev_b32 v120, 16, v36
    v_and_b32 v121, 0xffff0000, v36
    v_lshlrev_b32 v122, 16, v37
    v_and_b32 v123, 0xffff0000, v37
    v_lshlrev_b32 v124, 16, v38
    v_and_b32 v125, 0xffff0000, v38
    v_lshlrev_b32 v126, 16, v39
    v_and_b32 v127, 0xffff0000, v39
    v_add_f32 v96, v96, v120
    v_add_f32 v97, v97, v121
    v_add_f32 v98, v98, v122
    v_add_f32 v99, v99, v123
    v_add_f32 v100, v100, v124
    v_add_f32 v101, v101, v125
    v_add_f32 v102, v102, v126
    v_add_f32 v103, v103, v127
    v_lshlrev_b32 v120, 16, v40
    v_and_b32 v121, 0xffff0000, v40
    v_lshlrev_b32 v122, 16, v41
    v_and_b32 v123, 0xffff0000, v41
    v_lshlrev_b32 v124, 16, v42
    v_and_b32 v125, 0xffff0000, v42
    v_lshlrev_b32 v126, 16, v43
    v_and_b32 v127, 0xffff0000, v43
    v_add_f32 v96, v96, v120
    v_add_f32 v97, v97, v121
    v_add_f32 v98, v98, v122
    v_add_f32 v99, v99, v123
    v_add_f32 v100, v100, v124
    v_add_f32 v101, v101, v125
    v_add_f32 v102, v102, v126
    v_add_f32 v103, v103, v127
    v_lshlrev_b32 v120, 16, v44
    v_and_b32 v121, 0xffff0000, v44
    v_lshlrev_b32 v122, 16, v45
    v_and_b32 v123, 0xffff0000, v45
    v_lshlrev_b32 v124, 16, v46
    v_and_b32 v125, 0xffff0000, v46
    v_lshlrev_b32 v126, 16, v47
    v_and_b32 v127, 0xffff0000, v47
    v_add_f32 v96, v96, v120
    v_add_f32 v97, v97, v121
    v_add_f32 v98, v98, v122
    v_add_f32 v99, v99, v123
    v_add_f32 v100, v100, v124
    v_add_f32 v101, v101, v125
    v_add_f32 v102, v102, v126
    v_add_f32 v103, v103, v127
    v_cndmask_b32 v108, v88, v90, s[76:77]
    v_cndmask_b32 v109, v89, v91, s[76:77]
    v_cndmask_b32 v110, v90, v88, s[76:77]
    v_cndmask_b32 v111, v91, v89, s[76:77]
    v_cvt_pk_bf16_f32 v104, v96, v97
    v_lshlrev_b32 v96, 16, v104
    v_and_b32 v97, 0xffff0000, v104
    v_lshlrev_b32 v104, 16, v136
    v_and_b32 v105, 0xffff0000, v136
    v_mul_f32 v96, v96, v104
    v_mul_f32 v97, v97, v105
    v_cvt_pk_bf16_f32 v104, v96, v97
    v_lshlrev_b32 v96, 16, v104
    v_and_b32 v97, 0xffff0000, v104
    v_lshlrev_b32 v104, 16, v108
    v_and_b32 v105, 0xffff0000, v108
    v_add_f32 v96, v96, v104
    v_add_f32 v97, v97, v105
    v_cvt_pk_bf16_f32 v112, v96, v97
    v_cvt_pk_bf16_f32 v104, v98, v99
    v_lshlrev_b32 v98, 16, v104
    v_and_b32 v99, 0xffff0000, v104
    v_lshlrev_b32 v104, 16, v137
    v_and_b32 v105, 0xffff0000, v137
    v_mul_f32 v98, v98, v104
    v_mul_f32 v99, v99, v105
    v_cvt_pk_bf16_f32 v104, v98, v99
    v_lshlrev_b32 v98, 16, v104
    v_and_b32 v99, 0xffff0000, v104
    v_lshlrev_b32 v104, 16, v109
    v_and_b32 v105, 0xffff0000, v109
    v_add_f32 v98, v98, v104
    v_add_f32 v99, v99, v105
    v_cvt_pk_bf16_f32 v113, v98, v99
    v_cvt_pk_bf16_f32 v104, v100, v101
    v_lshlrev_b32 v100, 16, v104
    v_and_b32 v101, 0xffff0000, v104
    v_lshlrev_b32 v104, 16, v138
    v_and_b32 v105, 0xffff0000, v138
    v_mul_f32 v100, v100, v104
    v_mul_f32 v101, v101, v105
    v_cvt_pk_bf16_f32 v104, v100, v101
    v_lshlrev_b32 v100, 16, v104
    v_and_b32 v101, 0xffff0000, v104
    v_lshlrev_b32 v104, 16, v110
    v_and_b32 v105, 0xffff0000, v110
    v_add_f32 v100, v100, v104
    v_add_f32 v101, v101, v105
    v_cvt_pk_bf16_f32 v114, v100, v101
    v_cvt_pk_bf16_f32 v104, v102, v103
    v_lshlrev_b32 v102, 16, v104
    v_and_b32 v103, 0xffff0000, v104
    v_lshlrev_b32 v104, 16, v139
    v_and_b32 v105, 0xffff0000, v139
    v_mul_f32 v102, v102, v104
    v_mul_f32 v103, v103, v105
    v_cvt_pk_bf16_f32 v104, v102, v103
    v_lshlrev_b32 v102, 16, v104
    v_and_b32 v103, 0xffff0000, v104
    v_lshlrev_b32 v104, 16, v111
    v_and_b32 v105, 0xffff0000, v111
    v_add_f32 v102, v102, v104
    v_add_f32 v103, v103, v105
    v_cvt_pk_bf16_f32 v115, v102, v103
    v_cndmask_b32 v128, v112, v114, s[76:77]
    v_cndmask_b32 v129, v113, v115, s[76:77]
    v_cndmask_b32 v130, v114, v112, s[76:77]
    v_cndmask_b32 v131, v115, v113, s[76:77]
    buffer_store_dwordx4 v[128:131], v4, s[12:15], s74 offen offset:0
    s_branch w_fin_done
w_fin_done:
    s_cmp_lg_u32 s3, 0
    s_cbranch_scc1 pub_18
    v_mov_b32 v20, 131136
    s_mov_b64 exec, 1
    ds_write_b32 v20, v250
    s_mov_b64 exec, -1
    s_waitcnt lgkmcnt(0)
pub_18:
    s_barrier
    v_mov_b32 v20, 131136
    ds_read_b32 v20, v20
    s_waitcnt lgkmcnt(0)
    v_readfirstlane_b32 s59, v20
    s_add_u32 s59, s59, 32
    s_min_u32 s59, s59, 322
    s_lshl_b32 s57, s59, 6
    s_load_dwordx16 s[32:47], s[24:25], s57
    s_waitcnt lgkmcnt(0)
    s_barrier
    s_sub_u32 s57, s32, 1
    s_cmp_ge_u32 s57, 5
    s_cbranch_scc1 w_cold
    v_and_b32 v20, 63, v0
    v_lshlrev_b32 v1, 4, v20
    v_add_u32 v19, 0x1000, v1
    v_lshrrev_b32 v4, 4, v20
    v_mov_b32 v17, 0
    v_mov_b32 v18, 1
    s_lshr_b32 s26, s3, 2
    s_and_b32 s27, s3, 3
    s_lshl_b32 s21, s3, 11
    s_lshl_b32 s22, s3, 10
    s_add_u32 s22, s22, 16384
    s_mov_b32 s11, 131072
    s_mov_b32 s15, 131072
    s_mov_b32 s28, 0
    v_and_b32 v21, 15, v20
    v_lshlrev_b32 v22, 2, v4
    v_xor_b32 v21, v21, v22
    s_lshr_b32 s30, s3, 1
    s_and_b32 s30, s30, 1
    v_xor_b32 v21, s30, v21
    v_lshlrev_b32 v3, 4, v21
    s_lshl_b32 s30, s26, 13
    v_add_u32 v5, s30, v1
    v_add_u32 v6, 0x10000, v5
    v_bfe_u32 v21, v20, 2, 2
    v_and_b32 v22, 3, v20
    v_and_b32 v23, 1, v4
    v_xor_b32 v24, s27, v21
    v_xor_b32 v25, v22, v23
    v_lshl_add_u32 v24, v24, 2, v25
    v_lshlrev_b32 v24, 4, v24
    v_lshl_add_u32 v25, v4, 3, v21
    v_lshl_add_u32 v24, v25, 8, v24
    v_and_b32 v22, 1, v22
    v_xor_b32 v25, 0, v23
    v_lshl_add_u32 v8, v25, 10, v24
    v_xor_b32 v25, 0, v22
    v_lshl_add_u32 v8, v25, 3, v8
    v_add_u32 v12, 0x10000, v8
    v_xor_b32 v25, 1, v23
    v_lshl_add_u32 v9, v25, 10, v24
    v_xor_b32 v25, 0, v22
    v_lshl_add_u32 v9, v25, 3, v9
    v_add_u32 v13, 0x10000, v9
    v_xor_b32 v25, 0, v23
    v_lshl_add_u32 v10, v25, 10, v24
    v_xor_b32 v25, 1, v22
    v_lshl_add_u32 v10, v25, 3, v10
    v_add_u32 v14, 0x10000, v10
    v_xor_b32 v25, 1, v23
    v_lshl_add_u32 v11, v25, 10, v24
    v_xor_b32 v25, 1, v22
    v_lshl_add_u32 v11, v25, 3, v11
    v_add_u32 v15, 0x10000, v11
    s_lshl_b32 s30, s3, 2
    s_add_u32 s30, s30, 131072
    v_mov_b32 v7, s30
    s_branch w_cold
chain_map:
    s_lshl_b32 s52, s12, 5
    s_add_u32 s52, s52, s13
    s_lshr_b32 s15, s52, 2
    s_lshr_b32 s14, s52, 4
    s_and_b32 s34, s13, 15
    s_and_b32 s53, s13, 3
    s_mov_b32 s16, 0
    s_mov_b32 s22, 131072
    s_mov_b32 s100, 131072
    s_getreg_b32 s40, hwreg(HW_REG_XCC_ID)
    s_and_b32 s40, s40, 15
    s_mul_i32 s19, s40, s40
    s_lshl_b32 s19, s19, 18
    s_lshl_b32 s40, s40, 8
    s_add_u32 s40, s40, s19
    s_add_u32 s40, s40, 1
    s_lshl_b32 s35, s14, 4
    s_add_u32 s35, s35, 218104320
    s_and_b32 s21, s3, 3
    s_mul_i32 s42, s21, 24576
    s_add_u32 s42, s42, 65536
    s_lshl_b32 s41, s14, 2
    s_add_u32 s41, s41, s21
    s_lshl_b32 s41, s41, 12
    s_add_u32 s101, s42, 8192
    s_bfe_u32 s17, s34, 0x20001
    s_cmp_eq_u32 s17, s21
    s_cselect_b32 s68, 20480, s42
    s_xor_b32 s68, s68, s101
    s_lshl_b32 s43, s21, 13
    s_add_u32 s43, s43, 138412032
    s_lshl_b32 s69, s21, 24
    s_lshl_b32 s17, s52, 10
    s_add_u32 s69, s69, s17
    s_add_u32 s69, s69, 20971520
    s_cmp_ge_u32 s3, 4
    s_cbranch_scc1 ch_a_pro
    s_add_u32 s41, s41, 262144
    s_lshl_b32 s38, s15, 13
    s_add_u32 s38, s38, 214958080
    s_lshl_b32 s17, s13, 1
    s_and_b32 s18, s3, 1
    s_add_u32 s17, s17, s18
    s_lshl_b32 s17, s17, 1
    s_cmp_lt_u32 s3, 2
    s_cselect_b32 s56, 0xffff, 0
    s_mov_b32 s57, 0
    s_lshr_b32 s18, s17, 1
    s_and_b32 s19, s17, 1
    s_lshl_b32 s20, s12, 14
    s_add_u32 s20, s20, 213909504
    s_lshl_b32 s36, s3, 12
    s_add_u32 s36, s36, s20
    s_lshl_b32 s37, s18, 8
    s_add_u32 s37, s37, s20
    s_lshl_b32 s20, s19, 5
    s_add_u32 s37, s37, s20
    s_lshr_b32 s39, s17, 3
    s_lshl_b32 s39, s39, 14
    s_and_b32 s20, s17, 7
    s_lshl_b32 s20, s20, 10
    s_add_u32 s39, s39, s20
    s_add_u32 s39, s39, 209715200
    s_lshl_b32 s30, s14, 22
    s_lshl_b32 s20, s34, 11
    s_add_u32 s30, s30, s20
    s_lshl_b32 s20, s3, 9
    s_add_u32 s30, s30, s20
    s_add_u32 s30, s30, 78643200
    s_lshl_b32 s55, s15, 13
    s_add_u32 s55, s55, 192937984
    s_mov_b32 s26, s38
    s_mov_b32 s54, s30
    s_mov_b32 s29, 2
    s_mov_b32 s58, 0
    s_mov_b32 s59, 0
    s_bfe_u32 s17, s34, 0x20001
    s_lshl_b32 s60, s14, 2
    s_add_u32 s60, s60, s17
    s_lshl_b32 s60, s60, 2
    s_add_u32 s60, s60, s3
    s_lshl_b32 s60, s60, 10
    s_and_b32 s17, s34, 1
    s_lshl_b32 s17, s17, 17
    s_add_u32 s60, s60, s17
    s_add_u32 s60, s60, 175898624
    s_mov_b32 s31, 786432
    v_and_b32 v20, 63, v0
    v_lshlrev_b32 v1, 4, v20
    v_mov_b32 v10, -1
    v_mov_b32 v11, -1
    v_lshrrev_b32 v21, 2, v20
    v_and_b32 v22, 3, v20
    v_lshlrev_b32 v21, 13, v21
    v_lshl_add_u32 v21, v22, 4, v21
    s_lshl_b32 s17, s3, 21
    s_lshl_b32 s18, s52, 6
    s_add_u32 s17, s17, s18
    s_lshl_b32 s19, s3, 15
    s_mov_b32 s10, 8388608
    s_mov_b32 s11, 131072
    v_lshrrev_b32 v24, 5, v20
    v_bfe_u32 v25, v20, 3, 1
    v_lshl_add_u32 v24, v24, 1, v25
    v_bfe_u32 v26, v20, 4, 1
    v_xor_b32 v26, v26, v25
    v_lshl_add_u32 v24, v24, 1, v26
    v_bfe_u32 v25, v20, 2, 1
    v_lshl_add_u32 v24, v24, 2, v25
    v_lshlrev_b32 v24, 6, v24
    v_lshl_add_u32 v24, v22, 3, v24
    v_add_u32 v24, s19, v24
    s_and_b32 s70, s13, 0
    s_lshl_b32 s72, s70, 20
    s_lshl_b32 s73, s70, 21
    s_lshl_b32 s70, s70, 13
    s_sub_u32 s71, s19, s70
    s_add_u32 s70, s19, s70
    s_load_dwordx2 s[8:9], s[0:1], 16
    s_add_u32 s20, s17, s72
    s_waitcnt lgkmcnt(0)
    s_add_u32 m0, s70, 0
    s_nop 0
    buffer_load_dwordx4 v21, s[8:11], s20 offen lds
    s_add_u32 s20, s20, 131072
    s_add_u32 m0, s70, 1024
    s_nop 0
    buffer_load_dwordx4 v21, s[8:11], s20 offen lds
    s_add_u32 s20, s20, 131072
    s_barrier
    v_mov_b32 v27, 131136
    ds_read_b32 v27, v27
    s_mov_b32 s96, s97
    s_waitcnt lgkmcnt(0)
    v_readfirstlane_b32 s97, v27
    s_cmp_lg_u32 s96, s97
    s_cbranch_scc1 k_restart
    s_add_u32 m0, s70, 2048
    s_nop 0
    buffer_load_dwordx4 v21, s[8:11], s20 offen lds
    s_add_u32 s20, s20, 131072
    s_add_u32 m0, s70, 3072
    s_nop 0
    buffer_load_dwordx4 v21, s[8:11], s20 offen lds
    s_add_u32 s20, s20, 131072
    s_add_u32 m0, s70, 4096
    s_nop 0
    buffer_load_dwordx4 v21, s[8:11], s20 offen lds
    s_add_u32 s20, s20, 131072
    s_add_u32 m0, s70, 5120
    s_nop 0
    buffer_load_dwordx4 v21, s[8:11], s20 offen lds
    s_add_u32 s20, s20, 131072
    s_add_u32 m0, s70, 6144
    s_nop 0
    buffer_load_dwordx4 v21, s[8:11], s20 offen lds
    s_add_u32 s20, s20, 131072
    s_add_u32 m0, s70, 7168
    s_nop 0
    buffer_load_dwordx4 v21, s[8:11], s20 offen lds
    s_add_u32 s20, s20, 131072
    s_sub_u32 s20, s20, s73
    s_add_u32 m0, s71, 8192
    s_nop 0
    buffer_load_dwordx4 v21, s[8:11], s20 offen lds
    s_add_u32 s20, s20, 131072
    s_add_u32 m0, s71, 9216
    s_nop 0
    buffer_load_dwordx4 v21, s[8:11], s20 offen lds
    s_add_u32 s20, s20, 131072
    s_add_u32 m0, s71, 10240
    s_nop 0
    buffer_load_dwordx4 v21, s[8:11], s20 offen lds
    s_add_u32 s20, s20, 131072
    s_add_u32 m0, s71, 11264
    s_nop 0
    buffer_load_dwordx4 v21, s[8:11], s20 offen lds
    s_add_u32 s20, s20, 131072
    s_add_u32 m0, s71, 12288
    s_nop 0
    buffer_load_dwordx4 v21, s[8:11], s20 offen lds
    s_add_u32 s20, s20, 131072
    s_add_u32 m0, s71, 13312
    s_nop 0
    buffer_load_dwordx4 v21, s[8:11], s20 offen lds
    s_add_u32 s20, s20, 131072
    s_add_u32 m0, s71, 14336
    s_nop 0
    buffer_load_dwordx4 v21, s[8:11], s20 offen lds
    s_add_u32 s20, s20, 131072
    s_add_u32 m0, s71, 15360
    s_nop 0
    buffer_load_dwordx4 v21, s[8:11], s20 offen lds
    s_add_u32 s20, s20, 131072
    s_load_dwordx2 s[8:9], s[0:1], 24
    s_add_u32 s20, s17, s72
    s_waitcnt lgkmcnt(0)
    s_add_u32 m0, s70, 16384
    s_nop 0
    buffer_load_dwordx4 v21, s[8:11], s20 offen lds
    s_add_u32 s20, s20, 131072
    s_add_u32 m0, s70, 17408
    s_nop 0
    buffer_load_dwordx4 v21, s[8:11], s20 offen lds
    s_add_u32 s20, s20, 131072
    s_add_u32 m0, s70, 18432
    s_nop 0
    buffer_load_dwordx4 v21, s[8:11], s20 offen lds
    s_add_u32 s20, s20, 131072
    s_add_u32 m0, s70, 19456
    s_nop 0
    buffer_load_dwordx4 v21, s[8:11], s20 offen lds
    s_add_u32 s20, s20, 131072
    s_add_u32 m0, s70, 20480
    s_nop 0
    buffer_load_dwordx4 v21, s[8:11], s20 offen lds
    s_add_u32 s20, s20, 131072
    s_add_u32 m0, s70, 21504
    s_nop 0
    buffer_load_dwordx4 v21, s[8:11], s20 offen lds
    s_add_u32 s20, s20, 131072
    s_add_u32 m0, s70, 22528
    s_nop 0
    buffer_load_dwordx4 v21, s[8:11], s20 offen lds
    s_add_u32 s20, s20, 131072
    s_add_u32 m0, s70, 23552
    s_nop 0
    buffer_load_dwordx4 v21, s[8:11], s20 offen lds
    s_add_u32 s20, s20, 131072
    s_sub_u32 s20, s20, s73
    s_add_u32 m0, s71, 24576
    s_nop 0
    buffer_load_dwordx4 v21, s[8:11], s20 offen lds
    s_add_u32 s20, s20, 131072
    s_add_u32 m0, s71, 25600
    s_nop 0
    buffer_load_dwordx4 v21, s[8:11], s20 offen lds
    s_add_u32 s20, s20, 131072
    s_add_u32 m0, s71, 26624
    s_nop 0
    buffer_load_dwordx4 v21, s[8:11], s20 offen lds
    s_add_u32 s20, s20, 131072
    s_add_u32 m0, s71, 27648
    s_nop 0
    buffer_load_dwordx4 v21, s[8:11], s20 offen lds
    s_add_u32 s20, s20, 131072
    s_add_u32 m0, s71, 28672
    s_nop 0
    buffer_load_dwordx4 v21, s[8:11], s20 offen lds
    s_add_u32 s20, s20, 131072
    s_add_u32 m0, s71, 29696
    s_nop 0
    buffer_load_dwordx4 v21, s[8:11], s20 offen lds
    s_add_u32 s20, s20, 131072
    s_add_u32 m0, s71, 30720
    s_nop 0
    buffer_load_dwordx4 v21, s[8:11], s20 offen lds
    s_add_u32 s20, s20, 131072
    s_add_u32 m0, s71, 31744
    s_nop 0
    buffer_load_dwordx4 v21, s[8:11], s20 offen lds
    s_add_u32 s20, s20, 131072
    s_load_dwordx2 s[8:9], s[0:1], 32
    s_add_u32 s20, s17, s72
    s_waitcnt lgkmcnt(0)
    buffer_load_dwordx4 v[96:99], v21, s[8:11], s20 offen
    s_add_u32 s20, s20, 131072
    buffer_load_dwordx4 v[100:103], v21, s[8:11], s20 offen
    s_add_u32 s20, s20, 131072
    buffer_load_dwordx4 v[104:107], v21, s[8:11], s20 offen
    s_add_u32 s20, s20, 131072
    buffer_load_dwordx4 v[108:111], v21, s[8:11], s20 offen
    s_add_u32 s20, s20, 131072
    buffer_load_dwordx4 v[144:147], v21, s[8:11], s20 offen
    s_add_u32 s20, s20, 131072
    buffer_load_dwordx4 v[148:151], v21, s[8:11], s20 offen
    s_add_u32 s20, s20, 131072
    buffer_load_dwordx4 v[152:155], v21, s[8:11], s20 offen
    s_add_u32 s20, s20, 131072
    buffer_load_dwordx4 v[156:159], v21, s[8:11], s20 offen
    s_add_u32 s20, s20, 131072
    s_sub_u32 s20, s20, s73
    buffer_load_dwordx4 v[192:195], v21, s[8:11], s20 offen
    s_add_u32 s20, s20, 131072
    buffer_load_dwordx4 v[196:199], v21, s[8:11], s20 offen
    s_add_u32 s20, s20, 131072
    buffer_load_dwordx4 v[200:203], v21, s[8:11], s20 offen
    s_add_u32 s20, s20, 131072
    buffer_load_dwordx4 v[204:207], v21, s[8:11], s20 offen
    s_add_u32 s20, s20, 131072
    buffer_load_dwordx4 v[240:243], v21, s[8:11], s20 offen
    s_add_u32 s20, s20, 131072
    buffer_load_dwordx4 v[244:247], v21, s[8:11], s20 offen
    s_add_u32 s20, s20, 131072
    buffer_load_dwordx4 v[248:251], v21, s[8:11], s20 offen
    s_add_u32 s20, s20, 131072
    buffer_load_dwordx4 v[252:255], v21, s[8:11], s20 offen
    s_add_u32 s20, s20, 131072
    s_load_dwordx2 s[8:9], s[0:1], 8
    s_mov_b32 s10, 16384
    v_bfe_u32 v57, v20, 2, 2
    v_and_b32 v58, 1, v20
    v_lshl_add_u32 v57, v57, 1, v58
    v_lshlrev_b32 v57, 11, v57
    v_lshrrev_b32 v58, 4, v20
    v_lshl_add_u32 v57, v58, 5, v57
    v_bfe_u32 v58, v20, 1, 1
    v_lshl_add_u32 v57, v58, 4, v57
    v_lshl_add_u32 v59, v58, 3, v57
    v_xor_b32 v60, 8, v59
    s_lshl_b32 s20, s3, 9
    s_waitcnt lgkmcnt(0)
    buffer_load_dwordx2 v[32:33], v59, s[8:11], s20 offen offset:0
    buffer_load_dwordx2 v[34:35], v60, s[8:11], s20 offen offset:0
    buffer_load_dwordx2 v[36:37], v59, s[8:11], s20 offen offset:128
    buffer_load_dwordx2 v[38:39], v60, s[8:11], s20 offen offset:128
    buffer_load_dwordx2 v[40:41], v59, s[8:11], s20 offen offset:256
    buffer_load_dwordx2 v[42:43], v60, s[8:11], s20 offen offset:256
    buffer_load_dwordx2 v[44:45], v59, s[8:11], s20 offen offset:384
    buffer_load_dwordx2 v[46:47], v60, s[8:11], s20 offen offset:384
    s_barrier
    v_add_u32 v56, s70, v1
    v_add_u32 v26, s71, v1
    s_waitcnt vmcnt(40)
    ds_read_b64_tr_b16 v[64:65], v24 offset:0
    ds_read_b64_tr_b16 v[66:67], v24 offset:128
    ds_read_b64_tr_b16 v[68:69], v24 offset:2048
    ds_read_b64_tr_b16 v[70:71], v24 offset:2176
    ds_read_b64_tr_b16 v[72:73], v24 offset:32
    ds_read_b64_tr_b16 v[74:75], v24 offset:160
    ds_read_b64_tr_b16 v[76:77], v24 offset:2080
    ds_read_b64_tr_b16 v[78:79], v24 offset:2208
    s_waitcnt lgkmcnt(0)
    ds_read_b64_tr_b16 v[112:113], v24 offset:4096
    ds_read_b64_tr_b16 v[114:115], v24 offset:4224
    ds_read_b64_tr_b16 v[116:117], v24 offset:6144
    ds_read_b64_tr_b16 v[118:119], v24 offset:6272
    ds_read_b64_tr_b16 v[120:121], v24 offset:4128
    ds_read_b64_tr_b16 v[122:123], v24 offset:4256
    ds_read_b64_tr_b16 v[124:125], v24 offset:6176
    ds_read_b64_tr_b16 v[126:127], v24 offset:6304
    s_waitcnt lgkmcnt(0)
    ds_read_b64_tr_b16 v[160:161], v24 offset:8192
    ds_read_b64_tr_b16 v[162:163], v24 offset:8320
    ds_read_b64_tr_b16 v[164:165], v24 offset:10240
    ds_read_b64_tr_b16 v[166:167], v24 offset:10368
    ds_read_b64_tr_b16 v[168:169], v24 offset:8224
    ds_read_b64_tr_b16 v[170:171], v24 offset:8352
    ds_read_b64_tr_b16 v[172:173], v24 offset:10272
    ds_read_b64_tr_b16 v[174:175], v24 offset:10400
    s_waitcnt lgkmcnt(0)
    ds_read_b64_tr_b16 v[208:209], v24 offset:12288
    ds_read_b64_tr_b16 v[210:211], v24 offset:12416
    ds_read_b64_tr_b16 v[212:213], v24 offset:14336
    ds_read_b64_tr_b16 v[214:215], v24 offset:14464
    ds_read_b64_tr_b16 v[216:217], v24 offset:12320
    ds_read_b64_tr_b16 v[218:219], v24 offset:12448
    ds_read_b64_tr_b16 v[220:221], v24 offset:14368
    ds_read_b64_tr_b16 v[222:223], v24 offset:14496
    s_waitcnt lgkmcnt(0)
    s_waitcnt vmcnt(24)
    ds_read_b64_tr_b16 v[80:81], v24 offset:16384
    ds_read_b64_tr_b16 v[82:83], v24 offset:16512
    ds_read_b64_tr_b16 v[84:85], v24 offset:18432
    ds_read_b64_tr_b16 v[86:87], v24 offset:18560
    ds_read_b64_tr_b16 v[88:89], v24 offset:16416
    ds_read_b64_tr_b16 v[90:91], v24 offset:16544
    ds_read_b64_tr_b16 v[92:93], v24 offset:18464
    ds_read_b64_tr_b16 v[94:95], v24 offset:18592
    s_waitcnt lgkmcnt(0)
    ds_read_b64_tr_b16 v[128:129], v24 offset:20480
    ds_read_b64_tr_b16 v[130:131], v24 offset:20608
    ds_read_b64_tr_b16 v[132:133], v24 offset:22528
    ds_read_b64_tr_b16 v[134:135], v24 offset:22656
    ds_read_b64_tr_b16 v[136:137], v24 offset:20512
    ds_read_b64_tr_b16 v[138:139], v24 offset:20640
    ds_read_b64_tr_b16 v[140:141], v24 offset:22560
    ds_read_b64_tr_b16 v[142:143], v24 offset:22688
    s_waitcnt lgkmcnt(0)
    ds_read_b64_tr_b16 v[176:177], v24 offset:24576
    ds_read_b64_tr_b16 v[178:179], v24 offset:24704
    ds_read_b64_tr_b16 v[180:181], v24 offset:26624
    ds_read_b64_tr_b16 v[182:183], v24 offset:26752
    ds_read_b64_tr_b16 v[184:185], v24 offset:24608
    ds_read_b64_tr_b16 v[186:187], v24 offset:24736
    ds_read_b64_tr_b16 v[188:189], v24 offset:26656
    ds_read_b64_tr_b16 v[190:191], v24 offset:26784
    s_waitcnt lgkmcnt(0)
    ds_read_b64_tr_b16 v[224:225], v24 offset:28672
    ds_read_b64_tr_b16 v[226:227], v24 offset:28800
    ds_read_b64_tr_b16 v[228:229], v24 offset:30720
    ds_read_b64_tr_b16 v[230:231], v24 offset:30848
    ds_read_b64_tr_b16 v[232:233], v24 offset:28704
    ds_read_b64_tr_b16 v[234:235], v24 offset:28832
    ds_read_b64_tr_b16 v[236:237], v24 offset:30752
    ds_read_b64_tr_b16 v[238:239], v24 offset:30880
    s_waitcnt lgkmcnt(0)
    s_waitcnt vmcnt(8)
    ds_write_b128 v56, v[96:99] offset:0
    ds_write_b128 v56, v[100:103] offset:1024
    ds_write_b128 v56, v[104:107] offset:2048
    ds_write_b128 v56, v[108:111] offset:3072
    ds_write_b128 v56, v[144:147] offset:4096
    ds_write_b128 v56, v[148:151] offset:5120
    ds_write_b128 v56, v[152:155] offset:6144
    ds_write_b128 v56, v[156:159] offset:7168
    ds_write_b128 v26, v[192:195] offset:8192
    ds_write_b128 v26, v[196:199] offset:9216
    ds_write_b128 v26, v[200:203] offset:10240
    ds_write_b128 v26, v[204:207] offset:11264
    ds_write_b128 v26, v[240:243] offset:12288
    ds_write_b128 v26, v[244:247] offset:13312
    ds_write_b128 v26, v[248:251] offset:14336
    ds_write_b128 v26, v[252:255] offset:15360
    s_waitcnt lgkmcnt(0)
    ds_read_b64_tr_b16 v[96:97], v24 offset:0
    ds_read_b64_tr_b16 v[98:99], v24 offset:128
    ds_read_b64_tr_b16 v[100:101], v24 offset:2048
    ds_read_b64_tr_b16 v[102:103], v24 offset:2176
    ds_read_b64_tr_b16 v[104:105], v24 offset:32
    ds_read_b64_tr_b16 v[106:107], v24 offset:160
    ds_read_b64_tr_b16 v[108:109], v24 offset:2080
    ds_read_b64_tr_b16 v[110:111], v24 offset:2208
    s_waitcnt lgkmcnt(0)
    ds_read_b64_tr_b16 v[144:145], v24 offset:4096
    ds_read_b64_tr_b16 v[146:147], v24 offset:4224
    ds_read_b64_tr_b16 v[148:149], v24 offset:6144
    ds_read_b64_tr_b16 v[150:151], v24 offset:6272
    ds_read_b64_tr_b16 v[152:153], v24 offset:4128
    ds_read_b64_tr_b16 v[154:155], v24 offset:4256
    ds_read_b64_tr_b16 v[156:157], v24 offset:6176
    ds_read_b64_tr_b16 v[158:159], v24 offset:6304
    s_waitcnt lgkmcnt(0)
    ds_read_b64_tr_b16 v[192:193], v24 offset:8192
    ds_read_b64_tr_b16 v[194:195], v24 offset:8320
    ds_read_b64_tr_b16 v[196:197], v24 offset:10240
    ds_read_b64_tr_b16 v[198:199], v24 offset:10368
    ds_read_b64_tr_b16 v[200:201], v24 offset:8224
    ds_read_b64_tr_b16 v[202:203], v24 offset:8352
    ds_read_b64_tr_b16 v[204:205], v24 offset:10272
    ds_read_b64_tr_b16 v[206:207], v24 offset:10400
    s_waitcnt lgkmcnt(0)
    ds_read_b64_tr_b16 v[240:241], v24 offset:12288
    ds_read_b64_tr_b16 v[242:243], v24 offset:12416
    ds_read_b64_tr_b16 v[244:245], v24 offset:14336
    ds_read_b64_tr_b16 v[246:247], v24 offset:14464
    ds_read_b64_tr_b16 v[248:249], v24 offset:12320
    ds_read_b64_tr_b16 v[250:251], v24 offset:12448
    ds_read_b64_tr_b16 v[252:253], v24 offset:14368
    ds_read_b64_tr_b16 v[254:255], v24 offset:14496
    s_waitcnt lgkmcnt(0)
    v_mov_b32 v21, 0x44444444
    v_mov_b32 v22, 0xeeeeeeee
    v_and_b32 v23, 2, v20
    v_cmp_eq_u32 vcc, 0, v23
    s_nop 1
    v_cndmask_b32 v8, v22, v21, vcc
    v_bfe_u32 v21, v20, 2, 3
    v_lshrrev_b32 v22, 5, v20
    v_mul_u32_u24 v23, 160, v21
    v_mul_u32_u24 v24, 1280, v22
    v_add_u32 v23, v23, v24
    v_and_b32 v24, 3, v20
    v_lshl_add_u32 v27, v24, 4, v23
    v_lshrrev_b32 v23, 1, v21
    v_and_b32 v21, 1, v21
    v_lshl_add_u32 v21, v23, 2, v21
    v_xor_b32 v22, 1, v22
    v_lshl_add_u32 v21, v22, 1, v21
    v_bfe_u32 v22, v20, 1, 1
    v_lshl_add_u32 v21, v22, 4, v21
    v_xor_b32 v22, v20, v22
    v_and_b32 v22, 1, v22
    v_lshlrev_b32 v21, 4, v21
    v_lshl_add_u32 v25, v22, 3, v21
    v_lshrrev_b32 v21, 3, v20
    v_mul_u32_u24 v23, 160, v21
    v_and_b32 v24, 7, v20
    v_lshl_add_u32 v28, v24, 4, v23
    v_lshrrev_b32 v23, 1, v21
    v_and_b32 v21, 1, v21
    v_lshl_add_u32 v21, v23, 2, v21
    v_and_b32 v22, 1, v20
    v_lshl_add_u32 v21, v22, 1, v21
    v_bfe_u32 v22, v20, 2, 1
    v_lshl_add_u32 v21, v22, 4, v21
    v_bfe_u32 v22, v20, 1, 1
    v_lshlrev_b32 v21, 4, v21
    v_lshl_add_u32 v26, v22, 3, v21
    s_lshl_b32 s17, s53, 10
    s_lshl_b32 s18, s3, 9
    s_add_u32 s17, s17, s18
    s_lshl_b32 s18, s3, 6
    s_lshl_b32 s19, s53, 9
    s_add_u32 s19, s19, 4096
    s_cmp_ge_u32 s3, 2
    s_cselect_b32 s17, s19, s17
    s_cselect_b32 s18, 2560, s18
    s_cselect_b64 vcc, -1, 0
    v_cndmask_b32 v22, v25, v26, vcc
    v_cndmask_b32 v23, v27, v28, vcc
    v_add_u32 v2, s17, v22
    v_add_u32 v4, s18, v23
    v_lshrrev_b32 v21, 4, v20
    v_and_b32 v22, 15, v20
    v_mul_u32_u24 v23, 320, v21
    v_lshl_add_u32 v23, v22, 2, v23
    s_mul_i32 s17, s3, 3840
    v_add_u32 v3, s17, v23
    v_add_u32 v61, 1280, v3
    v_bfe_u32 v24, v20, 3, 1
    v_bfe_u32 v25, v20, 2, 1
    v_xor_b32 v25, v25, v24
    v_bfe_u32 v26, v20, 1, 1
    v_lshl_add_u32 v25, v26, 1, v25
    v_lshl_add_u32 v25, v24, 2, v25
    v_and_b32 v26, 1, v20
    v_lshl_add_u32 v25, v25, 1, v26
    v_sub_u32 v25, v25, v22
    v_lshl_add_u32 v25, v25, 2, v3
    v_add_u32 v62, 2560, v25
    v_lshlrev_b32 v23, 4, v22
    v_lshl_add_u32 v6, v21, 12, v23
    s_lshl_b32 s17, s3, 10
    s_add_u32 s17, s17, 32768
    v_add_u32 v6, s17, v6
    v_lshrrev_b32 v24, 1, v21
    v_lshl_add_u32 v23, v24, 15, v23
    v_and_b32 v24, 1, v21
    v_lshl_add_u32 v7, v24, 8, v23
    v_mov_b32 v58, 15872
    v_bfe_u32 v23, v20, 1, 2
    v_lshlrev_b32 v23, 6, v23
    v_and_b32 v25, 1, v20
    v_lshl_add_u32 v23, v25, 4, v23
    v_bfe_u32 v24, v20, 3, 1
    v_lshl_add_u32 v5, v24, 5, v23
    v_and_b32 v23, 7, v20
    v_lshlrev_b32 v23, 7, v23
    v_bfe_u32 v24, v20, 3, 1
    v_lshl_add_u32 v23, v24, 17, v23
    v_lshrrev_b32 v24, 4, v20
    v_add_u32 v24, 1, v24
    v_cmp_le_u32 vcc, 3, v24
    s_nop 1
    v_cndmask_b32 v24, v24, 0, vcc
    v_lshl_add_u32 v23, v24, 24, v23
    s_lshl_b32 s17, s14, 14
    s_lshl_b32 s18, s34, 10
    s_add_u32 s17, s17, s18
    s_add_u32 s17, s17, 4194304
    v_add_u32 v0, s17, v23
    s_lshl_b32 s17, s3, 2
    s_add_u32 s17, s17, 15872
    v_mov_b32 v63, s17
    v_and_b32 v21, 15, v20
    v_and_b32 v22, 1, v21
    v_lshlrev_b32 v22, 4, v22
    v_mov_b32 v12, 0x3f80
    v_lshlrev_b32 v22, v22, v12
    v_lshrrev_b32 v21, 1, v21
    v_cmp_eq_u32 vcc, 0, v21
    s_nop 1
    v_cndmask_b32 v12, 0, v22, vcc
    v_cmp_eq_u32 vcc, 1, v21
    s_nop 1
    v_cndmask_b32 v13, 0, v22, vcc
    v_cmp_eq_u32 vcc, 2, v21
    s_nop 1
    v_cndmask_b32 v14, 0, v22, vcc
    v_cmp_eq_u32 vcc, 3, v21
    s_nop 1
    v_cndmask_b32 v15, 0, v22, vcc
    s_waitcnt vmcnt(0)
    v_mov_b32 v16, v32
    v_mov_b32 v17, v33
    v_mov_b32 v18, v34
    v_mov_b32 v19, v35
    v_mov_b32 v20, v36
    v_mov_b32 v21, v37
    v_mov_b32 v22, v38
    v_mov_b32 v23, v39
    v_mov_b32 v24, v40
    v_mov_b32 v25, v41
    v_mov_b32 v26, v42
    v_mov_b32 v27, v43
    v_mov_b32 v28, v44
    v_mov_b32 v29, v45
    v_mov_b32 v30, v46
    v_mov_b32 v31, v47
    v_mov_b32 v52, -1
    v_mov_b32 v53, -1
    v_mov_b32 v54, -1
    v_mov_b32 v55, -1
    s_add_u32 s17, s30, 786432
    buffer_store_dwordx4 v[52:55], v7, s[4:7], s17 offen sc1
    s_add_u32 s17, s30, 851968
    buffer_store_dwordx4 v[52:55], v7, s[4:7], s17 offen sc1
    s_add_u32 s17, s30, 917504
    buffer_store_dwordx4 v[52:55], v7, s[4:7], s17 offen sc1
    s_add_u32 s17, s30, 983040
    buffer_store_dwordx4 v[52:55], v7, s[4:7], s17 offen sc1
    s_lshl_b32 s40, s40, 5
    s_barrier
    ds_write_b32 v63, v10
    ds_write_b32 v63, v10 offset:16
    ds_write_b32 v63, v10 offset:32
    ds_write_b32 v63, v10 offset:48
    v_mov_b32 v60, 12
    v_mov_b32 v56, 15968
    s_waitcnt lgkmcnt(0)
    s_barrier
    ds_read_b64 v[32:33], v56
    s_waitcnt lgkmcnt(0)
    v_cmp_ne_u32 vcc, s40, v32
    s_setprio 3
    v_readfirstlane_b32 s17, v33
    s_add_u32 s39, s39, s17
    s_cbranch_vccnz ch_p_slow
    v_mov_b32 v32, 0
    v_mov_b32 v33, 0
    v_mov_b32 v34, 0
    v_mov_b32 v35, 0
    v_mov_b32 v36, 0
    v_mov_b32 v37, 0
    v_mov_b32 v38, 0
    v_mov_b32 v39, 0
    v_mov_b32 v40, 0
    v_mov_b32 v41, 0
    v_mov_b32 v42, 0
    v_mov_b32 v43, 0
    v_mov_b32 v44, 0
    v_mov_b32 v45, 0
    v_mov_b32 v46, 0
    v_mov_b32 v47, 0
    v_mov_b32 v48, 0
    v_mov_b32 v49, 0
    v_mov_b32 v50, 0
    v_mov_b32 v51, 0
    v_mov_b32 v52, 0
    v_mov_b32 v53, 0
    v_mov_b32 v54, 0
    v_mov_b32 v55, 0
    v_mov_b32 v59, 0
    s_nop 1
    s_branch ploopL_20_nc
.p2align 6
    s_nop 0
    s_nop 0
    s_nop 0
    s_nop 0
    s_nop 0
    s_nop 0
    s_nop 0
    s_nop 0
    s_nop 0
    s_nop 0
    s_nop 0
ploopL_20:
    v_mov_b32 v32, 0
    v_mov_b32 v33, 0
    v_mov_b32 v34, 0
    v_mov_b32 v35, 0
    v_mov_b32 v36, 0
    v_mov_b32 v37, 0
    v_mov_b32 v38, 0
    v_mov_b32 v39, 0
    v_mov_b32 v40, 0
    v_mov_b32 v41, 0
    v_mov_b32 v42, 0
    v_mov_b32 v43, 0
    v_mov_b32 v44, 0
    v_mov_b32 v45, 0
    v_mov_b32 v46, 0
    v_mov_b32 v47, 0
    v_mov_b32 v48, 0
    v_mov_b32 v49, 0
    v_mov_b32 v50, 0
    v_mov_b32 v51, 0
    v_mov_b32 v52, 0
    v_mov_b32 v53, 0
    v_mov_b32 v54, 0
    v_mov_b32 v55, 0
    s_bitcmp1_b32 s29, 0
    s_cbranch_scc1 gate_21_ok
    s_add_u32 s21, s16, 1
    s_min_u32 s21, s21, 63
    s_cmp_ge_u32 s21, 16
    s_cselect_b32 s19, 12, 8
    s_and_b32 s32, s21, 4
    s_lshr_b32 s21, s21, 3
    s_lshl_b32 s21, s21, 8
    s_add_u32 s32, s32, s21
    s_add_u32 s32, s32, s35
gate_21:
    buffer_load_dword v9, off, s[4:7], s32 sc1
    s_waitcnt vmcnt(0)
    v_readfirstlane_b32 s21, v9
    s_cmp_ge_u32 s21, s19
    s_cbranch_scc1 gate_21_set
    s_sleep 8
    s_sub_u32 s22, s22, 1
    s_cbranch_scc0 gate_21
    s_mov_b32 s22, 0
gate_21_set:
    s_bitset1_b32 s29, 0
gate_21_ok:
    s_sleep 1
    buffer_load_dwordx4 v[16:19], v1, s[4:7], s23 offen offset:0 sc1
    buffer_load_dwordx4 v[20:23], v1, s[4:7], s23 offen offset:1024 sc1
    buffer_load_dwordx4 v[24:27], v1, s[4:7], s23 offen offset:2048 sc1
    buffer_load_dwordx4 v[28:31], v1, s[4:7], s23 offen offset:3072 sc1
    s_waitcnt vmcnt(3)
    v_cmp_eq_u32 vcc, -1, v16
    s_cbranch_vccnz ploopL_20_rm_0
ploopL_20_rm_0ok:
    v_smfmac_f32_16x16x64_bf16 v[32:35], v[16:19], v[64:71], v8
    v_smfmac_f32_16x16x64_bf16 v[36:39], v[16:19], v[72:79], v8
    s_waitcnt vmcnt(2)
    v_cmp_eq_u32 vcc, -1, v20
    v_smfmac_f32_16x16x64_bf16 v[40:43], v[16:19], v[80:87], v8
    v_smfmac_f32_16x16x64_bf16 v[44:47], v[16:19], v[88:95], v8
    v_smfmac_f32_16x16x64_bf16 v[48:51], v[16:19], v[96:103], v8
    v_smfmac_f32_16x16x64_bf16 v[52:55], v[16:19], v[104:111], v8
    s_cbranch_vccnz ploopL_20_rm_1
ploopL_20_rm_1ok:
    v_smfmac_f32_16x16x64_bf16 v[32:35], v[20:23], v[112:119], v8
    v_smfmac_f32_16x16x64_bf16 v[36:39], v[20:23], v[120:127], v8
    s_waitcnt vmcnt(1)
    v_cmp_eq_u32 vcc, -1, v24
    v_smfmac_f32_16x16x64_bf16 v[40:43], v[20:23], v[128:135], v8
    v_smfmac_f32_16x16x64_bf16 v[44:47], v[20:23], v[136:143], v8
    v_smfmac_f32_16x16x64_bf16 v[48:51], v[20:23], v[144:151], v8
    v_smfmac_f32_16x16x64_bf16 v[52:55], v[20:23], v[152:159], v8
    s_cbranch_vccnz ploopL_20_rm_2
ploopL_20_rm_2ok:
    v_smfmac_f32_16x16x64_bf16 v[32:35], v[24:27], v[160:167], v8
    v_smfmac_f32_16x16x64_bf16 v[36:39], v[24:27], v[168:175], v8
    s_waitcnt vmcnt(0)
    v_cmp_eq_u32 vcc, -1, v28
    v_smfmac_f32_16x16x64_bf16 v[40:43], v[24:27], v[176:183], v8
    v_smfmac_f32_16x16x64_bf16 v[44:47], v[24:27], v[184:191], v8
    v_smfmac_f32_16x16x64_bf16 v[48:51], v[24:27], v[192:199], v8
    v_smfmac_f32_16x16x64_bf16 v[52:55], v[24:27], v[200:207], v8
    s_cbranch_vccnz ploopL_20_rm_3
ploopL_20_rm_3ok:
    v_smfmac_f32_16x16x64_bf16 v[32:35], v[28:31], v[208:215], v8
    ds_write_b32 v63, v59 offset:32
    v_smfmac_f32_16x16x64_bf16 v[36:39], v[28:31], v[216:223], v8
    v_smfmac_f32_16x16x64_bf16 v[40:43], v[28:31], v[224:231], v8
    v_smfmac_f32_16x16x64_bf16 v[44:47], v[28:31], v[232:239], v8
    v_smfmac_f32_16x16x64_bf16 v[48:51], v[28:31], v[240:247], v8
    v_smfmac_f32_16x16x64_bf16 v[52:55], v[28:31], v[248:255], v8
    s_branch ploopL_20_mmd
ploopL_20_nc:
    v_smfmac_f32_16x16x64_bf16 v[32:35], v[16:19], v[64:71], v8
    v_smfmac_f32_16x16x64_bf16 v[36:39], v[16:19], v[72:79], v8
    v_smfmac_f32_16x16x64_bf16 v[40:43], v[16:19], v[80:87], v8
    v_smfmac_f32_16x16x64_bf16 v[44:47], v[16:19], v[88:95], v8
    v_smfmac_f32_16x16x64_bf16 v[48:51], v[16:19], v[96:103], v8
    v_smfmac_f32_16x16x64_bf16 v[52:55], v[16:19], v[104:111], v8
    v_smfmac_f32_16x16x64_bf16 v[32:35], v[20:23], v[112:119], v8
    v_smfmac_f32_16x16x64_bf16 v[36:39], v[20:23], v[120:127], v8
    v_smfmac_f32_16x16x64_bf16 v[40:43], v[20:23], v[128:135], v8
    v_smfmac_f32_16x16x64_bf16 v[44:47], v[20:23], v[136:143], v8
    v_smfmac_f32_16x16x64_bf16 v[48:51], v[20:23], v[144:151], v8
    v_smfmac_f32_16x16x64_bf16 v[52:55], v[20:23], v[152:159], v8
    v_smfmac_f32_16x16x64_bf16 v[32:35], v[24:27], v[160:167], v8
    v_smfmac_f32_16x16x64_bf16 v[36:39], v[24:27], v[168:175], v8
    v_smfmac_f32_16x16x64_bf16 v[40:43], v[24:27], v[176:183], v8
    v_smfmac_f32_16x16x64_bf16 v[44:47], v[24:27], v[184:191], v8
    v_smfmac_f32_16x16x64_bf16 v[48:51], v[24:27], v[192:199], v8
    v_smfmac_f32_16x16x64_bf16 v[52:55], v[24:27], v[200:207], v8
    v_smfmac_f32_16x16x64_bf16 v[32:35], v[28:31], v[208:215], v8
    ds_write_b32 v63, v59 offset:32
    v_smfmac_f32_16x16x64_bf16 v[36:39], v[28:31], v[216:223], v8
    v_smfmac_f32_16x16x64_bf16 v[40:43], v[28:31], v[224:231], v8
    v_smfmac_f32_16x16x64_bf16 v[44:47], v[28:31], v[232:239], v8
    v_smfmac_f32_16x16x64_bf16 v[48:51], v[28:31], v[240:247], v8
    v_smfmac_f32_16x16x64_bf16 v[52:55], v[28:31], v[248:255], v8
ploopL_20_mmd:
    s_cmp_eq_u32 s3, 3
    s_nop 1
    v_add_f32 v32, v32, v34
    v_add_f32 v33, v33, v35
    ds_write2_b32 v3, v32, v33 offset0:0 offset1:40
    v_add_f32 v36, v36, v38
    v_add_f32 v37, v37, v39
    ds_write2_b32 v3, v36, v37 offset0:16 offset1:56
    v_add_f32 v40, v40, v42
    v_add_f32 v41, v41, v43
    ds_write2_b32 v61, v40, v41 offset0:0 offset1:40
    v_add_f32 v44, v44, v46
    v_add_f32 v45, v45, v47
    ds_write2_b32 v61, v44, v45 offset0:16 offset1:56
    v_add_f32 v48, v48, v50
    v_add_f32 v49, v49, v51
    ds_write2_b32 v62, v48, v49 offset0:0 offset1:40
    v_add_f32 v52, v52, v54
    v_add_f32 v53, v53, v55
    ds_write2_b32 v62, v52, v53 offset0:16 offset1:56
    s_waitcnt lgkmcnt(0)
    s_barrier
    s_cbranch_scc1 ploopL_20_sk1
    ds_read_b128 v[32:35], v4 offset:0
    ds_read_b128 v[36:39], v4 offset:3840
    ds_read_b128 v[40:43], v4 offset:7680
    ds_read_b128 v[44:47], v4 offset:11520
    s_waitcnt lgkmcnt(2)
    v_add_f32 v32, v32, v36
    v_add_f32 v33, v33, v37
    v_add_f32 v34, v34, v38
    v_add_f32 v35, v35, v39
    s_waitcnt lgkmcnt(0)
    v_add_f32 v40, v40, v44
    v_add_f32 v41, v41, v45
    v_add_f32 v42, v42, v46
    v_add_f32 v43, v43, v47
    v_add_f32 v32, v32, v40
    v_add_f32 v33, v33, v41
    v_add_f32 v34, v34, v42
    v_add_f32 v35, v35, v43
    v_cvt_pk_bf16_f32 v56, v32, v33
    v_cvt_pk_bf16_f32 v57, v34, v35
    v_min_u32 v56, -2, v56
    buffer_store_dwordx2 v[56:57], v2, s[4:7], s26 offen
    s_add_u32 s27, s16, 2
    s_and_b32 s27, s27, 3
    s_lshl_b32 s27, s27, 18
    s_add_u32 s27, s27, s38
    buffer_store_dwordx2 v[10:11], v2, s[4:7], s27 offen
ploopL_20_sk1:
    s_setprio 0
    s_add_u32 s25, s16, 3
    s_and_b32 s25, s25, 3
    s_lshl_b32 s25, s25, 16
    s_add_u32 s25, s25, s37
    v_mov_b32 v44, -1
    v_mov_b32 v45, -1
    v_mov_b32 v46, -1
    v_mov_b32 v47, -1
    s_mov_b64 exec, s[56:57]
    buffer_store_dwordx4 v[44:47], v5, s[4:7], s25 offen
    s_mov_b64 exec, -1
    s_and_b32 s28, s16, 3
    s_lshl_b32 s28, s28, 18
    s_add_u32 s28, s28, s39
    s_add_u32 s24, s16, 1
    s_and_b32 s24, s24, 3
    s_lshl_b32 s24, s24, 16
    s_add_u32 s24, s24, s37
    s_add_u32 s23, s16, 1
    s_and_b32 s23, s23, 3
    s_lshl_b32 s23, s23, 16
    s_add_u32 s23, s23, s36
    s_add_u32 s26, s16, 1
    s_and_b32 s26, s26, 3
    s_lshl_b32 s26, s26, 18
    s_add_u32 s26, s26, s38
    s_cmp_eq_u32 s59, 0
    s_cbranch_scc1 ofl_22
    s_lshl_b32 s17, s3, 10
    v_add_u32 v39, s17, v1
    ds_read_b128 v[40:43], v39 offset:32768
ofl_22:
    s_cmp_ge_u32 s16, 16
    s_cbranch_scc1 ploopL_20_nx
    v_mov_b32 v40, v2
    v_mov_b32 v42, v56
    v_mov_b32 v43, v57
    s_cmp_lg_u32 s3, 2
    s_cbranch_scc1 ploopL_20_nx
    v_and_b32 v40, 0x60, v1
    v_lshlrev_b32 v40, 2, v40
    v_lshrrev_b32 v41, 3, v1
    v_and_b32 v41, 0x70, v41
    v_or_b32 v40, v40, v41
    v_bfe_u32 v41, v1, 4, 1
    v_lshl_or_b32 v40, v41, 3, v40
    s_lshl_b32 s17, s53, 9
    s_add_u32 s17, s17, 4096
    v_add_u32 v40, s17, v40
    s_mov_b32 vcc_lo, 0x55555555
    s_mov_b32 vcc_hi, 0x55555555
    v_cndmask_b32_dpp v42, v57, v56, vcc quad_perm:[1,0,3,2] row_mask:0xf bank_mask:0xf
    s_not_b64 vcc, vcc
    v_cndmask_b32_dpp v43, v56, v57, vcc quad_perm:[1,0,3,2] row_mask:0xf bank_mask:0xf
ploopL_20_nx:
    v_readfirstlane_b32 s21, v60
    s_lshr_b32 s29, s29, 1
    s_cmp_ge_u32 s21, s58
    s_cselect_b32 s21, 2, 0
    s_or_b32 s29, s29, s21
    s_cmp_eq_u32 s3, 3
    s_cselect_b32 s20, s21, 0
    s_add_u32 s21, s16, 4
    s_min_u32 s21, s21, 63
    s_cmp_ge_u32 s21, 16
    s_cselect_b32 s58, 12, 8
    s_and_b32 s33, s21, 4
    s_lshr_b32 s21, s21, 3
    s_lshl_b32 s21, s21, 8
    s_add_u32 s33, s33, s21
    s_add_u32 s33, s33, s35
    s_setprio 3
ploopL_20_fs:
    ds_read_b128 v[32:35], v58 offset:0
    s_waitcnt lgkmcnt(0)
    v_min3_i32 v32, v32, v33, v34
    v_min_i32 v32, v32, v35
    s_nop 0
    v_readfirstlane_b32 s18, v32
    s_cmp_ge_i32 s18, s16
    s_cbranch_scc1 ploopL_20_fsok
    s_sleep 1
    s_branch ploopL_20_fs
ploopL_20_fsok:
    s_setprio 1
    s_sleep 4
ploopL_20_nofd:
    s_cmp_eq_u32 s20, 0
    s_cbranch_scc1 ploopL_20_nt
    s_cmp_ge_u32 s16, 13
    s_cselect_b32 exec_hi, 0xffff, 0
    buffer_load_dword v60, v0, s[4:7], s31 offen sc1
    s_mov_b32 exec_hi, -1
ploopL_20_nt:
    s_cmp_eq_u32 s59, 0
    s_cbranch_scc1 ofl_23
    s_lshl_b32 s17, s16, 18
    s_add_u32 s17, s17, s60
    buffer_store_dwordx4 v[40:43], v1, s[4:7], s17 offen sc1
    s_mov_b32 s59, 0
ofl_23:
    s_lshr_b32 s17, s34, 3
    s_xor_b32 s17, s17, s16
    s_andn2_b32 s59, 1, s17
    s_cmp_ge_u32 s16, 16
    s_cselect_b32 s59, s59, 0
    s_cbranch_scc1 ploopL_20_nx2
    s_cmp_eq_u32 s3, 3
    s_cbranch_scc1 ploopL_20_nx2
    buffer_store_dwordx2 v[42:43], v40, s[4:7], s55 offen sc1
ploopL_20_nx2:
    s_add_u32 s55, s55, 262144
    s_or_b32 s17, s13, s3
    s_cmp_lg_u32 s17, 0
    s_cbranch_scc1 ploopL_20_npg
    s_sub_u32 s21, s16, 1
    s_cbranch_scc1 ploopL_20_npg
    s_sub_u32 s17, s21, 1
    s_and_b32 s17, s17, 3
    s_cmp_ge_u32 s16, 58
    s_cselect_b32 s17, 0, s17
    s_cmp_lg_u32 s17, 0
    s_cbranch_scc1 ploopL_20_npg
    s_lshl_b32 s17, s12, 7
    s_add_u32 s17, s17, 218112000
    v_mov_b32 v9, s21
    s_mov_b64 exec, 1
    buffer_store_dword v9, off, s[4:7], s17 sc1
    s_mov_b64 exec, -1
ploopL_20_npg:
    s_barrier
    buffer_load_dword v60, off, s[4:7], s33 sc1
    s_add_u32 s16, s16, 1
    v_mov_b32 v59, s16
    s_add_u32 s41, s41, 262144
    s_add_u32 s31, s31, 262144
    s_setprio 3
    s_sleep 13
ploopL_20_pagain:
    buffer_load_dwordx4 v[16:19], v1, s[4:7], s28 offen offset:0 sc1
    buffer_load_dwordx4 v[20:23], v1, s[4:7], s28 offen offset:1024 sc1
    s_waitcnt vmcnt(1)
    v_mfma_f32_16x16x32_bf16 v[32:35], v[12:15], v[16:19], 0
    s_waitcnt vmcnt(0)
    v_mfma_f32_16x16x32_bf16 v[32:35], v[12:15], v[20:23], v[32:35]
    v_max_u32 v9, v16, v20
    v_cmp_eq_u32 vcc, -1, v9
    s_cbranch_vccnz ploopL_20_rp
ploopL_20_pgo:
    s_cmp_lt_u32 s16, 48
    s_nop 3
    v_cvt_pk_bf16_f32 v52, v32, v33
    v_cvt_pk_bf16_f32 v53, v34, v35
    s_nop 0
    v_permlane16_swap_b32 v52, v54
    v_permlane16_swap_b32 v53, v55
    s_mov_b64 exec, s[56:57]
    v_min_u32 v52, -2, v52
    buffer_store_dwordx4 v[52:55], v5, s[4:7], s24 offen
    s_mov_b64 exec, -1
    ds_write_b32 v63, v59 offset:16
    s_cbranch_scc1 ploopL_20
    s_branch ploopH_19
ploopL_20_rm_0:
    s_sub_u32 s22, s22, 1
    s_cbranch_scc1 ploopL_20_rm_0_g
    buffer_load_dwordx4 v[16:19], v1, s[4:7], s23 offen offset:0 sc1
    buffer_load_dwordx4 v[20:23], v1, s[4:7], s23 offen offset:1024 sc1
    buffer_load_dwordx4 v[24:27], v1, s[4:7], s23 offen offset:2048 sc1
    buffer_load_dwordx4 v[28:31], v1, s[4:7], s23 offen offset:3072 sc1
    s_waitcnt vmcnt(3)
    v_cmp_eq_u32 vcc, -1, v16
    s_cbranch_vccnz ploopL_20_rm_0
    s_branch ploopL_20_rm_0ok
ploopL_20_rm_0_g:
    s_mov_b32 s22, 0
    s_waitcnt vmcnt(0)
    s_branch ploopL_20_rm_0ok
ploopL_20_rm_1:
    s_sub_u32 s22, s22, 1
    s_cbranch_scc1 ploopL_20_rm_1_g
    buffer_load_dwordx4 v[20:23], v1, s[4:7], s23 offen offset:1024 sc1
    buffer_load_dwordx4 v[24:27], v1, s[4:7], s23 offen offset:2048 sc1
    buffer_load_dwordx4 v[28:31], v1, s[4:7], s23 offen offset:3072 sc1
    s_waitcnt vmcnt(2)
    v_cmp_eq_u32 vcc, -1, v20
    s_cbranch_vccnz ploopL_20_rm_1
    s_branch ploopL_20_rm_1ok
ploopL_20_rm_1_g:
    s_mov_b32 s22, 0
    s_waitcnt vmcnt(0)
    s_branch ploopL_20_rm_1ok
ploopL_20_rm_2:
    s_sub_u32 s22, s22, 1
    s_cbranch_scc1 ploopL_20_rm_2_g
    buffer_load_dwordx4 v[24:27], v1, s[4:7], s23 offen offset:2048 sc1
    buffer_load_dwordx4 v[28:31], v1, s[4:7], s23 offen offset:3072 sc1
    s_waitcnt vmcnt(1)
    v_cmp_eq_u32 vcc, -1, v24
    s_cbranch_vccnz ploopL_20_rm_2
    s_branch ploopL_20_rm_2ok
ploopL_20_rm_2_g:
    s_mov_b32 s22, 0
    s_waitcnt vmcnt(0)
    s_branch ploopL_20_rm_2ok
ploopL_20_rm_3:
    s_sub_u32 s22, s22, 1
    s_cbranch_scc1 ploopL_20_rm_3_g
    buffer_load_dwordx4 v[28:31], v1, s[4:7], s23 offen offset:3072 sc1
    s_waitcnt vmcnt(0)
    v_cmp_eq_u32 vcc, -1, v28
    s_cbranch_vccnz ploopL_20_rm_3
    s_branch ploopL_20_rm_3ok
ploopL_20_rm_3_g:
    s_mov_b32 s22, 0
    s_waitcnt vmcnt(0)
    s_branch ploopL_20_rm_3ok
ploopL_20_rp:
    s_sub_u32 s22, s22, 1
    s_cbranch_scc0 ploopL_20_pagain
    s_mov_b32 s22, 0
    s_branch ploopL_20_pgo
.p2align 6
    s_nop 0
    s_nop 0
    s_nop 0
    s_nop 0
    s_nop 0
    s_nop 0
    s_nop 0
    s_nop 0
    s_nop 0
    s_nop 0
    s_nop 0
ploopH_19:
    v_mov_b32 v32, 0
    v_mov_b32 v33, 0
    v_mov_b32 v34, 0
    v_mov_b32 v35, 0
    v_mov_b32 v36, 0
    v_mov_b32 v37, 0
    v_mov_b32 v38, 0
    v_mov_b32 v39, 0
    v_mov_b32 v40, 0
    v_mov_b32 v41, 0
    v_mov_b32 v42, 0
    v_mov_b32 v43, 0
    v_mov_b32 v44, 0
    v_mov_b32 v45, 0
    v_mov_b32 v46, 0
    v_mov_b32 v47, 0
    v_mov_b32 v48, 0
    v_mov_b32 v49, 0
    v_mov_b32 v50, 0
    v_mov_b32 v51, 0
    v_mov_b32 v52, 0
    v_mov_b32 v53, 0
    v_mov_b32 v54, 0
    v_mov_b32 v55, 0
    s_sleep 1
    buffer_load_dwordx4 v[16:19], v1, s[4:7], s23 offen offset:0 sc1
    buffer_load_dwordx4 v[20:23], v1, s[4:7], s23 offen offset:1024 sc1
    buffer_load_dwordx4 v[24:27], v1, s[4:7], s23 offen offset:2048 sc1
    buffer_load_dwordx4 v[28:31], v1, s[4:7], s23 offen offset:3072 sc1
    s_waitcnt vmcnt(3)
    v_cmp_eq_u32 vcc, -1, v16
    s_cbranch_vccnz ploopH_19_rm_0
ploopH_19_rm_0ok:
    v_smfmac_f32_16x16x64_bf16 v[32:35], v[16:19], v[64:71], v8
    v_smfmac_f32_16x16x64_bf16 v[36:39], v[16:19], v[72:79], v8
    s_waitcnt vmcnt(2)
    v_cmp_eq_u32 vcc, -1, v20
    v_smfmac_f32_16x16x64_bf16 v[40:43], v[16:19], v[80:87], v8
    v_smfmac_f32_16x16x64_bf16 v[44:47], v[16:19], v[88:95], v8
    v_smfmac_f32_16x16x64_bf16 v[48:51], v[16:19], v[96:103], v8
    v_smfmac_f32_16x16x64_bf16 v[52:55], v[16:19], v[104:111], v8
    s_cbranch_vccnz ploopH_19_rm_1
ploopH_19_rm_1ok:
    v_smfmac_f32_16x16x64_bf16 v[32:35], v[20:23], v[112:119], v8
    v_smfmac_f32_16x16x64_bf16 v[36:39], v[20:23], v[120:127], v8
    s_waitcnt vmcnt(1)
    v_cmp_eq_u32 vcc, -1, v24
    v_smfmac_f32_16x16x64_bf16 v[40:43], v[20:23], v[128:135], v8
    v_smfmac_f32_16x16x64_bf16 v[44:47], v[20:23], v[136:143], v8
    v_smfmac_f32_16x16x64_bf16 v[48:51], v[20:23], v[144:151], v8
    v_smfmac_f32_16x16x64_bf16 v[52:55], v[20:23], v[152:159], v8
    s_cbranch_vccnz ploopH_19_rm_2
ploopH_19_rm_2ok:
    v_smfmac_f32_16x16x64_bf16 v[32:35], v[24:27], v[160:167], v8
    v_smfmac_f32_16x16x64_bf16 v[36:39], v[24:27], v[168:175], v8
    s_waitcnt vmcnt(0)
    v_cmp_eq_u32 vcc, -1, v28
    v_smfmac_f32_16x16x64_bf16 v[40:43], v[24:27], v[176:183], v8
    v_smfmac_f32_16x16x64_bf16 v[44:47], v[24:27], v[184:191], v8
    v_smfmac_f32_16x16x64_bf16 v[48:51], v[24:27], v[192:199], v8
    v_smfmac_f32_16x16x64_bf16 v[52:55], v[24:27], v[200:207], v8
    s_cbranch_vccnz ploopH_19_rm_3
ploopH_19_rm_3ok:
    v_smfmac_f32_16x16x64_bf16 v[32:35], v[28:31], v[208:215], v8
    ds_write_b32 v63, v59 offset:32
    v_smfmac_f32_16x16x64_bf16 v[36:39], v[28:31], v[216:223], v8
    v_smfmac_f32_16x16x64_bf16 v[40:43], v[28:31], v[224:231], v8
    v_smfmac_f32_16x16x64_bf16 v[44:47], v[28:31], v[232:239], v8
    v_smfmac_f32_16x16x64_bf16 v[48:51], v[28:31], v[240:247], v8
    v_smfmac_f32_16x16x64_bf16 v[52:55], v[28:31], v[248:255], v8
    s_cmp_eq_u32 s3, 3
    s_nop 1
    v_add_f32 v32, v32, v34
    v_add_f32 v33, v33, v35
    ds_write2_b32 v3, v32, v33 offset0:0 offset1:40
    v_add_f32 v36, v36, v38
    v_add_f32 v37, v37, v39
    ds_write2_b32 v3, v36, v37 offset0:16 offset1:56
    v_add_f32 v40, v40, v42
    v_add_f32 v41, v41, v43
    ds_write2_b32 v61, v40, v41 offset0:0 offset1:40
    v_add_f32 v44, v44, v46
    v_add_f32 v45, v45, v47
    ds_write2_b32 v61, v44, v45 offset0:16 offset1:56
    v_add_f32 v48, v48, v50
    v_add_f32 v49, v49, v51
    ds_write2_b32 v62, v48, v49 offset0:0 offset1:40
    v_add_f32 v52, v52, v54
    v_add_f32 v53, v53, v55
    ds_write2_b32 v62, v52, v53 offset0:16 offset1:56
    s_waitcnt lgkmcnt(0)
    s_barrier
    s_cbranch_scc1 ploopH_19_sk1
    ds_read_b128 v[32:35], v4 offset:0
    ds_read_b128 v[36:39], v4 offset:3840
    ds_read_b128 v[40:43], v4 offset:7680
    ds_read_b128 v[44:47], v4 offset:11520
    s_waitcnt lgkmcnt(2)
    v_add_f32 v32, v32, v36
    v_add_f32 v33, v33, v37
    v_add_f32 v34, v34, v38
    v_add_f32 v35, v35, v39
    s_waitcnt lgkmcnt(0)
    v_add_f32 v40, v40, v44
    v_add_f32 v41, v41, v45
    v_add_f32 v42, v42, v46
    v_add_f32 v43, v43, v47
    v_add_f32 v32, v32, v40
    v_add_f32 v33, v33, v41
    v_add_f32 v34, v34, v42
    v_add_f32 v35, v35, v43
    v_cvt_pk_bf16_f32 v56, v32, v33
    v_cvt_pk_bf16_f32 v57, v34, v35
    v_min_u32 v56, -2, v56
    buffer_store_dwordx2 v[56:57], v2, s[4:7], s26 offen
    s_add_u32 s27, s16, 2
    s_and_b32 s27, s27, 3
    s_lshl_b32 s27, s27, 18
    s_add_u32 s27, s27, s38
    buffer_store_dwordx2 v[10:11], v2, s[4:7], s27 offen
ploopH_19_sk1:
    s_setprio 0
    s_add_u32 s25, s16, 3
    s_and_b32 s25, s25, 3
    s_lshl_b32 s25, s25, 16
    s_add_u32 s25, s25, s37
    v_mov_b32 v44, -1
    v_mov_b32 v45, -1
    v_mov_b32 v46, -1
    v_mov_b32 v47, -1
    s_mov_b64 exec, s[56:57]
    buffer_store_dwordx4 v[44:47], v5, s[4:7], s25 offen
    s_mov_b64 exec, -1
    v_mov_b32_dpp v48, v12 row_ror:8 row_mask:0xf bank_mask:0xf
    v_mov_b32_dpp v49, v13 row_ror:8 row_mask:0xf bank_mask:0xf
    v_mov_b32_dpp v50, v14 row_ror:8 row_mask:0xf bank_mask:0xf
    v_mov_b32_dpp v51, v15 row_ror:8 row_mask:0xf bank_mask:0xf
    s_and_b32 s28, s16, 3
    s_lshl_b32 s28, s28, 18
    s_add_u32 s28, s28, s39
    s_add_u32 s24, s16, 1
    s_and_b32 s24, s24, 3
    s_lshl_b32 s24, s24, 16
    s_add_u32 s24, s24, s37
    s_add_u32 s23, s16, 1
    s_and_b32 s23, s23, 3
    s_lshl_b32 s23, s23, 16
    s_add_u32 s23, s23, s36
    s_add_u32 s26, s16, 1
    s_and_b32 s26, s26, 3
    s_lshl_b32 s26, s26, 18
    s_add_u32 s26, s26, s38
    s_cmp_eq_u32 s59, 0
    s_cbranch_scc1 ofl_24
    s_lshl_b32 s17, s3, 10
    v_add_u32 v39, s17, v1
    ds_read_b128 v[40:43], v39 offset:32768
ofl_24:
    s_cmp_eq_u32 s16, 63
    s_cbranch_scc1 ploopH_19_tail
    s_cmp_eq_u32 s30, s54
    s_cbranch_scc1 pnoseg_25
    ds_read_b128 v[16:19], v6 offset:0
    ds_read_b128 v[20:23], v6 offset:256
    ds_read_b128 v[24:27], v6 offset:512
    ds_read_b128 v[28:31], v6 offset:768
    v_xor_b32 v6, 0x4000, v6
    s_waitcnt lgkmcnt(2)
    v_mfma_f32_16x16x32_bf16 v[40:43], v[12:15], v[16:19], 0
    v_mfma_f32_16x16x32_bf16 v[40:43], v[48:51], v[20:23], v[40:43]
    s_waitcnt lgkmcnt(0)
    v_mfma_f32_16x16x32_bf16 v[44:47], v[12:15], v[24:27], 0
    v_mfma_f32_16x16x32_bf16 v[44:47], v[48:51], v[28:31], v[44:47]
    s_nop 7
    v_cvt_pk_bf16_f32 v40, v40, v41
    v_cvt_pk_bf16_f32 v41, v42, v43
    v_cvt_pk_bf16_f32 v42, v44, v45
    v_cvt_pk_bf16_f32 v43, v46, v47
    s_nop 1
    v_permlane16_swap_b32 v40, v42
    v_permlane16_swap_b32 v41, v43
    s_nop 1
    v_min_u32 v40, -2, v40
pnoseg_25:
    s_bitcmp1_b32 s29, 0
    s_cbranch_scc1 gate_26_ok
    s_add_u32 s21, s16, 1
    s_min_u32 s21, s21, 63
    s_cmp_ge_u32 s21, 16
    s_cselect_b32 s19, 12, 8
    s_and_b32 s32, s21, 4
    s_lshr_b32 s21, s21, 3
    s_lshl_b32 s21, s21, 8
    s_add_u32 s32, s32, s21
    s_add_u32 s32, s32, s35
gate_26:
    buffer_load_dword v9, off, s[4:7], s32 sc1
    s_waitcnt vmcnt(0)
    v_readfirstlane_b32 s21, v9
    s_cmp_ge_u32 s21, s19
    s_cbranch_scc1 gate_26_set
    s_sleep 8
    s_sub_u32 s22, s22, 1
    s_cbranch_scc0 gate_26
    s_mov_b32 s22, 0
gate_26_set:
    s_bitset1_b32 s29, 0
gate_26_ok:
    v_readfirstlane_b32 s21, v60
    s_lshr_b32 s29, s29, 1
    s_cmp_ge_u32 s21, s58
    s_cselect_b32 s21, 2, 0
    s_or_b32 s29, s29, s21
    s_cmp_eq_u32 s3, 3
    s_cselect_b32 s20, s21, 0
    s_add_u32 s21, s16, 4
    s_min_u32 s21, s21, 63
    s_cmp_ge_u32 s21, 16
    s_cselect_b32 s58, 12, 8
    s_and_b32 s33, s21, 4
    s_lshr_b32 s21, s21, 3
    s_lshl_b32 s21, s21, 8
    s_add_u32 s33, s33, s21
    s_add_u32 s33, s33, s35
    s_setprio 3
ploopH_19_fs:
    ds_read_b128 v[32:35], v58 offset:0
    s_waitcnt lgkmcnt(0)
    v_min3_i32 v32, v32, v33, v34
    v_min_i32 v32, v32, v35
    s_nop 0
    v_readfirstlane_b32 s18, v32
    s_cmp_ge_i32 s18, s16
    s_cbranch_scc1 ploopH_19_fsok
    s_sleep 1
    s_branch ploopH_19_fs
ploopH_19_fsok:
    s_setprio 1
    s_add_u32 m0, s42, 8192
    s_add_u32 s17, s41, 37748736
    buffer_load_dwordx4 v1, s[4:7], s17 offen offset:0 sc1 lds
    buffer_load_dwordx4 v1, s[4:7], s17 offen offset:1024 sc1 lds
    buffer_load_dwordx4 v1, s[4:7], s17 offen offset:2048 sc1 lds
    buffer_load_dwordx4 v1, s[4:7], s17 offen offset:3072 sc1 lds
    s_add_u32 m0, s42, 12288
    s_add_u32 s17, s41, 37879808
    buffer_load_dwordx4 v1, s[4:7], s17 offen offset:0 sc1 lds
    buffer_load_dwordx4 v1, s[4:7], s17 offen offset:1024 sc1 lds
    buffer_load_dwordx4 v1, s[4:7], s17 offen offset:2048 sc1 lds
    buffer_load_dwordx4 v1, s[4:7], s17 offen offset:3072 sc1 lds
    s_cmp_eq_u32 s20, 0
    s_cbranch_scc1 ploopH_19_nt
    s_mov_b32 exec_hi, 0xffff
    buffer_load_dword v60, v0, s[4:7], s31 offen sc1
    s_mov_b32 exec_hi, -1
ploopH_19_nt:
    s_cmp_eq_u32 s59, 0
    s_cbranch_scc1 ofl_27
    s_lshl_b32 s17, s16, 18
    s_add_u32 s17, s17, s60
    buffer_store_dwordx4 v[40:43], v1, s[4:7], s17 offen sc1
    s_mov_b32 s59, 0
ofl_27:
    s_cmp_eq_u32 s30, s54
    s_cbranch_scc1 pnoseg_28
    buffer_store_dwordx4 v[40:43], v7, s[4:7], s30 offen sc1
    s_add_u32 s30, s30, 65536
pnoseg_28:
    s_or_b32 s17, s13, s3
    s_cmp_lg_u32 s17, 0
    s_cbranch_scc1 ploopH_19_npg
    s_sub_u32 s21, s16, 1
    s_cbranch_scc1 ploopH_19_npg
    s_sub_u32 s17, s21, 1
    s_and_b32 s17, s17, 3
    s_cmp_ge_u32 s16, 58
    s_cselect_b32 s17, 0, s17
    s_cmp_lg_u32 s17, 0
    s_cbranch_scc1 ploopH_19_npg
    s_lshl_b32 s17, s12, 7
    s_add_u32 s17, s17, 218112000
    v_mov_b32 v9, s21
    s_mov_b64 exec, 1
    buffer_store_dword v9, off, s[4:7], s17 sc1
    s_mov_b64 exec, -1
ploopH_19_npg:
    s_barrier
    buffer_load_dword v60, off, s[4:7], s33 sc1
    s_add_u32 s16, s16, 1
    v_mov_b32 v59, s16
    s_add_u32 s41, s41, 262144
    s_add_u32 s31, s31, 262144
    s_mov_b32 s54, 0
    s_setprio 3
    s_sleep 13
ploopH_19_pagain:
    buffer_load_dwordx4 v[16:19], v1, s[4:7], s28 offen offset:0 sc1
    buffer_load_dwordx4 v[20:23], v1, s[4:7], s28 offen offset:1024 sc1
    s_waitcnt vmcnt(1)
    v_mfma_f32_16x16x32_bf16 v[32:35], v[12:15], v[16:19], 0
    s_waitcnt vmcnt(0)
    v_mfma_f32_16x16x32_bf16 v[32:35], v[12:15], v[20:23], v[32:35]
    v_max_u32 v9, v16, v20
    v_cmp_eq_u32 vcc, -1, v9
    s_cbranch_vccnz ploopH_19_rp
ploopH_19_pgo:
    s_nop 4
    v_cvt_pk_bf16_f32 v52, v32, v33
    v_cvt_pk_bf16_f32 v53, v34, v35
    s_nop 0
    v_permlane16_swap_b32 v52, v54
    v_permlane16_swap_b32 v53, v55
    s_mov_b64 exec, s[56:57]
    v_min_u32 v52, -2, v52
    buffer_store_dwordx4 v[52:55], v5, s[4:7], s24 offen
    s_mov_b64 exec, -1
    ds_write_b32 v63, v59 offset:16
    s_branch ploopH_19
ploopH_19_rm_0:
    s_sub_u32 s22, s22, 1
    s_cbranch_scc1 ploopH_19_rm_0_g
    buffer_load_dwordx4 v[16:19], v1, s[4:7], s23 offen offset:0 sc1
    buffer_load_dwordx4 v[20:23], v1, s[4:7], s23 offen offset:1024 sc1
    buffer_load_dwordx4 v[24:27], v1, s[4:7], s23 offen offset:2048 sc1
    buffer_load_dwordx4 v[28:31], v1, s[4:7], s23 offen offset:3072 sc1
    s_waitcnt vmcnt(3)
    v_cmp_eq_u32 vcc, -1, v16
    s_cbranch_vccnz ploopH_19_rm_0
    s_branch ploopH_19_rm_0ok
ploopH_19_rm_0_g:
    s_mov_b32 s22, 0
    s_waitcnt vmcnt(0)
    s_branch ploopH_19_rm_0ok
ploopH_19_rm_1:
    s_sub_u32 s22, s22, 1
    s_cbranch_scc1 ploopH_19_rm_1_g
    buffer_load_dwordx4 v[20:23], v1, s[4:7], s23 offen offset:1024 sc1
    buffer_load_dwordx4 v[24:27], v1, s[4:7], s23 offen offset:2048 sc1
    buffer_load_dwordx4 v[28:31], v1, s[4:7], s23 offen offset:3072 sc1
    s_waitcnt vmcnt(2)
    v_cmp_eq_u32 vcc, -1, v20
    s_cbranch_vccnz ploopH_19_rm_1
    s_branch ploopH_19_rm_1ok
ploopH_19_rm_1_g:
    s_mov_b32 s22, 0
    s_waitcnt vmcnt(0)
    s_branch ploopH_19_rm_1ok
ploopH_19_rm_2:
    s_sub_u32 s22, s22, 1
    s_cbranch_scc1 ploopH_19_rm_2_g
    buffer_load_dwordx4 v[24:27], v1, s[4:7], s23 offen offset:2048 sc1
    buffer_load_dwordx4 v[28:31], v1, s[4:7], s23 offen offset:3072 sc1
    s_waitcnt vmcnt(1)
    v_cmp_eq_u32 vcc, -1, v24
    s_cbranch_vccnz ploopH_19_rm_2
    s_branch ploopH_19_rm_2ok
ploopH_19_rm_2_g:
    s_mov_b32 s22, 0
    s_waitcnt vmcnt(0)
    s_branch ploopH_19_rm_2ok
ploopH_19_rm_3:
    s_sub_u32 s22, s22, 1
    s_cbranch_scc1 ploopH_19_rm_3_g
    buffer_load_dwordx4 v[28:31], v1, s[4:7], s23 offen offset:3072 sc1
    s_waitcnt vmcnt(0)
    v_cmp_eq_u32 vcc, -1, v28
    s_cbranch_vccnz ploopH_19_rm_3
    s_branch ploopH_19_rm_3ok
ploopH_19_rm_3_g:
    s_mov_b32 s22, 0
    s_waitcnt vmcnt(0)
    s_branch ploopH_19_rm_3ok
ploopH_19_rp:
    s_sub_u32 s22, s22, 1
    s_cbranch_scc0 ploopH_19_pagain
    s_mov_b32 s22, 0
    s_branch ploopH_19_pgo
ploopH_19_tail:
    ds_read_b128 v[16:19], v6 offset:0
    ds_read_b128 v[20:23], v6 offset:256
    ds_read_b128 v[24:27], v6 offset:512
    ds_read_b128 v[28:31], v6 offset:768
    v_xor_b32 v6, 0x4000, v6
    s_waitcnt lgkmcnt(2)
    v_mfma_f32_16x16x32_bf16 v[40:43], v[12:15], v[16:19], 0
    v_mfma_f32_16x16x32_bf16 v[40:43], v[48:51], v[20:23], v[40:43]
    s_waitcnt lgkmcnt(0)
    v_mfma_f32_16x16x32_bf16 v[44:47], v[12:15], v[24:27], 0
    v_mfma_f32_16x16x32_bf16 v[44:47], v[48:51], v[28:31], v[44:47]
    s_nop 7
    v_cvt_pk_bf16_f32 v40, v40, v41
    v_cvt_pk_bf16_f32 v41, v42, v43
    v_cvt_pk_bf16_f32 v42, v44, v45
    v_cvt_pk_bf16_f32 v43, v46, v47
    s_nop 1
    v_permlane16_swap_b32 v40, v42
    v_permlane16_swap_b32 v41, v43
    s_nop 1
    v_min_u32 v40, -2, v40
    buffer_store_dwordx4 v[40:43], v7, s[4:7], s30 offen sc1
    s_add_u32 s30, s30, 65536
    s_barrier
    ds_read_b128 v[16:19], v6 offset:0
    ds_read_b128 v[20:23], v6 offset:256
    ds_read_b128 v[24:27], v6 offset:512
    ds_read_b128 v[28:31], v6 offset:768
    v_xor_b32 v6, 0x4000, v6
    s_waitcnt lgkmcnt(2)
    v_mfma_f32_16x16x32_bf16 v[40:43], v[12:15], v[16:19], 0
    v_mfma_f32_16x16x32_bf16 v[40:43], v[48:51], v[20:23], v[40:43]
    s_waitcnt lgkmcnt(0)
    v_mfma_f32_16x16x32_bf16 v[44:47], v[12:15], v[24:27], 0
    v_mfma_f32_16x16x32_bf16 v[44:47], v[48:51], v[28:31], v[44:47]
    s_nop 7
    v_cvt_pk_bf16_f32 v40, v40, v41
    v_cvt_pk_bf16_f32 v41, v42, v43
    v_cvt_pk_bf16_f32 v42, v44, v45
    v_cvt_pk_bf16_f32 v43, v46, v47
    s_nop 1
    v_permlane16_swap_b32 v40, v42
    v_permlane16_swap_b32 v41, v43
    s_nop 1
    v_min_u32 v40, -2, v40
    buffer_store_dwordx4 v[40:43], v7, s[4:7], s30 offen sc1
    s_add_u32 s30, s30, 65536
    s_branch k_end
ch_p_slow:
    v_mov_b32 v32, 0
    v_mov_b32 v33, 0
    v_mov_b32 v34, 0
    v_mov_b32 v35, 0
    v_mov_b32 v36, 0
    v_mov_b32 v37, 0
    v_mov_b32 v38, 0
    v_mov_b32 v39, 0
    v_mov_b32 v40, 0
    v_mov_b32 v41, 0
    v_mov_b32 v42, 0
    v_mov_b32 v43, 0
    v_mov_b32 v44, 0
    v_mov_b32 v45, 0
    v_mov_b32 v46, 0
    v_mov_b32 v47, 0
    v_mov_b32 v48, 0
    v_mov_b32 v49, 0
    v_mov_b32 v50, 0
    v_mov_b32 v51, 0
    v_mov_b32 v52, 0
    v_mov_b32 v53, 0
    v_mov_b32 v54, 0
    v_mov_b32 v55, 0
    v_mov_b32 v59, 0
    s_nop 1
    s_branch ploopL_30_nc
.p2align 6
    s_nop 0
    s_nop 0
    s_nop 0
    s_nop 0
    s_nop 0
    s_nop 0
    s_nop 0
    s_nop 0
    s_nop 0
    s_nop 0
    s_nop 0
ploopL_30:
    v_mov_b32 v32, 0
    v_mov_b32 v33, 0
    v_mov_b32 v34, 0
    v_mov_b32 v35, 0
    v_mov_b32 v36, 0
    v_mov_b32 v37, 0
    v_mov_b32 v38, 0
    v_mov_b32 v39, 0
    v_mov_b32 v40, 0
    v_mov_b32 v41, 0
    v_mov_b32 v42, 0
    v_mov_b32 v43, 0
    v_mov_b32 v44, 0
    v_mov_b32 v45, 0
    v_mov_b32 v46, 0
    v_mov_b32 v47, 0
    v_mov_b32 v48, 0
    v_mov_b32 v49, 0
    v_mov_b32 v50, 0
    v_mov_b32 v51, 0
    v_mov_b32 v52, 0
    v_mov_b32 v53, 0
    v_mov_b32 v54, 0
    v_mov_b32 v55, 0
    s_bitcmp1_b32 s29, 0
    s_cbranch_scc1 gate_31_ok
    s_add_u32 s21, s16, 1
    s_min_u32 s21, s21, 63
    s_cmp_ge_u32 s21, 16
    s_cselect_b32 s19, 12, 8
    s_and_b32 s32, s21, 4
    s_lshr_b32 s21, s21, 3
    s_lshl_b32 s21, s21, 8
    s_add_u32 s32, s32, s21
    s_add_u32 s32, s32, s35
gate_31:
    buffer_load_dword v9, off, s[4:7], s32 sc1
    s_waitcnt vmcnt(0)
    v_readfirstlane_b32 s21, v9
    s_cmp_ge_u32 s21, s19
    s_cbranch_scc1 gate_31_set
    s_sleep 8
    s_sub_u32 s22, s22, 1
    s_cbranch_scc0 gate_31
    s_mov_b32 s22, 0
gate_31_set:
    s_bitset1_b32 s29, 0
gate_31_ok:
    s_sleep 1
    buffer_load_dwordx4 v[16:19], v1, s[4:7], s23 offen offset:0 sc1
    buffer_load_dwordx4 v[20:23], v1, s[4:7], s23 offen offset:1024 sc1
    buffer_load_dwordx4 v[24:27], v1, s[4:7], s23 offen offset:2048 sc1
    buffer_load_dwordx4 v[28:31], v1, s[4:7], s23 offen offset:3072 sc1
    s_waitcnt vmcnt(3)
    v_cmp_eq_u32 vcc, -1, v16
    s_cbranch_vccnz ploopL_30_rm_0
ploopL_30_rm_0ok:
    v_smfmac_f32_16x16x64_bf16 v[32:35], v[16:19], v[64:71], v8
    v_smfmac_f32_16x16x64_bf16 v[36:39], v[16:19], v[72:79], v8
    s_waitcnt vmcnt(2)
    v_cmp_eq_u32 vcc, -1, v20
    v_smfmac_f32_16x16x64_bf16 v[40:43], v[16:19], v[80:87], v8
    v_smfmac_f32_16x16x64_bf16 v[44:47], v[16:19], v[88:95], v8
    v_smfmac_f32_16x16x64_bf16 v[48:51], v[16:19], v[96:103], v8
    v_smfmac_f32_16x16x64_bf16 v[52:55], v[16:19], v[104:111], v8
    s_cbranch_vccnz ploopL_30_rm_1
ploopL_30_rm_1ok:
    v_smfmac_f32_16x16x64_bf16 v[32:35], v[20:23], v[112:119], v8
    v_smfmac_f32_16x16x64_bf16 v[36:39], v[20:23], v[120:127], v8
    s_waitcnt vmcnt(1)
    v_cmp_eq_u32 vcc, -1, v24
    v_smfmac_f32_16x16x64_bf16 v[40:43], v[20:23], v[128:135], v8
    v_smfmac_f32_16x16x64_bf16 v[44:47], v[20:23], v[136:143], v8
    v_smfmac_f32_16x16x64_bf16 v[48:51], v[20:23], v[144:151], v8
    v_smfmac_f32_16x16x64_bf16 v[52:55], v[20:23], v[152:159], v8
    s_cbranch_vccnz ploopL_30_rm_2
ploopL_30_rm_2ok:
    v_smfmac_f32_16x16x64_bf16 v[32:35], v[24:27], v[160:167], v8
    v_smfmac_f32_16x16x64_bf16 v[36:39], v[24:27], v[168:175], v8
    s_waitcnt vmcnt(0)
    v_cmp_eq_u32 vcc, -1, v28
    v_smfmac_f32_16x16x64_bf16 v[40:43], v[24:27], v[176:183], v8
    v_smfmac_f32_16x16x64_bf16 v[44:47], v[24:27], v[184:191], v8
    v_smfmac_f32_16x16x64_bf16 v[48:51], v[24:27], v[192:199], v8
    v_smfmac_f32_16x16x64_bf16 v[52:55], v[24:27], v[200:207], v8
    s_cbranch_vccnz ploopL_30_rm_3
ploopL_30_rm_3ok:
    v_smfmac_f32_16x16x64_bf16 v[32:35], v[28:31], v[208:215], v8
    ds_write_b32 v63, v59 offset:32
    v_smfmac_f32_16x16x64_bf16 v[36:39], v[28:31], v[216:223], v8
    v_smfmac_f32_16x16x64_bf16 v[40:43], v[28:31], v[224:231], v8
    v_smfmac_f32_16x16x64_bf16 v[44:47], v[28:31], v[232:239], v8
    v_smfmac_f32_16x16x64_bf16 v[48:51], v[28:31], v[240:247], v8
    v_smfmac_f32_16x16x64_bf16 v[52:55], v[28:31], v[248:255], v8
    s_branch ploopL_30_mmd
ploopL_30_nc:
    v_smfmac_f32_16x16x64_bf16 v[32:35], v[16:19], v[64:71], v8
    v_smfmac_f32_16x16x64_bf16 v[36:39], v[16:19], v[72:79], v8
    v_smfmac_f32_16x16x64_bf16 v[40:43], v[16:19], v[80:87], v8
    v_smfmac_f32_16x16x64_bf16 v[44:47], v[16:19], v[88:95], v8
    v_smfmac_f32_16x16x64_bf16 v[48:51], v[16:19], v[96:103], v8
    v_smfmac_f32_16x16x64_bf16 v[52:55], v[16:19], v[104:111], v8
    v_smfmac_f32_16x16x64_bf16 v[32:35], v[20:23], v[112:119], v8
    v_smfmac_f32_16x16x64_bf16 v[36:39], v[20:23], v[120:127], v8
    v_smfmac_f32_16x16x64_bf16 v[40:43], v[20:23], v[128:135], v8
    v_smfmac_f32_16x16x64_bf16 v[44:47], v[20:23], v[136:143], v8
    v_smfmac_f32_16x16x64_bf16 v[48:51], v[20:23], v[144:151], v8
    v_smfmac_f32_16x16x64_bf16 v[52:55], v[20:23], v[152:159], v8
    v_smfmac_f32_16x16x64_bf16 v[32:35], v[24:27], v[160:167], v8
    v_smfmac_f32_16x16x64_bf16 v[36:39], v[24:27], v[168:175], v8
    v_smfmac_f32_16x16x64_bf16 v[40:43], v[24:27], v[176:183], v8
    v_smfmac_f32_16x16x64_bf16 v[44:47], v[24:27], v[184:191], v8
    v_smfmac_f32_16x16x64_bf16 v[48:51], v[24:27], v[192:199], v8
    v_smfmac_f32_16x16x64_bf16 v[52:55], v[24:27], v[200:207], v8
    v_smfmac_f32_16x16x64_bf16 v[32:35], v[28:31], v[208:215], v8
    ds_write_b32 v63, v59 offset:32
    v_smfmac_f32_16x16x64_bf16 v[36:39], v[28:31], v[216:223], v8
    v_smfmac_f32_16x16x64_bf16 v[40:43], v[28:31], v[224:231], v8
    v_smfmac_f32_16x16x64_bf16 v[44:47], v[28:31], v[232:239], v8
    v_smfmac_f32_16x16x64_bf16 v[48:51], v[28:31], v[240:247], v8
    v_smfmac_f32_16x16x64_bf16 v[52:55], v[28:31], v[248:255], v8
ploopL_30_mmd:
    s_cmp_eq_u32 s3, 3
    s_nop 1
    v_add_f32 v32, v32, v34
    v_add_f32 v33, v33, v35
    ds_write2_b32 v3, v32, v33 offset0:0 offset1:40
    v_add_f32 v36, v36, v38
    v_add_f32 v37, v37, v39
    ds_write2_b32 v3, v36, v37 offset0:16 offset1:56
    v_add_f32 v40, v40, v42
    v_add_f32 v41, v41, v43
    ds_write2_b32 v61, v40, v41 offset0:0 offset1:40
    v_add_f32 v44, v44, v46
    v_add_f32 v45, v45, v47
    ds_write2_b32 v61, v44, v45 offset0:16 offset1:56
    v_add_f32 v48, v48, v50
    v_add_f32 v49, v49, v51
    ds_write2_b32 v62, v48, v49 offset0:0 offset1:40
    v_add_f32 v52, v52, v54
    v_add_f32 v53, v53, v55
    ds_write2_b32 v62, v52, v53 offset0:16 offset1:56
    s_waitcnt lgkmcnt(0)
    s_barrier
    s_cbranch_scc1 ploopL_30_sk1
    ds_read_b128 v[32:35], v4 offset:0
    ds_read_b128 v[36:39], v4 offset:3840
    ds_read_b128 v[40:43], v4 offset:7680
    ds_read_b128 v[44:47], v4 offset:11520
    s_waitcnt lgkmcnt(2)
    v_add_f32 v32, v32, v36
    v_add_f32 v33, v33, v37
    v_add_f32 v34, v34, v38
    v_add_f32 v35, v35, v39
    s_waitcnt lgkmcnt(0)
    v_add_f32 v40, v40, v44
    v_add_f32 v41, v41, v45
    v_add_f32 v42, v42, v46
    v_add_f32 v43, v43, v47
    v_add_f32 v32, v32, v40
    v_add_f32 v33, v33, v41
    v_add_f32 v34, v34, v42
    v_add_f32 v35, v35, v43
    v_cvt_pk_bf16_f32 v56, v32, v33
    v_cvt_pk_bf16_f32 v57, v34, v35
    v_min_u32 v56, -2, v56
    buffer_store_dwordx2 v[56:57], v2, s[4:7], s26 offen sc1
    s_add_u32 s27, s16, 2
    s_and_b32 s27, s27, 3
    s_lshl_b32 s27, s27, 18
    s_add_u32 s27, s27, s38
    buffer_store_dwordx2 v[10:11], v2, s[4:7], s27 offen sc1
ploopL_30_sk1:
    s_setprio 0
    s_add_u32 s25, s16, 3
    s_and_b32 s25, s25, 3
    s_lshl_b32 s25, s25, 16
    s_add_u32 s25, s25, s37
    v_mov_b32 v44, -1
    v_mov_b32 v45, -1
    v_mov_b32 v46, -1
    v_mov_b32 v47, -1
    s_mov_b64 exec, s[56:57]
    buffer_store_dwordx4 v[44:47], v5, s[4:7], s25 offen sc1
    s_mov_b64 exec, -1
    s_and_b32 s28, s16, 3
    s_lshl_b32 s28, s28, 18
    s_add_u32 s28, s28, s39
    s_add_u32 s24, s16, 1
    s_and_b32 s24, s24, 3
    s_lshl_b32 s24, s24, 16
    s_add_u32 s24, s24, s37
    s_add_u32 s23, s16, 1
    s_and_b32 s23, s23, 3
    s_lshl_b32 s23, s23, 16
    s_add_u32 s23, s23, s36
    s_add_u32 s26, s16, 1
    s_and_b32 s26, s26, 3
    s_lshl_b32 s26, s26, 18
    s_add_u32 s26, s26, s38
    s_cmp_eq_u32 s59, 0
    s_cbranch_scc1 ofl_32
    s_lshl_b32 s17, s3, 10
    v_add_u32 v39, s17, v1
    ds_read_b128 v[40:43], v39 offset:32768
ofl_32:
    s_cmp_ge_u32 s16, 16
    s_cbranch_scc1 ploopL_30_nx
    v_mov_b32 v40, v2
    v_mov_b32 v42, v56
    v_mov_b32 v43, v57
    s_cmp_lg_u32 s3, 2
    s_cbranch_scc1 ploopL_30_nx
    v_and_b32 v40, 0x60, v1
    v_lshlrev_b32 v40, 2, v40
    v_lshrrev_b32 v41, 3, v1
    v_and_b32 v41, 0x70, v41
    v_or_b32 v40, v40, v41
    v_bfe_u32 v41, v1, 4, 1
    v_lshl_or_b32 v40, v41, 3, v40
    s_lshl_b32 s17, s53, 9
    s_add_u32 s17, s17, 4096
    v_add_u32 v40, s17, v40
    s_mov_b32 vcc_lo, 0x55555555
    s_mov_b32 vcc_hi, 0x55555555
    v_cndmask_b32_dpp v42, v57, v56, vcc quad_perm:[1,0,3,2] row_mask:0xf bank_mask:0xf
    s_not_b64 vcc, vcc
    v_cndmask_b32_dpp v43, v56, v57, vcc quad_perm:[1,0,3,2] row_mask:0xf bank_mask:0xf
ploopL_30_nx:
    v_readfirstlane_b32 s21, v60
    s_lshr_b32 s29, s29, 1
    s_cmp_ge_u32 s21, s58
    s_cselect_b32 s21, 2, 0
    s_or_b32 s29, s29, s21
    s_cmp_eq_u32 s3, 3
    s_cselect_b32 s20, s21, 0
    s_add_u32 s21, s16, 4
    s_min_u32 s21, s21, 63
    s_cmp_ge_u32 s21, 16
    s_cselect_b32 s58, 12, 8
    s_and_b32 s33, s21, 4
    s_lshr_b32 s21, s21, 3
    s_lshl_b32 s21, s21, 8
    s_add_u32 s33, s33, s21
    s_add_u32 s33, s33, s35
    s_setprio 3
ploopL_30_fs:
    ds_read_b128 v[32:35], v58 offset:0
    s_waitcnt lgkmcnt(0)
    v_min3_i32 v32, v32, v33, v34
    v_min_i32 v32, v32, v35
    s_nop 0
    v_readfirstlane_b32 s18, v32
    s_cmp_ge_i32 s18, s16
    s_cbranch_scc1 ploopL_30_fsok
    s_sleep 1
    s_branch ploopL_30_fs
ploopL_30_fsok:
    s_setprio 1
    s_sleep 4
ploopL_30_nofd:
    s_cmp_eq_u32 s20, 0
    s_cbranch_scc1 ploopL_30_nt
    s_cmp_ge_u32 s16, 13
    s_cselect_b32 exec_hi, 0xffff, 0
    buffer_load_dword v60, v0, s[4:7], s31 offen sc1
    s_mov_b32 exec_hi, -1
ploopL_30_nt:
    s_cmp_eq_u32 s59, 0
    s_cbranch_scc1 ofl_33
    s_lshl_b32 s17, s16, 18
    s_add_u32 s17, s17, s60
    buffer_store_dwordx4 v[40:43], v1, s[4:7], s17 offen sc1
    s_mov_b32 s59, 0
ofl_33:
    s_lshr_b32 s17, s34, 3
    s_xor_b32 s17, s17, s16
    s_andn2_b32 s59, 1, s17
    s_cmp_ge_u32 s16, 16
    s_cselect_b32 s59, s59, 0
    s_cbranch_scc1 ploopL_30_nx2
    s_cmp_eq_u32 s3, 3
    s_cbranch_scc1 ploopL_30_nx2
    buffer_store_dwordx2 v[42:43], v40, s[4:7], s55 offen sc1
ploopL_30_nx2:
    s_add_u32 s55, s55, 262144
    s_or_b32 s17, s13, s3
    s_cmp_lg_u32 s17, 0
    s_cbranch_scc1 ploopL_30_npg
    s_sub_u32 s21, s16, 1
    s_cbranch_scc1 ploopL_30_npg
    s_sub_u32 s17, s21, 1
    s_and_b32 s17, s17, 3
    s_cmp_ge_u32 s16, 58
    s_cselect_b32 s17, 0, s17
    s_cmp_lg_u32 s17, 0
    s_cbranch_scc1 ploopL_30_npg
    s_lshl_b32 s17, s12, 7
    s_add_u32 s17, s17, 218112000
    v_mov_b32 v9, s21
    s_mov_b64 exec, 1
    buffer_store_dword v9, off, s[4:7], s17 sc1
    s_mov_b64 exec, -1
ploopL_30_npg:
    s_barrier
    buffer_load_dword v60, off, s[4:7], s33 sc1
    s_add_u32 s16, s16, 1
    v_mov_b32 v59, s16
    s_add_u32 s41, s41, 262144
    s_add_u32 s31, s31, 262144
    s_setprio 3
    s_sleep 13
ploopL_30_pagain:
    buffer_load_dwordx4 v[16:19], v1, s[4:7], s28 offen offset:0 sc1
    buffer_load_dwordx4 v[20:23], v1, s[4:7], s28 offen offset:1024 sc1
    s_waitcnt vmcnt(1)
    v_mfma_f32_16x16x32_bf16 v[32:35], v[12:15], v[16:19], 0
    s_waitcnt vmcnt(0)
    v_mfma_f32_16x16x32_bf16 v[32:35], v[12:15], v[20:23], v[32:35]
    v_max_u32 v9, v16, v20
    v_cmp_eq_u32 vcc, -1, v9
    s_cbranch_vccnz ploopL_30_rp
ploopL_30_pgo:
    s_cmp_lt_u32 s16, 48
    s_nop 3
    v_cvt_pk_bf16_f32 v52, v32, v33
    v_cvt_pk_bf16_f32 v53, v34, v35
    s_nop 0
    v_permlane16_swap_b32 v52, v54
    v_permlane16_swap_b32 v53, v55
    s_mov_b64 exec, s[56:57]
    v_min_u32 v52, -2, v52
    buffer_store_dwordx4 v[52:55], v5, s[4:7], s24 offen sc1
    s_mov_b64 exec, -1
    ds_write_b32 v63, v59 offset:16
    s_cbranch_scc1 ploopL_30
    s_branch ploopH_29
ploopL_30_rm_0:
    s_sub_u32 s22, s22, 1
    s_cbranch_scc1 ploopL_30_rm_0_g
    buffer_load_dwordx4 v[16:19], v1, s[4:7], s23 offen offset:0 sc1
    buffer_load_dwordx4 v[20:23], v1, s[4:7], s23 offen offset:1024 sc1
    buffer_load_dwordx4 v[24:27], v1, s[4:7], s23 offen offset:2048 sc1
    buffer_load_dwordx4 v[28:31], v1, s[4:7], s23 offen offset:3072 sc1
    s_waitcnt vmcnt(3)
    v_cmp_eq_u32 vcc, -1, v16
    s_cbranch_vccnz ploopL_30_rm_0
    s_branch ploopL_30_rm_0ok
ploopL_30_rm_0_g:
    s_mov_b32 s22, 0
    s_waitcnt vmcnt(0)
    s_branch ploopL_30_rm_0ok
ploopL_30_rm_1:
    s_sub_u32 s22, s22, 1
    s_cbranch_scc1 ploopL_30_rm_1_g
    buffer_load_dwordx4 v[20:23], v1, s[4:7], s23 offen offset:1024 sc1
    buffer_load_dwordx4 v[24:27], v1, s[4:7], s23 offen offset:2048 sc1
    buffer_load_dwordx4 v[28:31], v1, s[4:7], s23 offen offset:3072 sc1
    s_waitcnt vmcnt(2)
    v_cmp_eq_u32 vcc, -1, v20
    s_cbranch_vccnz ploopL_30_rm_1
    s_branch ploopL_30_rm_1ok
ploopL_30_rm_1_g:
    s_mov_b32 s22, 0
    s_waitcnt vmcnt(0)
    s_branch ploopL_30_rm_1ok
ploopL_30_rm_2:
    s_sub_u32 s22, s22, 1
    s_cbranch_scc1 ploopL_30_rm_2_g
    buffer_load_dwordx4 v[24:27], v1, s[4:7], s23 offen offset:2048 sc1
    buffer_load_dwordx4 v[28:31], v1, s[4:7], s23 offen offset:3072 sc1
    s_waitcnt vmcnt(1)
    v_cmp_eq_u32 vcc, -1, v24
    s_cbranch_vccnz ploopL_30_rm_2
    s_branch ploopL_30_rm_2ok
ploopL_30_rm_2_g:
    s_mov_b32 s22, 0
    s_waitcnt vmcnt(0)
    s_branch ploopL_30_rm_2ok
ploopL_30_rm_3:
    s_sub_u32 s22, s22, 1
    s_cbranch_scc1 ploopL_30_rm_3_g
    buffer_load_dwordx4 v[28:31], v1, s[4:7], s23 offen offset:3072 sc1
    s_waitcnt vmcnt(0)
    v_cmp_eq_u32 vcc, -1, v28
    s_cbranch_vccnz ploopL_30_rm_3
    s_branch ploopL_30_rm_3ok
ploopL_30_rm_3_g:
    s_mov_b32 s22, 0
    s_waitcnt vmcnt(0)
    s_branch ploopL_30_rm_3ok
ploopL_30_rp:
    s_sub_u32 s22, s22, 1
    s_cbranch_scc0 ploopL_30_pagain
    s_mov_b32 s22, 0
    s_branch ploopL_30_pgo
.p2align 6
    s_nop 0
    s_nop 0
    s_nop 0
    s_nop 0
    s_nop 0
    s_nop 0
    s_nop 0
    s_nop 0
    s_nop 0
    s_nop 0
    s_nop 0
ploopH_29:
    v_mov_b32 v32, 0
    v_mov_b32 v33, 0
    v_mov_b32 v34, 0
    v_mov_b32 v35, 0
    v_mov_b32 v36, 0
    v_mov_b32 v37, 0
    v_mov_b32 v38, 0
    v_mov_b32 v39, 0
    v_mov_b32 v40, 0
    v_mov_b32 v41, 0
    v_mov_b32 v42, 0
    v_mov_b32 v43, 0
    v_mov_b32 v44, 0
    v_mov_b32 v45, 0
    v_mov_b32 v46, 0
    v_mov_b32 v47, 0
    v_mov_b32 v48, 0
    v_mov_b32 v49, 0
    v_mov_b32 v50, 0
    v_mov_b32 v51, 0
    v_mov_b32 v52, 0
    v_mov_b32 v53, 0
    v_mov_b32 v54, 0
    v_mov_b32 v55, 0
    s_sleep 1
    buffer_load_dwordx4 v[16:19], v1, s[4:7], s23 offen offset:0 sc1
    buffer_load_dwordx4 v[20:23], v1, s[4:7], s23 offen offset:1024 sc1
    buffer_load_dwordx4 v[24:27], v1, s[4:7], s23 offen offset:2048 sc1
    buffer_load_dwordx4 v[28:31], v1, s[4:7], s23 offen offset:3072 sc1
    s_waitcnt vmcnt(3)
    v_cmp_eq_u32 vcc, -1, v16
    s_cbranch_vccnz ploopH_29_rm_0
ploopH_29_rm_0ok:
    v_smfmac_f32_16x16x64_bf16 v[32:35], v[16:19], v[64:71], v8
    v_smfmac_f32_16x16x64_bf16 v[36:39], v[16:19], v[72:79], v8
    s_waitcnt vmcnt(2)
    v_cmp_eq_u32 vcc, -1, v20
    v_smfmac_f32_16x16x64_bf16 v[40:43], v[16:19], v[80:87], v8
    v_smfmac_f32_16x16x64_bf16 v[44:47], v[16:19], v[88:95], v8
    v_smfmac_f32_16x16x64_bf16 v[48:51], v[16:19], v[96:103], v8
    v_smfmac_f32_16x16x64_bf16 v[52:55], v[16:19], v[104:111], v8
    s_cbranch_vccnz ploopH_29_rm_1
ploopH_29_rm_1ok:
    v_smfmac_f32_16x16x64_bf16 v[32:35], v[20:23], v[112:119], v8
    v_smfmac_f32_16x16x64_bf16 v[36:39], v[20:23], v[120:127], v8
    s_waitcnt vmcnt(1)
    v_cmp_eq_u32 vcc, -1, v24
    v_smfmac_f32_16x16x64_bf16 v[40:43], v[20:23], v[128:135], v8
    v_smfmac_f32_16x16x64_bf16 v[44:47], v[20:23], v[136:143], v8
    v_smfmac_f32_16x16x64_bf16 v[48:51], v[20:23], v[144:151], v8
    v_smfmac_f32_16x16x64_bf16 v[52:55], v[20:23], v[152:159], v8
    s_cbranch_vccnz ploopH_29_rm_2
ploopH_29_rm_2ok:
    v_smfmac_f32_16x16x64_bf16 v[32:35], v[24:27], v[160:167], v8
    v_smfmac_f32_16x16x64_bf16 v[36:39], v[24:27], v[168:175], v8
    s_waitcnt vmcnt(0)
    v_cmp_eq_u32 vcc, -1, v28
    v_smfmac_f32_16x16x64_bf16 v[40:43], v[24:27], v[176:183], v8
    v_smfmac_f32_16x16x64_bf16 v[44:47], v[24:27], v[184:191], v8
    v_smfmac_f32_16x16x64_bf16 v[48:51], v[24:27], v[192:199], v8
    v_smfmac_f32_16x16x64_bf16 v[52:55], v[24:27], v[200:207], v8
    s_cbranch_vccnz ploopH_29_rm_3
ploopH_29_rm_3ok:
    v_smfmac_f32_16x16x64_bf16 v[32:35], v[28:31], v[208:215], v8
    ds_write_b32 v63, v59 offset:32
    v_smfmac_f32_16x16x64_bf16 v[36:39], v[28:31], v[216:223], v8
    v_smfmac_f32_16x16x64_bf16 v[40:43], v[28:31], v[224:231], v8
    v_smfmac_f32_16x16x64_bf16 v[44:47], v[28:31], v[232:239], v8
    v_smfmac_f32_16x16x64_bf16 v[48:51], v[28:31], v[240:247], v8
    v_smfmac_f32_16x16x64_bf16 v[52:55], v[28:31], v[248:255], v8
    s_cmp_eq_u32 s3, 3
    s_nop 1
    v_add_f32 v32, v32, v34
    v_add_f32 v33, v33, v35
    ds_write2_b32 v3, v32, v33 offset0:0 offset1:40
    v_add_f32 v36, v36, v38
    v_add_f32 v37, v37, v39
    ds_write2_b32 v3, v36, v37 offset0:16 offset1:56
    v_add_f32 v40, v40, v42
    v_add_f32 v41, v41, v43
    ds_write2_b32 v61, v40, v41 offset0:0 offset1:40
    v_add_f32 v44, v44, v46
    v_add_f32 v45, v45, v47
    ds_write2_b32 v61, v44, v45 offset0:16 offset1:56
    v_add_f32 v48, v48, v50
    v_add_f32 v49, v49, v51
    ds_write2_b32 v62, v48, v49 offset0:0 offset1:40
    v_add_f32 v52, v52, v54
    v_add_f32 v53, v53, v55
    ds_write2_b32 v62, v52, v53 offset0:16 offset1:56
    s_waitcnt lgkmcnt(0)
    s_barrier
    s_cbranch_scc1 ploopH_29_sk1
    ds_read_b128 v[32:35], v4 offset:0
    ds_read_b128 v[36:39], v4 offset:3840
    ds_read_b128 v[40:43], v4 offset:7680
    ds_read_b128 v[44:47], v4 offset:11520
    s_waitcnt lgkmcnt(2)
    v_add_f32 v32, v32, v36
    v_add_f32 v33, v33, v37
    v_add_f32 v34, v34, v38
    v_add_f32 v35, v35, v39
    s_waitcnt lgkmcnt(0)
    v_add_f32 v40, v40, v44
    v_add_f32 v41, v41, v45
    v_add_f32 v42, v42, v46
    v_add_f32 v43, v43, v47
    v_add_f32 v32, v32, v40
    v_add_f32 v33, v33, v41
    v_add_f32 v34, v34, v42
    v_add_f32 v35, v35, v43
    v_cvt_pk_bf16_f32 v56, v32, v33
    v_cvt_pk_bf16_f32 v57, v34, v35
    v_min_u32 v56, -2, v56
    buffer_store_dwordx2 v[56:57], v2, s[4:7], s26 offen sc1
    s_add_u32 s27, s16, 2
    s_and_b32 s27, s27, 3
    s_lshl_b32 s27, s27, 18
    s_add_u32 s27, s27, s38
    buffer_store_dwordx2 v[10:11], v2, s[4:7], s27 offen sc1
ploopH_29_sk1:
    s_setprio 0
    s_add_u32 s25, s16, 3
    s_and_b32 s25, s25, 3
    s_lshl_b32 s25, s25, 16
    s_add_u32 s25, s25, s37
    v_mov_b32 v44, -1
    v_mov_b32 v45, -1
    v_mov_b32 v46, -1
    v_mov_b32 v47, -1
    s_mov_b64 exec, s[56:57]
    buffer_store_dwordx4 v[44:47], v5, s[4:7], s25 offen sc1
    s_mov_b64 exec, -1
    v_mov_b32_dpp v48, v12 row_ror:8 row_mask:0xf bank_mask:0xf
    v_mov_b32_dpp v49, v13 row_ror:8 row_mask:0xf bank_mask:0xf
    v_mov_b32_dpp v50, v14 row_ror:8 row_mask:0xf bank_mask:0xf
    v_mov_b32_dpp v51, v15 row_ror:8 row_mask:0xf bank_mask:0xf
    s_and_b32 s28, s16, 3
    s_lshl_b32 s28, s28, 18
    s_add_u32 s28, s28, s39
    s_add_u32 s24, s16, 1
    s_and_b32 s24, s24, 3
    s_lshl_b32 s24, s24, 16
    s_add_u32 s24, s24, s37
    s_add_u32 s23, s16, 1
    s_and_b32 s23, s23, 3
    s_lshl_b32 s23, s23, 16
    s_add_u32 s23, s23, s36
    s_add_u32 s26, s16, 1
    s_and_b32 s26, s26, 3
    s_lshl_b32 s26, s26, 18
    s_add_u32 s26, s26, s38
    s_cmp_eq_u32 s59, 0
    s_cbranch_scc1 ofl_34
    s_lshl_b32 s17, s3, 10
    v_add_u32 v39, s17, v1
    ds_read_b128 v[40:43], v39 offset:32768
ofl_34:
    s_cmp_eq_u32 s16, 63
    s_cbranch_scc1 ploopH_29_tail
    s_cmp_eq_u32 s30, s54
    s_cbranch_scc1 pnoseg_35
    ds_read_b128 v[16:19], v6 offset:0
    ds_read_b128 v[20:23], v6 offset:256
    ds_read_b128 v[24:27], v6 offset:512
    ds_read_b128 v[28:31], v6 offset:768
    v_xor_b32 v6, 0x4000, v6
    s_waitcnt lgkmcnt(2)
    v_mfma_f32_16x16x32_bf16 v[40:43], v[12:15], v[16:19], 0
    v_mfma_f32_16x16x32_bf16 v[40:43], v[48:51], v[20:23], v[40:43]
    s_waitcnt lgkmcnt(0)
    v_mfma_f32_16x16x32_bf16 v[44:47], v[12:15], v[24:27], 0
    v_mfma_f32_16x16x32_bf16 v[44:47], v[48:51], v[28:31], v[44:47]
    s_nop 7
    v_cvt_pk_bf16_f32 v40, v40, v41
    v_cvt_pk_bf16_f32 v41, v42, v43
    v_cvt_pk_bf16_f32 v42, v44, v45
    v_cvt_pk_bf16_f32 v43, v46, v47
    s_nop 1
    v_permlane16_swap_b32 v40, v42
    v_permlane16_swap_b32 v41, v43
    s_nop 1
    v_min_u32 v40, -2, v40
pnoseg_35:
    s_bitcmp1_b32 s29, 0
    s_cbranch_scc1 gate_36_ok
    s_add_u32 s21, s16, 1
    s_min_u32 s21, s21, 63
    s_cmp_ge_u32 s21, 16
    s_cselect_b32 s19, 12, 8
    s_and_b32 s32, s21, 4
    s_lshr_b32 s21, s21, 3
    s_lshl_b32 s21, s21, 8
    s_add_u32 s32, s32, s21
    s_add_u32 s32, s32, s35
gate_36:
    buffer_load_dword v9, off, s[4:7], s32 sc1
    s_waitcnt vmcnt(0)
    v_readfirstlane_b32 s21, v9
    s_cmp_ge_u32 s21, s19
    s_cbranch_scc1 gate_36_set
    s_sleep 8
    s_sub_u32 s22, s22, 1
    s_cbranch_scc0 gate_36
    s_mov_b32 s22, 0
gate_36_set:
    s_bitset1_b32 s29, 0
gate_36_ok:
    v_readfirstlane_b32 s21, v60
    s_lshr_b32 s29, s29, 1
    s_cmp_ge_u32 s21, s58
    s_cselect_b32 s21, 2, 0
    s_or_b32 s29, s29, s21
    s_cmp_eq_u32 s3, 3
    s_cselect_b32 s20, s21, 0
    s_add_u32 s21, s16, 4
    s_min_u32 s21, s21, 63
    s_cmp_ge_u32 s21, 16
    s_cselect_b32 s58, 12, 8
    s_and_b32 s33, s21, 4
    s_lshr_b32 s21, s21, 3
    s_lshl_b32 s21, s21, 8
    s_add_u32 s33, s33, s21
    s_add_u32 s33, s33, s35
    s_setprio 3
ploopH_29_fs:
    ds_read_b128 v[32:35], v58 offset:0
    s_waitcnt lgkmcnt(0)
    v_min3_i32 v32, v32, v33, v34
    v_min_i32 v32, v32, v35
    s_nop 0
    v_readfirstlane_b32 s18, v32
    s_cmp_ge_i32 s18, s16
    s_cbranch_scc1 ploopH_29_fsok
    s_sleep 1
    s_branch ploopH_29_fs
ploopH_29_fsok:
    s_setprio 1
    s_add_u32 m0, s42, 8192
    s_add_u32 s17, s41, 37748736
    buffer_load_dwordx4 v1, s[4:7], s17 offen offset:0 sc1 lds
    buffer_load_dwordx4 v1, s[4:7], s17 offen offset:1024 sc1 lds
    buffer_load_dwordx4 v1, s[4:7], s17 offen offset:2048 sc1 lds
    buffer_load_dwordx4 v1, s[4:7], s17 offen offset:3072 sc1 lds
    s_add_u32 m0, s42, 12288
    s_add_u32 s17, s41, 37879808
    buffer_load_dwordx4 v1, s[4:7], s17 offen offset:0 sc1 lds
    buffer_load_dwordx4 v1, s[4:7], s17 offen offset:1024 sc1 lds
    buffer_load_dwordx4 v1, s[4:7], s17 offen offset:2048 sc1 lds
    buffer_load_dwordx4 v1, s[4:7], s17 offen offset:3072 sc1 lds
    s_cmp_eq_u32 s20, 0
    s_cbranch_scc1 ploopH_29_nt
    s_mov_b32 exec_hi, 0xffff
    buffer_load_dword v60, v0, s[4:7], s31 offen sc1
    s_mov_b32 exec_hi, -1
ploopH_29_nt:
    s_cmp_eq_u32 s59, 0
    s_cbranch_scc1 ofl_37
    s_lshl_b32 s17, s16, 18
    s_add_u32 s17, s17, s60
    buffer_store_dwordx4 v[40:43], v1, s[4:7], s17 offen sc1
    s_mov_b32 s59, 0
ofl_37:
    s_cmp_eq_u32 s30, s54
    s_cbranch_scc1 pnoseg_38
    buffer_store_dwordx4 v[40:43], v7, s[4:7], s30 offen sc1
    s_add_u32 s30, s30, 65536
pnoseg_38:
    s_or_b32 s17, s13, s3
    s_cmp_lg_u32 s17, 0
    s_cbranch_scc1 ploopH_29_npg
    s_sub_u32 s21, s16, 1
    s_cbranch_scc1 ploopH_29_npg
    s_sub_u32 s17, s21, 1
    s_and_b32 s17, s17, 3
    s_cmp_ge_u32 s16, 58
    s_cselect_b32 s17, 0, s17
    s_cmp_lg_u32 s17, 0
    s_cbranch_scc1 ploopH_29_npg
    s_lshl_b32 s17, s12, 7
    s_add_u32 s17, s17, 218112000
    v_mov_b32 v9, s21
    s_mov_b64 exec, 1
    buffer_store_dword v9, off, s[4:7], s17 sc1
    s_mov_b64 exec, -1
ploopH_29_npg:
    s_barrier
    buffer_load_dword v60, off, s[4:7], s33 sc1
    s_add_u32 s16, s16, 1
    v_mov_b32 v59, s16
    s_add_u32 s41, s41, 262144
    s_add_u32 s31, s31, 262144
    s_mov_b32 s54, 0
    s_setprio 3
    s_sleep 13
ploopH_29_pagain:
    buffer_load_dwordx4 v[16:19], v1, s[4:7], s28 offen offset:0 sc1
    buffer_load_dwordx4 v[20:23], v1, s[4:7], s28 offen offset:1024 sc1
    s_waitcnt vmcnt(1)
    v_mfma_f32_16x16x32_bf16 v[32:35], v[12:15], v[16:19], 0
    s_waitcnt vmcnt(0)
    v_mfma_f32_16x16x32_bf16 v[32:35], v[12:15], v[20:23], v[32:35]
    v_max_u32 v9, v16, v20
    v_cmp_eq_u32 vcc, -1, v9
    s_cbranch_vccnz ploopH_29_rp
ploopH_29_pgo:
    s_nop 4
    v_cvt_pk_bf16_f32 v52, v32, v33
    v_cvt_pk_bf16_f32 v53, v34, v35
    s_nop 0
    v_permlane16_swap_b32 v52, v54
    v_permlane16_swap_b32 v53, v55
    s_mov_b64 exec, s[56:57]
    v_min_u32 v52, -2, v52
    buffer_store_dwordx4 v[52:55], v5, s[4:7], s24 offen sc1
    s_mov_b64 exec, -1
    ds_write_b32 v63, v59 offset:16
    s_branch ploopH_29
ploopH_29_rm_0:
    s_sub_u32 s22, s22, 1
    s_cbranch_scc1 ploopH_29_rm_0_g
    buffer_load_dwordx4 v[16:19], v1, s[4:7], s23 offen offset:0 sc1
    buffer_load_dwordx4 v[20:23], v1, s[4:7], s23 offen offset:1024 sc1
    buffer_load_dwordx4 v[24:27], v1, s[4:7], s23 offen offset:2048 sc1
    buffer_load_dwordx4 v[28:31], v1, s[4:7], s23 offen offset:3072 sc1
    s_waitcnt vmcnt(3)
    v_cmp_eq_u32 vcc, -1, v16
    s_cbranch_vccnz ploopH_29_rm_0
    s_branch ploopH_29_rm_0ok
ploopH_29_rm_0_g:
    s_mov_b32 s22, 0
    s_waitcnt vmcnt(0)
    s_branch ploopH_29_rm_0ok
ploopH_29_rm_1:
    s_sub_u32 s22, s22, 1
    s_cbranch_scc1 ploopH_29_rm_1_g
    buffer_load_dwordx4 v[20:23], v1, s[4:7], s23 offen offset:1024 sc1
    buffer_load_dwordx4 v[24:27], v1, s[4:7], s23 offen offset:2048 sc1
    buffer_load_dwordx4 v[28:31], v1, s[4:7], s23 offen offset:3072 sc1
    s_waitcnt vmcnt(2)
    v_cmp_eq_u32 vcc, -1, v20
    s_cbranch_vccnz ploopH_29_rm_1
    s_branch ploopH_29_rm_1ok
ploopH_29_rm_1_g:
    s_mov_b32 s22, 0
    s_waitcnt vmcnt(0)
    s_branch ploopH_29_rm_1ok
ploopH_29_rm_2:
    s_sub_u32 s22, s22, 1
    s_cbranch_scc1 ploopH_29_rm_2_g
    buffer_load_dwordx4 v[24:27], v1, s[4:7], s23 offen offset:2048 sc1
    buffer_load_dwordx4 v[28:31], v1, s[4:7], s23 offen offset:3072 sc1
    s_waitcnt vmcnt(1)
    v_cmp_eq_u32 vcc, -1, v24
    s_cbranch_vccnz ploopH_29_rm_2
    s_branch ploopH_29_rm_2ok
ploopH_29_rm_2_g:
    s_mov_b32 s22, 0
    s_waitcnt vmcnt(0)
    s_branch ploopH_29_rm_2ok
ploopH_29_rm_3:
    s_sub_u32 s22, s22, 1
    s_cbranch_scc1 ploopH_29_rm_3_g
    buffer_load_dwordx4 v[28:31], v1, s[4:7], s23 offen offset:3072 sc1
    s_waitcnt vmcnt(0)
    v_cmp_eq_u32 vcc, -1, v28
    s_cbranch_vccnz ploopH_29_rm_3
    s_branch ploopH_29_rm_3ok
ploopH_29_rm_3_g:
    s_mov_b32 s22, 0
    s_waitcnt vmcnt(0)
    s_branch ploopH_29_rm_3ok
ploopH_29_rp:
    s_sub_u32 s22, s22, 1
    s_cbranch_scc0 ploopH_29_pagain
    s_mov_b32 s22, 0
    s_branch ploopH_29_pgo
ploopH_29_tail:
    ds_read_b128 v[16:19], v6 offset:0
    ds_read_b128 v[20:23], v6 offset:256
    ds_read_b128 v[24:27], v6 offset:512
    ds_read_b128 v[28:31], v6 offset:768
    v_xor_b32 v6, 0x4000, v6
    s_waitcnt lgkmcnt(2)
    v_mfma_f32_16x16x32_bf16 v[40:43], v[12:15], v[16:19], 0
    v_mfma_f32_16x16x32_bf16 v[40:43], v[48:51], v[20:23], v[40:43]
    s_waitcnt lgkmcnt(0)
    v_mfma_f32_16x16x32_bf16 v[44:47], v[12:15], v[24:27], 0
    v_mfma_f32_16x16x32_bf16 v[44:47], v[48:51], v[28:31], v[44:47]
    s_nop 7
    v_cvt_pk_bf16_f32 v40, v40, v41
    v_cvt_pk_bf16_f32 v41, v42, v43
    v_cvt_pk_bf16_f32 v42, v44, v45
    v_cvt_pk_bf16_f32 v43, v46, v47
    s_nop 1
    v_permlane16_swap_b32 v40, v42
    v_permlane16_swap_b32 v41, v43
    s_nop 1
    v_min_u32 v40, -2, v40
    buffer_store_dwordx4 v[40:43], v7, s[4:7], s30 offen sc1
    s_add_u32 s30, s30, 65536
    s_barrier
    ds_read_b128 v[16:19], v6 offset:0
    ds_read_b128 v[20:23], v6 offset:256
    ds_read_b128 v[24:27], v6 offset:512
    ds_read_b128 v[28:31], v6 offset:768
    v_xor_b32 v6, 0x4000, v6
    s_waitcnt lgkmcnt(2)
    v_mfma_f32_16x16x32_bf16 v[40:43], v[12:15], v[16:19], 0
    v_mfma_f32_16x16x32_bf16 v[40:43], v[48:51], v[20:23], v[40:43]
    s_waitcnt lgkmcnt(0)
    v_mfma_f32_16x16x32_bf16 v[44:47], v[12:15], v[24:27], 0
    v_mfma_f32_16x16x32_bf16 v[44:47], v[48:51], v[28:31], v[44:47]
    s_nop 7
    v_cvt_pk_bf16_f32 v40, v40, v41
    v_cvt_pk_bf16_f32 v41, v42, v43
    v_cvt_pk_bf16_f32 v42, v44, v45
    v_cvt_pk_bf16_f32 v43, v46, v47
    s_nop 1
    v_permlane16_swap_b32 v40, v42
    v_permlane16_swap_b32 v41, v43
    s_nop 1
    v_min_u32 v40, -2, v40
    buffer_store_dwordx4 v[40:43], v7, s[4:7], s30 offen sc1
    s_add_u32 s30, s30, 65536
    s_branch k_end
ch_a_pro:
    s_sub_u32 s21, s3, 4
    s_lshl_b32 s15, s14, 2
    s_add_u32 s15, s15, s21
    s_lshl_b32 s38, s15, 13
    s_add_u32 s38, s38, 214958080
    s_cmp_lg_u32 s3, 7
    s_cbranch_scc1 ch_nrp
    s_mov_b32 s95, 0x10000
rp_39:
    buffer_load_dword v28, off, s[64:67], 0 offset:224 sc1
    s_waitcnt vmcnt(0)
    v_readfirstlane_b32 s96, v28
    s_cmp_lg_u32 s96, 0
    s_cbranch_scc1 rp_39_ok
    s_sleep 2
    s_sub_u32 s95, s95, 1
    s_cbranch_scc0 rp_39
    s_add_u32 s96, s97, 1
rp_39_ok:
    s_sub_u32 s96, s96, 1
    v_mov_b32 v27, 131136
    v_mov_b32 v28, s96
    ds_write_b32 v27, v28
    s_waitcnt lgkmcnt(0)
ch_nrp:
    s_barrier
    v_mov_b32 v27, 131136
    ds_read_b32 v27, v27
    s_mov_b32 s96, s97
    s_waitcnt lgkmcnt(0)
    v_readfirstlane_b32 s97, v27
    s_cmp_lg_u32 s96, s97
    s_cbranch_scc1 k_restart
    s_min_u32 s20, s21, 2
    s_lshl_b32 s18, s20, 3
    s_add_u32 s18, s18, 16
    s_load_dwordx2 s[8:9], s[0:1], s18
    s_mov_b32 s10, 8388608
    s_mov_b32 s11, 131072
    v_and_b32 v20, 63, v0
    v_lshlrev_b32 v21, 13, v20
    s_lshl_b32 s17, s34, 19
    s_lshl_b32 s18, s14, 10
    s_add_u32 s17, s17, s18
    s_waitcnt lgkmcnt(0)
    buffer_load_dword v26, v21, s[8:11], s17 offen offset:384
    v_and_b32 v20, 63, v0
    v_lshrrev_b32 v21, 4, v20
    v_bfe_u32 v22, v20, 1, 1
    v_xor_b32 v22, 1, v22
    v_lshl_add_u32 v23, v22, 2, v21
    v_bfe_u32 v22, v20, 2, 2
    v_and_b32 v24, 1, v20
    v_lshl_add_u32 v22, v22, 1, v24
    v_lshl_add_u32 v23, v23, 3, v22
    v_and_b32 v22, 7, v20
    v_lshlrev_b32 v23, 4, v23
    s_lshl_b32 s17, s21, 10
    s_add_u32 s17, s17, 16384
    v_add_u32 v160, s17, v23
    v_and_b32 v24, 15, v20
    v_lshlrev_b32 v24, 4, v24
    v_lshl_add_u32 v23, v21, 10, v24
    s_lshl_b32 s17, s21, 8
    s_add_u32 s17, s17, 16384
    v_add_u32 v161, s17, v23
    v_lshl_add_u32 v23, v21, 9, v24
    s_lshl_b32 s17, s21, 12
    s_add_u32 s17, s17, 32768
    v_add_u32 v162, s17, v23
    v_bfe_u32 v23, v20, 3, 1
    v_lshlrev_b32 v23, 10, v23
    v_lshl_add_u32 v23, v22, 4, v23
    v_lshlrev_b32 v1, 4, v20
    s_lshl_b32 s39, s34, 14
    s_lshl_b32 s17, s21, 11
    s_add_u32 s39, s39, s17
    s_lshl_b32 s17, s14, 8
    s_add_u32 s39, s39, s17
    s_add_u32 s39, s39, 209715200
    v_mov_b32 v176, -1
    v_mov_b32 v177, -1
    v_mov_b32 v178, -1
    v_mov_b32 v179, -1
    v_lshlrev_b32 v24, 4, v0
    s_lshl_b32 s17, s52, 13
    s_add_u32 s19, s17, 209711104
    s_add_u32 s17, s17, 214953984
    s_lshl_b32 s18, s52, 12
    s_add_u32 s18, s18, 213905408
    buffer_store_dwordx4 v[176:179], v24, s[4:7], s19 offen sc1
    s_add_u32 s19, s19, 4096
    buffer_store_dwordx4 v[176:179], v24, s[4:7], s19 offen sc1
    buffer_store_dwordx4 v[176:179], v24, s[4:7], s17 offen sc1
    s_add_u32 s17, s17, 4096
    buffer_store_dwordx4 v[176:179], v24, s[4:7], s17 offen sc1
    buffer_store_dwordx4 v[176:179], v24, s[4:7], s18 offen sc1
    s_and_b32 s17, s13, 7
    s_sub_u32 s18, s21, 1
    s_cmp_lt_u32 s18, 2
    s_cselect_b32 s54, s17, 1
    s_lshr_b32 s19, s52, 3
    s_lshl_b32 s19, s19, 8
    s_lshl_b32 s18, s18, 7
    s_add_u32 s19, s19, s18
    s_add_u32 s55, s19, 210763776
    s_cmp_lg_u32 s54, 0
    s_cbranch_scc1 ch_nv0
    v_lshlrev_b32 v24, 13, v20
    s_mov_b64 exec, 0xffff
    buffer_store_dword v176, v24, s[4:7], s55 offen sc1
    s_mov_b64 exec, -1
ch_nv0:
    v_mov_b32 v2, s40
    s_lshl_b32 s17, s12, 2
    s_add_u32 s17, s17, 128
    s_waitcnt vmcnt(0)
    s_barrier
    s_cmp_lg_u32 s3, 4
    s_cbranch_scc1 ch_nox
    s_mov_b64 exec, 1
    buffer_atomic_add v2, off, s[64:67], s17 sc1
    s_mov_b64 exec, -1
ch_nox:
    v_and_b32 v20, 63, v0
    v_lshlrev_b32 v0, 4, v20
    s_lshl_b32 s17, s15, 18
    s_lshl_b32 s18, s34, 7
    s_add_u32 s17, s17, s18
    s_lshl_b32 s19, s21, 13
    s_add_u32 s19, s19, 131072
    s_load_dwordx2 s[8:9], s[0:1], 40
    s_mov_b32 s10, 8388608
    s_mov_b32 s11, 131072
    v_lshrrev_b32 v21, 3, v20
    v_and_b32 v22, 7, v20
    v_lshlrev_b32 v21, 11, v21
    v_lshl_add_u32 v21, v22, 4, v21
    v_lshrrev_b32 v28, 4, v20
    v_and_b32 v29, 1, v28
    v_xor_b32 v29, 0, v29
    v_lshlrev_b32 v29, 2, v29
    v_lshl_add_u32 v29, v28, 3, v29
    v_bfe_u32 v28, v20, 2, 2
    v_add_u32 v29, v29, v28
    v_lshlrev_b32 v29, 7, v29
    v_and_b32 v28, 3, v20
    v_lshl_add_u32 v29, v28, 4, v29
    v_and_b32 v28, 1, v28
    v_xor_b32 v28, 0, v28
    v_lshl_add_u32 v24, v28, 3, v29
    v_add_u32 v24, s19, v24
    v_lshrrev_b32 v28, 4, v20
    v_and_b32 v29, 1, v28
    v_xor_b32 v29, 1, v29
    v_lshlrev_b32 v29, 2, v29
    v_lshl_add_u32 v29, v28, 3, v29
    v_bfe_u32 v28, v20, 2, 2
    v_add_u32 v29, v29, v28
    v_lshlrev_b32 v29, 7, v29
    v_and_b32 v28, 3, v20
    v_lshl_add_u32 v29, v28, 4, v29
    v_and_b32 v28, 1, v28
    v_xor_b32 v28, 0, v28
    v_lshl_add_u32 v25, v28, 3, v29
    v_add_u32 v25, s19, v25
    v_lshrrev_b32 v28, 4, v20
    v_and_b32 v29, 1, v28
    v_xor_b32 v29, 0, v29
    v_lshlrev_b32 v29, 2, v29
    v_lshl_add_u32 v29, v28, 3, v29
    v_bfe_u32 v28, v20, 2, 2
    v_add_u32 v29, v29, v28
    v_lshlrev_b32 v29, 7, v29
    v_and_b32 v28, 3, v20
    v_lshl_add_u32 v29, v28, 4, v29
    v_and_b32 v28, 1, v28
    v_xor_b32 v28, 1, v28
    v_lshl_add_u32 v26, v28, 3, v29
    v_add_u32 v26, s19, v26
    v_lshrrev_b32 v28, 4, v20
    v_and_b32 v29, 1, v28
    v_xor_b32 v29, 1, v29
    v_lshlrev_b32 v29, 2, v29
    v_lshl_add_u32 v29, v28, 3, v29
    v_bfe_u32 v28, v20, 2, 2
    v_add_u32 v29, v29, v28
    v_lshlrev_b32 v29, 7, v29
    v_and_b32 v28, 3, v20
    v_lshl_add_u32 v29, v28, 4, v29
    v_and_b32 v28, 1, v28
    v_xor_b32 v28, 1, v28
    v_lshl_add_u32 v27, v28, 3, v29
    v_add_u32 v27, s19, v27
    s_waitcnt lgkmcnt(0)
    s_add_u32 m0, s19, 0
    s_nop 0
    buffer_load_dwordx4 v21, s[8:11], s17 offen lds
    s_add_u32 s17, s17, 16384
    s_add_u32 m0, s19, 1024
    s_nop 0
    buffer_load_dwordx4 v21, s[8:11], s17 offen lds
    s_add_u32 s17, s17, 16384
    s_add_u32 m0, s19, 2048
    s_nop 0
    buffer_load_dwordx4 v21, s[8:11], s17 offen lds
    s_add_u32 s17, s17, 16384
    s_add_u32 m0, s19, 3072
    s_nop 0
    buffer_load_dwordx4 v21, s[8:11], s17 offen lds
    s_add_u32 s17, s17, 16384
    s_add_u32 m0, s19, 4096
    s_nop 0
    buffer_load_dwordx4 v21, s[8:11], s17 offen lds
    s_add_u32 s17, s17, 16384
    s_add_u32 m0, s19, 5120
    s_nop 0
    buffer_load_dwordx4 v21, s[8:11], s17 offen lds
    s_add_u32 s17, s17, 16384
    s_add_u32 m0, s19, 6144
    s_nop 0
    buffer_load_dwordx4 v21, s[8:11], s17 offen lds
    s_add_u32 s17, s17, 16384
    s_add_u32 m0, s19, 7168
    s_nop 0
    buffer_load_dwordx4 v21, s[8:11], s17 offen lds
    s_add_u32 s17, s17, 16384
    buffer_load_dwordx4 v[96:99], v21, s[8:11], s17 offen
    s_add_u32 s17, s17, 16384
    buffer_load_dwordx4 v[100:103], v21, s[8:11], s17 offen
    s_add_u32 s17, s17, 16384
    buffer_load_dwordx4 v[104:107], v21, s[8:11], s17 offen
    s_add_u32 s17, s17, 16384
    buffer_load_dwordx4 v[108:111], v21, s[8:11], s17 offen
    s_add_u32 s17, s17, 16384
    buffer_load_dwordx4 v[112:115], v21, s[8:11], s17 offen
    s_add_u32 s17, s17, 16384
    buffer_load_dwordx4 v[116:119], v21, s[8:11], s17 offen
    s_add_u32 s17, s17, 16384
    buffer_load_dwordx4 v[120:123], v21, s[8:11], s17 offen
    s_add_u32 s17, s17, 16384
    buffer_load_dwordx4 v[124:127], v21, s[8:11], s17 offen
    s_add_u32 s17, s17, 16384
    s_cmp_lg_u32 s54, 0
    s_cbranch_scc1 ch_nv1
    s_mov_b32 s58, -1
    s_mov_b32 s59, -1
    s_memtime s[60:61]
    s_add_u32 s56, s55, 0
    s_waitcnt lgkmcnt(0)
    s_load_dword s57, s[4:5], s56 glc
    s_waitcnt lgkmcnt(0)
    s_memtime s[62:63]
    s_waitcnt lgkmcnt(0)
    s_sub_u32 s57, s62, s60
    s_min_u32 s58, s58, s57
    s_memtime s[60:61]
    s_add_u32 s56, s55, 8192
    s_waitcnt lgkmcnt(0)
    s_load_dword s57, s[4:5], s56 glc
    s_waitcnt lgkmcnt(0)
    s_memtime s[62:63]
    s_waitcnt lgkmcnt(0)
    s_sub_u32 s57, s62, s60
    s_min_u32 s59, s59, s57
    s_memtime s[60:61]
    s_add_u32 s56, s55, 16384
    s_waitcnt lgkmcnt(0)
    s_load_dword s57, s[4:5], s56 glc
    s_waitcnt lgkmcnt(0)
    s_memtime s[62:63]
    s_waitcnt lgkmcnt(0)
    s_sub_u32 s57, s62, s60
    s_min_u32 s58, s58, s57
    s_memtime s[60:61]
    s_add_u32 s56, s55, 24576
    s_waitcnt lgkmcnt(0)
    s_load_dword s57, s[4:5], s56 glc
    s_waitcnt lgkmcnt(0)
    s_memtime s[62:63]
    s_waitcnt lgkmcnt(0)
    s_sub_u32 s57, s62, s60
    s_min_u32 s59, s59, s57
    s_memtime s[60:61]
    s_add_u32 s56, s55, 32768
    s_waitcnt lgkmcnt(0)
    s_load_dword s57, s[4:5], s56 glc
    s_waitcnt lgkmcnt(0)
    s_memtime s[62:63]
    s_waitcnt lgkmcnt(0)
    s_sub_u32 s57, s62, s60
    s_min_u32 s58, s58, s57
    s_memtime s[60:61]
    s_add_u32 s56, s55, 40960
    s_waitcnt lgkmcnt(0)
    s_load_dword s57, s[4:5], s56 glc
    s_waitcnt lgkmcnt(0)
    s_memtime s[62:63]
    s_waitcnt lgkmcnt(0)
    s_sub_u32 s57, s62, s60
    s_min_u32 s59, s59, s57
    s_memtime s[60:61]
    s_add_u32 s56, s55, 49152
    s_waitcnt lgkmcnt(0)
    s_load_dword s57, s[4:5], s56 glc
    s_waitcnt lgkmcnt(0)
    s_memtime s[62:63]
    s_waitcnt lgkmcnt(0)
    s_sub_u32 s57, s62, s60
    s_min_u32 s58, s58, s57
    s_memtime s[60:61]
    s_add_u32 s56, s55, 57344
    s_waitcnt lgkmcnt(0)
    s_load_dword s57, s[4:5], s56 glc
    s_waitcnt lgkmcnt(0)
    s_memtime s[62:63]
    s_waitcnt lgkmcnt(0)
    s_sub_u32 s57, s62, s60
    s_min_u32 s59, s59, s57
    s_memtime s[60:61]
    s_add_u32 s56, s55, 65536
    s_waitcnt lgkmcnt(0)
    s_load_dword s57, s[4:5], s56 glc
    s_waitcnt lgkmcnt(0)
    s_memtime s[62:63]
    s_waitcnt lgkmcnt(0)
    s_sub_u32 s57, s62, s60
    s_min_u32 s58, s58, s57
    s_memtime s[60:61]
    s_add_u32 s56, s55, 73728
    s_waitcnt lgkmcnt(0)
    s_load_dword s57, s[4:5], s56 glc
    s_waitcnt lgkmcnt(0)
    s_memtime s[62:63]
    s_waitcnt lgkmcnt(0)
    s_sub_u32 s57, s62, s60
    s_min_u32 s59, s59, s57
    s_memtime s[60:61]
    s_add_u32 s56, s55, 81920
    s_waitcnt lgkmcnt(0)
    s_load_dword s57, s[4:5], s56 glc
    s_waitcnt lgkmcnt(0)
    s_memtime s[62:63]
    s_waitcnt lgkmcnt(0)
    s_sub_u32 s57, s62, s60
    s_min_u32 s58, s58, s57
    s_memtime s[60:61]
    s_add_u32 s56, s55, 90112
    s_waitcnt lgkmcnt(0)
    s_load_dword s57, s[4:5], s56 glc
    s_waitcnt lgkmcnt(0)
    s_memtime s[62:63]
    s_waitcnt lgkmcnt(0)
    s_sub_u32 s57, s62, s60
    s_min_u32 s59, s59, s57
    s_memtime s[60:61]
    s_add_u32 s56, s55, 98304
    s_waitcnt lgkmcnt(0)
    s_load_dword s57, s[4:5], s56 glc
    s_waitcnt lgkmcnt(0)
    s_memtime s[62:63]
    s_waitcnt lgkmcnt(0)
    s_sub_u32 s57, s62, s60
    s_min_u32 s58, s58, s57
    s_memtime s[60:61]
    s_add_u32 s56, s55, 106496
    s_waitcnt lgkmcnt(0)
    s_load_dword s57, s[4:5], s56 glc
    s_waitcnt lgkmcnt(0)
    s_memtime s[62:63]
    s_waitcnt lgkmcnt(0)
    s_sub_u32 s57, s62, s60
    s_min_u32 s59, s59, s57
    s_memtime s[60:61]
    s_add_u32 s56, s55, 114688
    s_waitcnt lgkmcnt(0)
    s_load_dword s57, s[4:5], s56 glc
    s_waitcnt lgkmcnt(0)
    s_memtime s[62:63]
    s_waitcnt lgkmcnt(0)
    s_sub_u32 s57, s62, s60
    s_min_u32 s58, s58, s57
    s_memtime s[60:61]
    s_add_u32 s56, s55, 122880
    s_waitcnt lgkmcnt(0)
    s_load_dword s57, s[4:5], s56 glc
    s_waitcnt lgkmcnt(0)
    s_memtime s[62:63]
    s_waitcnt lgkmcnt(0)
    s_sub_u32 s57, s62, s60
    s_min_u32 s59, s59, s57
    s_sub_i32 s57, s58, s59
    s_min_i32 s57, s57, 400
    s_max_i32 s57, s57, -400
    s_add_u32 s57, s57, 16777616
    s_getreg_b32 s56, hwreg(HW_REG_XCC_ID)
    s_and_b32 s56, s56, 0
    v_mov_b32 v2, s57
    s_mov_b64 exec, 1
    buffer_atomic_add v2, off, s[64:67], s56 offset:160 sc1
    s_mov_b64 exec, -1
    s_waitcnt vmcnt(0)
ch_nv1:
    s_lshl_b32 s19, s21, 13
    s_add_u32 s19, s19, 131072
    v_add_u32 v30, s19, v0
    s_waitcnt vmcnt(8)
    ds_read_b64_tr_b16 v[192:193], v24 offset:0
    ds_read_b64_tr_b16 v[194:195], v25 offset:0
    ds_read_b64_tr_b16 v[208:209], v26 offset:0
    ds_read_b64_tr_b16 v[210:211], v27 offset:0
    ds_read_b64_tr_b16 v[224:225], v24 offset:64
    ds_read_b64_tr_b16 v[226:227], v25 offset:64
    ds_read_b64_tr_b16 v[240:241], v26 offset:64
    ds_read_b64_tr_b16 v[242:243], v27 offset:64
    s_waitcnt lgkmcnt(0)
    ds_read_b64_tr_b16 v[196:197], v24 offset:4096
    ds_read_b64_tr_b16 v[198:199], v25 offset:4096
    ds_read_b64_tr_b16 v[212:213], v26 offset:4096
    ds_read_b64_tr_b16 v[214:215], v27 offset:4096
    ds_read_b64_tr_b16 v[228:229], v24 offset:4160
    ds_read_b64_tr_b16 v[230:231], v25 offset:4160
    ds_read_b64_tr_b16 v[244:245], v26 offset:4160
    ds_read_b64_tr_b16 v[246:247], v27 offset:4160
    s_waitcnt lgkmcnt(0)
    s_waitcnt vmcnt(0)
    ds_write_b128 v30, v[96:99] offset:0
    ds_write_b128 v30, v[100:103] offset:1024
    ds_write_b128 v30, v[104:107] offset:2048
    ds_write_b128 v30, v[108:111] offset:3072
    ds_write_b128 v30, v[112:115] offset:4096
    ds_write_b128 v30, v[116:119] offset:5120
    ds_write_b128 v30, v[120:123] offset:6144
    ds_write_b128 v30, v[124:127] offset:7168
    s_waitcnt lgkmcnt(0)
    ds_read_b64_tr_b16 v[200:201], v24 offset:0
    ds_read_b64_tr_b16 v[202:203], v25 offset:0
    ds_read_b64_tr_b16 v[216:217], v26 offset:0
    ds_read_b64_tr_b16 v[218:219], v27 offset:0
    ds_read_b64_tr_b16 v[232:233], v24 offset:64
    ds_read_b64_tr_b16 v[234:235], v25 offset:64
    ds_read_b64_tr_b16 v[248:249], v26 offset:64
    ds_read_b64_tr_b16 v[250:251], v27 offset:64
    s_waitcnt lgkmcnt(0)
    ds_read_b64_tr_b16 v[204:205], v24 offset:4096
    ds_read_b64_tr_b16 v[206:207], v25 offset:4096
    ds_read_b64_tr_b16 v[220:221], v26 offset:4096
    ds_read_b64_tr_b16 v[222:223], v27 offset:4096
    ds_read_b64_tr_b16 v[236:237], v24 offset:4160
    ds_read_b64_tr_b16 v[238:239], v25 offset:4160
    ds_read_b64_tr_b16 v[252:253], v26 offset:4160
    ds_read_b64_tr_b16 v[254:255], v27 offset:4160
    s_waitcnt lgkmcnt(0)
    v_lshrrev_b32 v21, 4, v20
    v_and_b32 v22, 2, v20
    v_cmp_eq_u32 s[56:57], 2, v22
    v_and_b32 v23, 15, v20
    v_lshlrev_b32 v21, 2, v21
    v_mov_b32 v8, 0x44444444
    v_mov_b32 v9, 0xeeeeeeee
    v_cndmask_b32 v166, v8, v9, s[56:57]
    v_mov_b32 v8, 0x3f803f80
    v_mov_b32 v9, 0
    v_mov_b32 v10, 0
    v_mov_b32 v11, 0
    v_mov_b32 v4, 0x3f803f80
    v_mov_b32 v5, 0x3f803f80
    v_mov_b32 v6, 0x3f803f80
    v_mov_b32 v7, 0x3f803f80
    s_mov_b32 s29, 0x3e0293ee
    s_lshl_b32 s27, s13, 2
    s_add_u32 s27, s27, s21
    s_lshl_b32 s28, s12, 7
    s_add_u32 s28, s28, 218112000
    v_add_u32 v163, s42, v0
    s_lshl_b32 s17, s21, 2
    s_add_u32 s17, s17, 15872
    v_mov_b32 v164, s17
    v_mov_b32 v167, 15872
    v_and_b32 v24, 15, v20
    v_and_b32 v25, 1, v24
    v_lshlrev_b32 v25, 4, v25
    v_mov_b32 v184, 0x3f80
    v_lshlrev_b32 v25, v25, v184
    v_lshrrev_b32 v24, 1, v24
    v_cmp_eq_u32 vcc, 0, v24
    s_nop 1
    v_cndmask_b32 v184, 0, v25, vcc
    v_cmp_eq_u32 vcc, 1, v24
    s_nop 1
    v_cndmask_b32 v185, 0, v25, vcc
    v_cmp_eq_u32 vcc, 2, v24
    s_nop 1
    v_cndmask_b32 v186, 0, v25, vcc
    v_cmp_eq_u32 vcc, 3, v24
    s_nop 1
    v_cndmask_b32 v187, 0, v25, vcc
    v_lshrrev_b32 v24, 4, v20
    v_bfe_u32 v25, v20, 2, 2
    v_and_b32 v26, 1, v20
    v_lshl_add_u32 v26, v25, 1, v26
    v_lshlrev_b32 v26, 4, v26
    v_lshl_add_u32 v26, v24, 8, v26
    v_bfe_u32 v27, v20, 1, 1
    v_lshl_add_u32 v26, v27, 2, v26
    s_add_u32 s17, s42, 20480
    v_add_u32 v180, s17, v26
    v_and_b32 v26, 3, v20
    v_lshl_add_u32 v27, v24, 2, v25
    v_lshl_add_u32 v27, v26, 4, v27
    v_lshlrev_b32 v27, 4, v27
    v_add_u32 v181, s42, v27
    v_and_b32 v25, 1, v25
    v_lshl_add_u32 v25, v24, 1, v25
    v_lshl_add_u32 v25, v26, 3, v25
    v_lshlrev_b32 v25, 4, v25
    v_add_u32 v182, s17, v25
    s_bfe_u32 s17, s34, 0x20001
    s_lshr_b32 s30, s34, 3
    s_cmp_eq_u32 s17, s21
    s_cselect_b32 s30, s30, 2
    s_and_b32 s33, s34, 1
    s_lshl_b32 s33, s33, 17
    s_mov_b32 s32, 0
    v_add_u32 v24, 0, v21
    v_cmp_gt_u32 s[44:45], v24, v23
    v_add_u32 v24, 1, v21
    v_cmp_gt_u32 s[46:47], v24, v23
    v_add_u32 v24, 2, v21
    v_cmp_gt_u32 s[48:49], v24, v23
    v_add_u32 v24, 3, v21
    v_cmp_gt_u32 s[50:51], v24, v23
    s_cmp_lg_u32 s3, 4
    s_cbranch_scc1 ch_xcc_skip
    v_lshrrev_b32 v56, 2, v0
    v_add_u32 v56, 128, v56
    v_writelane_b32 v56, 0, 10
    v_mov_b32 v59, 63
    v_mov_b32 v60, 32
    v_writelane_b32 v59, 0, 8
    v_writelane_b32 v60, 0, 8
    v_writelane_b32 v59, 0, 9
    v_writelane_b32 v60, 0, 9
    v_writelane_b32 v59, -1, 10
    s_movk_i32 s17, 128
    v_writelane_b32 v60, s17, 10
    s_mov_b64 exec, 0x70f
ch_xcc:
    buffer_load_dword v57, v56, s[64:67], 0 offen sc1
    s_waitcnt vmcnt(0)
    v_and_b32 v62, v59, v57
    v_cmp_ne_u32 vcc, v62, v60
    v_readlane_b32 s18, v57, 8
    v_readlane_b32 s19, v57, 9
    s_add_u32 s17, s18, s19
    s_lshr_b32 s17, s17, 24
    s_cmp_lg_u32 s17, 32
    s_cbranch_scc1 ch_xcc_w
    s_cbranch_vccz ch_xcc_ok
ch_xcc_w:
    s_sleep 16
    s_sub_u32 s22, s22, 1
    s_cbranch_scc0 ch_xcc
    s_mov_b32 s22, 0
ch_xcc_ok:
    s_getreg_b32 s17, hwreg(HW_REG_XCC_ID)
    s_bitcmp1_b32 s17, 2
    s_cselect_b32 s18, s18, s18
    v_readlane_b32 s17, v57, s12
    s_mov_b64 exec, -1
    s_lshr_b32 s19, s18, 24
    s_mul_i32 s19, s19, 400
    s_and_b32 s18, s18, 0xffffff
    s_cmp_gt_u32 s18, s19
    s_cselect_b32 s18, 8192, 0
    v_mov_b32 v58, 15968
    v_mov_b32 v60, s17
    v_mov_b32 v61, s18
    s_barrier
    ds_write_b64 v58, v[60:61]
    s_waitcnt lgkmcnt(0)
    s_branch ch_xcc_b3
ch_xcc_skip:
    s_barrier
ch_xcc_b3:
    s_barrier
    v_mov_b32 v58, 15968
    ds_read_b64 v[60:61], v58
    v_and_b32 v23, 7, v20
    v_lshlrev_b32 v23, 7, v23
    v_bfe_u32 v24, v20, 3, 1
    v_lshl_add_u32 v23, v24, 17, v23
    v_lshrrev_b32 v24, 4, v20
    v_lshl_add_u32 v23, v24, 24, v23
    s_lshl_b32 s19, s14, 14
    s_lshl_b32 s18, s34, 10
    s_add_u32 s19, s19, s18
    s_and_b32 s18, s21, 1
    s_lshl_b32 s18, s18, 18
    s_add_u32 s19, s19, s18
    s_add_u32 s19, s19, 4456448
    s_waitcnt lgkmcnt(0)
    v_readfirstlane_b32 s17, v61
    s_add_u32 s39, s39, s17
ch_g0:
    buffer_load_dword v57, off, s[4:7], s35 sc1
    s_waitcnt vmcnt(0)
    v_readfirstlane_b32 s17, v57
    s_cmp_ge_u32 s17, 8
    s_cbranch_scc1 ch_g0b
    s_sleep 3
    s_sub_u32 s22, s22, 1
    s_cbranch_scc0 ch_g0
    s_mov_b32 s22, 0
ch_g0b:
    s_add_u32 s23, s41, 37748736
    buffer_load_dwordx4 v[128:131], v0, s[4:7], s23 offen offset:0 sc1
    buffer_load_dwordx4 v[132:135], v0, s[4:7], s23 offen offset:1024 sc1
    buffer_load_dwordx4 v[136:139], v0, s[4:7], s23 offen offset:2048 sc1
    buffer_load_dwordx4 v[140:143], v0, s[4:7], s23 offen offset:3072 sc1
    s_add_u32 s24, s41, 37879808
    buffer_load_dwordx4 v[144:147], v0, s[4:7], s24 offen offset:0 sc1
    buffer_load_dwordx4 v[148:151], v0, s[4:7], s24 offen offset:1024 sc1
    buffer_load_dwordx4 v[152:155], v0, s[4:7], s24 offen offset:2048 sc1
    buffer_load_dwordx4 v[156:159], v0, s[4:7], s24 offen offset:3072 sc1
    s_add_u32 s23, s41, 20971520
    buffer_load_dwordx4 v[96:99], v0, s[4:7], s23 offen offset:0 sc1
    buffer_load_dwordx4 v[100:103], v0, s[4:7], s23 offen offset:1024 sc1
    buffer_load_dwordx4 v[104:107], v0, s[4:7], s23 offen offset:2048 sc1
    buffer_load_dwordx4 v[108:111], v0, s[4:7], s23 offen offset:3072 sc1
    s_add_u32 s24, s41, 21102592
    buffer_load_dwordx4 v[112:115], v0, s[4:7], s24 offen offset:0 sc1
    buffer_load_dwordx4 v[116:119], v0, s[4:7], s24 offen offset:1024 sc1
    buffer_load_dwordx4 v[120:123], v0, s[4:7], s24 offen offset:2048 sc1
    buffer_load_dwordx4 v[124:127], v0, s[4:7], s24 offen offset:3072 sc1
    s_mov_b32 exec_hi, 0xffff
    buffer_load_dword v175, v23, s[4:7], s19 offen sc1
    s_mov_b32 exec_hi, -1
    v_mov_b32 v165, 0
    s_waitcnt vmcnt(1)
    ds_write_b32 v164, v165 offset:16
.p2align 6
aloopL_41:
    s_and_b32 s23, s16, 3
    s_lshl_b32 s23, s23, 18
    s_add_u32 s23, s23, s38
    s_add_u32 s24, s23, 4096
    s_and_b32 s25, s16, 3
    s_lshl_b32 s25, s25, 18
    s_add_u32 s25, s25, s39
    s_add_u32 s26, s16, 2
    s_and_b32 s26, s26, 3
    s_lshl_b32 s26, s26, 18
    s_add_u32 s26, s26, s39
    v_mov_b32 v165, s16
    s_waitcnt vmcnt(8)
    s_and_b32 s31, s16, 1
    s_cmp_lt_u32 s16, 16
    s_cselect_b32 s31, 3, s31
    s_cmp_lg_u32 s31, s30
    s_cbranch_scc1 aloopL_41_nd0
    ds_write_b128 v163, v[128:131] offset:0
    ds_write_b128 v163, v[132:135] offset:1024
    ds_write_b128 v163, v[136:139] offset:2048
    ds_write_b128 v163, v[140:143] offset:3072
    ds_write_b128 v163, v[144:147] offset:4096
    ds_write_b128 v163, v[148:151] offset:5120
    ds_write_b128 v163, v[152:155] offset:6144
    ds_write_b128 v163, v[156:159] offset:7168
aloopL_41_nd0:
    v_mfma_f32_16x16x32_bf16 v[48:51], v[128:131], v[192:195], 0
    v_mfma_f32_16x16x32_bf16 v[52:55], v[128:131], v[208:211], 0
    v_mfma_f32_16x16x32_bf16 v[56:59], v[128:131], v[224:227], 0
    v_mfma_f32_16x16x32_bf16 v[60:63], v[128:131], v[240:243], 0
    v_mfma_f32_16x16x32_bf16 v[64:67], v[144:147], v[192:195], 0
    v_mfma_f32_16x16x32_bf16 v[68:71], v[144:147], v[208:211], 0
    v_mfma_f32_16x16x32_bf16 v[72:75], v[144:147], v[224:227], 0
    v_mfma_f32_16x16x32_bf16 v[76:79], v[144:147], v[240:243], 0
    v_mfma_f32_16x16x32_bf16 v[48:51], v[132:135], v[196:199], v[48:51]
    v_mfma_f32_16x16x32_bf16 v[52:55], v[132:135], v[212:215], v[52:55]
    v_mfma_f32_16x16x32_bf16 v[56:59], v[132:135], v[228:231], v[56:59]
    v_mfma_f32_16x16x32_bf16 v[60:63], v[132:135], v[244:247], v[60:63]
    v_mfma_f32_16x16x32_bf16 v[64:67], v[148:151], v[196:199], v[64:67]
    v_mfma_f32_16x16x32_bf16 v[68:71], v[148:151], v[212:215], v[68:71]
    v_mfma_f32_16x16x32_bf16 v[72:75], v[148:151], v[228:231], v[72:75]
    v_mfma_f32_16x16x32_bf16 v[76:79], v[148:151], v[244:247], v[76:79]
    v_mfma_f32_16x16x32_bf16 v[48:51], v[136:139], v[200:203], v[48:51]
    v_mfma_f32_16x16x32_bf16 v[52:55], v[136:139], v[216:219], v[52:55]
    v_mfma_f32_16x16x32_bf16 v[56:59], v[136:139], v[232:235], v[56:59]
    v_mfma_f32_16x16x32_bf16 v[60:63], v[136:139], v[248:251], v[60:63]
    v_mfma_f32_16x16x32_bf16 v[64:67], v[152:155], v[200:203], v[64:67]
    v_mfma_f32_16x16x32_bf16 v[68:71], v[152:155], v[216:219], v[68:71]
    v_mfma_f32_16x16x32_bf16 v[72:75], v[152:155], v[232:235], v[72:75]
    v_mfma_f32_16x16x32_bf16 v[76:79], v[152:155], v[248:251], v[76:79]
    v_mfma_f32_16x16x32_bf16 v[48:51], v[140:143], v[204:207], v[48:51]
    v_mfma_f32_16x16x32_bf16 v[52:55], v[140:143], v[220:223], v[52:55]
    v_mfma_f32_16x16x32_bf16 v[56:59], v[140:143], v[236:239], v[56:59]
    v_mfma_f32_16x16x32_bf16 v[60:63], v[140:143], v[252:255], v[60:63]
    v_mfma_f32_16x16x32_bf16 v[64:67], v[156:159], v[204:207], v[64:67]
    v_mfma_f32_16x16x32_bf16 v[68:71], v[156:159], v[220:223], v[68:71]
    v_mfma_f32_16x16x32_bf16 v[72:75], v[156:159], v[236:239], v[72:75]
    v_mfma_f32_16x16x32_bf16 v[76:79], v[156:159], v[252:255], v[76:79]
    s_nop 2
    v_cvt_pk_bf16_f32 v80, v48, v49
    v_cvt_pk_bf16_f32 v81, v50, v51
    v_cvt_pk_bf16_f32 v82, v64, v65
    v_cvt_pk_bf16_f32 v83, v66, v67
    v_cvt_pk_bf16_f32 v84, v52, v53
    v_cvt_pk_bf16_f32 v85, v54, v55
    v_cvt_pk_bf16_f32 v86, v68, v69
    v_cvt_pk_bf16_f32 v87, v70, v71
    v_cvt_pk_bf16_f32 v88, v56, v57
    v_cvt_pk_bf16_f32 v89, v58, v59
    v_cvt_pk_bf16_f32 v90, v72, v73
    v_cvt_pk_bf16_f32 v91, v74, v75
    v_cvt_pk_bf16_f32 v92, v60, v61
    v_cvt_pk_bf16_f32 v93, v62, v63
    v_cvt_pk_bf16_f32 v94, v76, v77
    v_cvt_pk_bf16_f32 v95, v78, v79
    v_mov_b32 v24, 0
    v_mov_b32 v25, 0
    v_mov_b32 v26, 0
    v_mov_b32 v27, 0
    v_mov_b32 v28, 0
    v_mov_b32 v29, 0
    v_mov_b32 v30, 0
    v_mov_b32 v31, 0
    v_mov_b32 v32, 0
    v_mov_b32 v33, 0
    v_mov_b32 v34, 0
    v_mov_b32 v35, 0
    v_mov_b32 v36, 0
    v_mov_b32 v37, 0
    v_mov_b32 v38, 0
    v_mov_b32 v39, 0
    s_setprio 2
    s_cmp_lg_u32 s31, s30
    s_cbranch_scc1 aloopL_41_nd1
    s_add_u32 m0, s42, 16384
    s_add_u32 s17, s41, s33
    s_add_u32 s17, s17, 4194304
    buffer_load_dwordx4 v0, s[4:7], s17 offen offset:0 sc1 lds
    buffer_load_dwordx4 v0, s[4:7], s17 offen offset:1024 sc1 lds
    buffer_load_dwordx4 v0, s[4:7], s17 offen offset:2048 sc1 lds
    buffer_load_dwordx4 v0, s[4:7], s17 offen offset:3072 sc1 lds
aloopL_41_nd1:
    s_add_u32 s41, s41, 262144
    s_waitcnt lgkmcnt(0)
    s_barrier
    s_sleep 9
    s_waitcnt lgkmcnt(0)
    buffer_load_dwordx4 v[48:51], v0, s[4:7], s23 offen offset:0 sc1
    buffer_load_dwordx4 v[52:55], v0, s[4:7], s23 offen offset:1024 sc1
    buffer_load_dwordx4 v[56:59], v0, s[4:7], s23 offen offset:2048 sc1
    buffer_load_dwordx4 v[60:63], v0, s[4:7], s23 offen offset:3072 sc1
    s_sleep 2
    buffer_load_dwordx4 v[64:67], v0, s[4:7], s24 offen offset:0 sc1
    buffer_load_dwordx4 v[68:71], v0, s[4:7], s24 offen offset:1024 sc1
    s_waitcnt vmcnt(5)
    v_mfma_f32_16x16x32_bf16 v[12:15], v[96:99], v[48:51], 0
    v_mfma_f32_16x16x32_bf16 v[16:19], v[112:115], v[48:51], 0
    v_max_u32 v3, v48, v50
    v_cmp_eq_u32 vcc, -1, v3
    v_mfma_f32_16x16x32_bf16 v[20:23], v[48:51], v[48:51], 0
    s_cbranch_vccnz aloopL_41_rq_0
    s_waitcnt vmcnt(4)
    v_mfma_f32_16x16x32_bf16 v[12:15], v[100:103], v[52:55], v[12:15]
    v_mfma_f32_16x16x32_bf16 v[16:19], v[116:119], v[52:55], v[16:19]
    v_max_u32 v3, v52, v54
    v_cmp_eq_u32 vcc, -1, v3
    v_mfma_f32_16x16x32_bf16 v[20:23], v[52:55], v[52:55], v[20:23]
    s_cbranch_vccnz aloopL_41_rq_1
    s_waitcnt vmcnt(3)
    v_mfma_f32_16x16x32_bf16 v[12:15], v[104:107], v[56:59], v[12:15]
    v_mfma_f32_16x16x32_bf16 v[16:19], v[120:123], v[56:59], v[16:19]
    v_max_u32 v3, v56, v58
    v_cmp_eq_u32 vcc, -1, v3
    v_mfma_f32_16x16x32_bf16 v[20:23], v[56:59], v[56:59], v[20:23]
    s_cbranch_vccnz aloopL_41_rq_2
    s_waitcnt vmcnt(2)
    v_mfma_f32_16x16x32_bf16 v[12:15], v[108:111], v[60:63], v[12:15]
    v_mfma_f32_16x16x32_bf16 v[16:19], v[124:127], v[60:63], v[16:19]
    v_max_u32 v3, v60, v62
    v_cmp_eq_u32 vcc, -1, v3
    v_mfma_f32_16x16x32_bf16 v[20:23], v[60:63], v[60:63], v[20:23]
    s_cbranch_vccnz aloopL_41_rq_3
aloopL_41_sdone:
    s_nop 1
    ds_write_b32 v164, v165
    s_nop 0
    v_max3_f32 v2, v12, v13, v14
    v_max3_f32 v3, v15, v16, v17
    v_max3_f32 v2, v2, v18, v19
    v_max3_f32 v3, v3, v20, v21
    v_max_f32 v2, v2, v3
    v_mov_b32 v3, v2
    s_nop 1
    v_permlane16_swap_b32 v3, v2
    v_max_f32 v2, v2, v3
    v_mov_b32 v3, v2
    s_waitcnt vmcnt(0)
    v_max3_u32 v188, v64, v66, v68
    v_permlane32_swap_b32 v3, v2
    v_max_f32 v2, v2, v3
    v_max_u32 v188, v188, v70
    v_mul_f32 v2, s29, v2
    v_cmp_eq_u32 vcc, -1, v188
    v_fma_f32 v12, v12, s29, -v2
    v_fma_f32 v13, v13, s29, -v2
    s_cbranch_vccnz aloopL_41_rq_v
aloopL_41_vok:
    v_smfmac_f32_16x16x64_bf16 v[24:27], v[64:67], v[192:199], v166
    v_fma_f32 v14, v14, s29, -v2
    v_exp_f32 v12, v12
    v_smfmac_f32_16x16x64_bf16 v[32:35], v[64:67], v[224:231], v166
    s_add_u32 s17, s41, 37748736
    buffer_load_dwordx4 v[128:131], v0, s[4:7], s17 offen offset:0 sc1
    v_fma_f32 v15, v15, s29, -v2
    v_exp_f32 v13, v13
    v_smfmac_f32_16x16x64_bf16 v[28:31], v[64:67], v[208:215], v166
    buffer_load_dwordx4 v[132:135], v0, s[4:7], s17 offen offset:1024 sc1
    v_fma_f32 v16, v16, s29, -v2
    v_exp_f32 v14, v14
    v_smfmac_f32_16x16x64_bf16 v[36:39], v[64:67], v[240:247], v166
    buffer_load_dwordx4 v[136:139], v0, s[4:7], s17 offen offset:2048 sc1
    v_fma_f32 v17, v17, s29, -v2
    v_exp_f32 v15, v15
    v_smfmac_f32_16x16x64_bf16 v[24:27], v[68:71], v[200:207], v166
    buffer_load_dwordx4 v[140:143], v0, s[4:7], s17 offen offset:3072 sc1
    v_fma_f32 v18, v18, s29, -v2
    v_exp_f32 v16, v16
    v_smfmac_f32_16x16x64_bf16 v[32:35], v[68:71], v[232:239], v166
    s_add_u32 s18, s41, 37879808
    buffer_load_dwordx4 v[144:147], v0, s[4:7], s18 offen offset:0 sc1
    v_fma_f32 v19, v19, s29, -v2
    v_exp_f32 v17, v17
    v_smfmac_f32_16x16x64_bf16 v[28:31], v[68:71], v[216:223], v166
    buffer_load_dwordx4 v[148:151], v0, s[4:7], s18 offen offset:1024 sc1
    v_fma_f32 v20, v20, s29, -v2
    v_exp_f32 v18, v18
    v_smfmac_f32_16x16x64_bf16 v[36:39], v[68:71], v[248:255], v166
    buffer_load_dwordx4 v[152:155], v0, s[4:7], s18 offen offset:2048 sc1
    v_fma_f32 v21, v21, s29, -v2
    v_exp_f32 v19, v19
    buffer_load_dwordx4 v[156:159], v0, s[4:7], s18 offen offset:3072 sc1
    v_exp_f32 v20, v20
    v_exp_f32 v21, v21
    v_cvt_pk_bf16_f32 v12, v12, v13
    v_cvt_pk_bf16_f32 v13, v14, v15
    v_cvt_pk_bf16_f32 v14, v16, v17
    v_cvt_pk_bf16_f32 v15, v18, v19
    v_cvt_pk_bf16_f32 v20, v20, v21
    v_mov_b32 v22, 0
    v_mfma_f32_16x16x32_bf16 v[16:19], v[4:7], v[12:15], 0
    v_mov_b32 v21, v20
    v_mov_b32 v23, 0
    v_cvt_pk_bf16_f32 v40, v24, v25
    v_cvt_pk_bf16_f32 v41, v26, v27
    v_mfma_f32_16x16x32_bf16 v[16:19], v[8:11], v[20:23], v[16:19]
    v_mfma_f32_16x16x32_bf16 v[24:27], v[80:83], v[12:15], 0
    v_cvt_pk_bf16_f32 v44, v32, v33
    v_cvt_pk_bf16_f32 v45, v34, v35
    v_mfma_f32_16x16x32_bf16 v[32:35], v[88:91], v[12:15], 0
    v_cvt_pk_bf16_f32 v42, v28, v29
    v_cvt_pk_bf16_f32 v43, v30, v31
    v_mfma_f32_16x16x32_bf16 v[28:31], v[84:87], v[12:15], 0
    v_cvt_pk_bf16_f32 v46, v36, v37
    v_cvt_pk_bf16_f32 v47, v38, v39
    v_mfma_f32_16x16x32_bf16 v[36:39], v[92:95], v[12:15], 0
aloopL_41_midE:
    s_mov_b64 vcc, s[56:57]
    v_rcp_f32 v3, v16
    v_mfma_f32_16x16x32_bf16 v[24:27], v[40:43], v[20:23], v[24:27]
    v_mfma_f32_16x16x32_bf16 v[32:35], v[44:47], v[20:23], v[32:35]
    v_mfma_f32_16x16x32_bf16 v[28:31], v[42:45], v[20:23], v[28:31]
    v_mfma_f32_16x16x32_bf16 v[36:39], v[46:49], v[20:23], v[36:39]
    v_mov_b32_dpp v3, v3 quad_perm:[2,3,2,3] row_mask:0xf bank_mask:0xf
    s_nop 4
    v_cndmask_b32_dpp v24, v32, v24, vcc quad_perm:[2,3,2,3] row_mask:0xf bank_mask:0xf
    v_cndmask_b32_dpp v25, v33, v25, vcc quad_perm:[2,3,2,3] row_mask:0xf bank_mask:0xf
    v_cndmask_b32_dpp v26, v34, v26, vcc quad_perm:[2,3,2,3] row_mask:0xf bank_mask:0xf
    v_cndmask_b32_dpp v27, v35, v27, vcc quad_perm:[2,3,2,3] row_mask:0xf bank_mask:0xf
    v_cndmask_b32_dpp v28, v36, v28, vcc quad_perm:[2,3,2,3] row_mask:0xf bank_mask:0xf
    v_cndmask_b32_dpp v29, v37, v29, vcc quad_perm:[2,3,2,3] row_mask:0xf bank_mask:0xf
    v_cndmask_b32_dpp v30, v38, v30, vcc quad_perm:[2,3,2,3] row_mask:0xf bank_mask:0xf
    v_cndmask_b32_dpp v31, v39, v31, vcc quad_perm:[2,3,2,3] row_mask:0xf bank_mask:0xf
    v_mul_f32 v24, v24, v3
    v_mul_f32 v25, v25, v3
    v_mul_f32 v26, v26, v3
    v_mul_f32 v27, v27, v3
    v_mul_f32 v28, v28, v3
    v_mul_f32 v29, v29, v3
    v_mul_f32 v30, v30, v3
    v_mul_f32 v31, v31, v3
    v_cvt_pk_bf16_f32 v168, v24, v25
    v_cvt_pk_bf16_f32 v169, v26, v27
    v_cvt_pk_bf16_f32 v170, v28, v29
    v_cvt_pk_bf16_f32 v171, v30, v31
    ds_write_b128 v160, v[168:171]
    s_waitcnt lgkmcnt(0)
    s_barrier
    ds_read_b128 v[172:175], v161
    s_waitcnt lgkmcnt(0)
    v_mfma_f32_16x16x32_bf16 v[24:27], v[184:187], v[172:175], 0
    s_nop 7
    v_cvt_pk_bf16_f32 v168, v24, v25
    v_cvt_pk_bf16_f32 v169, v26, v27
    s_nop 0
    v_permlane16_swap_b32 v168, v170
    v_permlane16_swap_b32 v169, v171
    s_mov_b64 exec, 0xffff
    v_min_u32 v168, -2, v168
    buffer_store_dwordx4 v[168:171], v1, s[4:7], s25 offen sc1
    s_setprio 0
    buffer_store_dwordx4 v[176:179], v1, s[4:7], s26 offen sc1
    s_mov_b64 exec, -1
    s_branch pg_42
    s_cmp_lg_u32 s27, 0
    s_cbranch_scc1 pg_42
    s_sub_u32 s21, s16, 1
    s_cbranch_scc1 pg_42
    s_sub_u32 s17, s21, 1
    s_and_b32 s17, s17, 3
    s_cmp_ge_u32 s16, 58
    s_cselect_b32 s17, 0, s17
    s_cmp_lg_u32 s17, 0
    s_cbranch_scc1 pg_42
    v_mov_b32 v3, s21
    s_mov_b64 exec, 1
    buffer_store_dword v3, off, s[4:7], s28 sc1
    s_mov_b64 exec, -1
pg_42:
    s_cmp_lg_u32 s31, s30
    s_cbranch_scc1 aloopL_41_nd2
    ds_read_b128 v[24:27], v163 offset:16384
    ds_read_b128 v[28:31], v163 offset:17408
    ds_read_b128 v[32:35], v163 offset:18432
    ds_read_b128 v[36:39], v163 offset:19456
    ds_write_b32 v180, v64 offset:0
    ds_write_b32 v180, v65 offset:8
    ds_write_b32 v180, v66 offset:128
    ds_write_b32 v180, v67 offset:136
    ds_write_b32 v180, v68 offset:1024
    ds_write_b32 v180, v69 offset:1032
    ds_write_b32 v180, v70 offset:1152
    ds_write_b32 v180, v71 offset:1160
    s_mov_b32 s32, 1
    s_waitcnt lgkmcnt(11)
    v_mfma_f32_16x16x32_bf16 v[12:15], v[96:99], v[24:27], 0
    v_mfma_f32_16x16x32_bf16 v[16:19], v[112:115], v[24:27], 0
    v_mfma_f32_16x16x32_bf16 v[20:23], v[48:51], v[24:27], 0
    s_waitcnt lgkmcnt(10)
    v_mfma_f32_16x16x32_bf16 v[12:15], v[100:103], v[28:31], v[12:15]
    v_mfma_f32_16x16x32_bf16 v[16:19], v[116:119], v[28:31], v[16:19]
    v_mfma_f32_16x16x32_bf16 v[20:23], v[52:55], v[28:31], v[20:23]
    s_waitcnt lgkmcnt(9)
    v_mfma_f32_16x16x32_bf16 v[12:15], v[104:107], v[32:35], v[12:15]
    v_mfma_f32_16x16x32_bf16 v[16:19], v[120:123], v[32:35], v[16:19]
    v_mfma_f32_16x16x32_bf16 v[20:23], v[56:59], v[32:35], v[20:23]
    s_waitcnt lgkmcnt(8)
    v_mfma_f32_16x16x32_bf16 v[12:15], v[108:111], v[36:39], v[12:15]
    v_mfma_f32_16x16x32_bf16 v[16:19], v[124:127], v[36:39], v[16:19]
    v_mfma_f32_16x16x32_bf16 v[20:23], v[60:63], v[36:39], v[20:23]
    s_waitcnt lgkmcnt(0)
    s_nop 3
    s_nop 3
    s_cmp_eq_u32 s32, 0
    s_cbranch_scc1 aloopL_41_p2e
    s_mov_b32 s32, 0
    ds_read_b64_tr_b16 v[96:97], v181 offset:0
    ds_read_b64_tr_b16 v[98:99], v181 offset:4096
    ds_read_b64_tr_b16 v[64:65], v182 offset:0
    ds_read_b64_tr_b16 v[100:101], v181 offset:8
    ds_read_b64_tr_b16 v[102:103], v181 offset:4104
    ds_read_b64_tr_b16 v[66:67], v182 offset:8
    ds_read_b64_tr_b16 v[104:105], v181 offset:1024
    ds_read_b64_tr_b16 v[106:107], v181 offset:5120
    ds_read_b64_tr_b16 v[68:69], v182 offset:512
    ds_read_b64_tr_b16 v[108:109], v181 offset:1032
    ds_read_b64_tr_b16 v[110:111], v181 offset:5128
    ds_read_b64_tr_b16 v[70:71], v182 offset:520
    ds_read_b64_tr_b16 v[112:113], v181 offset:2048
    ds_read_b64_tr_b16 v[114:115], v181 offset:6144
    ds_read_b64_tr_b16 v[72:73], v182 offset:1024
    ds_read_b64_tr_b16 v[116:117], v181 offset:2056
    ds_read_b64_tr_b16 v[118:119], v181 offset:6152
    ds_read_b64_tr_b16 v[74:75], v182 offset:1032
    ds_read_b64_tr_b16 v[120:121], v181 offset:3072
    ds_read_b64_tr_b16 v[122:123], v181 offset:7168
    ds_read_b64_tr_b16 v[76:77], v182 offset:1536
    ds_read_b64_tr_b16 v[124:125], v181 offset:3080
    ds_read_b64_tr_b16 v[126:127], v181 offset:7176
    ds_read_b64_tr_b16 v[78:79], v182 offset:1544
    v_mov_b32 v188, 0xff61b1e6
    s_cmp_eq_u32 s33, 0
    s_cselect_b64 vcc, s[44:45], 0
    v_cndmask_b32 v12, v12, v188, vcc
    s_cselect_b64 vcc, -1, s[44:45]
    v_cndmask_b32 v16, v16, v188, vcc
    s_cselect_b64 vcc, s[46:47], 0
    v_cndmask_b32 v13, v13, v188, vcc
    s_cselect_b64 vcc, -1, s[46:47]
    v_cndmask_b32 v17, v17, v188, vcc
    s_cselect_b64 vcc, s[48:49], 0
    v_cndmask_b32 v14, v14, v188, vcc
    s_cselect_b64 vcc, -1, s[48:49]
    v_cndmask_b32 v18, v18, v188, vcc
    s_cselect_b64 vcc, s[50:51], 0
    v_cndmask_b32 v15, v15, v188, vcc
    s_cselect_b64 vcc, -1, s[50:51]
    v_cndmask_b32 v19, v19, v188, vcc
    v_max3_f32 v2, v12, v13, v14
    v_max3_f32 v3, v15, v16, v17
    v_max3_f32 v2, v2, v18, v19
    v_max3_f32 v3, v3, v20, v21
    v_max_f32 v2, v2, v3
    v_mov_b32 v3, v2
    s_nop 1
    v_permlane16_swap_b32 v3, v2
    v_max_f32 v2, v2, v3
    v_mov_b32 v3, v2
    s_nop 1
    v_permlane32_swap_b32 v3, v2
    v_max_f32 v2, v2, v3
    v_mul_f32 v2, s29, v2
    v_fma_f32 v12, v12, s29, -v2
    v_fma_f32 v13, v13, s29, -v2
    v_fma_f32 v14, v14, s29, -v2
    v_exp_f32 v12, v12
    v_fma_f32 v15, v15, s29, -v2
    v_exp_f32 v13, v13
    v_fma_f32 v16, v16, s29, -v2
    v_exp_f32 v14, v14
    v_fma_f32 v17, v17, s29, -v2
    v_exp_f32 v15, v15
    v_fma_f32 v18, v18, s29, -v2
    v_exp_f32 v16, v16
    v_fma_f32 v19, v19, s29, -v2
    v_exp_f32 v17, v17
    v_fma_f32 v20, v20, s29, -v2
    v_exp_f32 v18, v18
    v_fma_f32 v21, v21, s29, -v2
    v_exp_f32 v19, v19
    v_exp_f32 v20, v20
    v_exp_f32 v21, v21
    v_cvt_pk_bf16_f32 v12, v12, v13
    v_cvt_pk_bf16_f32 v13, v14, v15
    v_cvt_pk_bf16_f32 v14, v16, v17
    v_cvt_pk_bf16_f32 v15, v18, v19
    v_cvt_pk_bf16_f32 v20, v20, v21
    v_mov_b32 v22, 0
    v_mov_b32 v21, 0
    v_mov_b32 v23, 0
    s_waitcnt lgkmcnt(0)
    s_nop 0
    v_mfma_f32_16x16x32_bf16 v[16:19], v[4:7], v[12:15], 0
    v_mfma_f32_16x16x32_bf16 v[16:19], v[4:7], v[20:23], v[16:19]
    v_mfma_f32_16x16x32_bf16 v[24:27], v[96:99], v[12:15], 0
    v_mfma_f32_16x16x32_bf16 v[24:27], v[64:67], v[20:23], v[24:27]
    v_mfma_f32_16x16x32_bf16 v[28:31], v[100:103], v[12:15], 0
    v_mfma_f32_16x16x32_bf16 v[28:31], v[66:69], v[20:23], v[28:31]
    v_mfma_f32_16x16x32_bf16 v[32:35], v[104:107], v[12:15], 0
    v_mfma_f32_16x16x32_bf16 v[32:35], v[68:71], v[20:23], v[32:35]
    v_mfma_f32_16x16x32_bf16 v[36:39], v[108:111], v[12:15], 0
    v_mfma_f32_16x16x32_bf16 v[36:39], v[70:73], v[20:23], v[36:39]
    v_mfma_f32_16x16x32_bf16 v[48:51], v[112:115], v[12:15], 0
    v_mfma_f32_16x16x32_bf16 v[48:51], v[72:75], v[20:23], v[48:51]
    v_mfma_f32_16x16x32_bf16 v[52:55], v[116:119], v[12:15], 0
    v_mfma_f32_16x16x32_bf16 v[52:55], v[74:77], v[20:23], v[52:55]
    v_mfma_f32_16x16x32_bf16 v[56:59], v[120:123], v[12:15], 0
    v_mfma_f32_16x16x32_bf16 v[56:59], v[76:79], v[20:23], v[56:59]
    v_mfma_f32_16x16x32_bf16 v[60:63], v[124:127], v[12:15], 0
    v_mfma_f32_16x16x32_bf16 v[60:63], v[78:81], v[20:23], v[60:63]
    v_rcp_f32 v3, v16
    s_nop 0
    v_mul_f32 v24, v24, v3
    v_mul_f32 v25, v25, v3
    v_mul_f32 v26, v26, v3
    v_mul_f32 v27, v27, v3
    v_mul_f32 v28, v28, v3
    v_mul_f32 v29, v29, v3
    v_mul_f32 v30, v30, v3
    v_mul_f32 v31, v31, v3
    v_cvt_pk_bf16_f32 v24, v24, v25
    v_cvt_pk_bf16_f32 v25, v26, v27
    v_cvt_pk_bf16_f32 v26, v28, v29
    v_cvt_pk_bf16_f32 v27, v30, v31
    ds_write_b128 v0, v[24:27] offset:32768
    v_mul_f32 v32, v32, v3
    v_mul_f32 v33, v33, v3
    v_mul_f32 v34, v34, v3
    v_mul_f32 v35, v35, v3
    v_mul_f32 v36, v36, v3
    v_mul_f32 v37, v37, v3
    v_mul_f32 v38, v38, v3
    v_mul_f32 v39, v39, v3
    v_cvt_pk_bf16_f32 v32, v32, v33
    v_cvt_pk_bf16_f32 v33, v34, v35
    v_cvt_pk_bf16_f32 v34, v36, v37
    v_cvt_pk_bf16_f32 v35, v38, v39
    ds_write_b128 v0, v[32:35] offset:33792
    v_mul_f32 v48, v48, v3
    v_mul_f32 v49, v49, v3
    v_mul_f32 v50, v50, v3
    v_mul_f32 v51, v51, v3
    v_mul_f32 v52, v52, v3
    v_mul_f32 v53, v53, v3
    v_mul_f32 v54, v54, v3
    v_mul_f32 v55, v55, v3
    v_cvt_pk_bf16_f32 v48, v48, v49
    v_cvt_pk_bf16_f32 v49, v50, v51
    v_cvt_pk_bf16_f32 v50, v52, v53
    v_cvt_pk_bf16_f32 v51, v54, v55
    ds_write_b128 v0, v[48:51] offset:34816
    v_mul_f32 v56, v56, v3
    v_mul_f32 v57, v57, v3
    v_mul_f32 v58, v58, v3
    v_mul_f32 v59, v59, v3
    v_mul_f32 v60, v60, v3
    v_mul_f32 v61, v61, v3
    v_mul_f32 v62, v62, v3
    v_mul_f32 v63, v63, v3
    v_cvt_pk_bf16_f32 v56, v56, v57
    v_cvt_pk_bf16_f32 v57, v58, v59
    v_cvt_pk_bf16_f32 v58, v60, v61
    v_cvt_pk_bf16_f32 v59, v62, v63
    ds_write_b128 v0, v[56:59] offset:35840
aloopL_41_p2e:
    s_nop 3
aloopL_41_nd2:
    s_add_u32 s19, s41, 20971520
    buffer_load_dwordx4 v[96:99], v0, s[4:7], s19 offen offset:0 sc1
    buffer_load_dwordx4 v[100:103], v0, s[4:7], s19 offen offset:1024 sc1
    buffer_load_dwordx4 v[104:107], v0, s[4:7], s19 offen offset:2048 sc1
    buffer_load_dwordx4 v[108:111], v0, s[4:7], s19 offen offset:3072 sc1
    s_add_u32 s20, s41, 21102592
    buffer_load_dwordx4 v[112:115], v0, s[4:7], s20 offen offset:0 sc1
    buffer_load_dwordx4 v[116:119], v0, s[4:7], s20 offen offset:1024 sc1
    buffer_load_dwordx4 v[120:123], v0, s[4:7], s20 offen offset:2048 sc1
    buffer_load_dwordx4 v[124:127], v0, s[4:7], s20 offen offset:3072 sc1
    s_add_u32 s16, s16, 1
    s_cmp_lt_u32 s16, 48
    s_cbranch_scc1 aloopL_41
    s_waitcnt vmcnt(0)
    ds_write_b128 v163, v[128:131] offset:8192
    ds_write_b128 v163, v[132:135] offset:9216
    ds_write_b128 v163, v[136:139] offset:10240
    ds_write_b128 v163, v[140:143] offset:11264
    ds_write_b128 v163, v[144:147] offset:12288
    ds_write_b128 v163, v[148:151] offset:13312
    ds_write_b128 v163, v[152:155] offset:14336
    ds_write_b128 v163, v[156:159] offset:15360
    s_waitcnt lgkmcnt(0)
    s_branch aloopH_40
aloopL_41_rq_0:
    s_sub_u32 s22, s22, 1
    s_cbranch_scc1 aloopL_41_rq_0_g
    buffer_load_dwordx4 v[48:51], v0, s[4:7], s23 offen offset:0 sc1
    buffer_load_dwordx4 v[52:55], v0, s[4:7], s23 offen offset:1024 sc1
    buffer_load_dwordx4 v[56:59], v0, s[4:7], s23 offen offset:2048 sc1
    buffer_load_dwordx4 v[60:63], v0, s[4:7], s23 offen offset:3072 sc1
    buffer_load_dwordx4 v[64:67], v0, s[4:7], s24 offen offset:0 sc1
    buffer_load_dwordx4 v[68:71], v0, s[4:7], s24 offen offset:1024 sc1
    s_waitcnt vmcnt(5)
    v_max_u32 v3, v48, v50
    v_cmp_eq_u32 vcc, -1, v3
    s_cbranch_vccnz aloopL_41_rq_0
    s_branch aloopL_41_again
aloopL_41_rq_0_g:
    s_mov_b32 s22, 0
    s_waitcnt vmcnt(0)
    s_branch aloopL_41_nochk
aloopL_41_rq_1:
    s_sub_u32 s22, s22, 1
    s_cbranch_scc1 aloopL_41_rq_1_g
    buffer_load_dwordx4 v[52:55], v0, s[4:7], s23 offen offset:1024 sc1
    buffer_load_dwordx4 v[56:59], v0, s[4:7], s23 offen offset:2048 sc1
    buffer_load_dwordx4 v[60:63], v0, s[4:7], s23 offen offset:3072 sc1
    buffer_load_dwordx4 v[64:67], v0, s[4:7], s24 offen offset:0 sc1
    buffer_load_dwordx4 v[68:71], v0, s[4:7], s24 offen offset:1024 sc1
    s_waitcnt vmcnt(4)
    v_max_u32 v3, v52, v54
    v_cmp_eq_u32 vcc, -1, v3
    s_cbranch_vccnz aloopL_41_rq_1
    s_branch aloopL_41_again
aloopL_41_rq_1_g:
    s_mov_b32 s22, 0
    s_waitcnt vmcnt(0)
    s_branch aloopL_41_nochk
aloopL_41_rq_2:
    s_sub_u32 s22, s22, 1
    s_cbranch_scc1 aloopL_41_rq_2_g
    buffer_load_dwordx4 v[56:59], v0, s[4:7], s23 offen offset:2048 sc1
    buffer_load_dwordx4 v[60:63], v0, s[4:7], s23 offen offset:3072 sc1
    buffer_load_dwordx4 v[64:67], v0, s[4:7], s24 offen offset:0 sc1
    buffer_load_dwordx4 v[68:71], v0, s[4:7], s24 offen offset:1024 sc1
    s_waitcnt vmcnt(3)
    v_max_u32 v3, v56, v58
    v_cmp_eq_u32 vcc, -1, v3
    s_cbranch_vccnz aloopL_41_rq_2
    s_branch aloopL_41_again
aloopL_41_rq_2_g:
    s_mov_b32 s22, 0
    s_waitcnt vmcnt(0)
    s_branch aloopL_41_nochk
aloopL_41_rq_3:
    s_sub_u32 s22, s22, 1
    s_cbranch_scc1 aloopL_41_rq_3_g
    buffer_load_dwordx4 v[60:63], v0, s[4:7], s23 offen offset:3072 sc1
    buffer_load_dwordx4 v[64:67], v0, s[4:7], s24 offen offset:0 sc1
    buffer_load_dwordx4 v[68:71], v0, s[4:7], s24 offen offset:1024 sc1
    s_waitcnt vmcnt(2)
    v_max_u32 v3, v60, v62
    v_cmp_eq_u32 vcc, -1, v3
    s_cbranch_vccnz aloopL_41_rq_3
    s_branch aloopL_41_again
aloopL_41_rq_3_g:
    s_mov_b32 s22, 0
    s_waitcnt vmcnt(0)
    s_branch aloopL_41_nochk
aloopL_41_again:
    s_waitcnt vmcnt(5)
    v_mfma_f32_16x16x32_bf16 v[12:15], v[96:99], v[48:51], 0
    v_mfma_f32_16x16x32_bf16 v[16:19], v[112:115], v[48:51], 0
    v_max_u32 v3, v48, v50
    v_cmp_eq_u32 vcc, -1, v3
    v_mfma_f32_16x16x32_bf16 v[20:23], v[48:51], v[48:51], 0
    s_cbranch_vccnz aloopL_41_rq_0
    s_waitcnt vmcnt(4)
    v_mfma_f32_16x16x32_bf16 v[12:15], v[100:103], v[52:55], v[12:15]
    v_mfma_f32_16x16x32_bf16 v[16:19], v[116:119], v[52:55], v[16:19]
    v_max_u32 v3, v52, v54
    v_cmp_eq_u32 vcc, -1, v3
    v_mfma_f32_16x16x32_bf16 v[20:23], v[52:55], v[52:55], v[20:23]
    s_cbranch_vccnz aloopL_41_rq_1
    s_waitcnt vmcnt(3)
    v_mfma_f32_16x16x32_bf16 v[12:15], v[104:107], v[56:59], v[12:15]
    v_mfma_f32_16x16x32_bf16 v[16:19], v[120:123], v[56:59], v[16:19]
    v_max_u32 v3, v56, v58
    v_cmp_eq_u32 vcc, -1, v3
    v_mfma_f32_16x16x32_bf16 v[20:23], v[56:59], v[56:59], v[20:23]
    s_cbranch_vccnz aloopL_41_rq_2
    s_waitcnt vmcnt(2)
    v_mfma_f32_16x16x32_bf16 v[12:15], v[108:111], v[60:63], v[12:15]
    v_mfma_f32_16x16x32_bf16 v[16:19], v[124:127], v[60:63], v[16:19]
    v_max_u32 v3, v60, v62
    v_cmp_eq_u32 vcc, -1, v3
    v_mfma_f32_16x16x32_bf16 v[20:23], v[60:63], v[60:63], v[20:23]
    s_cbranch_vccnz aloopL_41_rq_3
    s_branch aloopL_41_sdone
aloopL_41_rq_v:
    s_sub_u32 s22, s22, 1
    s_cbranch_scc1 aloopL_41_rq_vg
    buffer_load_dwordx4 v[64:67], v0, s[4:7], s24 offen offset:0 sc1
    buffer_load_dwordx4 v[68:71], v0, s[4:7], s24 offen offset:1024 sc1
    s_waitcnt vmcnt(0)
    v_max3_u32 v188, v64, v66, v68
    v_max_u32 v188, v188, v70
    v_cmp_eq_u32 vcc, -1, v188
    s_cbranch_vccnz aloopL_41_rq_v
    s_branch aloopL_41_vok
aloopL_41_rq_vg:
    s_mov_b32 s22, 0
    s_branch aloopL_41_vok
aloopL_41_nochk:
    v_mfma_f32_16x16x32_bf16 v[12:15], v[96:99], v[48:51], 0
    v_mfma_f32_16x16x32_bf16 v[16:19], v[112:115], v[48:51], 0
    v_mfma_f32_16x16x32_bf16 v[20:23], v[48:51], v[48:51], 0
    v_mfma_f32_16x16x32_bf16 v[12:15], v[100:103], v[52:55], v[12:15]
    v_mfma_f32_16x16x32_bf16 v[16:19], v[116:119], v[52:55], v[16:19]
    v_mfma_f32_16x16x32_bf16 v[20:23], v[52:55], v[52:55], v[20:23]
    v_mfma_f32_16x16x32_bf16 v[12:15], v[104:107], v[56:59], v[12:15]
    v_mfma_f32_16x16x32_bf16 v[16:19], v[120:123], v[56:59], v[16:19]
    v_mfma_f32_16x16x32_bf16 v[20:23], v[56:59], v[56:59], v[20:23]
    v_mfma_f32_16x16x32_bf16 v[12:15], v[108:111], v[60:63], v[12:15]
    v_mfma_f32_16x16x32_bf16 v[16:19], v[124:127], v[60:63], v[16:19]
    v_mfma_f32_16x16x32_bf16 v[20:23], v[60:63], v[60:63], v[20:23]
    s_nop 1
    s_branch aloopL_41_sdone
ct_aH:
.p2align 6
aloopH_40:
    s_and_b32 s23, s16, 3
    s_lshl_b32 s23, s23, 18
    s_add_u32 s23, s23, s38
    s_add_u32 s24, s23, 4096
    s_and_b32 s25, s16, 3
    s_lshl_b32 s25, s25, 18
    s_add_u32 s25, s25, s39
    s_add_u32 s26, s16, 2
    s_and_b32 s26, s26, 3
    s_lshl_b32 s26, s26, 18
    s_add_u32 s26, s26, s39
    v_mov_b32 v165, s16
aloopH_40_wkv:
    ds_read_b32 v188, v164 offset:16
    s_waitcnt lgkmcnt(0)
    v_readfirstlane_b32 s19, v188
    s_cmp_ge_i32 s19, s16
    s_cbranch_scc1 aloopH_40_wkvok
    s_sleep 1
    s_branch aloopH_40_wkv
aloopH_40_wkvok:
    ds_read_b128 v[128:131], v163 offset:8192
    ds_read_b128 v[144:147], v163 offset:12288
    ds_read_b128 v[132:135], v163 offset:9216
    ds_read_b128 v[148:151], v163 offset:13312
    ds_read_b128 v[136:139], v163 offset:10240
    ds_read_b128 v[152:155], v163 offset:14336
    ds_read_b128 v[140:143], v163 offset:11264
    ds_read_b128 v[156:159], v163 offset:15360
    s_waitcnt lgkmcnt(6)
    v_mfma_f32_16x16x32_bf16 v[48:51], v[128:131], v[192:195], 0
    v_mfma_f32_16x16x32_bf16 v[52:55], v[128:131], v[208:211], 0
    v_mfma_f32_16x16x32_bf16 v[56:59], v[128:131], v[224:227], 0
    v_mfma_f32_16x16x32_bf16 v[60:63], v[128:131], v[240:243], 0
    v_mfma_f32_16x16x32_bf16 v[64:67], v[144:147], v[192:195], 0
    v_mfma_f32_16x16x32_bf16 v[68:71], v[144:147], v[208:211], 0
    v_mfma_f32_16x16x32_bf16 v[72:75], v[144:147], v[224:227], 0
    v_mfma_f32_16x16x32_bf16 v[76:79], v[144:147], v[240:243], 0
    s_setprio 2
aloopH_40_wm:
    ds_read_b32 v188, v164 offset:32
    s_waitcnt lgkmcnt(0)
    v_readfirstlane_b32 s19, v188
    s_cmp_ge_i32 s19, s16
    s_cbranch_scc1 aloopH_40_wmok
    s_sleep 1
    s_branch aloopH_40_wm
aloopH_40_wmok:
    s_add_u32 m0, s42, 16384
    s_add_u32 s17, s41, 4194304
    buffer_load_dwordx4 v0, s[4:7], s17 offen offset:0 sc1 lds
    buffer_load_dwordx4 v0, s[4:7], s17 offen offset:1024 sc1 lds
    buffer_load_dwordx4 v0, s[4:7], s17 offen offset:2048 sc1 lds
    buffer_load_dwordx4 v0, s[4:7], s17 offen offset:3072 sc1 lds
    s_add_u32 m0, s42, 20480
    s_add_u32 s17, s41, 4325376
    buffer_load_dwordx4 v0, s[4:7], s17 offen offset:0 sc1 lds
    buffer_load_dwordx4 v0, s[4:7], s17 offen offset:1024 sc1 lds
    buffer_load_dwordx4 v0, s[4:7], s17 offen offset:2048 sc1 lds
    buffer_load_dwordx4 v0, s[4:7], s17 offen offset:3072 sc1 lds
    s_add_u32 s41, s41, 262144
    s_barrier
    s_waitcnt lgkmcnt(4)
    v_mfma_f32_16x16x32_bf16 v[48:51], v[132:135], v[196:199], v[48:51]
    v_mfma_f32_16x16x32_bf16 v[52:55], v[132:135], v[212:215], v[52:55]
    v_mfma_f32_16x16x32_bf16 v[56:59], v[132:135], v[228:231], v[56:59]
    v_mfma_f32_16x16x32_bf16 v[60:63], v[132:135], v[244:247], v[60:63]
    v_mfma_f32_16x16x32_bf16 v[64:67], v[148:151], v[196:199], v[64:67]
    v_mfma_f32_16x16x32_bf16 v[68:71], v[148:151], v[212:215], v[68:71]
    v_mfma_f32_16x16x32_bf16 v[72:75], v[148:151], v[228:231], v[72:75]
    v_mfma_f32_16x16x32_bf16 v[76:79], v[148:151], v[244:247], v[76:79]
    s_waitcnt lgkmcnt(2)
    v_mfma_f32_16x16x32_bf16 v[48:51], v[136:139], v[200:203], v[48:51]
    v_mfma_f32_16x16x32_bf16 v[52:55], v[136:139], v[216:219], v[52:55]
    v_mfma_f32_16x16x32_bf16 v[56:59], v[136:139], v[232:235], v[56:59]
    v_mfma_f32_16x16x32_bf16 v[60:63], v[136:139], v[248:251], v[60:63]
    v_mfma_f32_16x16x32_bf16 v[64:67], v[152:155], v[200:203], v[64:67]
    v_mfma_f32_16x16x32_bf16 v[68:71], v[152:155], v[216:219], v[68:71]
    v_mfma_f32_16x16x32_bf16 v[72:75], v[152:155], v[232:235], v[72:75]
    v_mfma_f32_16x16x32_bf16 v[76:79], v[152:155], v[248:251], v[76:79]
    s_waitcnt lgkmcnt(0)
    v_mfma_f32_16x16x32_bf16 v[48:51], v[140:143], v[204:207], v[48:51]
    v_mfma_f32_16x16x32_bf16 v[52:55], v[140:143], v[220:223], v[52:55]
    v_mfma_f32_16x16x32_bf16 v[56:59], v[140:143], v[236:239], v[56:59]
    v_mfma_f32_16x16x32_bf16 v[60:63], v[140:143], v[252:255], v[60:63]
    v_mfma_f32_16x16x32_bf16 v[64:67], v[156:159], v[204:207], v[64:67]
    v_mfma_f32_16x16x32_bf16 v[68:71], v[156:159], v[220:223], v[68:71]
    v_mfma_f32_16x16x32_bf16 v[72:75], v[156:159], v[236:239], v[72:75]
    v_mfma_f32_16x16x32_bf16 v[76:79], v[156:159], v[252:255], v[76:79]
    s_nop 2
    v_cvt_pk_bf16_f32 v80, v48, v49
    v_cvt_pk_bf16_f32 v81, v50, v51
    v_cvt_pk_bf16_f32 v82, v64, v65
    v_cvt_pk_bf16_f32 v83, v66, v67
    v_cvt_pk_bf16_f32 v84, v52, v53
    v_cvt_pk_bf16_f32 v85, v54, v55
    v_cvt_pk_bf16_f32 v86, v68, v69
    v_cvt_pk_bf16_f32 v87, v70, v71
    v_cvt_pk_bf16_f32 v88, v56, v57
    v_cvt_pk_bf16_f32 v89, v58, v59
    v_cvt_pk_bf16_f32 v90, v72, v73
    v_cvt_pk_bf16_f32 v91, v74, v75
    v_cvt_pk_bf16_f32 v92, v60, v61
    v_cvt_pk_bf16_f32 v93, v62, v63
    v_cvt_pk_bf16_f32 v94, v76, v77
    v_cvt_pk_bf16_f32 v95, v78, v79
    v_mov_b32 v24, 0
    v_mov_b32 v25, 0
    v_mov_b32 v26, 0
    v_mov_b32 v27, 0
    v_mov_b32 v28, 0
    v_mov_b32 v29, 0
    v_mov_b32 v30, 0
    v_mov_b32 v31, 0
    v_mov_b32 v32, 0
    v_mov_b32 v33, 0
    v_mov_b32 v34, 0
    v_mov_b32 v35, 0
    v_mov_b32 v36, 0
    v_mov_b32 v37, 0
    v_mov_b32 v38, 0
    v_mov_b32 v39, 0
    s_waitcnt lgkmcnt(0)
    buffer_load_dwordx4 v[48:51], v0, s[4:7], s23 offen offset:0 sc1
    buffer_load_dwordx4 v[52:55], v0, s[4:7], s23 offen offset:1024 sc1
    buffer_load_dwordx4 v[56:59], v0, s[4:7], s23 offen offset:2048 sc1
    buffer_load_dwordx4 v[60:63], v0, s[4:7], s23 offen offset:3072 sc1
    s_sleep 2
    buffer_load_dwordx4 v[64:67], v0, s[4:7], s24 offen offset:0 sc1
    buffer_load_dwordx4 v[68:71], v0, s[4:7], s24 offen offset:1024 sc1
    s_waitcnt vmcnt(5)
    v_mfma_f32_16x16x32_bf16 v[12:15], v[96:99], v[48:51], 0
    v_mfma_f32_16x16x32_bf16 v[16:19], v[112:115], v[48:51], 0
    v_max_u32 v3, v48, v50
    v_cmp_eq_u32 vcc, -1, v3
    v_mfma_f32_16x16x32_bf16 v[20:23], v[48:51], v[48:51], 0
    s_cbranch_vccnz aloopH_40_rq_0
    s_waitcnt vmcnt(4)
    v_mfma_f32_16x16x32_bf16 v[12:15], v[100:103], v[52:55], v[12:15]
    v_mfma_f32_16x16x32_bf16 v[16:19], v[116:119], v[52:55], v[16:19]
    v_max_u32 v3, v52, v54
    v_cmp_eq_u32 vcc, -1, v3
    v_mfma_f32_16x16x32_bf16 v[20:23], v[52:55], v[52:55], v[20:23]
    s_cbranch_vccnz aloopH_40_rq_1
    s_waitcnt vmcnt(3)
    v_mfma_f32_16x16x32_bf16 v[12:15], v[104:107], v[56:59], v[12:15]
    v_mfma_f32_16x16x32_bf16 v[16:19], v[120:123], v[56:59], v[16:19]
    v_max_u32 v3, v56, v58
    v_cmp_eq_u32 vcc, -1, v3
    v_mfma_f32_16x16x32_bf16 v[20:23], v[56:59], v[56:59], v[20:23]
    s_cbranch_vccnz aloopH_40_rq_2
    s_waitcnt vmcnt(2)
    v_mfma_f32_16x16x32_bf16 v[12:15], v[108:111], v[60:63], v[12:15]
    v_mfma_f32_16x16x32_bf16 v[16:19], v[124:127], v[60:63], v[16:19]
    v_max_u32 v3, v60, v62
    v_cmp_eq_u32 vcc, -1, v3
    v_mfma_f32_16x16x32_bf16 v[20:23], v[60:63], v[60:63], v[20:23]
    s_cbranch_vccnz aloopH_40_rq_3
aloopH_40_sdone:
    s_cmp_eq_u32 s16, 63
    s_cbranch_scc1 aloopH_40_lsk
    ds_write_b32 v164, v165
    s_nop 0
    v_max3_f32 v2, v12, v13, v14
    v_max3_f32 v3, v15, v16, v17
    v_max3_f32 v2, v2, v18, v19
    v_max3_f32 v3, v3, v20, v21
    v_max_f32 v2, v2, v3
    v_mov_b32 v3, v2
    s_nop 1
    v_permlane16_swap_b32 v3, v2
    v_max_f32 v2, v2, v3
    v_mov_b32 v3, v2
    s_waitcnt vmcnt(0)
    v_max3_u32 v188, v64, v66, v68
    v_permlane32_swap_b32 v3, v2
    v_max_f32 v2, v2, v3
    v_max_u32 v188, v188, v70
    v_mul_f32 v2, s29, v2
    v_cmp_eq_u32 vcc, -1, v188
    v_fma_f32 v12, v12, s29, -v2
    v_fma_f32 v13, v13, s29, -v2
    s_cbranch_vccnz aloopH_40_rq_v
aloopH_40_vok:
    v_smfmac_f32_16x16x64_bf16 v[24:27], v[64:67], v[192:199], v166
    v_fma_f32 v14, v14, s29, -v2
    v_exp_f32 v12, v12
    v_smfmac_f32_16x16x64_bf16 v[32:35], v[64:67], v[224:231], v166
    v_fma_f32 v15, v15, s29, -v2
    v_exp_f32 v13, v13
    v_smfmac_f32_16x16x64_bf16 v[28:31], v[64:67], v[208:215], v166
    v_fma_f32 v16, v16, s29, -v2
    v_exp_f32 v14, v14
    v_smfmac_f32_16x16x64_bf16 v[36:39], v[64:67], v[240:247], v166
    v_fma_f32 v17, v17, s29, -v2
    v_exp_f32 v15, v15
    v_smfmac_f32_16x16x64_bf16 v[24:27], v[68:71], v[200:207], v166
    v_fma_f32 v18, v18, s29, -v2
    v_exp_f32 v16, v16
    v_smfmac_f32_16x16x64_bf16 v[32:35], v[68:71], v[232:239], v166
    v_fma_f32 v19, v19, s29, -v2
    v_exp_f32 v17, v17
    v_smfmac_f32_16x16x64_bf16 v[28:31], v[68:71], v[216:223], v166
    v_fma_f32 v20, v20, s29, -v2
    v_exp_f32 v18, v18
    v_smfmac_f32_16x16x64_bf16 v[36:39], v[68:71], v[248:255], v166
    v_fma_f32 v21, v21, s29, -v2
    v_exp_f32 v19, v19
    v_exp_f32 v20, v20
    v_exp_f32 v21, v21
    v_cvt_pk_bf16_f32 v12, v12, v13
    v_cvt_pk_bf16_f32 v13, v14, v15
    v_cvt_pk_bf16_f32 v14, v16, v17
    v_cvt_pk_bf16_f32 v15, v18, v19
    v_cvt_pk_bf16_f32 v20, v20, v21
    v_mov_b32 v22, 0
    v_mfma_f32_16x16x32_bf16 v[16:19], v[4:7], v[12:15], 0
    v_mov_b32 v21, v20
    v_mov_b32 v23, 0
    v_cvt_pk_bf16_f32 v40, v24, v25
    v_cvt_pk_bf16_f32 v41, v26, v27
    v_mfma_f32_16x16x32_bf16 v[16:19], v[8:11], v[20:23], v[16:19]
    v_mfma_f32_16x16x32_bf16 v[24:27], v[80:83], v[12:15], 0
    v_cvt_pk_bf16_f32 v44, v32, v33
    v_cvt_pk_bf16_f32 v45, v34, v35
    v_mfma_f32_16x16x32_bf16 v[32:35], v[88:91], v[12:15], 0
    v_cvt_pk_bf16_f32 v42, v28, v29
    v_cvt_pk_bf16_f32 v43, v30, v31
    v_mfma_f32_16x16x32_bf16 v[28:31], v[84:87], v[12:15], 0
    v_cvt_pk_bf16_f32 v46, v36, v37
    v_cvt_pk_bf16_f32 v47, v38, v39
    v_mfma_f32_16x16x32_bf16 v[36:39], v[92:95], v[12:15], 0
aloopH_40_midE:
    s_mov_b64 vcc, s[56:57]
    v_rcp_f32 v3, v16
    v_mfma_f32_16x16x32_bf16 v[24:27], v[40:43], v[20:23], v[24:27]
    v_mfma_f32_16x16x32_bf16 v[32:35], v[44:47], v[20:23], v[32:35]
    v_mfma_f32_16x16x32_bf16 v[28:31], v[42:45], v[20:23], v[28:31]
    v_mfma_f32_16x16x32_bf16 v[36:39], v[46:49], v[20:23], v[36:39]
    v_mov_b32_dpp v3, v3 quad_perm:[2,3,2,3] row_mask:0xf bank_mask:0xf
    s_nop 4
    v_cndmask_b32_dpp v24, v32, v24, vcc quad_perm:[2,3,2,3] row_mask:0xf bank_mask:0xf
    v_cndmask_b32_dpp v25, v33, v25, vcc quad_perm:[2,3,2,3] row_mask:0xf bank_mask:0xf
    v_cndmask_b32_dpp v26, v34, v26, vcc quad_perm:[2,3,2,3] row_mask:0xf bank_mask:0xf
    v_cndmask_b32_dpp v27, v35, v27, vcc quad_perm:[2,3,2,3] row_mask:0xf bank_mask:0xf
    v_cndmask_b32_dpp v28, v36, v28, vcc quad_perm:[2,3,2,3] row_mask:0xf bank_mask:0xf
    v_cndmask_b32_dpp v29, v37, v29, vcc quad_perm:[2,3,2,3] row_mask:0xf bank_mask:0xf
    v_cndmask_b32_dpp v30, v38, v30, vcc quad_perm:[2,3,2,3] row_mask:0xf bank_mask:0xf
    v_cndmask_b32_dpp v31, v39, v31, vcc quad_perm:[2,3,2,3] row_mask:0xf bank_mask:0xf
    v_mul_f32 v24, v24, v3
    v_mul_f32 v25, v25, v3
    v_mul_f32 v26, v26, v3
    v_mul_f32 v27, v27, v3
    v_mul_f32 v28, v28, v3
    v_mul_f32 v29, v29, v3
    v_mul_f32 v30, v30, v3
    v_mul_f32 v31, v31, v3
    v_cvt_pk_bf16_f32 v168, v24, v25
    v_cvt_pk_bf16_f32 v169, v26, v27
    v_cvt_pk_bf16_f32 v170, v28, v29
    v_cvt_pk_bf16_f32 v171, v30, v31
    ds_write_b128 v160, v[168:171]
    s_waitcnt lgkmcnt(0)
    s_barrier
    ds_read_b128 v[172:175], v161
    s_waitcnt lgkmcnt(0)
    v_mfma_f32_16x16x32_bf16 v[24:27], v[184:187], v[172:175], 0
    s_nop 7
    v_cvt_pk_bf16_f32 v168, v24, v25
    v_cvt_pk_bf16_f32 v169, v26, v27
    s_nop 0
    v_permlane16_swap_b32 v168, v170
    v_permlane16_swap_b32 v169, v171
    s_mov_b64 exec, 0xffff
    v_min_u32 v168, -2, v168
    buffer_store_dwordx4 v[168:171], v1, s[4:7], s25 offen sc1
    s_setprio 0
    buffer_store_dwordx4 v[176:179], v1, s[4:7], s26 offen sc1
    s_mov_b64 exec, -1
    s_branch pg_43
    s_cmp_lg_u32 s27, 0
    s_cbranch_scc1 pg_43
    s_sub_u32 s21, s16, 1
    s_cbranch_scc1 pg_43
    s_sub_u32 s17, s21, 1
    s_and_b32 s17, s17, 3
    s_cmp_ge_u32 s16, 58
    s_cselect_b32 s17, 0, s17
    s_cmp_lg_u32 s17, 0
    s_cbranch_scc1 pg_43
    v_mov_b32 v3, s21
    s_mov_b64 exec, 1
    buffer_store_dword v3, off, s[4:7], s28 sc1
    s_mov_b64 exec, -1
pg_43:
aloopH_40_lskb:
    v_mov_b32 v64, 0xff61b1e6
    ds_read_b128 v[128:131], v163 offset:16384
    ds_read_b128 v[132:135], v163 offset:17408
    ds_read_b128 v[136:139], v163 offset:18432
    ds_read_b128 v[140:143], v163 offset:19456
    ds_read_b128 v[144:147], v163 offset:20480
    ds_read_b128 v[148:151], v163 offset:21504
    ds_read_b128 v[152:155], v163 offset:22528
    ds_read_b128 v[156:159], v163 offset:23552
    s_waitcnt lgkmcnt(4)
    v_mfma_f32_16x16x32_bf16 v[12:15], v[96:99], v[128:131], 0
    v_mfma_f32_16x16x32_bf16 v[20:23], v[48:51], v[128:131], 0
    v_mfma_f32_16x16x32_bf16 v[12:15], v[100:103], v[132:135], v[12:15]
    v_mfma_f32_16x16x32_bf16 v[20:23], v[52:55], v[132:135], v[20:23]
    v_mfma_f32_16x16x32_bf16 v[12:15], v[104:107], v[136:139], v[12:15]
    v_mfma_f32_16x16x32_bf16 v[20:23], v[56:59], v[136:139], v[20:23]
    v_mfma_f32_16x16x32_bf16 v[12:15], v[108:111], v[140:143], v[12:15]
    v_mfma_f32_16x16x32_bf16 v[20:23], v[60:63], v[140:143], v[20:23]
    s_waitcnt lgkmcnt(0)
    v_mfma_f32_16x16x32_bf16 v[68:71], v[96:99], v[144:147], 0
    v_mfma_f32_16x16x32_bf16 v[72:75], v[112:115], v[144:147], 0
    v_mfma_f32_16x16x32_bf16 v[76:79], v[48:51], v[144:147], 0
    v_mfma_f32_16x16x32_bf16 v[68:71], v[100:103], v[148:151], v[68:71]
    v_mfma_f32_16x16x32_bf16 v[72:75], v[116:119], v[148:151], v[72:75]
    v_mfma_f32_16x16x32_bf16 v[76:79], v[52:55], v[148:151], v[76:79]
    v_mfma_f32_16x16x32_bf16 v[68:71], v[104:107], v[152:155], v[68:71]
    v_mfma_f32_16x16x32_bf16 v[72:75], v[120:123], v[152:155], v[72:75]
    v_mfma_f32_16x16x32_bf16 v[76:79], v[56:59], v[152:155], v[76:79]
    v_mfma_f32_16x16x32_bf16 v[68:71], v[108:111], v[156:159], v[68:71]
    v_mfma_f32_16x16x32_bf16 v[72:75], v[124:127], v[156:159], v[72:75]
    v_mfma_f32_16x16x32_bf16 v[76:79], v[60:63], v[156:159], v[76:79]
    v_cndmask_b32 v12, v12, v64, s[44:45]
    v_cndmask_b32 v13, v13, v64, s[46:47]
    v_cndmask_b32 v14, v14, v64, s[48:49]
    v_cndmask_b32 v15, v15, v64, s[50:51]
    s_add_u32 s17, s41, 20971520
    buffer_load_dwordx4 v[96:99], v0, s[4:7], s17 offen offset:0 sc1
    v_max3_f32 v2, v12, v13, v14
    buffer_load_dwordx4 v[100:103], v0, s[4:7], s17 offen offset:1024 sc1
    v_max3_f32 v3, v15, v20, v21
    buffer_load_dwordx4 v[104:107], v0, s[4:7], s17 offen offset:2048 sc1
    v_max_f32 v2, v2, v3
    buffer_load_dwordx4 v[108:111], v0, s[4:7], s17 offen offset:3072 sc1
    v_mov_b32 v3, v2
    s_add_u32 s18, s41, 21102592
    buffer_load_dwordx4 v[112:115], v0, s[4:7], s18 offen offset:0 sc1
    s_nop 1
    buffer_load_dwordx4 v[116:119], v0, s[4:7], s18 offen offset:1024 sc1
    v_permlane16_swap_b32 v3, v2
    buffer_load_dwordx4 v[120:123], v0, s[4:7], s18 offen offset:2048 sc1
    v_max_f32 v2, v2, v3
    buffer_load_dwordx4 v[124:127], v0, s[4:7], s18 offen offset:3072 sc1
    v_mov_b32 v3, v2
    s_nop 1
    v_permlane32_swap_b32 v3, v2
    v_max_f32 v2, v2, v3
    v_mul_f32 v2, s29, v2
    v_fma_f32 v12, v12, s29, -v2
    v_fma_f32 v13, v13, s29, -v2
    v_fma_f32 v14, v14, s29, -v2
    v_exp_f32 v12, v12
    v_fma_f32 v15, v15, s29, -v2
    v_exp_f32 v13, v13
    v_fma_f32 v20, v20, s29, -v2
    v_exp_f32 v14, v14
    v_fma_f32 v21, v21, s29, -v2
    v_exp_f32 v15, v15
    v_exp_f32 v20, v20
    v_exp_f32 v21, v21
    v_cvt_pk_bf16_f32 v12, v12, v13
    v_cvt_pk_bf16_f32 v13, v14, v15
    v_mov_b32 v14, 0
    v_mov_b32 v15, 0
    v_cvt_pk_bf16_f32 v20, v20, v21
    v_mov_b32 v22, 0
    v_mov_b32 v21, v20
    v_mov_b32 v23, 0
    s_nop 1
    v_cndmask_b32 v72, v72, v64, s[44:45]
    v_mfma_f32_16x16x32_bf16 v[16:19], v[4:7], v[12:15], 0
    v_cndmask_b32 v73, v73, v64, s[46:47]
    v_cndmask_b32 v74, v74, v64, s[48:49]
    v_mfma_f32_16x16x32_bf16 v[16:19], v[8:11], v[20:23], v[16:19]
    v_cndmask_b32 v75, v75, v64, s[50:51]
    v_max3_f32 v2, v68, v69, v70
    v_mfma_f32_16x16x32_bf16 v[24:27], v[80:83], v[12:15], 0
    v_max3_f32 v3, v71, v72, v73
    v_max3_f32 v2, v2, v74, v75
    v_mfma_f32_16x16x32_bf16 v[24:27], v[40:43], v[20:23], v[24:27]
    v_max3_f32 v3, v3, v76, v77
    v_max_f32 v2, v2, v3
    v_mfma_f32_16x16x32_bf16 v[28:31], v[84:87], v[12:15], 0
    v_mov_b32 v3, v2
    s_nop 1
    v_mfma_f32_16x16x32_bf16 v[28:31], v[42:45], v[20:23], v[28:31]
    v_permlane16_swap_b32 v3, v2
    v_max_f32 v2, v2, v3
    v_mfma_f32_16x16x32_bf16 v[32:35], v[88:91], v[12:15], 0
    v_mov_b32 v3, v2
    s_nop 1
    v_mfma_f32_16x16x32_bf16 v[32:35], v[44:47], v[20:23], v[32:35]
    v_permlane32_swap_b32 v3, v2
    v_max_f32 v2, v2, v3
    v_mfma_f32_16x16x32_bf16 v[36:39], v[92:95], v[12:15], 0
    v_mul_f32 v2, s29, v2
    v_fma_f32 v68, v68, s29, -v2
    v_mfma_f32_16x16x32_bf16 v[36:39], v[46:49], v[20:23], v[36:39]
    v_fma_f32 v69, v69, s29, -v2
    v_fma_f32 v70, v70, s29, -v2
    v_exp_f32 v68, v68
    v_fma_f32 v71, v71, s29, -v2
    v_exp_f32 v69, v69
    v_fma_f32 v72, v72, s29, -v2
    v_exp_f32 v70, v70
    v_fma_f32 v73, v73, s29, -v2
    v_exp_f32 v71, v71
    v_fma_f32 v74, v74, s29, -v2
    v_exp_f32 v72, v72
    v_fma_f32 v75, v75, s29, -v2
    v_exp_f32 v73, v73
    v_fma_f32 v76, v76, s29, -v2
    v_exp_f32 v74, v74
    v_fma_f32 v77, v77, s29, -v2
    v_exp_f32 v75, v75
    v_exp_f32 v76, v76
    v_exp_f32 v77, v77
    v_cvt_pk_bf16_f32 v68, v68, v69
    v_cvt_pk_bf16_f32 v69, v70, v71
    v_cvt_pk_bf16_f32 v70, v72, v73
    v_cvt_pk_bf16_f32 v71, v74, v75
    v_cvt_pk_bf16_f32 v76, v76, v77
    v_mov_b32 v78, 0
    v_mov_b32 v77, v76
    v_mov_b32 v79, 0
    v_rcp_f32 v66, v16
    s_nop 0
    v_mul_f32 v24, v24, v66
    v_mul_f32 v25, v25, v66
    v_mul_f32 v26, v26, v66
    v_mul_f32 v27, v27, v66
    v_cvt_pk_bf16_f32 v168, v24, v25
    v_cvt_pk_bf16_f32 v169, v26, v27
    v_mul_f32 v28, v28, v66
    v_mul_f32 v29, v29, v66
    v_mul_f32 v30, v30, v66
    v_mul_f32 v31, v31, v66
    v_cvt_pk_bf16_f32 v170, v28, v29
    v_cvt_pk_bf16_f32 v171, v30, v31
    v_mul_f32 v32, v32, v66
    v_mul_f32 v33, v33, v66
    v_mul_f32 v34, v34, v66
    v_mul_f32 v35, v35, v66
    v_cvt_pk_bf16_f32 v172, v32, v33
    v_cvt_pk_bf16_f32 v173, v34, v35
    v_mul_f32 v36, v36, v66
    v_mul_f32 v37, v37, v66
    v_mul_f32 v38, v38, v66
    v_mul_f32 v39, v39, v66
    v_cvt_pk_bf16_f32 v174, v36, v37
    v_cvt_pk_bf16_f32 v175, v38, v39
    ds_write_b128 v162, v[168:171] offset:0
    ds_write_b128 v162, v[172:175] offset:2048
    v_mfma_f32_16x16x32_bf16 v[72:75], v[4:7], v[68:71], 0
    v_mfma_f32_16x16x32_bf16 v[72:75], v[8:11], v[76:79], v[72:75]
    v_mfma_f32_16x16x32_bf16 v[24:27], v[80:83], v[68:71], 0
    v_mfma_f32_16x16x32_bf16 v[24:27], v[40:43], v[76:79], v[24:27]
    v_mfma_f32_16x16x32_bf16 v[28:31], v[84:87], v[68:71], 0
    v_mfma_f32_16x16x32_bf16 v[28:31], v[42:45], v[76:79], v[28:31]
    v_mfma_f32_16x16x32_bf16 v[32:35], v[88:91], v[68:71], 0
    v_mfma_f32_16x16x32_bf16 v[32:35], v[44:47], v[76:79], v[32:35]
    v_mfma_f32_16x16x32_bf16 v[36:39], v[92:95], v[68:71], 0
    v_mfma_f32_16x16x32_bf16 v[36:39], v[46:49], v[76:79], v[36:39]
    v_rcp_f32 v3, v72
    s_nop 0
    v_mul_f32 v24, v24, v3
    v_mul_f32 v25, v25, v3
    v_mul_f32 v26, v26, v3
    v_mul_f32 v27, v27, v3
    v_cvt_pk_bf16_f32 v168, v24, v25
    v_cvt_pk_bf16_f32 v169, v26, v27
    v_mul_f32 v28, v28, v3
    v_mul_f32 v29, v29, v3
    v_mul_f32 v30, v30, v3
    v_mul_f32 v31, v31, v3
    v_cvt_pk_bf16_f32 v170, v28, v29
    v_cvt_pk_bf16_f32 v171, v30, v31
    v_mul_f32 v32, v32, v3
    v_mul_f32 v33, v33, v3
    v_mul_f32 v34, v34, v3
    v_mul_f32 v35, v35, v3
    v_cvt_pk_bf16_f32 v172, v32, v33
    v_cvt_pk_bf16_f32 v173, v34, v35
    v_mul_f32 v36, v36, v3
    v_mul_f32 v37, v37, v3
    v_mul_f32 v38, v38, v3
    v_mul_f32 v39, v39, v3
    v_cvt_pk_bf16_f32 v174, v36, v37
    v_cvt_pk_bf16_f32 v175, v38, v39
    ds_write_b128 v162, v[168:171] offset:256
    ds_write_b128 v162, v[172:175] offset:2304
    v_xor_b32 v162, 0x4000, v162
    s_add_u32 s16, s16, 1
    s_cmp_le_u32 s16, 63
    s_cbranch_scc1 aloopH_40
    s_waitcnt lgkmcnt(0)
    s_barrier
    s_waitcnt vmcnt(0)
    s_branch k_end
aloopH_40_rq_0:
    s_sub_u32 s22, s22, 1
    s_cbranch_scc1 aloopH_40_rq_0_g
    buffer_load_dwordx4 v[48:51], v0, s[4:7], s23 offen offset:0 sc1
    buffer_load_dwordx4 v[52:55], v0, s[4:7], s23 offen offset:1024 sc1
    buffer_load_dwordx4 v[56:59], v0, s[4:7], s23 offen offset:2048 sc1
    buffer_load_dwordx4 v[60:63], v0, s[4:7], s23 offen offset:3072 sc1
    buffer_load_dwordx4 v[64:67], v0, s[4:7], s24 offen offset:0 sc1
    buffer_load_dwordx4 v[68:71], v0, s[4:7], s24 offen offset:1024 sc1
    s_waitcnt vmcnt(5)
    v_max_u32 v3, v48, v50
    v_cmp_eq_u32 vcc, -1, v3
    s_cbranch_vccnz aloopH_40_rq_0
    s_branch aloopH_40_again
aloopH_40_rq_0_g:
    s_mov_b32 s22, 0
    s_waitcnt vmcnt(0)
    s_branch aloopH_40_nochk
aloopH_40_rq_1:
    s_sub_u32 s22, s22, 1
    s_cbranch_scc1 aloopH_40_rq_1_g
    buffer_load_dwordx4 v[52:55], v0, s[4:7], s23 offen offset:1024 sc1
    buffer_load_dwordx4 v[56:59], v0, s[4:7], s23 offen offset:2048 sc1
    buffer_load_dwordx4 v[60:63], v0, s[4:7], s23 offen offset:3072 sc1
    buffer_load_dwordx4 v[64:67], v0, s[4:7], s24 offen offset:0 sc1
    buffer_load_dwordx4 v[68:71], v0, s[4:7], s24 offen offset:1024 sc1
    s_waitcnt vmcnt(4)
    v_max_u32 v3, v52, v54
    v_cmp_eq_u32 vcc, -1, v3
    s_cbranch_vccnz aloopH_40_rq_1
    s_branch aloopH_40_again
aloopH_40_rq_1_g:
    s_mov_b32 s22, 0
    s_waitcnt vmcnt(0)
    s_branch aloopH_40_nochk
aloopH_40_rq_2:
    s_sub_u32 s22, s22, 1
    s_cbranch_scc1 aloopH_40_rq_2_g
    buffer_load_dwordx4 v[56:59], v0, s[4:7], s23 offen offset:2048 sc1
    buffer_load_dwordx4 v[60:63], v0, s[4:7], s23 offen offset:3072 sc1
    buffer_load_dwordx4 v[64:67], v0, s[4:7], s24 offen offset:0 sc1
    buffer_load_dwordx4 v[68:71], v0, s[4:7], s24 offen offset:1024 sc1
    s_waitcnt vmcnt(3)
    v_max_u32 v3, v56, v58
    v_cmp_eq_u32 vcc, -1, v3
    s_cbranch_vccnz aloopH_40_rq_2
    s_branch aloopH_40_again
aloopH_40_rq_2_g:
    s_mov_b32 s22, 0
    s_waitcnt vmcnt(0)
    s_branch aloopH_40_nochk
aloopH_40_rq_3:
    s_sub_u32 s22, s22, 1
    s_cbranch_scc1 aloopH_40_rq_3_g
    buffer_load_dwordx4 v[60:63], v0, s[4:7], s23 offen offset:3072 sc1
    buffer_load_dwordx4 v[64:67], v0, s[4:7], s24 offen offset:0 sc1
    buffer_load_dwordx4 v[68:71], v0, s[4:7], s24 offen offset:1024 sc1
    s_waitcnt vmcnt(2)
    v_max_u32 v3, v60, v62
    v_cmp_eq_u32 vcc, -1, v3
    s_cbranch_vccnz aloopH_40_rq_3
    s_branch aloopH_40_again
aloopH_40_rq_3_g:
    s_mov_b32 s22, 0
    s_waitcnt vmcnt(0)
    s_branch aloopH_40_nochk
aloopH_40_again:
    s_waitcnt vmcnt(5)
    v_mfma_f32_16x16x32_bf16 v[12:15], v[96:99], v[48:51], 0
    v_mfma_f32_16x16x32_bf16 v[16:19], v[112:115], v[48:51], 0
    v_max_u32 v3, v48, v50
    v_cmp_eq_u32 vcc, -1, v3
    v_mfma_f32_16x16x32_bf16 v[20:23], v[48:51], v[48:51], 0
    s_cbranch_vccnz aloopH_40_rq_0
    s_waitcnt vmcnt(4)
    v_mfma_f32_16x16x32_bf16 v[12:15], v[100:103], v[52:55], v[12:15]
    v_mfma_f32_16x16x32_bf16 v[16:19], v[116:119], v[52:55], v[16:19]
    v_max_u32 v3, v52, v54
    v_cmp_eq_u32 vcc, -1, v3
    v_mfma_f32_16x16x32_bf16 v[20:23], v[52:55], v[52:55], v[20:23]
    s_cbranch_vccnz aloopH_40_rq_1
    s_waitcnt vmcnt(3)
    v_mfma_f32_16x16x32_bf16 v[12:15], v[104:107], v[56:59], v[12:15]
    v_mfma_f32_16x16x32_bf16 v[16:19], v[120:123], v[56:59], v[16:19]
    v_max_u32 v3, v56, v58
    v_cmp_eq_u32 vcc, -1, v3
    v_mfma_f32_16x16x32_bf16 v[20:23], v[56:59], v[56:59], v[20:23]
    s_cbranch_vccnz aloopH_40_rq_2
    s_waitcnt vmcnt(2)
    v_mfma_f32_16x16x32_bf16 v[12:15], v[108:111], v[60:63], v[12:15]
    v_mfma_f32_16x16x32_bf16 v[16:19], v[124:127], v[60:63], v[16:19]
    v_max_u32 v3, v60, v62
    v_cmp_eq_u32 vcc, -1, v3
    v_mfma_f32_16x16x32_bf16 v[20:23], v[60:63], v[60:63], v[20:23]
    s_cbranch_vccnz aloopH_40_rq_3
    s_branch aloopH_40_sdone
aloopH_40_rq_v:
    s_sub_u32 s22, s22, 1
    s_cbranch_scc1 aloopH_40_rq_vg
    buffer_load_dwordx4 v[64:67], v0, s[4:7], s24 offen offset:0 sc1
    buffer_load_dwordx4 v[68:71], v0, s[4:7], s24 offen offset:1024 sc1
    s_waitcnt vmcnt(0)
    v_max3_u32 v188, v64, v66, v68
    v_max_u32 v188, v188, v70
    v_cmp_eq_u32 vcc, -1, v188
    s_cbranch_vccnz aloopH_40_rq_v
    s_branch aloopH_40_vok
aloopH_40_rq_vg:
    s_mov_b32 s22, 0
    s_branch aloopH_40_vok
aloopH_40_nochk:
    v_mfma_f32_16x16x32_bf16 v[12:15], v[96:99], v[48:51], 0
    v_mfma_f32_16x16x32_bf16 v[16:19], v[112:115], v[48:51], 0
    v_mfma_f32_16x16x32_bf16 v[20:23], v[48:51], v[48:51], 0
    v_mfma_f32_16x16x32_bf16 v[12:15], v[100:103], v[52:55], v[12:15]
    v_mfma_f32_16x16x32_bf16 v[16:19], v[116:119], v[52:55], v[16:19]
    v_mfma_f32_16x16x32_bf16 v[20:23], v[52:55], v[52:55], v[20:23]
    v_mfma_f32_16x16x32_bf16 v[12:15], v[104:107], v[56:59], v[12:15]
    v_mfma_f32_16x16x32_bf16 v[16:19], v[120:123], v[56:59], v[16:19]
    v_mfma_f32_16x16x32_bf16 v[20:23], v[56:59], v[56:59], v[20:23]
    v_mfma_f32_16x16x32_bf16 v[12:15], v[108:111], v[60:63], v[12:15]
    v_mfma_f32_16x16x32_bf16 v[16:19], v[124:127], v[60:63], v[16:19]
    v_mfma_f32_16x16x32_bf16 v[20:23], v[60:63], v[60:63], v[20:23]
    s_nop 1
    s_branch aloopH_40_sdone
aloopH_40_rq_v2:
    s_sub_u32 s22, s22, 1
    s_cbranch_scc1 aloopH_40_rq_v2g
    buffer_load_dwordx4 v[64:67], v0, s[4:7], s24 offen offset:0 sc1
    buffer_load_dwordx4 v[68:71], v0, s[4:7], s24 offen offset:1024 sc1
    s_waitcnt vmcnt(0)
    v_max3_u32 v188, v64, v66, v68
    v_max_u32 v188, v188, v70
    v_cmp_eq_u32 vcc, -1, v188
    s_cbranch_vccnz aloopH_40_rq_v2
    s_branch aloopH_40_lsk3
aloopH_40_rq_v2g:
    s_mov_b32 s22, 0
    s_branch aloopH_40_lsk3
ct_tail:
aloopH_40_lsk:
    s_cmp_lg_u32 s27, 0
    s_cbranch_scc1 aloopH_40_lsk2
    v_mov_b32 v3, 62
    s_mov_b64 exec, 1
    buffer_store_dword v3, off, s[4:7], s28 sc1
    s_mov_b64 exec, -1
aloopH_40_lsk2:
    s_waitcnt vmcnt(0)
    v_max3_u32 v188, v64, v66, v68
    v_max_u32 v188, v188, v70
    v_cmp_eq_u32 vcc, -1, v188
    s_cbranch_vccnz aloopH_40_rq_v2
aloopH_40_lsk3:
    v_smfmac_f32_16x16x64_bf16 v[24:27], v[64:67], v[192:199], v166
    v_smfmac_f32_16x16x64_bf16 v[32:35], v[64:67], v[224:231], v166
    v_smfmac_f32_16x16x64_bf16 v[28:31], v[64:67], v[208:215], v166
    v_smfmac_f32_16x16x64_bf16 v[36:39], v[64:67], v[240:247], v166
    v_smfmac_f32_16x16x64_bf16 v[24:27], v[68:71], v[200:207], v166
    v_smfmac_f32_16x16x64_bf16 v[32:35], v[68:71], v[232:239], v166
    v_smfmac_f32_16x16x64_bf16 v[28:31], v[68:71], v[216:223], v166
    v_smfmac_f32_16x16x64_bf16 v[36:39], v[68:71], v[248:255], v166
    s_nop 7
    s_nop 1
    v_cvt_pk_bf16_f32 v40, v24, v25
    v_cvt_pk_bf16_f32 v41, v26, v27
    v_cvt_pk_bf16_f32 v42, v28, v29
    v_cvt_pk_bf16_f32 v43, v30, v31
    v_cvt_pk_bf16_f32 v44, v32, v33
    v_cvt_pk_bf16_f32 v45, v34, v35
    v_cvt_pk_bf16_f32 v46, v36, v37
    v_cvt_pk_bf16_f32 v47, v38, v39
    s_waitcnt lgkmcnt(0)
    s_branch aloopH_40_lskb
k_end:
k_exit:
    s_endpgm
.section .rodata,"a"
.p2align 6
jobtab:
    .long 4, 24, 24, 8192, 0, 262144, 8388608, 0, 32768, 4, 20971520, 131072, 0, 0, 218104321, 0
    .long 4, 24, 24, 8192, 256, 262400, 8388608, 0, 32768, 4, 20975616, 131072, 0, 0, 218104321, 0
    .long 4, 24, 24, 8192, 512, 262656, 8388608, 0, 32768, 4, 20979712, 131072, 0, 0, 218104321, 0
    .long 4, 24, 24, 8192, 768, 262912, 8388608, 0, 32768, 4, 20983808, 131072, 0, 0, 218104321, 0
    .long 4, 24, 24, 8192, 1024, 263168, 8388608, 0, 32768, 4, 20987904, 131072, 0, 0, 218104337, 0
    .long 4, 24, 24, 8192, 1280, 263424, 8388608, 0, 32768, 4, 20992000, 131072, 0, 0, 218104337, 0
    .long 4, 24, 24, 8192, 1536, 263680, 8388608, 0, 32768, 4, 20996096, 131072, 0, 0, 218104337, 0
    .long 4, 24, 24, 8192, 1792, 263936, 8388608, 0, 32768, 4, 21000192, 131072, 0, 0, 218104337, 0
    .long 4, 32, 32, 8192, 0, 262144, 8388608, 0, 32768, 4, 37748736, 131072, 0, 0, 218104321, 0
    .long 4, 32, 32, 8192, 256, 262400, 8388608, 0, 32768, 4, 37752832, 131072, 0, 0, 218104321, 0
    .long 4, 32, 32, 8192, 512, 262656, 8388608, 0, 32768, 4, 37756928, 131072, 0, 0, 218104321, 0
    .long 4, 32, 32, 8192, 768, 262912, 8388608, 0, 32768, 4, 37761024, 131072, 0, 0, 218104321, 0
    .long 4, 32, 32, 8192, 1024, 263168, 8388608, 0, 32768, 4, 37765120, 131072, 0, 0, 218104337, 0
    .long 4, 32, 32, 8192, 1280, 263424, 8388608, 0, 32768, 4, 37769216, 131072, 0, 0, 218104337, 0
    .long 4, 32, 32, 8192, 1536, 263680, 8388608, 0, 32768, 4, 37773312, 131072, 0, 0, 218104337, 0
    .long 4, 32, 32, 8192, 1792, 263936, 8388608, 0, 32768, 4, 37777408, 131072, 0, 0, 218104337, 0
    .long 4, 24, 24, 8192, 0, 262144, 8388608, 262144, 32768, 4, 22020096, 131072, 0, 0, 218104324, 0
    .long 4, 24, 24, 8192, 256, 262400, 8388608, 262144, 32768, 4, 22024192, 131072, 0, 0, 218104324, 0
    .long 4, 24, 24, 8192, 512, 262656, 8388608, 262144, 32768, 4, 22028288, 131072, 0, 0, 218104324, 0
    .long 4, 24, 24, 8192, 768, 262912, 8388608, 262144, 32768, 4, 22032384, 131072, 0, 0, 218104324, 0
    .long 4, 24, 24, 8192, 1024, 263168, 8388608, 262144, 32768, 4, 22036480, 131072, 0, 0, 218104340, 0
    .long 4, 24, 24, 8192, 1280, 263424, 8388608, 262144, 32768, 4, 22040576, 131072, 0, 0, 218104340, 0
    .long 4, 24, 24, 8192, 1536, 263680, 8388608, 262144, 32768, 4, 22044672, 131072, 0, 0, 218104340, 0
    .long 4, 24, 24, 8192, 1792, 263936, 8388608, 262144, 32768, 4, 22048768, 131072, 0, 0, 218104340, 0
    .long 4, 32, 32, 8192, 0, 262144, 8388608, 262144, 32768, 4, 38797312, 131072, 0, 0, 218104324, 0
    .long 4, 32, 32, 8192, 256, 262400, 8388608, 262144, 32768, 4, 38801408, 131072, 0, 0, 218104324, 0
    .long 4, 32, 32, 8192, 512, 262656, 8388608, 262144, 32768, 4, 38805504, 131072, 0, 0, 218104324, 0
    .long 4, 32, 32, 8192, 768, 262912, 8388608, 262144, 32768, 4, 38809600, 131072, 0, 0, 218104324, 0
    .long 4, 32, 32, 8192, 1024, 263168, 8388608, 262144, 32768, 4, 38813696, 131072, 0, 0, 218104340, 0
    .long 4, 32, 32, 8192, 1280, 263424, 8388608, 262144, 32768, 4, 38817792, 131072, 0, 0, 218104340, 0
    .long 4, 32, 32, 8192, 1536, 263680, 8388608, 262144, 32768, 4, 38821888, 131072, 0, 0, 218104340, 0
    .long 4, 32, 32, 8192, 1792, 263936, 8388608, 262144, 32768, 4, 38825984, 131072, 0, 0, 218104340, 0
    .long 4, 32, 32, 8192, 256, 262400, 8388608, 786432, 32768, 4, 40898560, 131072, 0, 0, 218104580, 0
    .long 4, 24, 24, 8192, 512, 262656, 8388608, 786432, 32768, 4, 24125440, 131072, 0, 0, 218104580, 0
    .long 4, 24, 24, 8192, 1536, 263680, 8388608, 786432, 32768, 4, 24141824, 131072, 0, 0, 218104596, 0
    .long 4, 32, 32, 8192, 768, 262912, 8388608, 524288, 32768, 4, 39858176, 131072, 0, 0, 218104577, 0
    .long 4, 32, 32, 8192, 1536, 263680, 8388608, 786432, 32768, 4, 40919040, 131072, 0, 0, 218104596, 0
    .long 4, 32, 32, 8192, 1280, 263424, 8388608, 524288, 32768, 4, 39866368, 131072, 0, 0, 218104593, 0
    .long 4, 24, 24, 8192, 1024, 263168, 8388608, 786432, 32768, 4, 24133632, 131072, 0, 0, 218104596, 0
    .long 4, 32, 32, 8192, 1792, 263936, 8388608, 524288, 32768, 4, 39874560, 131072, 0, 0, 218104593, 0
    .long 4, 32, 32, 8192, 512, 262656, 8388608, 786432, 32768, 4, 40902656, 131072, 0, 0, 218104580, 0
    .long 4, 32, 32, 8192, 512, 262656, 8388608, 524288, 32768, 4, 39854080, 131072, 0, 0, 218104577, 0
    .long 4, 32, 32, 8192, 1024, 263168, 8388608, 786432, 32768, 4, 40910848, 131072, 0, 0, 218104596, 0
    .long 4, 24, 24, 8192, 768, 262912, 8388608, 524288, 32768, 4, 23080960, 131072, 0, 0, 218104577, 0
    .long 2, 64, 72, 7168, 0, 0, 7340032, 1048576, 32768, 8, 58195968, 114688, 0, 0, 218103937, 0
    .long 4, 24, 24, 8192, 256, 262400, 8388608, 786432, 32768, 4, 24121344, 131072, 0, 0, 218104580, 0
    .long 4, 24, 24, 8192, 1280, 263424, 8388608, 524288, 32768, 4, 23089152, 131072, 0, 0, 218104593, 0
    .long 4, 32, 32, 8192, 256, 262400, 8388608, 524288, 32768, 4, 39849984, 131072, 0, 0, 218104577, 0
    .long 4, 32, 32, 8192, 1792, 263936, 8388608, 786432, 32768, 4, 40923136, 131072, 0, 0, 218104596, 0
    .long 4, 24, 24, 8192, 0, 262144, 8388608, 524288, 32768, 4, 23068672, 131072, 0, 0, 218104577, 0
    .long 4, 24, 24, 8192, 1536, 263680, 8388608, 524288, 32768, 4, 23093248, 131072, 0, 0, 218104593, 0
    .long 4, 32, 32, 8192, 0, 262144, 8388608, 524288, 32768, 4, 39845888, 131072, 0, 0, 218104577, 0
    .long 4, 24, 24, 8192, 1792, 263936, 8388608, 524288, 32768, 4, 23097344, 131072, 0, 0, 218104593, 0
    .long 4, 32, 32, 8192, 0, 262144, 8388608, 786432, 32768, 4, 40894464, 131072, 0, 0, 218104580, 0
    .long 4, 24, 24, 8192, 768, 262912, 8388608, 786432, 32768, 4, 24129536, 131072, 0, 0, 218104580, 0
    .long 4, 32, 32, 8192, 768, 262912, 8388608, 786432, 32768, 4, 40906752, 131072, 0, 0, 218104580, 0
    .long 4, 32, 32, 8192, 1536, 263680, 8388608, 524288, 32768, 4, 39870464, 131072, 0, 0, 218104593, 0
    .long 4, 24, 24, 8192, 1024, 263168, 8388608, 524288, 32768, 4, 23085056, 131072, 0, 0, 218104593, 0
    .long 4, 32, 32, 8192, 1280, 263424, 8388608, 786432, 32768, 4, 40914944, 131072, 0, 0, 218104596, 0
    .long 4, 24, 24, 8192, 256, 262400, 8388608, 524288, 32768, 4, 23072768, 131072, 0, 0, 218104577, 0
    .long 4, 32, 32, 8192, 1024, 263168, 8388608, 524288, 32768, 4, 39862272, 131072, 0, 0, 218104593, 0
    .long 4, 24, 24, 8192, 512, 262656, 8388608, 524288, 32768, 4, 23076864, 131072, 0, 0, 218104577, 0
    .long 4, 24, 24, 8192, 1280, 263424, 8388608, 786432, 32768, 4, 24137728, 131072, 0, 0, 218104596, 0
    .long 4, 24, 24, 8192, 0, 262144, 8388608, 786432, 32768, 4, 24117248, 131072, 0, 0, 218104580, 0
    .long 1, 32, 32, 8192, 1024, 1280, 8388608, 1048576, 32768, 8, 41959424, 131072, 0, 0, 218104858, 0
    .long 1, 24, 24, 8192, 512, 768, 8388608, 1048576, 32768, 8, 25174016, 131072, 0, 0, 218104842, 0
    .long 1, 16, 16, 8192, 512, 768, 8388608, 1048576, 32768, 8, 8396800, 131072, 0, 0, 218104842, 0
    .long 1, 24, 24, 8192, 1024, 1280, 8388608, 1048576, 32768, 8, 25182208, 131072, 0, 0, 218104858, 0
    .long 4, 24, 24, 8192, 1792, 263936, 8388608, 786432, 32768, 4, 24145920, 131072, 0, 0, 218104596, 0
    .long 1, 16, 16, 8192, 0, 256, 8388608, 1048576, 32768, 8, 8388608, 131072, 0, 0, 218104842, 0
    .long 1, 24, 24, 8192, 512, 768, 8388608, 1572864, 32768, 8, 27271168, 131072, 0, 0, 218105098, 0
    .long 1, 32, 32, 8192, 1024, 1280, 8388608, 1572864, 32768, 8, 44056576, 131072, 0, 0, 218105114, 0
    .long 1, 24, 24, 8192, 0, 256, 8388608, 1048576, 32768, 8, 25165824, 131072, 0, 0, 218104842, 0
    .long 1, 32, 32, 8192, 512, 768, 8388608, 1048576, 32768, 8, 41951232, 131072, 0, 0, 218104842, 0
    .long 1, 16, 16, 8192, 1536, 1792, 8388608, 1572864, 32768, 8, 10510336, 131072, 0, 0, 218105114, 0
    .long 1, 16, 16, 8192, 0, 256, 8388608, 0, 32768, 8, 4194304, 131072, 0, 0, 218107914, 0
    .long 1, 24, 24, 8192, 1024, 1280, 8388608, 1572864, 32768, 8, 27279360, 131072, 0, 0, 218105114, 0
    .long 1, 32, 32, 8192, 1536, 1792, 8388608, 1572864, 32768, 8, 44064768, 131072, 0, 0, 218105114, 0
    .long 1, 32, 32, 8192, 0, 256, 8388608, 1048576, 32768, 8, 41943040, 131072, 0, 0, 218104842, 0
    .long 1, 16, 16, 8192, 1024, 1280, 8388608, 1572864, 32768, 8, 10502144, 131072, 0, 0, 218105114, 0
    .long 1, 32, 32, 8192, 1536, 1792, 8388608, 1048576, 32768, 8, 41967616, 131072, 0, 0, 218104858, 0
    .long 1, 24, 24, 8192, 1536, 1792, 8388608, 1572864, 32768, 8, 27287552, 131072, 0, 0, 218105114, 0
    .long 1, 16, 16, 8192, 1536, 1792, 8388608, 1048576, 32768, 8, 8413184, 131072, 0, 0, 218104858, 0
    .long 1, 32, 32, 8192, 0, 256, 8388608, 1572864, 32768, 8, 44040192, 131072, 0, 0, 218105098, 0
    .long 1, 16, 16, 8192, 1536, 1792, 8388608, 0, 32768, 8, 4218880, 131072, 0, 0, 218107930, 0
    .long 1, 16, 16, 8192, 512, 768, 8388608, 2097152, 32768, 8, 12591104, 131072, 0, 0, 218105354, 0
    .long 1, 16, 16, 8192, 1024, 1280, 8388608, 1048576, 32768, 8, 8404992, 131072, 0, 0, 218104858, 0
    .long 1, 16, 16, 8192, 0, 256, 8388608, 1572864, 32768, 8, 10485760, 131072, 0, 0, 218105098, 0
    .long 1, 32, 32, 8192, 0, 256, 8388608, 2097152, 32768, 8, 46137344, 131072, 0, 0, 218105354, 0
    .long 1, 16, 16, 8192, 512, 768, 8388608, 0, 32768, 8, 4202496, 131072, 0, 0, 218107914, 0
    .long 1, 24, 24, 8192, 1536, 1792, 8388608, 1048576, 32768, 8, 25190400, 131072, 0, 0, 218104858, 0
    .long 1, 16, 16, 8192, 512, 768, 8388608, 1572864, 32768, 8, 10493952, 131072, 0, 0, 218105098, 0
    .long 1, 16, 16, 8192, 1024, 1280, 8388608, 0, 32768, 8, 4210688, 131072, 0, 0, 218107930, 0
    .long 1, 32, 32, 8192, 512, 768, 8388608, 2097152, 32768, 8, 46145536, 131072, 0, 0, 218105354, 0
    .long 1, 32, 32, 8192, 512, 768, 8388608, 1572864, 32768, 8, 44048384, 131072, 0, 0, 218105098, 0
    .long 1, 24, 24, 8192, 0, 256, 8388608, 1572864, 32768, 8, 27262976, 131072, 0, 0, 218105098, 0
    .long 1, 16, 16, 8192, 0, 256, 8388608, 524288, 32768, 8, 6291456, 131072, 0, 0, 218108170, 0
    .long 1, 32, 32, 8192, 1024, 1280, 8388608, 3670016, 32768, 8, 52445184, 131072, 0, 0, 218106138, 0
    .long 1, 16, 16, 8192, 1024, 1280, 8388608, 2621440, 32768, 8, 14696448, 131072, 0, 0, 218105626, 0
    .long 1, 24, 24, 8192, 512, 768, 8388608, 3145728, 32768, 8, 33562624, 131072, 0, 0, 218105866, 0
    .long 1, 16, 16, 8192, 0, 256, 8388608, 2621440, 32768, 8, 14680064, 131072, 0, 0, 218105610, 0
    .long 1, 32, 32, 8192, 1536, 1792, 8388608, 3670016, 32768, 8, 52453376, 131072, 0, 0, 218106138, 0
    .long 1, 16, 16, 8192, 0, 256, 8388608, 3145728, 32768, 8, 16777216, 131072, 0, 0, 218105866, 0
    .long 1, 24, 24, 8192, 1024, 1280, 8388608, 2097152, 32768, 8, 29376512, 131072, 0, 0, 218105370, 0
    .long 1, 16, 16, 8192, 1536, 1792, 8388608, 2097152, 32768, 8, 12607488, 131072, 0, 0, 218105370, 0
    .long 1, 24, 24, 8192, 512, 768, 8388608, 3670016, 32768, 8, 35659776, 131072, 0, 0, 218106122, 0
    .long 1, 24, 24, 8192, 1536, 1792, 8388608, 3145728, 32768, 8, 33579008, 131072, 0, 0, 218105882, 0
    .long 1, 32, 32, 8192, 1536, 1792, 8388608, 2621440, 32768, 8, 48259072, 131072, 0, 0, 218105626, 0
    .long 1, 32, 32, 8192, 1536, 1792, 8388608, 2097152, 32768, 8, 46161920, 131072, 0, 0, 218105370, 0
    .long 1, 24, 24, 8192, 1536, 1792, 8388608, 2097152, 32768, 8, 29384704, 131072, 0, 0, 218105370, 0
    .long 1, 24, 24, 8192, 0, 256, 8388608, 2097152, 32768, 8, 29360128, 131072, 0, 0, 218105354, 0
    .long 1, 32, 32, 8192, 1536, 1792, 8388608, 3145728, 32768, 8, 50356224, 131072, 0, 0, 218105882, 0
    .long 1, 32, 32, 8192, 0, 256, 8388608, 3145728, 32768, 8, 50331648, 131072, 0, 0, 218105866, 0
    .long 1, 16, 16, 8192, 1024, 1280, 8388608, 3145728, 32768, 8, 16793600, 131072, 0, 0, 218105882, 0
    .long 1, 16, 16, 8192, 1024, 1280, 8388608, 2097152, 32768, 8, 12599296, 131072, 0, 0, 218105370, 0
    .long 5, 218107920, 0, 0, 4, 0, 0, 0, 0, 0, 0, 0, 218112000, 4, 218106881, 0
    .long 1, 32, 32, 8192, 1024, 1280, 8388608, 3145728, 32768, 8, 50348032, 131072, 0, 0, 218105882, 0
    .long 1, 24, 24, 8192, 1536, 1792, 8388608, 3670016, 32768, 8, 35676160, 131072, 0, 0, 218106138, 0
    .long 1, 32, 32, 8192, 0, 256, 8388608, 2621440, 32768, 8, 48234496, 131072, 0, 0, 218105610, 0
    .long 1, 32, 32, 8192, 1024, 1280, 8388608, 2097152, 32768, 8, 46153728, 131072, 0, 0, 218105370, 0
    .long 1, 24, 24, 8192, 512, 768, 8388608, 2621440, 32768, 8, 31465472, 131072, 0, 0, 218105610, 0
    .long 1, 24, 24, 8192, 512, 768, 8388608, 2097152, 32768, 8, 29368320, 131072, 0, 0, 218105354, 0
    .long 1, 16, 16, 8192, 1536, 1792, 8388608, 524288, 32768, 8, 6316032, 131072, 0, 0, 218108186, 0
    .long 1, 32, 32, 8192, 1024, 1280, 8388608, 2621440, 32768, 8, 48250880, 131072, 0, 0, 218105626, 0
    .long 1, 16, 16, 8192, 1024, 1280, 8388608, 524288, 32768, 8, 6307840, 131072, 0, 0, 218108186, 0
    .long 1, 24, 24, 8192, 0, 256, 8388608, 2621440, 32768, 8, 31457280, 131072, 0, 0, 218105610, 0
    .long 1, 16, 16, 8192, 0, 256, 8388608, 2097152, 32768, 8, 12582912, 131072, 0, 0, 218105354, 0
    .long 5, 218107920, 0, 0, 4, 0, 0, 4, 0, 0, 0, 0, 218112000, 8, 218106881, 0
    .long 5, 218107904, 0, 0, 0, 0, 0, 0, 0, 0, 0, 0, 218112000, 4, 218106881, 0
    .long 1, 24, 24, 8192, 1024, 1280, 8388608, 3670016, 32768, 8, 35667968, 131072, 0, 0, 218106138, 0
    .long 2, 64, 72, 7168, 0, 0, 7340032, 2097152, 32768, 8, 61865984, 114688, 0, 0, 218104065, 0
    .long 1, 24, 24, 8192, 1536, 1792, 8388608, 2621440, 32768, 8, 31481856, 131072, 0, 0, 218105626, 0
    .long 2, 64, 72, 7168, 256, 256, 7340032, 0, 32768, 8, 54530048, 114688, 0, 0, 218103809, 0
    .long 1, 24, 24, 8192, 0, 256, 8388608, 3670016, 32768, 8, 35651584, 131072, 0, 0, 218106122, 0
    .long 1, 32, 32, 8192, 512, 768, 8388608, 3670016, 32768, 8, 52436992, 131072, 0, 0, 218106122, 0
    .long 2, 64, 72, 7168, 1024, 1024, 7340032, 2621440, 32768, 8, 63717376, 114688, 0, 0, 218104129, 0
    .long 1, 32, 32, 8192, 512, 768, 8388608, 2621440, 32768, 8, 48242688, 131072, 0, 0, 218105610, 0
    .long 1, 16, 16, 8192, 512, 768, 8388608, 2621440, 32768, 8, 14688256, 131072, 0, 0, 218105610, 0
    .long 2, 64, 72, 7168, 0, 0, 7340032, 0, 32768, 8, 54525952, 114688, 0, 0, 218103809, 0
    .long 1, 16, 16, 8192, 1536, 1792, 8388608, 3145728, 32768, 8, 16801792, 131072, 0, 0, 218105882, 0
    .long 1, 24, 24, 8192, 1024, 1280, 8388608, 2621440, 32768, 8, 31473664, 131072, 0, 0, 218105626, 0
    .long 2, 64, 72, 7168, 256, 256, 7340032, 524288, 32768, 8, 56365056, 114688, 0, 0, 218103873, 0
    .long 1, 24, 24, 8192, 0, 256, 8388608, 3145728, 32768, 8, 33554432, 131072, 0, 0, 218105866, 0
    .long 2, 64, 72, 7168, 768, 768, 7340032, 0, 32768, 8, 54538240, 114688, 0, 0, 218103809, 0
    .long 2, 64, 72, 7168, 768, 768, 7340032, 524288, 32768, 8, 56373248, 114688, 0, 0, 218103873, 0
    .long 2, 64, 72, 7168, 512, 512, 7340032, 2097152, 32768, 8, 61874176, 114688, 0, 0, 218104065, 0
    .long 2, 64, 72, 7168, 1024, 1024, 7340032, 2097152, 32768, 8, 61882368, 114688, 0, 0, 218104065, 0
    .long 1, 16, 16, 8192, 512, 768, 8388608, 524288, 32768, 8, 6299648, 131072, 0, 0, 218108170, 0
    .long 1, 16, 16, 8192, 512, 768, 8388608, 3145728, 32768, 8, 16785408, 131072, 0, 0, 218105866, 0
    .long 2, 64, 72, 7168, 1024, 1024, 7340032, 0, 32768, 8, 54542336, 114688, 0, 0, 218103809, 0
    .long 2, 64, 72, 7168, 1280, 1280, 7340032, 0, 32768, 8, 54546432, 114688, 0, 0, 218103809, 0
    .long 1, 16, 16, 8192, 1536, 1792, 8388608, 2621440, 32768, 8, 14704640, 131072, 0, 0, 218105626, 0
    .long 1, 24, 24, 8192, 1024, 1280, 8388608, 3145728, 32768, 8, 33570816, 131072, 0, 0, 218105882, 0
    .long 2, 64, 72, 7168, 1280, 1280, 7340032, 3145728, 32768, 8, 65556480, 114688, 0, 0, 218104193, 0
    .long 1, 32, 32, 8192, 512, 768, 8388608, 3145728, 32768, 8, 50339840, 131072, 0, 0, 218105866, 0
    .long 1, 16, 16, 8192, 1536, 1792, 8388608, 3670016, 32768, 8, 18898944, 131072, 0, 0, 218106138, 0
    .long 2, 64, 72, 7168, 1536, 1536, 7340032, 0, 32768, 8, 54550528, 114688, 0, 0, 218103809, 0
    .long 2, 64, 72, 7168, 512, 512, 7340032, 0, 32768, 8, 54534144, 114688, 0, 0, 218103809, 0
    .long 5, 218107904, 0, 0, 0, 0, 0, 4, 0, 0, 0, 0, 218112000, 8, 218106881, 0
    .long 2, 64, 72, 7168, 1536, 1536, 7340032, 3145728, 32768, 8, 65560576, 114688, 0, 0, 218104193, 0
    .long 2, 64, 72, 7168, 0, 0, 7340032, 524288, 32768, 8, 56360960, 114688, 0, 0, 218103873, 0
    .long 2, 64, 72, 7168, 1280, 1280, 7340032, 1572864, 32768, 8, 60051456, 114688, 0, 0, 218104001, 0
    .long 2, 64, 72, 7168, 1536, 1536, 7340032, 524288, 32768, 8, 56385536, 114688, 0, 0, 218103873, 0
    .long 1, 16, 16, 8192, 0, 256, 8388608, 3670016, 32768, 8, 18874368, 131072, 0, 0, 218106122, 0
    .long 5, 218108176, 0, 0, 4, 0, 0, 8, 0, 0, 0, 0, 218112000, 12, 218106945, 0
    .long 2, 64, 72, 7168, 0, 0, 7340032, 3145728, 32768, 8, 65536000, 114688, 0, 0, 218104193, 0
    .long 2, 64, 72, 7168, 512, 512, 7340032, 1572864, 32768, 8, 60039168, 114688, 0, 0, 218104001, 0
    .long 2, 64, 72, 7168, 768, 768, 7340032, 2097152, 32768, 8, 61878272, 114688, 0, 0, 218104065, 0
    .long 2, 64, 72, 7168, 0, 0, 7340032, 1572864, 32768, 8, 60030976, 114688, 0, 0, 218104001, 0
    .long 2, 64, 72, 7168, 768, 768, 7340032, 1572864, 32768, 8, 60043264, 114688, 0, 0, 218104001, 0
    .long 2, 64, 72, 7168, 1536, 1536, 7340032, 1572864, 32768, 8, 60055552, 114688, 0, 0, 218104001, 0
    .long 2, 64, 72, 7168, 256, 256, 7340032, 1572864, 32768, 8, 60035072, 114688, 0, 0, 218104001, 0
    .long 2, 64, 72, 7168, 256, 256, 7340032, 2097152, 32768, 8, 61870080, 114688, 0, 0, 218104065, 0
    .long 2, 64, 72, 7168, 1280, 1280, 7340032, 2097152, 32768, 8, 61886464, 114688, 0, 0, 218104065, 0
    .long 2, 64, 72, 7168, 512, 512, 7340032, 524288, 32768, 8, 56369152, 114688, 0, 0, 218103873, 0
    .long 2, 64, 72, 7168, 1536, 1536, 7340032, 2097152, 32768, 8, 61890560, 114688, 0, 0, 218104065, 0
    .long 2, 64, 72, 7168, 1024, 1024, 7340032, 1572864, 32768, 8, 60047360, 114688, 0, 0, 218104001, 0
    .long 2, 64, 72, 7168, 256, 256, 7340032, 1048576, 32768, 8, 58200064, 114688, 0, 0, 218103937, 0
    .long 2, 64, 72, 7168, 1024, 1024, 7340032, 1048576, 32768, 8, 58212352, 114688, 0, 0, 218103937, 0
    .long 2, 64, 72, 7168, 512, 512, 7340032, 3145728, 32768, 8, 65544192, 114688, 0, 0, 218104193, 0
    .long 2, 64, 72, 7168, 1280, 1280, 7340032, 1048576, 32768, 8, 58216448, 114688, 0, 0, 218103937, 0
    .long 5, 218108176, 0, 0, 4, 0, 0, 12, 0, 0, 0, 0, 218112000, 16, 218106945, 0
    .long 2, 64, 72, 7168, 1536, 1536, 7340032, 1048576, 32768, 8, 58220544, 114688, 0, 0, 218103937, 0
    .long 2, 64, 72, 7168, 1024, 1024, 7340032, 3145728, 32768, 8, 65552384, 114688, 0, 0, 218104193, 0
    .long 2, 64, 72, 7168, 1280, 1280, 7340032, 524288, 32768, 8, 56381440, 114688, 0, 0, 218103873, 0
    .long 2, 64, 72, 7168, 768, 768, 7340032, 1048576, 32768, 8, 58208256, 114688, 0, 0, 218103937, 0
    .long 2, 64, 72, 7168, 512, 512, 7340032, 1048576, 32768, 8, 58204160, 114688, 0, 0, 218103937, 0
    .long 2, 64, 72, 7168, 256, 256, 7340032, 3145728, 32768, 8, 65540096, 114688, 0, 0, 218104193, 0
    .long 5, 218108160, 0, 0, 0, 0, 0, 12, 0, 0, 0, 0, 218112000, 16, 218106945, 0
    .long 2, 64, 72, 7168, 768, 768, 7340032, 3670016, 32768, 8, 67383296, 114688, 0, 0, 218104257, 0
    .long 2, 64, 72, 7168, 1024, 1024, 7340032, 524288, 32768, 8, 56377344, 114688, 0, 0, 218103873, 0
    .long 1, 80, 80, 2048, 512, 768, 7340032, 54525952, 114688, 14, 117448704, 32768, 218103808, 14, 218106370, 0
    .long 1, 40, 40, 2048, 0, 256, 8388608, 176160768, 131072, 16, 75497472, 32768, 218106880, 8, 218106376, 0
    .long 5, 218108160, 0, 0, 0, 0, 0, 8, 0, 0, 0, 0, 218112000, 12, 218106945, 0
    .long 1, 32, 32, 8192, 0, 256, 8388608, 3670016, 32768, 8, 52428800, 131072, 0, 0, 218106122, 0
    .long 1, 16, 16, 8192, 512, 768, 8388608, 3670016, 32768, 8, 18882560, 131072, 0, 0, 218106122, 0
    .long 1, 16, 16, 8192, 1024, 1280, 8388608, 3670016, 32768, 8, 18890752, 131072, 0, 0, 218106138, 0
    .long 1, 40, 40, 2048, 512, 768, 8388608, 182452224, 131072, 16, 77078528, 32768, 218112000, 33, 218106568, 0
    .long 1, 40, 40, 2048, 512, 768, 8388608, 176160768, 131072, 16, 75505664, 32768, 218106880, 8, 218106376, 0
    .long 2, 64, 72, 7168, 768, 768, 7340032, 3145728, 32768, 8, 65548288, 114688, 0, 0, 218104193, 0
    .long 1, 40, 40, 2048, 0, 256, 8388608, 180355072, 131072, 16, 76546048, 32768, 218112000, 25, 218106504, 0
    .long 1, 40, 40, 2048, 512, 768, 8388608, 180355072, 131072, 16, 76554240, 32768, 218112000, 25, 218106504, 0
    .long 2, 64, 72, 7168, 1280, 1280, 7340032, 2621440, 32768, 8, 63721472, 114688, 0, 0, 218104129, 0
    .long 1, 40, 40, 2048, 0, 256, 8388608, 182452224, 131072, 16, 77070336, 32768, 218112000, 33, 218106568, 0
    .long 2, 64, 72, 7168, 0, 0, 7340032, 2621440, 32768, 8, 63700992, 114688, 0, 0, 218104129, 0
    .long 1, 80, 80, 2048, 0, 256, 7340032, 54525952, 114688, 14, 117440512, 32768, 218103808, 14, 218106370, 0
    .long 2, 64, 72, 7168, 1536, 1536, 7340032, 2621440, 32768, 8, 63725568, 114688, 0, 0, 218104129, 0
    .long 2, 64, 72, 7168, 256, 256, 7340032, 2621440, 32768, 8, 63705088, 114688, 0, 0, 218104129, 0
    .long 2, 64, 72, 7168, 512, 512, 7340032, 3670016, 32768, 8, 67379200, 114688, 0, 0, 218104257, 0
    .long 2, 64, 72, 7168, 1280, 1280, 7340032, 3670016, 32768, 8, 67391488, 114688, 0, 0, 218104257, 0
    .long 1, 40, 40, 2048, 0, 256, 8388608, 178257920, 131072, 16, 76021760, 32768, 218106944, 8, 218106440, 0
    .long 1, 40, 40, 2048, 512, 768, 8388608, 178257920, 131072, 16, 76029952, 32768, 218106944, 8, 218106440, 0
    .long 2, 64, 72, 7168, 768, 768, 7340032, 2621440, 32768, 8, 63713280, 114688, 0, 0, 218104129, 0
    .long 2, 64, 72, 7168, 0, 0, 7340032, 3670016, 32768, 8, 67371008, 114688, 0, 0, 218104257, 0
    .long 2, 64, 72, 7168, 512, 512, 7340032, 2621440, 32768, 8, 63709184, 114688, 0, 0, 218104129, 0
    .long 1, 80, 80, 2048, 512, 768, 7340032, 61865984, 114688, 14, 119545856, 32768, 218104064, 14, 218106626, 0
    .long 1, 80, 80, 2048, 0, 256, 7340032, 60030976, 114688, 14, 119013376, 32768, 218104000, 14, 218106562, 0
    .long 1, 80, 80, 2048, 0, 256, 7340032, 61865984, 114688, 14, 119537664, 32768, 218104064, 14, 218106626, 0
    .long 1, 80, 80, 2048, 512, 768, 7340032, 60030976, 114688, 14, 119021568, 32768, 218104000, 14, 218106562, 0
    .long 2, 64, 72, 7168, 1024, 1024, 7340032, 3670016, 32768, 8, 67387392, 114688, 0, 0, 218104257, 0
    .long 2, 64, 72, 7168, 256, 256, 7340032, 3670016, 32768, 8, 67375104, 114688, 0, 0, 218104257, 0
    .long 1, 80, 80, 2048, 0, 256, 7340032, 58195968, 114688, 14, 118489088, 32768, 218103936, 14, 218106498, 0
    .long 1, 80, 80, 2048, 512, 768, 7340032, 58195968, 114688, 14, 118497280, 32768, 218103936, 14, 218106498, 0
    .long 2, 64, 72, 7168, 1536, 1536, 7340032, 3670016, 32768, 8, 67395584, 114688, 0, 0, 218104257, 0
    .long 1, 80, 80, 2048, 512, 768, 7340032, 56360960, 114688, 14, 117972992, 32768, 218103872, 14, 218106434, 0
    .long 1, 80, 80, 2048, 0, 256, 7340032, 56360960, 114688, 14, 117964800, 32768, 218103872, 14, 218106434, 0
    .long 1, 40, 40, 2048, 512, 768, 8388608, 184549376, 131072, 8, 77602816, 32768, 218112000, 41, 218106628, 0
    .long 1, 80, 80, 2048, 0, 256, 7340032, 65536000, 114688, 7, 120586240, 32768, 218104192, 7, 218106753, 0
    .long 1, 80, 80, 2048, 512, 768, 7340032, 65536000, 114688, 7, 120594432, 32768, 218104192, 7, 218106753, 0
    .long 1, 40, 40, 2048, 0, 256, 8388608, 184549376, 131072, 8, 77594624, 32768, 218112000, 41, 218106628, 0
    .long 1, 80, 80, 2048, 1536, 1792, 7340032, 65536000, 114688, 7, 120610816, 32768, 218104192, 7, 218106753, 0
    .long 1, 40, 40, 2048, 1024, 1280, 8388608, 184549376, 131072, 8, 77611008, 32768, 218112000, 41, 218106628, 0
    .long 1, 40, 40, 2048, 1536, 1792, 8388608, 184549376, 131072, 8, 77619200, 32768, 218112000, 41, 218106628, 0
    .long 1, 40, 40, 2048, 512, 768, 8388608, 186646528, 131072, 8, 78127104, 32768, 218112000, 49, 218106692, 0
    .long 1, 80, 80, 2048, 1024, 1280, 7340032, 65536000, 114688, 7, 120602624, 32768, 218104192, 7, 218106753, 0
    .long 1, 40, 40, 2048, 1024, 1280, 8388608, 186646528, 131072, 8, 78135296, 32768, 218112000, 49, 218106692, 0
    .long 1, 40, 40, 2048, 0, 256, 8388608, 186646528, 131072, 8, 78118912, 32768, 218112000, 49, 218106692, 0
    .long 1, 40, 40, 2048, 1536, 1792, 8388608, 186646528, 131072, 8, 78143488, 32768, 218112000, 49, 218106692, 0
    .long 1, 80, 80, 2048, 1024, 1280, 7340032, 63700992, 114688, 7, 120078336, 32768, 218104128, 7, 218106689, 0
    .long 1, 80, 80, 2048, 1536, 1792, 7340032, 63700992, 114688, 7, 120086528, 32768, 218104128, 7, 218106689, 0
    .long 1, 80, 80, 2048, 0, 256, 7340032, 63700992, 114688, 7, 120061952, 32768, 218104128, 7, 218106689, 0
    .long 1, 80, 80, 2048, 512, 768, 7340032, 63700992, 114688, 7, 120070144, 32768, 218104128, 7, 218106689, 0
    .long 1, 80, 80, 2048, 512, 768, 7340032, 67371008, 114688, 7, 121118720, 32768, 218104256, 7, 218106817, 0
    .long 1, 80, 80, 2048, 1024, 1280, 7340032, 67371008, 114688, 7, 121126912, 32768, 218104256, 7, 218106817, 0
    .long 1, 80, 80, 2048, 1536, 1792, 7340032, 67371008, 114688, 7, 121135104, 32768, 218104256, 7, 218106817, 0
    .long 1, 80, 80, 2048, 0, 256, 7340032, 67371008, 114688, 7, 121110528, 32768, 218104256, 7, 218106817, 0
    .long 6, 1, 0, 2, 0, 16, 0, 3, 0, 0, 0, 0, 0, 0, 0, 0
    .long 6, 0, 0, 0, 0, 0, 0, 51, 0, 0, 0, 0, 0, 0, 0, 0
    .long 6, 1, 0, 2, 0, 16, 0, 1, 0, 0, 0, 0, 0, 0, 0, 0
    .long 6, 1, 0, 2, 0, 16, 0, 0, 0, 0, 0, 0, 0, 0, 0, 0
    .long 6, 1, 0, 2, 0, 16, 0, 5, 0, 0, 0, 0, 0, 0, 0, 0
    .long 6, 1, 0, 2, 0, 16, 0, 4, 0, 0, 0, 0, 0, 0, 0, 0
    .long 6, 1, 0, 2, 0, 16, 0, 22, 0, 0, 0, 0, 0, 0, 0, 0
    .long 6, 1, 0, 2, 0, 16, 0, 6, 0, 0, 0, 0, 0, 0, 0, 0
    .long 6, 1, 0, 2, 0, 16, 0, 18, 0, 0, 0, 0, 0, 0, 0, 0
    .long 6, 1, 0, 2, 0, 16, 0, 19, 0, 0, 0, 0, 0, 0, 0, 0
    .long 6, 1, 0, 2, 0, 16, 0, 20, 0, 0, 0, 0, 0, 0, 0, 0
    .long 6, 1, 0, 2, 0, 16, 0, 7, 0, 0, 0, 0, 0, 0, 0, 0
    .long 6, 1, 0, 2, 0, 16, 0, 2, 0, 0, 0, 0, 0, 0, 0, 0
    .long 6, 1, 0, 2, 0, 16, 0, 17, 0, 0, 0, 0, 0, 0, 0, 0
    .long 6, 1, 0, 2, 0, 16, 0, 21, 0, 0, 0, 0, 0, 0, 0, 0
    .long 6, 1, 0, 2, 0, 16, 0, 16, 0, 0, 0, 0, 0, 0, 0, 0
    .long 6, 0, 0, 0, 0, 0, 0, 50, 0, 0, 0, 0, 0, 0, 0, 0
    .long 6, 0, 0, 0, 0, 0, 0, 52, 0, 0, 0, 0, 0, 0, 0, 0
    .long 6, 0, 0, 0, 0, 0, 0, 54, 0, 0, 0, 0, 0, 0, 0, 0
    .long 6, 0, 0, 0, 0, 0, 0, 49, 0, 0, 0, 0, 0, 0, 0, 0
    .long 6, 0, 0, 0, 0, 0, 0, 48, 0, 0, 0, 0, 0, 0, 0, 0
    .long 6, 0, 0, 0, 0, 0, 0, 53, 0, 0, 0, 0, 0, 0, 0, 0
    .long 6, 0, 0, 0, 0, 0, 0, 55, 0, 0, 0, 0, 0, 0, 0, 0
    .long 6, 0, 0, 0, 0, 0, 0, 56, 0, 0, 0, 0, 0, 0, 0, 0
    .long 6, 1, 0, 2, 0, 16, 0, 23, 0, 0, 0, 0, 0, 0, 0, 0
    .long 6, 1, 0, 2, 0, 16, 0, 24, 0, 0, 0, 0, 0, 0, 0, 0
    .long 6, 1, 0, 2, 0, 16, 0, 25, 0, 0, 0, 0, 0, 0, 0, 0
    .long 6, 1, 0, 2, 0, 16, 0, 26, 0, 0, 0, 0, 0, 0, 0, 0
    .long 6, 1, 0, 2, 0, 16, 0, 27, 0, 0, 0, 0, 0, 0, 0, 0
    .long 6, 1, 0, 2, 0, 16, 0, 28, 0, 0, 0, 0, 0, 0, 0, 0
    .long 6, 1, 0, 2, 0, 16, 0, 29, 0, 0, 0, 0, 0, 0, 0, 0
    .long 6, 1, 0, 2, 0, 16, 0, 30, 0, 0, 0, 0, 0, 0, 0, 0
    .long 6, 1, 0, 2, 0, 16, 0, 31, 0, 0, 0, 0, 0, 0, 0, 0
    .long 6, 0, 0, 1, 0, 16, 0, 40, 0, 0, 0, 0, 0, 0, 0, 0
    .long 6, 0, 0, 1, 0, 16, 0, 41, 0, 0, 0, 0, 0, 0, 0, 0
    .long 6, 0, 0, 1, 0, 16, 0, 43, 0, 0, 0, 0, 0, 0, 0, 0
    .long 6, 0, 0, 1, 0, 16, 0, 45, 0, 0, 0, 0, 0, 0, 0, 0
    .long 6, 0, 0, 1, 0, 16, 0, 46, 0, 0, 0, 0, 0, 0, 0, 0
    .long 6, 0, 0, 1, 0, 16, 0, 47, 0, 0, 0, 0, 0, 0, 0, 0
    .long 6, 1, 0, 1, 0, 16, 0, 32, 0, 0, 0, 0, 0, 0, 0, 0
    .long 6, 1, 0, 1, 0, 16, 0, 33, 0, 0, 0, 0, 0, 0, 0, 0
    .long 6, 1, 0, 1, 0, 16, 0, 35, 0, 0, 0, 0, 0, 0, 0, 0
    .long 6, 1, 0, 1, 0, 16, 0, 36, 0, 0, 0, 0, 0, 0, 0, 0
    .long 6, 1, 0, 1, 0, 16, 0, 38, 0, 0, 0, 0, 0, 0, 0, 0
    .long 6, 1, 0, 1, 0, 16, 0, 39, 0, 0, 0, 0, 0, 0, 0, 0
    .long 6, 0, 0, 0, 0, 0, 0, 57, 0, 0, 0, 0, 0, 0, 0, 0
    .long 6, 0, 0, 1, 0, 16, 0, 44, 0, 0, 0, 0, 0, 0, 0, 0
    .long 6, 1, 0, 1, 0, 16, 0, 34, 0, 0, 0, 0, 0, 0, 0, 0
    .long 6, 0, 0, 0, 0, 0, 0, 58, 0, 0, 0, 0, 0, 0, 0, 0
    .long 6, 1, 0, 1, 0, 16, 0, 37, 0, 0, 0, 0, 0, 0, 0, 0
    .long 6, 0, 0, 1, 0, 16, 0, 42, 0, 0, 0, 0, 0, 0, 0, 0
    .long 6, 0, 0, 0, 0, 0, 0, 59, 0, 0, 0, 0, 0, 0, 0, 0
    .long 6, 1, 0, 2, 0, 16, 0, 8, 0, 0, 0, 0, 0, 0, 0, 0
    .long 6, 1, 0, 2, 0, 16, 0, 9, 0, 0, 0, 0, 0, 0, 0, 0
    .long 6, 1, 0, 2, 0, 16, 0, 10, 0, 0, 0, 0, 0, 0, 0, 0
    .long 6, 1, 0, 2, 0, 16, 0, 11, 0, 0, 0, 0, 0, 0, 0, 0
    .long 6, 1, 0, 2, 0, 16, 0, 12, 0, 0, 0, 0, 0, 0, 0, 0
    .long 6, 1, 0, 2, 0, 16, 0, 13, 0, 0, 0, 0, 0, 0, 0, 0
    .long 6, 1, 0, 2, 0, 16, 0, 14, 0, 0, 0, 0, 0, 0, 0, 0
    .long 6, 1, 0, 2, 0, 16, 0, 15, 0, 0, 0, 0, 0, 0, 0, 0
    .long 7, 0, 0, 0, 0, 0, 0, 60, 0, 0, 0, 0, 0, 0, 0, 0
    .long 7, 0, 0, 0, 1, 0, 0, 60, 0, 0, 0, 0, 0, 0, 0, 0
    .long 7, 0, 0, 0, 2, 0, 0, 60, 0, 0, 0, 0, 0, 0, 0, 0
    .long 7, 0, 0, 0, 3, 0, 0, 60, 0, 0, 0, 0, 0, 0, 0, 0
    .long 7, 0, 0, 0, 0, 0, 0, 61, 0, 0, 0, 0, 0, 0, 0, 0
    .long 7, 0, 0, 0, 1, 0, 0, 61, 0, 0, 0, 0, 0, 0, 0, 0
    .long 7, 0, 0, 0, 2, 0, 0, 61, 0, 0, 0, 0, 0, 0, 0, 0
    .long 7, 0, 0, 0, 3, 0, 0, 61, 0, 0, 0, 0, 0, 0, 0, 0
    .long 7, 0, 0, 0, 0, 0, 0, 62, 0, 0, 0, 0, 0, 0, 0, 0
    .long 7, 0, 0, 0, 1, 0, 0, 62, 0, 0, 0, 0, 0, 0, 0, 0
    .long 7, 0, 0, 0, 2, 0, 0, 62, 0, 0, 0, 0, 0, 0, 0, 0
    .long 7, 0, 0, 0, 3, 0, 0, 62, 0, 0, 0, 0, 0, 0, 0, 0
    .long 7, 0, 0, 0, 0, 0, 0, 63, 0, 0, 0, 0, 0, 0, 0, 0
    .long 7, 0, 0, 0, 1, 0, 0, 63, 0, 0, 0, 0, 0, 0, 0, 0
    .long 7, 0, 0, 0, 2, 0, 0, 63, 0, 0, 0, 0, 0, 0, 0, 0
    .long 7, 0, 0, 0, 3, 0, 0, 63, 0, 0, 0, 0, 0, 0, 0, 0
    .long 0, 0, 0, 0, 0, 0, 0, 0, 0, 0, 0, 0, 0, 0, 0, 0
    .long 4, 24, 24, 8192, 2048, 264192, 8388608, 0, 32768, 4, 21004288, 131072, 0, 0, 218104353, 0
    .long 4, 24, 24, 8192, 2304, 264448, 8388608, 0, 32768, 4, 21008384, 131072, 0, 0, 218104353, 0
    .long 4, 24, 24, 8192, 2560, 264704, 8388608, 0, 32768, 4, 21012480, 131072, 0, 0, 218104353, 0
    .long 4, 24, 24, 8192, 2816, 264960, 8388608, 0, 32768, 4, 21016576, 131072, 0, 0, 218104353, 0
    .long 4, 24, 24, 8192, 3072, 265216, 8388608, 0, 32768, 4, 21020672, 131072, 0, 0, 218104369, 0
    .long 4, 24, 24, 8192, 3328, 265472, 8388608, 0, 32768, 4, 21024768, 131072, 0, 0, 218104369, 0
    .long 4, 24, 24, 8192, 3584, 265728, 8388608, 0, 32768, 4, 21028864, 131072, 0, 0, 218104369, 0
    .long 4, 24, 24, 8192, 3840, 265984, 8388608, 0, 32768, 4, 21032960, 131072, 0, 0, 218104369, 0
    .long 4, 32, 32, 8192, 2048, 264192, 8388608, 0, 32768, 4, 37781504, 131072, 0, 0, 218104353, 0
    .long 4, 32, 32, 8192, 2304, 264448, 8388608, 0, 32768, 4, 37785600, 131072, 0, 0, 218104353, 0
    .long 4, 32, 32, 8192, 2560, 264704, 8388608, 0, 32768, 4, 37789696, 131072, 0, 0, 218104353, 0
    .long 4, 32, 32, 8192, 2816, 264960, 8388608, 0, 32768, 4, 37793792, 131072, 0, 0, 218104353, 0
    .long 4, 32, 32, 8192, 3072, 265216, 8388608, 0, 32768, 4, 37797888, 131072, 0, 0, 218104369, 0
    .long 4, 32, 32, 8192, 3328, 265472, 8388608, 0, 32768, 4, 37801984, 131072, 0, 0, 218104369, 0
    .long 4, 32, 32, 8192, 3584, 265728, 8388608, 0, 32768, 4, 37806080, 131072, 0, 0, 218104369, 0
    .long 4, 32, 32, 8192, 3840, 265984, 8388608, 0, 32768, 4, 37810176, 131072, 0, 0, 218104369, 0
    .long 4, 24, 24, 8192, 2048, 264192, 8388608, 262144, 32768, 4, 22052864, 131072, 0, 0, 218104356, 0
    .long 4, 24, 24, 8192, 2304, 264448, 8388608, 262144, 32768, 4, 22056960, 131072, 0, 0, 218104356, 0
    .long 4, 24, 24, 8192, 2560, 264704, 8388608, 262144, 32768, 4, 22061056, 131072, 0, 0, 218104356, 0
    .long 4, 24, 24, 8192, 2816, 264960, 8388608, 262144, 32768, 4, 22065152, 131072, 0, 0, 218104356, 0
    .long 4, 24, 24, 8192, 3072, 265216, 8388608, 262144, 32768, 4, 22069248, 131072, 0, 0, 218104372, 0
    .long 4, 24, 24, 8192, 3328, 265472, 8388608, 262144, 32768, 4, 22073344, 131072, 0, 0, 218104372, 0
    .long 4, 24, 24, 8192, 3584, 265728, 8388608, 262144, 32768, 4, 22077440, 131072, 0, 0, 218104372, 0
    .long 4, 24, 24, 8192, 3840, 265984, 8388608, 262144, 32768, 4, 22081536, 131072, 0, 0, 218104372, 0
    .long 4, 32, 32, 8192, 2048, 264192, 8388608, 262144, 32768, 4, 38830080, 131072, 0, 0, 218104356, 0
    .long 4, 32, 32, 8192, 2304, 264448, 8388608, 262144, 32768, 4, 38834176, 131072, 0, 0, 218104356, 0
    .long 4, 32, 32, 8192, 2560, 264704, 8388608, 262144, 32768, 4, 38838272, 131072, 0, 0, 218104356, 0
    .long 4, 32, 32, 8192, 2816, 264960, 8388608, 262144, 32768, 4, 38842368, 131072, 0, 0, 218104356, 0
    .long 4, 32, 32, 8192, 3072, 265216, 8388608, 262144, 32768, 4, 38846464, 131072, 0, 0, 218104372, 0
    .long 4, 32, 32, 8192, 3328, 265472, 8388608, 262144, 32768, 4, 38850560, 131072, 0, 0, 218104372, 0
    .long 4, 32, 32, 8192, 3584, 265728, 8388608, 262144, 32768, 4, 38854656, 131072, 0, 0, 218104372, 0
    .long 4, 32, 32, 8192, 3840, 265984, 8388608, 262144, 32768, 4, 38858752, 131072, 0, 0, 218104372, 0
    .long 4, 32, 32, 8192, 2304, 264448, 8388608, 786432, 32768, 4, 40931328, 131072, 0, 0, 218104612, 0
    .long 4, 24, 24, 8192, 2560, 264704, 8388608, 786432, 32768, 4, 24158208, 131072, 0, 0, 218104612, 0
    .long 4, 24, 24, 8192, 3584, 265728, 8388608, 786432, 32768, 4, 24174592, 131072, 0, 0, 218104628, 0
    .long 4, 32, 32, 8192, 2816, 264960, 8388608, 524288, 32768, 4, 39890944, 131072, 0, 0, 218104609, 0
    .long 4, 32, 32, 8192, 3584, 265728, 8388608, 786432, 32768, 4, 40951808, 131072, 0, 0, 218104628, 0
    .long 4, 32, 32, 8192, 3328, 265472, 8388608, 524288, 32768, 4, 39899136, 131072, 0, 0, 218104625, 0
    .long 4, 24, 24, 8192, 3072, 265216, 8388608, 786432, 32768, 4, 24166400, 131072, 0, 0, 218104628, 0
    .long 4, 32, 32, 8192, 3840, 265984, 8388608, 524288, 32768, 4, 39907328, 131072, 0, 0, 218104625, 0
    .long 4, 32, 32, 8192, 2560, 264704, 8388608, 786432, 32768, 4, 40935424, 131072, 0, 0, 218104612, 0
    .long 4, 32, 32, 8192, 2560, 264704, 8388608, 524288, 32768, 4, 39886848, 131072, 0, 0, 218104609, 0
    .long 4, 32, 32, 8192, 3072, 265216, 8388608, 786432, 32768, 4, 40943616, 131072, 0, 0, 218104628, 0
    .long 4, 24, 24, 8192, 2816, 264960, 8388608, 524288, 32768, 4, 23113728, 131072, 0, 0, 218104609, 0
    .long 2, 64, 72, 7168, 1792, 1792, 7340032, 1048576, 32768, 8, 58224640, 114688, 0, 0, 218103937, 0
    .long 4, 24, 24, 8192, 2304, 264448, 8388608, 786432, 32768, 4, 24154112, 131072, 0, 0, 218104612, 0
    .long 4, 24, 24, 8192, 3328, 265472, 8388608, 524288, 32768, 4, 23121920, 131072, 0, 0, 218104625, 0
    .long 4, 32, 32, 8192, 2304, 264448, 8388608, 524288, 32768, 4, 39882752, 131072, 0, 0, 218104609, 0
    .long 4, 32, 32, 8192, 3840, 265984, 8388608, 786432, 32768, 4, 40955904, 131072, 0, 0, 218104628, 0
    .long 4, 24, 24, 8192, 2048, 264192, 8388608, 524288, 32768, 4, 23101440, 131072, 0, 0, 218104609, 0
    .long 4, 24, 24, 8192, 3584, 265728, 8388608, 524288, 32768, 4, 23126016, 131072, 0, 0, 218104625, 0
    .long 4, 32, 32, 8192, 2048, 264192, 8388608, 524288, 32768, 4, 39878656, 131072, 0, 0, 218104609, 0
    .long 4, 24, 24, 8192, 3840, 265984, 8388608, 524288, 32768, 4, 23130112, 131072, 0, 0, 218104625, 0
    .long 4, 32, 32, 8192, 2048, 264192, 8388608, 786432, 32768, 4, 40927232, 131072, 0, 0, 218104612, 0
    .long 4, 24, 24, 8192, 2816, 264960, 8388608, 786432, 32768, 4, 24162304, 131072, 0, 0, 218104612, 0
    .long 4, 32, 32, 8192, 2816, 264960, 8388608, 786432, 32768, 4, 40939520, 131072, 0, 0, 218104612, 0
    .long 4, 32, 32, 8192, 3584, 265728, 8388608, 524288, 32768, 4, 39903232, 131072, 0, 0, 218104625, 0
    .long 4, 24, 24, 8192, 3072, 265216, 8388608, 524288, 32768, 4, 23117824, 131072, 0, 0, 218104625, 0
    .long 4, 32, 32, 8192, 3328, 265472, 8388608, 786432, 32768, 4, 40947712, 131072, 0, 0, 218104628, 0
    .long 4, 24, 24, 8192, 2304, 264448, 8388608, 524288, 32768, 4, 23105536, 131072, 0, 0, 218104609, 0
    .long 4, 32, 32, 8192, 3072, 265216, 8388608, 524288, 32768, 4, 39895040, 131072, 0, 0, 218104625, 0
    .long 4, 24, 24, 8192, 2560, 264704, 8388608, 524288, 32768, 4, 23109632, 131072, 0, 0, 218104609, 0
    .long 4, 24, 24, 8192, 3328, 265472, 8388608, 786432, 32768, 4, 24170496, 131072, 0, 0, 218104628, 0
    .long 4, 24, 24, 8192, 2048, 264192, 8388608, 786432, 32768, 4, 24150016, 131072, 0, 0, 218104612, 0
    .long 1, 32, 32, 8192, 3072, 3328, 8388608, 1048576, 32768, 8, 41992192, 131072, 0, 0, 218104890, 0
    .long 1, 24, 24, 8192, 2560, 2816, 8388608, 1048576, 32768, 8, 25206784, 131072, 0, 0, 218104874, 0
    .long 1, 16, 16, 8192, 2560, 2816, 8388608, 1048576, 32768, 8, 8429568, 131072, 0, 0, 218104874, 0
    .long 1, 24, 24, 8192, 3072, 3328, 8388608, 1048576, 32768, 8, 25214976, 131072, 0, 0, 218104890, 0
    .long 4, 24, 24, 8192, 3840, 265984, 8388608, 786432, 32768, 4, 24178688, 131072, 0, 0, 218104628, 0
    .long 1, 16, 16, 8192, 2048, 2304, 8388608, 1048576, 32768, 8, 8421376, 131072, 0, 0, 218104874, 0
    .long 1, 24, 24, 8192, 2560, 2816, 8388608, 1572864, 32768, 8, 27303936, 131072, 0, 0, 218105130, 0
    .long 1, 32, 32, 8192, 3072, 3328, 8388608, 1572864, 32768, 8, 44089344, 131072, 0, 0, 218105146, 0
    .long 1, 24, 24, 8192, 2048, 2304, 8388608, 1048576, 32768, 8, 25198592, 131072, 0, 0, 218104874, 0
    .long 1, 32, 32, 8192, 2560, 2816, 8388608, 1048576, 32768, 8, 41984000, 131072, 0, 0, 218104874, 0
    .long 1, 16, 16, 8192, 3584, 3840, 8388608, 1572864, 32768, 8, 10543104, 131072, 0, 0, 218105146, 0
    .long 1, 16, 16, 8192, 2048, 2304, 8388608, 0, 32768, 8, 4227072, 131072, 0, 0, 218107946, 0
    .long 1, 24, 24, 8192, 3072, 3328, 8388608, 1572864, 32768, 8, 27312128, 131072, 0, 0, 218105146, 0
    .long 1, 32, 32, 8192, 3584, 3840, 8388608, 1572864, 32768, 8, 44097536, 131072, 0, 0, 218105146, 0
    .long 1, 32, 32, 8192, 2048, 2304, 8388608, 1048576, 32768, 8, 41975808, 131072, 0, 0, 218104874, 0
    .long 1, 16, 16, 8192, 3072, 3328, 8388608, 1572864, 32768, 8, 10534912, 131072, 0, 0, 218105146, 0
    .long 1, 32, 32, 8192, 3584, 3840, 8388608, 1048576, 32768, 8, 42000384, 131072, 0, 0, 218104890, 0
    .long 1, 24, 24, 8192, 3584, 3840, 8388608, 1572864, 32768, 8, 27320320, 131072, 0, 0, 218105146, 0
    .long 1, 16, 16, 8192, 3584, 3840, 8388608, 1048576, 32768, 8, 8445952, 131072, 0, 0, 218104890, 0
    .long 1, 32, 32, 8192, 2048, 2304, 8388608, 1572864, 32768, 8, 44072960, 131072, 0, 0, 218105130, 0
    .long 1, 16, 16, 8192, 3584, 3840, 8388608, 0, 32768, 8, 4251648, 131072, 0, 0, 218107962, 0
    .long 1, 16, 16, 8192, 2560, 2816, 8388608, 2097152, 32768, 8, 12623872, 131072, 0, 0, 218105386, 0
    .long 1, 16, 16, 8192, 3072, 3328, 8388608, 1048576, 32768, 8, 8437760, 131072, 0, 0, 218104890, 0
    .long 1, 16, 16, 8192, 2048, 2304, 8388608, 1572864, 32768, 8, 10518528, 131072, 0, 0, 218105130, 0
    .long 1, 32, 32, 8192, 2048, 2304, 8388608, 2097152, 32768, 8, 46170112, 131072, 0, 0, 218105386, 0
    .long 1, 16, 16, 8192, 2560, 2816, 8388608, 0, 32768, 8, 4235264, 131072, 0, 0, 218107946, 0
    .long 1, 24, 24, 8192, 3584, 3840, 8388608, 1048576, 32768, 8, 25223168, 131072, 0, 0, 218104890, 0
    .long 1, 16, 16, 8192, 2560, 2816, 8388608, 1572864, 32768, 8, 10526720, 131072, 0, 0, 218105130, 0
    .long 1, 16, 16, 8192, 3072, 3328, 8388608, 0, 32768, 8, 4243456, 131072, 0, 0, 218107962, 0
    .long 1, 32, 32, 8192, 2560, 2816, 8388608, 2097152, 32768, 8, 46178304, 131072, 0, 0, 218105386, 0
    .long 1, 32, 32, 8192, 2560, 2816, 8388608, 1572864, 32768, 8, 44081152, 131072, 0, 0, 218105130, 0
    .long 1, 24, 24, 8192, 2048, 2304, 8388608, 1572864, 32768, 8, 27295744, 131072, 0, 0, 218105130, 0
    .long 1, 16, 16, 8192, 2048, 2304, 8388608, 524288, 32768, 8, 6324224, 131072, 0, 0, 218108202, 0
    .long 1, 32, 32, 8192, 3072, 3328, 8388608, 3670016, 32768, 8, 52477952, 131072, 0, 0, 218106170, 0
    .long 1, 16, 16, 8192, 3072, 3328, 8388608, 2621440, 32768, 8, 14729216, 131072, 0, 0, 218105658, 0
    .long 1, 24, 24, 8192, 2560, 2816, 8388608, 3145728, 32768, 8, 33595392, 131072, 0, 0, 218105898, 0
    .long 1, 16, 16, 8192, 2048, 2304, 8388608, 2621440, 32768, 8, 14712832, 131072, 0, 0, 218105642, 0
    .long 1, 32, 32, 8192, 3584, 3840, 8388608, 3670016, 32768, 8, 52486144, 131072, 0, 0, 218106170, 0
    .long 1, 16, 16, 8192, 2048, 2304, 8388608, 3145728, 32768, 8, 16809984, 131072, 0, 0, 218105898, 0
    .long 1, 24, 24, 8192, 3072, 3328, 8388608, 2097152, 32768, 8, 29409280, 131072, 0, 0, 218105402, 0
    .long 1, 16, 16, 8192, 3584, 3840, 8388608, 2097152, 32768, 8, 12640256, 131072, 0, 0, 218105402, 0
    .long 1, 24, 24, 8192, 2560, 2816, 8388608, 3670016, 32768, 8, 35692544, 131072, 0, 0, 218106154, 0
    .long 1, 24, 24, 8192, 3584, 3840, 8388608, 3145728, 32768, 8, 33611776, 131072, 0, 0, 218105914, 0
    .long 1, 32, 32, 8192, 3584, 3840, 8388608, 2621440, 32768, 8, 48291840, 131072, 0, 0, 218105658, 0
    .long 1, 32, 32, 8192, 3584, 3840, 8388608, 2097152, 32768, 8, 46194688, 131072, 0, 0, 218105402, 0
    .long 1, 24, 24, 8192, 3584, 3840, 8388608, 2097152, 32768, 8, 29417472, 131072, 0, 0, 218105402, 0
    .long 1, 24, 24, 8192, 2048, 2304, 8388608, 2097152, 32768, 8, 29392896, 131072, 0, 0, 218105386, 0
    .long 1, 32, 32, 8192, 3584, 3840, 8388608, 3145728, 32768, 8, 50388992, 131072, 0, 0, 218105914, 0
    .long 1, 32, 32, 8192, 2048, 2304, 8388608, 3145728, 32768, 8, 50364416, 131072, 0, 0, 218105898, 0
    .long 1, 16, 16, 8192, 3072, 3328, 8388608, 3145728, 32768, 8, 16826368, 131072, 0, 0, 218105914, 0
    .long 1, 16, 16, 8192, 3072, 3328, 8388608, 2097152, 32768, 8, 12632064, 131072, 0, 0, 218105402, 0
    .long 5, 218107952, 0, 0, 12, 0, 0, 0, 0, 0, 0, 0, 218112128, 4, 218106881, 0
    .long 1, 32, 32, 8192, 3072, 3328, 8388608, 3145728, 32768, 8, 50380800, 131072, 0, 0, 218105914, 0
    .long 1, 24, 24, 8192, 3584, 3840, 8388608, 3670016, 32768, 8, 35708928, 131072, 0, 0, 218106170, 0
    .long 1, 32, 32, 8192, 2048, 2304, 8388608, 2621440, 32768, 8, 48267264, 131072, 0, 0, 218105642, 0
    .long 1, 32, 32, 8192, 3072, 3328, 8388608, 2097152, 32768, 8, 46186496, 131072, 0, 0, 218105402, 0
    .long 1, 24, 24, 8192, 2560, 2816, 8388608, 2621440, 32768, 8, 31498240, 131072, 0, 0, 218105642, 0
    .long 1, 24, 24, 8192, 2560, 2816, 8388608, 2097152, 32768, 8, 29401088, 131072, 0, 0, 218105386, 0
    .long 1, 16, 16, 8192, 3584, 3840, 8388608, 524288, 32768, 8, 6348800, 131072, 0, 0, 218108218, 0
    .long 1, 32, 32, 8192, 3072, 3328, 8388608, 2621440, 32768, 8, 48283648, 131072, 0, 0, 218105658, 0
    .long 1, 16, 16, 8192, 3072, 3328, 8388608, 524288, 32768, 8, 6340608, 131072, 0, 0, 218108218, 0
    .long 1, 24, 24, 8192, 2048, 2304, 8388608, 2621440, 32768, 8, 31490048, 131072, 0, 0, 218105642, 0
    .long 1, 16, 16, 8192, 2048, 2304, 8388608, 2097152, 32768, 8, 12615680, 131072, 0, 0, 218105386, 0
    .long 5, 218107952, 0, 0, 12, 0, 0, 4, 0, 0, 0, 0, 218112128, 8, 218106881, 0
    .long 5, 218107936, 0, 0, 8, 0, 0, 0, 0, 0, 0, 0, 218112128, 4, 218106881, 0
    .long 1, 24, 24, 8192, 3072, 3328, 8388608, 3670016, 32768, 8, 35700736, 131072, 0, 0, 218106170, 0
    .long 2, 64, 72, 7168, 1792, 1792, 7340032, 2097152, 32768, 8, 61894656, 114688, 0, 0, 218104065, 0
    .long 1, 24, 24, 8192, 3584, 3840, 8388608, 2621440, 32768, 8, 31514624, 131072, 0, 0, 218105658, 0
    .long 2, 64, 72, 7168, 2048, 2048, 7340032, 0, 32768, 8, 54558720, 114688, 0, 0, 218103809, 0
    .long 1, 24, 24, 8192, 2048, 2304, 8388608, 3670016, 32768, 8, 35684352, 131072, 0, 0, 218106154, 0
    .long 1, 32, 32, 8192, 2560, 2816, 8388608, 3670016, 32768, 8, 52469760, 131072, 0, 0, 218106154, 0
    .long 2, 64, 72, 7168, 2816, 2816, 7340032, 2621440, 32768, 8, 63746048, 114688, 0, 0, 218104132, 0
    .long 1, 32, 32, 8192, 2560, 2816, 8388608, 2621440, 32768, 8, 48275456, 131072, 0, 0, 218105642, 0
    .long 1, 16, 16, 8192, 2560, 2816, 8388608, 2621440, 32768, 8, 14721024, 131072, 0, 0, 218105642, 0
    .long 2, 64, 72, 7168, 1792, 1792, 7340032, 0, 32768, 8, 54554624, 114688, 0, 0, 218103809, 0
    .long 1, 16, 16, 8192, 3584, 3840, 8388608, 3145728, 32768, 8, 16834560, 131072, 0, 0, 218105914, 0
    .long 1, 24, 24, 8192, 3072, 3328, 8388608, 2621440, 32768, 8, 31506432, 131072, 0, 0, 218105658, 0
    .long 2, 64, 72, 7168, 2048, 2048, 7340032, 524288, 32768, 8, 56393728, 114688, 0, 0, 218103873, 0
    .long 1, 24, 24, 8192, 2048, 2304, 8388608, 3145728, 32768, 8, 33587200, 131072, 0, 0, 218105898, 0
    .long 2, 64, 72, 7168, 2560, 2560, 7340032, 0, 32768, 8, 54566912, 114688, 0, 0, 218103809, 0
    .long 2, 64, 72, 7168, 2560, 2560, 7340032, 524288, 32768, 8, 56401920, 114688, 0, 0, 218103873, 0
    .long 2, 64, 72, 7168, 2304, 2304, 7340032, 2097152, 32768, 8, 61902848, 114688, 0, 0, 218104065, 0
    .long 2, 64, 72, 7168, 2816, 2816, 7340032, 2097152, 32768, 8, 61911040, 114688, 0, 0, 218104065, 0
    .long 1, 16, 16, 8192, 2560, 2816, 8388608, 524288, 32768, 8, 6332416, 131072, 0, 0, 218108202, 0
    .long 1, 16, 16, 8192, 2560, 2816, 8388608, 3145728, 32768, 8, 16818176, 131072, 0, 0, 218105898, 0
    .long 2, 64, 72, 7168, 2816, 2816, 7340032, 0, 32768, 8, 54571008, 114688, 0, 0, 218103809, 0
    .long 2, 64, 72, 7168, 3072, 3072, 7340032, 0, 32768, 8, 54575104, 114688, 0, 0, 218103809, 0
    .long 1, 16, 16, 8192, 3584, 3840, 8388608, 2621440, 32768, 8, 14737408, 131072, 0, 0, 218105658, 0
    .long 1, 24, 24, 8192, 3072, 3328, 8388608, 3145728, 32768, 8, 33603584, 131072, 0, 0, 218105914, 0
    .long 2, 64, 72, 7168, 3072, 3072, 7340032, 3145728, 32768, 8, 65585152, 114688, 0, 0, 218104196, 0
    .long 1, 32, 32, 8192, 2560, 2816, 8388608, 3145728, 32768, 8, 50372608, 131072, 0, 0, 218105898, 0
    .long 1, 16, 16, 8192, 3584, 3840, 8388608, 3670016, 32768, 8, 18931712, 131072, 0, 0, 218106170, 0
    .long 2, 64, 72, 7168, 3328, 3328, 7340032, 0, 32768, 8, 54579200, 114688, 0, 0, 218103809, 0
    .long 2, 64, 72, 7168, 2304, 2304, 7340032, 0, 32768, 8, 54562816, 114688, 0, 0, 218103809, 0
    .long 5, 218107936, 0, 0, 8, 0, 0, 4, 0, 0, 0, 0, 218112128, 8, 218106881, 0
    .long 2, 64, 72, 7168, 3328, 3328, 7340032, 3145728, 32768, 8, 65589248, 114688, 0, 0, 218104196, 0
    .long 2, 64, 72, 7168, 1792, 1792, 7340032, 524288, 32768, 8, 56389632, 114688, 0, 0, 218103873, 0
    .long 2, 64, 72, 7168, 3072, 3072, 7340032, 1572864, 32768, 8, 60080128, 114688, 0, 0, 218104001, 0
    .long 2, 64, 72, 7168, 3328, 3328, 7340032, 524288, 32768, 8, 56414208, 114688, 0, 0, 218103873, 0
    .long 1, 16, 16, 8192, 2048, 2304, 8388608, 3670016, 32768, 8, 18907136, 131072, 0, 0, 218106154, 0
    .long 5, 218108208, 0, 0, 12, 0, 0, 8, 0, 0, 0, 0, 218112128, 12, 218106945, 0
    .long 2, 64, 72, 7168, 1792, 1792, 7340032, 3145728, 32768, 8, 65564672, 114688, 0, 0, 218104196, 0
    .long 2, 64, 72, 7168, 2304, 2304, 7340032, 1572864, 32768, 8, 60067840, 114688, 0, 0, 218104001, 0
    .long 2, 64, 72, 7168, 2560, 2560, 7340032, 2097152, 32768, 8, 61906944, 114688, 0, 0, 218104065, 0
    .long 2, 64, 72, 7168, 1792, 1792, 7340032, 1572864, 32768, 8, 60059648, 114688, 0, 0, 218104001, 0
    .long 2, 64, 72, 7168, 2560, 2560, 7340032, 1572864, 32768, 8, 60071936, 114688, 0, 0, 218104001, 0
    .long 2, 64, 72, 7168, 3328, 3328, 7340032, 1572864, 32768, 8, 60084224, 114688, 0, 0, 218104001, 0
    .long 2, 64, 72, 7168, 2048, 2048, 7340032, 1572864, 32768, 8, 60063744, 114688, 0, 0, 218104001, 0
    .long 2, 64, 72, 7168, 2048, 2048, 7340032, 2097152, 32768, 8, 61898752, 114688, 0, 0, 218104065, 0
    .long 2, 64, 72, 7168, 3072, 3072, 7340032, 2097152, 32768, 8, 61915136, 114688, 0, 0, 218104065, 0
    .long 2, 64, 72, 7168, 2304, 2304, 7340032, 524288, 32768, 8, 56397824, 114688, 0, 0, 218103873, 0
    .long 2, 64, 72, 7168, 3328, 3328, 7340032, 2097152, 32768, 8, 61919232, 114688, 0, 0, 218104065, 0
    .long 2, 64, 72, 7168, 2816, 2816, 7340032, 1572864, 32768, 8, 60076032, 114688, 0, 0, 218104001, 0
    .long 2, 64, 72, 7168, 2048, 2048, 7340032, 1048576, 32768, 8, 58228736, 114688, 0, 0, 218103937, 0
    .long 2, 64, 72, 7168, 2816, 2816, 7340032, 1048576, 32768, 8, 58241024, 114688, 0, 0, 218103937, 0
    .long 2, 64, 72, 7168, 2304, 2304, 7340032, 3145728, 32768, 8, 65572864, 114688, 0, 0, 218104196, 0
    .long 2, 64, 72, 7168, 3072, 3072, 7340032, 1048576, 32768, 8, 58245120, 114688, 0, 0, 218103937, 0
    .long 5, 218108208, 0, 0, 12, 0, 0, 12, 0, 0, 0, 0, 218112128, 16, 218106945, 0
    .long 2, 64, 72, 7168, 3328, 3328, 7340032, 1048576, 32768, 8, 58249216, 114688, 0, 0, 218103937, 0
    .long 2, 64, 72, 7168, 2816, 2816, 7340032, 3145728, 32768, 8, 65581056, 114688, 0, 0, 218104196, 0
    .long 2, 64, 72, 7168, 3072, 3072, 7340032, 524288, 32768, 8, 56410112, 114688, 0, 0, 218103873, 0
    .long 2, 64, 72, 7168, 2560, 2560, 7340032, 1048576, 32768, 8, 58236928, 114688, 0, 0, 218103937, 0
    .long 2, 64, 72, 7168, 2304, 2304, 7340032, 1048576, 32768, 8, 58232832, 114688, 0, 0, 218103937, 0
    .long 2, 64, 72, 7168, 2048, 2048, 7340032, 3145728, 32768, 8, 65568768, 114688, 0, 0, 218104196, 0
    .long 5, 218108192, 0, 0, 8, 0, 0, 12, 0, 0, 0, 0, 218112128, 16, 218106945, 0
    .long 2, 64, 72, 7168, 2560, 2560, 7340032, 3670016, 32768, 8, 67411968, 114688, 0, 0, 218104260, 0
    .long 2, 64, 72, 7168, 2816, 2816, 7340032, 524288, 32768, 8, 56406016, 114688, 0, 0, 218103873, 0
    .long 1, 80, 80, 2048, 1536, 1792, 7340032, 54525952, 114688, 14, 117465088, 32768, 218103808, 14, 218106370, 0
    .long 1, 40, 40, 2048, 1024, 1280, 8388608, 176160768, 131072, 16, 75513856, 32768, 218106880, 8, 218106376, 0
    .long 5, 218108192, 0, 0, 8, 0, 0, 8, 0, 0, 0, 0, 218112128, 12, 218106945, 0
    .long 1, 32, 32, 8192, 2048, 2304, 8388608, 3670016, 32768, 8, 52461568, 131072, 0, 0, 218106154, 0
    .long 1, 16, 16, 8192, 2560, 2816, 8388608, 3670016, 32768, 8, 18915328, 131072, 0, 0, 218106154, 0
    .long 1, 16, 16, 8192, 3072, 3328, 8388608, 3670016, 32768, 8, 18923520, 131072, 0, 0, 218106170, 0
    .long 1, 40, 40, 2048, 1536, 1792, 8388608, 182452224, 131072, 16, 77094912, 32768, 218112128, 33, 218106568, 0
    .long 1, 40, 40, 2048, 1536, 1792, 8388608, 176160768, 131072, 16, 75522048, 32768, 218106880, 8, 218106376, 0
    .long 2, 64, 72, 7168, 2560, 2560, 7340032, 3145728, 32768, 8, 65576960, 114688, 0, 0, 218104196, 0
    .long 1, 40, 40, 2048, 1024, 1280, 8388608, 180355072, 131072, 16, 76562432, 32768, 218112128, 25, 218106504, 0
    .long 1, 40, 40, 2048, 1536, 1792, 8388608, 180355072, 131072, 16, 76570624, 32768, 218112128, 25, 218106504, 0
    .long 2, 64, 72, 7168, 3072, 3072, 7340032, 2621440, 32768, 8, 63750144, 114688, 0, 0, 218104132, 0
    .long 1, 40, 40, 2048, 1024, 1280, 8388608, 182452224, 131072, 16, 77086720, 32768, 218112128, 33, 218106568, 0
    .long 2, 64, 72, 7168, 1792, 1792, 7340032, 2621440, 32768, 8, 63729664, 114688, 0, 0, 218104132, 0
    .long 1, 80, 80, 2048, 1024, 1280, 7340032, 54525952, 114688, 14, 117456896, 32768, 218103808, 14, 218106370, 0
    .long 2, 64, 72, 7168, 3328, 3328, 7340032, 2621440, 32768, 8, 63754240, 114688, 0, 0, 218104132, 0
    .long 2, 64, 72, 7168, 2048, 2048, 7340032, 2621440, 32768, 8, 63733760, 114688, 0, 0, 218104132, 0
    .long 2, 64, 72, 7168, 2304, 2304, 7340032, 3670016, 32768, 8, 67407872, 114688, 0, 0, 218104260, 0
    .long 2, 64, 72, 7168, 3072, 3072, 7340032, 3670016, 32768, 8, 67420160, 114688, 0, 0, 218104260, 0
    .long 1, 40, 40, 2048, 1024, 1280, 8388608, 178257920, 131072, 16, 76038144, 32768, 218106944, 8, 218106440, 0
    .long 1, 40, 40, 2048, 1536, 1792, 8388608, 178257920, 131072, 16, 76046336, 32768, 218106944, 8, 218106440, 0
    .long 2, 64, 72, 7168, 2560, 2560, 7340032, 2621440, 32768, 8, 63741952, 114688, 0, 0, 218104132, 0
    .long 2, 64, 72, 7168, 1792, 1792, 7340032, 3670016, 32768, 8, 67399680, 114688, 0, 0, 218104260, 0
    .long 2, 64, 72, 7168, 2304, 2304, 7340032, 2621440, 32768, 8, 63737856, 114688, 0, 0, 218104132, 0
    .long 1, 80, 80, 2048, 1536, 1792, 7340032, 61865984, 114688, 14, 119562240, 32768, 218104064, 14, 218106626, 0
    .long 1, 80, 80, 2048, 1024, 1280, 7340032, 60030976, 114688, 14, 119029760, 32768, 218104000, 14, 218106562, 0
    .long 1, 80, 80, 2048, 1024, 1280, 7340032, 61865984, 114688, 14, 119554048, 32768, 218104064, 14, 218106626, 0
    .long 1, 80, 80, 2048, 1536, 1792, 7340032, 60030976, 114688, 14, 119037952, 32768, 218104000, 14, 218106562, 0
    .long 2, 64, 72, 7168, 2816, 2816, 7340032, 3670016, 32768, 8, 67416064, 114688, 0, 0, 218104260, 0
    .long 2, 64, 72, 7168, 2048, 2048, 7340032, 3670016, 32768, 8, 67403776, 114688, 0, 0, 218104260, 0
    .long 1, 80, 80, 2048, 1024, 1280, 7340032, 58195968, 114688, 14, 118505472, 32768, 218103936, 14, 218106498, 0
    .long 1, 80, 80, 2048, 1536, 1792, 7340032, 58195968, 114688, 14, 118513664, 32768, 218103936, 14, 218106498, 0
    .long 2, 64, 72, 7168, 3328, 3328, 7340032, 3670016, 32768, 8, 67424256, 114688, 0, 0, 218104260, 0
    .long 1, 80, 80, 2048, 1536, 1792, 7340032, 56360960, 114688, 14, 117989376, 32768, 218103872, 14, 218106434, 0
    .long 1, 80, 80, 2048, 1024, 1280, 7340032, 56360960, 114688, 14, 117981184, 32768, 218103872, 14, 218106434, 0
    .long 1, 40, 40, 2048, 2097664, 2097920, 8388608, 184582144, 131072, 8, 81797120, 32768, 218112128, 41, 218106628, 0
    .long 1, 80, 80, 2048, 1835008, 1835264, 7340032, 65564672, 114688, 7, 124780544, 32768, 218104196, 7, 218106753, 0
    .long 1, 80, 80, 2048, 1835520, 1835776, 7340032, 65564672, 114688, 7, 124788736, 32768, 218104196, 7, 218106753, 0
    .long 1, 40, 40, 2048, 2097152, 2097408, 8388608, 184582144, 131072, 8, 81788928, 32768, 218112128, 41, 218106628, 0
    .long 1, 80, 80, 2048, 1836544, 1836800, 7340032, 65564672, 114688, 7, 124805120, 32768, 218104196, 7, 218106753, 0
    .long 1, 40, 40, 2048, 2098176, 2098432, 8388608, 184582144, 131072, 8, 81805312, 32768, 218112128, 41, 218106628, 0
    .long 1, 40, 40, 2048, 2098688, 2098944, 8388608, 184582144, 131072, 8, 81813504, 32768, 218112128, 41, 218106628, 0
    .long 1, 40, 40, 2048, 2097664, 2097920, 8388608, 186679296, 131072, 8, 82321408, 32768, 218112128, 49, 218106692, 0
    .long 1, 80, 80, 2048, 1836032, 1836288, 7340032, 65564672, 114688, 7, 124796928, 32768, 218104196, 7, 218106753, 0
    .long 1, 40, 40, 2048, 2098176, 2098432, 8388608, 186679296, 131072, 8, 82329600, 32768, 218112128, 49, 218106692, 0
    .long 1, 40, 40, 2048, 2097152, 2097408, 8388608, 186679296, 131072, 8, 82313216, 32768, 218112128, 49, 218106692, 0
    .long 1, 40, 40, 2048, 2098688, 2098944, 8388608, 186679296, 131072, 8, 82337792, 32768, 218112128, 49, 218106692, 0
    .long 1, 80, 80, 2048, 1836032, 1836288, 7340032, 63729664, 114688, 7, 124272640, 32768, 218104132, 7, 218106689, 0
    .long 1, 80, 80, 2048, 1836544, 1836800, 7340032, 63729664, 114688, 7, 124280832, 32768, 218104132, 7, 218106689, 0
    .long 1, 80, 80, 2048, 1835008, 1835264, 7340032, 63729664, 114688, 7, 124256256, 32768, 218104132, 7, 218106689, 0
    .long 1, 80, 80, 2048, 1835520, 1835776, 7340032, 63729664, 114688, 7, 124264448, 32768, 218104132, 7, 218106689, 0
    .long 1, 80, 80, 2048, 1835520, 1835776, 7340032, 67399680, 114688, 7, 125313024, 32768, 218104260, 7, 218106817, 0
    .long 1, 80, 80, 2048, 1836032, 1836288, 7340032, 67399680, 114688, 7, 125321216, 32768, 218104260, 7, 218106817, 0
    .long 1, 80, 80, 2048, 1836544, 1836800, 7340032, 67399680, 114688, 7, 125329408, 32768, 218104260, 7, 218106817, 0
    .long 1, 80, 80, 2048, 1835008, 1835264, 7340032, 67399680, 114688, 7, 125304832, 32768, 218104260, 7, 218106817, 0
    .long 6, 1, 0, 2, 1, 16, 0, 3, 0, 0, 0, 0, 0, 0, 0, 0
    .long 6, 0, 0, 0, 1, 0, 0, 51, 0, 0, 0, 0, 0, 0, 0, 0
    .long 6, 1, 0, 2, 1, 16, 0, 1, 0, 0, 0, 0, 0, 0, 0, 0
    .long 6, 1, 0, 2, 1, 16, 0, 0, 0, 0, 0, 0, 0, 0, 0, 0
    .long 6, 1, 0, 2, 1, 16, 0, 5, 0, 0, 0, 0, 0, 0, 0, 0
    .long 6, 1, 0, 2, 1, 16, 0, 4, 0, 0, 0, 0, 0, 0, 0, 0
    .long 6, 1, 0, 2, 1, 16, 0, 22, 0, 0, 0, 0, 0, 0, 0, 0
    .long 6, 1, 0, 2, 1, 16, 0, 6, 0, 0, 0, 0, 0, 0, 0, 0
    .long 6, 1, 0, 2, 1, 16, 0, 18, 0, 0, 0, 0, 0, 0, 0, 0
    .long 6, 1, 0, 2, 1, 16, 0, 19, 0, 0, 0, 0, 0, 0, 0, 0
    .long 6, 1, 0, 2, 1, 16, 0, 20, 0, 0, 0, 0, 0, 0, 0, 0
    .long 6, 1, 0, 2, 1, 16, 0, 7, 0, 0, 0, 0, 0, 0, 0, 0
    .long 6, 1, 0, 2, 1, 16, 0, 2, 0, 0, 0, 0, 0, 0, 0, 0
    .long 6, 1, 0, 2, 1, 16, 0, 17, 0, 0, 0, 0, 0, 0, 0, 0
    .long 6, 1, 0, 2, 1, 16, 0, 21, 0, 0, 0, 0, 0, 0, 0, 0
    .long 6, 1, 0, 2, 1, 16, 0, 16, 0, 0, 0, 0, 0, 0, 0, 0
    .long 6, 0, 0, 0, 1, 0, 0, 50, 0, 0, 0, 0, 0, 0, 0, 0
    .long 6, 0, 0, 0, 1, 0, 0, 52, 0, 0, 0, 0, 0, 0, 0, 0
    .long 6, 0, 0, 0, 1, 0, 0, 54, 0, 0, 0, 0, 0, 0, 0, 0
    .long 6, 0, 0, 0, 1, 0, 0, 49, 0, 0, 0, 0, 0, 0, 0, 0
    .long 6, 0, 0, 0, 1, 0, 0, 48, 0, 0, 0, 0, 0, 0, 0, 0
    .long 6, 0, 0, 0, 1, 0, 0, 53, 0, 0, 0, 0, 0, 0, 0, 0
    .long 6, 0, 0, 0, 1, 0, 0, 55, 0, 0, 0, 0, 0, 0, 0, 0
    .long 6, 0, 0, 0, 1, 0, 0, 56, 0, 0, 0, 0, 0, 0, 0, 0
    .long 6, 1, 0, 2, 1, 16, 0, 23, 0, 0, 0, 0, 0, 0, 0, 0
    .long 6, 1, 0, 2, 1, 16, 0, 24, 0, 0, 0, 0, 0, 0, 0, 0
    .long 6, 1, 0, 2, 1, 16, 0, 25, 0, 0, 0, 0, 0, 0, 0, 0
    .long 6, 1, 0, 2, 1, 16, 0, 26, 0, 0, 0, 0, 0, 0, 0, 0
    .long 6, 1, 0, 2, 1, 16, 0, 27, 0, 0, 0, 0, 0, 0, 0, 0
    .long 6, 1, 0, 2, 1, 16, 0, 28, 0, 0, 0, 0, 0, 0, 0, 0
    .long 6, 1, 0, 2, 1, 16, 0, 29, 0, 0, 0, 0, 0, 0, 0, 0
    .long 6, 1, 0, 2, 1, 16, 0, 30, 0, 0, 0, 0, 0, 0, 0, 0
    .long 6, 1, 0, 2, 1, 16, 0, 31, 0, 0, 0, 0, 0, 0, 0, 0
    .long 6, 0, 0, 1, 1, 16, 0, 40, 0, 0, 0, 0, 0, 0, 0, 0
    .long 6, 0, 0, 1, 1, 16, 0, 41, 0, 0, 0, 0, 0, 0, 0, 0
    .long 6, 0, 0, 1, 1, 16, 0, 43, 0, 0, 0, 0, 0, 0, 0, 0
    .long 6, 0, 0, 1, 1, 16, 0, 45, 0, 0, 0, 0, 0, 0, 0, 0
    .long 6, 0, 0, 1, 1, 16, 0, 46, 0, 0, 0, 0, 0, 0, 0, 0
    .long 6, 0, 0, 1, 1, 16, 0, 47, 0, 0, 0, 0, 0, 0, 0, 0
    .long 6, 1, 0, 1, 1, 16, 0, 32, 0, 0, 0, 0, 0, 0, 0, 0
    .long 6, 1, 0, 1, 1, 16, 0, 33, 0, 0, 0, 0, 0, 0, 0, 0
    .long 6, 1, 0, 1, 1, 16, 0, 35, 0, 0, 0, 0, 0, 0, 0, 0
    .long 6, 1, 0, 1, 1, 16, 0, 36, 0, 0, 0, 0, 0, 0, 0, 0
    .long 6, 1, 0, 1, 1, 16, 0, 38, 0, 0, 0, 0, 0, 0, 0, 0
    .long 6, 1, 0, 1, 1, 16, 0, 39, 0, 0, 0, 0, 0, 0, 0, 0
    .long 6, 0, 0, 0, 1, 0, 0, 57, 0, 0, 0, 0, 0, 0, 0, 0
    .long 6, 0, 0, 1, 1, 16, 0, 44, 0, 0, 0, 0, 0, 0, 0, 0
    .long 6, 1, 0, 1, 1, 16, 0, 34, 0, 0, 0, 0, 0, 0, 0, 0
    .long 6, 0, 0, 0, 1, 0, 0, 58, 0, 0, 0, 0, 0, 0, 0, 0
    .long 6, 1, 0, 1, 1, 16, 0, 37, 0, 0, 0, 0, 0, 0, 0, 0
    .long 6, 0, 0, 1, 1, 16, 0, 42, 0, 0, 0, 0, 0, 0, 0, 0
    .long 6, 0, 0, 0, 1, 0, 0, 59, 0, 0, 0, 0, 0, 0, 0, 0
    .long 6, 1, 0, 2, 1, 16, 0, 8, 0, 0, 0, 0, 0, 0, 0, 0
    .long 6, 1, 0, 2, 1, 16, 0, 9, 0, 0, 0, 0, 0, 0, 0, 0
    .long 6, 1, 0, 2, 1, 16, 0, 10, 0, 0, 0, 0, 0, 0, 0, 0
    .long 6, 1, 0, 2, 1, 16, 0, 11, 0, 0, 0, 0, 0, 0, 0, 0
    .long 6, 1, 0, 2, 1, 16, 0, 12, 0, 0, 0, 0, 0, 0, 0, 0
    .long 6, 1, 0, 2, 1, 16, 0, 13, 0, 0, 0, 0, 0, 0, 0, 0
    .long 6, 1, 0, 2, 1, 16, 0, 14, 0, 0, 0, 0, 0, 0, 0, 0
    .long 6, 1, 0, 2, 1, 16, 0, 15, 0, 0, 0, 0, 0, 0, 0, 0
    .long 7, 0, 0, 0, 4, 0, 0, 60, 0, 0, 0, 0, 0, 0, 0, 0
    .long 7, 0, 0, 0, 5, 0, 0, 60, 0, 0, 0, 0, 0, 0, 0, 0
    .long 7, 0, 0, 0, 6, 0, 0, 60, 0, 0, 0, 0, 0, 0, 0, 0
    .long 7, 0, 0, 0, 7, 0, 0, 60, 0, 0, 0, 0, 0, 0, 0, 0
    .long 7, 0, 0, 0, 4, 0, 0, 61, 0, 0, 0, 0, 0, 0, 0, 0
    .long 7, 0, 0, 0, 5, 0, 0, 61, 0, 0, 0, 0, 0, 0, 0, 0
    .long 7, 0, 0, 0, 6, 0, 0, 61, 0, 0, 0, 0, 0, 0, 0, 0
    .long 7, 0, 0, 0, 7, 0, 0, 61, 0, 0, 0, 0, 0, 0, 0, 0
    .long 7, 0, 0, 0, 4, 0, 0, 62, 0, 0, 0, 0, 0, 0, 0, 0
    .long 7, 0, 0, 0, 5, 0, 0, 62, 0, 0, 0, 0, 0, 0, 0, 0
    .long 7, 0, 0, 0, 6, 0, 0, 62, 0, 0, 0, 0, 0, 0, 0, 0
    .long 7, 0, 0, 0, 7, 0, 0, 62, 0, 0, 0, 0, 0, 0, 0, 0
    .long 7, 0, 0, 0, 4, 0, 0, 63, 0, 0, 0, 0, 0, 0, 0, 0
    .long 7, 0, 0, 0, 5, 0, 0, 63, 0, 0, 0, 0, 0, 0, 0, 0
    .long 7, 0, 0, 0, 6, 0, 0, 63, 0, 0, 0, 0, 0, 0, 0, 0
    .long 7, 0, 0, 0, 7, 0, 0, 63, 0, 0, 0, 0, 0, 0, 0, 0
    .long 0, 0, 0, 0, 0, 0, 0, 0, 0, 0, 0, 0, 0, 0, 0, 0
    .long 4, 24, 24, 8192, 4096, 266240, 8388608, 0, 32768, 4, 21037056, 131072, 0, 0, 218104385, 0
    .long 4, 24, 24, 8192, 4352, 266496, 8388608, 0, 32768, 4, 21041152, 131072, 0, 0, 218104385, 0
    .long 4, 24, 24, 8192, 4608, 266752, 8388608, 0, 32768, 4, 21045248, 131072, 0, 0, 218104385, 0
    .long 4, 24, 24, 8192, 4864, 267008, 8388608, 0, 32768, 4, 21049344, 131072, 0, 0, 218104385, 0
    .long 4, 24, 24, 8192, 5120, 267264, 8388608, 0, 32768, 4, 21053440, 131072, 0, 0, 218104401, 0
    .long 4, 24, 24, 8192, 5376, 267520, 8388608, 0, 32768, 4, 21057536, 131072, 0, 0, 218104401, 0
    .long 4, 24, 24, 8192, 5632, 267776, 8388608, 0, 32768, 4, 21061632, 131072, 0, 0, 218104401, 0
    .long 4, 24, 24, 8192, 5888, 268032, 8388608, 0, 32768, 4, 21065728, 131072, 0, 0, 218104401, 0
    .long 4, 32, 32, 8192, 4096, 266240, 8388608, 0, 32768, 4, 37814272, 131072, 0, 0, 218104385, 0
    .long 4, 32, 32, 8192, 4352, 266496, 8388608, 0, 32768, 4, 37818368, 131072, 0, 0, 218104385, 0
    .long 4, 32, 32, 8192, 4608, 266752, 8388608, 0, 32768, 4, 37822464, 131072, 0, 0, 218104385, 0
    .long 4, 32, 32, 8192, 4864, 267008, 8388608, 0, 32768, 4, 37826560, 131072, 0, 0, 218104385, 0
    .long 4, 32, 32, 8192, 5120, 267264, 8388608, 0, 32768, 4, 37830656, 131072, 0, 0, 218104401, 0
    .long 4, 32, 32, 8192, 5376, 267520, 8388608, 0, 32768, 4, 37834752, 131072, 0, 0, 218104401, 0
    .long 4, 32, 32, 8192, 5632, 267776, 8388608, 0, 32768, 4, 37838848, 131072, 0, 0, 218104401, 0
    .long 4, 32, 32, 8192, 5888, 268032, 8388608, 0, 32768, 4, 37842944, 131072, 0, 0, 218104401, 0
    .long 4, 24, 24, 8192, 4096, 266240, 8388608, 262144, 32768, 4, 22085632, 131072, 0, 0, 218104388, 0
    .long 4, 24, 24, 8192, 4352, 266496, 8388608, 262144, 32768, 4, 22089728, 131072, 0, 0, 218104388, 0
    .long 4, 24, 24, 8192, 4608, 266752, 8388608, 262144, 32768, 4, 22093824, 131072, 0, 0, 218104388, 0
    .long 4, 24, 24, 8192, 4864, 267008, 8388608, 262144, 32768, 4, 22097920, 131072, 0, 0, 218104388, 0
    .long 4, 24, 24, 8192, 5120, 267264, 8388608, 262144, 32768, 4, 22102016, 131072, 0, 0, 218104404, 0
    .long 4, 24, 24, 8192, 5376, 267520, 8388608, 262144, 32768, 4, 22106112, 131072, 0, 0, 218104404, 0
    .long 4, 24, 24, 8192, 5632, 267776, 8388608, 262144, 32768, 4, 22110208, 131072, 0, 0, 218104404, 0
    .long 4, 24, 24, 8192, 5888, 268032, 8388608, 262144, 32768, 4, 22114304, 131072, 0, 0, 218104404, 0
    .long 4, 32, 32, 8192, 4096, 266240, 8388608, 262144, 32768, 4, 38862848, 131072, 0, 0, 218104388, 0
    .long 4, 32, 32, 8192, 4352, 266496, 8388608, 262144, 32768, 4, 38866944, 131072, 0, 0, 218104388, 0
    .long 4, 32, 32, 8192, 4608, 266752, 8388608, 262144, 32768, 4, 38871040, 131072, 0, 0, 218104388, 0
    .long 4, 32, 32, 8192, 4864, 267008, 8388608, 262144, 32768, 4, 38875136, 131072, 0, 0, 218104388, 0
    .long 4, 32, 32, 8192, 5120, 267264, 8388608, 262144, 32768, 4, 38879232, 131072, 0, 0, 218104404, 0
    .long 4, 32, 32, 8192, 5376, 267520, 8388608, 262144, 32768, 4, 38883328, 131072, 0, 0, 218104404, 0
    .long 4, 32, 32, 8192, 5632, 267776, 8388608, 262144, 32768, 4, 38887424, 131072, 0, 0, 218104404, 0
    .long 4, 32, 32, 8192, 5888, 268032, 8388608, 262144, 32768, 4, 38891520, 131072, 0, 0, 218104404, 0
    .long 4, 32, 32, 8192, 4352, 266496, 8388608, 786432, 32768, 4, 40964096, 131072, 0, 0, 218104644, 0
    .long 4, 24, 24, 8192, 4608, 266752, 8388608, 786432, 32768, 4, 24190976, 131072, 0, 0, 218104644, 0
    .long 4, 24, 24, 8192, 5632, 267776, 8388608, 786432, 32768, 4, 24207360, 131072, 0, 0, 218104660, 0
    .long 4, 32, 32, 8192, 4864, 267008, 8388608, 524288, 32768, 4, 39923712, 131072, 0, 0, 218104641, 0
    .long 4, 32, 32, 8192, 5632, 267776, 8388608, 786432, 32768, 4, 40984576, 131072, 0, 0, 218104660, 0
    .long 4, 32, 32, 8192, 5376, 267520, 8388608, 524288, 32768, 4, 39931904, 131072, 0, 0, 218104657, 0
    .long 4, 24, 24, 8192, 5120, 267264, 8388608, 786432, 32768, 4, 24199168, 131072, 0, 0, 218104660, 0
    .long 4, 32, 32, 8192, 5888, 268032, 8388608, 524288, 32768, 4, 39940096, 131072, 0, 0, 218104657, 0
    .long 4, 32, 32, 8192, 4608, 266752, 8388608, 786432, 32768, 4, 40968192, 131072, 0, 0, 218104644, 0
    .long 4, 32, 32, 8192, 4608, 266752, 8388608, 524288, 32768, 4, 39919616, 131072, 0, 0, 218104641, 0
    .long 4, 32, 32, 8192, 5120, 267264, 8388608, 786432, 32768, 4, 40976384, 131072, 0, 0, 218104660, 0
    .long 4, 24, 24, 8192, 4864, 267008, 8388608, 524288, 32768, 4, 23146496, 131072, 0, 0, 218104641, 0
    .long 2, 64, 72, 7168, 3584, 3584, 7340032, 1048576, 32768, 8, 58253312, 114688, 0, 0, 218103953, 0
    .long 4, 24, 24, 8192, 4352, 266496, 8388608, 786432, 32768, 4, 24186880, 131072, 0, 0, 218104644, 0
    .long 4, 24, 24, 8192, 5376, 267520, 8388608, 524288, 32768, 4, 23154688, 131072, 0, 0, 218104657, 0
    .long 4, 32, 32, 8192, 4352, 266496, 8388608, 524288, 32768, 4, 39915520, 131072, 0, 0, 218104641, 0
    .long 4, 32, 32, 8192, 5888, 268032, 8388608, 786432, 32768, 4, 40988672, 131072, 0, 0, 218104660, 0
    .long 4, 24, 24, 8192, 4096, 266240, 8388608, 524288, 32768, 4, 23134208, 131072, 0, 0, 218104641, 0
    .long 4, 24, 24, 8192, 5632, 267776, 8388608, 524288, 32768, 4, 23158784, 131072, 0, 0, 218104657, 0
    .long 4, 32, 32, 8192, 4096, 266240, 8388608, 524288, 32768, 4, 39911424, 131072, 0, 0, 218104641, 0
    .long 4, 24, 24, 8192, 5888, 268032, 8388608, 524288, 32768, 4, 23162880, 131072, 0, 0, 218104657, 0
    .long 4, 32, 32, 8192, 4096, 266240, 8388608, 786432, 32768, 4, 40960000, 131072, 0, 0, 218104644, 0
    .long 4, 24, 24, 8192, 4864, 267008, 8388608, 786432, 32768, 4, 24195072, 131072, 0, 0, 218104644, 0
    .long 4, 32, 32, 8192, 4864, 267008, 8388608, 786432, 32768, 4, 40972288, 131072, 0, 0, 218104644, 0
    .long 4, 32, 32, 8192, 5632, 267776, 8388608, 524288, 32768, 4, 39936000, 131072, 0, 0, 218104657, 0
    .long 4, 24, 24, 8192, 5120, 267264, 8388608, 524288, 32768, 4, 23150592, 131072, 0, 0, 218104657, 0
    .long 4, 32, 32, 8192, 5376, 267520, 8388608, 786432, 32768, 4, 40980480, 131072, 0, 0, 218104660, 0
    .long 4, 24, 24, 8192, 4352, 266496, 8388608, 524288, 32768, 4, 23138304, 131072, 0, 0, 218104641, 0
    .long 4, 32, 32, 8192, 5120, 267264, 8388608, 524288, 32768, 4, 39927808, 131072, 0, 0, 218104657, 0
    .long 4, 24, 24, 8192, 4608, 266752, 8388608, 524288, 32768, 4, 23142400, 131072, 0, 0, 218104641, 0
    .long 4, 24, 24, 8192, 5376, 267520, 8388608, 786432, 32768, 4, 24203264, 131072, 0, 0, 218104660, 0
    .long 4, 24, 24, 8192, 4096, 266240, 8388608, 786432, 32768, 4, 24182784, 131072, 0, 0, 218104644, 0
    .long 1, 32, 32, 8192, 5120, 5376, 8388608, 1048576, 32768, 8, 42024960, 131072, 0, 0, 218104922, 0
    .long 1, 24, 24, 8192, 4608, 4864, 8388608, 1048576, 32768, 8, 25239552, 131072, 0, 0, 218104906, 0
    .long 1, 16, 16, 8192, 4608, 4864, 8388608, 1048576, 32768, 8, 8462336, 131072, 0, 0, 218104906, 0
    .long 1, 24, 24, 8192, 5120, 5376, 8388608, 1048576, 32768, 8, 25247744, 131072, 0, 0, 218104922, 0
    .long 4, 24, 24, 8192, 5888, 268032, 8388608, 786432, 32768, 4, 24211456, 131072, 0, 0, 218104660, 0
    .long 1, 16, 16, 8192, 4096, 4352, 8388608, 1048576, 32768, 8, 8454144, 131072, 0, 0, 218104906, 0
    .long 1, 24, 24, 8192, 4608, 4864, 8388608, 1572864, 32768, 8, 27336704, 131072, 0, 0, 218105162, 0
    .long 1, 32, 32, 8192, 5120, 5376, 8388608, 1572864, 32768, 8, 44122112, 131072, 0, 0, 218105178, 0
    .long 1, 24, 24, 8192, 4096, 4352, 8388608, 1048576, 32768, 8, 25231360, 131072, 0, 0, 218104906, 0
    .long 1, 32, 32, 8192, 4608, 4864, 8388608, 1048576, 32768, 8, 42016768, 131072, 0, 0, 218104906, 0
    .long 1, 16, 16, 8192, 5632, 5888, 8388608, 1572864, 32768, 8, 10575872, 131072, 0, 0, 218105178, 0
    .long 1, 16, 16, 8192, 4096, 4352, 8388608, 0, 32768, 8, 4259840, 131072, 0, 0, 218107978, 0
    .long 1, 24, 24, 8192, 5120, 5376, 8388608, 1572864, 32768, 8, 27344896, 131072, 0, 0, 218105178, 0
    .long 1, 32, 32, 8192, 5632, 5888, 8388608, 1572864, 32768, 8, 44130304, 131072, 0, 0, 218105178, 0
    .long 1, 32, 32, 8192, 4096, 4352, 8388608, 1048576, 32768, 8, 42008576, 131072, 0, 0, 218104906, 0
    .long 1, 16, 16, 8192, 5120, 5376, 8388608, 1572864, 32768, 8, 10567680, 131072, 0, 0, 218105178, 0
    .long 1, 32, 32, 8192, 5632, 5888, 8388608, 1048576, 32768, 8, 42033152, 131072, 0, 0, 218104922, 0
    .long 1, 24, 24, 8192, 5632, 5888, 8388608, 1572864, 32768, 8, 27353088, 131072, 0, 0, 218105178, 0
    .long 1, 16, 16, 8192, 5632, 5888, 8388608, 1048576, 32768, 8, 8478720, 131072, 0, 0, 218104922, 0
    .long 1, 32, 32, 8192, 4096, 4352, 8388608, 1572864, 32768, 8, 44105728, 131072, 0, 0, 218105162, 0
    .long 1, 16, 16, 8192, 5632, 5888, 8388608, 0, 32768, 8, 4284416, 131072, 0, 0, 218107994, 0
    .long 1, 16, 16, 8192, 4608, 4864, 8388608, 2097152, 32768, 8, 12656640, 131072, 0, 0, 218105418, 0
    .long 1, 16, 16, 8192, 5120, 5376, 8388608, 1048576, 32768, 8, 8470528, 131072, 0, 0, 218104922, 0
    .long 1, 16, 16, 8192, 4096, 4352, 8388608, 1572864, 32768, 8, 10551296, 131072, 0, 0, 218105162, 0
    .long 1, 32, 32, 8192, 4096, 4352, 8388608, 2097152, 32768, 8, 46202880, 131072, 0, 0, 218105418, 0
    .long 1, 16, 16, 8192, 4608, 4864, 8388608, 0, 32768, 8, 4268032, 131072, 0, 0, 218107978, 0
    .long 1, 24, 24, 8192, 5632, 5888, 8388608, 1048576, 32768, 8, 25255936, 131072, 0, 0, 218104922, 0
    .long 1, 16, 16, 8192, 4608, 4864, 8388608, 1572864, 32768, 8, 10559488, 131072, 0, 0, 218105162, 0
    .long 1, 16, 16, 8192, 5120, 5376, 8388608, 0, 32768, 8, 4276224, 131072, 0, 0, 218107994, 0
    .long 1, 32, 32, 8192, 4608, 4864, 8388608, 2097152, 32768, 8, 46211072, 131072, 0, 0, 218105418, 0
    .long 1, 32, 32, 8192, 4608, 4864, 8388608, 1572864, 32768, 8, 44113920, 131072, 0, 0, 218105162, 0
    .long 1, 24, 24, 8192, 4096, 4352, 8388608, 1572864, 32768, 8, 27328512, 131072, 0, 0, 218105162, 0
    .long 1, 16, 16, 8192, 4096, 4352, 8388608, 524288, 32768, 8, 6356992, 131072, 0, 0, 218108234, 0
    .long 1, 32, 32, 8192, 5120, 5376, 8388608, 3670016, 32768, 8, 52510720, 131072, 0, 0, 218106202, 0
    .long 1, 16, 16, 8192, 5120, 5376, 8388608, 2621440, 32768, 8, 14761984, 131072, 0, 0, 218105690, 0
    .long 1, 24, 24, 8192, 4608, 4864, 8388608, 3145728, 32768, 8, 33628160, 131072, 0, 0, 218105930, 0
    .long 1, 16, 16, 8192, 4096, 4352, 8388608, 2621440, 32768, 8, 14745600, 131072, 0, 0, 218105674, 0
    .long 1, 32, 32, 8192, 5632, 5888, 8388608, 3670016, 32768, 8, 52518912, 131072, 0, 0, 218106202, 0
    .long 1, 16, 16, 8192, 4096, 4352, 8388608, 3145728, 32768, 8, 16842752, 131072, 0, 0, 218105930, 0
    .long 1, 24, 24, 8192, 5120, 5376, 8388608, 2097152, 32768, 8, 29442048, 131072, 0, 0, 218105434, 0
    .long 1, 16, 16, 8192, 5632, 5888, 8388608, 2097152, 32768, 8, 12673024, 131072, 0, 0, 218105434, 0
    .long 1, 24, 24, 8192, 4608, 4864, 8388608, 3670016, 32768, 8, 35725312, 131072, 0, 0, 218106186, 0
    .long 1, 24, 24, 8192, 5632, 5888, 8388608, 3145728, 32768, 8, 33644544, 131072, 0, 0, 218105946, 0
    .long 1, 32, 32, 8192, 5632, 5888, 8388608, 2621440, 32768, 8, 48324608, 131072, 0, 0, 218105690, 0
    .long 1, 32, 32, 8192, 5632, 5888, 8388608, 2097152, 32768, 8, 46227456, 131072, 0, 0, 218105434, 0
    .long 1, 24, 24, 8192, 5632, 5888, 8388608, 2097152, 32768, 8, 29450240, 131072, 0, 0, 218105434, 0
    .long 1, 24, 24, 8192, 4096, 4352, 8388608, 2097152, 32768, 8, 29425664, 131072, 0, 0, 218105418, 0
    .long 1, 32, 32, 8192, 5632, 5888, 8388608, 3145728, 32768, 8, 50421760, 131072, 0, 0, 218105946, 0
    .long 1, 32, 32, 8192, 4096, 4352, 8388608, 3145728, 32768, 8, 50397184, 131072, 0, 0, 218105930, 0
    .long 1, 16, 16, 8192, 5120, 5376, 8388608, 3145728, 32768, 8, 16859136, 131072, 0, 0, 218105946, 0
    .long 1, 16, 16, 8192, 5120, 5376, 8388608, 2097152, 32768, 8, 12664832, 131072, 0, 0, 218105434, 0
    .long 5, 218107984, 0, 0, 20, 0, 0, 0, 0, 0, 0, 0, 218112256, 4, 218106897, 0
    .long 1, 32, 32, 8192, 5120, 5376, 8388608, 3145728, 32768, 8, 50413568, 131072, 0, 0, 218105946, 0
    .long 1, 24, 24, 8192, 5632, 5888, 8388608, 3670016, 32768, 8, 35741696, 131072, 0, 0, 218106202, 0
    .long 1, 32, 32, 8192, 4096, 4352, 8388608, 2621440, 32768, 8, 48300032, 131072, 0, 0, 218105674, 0
    .long 1, 32, 32, 8192, 5120, 5376, 8388608, 2097152, 32768, 8, 46219264, 131072, 0, 0, 218105434, 0
    .long 1, 24, 24, 8192, 4608, 4864, 8388608, 2621440, 32768, 8, 31531008, 131072, 0, 0, 218105674, 0
    .long 1, 24, 24, 8192, 4608, 4864, 8388608, 2097152, 32768, 8, 29433856, 131072, 0, 0, 218105418, 0
    .long 1, 16, 16, 8192, 5632, 5888, 8388608, 524288, 32768, 8, 6381568, 131072, 0, 0, 218108250, 0
    .long 1, 32, 32, 8192, 5120, 5376, 8388608, 2621440, 32768, 8, 48316416, 131072, 0, 0, 218105690, 0
    .long 1, 16, 16, 8192, 5120, 5376, 8388608, 524288, 32768, 8, 6373376, 131072, 0, 0, 218108250, 0
    .long 1, 24, 24, 8192, 4096, 4352, 8388608, 2621440, 32768, 8, 31522816, 131072, 0, 0, 218105674, 0
    .long 1, 16, 16, 8192, 4096, 4352, 8388608, 2097152, 32768, 8, 12648448, 131072, 0, 0, 218105418, 0
    .long 5, 218107984, 0, 0, 20, 0, 0, 4, 0, 0, 0, 0, 218112256, 8, 218106897, 0
    .long 5, 218107968, 0, 0, 16, 0, 0, 0, 0, 0, 0, 0, 218112256, 4, 218106897, 0
    .long 1, 24, 24, 8192, 5120, 5376, 8388608, 3670016, 32768, 8, 35733504, 131072, 0, 0, 218106202, 0
    .long 2, 64, 72, 7168, 3584, 3584, 7340032, 2097152, 32768, 8, 61923328, 114688, 0, 0, 218104081, 0
    .long 1, 24, 24, 8192, 5632, 5888, 8388608, 2621440, 32768, 8, 31547392, 131072, 0, 0, 218105690, 0
    .long 2, 64, 72, 7168, 3840, 3840, 7340032, 0, 32768, 8, 54587392, 114688, 0, 0, 218103825, 0
    .long 1, 24, 24, 8192, 4096, 4352, 8388608, 3670016, 32768, 8, 35717120, 131072, 0, 0, 218106186, 0
    .long 1, 32, 32, 8192, 4608, 4864, 8388608, 3670016, 32768, 8, 52502528, 131072, 0, 0, 218106186, 0
    .long 2, 64, 72, 7168, 4608, 4608, 7340032, 2621440, 32768, 8, 63774720, 114688, 0, 0, 218104145, 0
    .long 1, 32, 32, 8192, 4608, 4864, 8388608, 2621440, 32768, 8, 48308224, 131072, 0, 0, 218105674, 0
    .long 1, 16, 16, 8192, 4608, 4864, 8388608, 2621440, 32768, 8, 14753792, 131072, 0, 0, 218105674, 0
    .long 2, 64, 72, 7168, 3584, 3584, 7340032, 0, 32768, 8, 54583296, 114688, 0, 0, 218103825, 0
    .long 1, 16, 16, 8192, 5632, 5888, 8388608, 3145728, 32768, 8, 16867328, 131072, 0, 0, 218105946, 0
    .long 1, 24, 24, 8192, 5120, 5376, 8388608, 2621440, 32768, 8, 31539200, 131072, 0, 0, 218105690, 0
    .long 2, 64, 72, 7168, 3840, 3840, 7340032, 524288, 32768, 8, 56422400, 114688, 0, 0, 218103889, 0
    .long 1, 24, 24, 8192, 4096, 4352, 8388608, 3145728, 32768, 8, 33619968, 131072, 0, 0, 218105930, 0
    .long 2, 64, 72, 7168, 4352, 4352, 7340032, 0, 32768, 8, 54595584, 114688, 0, 0, 218103825, 0
    .long 2, 64, 72, 7168, 4352, 4352, 7340032, 524288, 32768, 8, 56430592, 114688, 0, 0, 218103889, 0
    .long 2, 64, 72, 7168, 4096, 4096, 7340032, 2097152, 32768, 8, 61931520, 114688, 0, 0, 218104081, 0
    .long 2, 64, 72, 7168, 4608, 4608, 7340032, 2097152, 32768, 8, 61939712, 114688, 0, 0, 218104081, 0
    .long 1, 16, 16, 8192, 4608, 4864, 8388608, 524288, 32768, 8, 6365184, 131072, 0, 0, 218108234, 0
    .long 1, 16, 16, 8192, 4608, 4864, 8388608, 3145728, 32768, 8, 16850944, 131072, 0, 0, 218105930, 0
    .long 2, 64, 72, 7168, 4608, 4608, 7340032, 0, 32768, 8, 54599680, 114688, 0, 0, 218103825, 0
    .long 2, 64, 72, 7168, 4864, 4864, 7340032, 0, 32768, 8, 54603776, 114688, 0, 0, 218103825, 0
    .long 1, 16, 16, 8192, 5632, 5888, 8388608, 2621440, 32768, 8, 14770176, 131072, 0, 0, 218105690, 0
    .long 1, 24, 24, 8192, 5120, 5376, 8388608, 3145728, 32768, 8, 33636352, 131072, 0, 0, 218105946, 0
    .long 2, 64, 72, 7168, 4864, 4864, 7340032, 3145728, 32768, 8, 65613824, 114688, 0, 0, 218104209, 0
    .long 1, 32, 32, 8192, 4608, 4864, 8388608, 3145728, 32768, 8, 50405376, 131072, 0, 0, 218105930, 0
    .long 1, 16, 16, 8192, 5632, 5888, 8388608, 3670016, 32768, 8, 18964480, 131072, 0, 0, 218106202, 0
    .long 2, 64, 72, 7168, 5120, 5120, 7340032, 0, 32768, 8, 54607872, 114688, 0, 0, 218103825, 0
    .long 2, 64, 72, 7168, 4096, 4096, 7340032, 0, 32768, 8, 54591488, 114688, 0, 0, 218103825, 0
    .long 5, 218107968, 0, 0, 16, 0, 0, 4, 0, 0, 0, 0, 218112256, 8, 218106897, 0
    .long 2, 64, 72, 7168, 5120, 5120, 7340032, 3145728, 32768, 8, 65617920, 114688, 0, 0, 218104209, 0
    .long 2, 64, 72, 7168, 3584, 3584, 7340032, 524288, 32768, 8, 56418304, 114688, 0, 0, 218103889, 0
    .long 2, 64, 72, 7168, 4864, 4864, 7340032, 1572864, 32768, 8, 60108800, 114688, 0, 0, 218104017, 0
    .long 2, 64, 72, 7168, 5120, 5120, 7340032, 524288, 32768, 8, 56442880, 114688, 0, 0, 218103889, 0
    .long 1, 16, 16, 8192, 4096, 4352, 8388608, 3670016, 32768, 8, 18939904, 131072, 0, 0, 218106186, 0
    .long 5, 218108240, 0, 0, 20, 0, 0, 8, 0, 0, 0, 0, 218112256, 12, 218106961, 0
    .long 2, 64, 72, 7168, 3584, 3584, 7340032, 3145728, 32768, 8, 65593344, 114688, 0, 0, 218104209, 0
    .long 2, 64, 72, 7168, 4096, 4096, 7340032, 1572864, 32768, 8, 60096512, 114688, 0, 0, 218104017, 0
    .long 2, 64, 72, 7168, 4352, 4352, 7340032, 2097152, 32768, 8, 61935616, 114688, 0, 0, 218104081, 0
    .long 2, 64, 72, 7168, 3584, 3584, 7340032, 1572864, 32768, 8, 60088320, 114688, 0, 0, 218104017, 0
    .long 2, 64, 72, 7168, 4352, 4352, 7340032, 1572864, 32768, 8, 60100608, 114688, 0, 0, 218104017, 0
    .long 2, 64, 72, 7168, 5120, 5120, 7340032, 1572864, 32768, 8, 60112896, 114688, 0, 0, 218104017, 0
    .long 2, 64, 72, 7168, 3840, 3840, 7340032, 1572864, 32768, 8, 60092416, 114688, 0, 0, 218104017, 0
    .long 2, 64, 72, 7168, 3840, 3840, 7340032, 2097152, 32768, 8, 61927424, 114688, 0, 0, 218104081, 0
    .long 2, 64, 72, 7168, 4864, 4864, 7340032, 2097152, 32768, 8, 61943808, 114688, 0, 0, 218104081, 0
    .long 2, 64, 72, 7168, 4096, 4096, 7340032, 524288, 32768, 8, 56426496, 114688, 0, 0, 218103889, 0
    .long 2, 64, 72, 7168, 5120, 5120, 7340032, 2097152, 32768, 8, 61947904, 114688, 0, 0, 218104081, 0
    .long 2, 64, 72, 7168, 4608, 4608, 7340032, 1572864, 32768, 8, 60104704, 114688, 0, 0, 218104017, 0
    .long 2, 64, 72, 7168, 3840, 3840, 7340032, 1048576, 32768, 8, 58257408, 114688, 0, 0, 218103953, 0
    .long 2, 64, 72, 7168, 4608, 4608, 7340032, 1048576, 32768, 8, 58269696, 114688, 0, 0, 218103953, 0
    .long 2, 64, 72, 7168, 4096, 4096, 7340032, 3145728, 32768, 8, 65601536, 114688, 0, 0, 218104209, 0
    .long 2, 64, 72, 7168, 4864, 4864, 7340032, 1048576, 32768, 8, 58273792, 114688, 0, 0, 218103953, 0
    .long 5, 218108240, 0, 0, 20, 0, 0, 12, 0, 0, 0, 0, 218112256, 16, 218106961, 0
    .long 2, 64, 72, 7168, 5120, 5120, 7340032, 1048576, 32768, 8, 58277888, 114688, 0, 0, 218103953, 0
    .long 2, 64, 72, 7168, 4608, 4608, 7340032, 3145728, 32768, 8, 65609728, 114688, 0, 0, 218104209, 0
    .long 2, 64, 72, 7168, 4864, 4864, 7340032, 524288, 32768, 8, 56438784, 114688, 0, 0, 218103889, 0
    .long 2, 64, 72, 7168, 4352, 4352, 7340032, 1048576, 32768, 8, 58265600, 114688, 0, 0, 218103953, 0
    .long 2, 64, 72, 7168, 4096, 4096, 7340032, 1048576, 32768, 8, 58261504, 114688, 0, 0, 218103953, 0
    .long 2, 64, 72, 7168, 3840, 3840, 7340032, 3145728, 32768, 8, 65597440, 114688, 0, 0, 218104209, 0
    .long 5, 218108224, 0, 0, 16, 0, 0, 12, 0, 0, 0, 0, 218112256, 16, 218106961, 0
    .long 2, 64, 72, 7168, 4352, 4352, 7340032, 3670016, 32768, 8, 67440640, 114688, 0, 0, 218104273, 0
    .long 2, 64, 72, 7168, 4608, 4608, 7340032, 524288, 32768, 8, 56434688, 114688, 0, 0, 218103889, 0
    .long 1, 80, 80, 2048, 3670528, 3670784, 7340032, 54583296, 114688, 14, 121643008, 32768, 218103824, 14, 218106370, 0
    .long 1, 40, 40, 2048, 4194304, 4194560, 8388608, 176226304, 131072, 16, 79691776, 32768, 218106896, 8, 218106376, 0
    .long 5, 218108224, 0, 0, 16, 0, 0, 8, 0, 0, 0, 0, 218112256, 12, 218106961, 0
    .long 1, 32, 32, 8192, 4096, 4352, 8388608, 3670016, 32768, 8, 52494336, 131072, 0, 0, 218106186, 0
    .long 1, 16, 16, 8192, 4608, 4864, 8388608, 3670016, 32768, 8, 18948096, 131072, 0, 0, 218106186, 0
    .long 1, 16, 16, 8192, 5120, 5376, 8388608, 3670016, 32768, 8, 18956288, 131072, 0, 0, 218106202, 0
    .long 1, 40, 40, 2048, 4194816, 4195072, 8388608, 182517760, 131072, 16, 81272832, 32768, 218112256, 33, 218106568, 0
    .long 1, 40, 40, 2048, 4194816, 4195072, 8388608, 176226304, 131072, 16, 79699968, 32768, 218106896, 8, 218106376, 0
    .long 2, 64, 72, 7168, 4352, 4352, 7340032, 3145728, 32768, 8, 65605632, 114688, 0, 0, 218104209, 0
    .long 1, 40, 40, 2048, 4194304, 4194560, 8388608, 180420608, 131072, 16, 80740352, 32768, 218112256, 25, 218106504, 0
    .long 1, 40, 40, 2048, 4194816, 4195072, 8388608, 180420608, 131072, 16, 80748544, 32768, 218112256, 25, 218106504, 0
    .long 2, 64, 72, 7168, 4864, 4864, 7340032, 2621440, 32768, 8, 63778816, 114688, 0, 0, 218104145, 0
    .long 1, 40, 40, 2048, 4194304, 4194560, 8388608, 182517760, 131072, 16, 81264640, 32768, 218112256, 33, 218106568, 0
    .long 2, 64, 72, 7168, 3584, 3584, 7340032, 2621440, 32768, 8, 63758336, 114688, 0, 0, 218104145, 0
    .long 1, 80, 80, 2048, 3670016, 3670272, 7340032, 54583296, 114688, 14, 121634816, 32768, 218103824, 14, 218106370, 0
    .long 2, 64, 72, 7168, 5120, 5120, 7340032, 2621440, 32768, 8, 63782912, 114688, 0, 0, 218104145, 0
    .long 2, 64, 72, 7168, 3840, 3840, 7340032, 2621440, 32768, 8, 63762432, 114688, 0, 0, 218104145, 0
    .long 2, 64, 72, 7168, 4096, 4096, 7340032, 3670016, 32768, 8, 67436544, 114688, 0, 0, 218104273, 0
    .long 2, 64, 72, 7168, 4864, 4864, 7340032, 3670016, 32768, 8, 67448832, 114688, 0, 0, 218104273, 0
    .long 1, 40, 40, 2048, 4194304, 4194560, 8388608, 178323456, 131072, 16, 80216064, 32768, 218106960, 8, 218106440, 0
    .long 1, 40, 40, 2048, 4194816, 4195072, 8388608, 178323456, 131072, 16, 80224256, 32768, 218106960, 8, 218106440, 0
    .long 2, 64, 72, 7168, 4352, 4352, 7340032, 2621440, 32768, 8, 63770624, 114688, 0, 0, 218104145, 0
    .long 2, 64, 72, 7168, 3584, 3584, 7340032, 3670016, 32768, 8, 67428352, 114688, 0, 0, 218104273, 0
    .long 2, 64, 72, 7168, 4096, 4096, 7340032, 2621440, 32768, 8, 63766528, 114688, 0, 0, 218104145, 0
    .long 1, 80, 80, 2048, 3670528, 3670784, 7340032, 61923328, 114688, 14, 123740160, 32768, 218104080, 14, 218106626, 0
    .long 1, 80, 80, 2048, 3670016, 3670272, 7340032, 60088320, 114688, 14, 123207680, 32768, 218104016, 14, 218106562, 0
    .long 1, 80, 80, 2048, 3670016, 3670272, 7340032, 61923328, 114688, 14, 123731968, 32768, 218104080, 14, 218106626, 0
    .long 1, 80, 80, 2048, 3670528, 3670784, 7340032, 60088320, 114688, 14, 123215872, 32768, 218104016, 14, 218106562, 0
    .long 2, 64, 72, 7168, 4608, 4608, 7340032, 3670016, 32768, 8, 67444736, 114688, 0, 0, 218104273, 0
    .long 2, 64, 72, 7168, 3840, 3840, 7340032, 3670016, 32768, 8, 67432448, 114688, 0, 0, 218104273, 0
    .long 1, 80, 80, 2048, 3670016, 3670272, 7340032, 58253312, 114688, 14, 122683392, 32768, 218103952, 14, 218106498, 0
    .long 1, 80, 80, 2048, 3670528, 3670784, 7340032, 58253312, 114688, 14, 122691584, 32768, 218103952, 14, 218106498, 0
    .long 2, 64, 72, 7168, 5120, 5120, 7340032, 3670016, 32768, 8, 67452928, 114688, 0, 0, 218104273, 0
    .long 1, 80, 80, 2048, 3670528, 3670784, 7340032, 56418304, 114688, 14, 122167296, 32768, 218103888, 14, 218106434, 0
    .long 1, 80, 80, 2048, 3670016, 3670272, 7340032, 56418304, 114688, 14, 122159104, 32768, 218103888, 14, 218106434, 0
    .long 1, 40, 40, 2048, 4194816, 4195072, 8388608, 184614912, 131072, 8, 85991424, 32768, 218112256, 41, 218106628, 0
    .long 1, 80, 80, 2048, 3670016, 3670272, 7340032, 65593344, 114688, 7, 128974848, 32768, 218104208, 7, 218106753, 0
    .long 1, 80, 80, 2048, 3670528, 3670784, 7340032, 65593344, 114688, 7, 128983040, 32768, 218104208, 7, 218106753, 0
    .long 1, 40, 40, 2048, 4194304, 4194560, 8388608, 184614912, 131072, 8, 85983232, 32768, 218112256, 41, 218106628, 0
    .long 1, 80, 80, 2048, 3671552, 3671808, 7340032, 65593344, 114688, 7, 128999424, 32768, 218104208, 7, 218106753, 0
    .long 1, 40, 40, 2048, 4195328, 4195584, 8388608, 184614912, 131072, 8, 85999616, 32768, 218112256, 41, 218106628, 0
    .long 1, 40, 40, 2048, 4195840, 4196096, 8388608, 184614912, 131072, 8, 86007808, 32768, 218112256, 41, 218106628, 0
    .long 1, 40, 40, 2048, 4194816, 4195072, 8388608, 186712064, 131072, 8, 86515712, 32768, 218112256, 49, 218106692, 0
    .long 1, 80, 80, 2048, 3671040, 3671296, 7340032, 65593344, 114688, 7, 128991232, 32768, 218104208, 7, 218106753, 0
    .long 1, 40, 40, 2048, 4195328, 4195584, 8388608, 186712064, 131072, 8, 86523904, 32768, 218112256, 49, 218106692, 0
    .long 1, 40, 40, 2048, 4194304, 4194560, 8388608, 186712064, 131072, 8, 86507520, 32768, 218112256, 49, 218106692, 0
    .long 1, 40, 40, 2048, 4195840, 4196096, 8388608, 186712064, 131072, 8, 86532096, 32768, 218112256, 49, 218106692, 0
    .long 1, 80, 80, 2048, 3671040, 3671296, 7340032, 63758336, 114688, 7, 128466944, 32768, 218104144, 7, 218106689, 0
    .long 1, 80, 80, 2048, 3671552, 3671808, 7340032, 63758336, 114688, 7, 128475136, 32768, 218104144, 7, 218106689, 0
    .long 1, 80, 80, 2048, 3670016, 3670272, 7340032, 63758336, 114688, 7, 128450560, 32768, 218104144, 7, 218106689, 0
    .long 1, 80, 80, 2048, 3670528, 3670784, 7340032, 63758336, 114688, 7, 128458752, 32768, 218104144, 7, 218106689, 0
    .long 1, 80, 80, 2048, 3670528, 3670784, 7340032, 67428352, 114688, 7, 129507328, 32768, 218104272, 7, 218106817, 0
    .long 1, 80, 80, 2048, 3671040, 3671296, 7340032, 67428352, 114688, 7, 129515520, 32768, 218104272, 7, 218106817, 0
    .long 1, 80, 80, 2048, 3671552, 3671808, 7340032, 67428352, 114688, 7, 129523712, 32768, 218104272, 7, 218106817, 0
    .long 1, 80, 80, 2048, 3670016, 3670272, 7340032, 67428352, 114688, 7, 129499136, 32768, 218104272, 7, 218106817, 0
    .long 6, 1, 0, 2, 2, 16, 0, 3, 0, 0, 0, 0, 0, 0, 0, 0
    .long 6, 0, 0, 0, 2, 0, 0, 51, 0, 0, 0, 0, 0, 0, 0, 0
    .long 6, 1, 0, 2, 2, 16, 0, 1, 0, 0, 0, 0, 0, 0, 0, 0
    .long 6, 1, 0, 2, 2, 16, 0, 0, 0, 0, 0, 0, 0, 0, 0, 0
    .long 6, 1, 0, 2, 2, 16, 0, 5, 0, 0, 0, 0, 0, 0, 0, 0
    .long 6, 1, 0, 2, 2, 16, 0, 4, 0, 0, 0, 0, 0, 0, 0, 0
    .long 6, 1, 0, 2, 2, 16, 0, 22, 0, 0, 0, 0, 0, 0, 0, 0
    .long 6, 1, 0, 2, 2, 16, 0, 6, 0, 0, 0, 0, 0, 0, 0, 0
    .long 6, 1, 0, 2, 2, 16, 0, 18, 0, 0, 0, 0, 0, 0, 0, 0
    .long 6, 1, 0, 2, 2, 16, 0, 19, 0, 0, 0, 0, 0, 0, 0, 0
    .long 6, 1, 0, 2, 2, 16, 0, 20, 0, 0, 0, 0, 0, 0, 0, 0
    .long 6, 1, 0, 2, 2, 16, 0, 7, 0, 0, 0, 0, 0, 0, 0, 0
    .long 6, 1, 0, 2, 2, 16, 0, 2, 0, 0, 0, 0, 0, 0, 0, 0
    .long 6, 1, 0, 2, 2, 16, 0, 17, 0, 0, 0, 0, 0, 0, 0, 0
    .long 6, 1, 0, 2, 2, 16, 0, 21, 0, 0, 0, 0, 0, 0, 0, 0
    .long 6, 1, 0, 2, 2, 16, 0, 16, 0, 0, 0, 0, 0, 0, 0, 0
    .long 6, 0, 0, 0, 2, 0, 0, 50, 0, 0, 0, 0, 0, 0, 0, 0
    .long 6, 0, 0, 0, 2, 0, 0, 52, 0, 0, 0, 0, 0, 0, 0, 0
    .long 6, 0, 0, 0, 2, 0, 0, 54, 0, 0, 0, 0, 0, 0, 0, 0
    .long 6, 0, 0, 0, 2, 0, 0, 49, 0, 0, 0, 0, 0, 0, 0, 0
    .long 6, 0, 0, 0, 2, 0, 0, 48, 0, 0, 0, 0, 0, 0, 0, 0
    .long 6, 0, 0, 0, 2, 0, 0, 53, 0, 0, 0, 0, 0, 0, 0, 0
    .long 6, 0, 0, 0, 2, 0, 0, 55, 0, 0, 0, 0, 0, 0, 0, 0
    .long 6, 0, 0, 0, 2, 0, 0, 56, 0, 0, 0, 0, 0, 0, 0, 0
    .long 6, 1, 0, 2, 2, 16, 0, 23, 0, 0, 0, 0, 0, 0, 0, 0
    .long 6, 1, 0, 2, 2, 16, 0, 24, 0, 0, 0, 0, 0, 0, 0, 0
    .long 6, 1, 0, 2, 2, 16, 0, 25, 0, 0, 0, 0, 0, 0, 0, 0
    .long 6, 1, 0, 2, 2, 16, 0, 26, 0, 0, 0, 0, 0, 0, 0, 0
    .long 6, 1, 0, 2, 2, 16, 0, 27, 0, 0, 0, 0, 0, 0, 0, 0
    .long 6, 1, 0, 2, 2, 16, 0, 28, 0, 0, 0, 0, 0, 0, 0, 0
    .long 6, 1, 0, 2, 2, 16, 0, 29, 0, 0, 0, 0, 0, 0, 0, 0
    .long 6, 1, 0, 2, 2, 16, 0, 30, 0, 0, 0, 0, 0, 0, 0, 0
    .long 6, 1, 0, 2, 2, 16, 0, 31, 0, 0, 0, 0, 0, 0, 0, 0
    .long 6, 0, 0, 1, 2, 16, 0, 40, 0, 0, 0, 0, 0, 0, 0, 0
    .long 6, 0, 0, 1, 2, 16, 0, 41, 0, 0, 0, 0, 0, 0, 0, 0
    .long 6, 0, 0, 1, 2, 16, 0, 43, 0, 0, 0, 0, 0, 0, 0, 0
    .long 6, 0, 0, 1, 2, 16, 0, 45, 0, 0, 0, 0, 0, 0, 0, 0
    .long 6, 0, 0, 1, 2, 16, 0, 46, 0, 0, 0, 0, 0, 0, 0, 0
    .long 6, 0, 0, 1, 2, 16, 0, 47, 0, 0, 0, 0, 0, 0, 0, 0
    .long 6, 1, 0, 1, 2, 16, 0, 32, 0, 0, 0, 0, 0, 0, 0, 0
    .long 6, 1, 0, 1, 2, 16, 0, 33, 0, 0, 0, 0, 0, 0, 0, 0
    .long 6, 1, 0, 1, 2, 16, 0, 35, 0, 0, 0, 0, 0, 0, 0, 0
    .long 6, 1, 0, 1, 2, 16, 0, 36, 0, 0, 0, 0, 0, 0, 0, 0
    .long 6, 1, 0, 1, 2, 16, 0, 38, 0, 0, 0, 0, 0, 0, 0, 0
    .long 6, 1, 0, 1, 2, 16, 0, 39, 0, 0, 0, 0, 0, 0, 0, 0
    .long 6, 0, 0, 0, 2, 0, 0, 57, 0, 0, 0, 0, 0, 0, 0, 0
    .long 6, 0, 0, 1, 2, 16, 0, 44, 0, 0, 0, 0, 0, 0, 0, 0
    .long 6, 1, 0, 1, 2, 16, 0, 34, 0, 0, 0, 0, 0, 0, 0, 0
    .long 6, 0, 0, 0, 2, 0, 0, 58, 0, 0, 0, 0, 0, 0, 0, 0
    .long 6, 1, 0, 1, 2, 16, 0, 37, 0, 0, 0, 0, 0, 0, 0, 0
    .long 6, 0, 0, 1, 2, 16, 0, 42, 0, 0, 0, 0, 0, 0, 0, 0
    .long 6, 0, 0, 0, 2, 0, 0, 59, 0, 0, 0, 0, 0, 0, 0, 0
    .long 6, 1, 0, 2, 2, 16, 0, 8, 0, 0, 0, 0, 0, 0, 0, 0
    .long 6, 1, 0, 2, 2, 16, 0, 9, 0, 0, 0, 0, 0, 0, 0, 0
    .long 6, 1, 0, 2, 2, 16, 0, 10, 0, 0, 0, 0, 0, 0, 0, 0
    .long 6, 1, 0, 2, 2, 16, 0, 11, 0, 0, 0, 0, 0, 0, 0, 0
    .long 6, 1, 0, 2, 2, 16, 0, 12, 0, 0, 0, 0, 0, 0, 0, 0
    .long 6, 1, 0, 2, 2, 16, 0, 13, 0, 0, 0, 0, 0, 0, 0, 0
    .long 6, 1, 0, 2, 2, 16, 0, 14, 0, 0, 0, 0, 0, 0, 0, 0
    .long 6, 1, 0, 2, 2, 16, 0, 15, 0, 0, 0, 0, 0, 0, 0, 0
    .long 7, 0, 0, 0, 8, 0, 0, 60, 0, 0, 0, 0, 0, 0, 0, 0
    .long 7, 0, 0, 0, 9, 0, 0, 60, 0, 0, 0, 0, 0, 0, 0, 0
    .long 7, 0, 0, 0, 10, 0, 0, 60, 0, 0, 0, 0, 0, 0, 0, 0
    .long 7, 0, 0, 0, 11, 0, 0, 60, 0, 0, 0, 0, 0, 0, 0, 0
    .long 7, 0, 0, 0, 8, 0, 0, 61, 0, 0, 0, 0, 0, 0, 0, 0
    .long 7, 0, 0, 0, 9, 0, 0, 61, 0, 0, 0, 0, 0, 0, 0, 0
    .long 7, 0, 0, 0, 10, 0, 0, 61, 0, 0, 0, 0, 0, 0, 0, 0
    .long 7, 0, 0, 0, 11, 0, 0, 61, 0, 0, 0, 0, 0, 0, 0, 0
    .long 7, 0, 0, 0, 8, 0, 0, 62, 0, 0, 0, 0, 0, 0, 0, 0
    .long 7, 0, 0, 0, 9, 0, 0, 62, 0, 0, 0, 0, 0, 0, 0, 0
    .long 7, 0, 0, 0, 10, 0, 0, 62, 0, 0, 0, 0, 0, 0, 0, 0
    .long 7, 0, 0, 0, 11, 0, 0, 62, 0, 0, 0, 0, 0, 0, 0, 0
    .long 7, 0, 0, 0, 8, 0, 0, 63, 0, 0, 0, 0, 0, 0, 0, 0
    .long 7, 0, 0, 0, 9, 0, 0, 63, 0, 0, 0, 0, 0, 0, 0, 0
    .long 7, 0, 0, 0, 10, 0, 0, 63, 0, 0, 0, 0, 0, 0, 0, 0
    .long 7, 0, 0, 0, 11, 0, 0, 63, 0, 0, 0, 0, 0, 0, 0, 0
    .long 0, 0, 0, 0, 0, 0, 0, 0, 0, 0, 0, 0, 0, 0, 0, 0
    .long 4, 24, 24, 8192, 6144, 268288, 8388608, 0, 32768, 4, 21069824, 131072, 0, 0, 218104417, 0
    .long 4, 24, 24, 8192, 6400, 268544, 8388608, 0, 32768, 4, 21073920, 131072, 0, 0, 218104417, 0
    .long 4, 24, 24, 8192, 6656, 268800, 8388608, 0, 32768, 4, 21078016, 131072, 0, 0, 218104417, 0
    .long 4, 24, 24, 8192, 6912, 269056, 8388608, 0, 32768, 4, 21082112, 131072, 0, 0, 218104417, 0
    .long 4, 24, 24, 8192, 7168, 269312, 8388608, 0, 32768, 4, 21086208, 131072, 0, 0, 218104433, 0
    .long 4, 24, 24, 8192, 7424, 269568, 8388608, 0, 32768, 4, 21090304, 131072, 0, 0, 218104433, 0
    .long 4, 24, 24, 8192, 7680, 269824, 8388608, 0, 32768, 4, 21094400, 131072, 0, 0, 218104433, 0
    .long 4, 24, 24, 8192, 7936, 270080, 8388608, 0, 32768, 4, 21098496, 131072, 0, 0, 218104433, 0
    .long 4, 32, 32, 8192, 6144, 268288, 8388608, 0, 32768, 4, 37847040, 131072, 0, 0, 218104417, 0
    .long 4, 32, 32, 8192, 6400, 268544, 8388608, 0, 32768, 4, 37851136, 131072, 0, 0, 218104417, 0
    .long 4, 32, 32, 8192, 6656, 268800, 8388608, 0, 32768, 4, 37855232, 131072, 0, 0, 218104417, 0
    .long 4, 32, 32, 8192, 6912, 269056, 8388608, 0, 32768, 4, 37859328, 131072, 0, 0, 218104417, 0
    .long 4, 32, 32, 8192, 7168, 269312, 8388608, 0, 32768, 4, 37863424, 131072, 0, 0, 218104433, 0
    .long 4, 32, 32, 8192, 7424, 269568, 8388608, 0, 32768, 4, 37867520, 131072, 0, 0, 218104433, 0
    .long 4, 32, 32, 8192, 7680, 269824, 8388608, 0, 32768, 4, 37871616, 131072, 0, 0, 218104433, 0
    .long 4, 32, 32, 8192, 7936, 270080, 8388608, 0, 32768, 4, 37875712, 131072, 0, 0, 218104433, 0
    .long 4, 24, 24, 8192, 6144, 268288, 8388608, 262144, 32768, 4, 22118400, 131072, 0, 0, 218104420, 0
    .long 4, 24, 24, 8192, 6400, 268544, 8388608, 262144, 32768, 4, 22122496, 131072, 0, 0, 218104420, 0
    .long 4, 24, 24, 8192, 6656, 268800, 8388608, 262144, 32768, 4, 22126592, 131072, 0, 0, 218104420, 0
    .long 4, 24, 24, 8192, 6912, 269056, 8388608, 262144, 32768, 4, 22130688, 131072, 0, 0, 218104420, 0
    .long 4, 24, 24, 8192, 7168, 269312, 8388608, 262144, 32768, 4, 22134784, 131072, 0, 0, 218104436, 0
    .long 4, 24, 24, 8192, 7424, 269568, 8388608, 262144, 32768, 4, 22138880, 131072, 0, 0, 218104436, 0
    .long 4, 24, 24, 8192, 7680, 269824, 8388608, 262144, 32768, 4, 22142976, 131072, 0, 0, 218104436, 0
    .long 4, 24, 24, 8192, 7936, 270080, 8388608, 262144, 32768, 4, 22147072, 131072, 0, 0, 218104436, 0
    .long 4, 32, 32, 8192, 6144, 268288, 8388608, 262144, 32768, 4, 38895616, 131072, 0, 0, 218104420, 0
    .long 4, 32, 32, 8192, 6400, 268544, 8388608, 262144, 32768, 4, 38899712, 131072, 0, 0, 218104420, 0
    .long 4, 32, 32, 8192, 6656, 268800, 8388608, 262144, 32768, 4, 38903808, 131072, 0, 0, 218104420, 0
    .long 4, 32, 32, 8192, 6912, 269056, 8388608, 262144, 32768, 4, 38907904, 131072, 0, 0, 218104420, 0
    .long 4, 32, 32, 8192, 7168, 269312, 8388608, 262144, 32768, 4, 38912000, 131072, 0, 0, 218104436, 0
    .long 4, 32, 32, 8192, 7424, 269568, 8388608, 262144, 32768, 4, 38916096, 131072, 0, 0, 218104436, 0
    .long 4, 32, 32, 8192, 7680, 269824, 8388608, 262144, 32768, 4, 38920192, 131072, 0, 0, 218104436, 0
    .long 4, 32, 32, 8192, 7936, 270080, 8388608, 262144, 32768, 4, 38924288, 131072, 0, 0, 218104436, 0
    .long 4, 32, 32, 8192, 6400, 268544, 8388608, 786432, 32768, 4, 40996864, 131072, 0, 0, 218104676, 0
    .long 4, 24, 24, 8192, 6656, 268800, 8388608, 786432, 32768, 4, 24223744, 131072, 0, 0, 218104676, 0
    .long 4, 24, 24, 8192, 7680, 269824, 8388608, 786432, 32768, 4, 24240128, 131072, 0, 0, 218104692, 0
    .long 4, 32, 32, 8192, 6912, 269056, 8388608, 524288, 32768, 4, 39956480, 131072, 0, 0, 218104673, 0
    .long 4, 32, 32, 8192, 7680, 269824, 8388608, 786432, 32768, 4, 41017344, 131072, 0, 0, 218104692, 0
    .long 4, 32, 32, 8192, 7424, 269568, 8388608, 524288, 32768, 4, 39964672, 131072, 0, 0, 218104689, 0
    .long 4, 24, 24, 8192, 7168, 269312, 8388608, 786432, 32768, 4, 24231936, 131072, 0, 0, 218104692, 0
    .long 4, 32, 32, 8192, 7936, 270080, 8388608, 524288, 32768, 4, 39972864, 131072, 0, 0, 218104689, 0
    .long 4, 32, 32, 8192, 6656, 268800, 8388608, 786432, 32768, 4, 41000960, 131072, 0, 0, 218104676, 0
    .long 4, 32, 32, 8192, 6656, 268800, 8388608, 524288, 32768, 4, 39952384, 131072, 0, 0, 218104673, 0
    .long 4, 32, 32, 8192, 7168, 269312, 8388608, 786432, 32768, 4, 41009152, 131072, 0, 0, 218104692, 0
    .long 4, 24, 24, 8192, 6912, 269056, 8388608, 524288, 32768, 4, 23179264, 131072, 0, 0, 218104673, 0
    .long 2, 64, 72, 7168, 5376, 5376, 7340032, 1048576, 32768, 8, 58281984, 114688, 0, 0, 218103953, 0
    .long 4, 24, 24, 8192, 6400, 268544, 8388608, 786432, 32768, 4, 24219648, 131072, 0, 0, 218104676, 0
    .long 4, 24, 24, 8192, 7424, 269568, 8388608, 524288, 32768, 4, 23187456, 131072, 0, 0, 218104689, 0
    .long 4, 32, 32, 8192, 6400, 268544, 8388608, 524288, 32768, 4, 39948288, 131072, 0, 0, 218104673, 0
    .long 4, 32, 32, 8192, 7936, 270080, 8388608, 786432, 32768, 4, 41021440, 131072, 0, 0, 218104692, 0
    .long 4, 24, 24, 8192, 6144, 268288, 8388608, 524288, 32768, 4, 23166976, 131072, 0, 0, 218104673, 0
    .long 4, 24, 24, 8192, 7680, 269824, 8388608, 524288, 32768, 4, 23191552, 131072, 0, 0, 218104689, 0
    .long 4, 32, 32, 8192, 6144, 268288, 8388608, 524288, 32768, 4, 39944192, 131072, 0, 0, 218104673, 0
    .long 4, 24, 24, 8192, 7936, 270080, 8388608, 524288, 32768, 4, 23195648, 131072, 0, 0, 218104689, 0
    .long 4, 32, 32, 8192, 6144, 268288, 8388608, 786432, 32768, 4, 40992768, 131072, 0, 0, 218104676, 0
    .long 4, 24, 24, 8192, 6912, 269056, 8388608, 786432, 32768, 4, 24227840, 131072, 0, 0, 218104676, 0
    .long 4, 32, 32, 8192, 6912, 269056, 8388608, 786432, 32768, 4, 41005056, 131072, 0, 0, 218104676, 0
    .long 4, 32, 32, 8192, 7680, 269824, 8388608, 524288, 32768, 4, 39968768, 131072, 0, 0, 218104689, 0
    .long 4, 24, 24, 8192, 7168, 269312, 8388608, 524288, 32768, 4, 23183360, 131072, 0, 0, 218104689, 0
    .long 4, 32, 32, 8192, 7424, 269568, 8388608, 786432, 32768, 4, 41013248, 131072, 0, 0, 218104692, 0
    .long 4, 24, 24, 8192, 6400, 268544, 8388608, 524288, 32768, 4, 23171072, 131072, 0, 0, 218104673, 0
    .long 4, 32, 32, 8192, 7168, 269312, 8388608, 524288, 32768, 4, 39960576, 131072, 0, 0, 218104689, 0
    .long 4, 24, 24, 8192, 6656, 268800, 8388608, 524288, 32768, 4, 23175168, 131072, 0, 0, 218104673, 0
    .long 4, 24, 24, 8192, 7424, 269568, 8388608, 786432, 32768, 4, 24236032, 131072, 0, 0, 218104692, 0
    .long 4, 24, 24, 8192, 6144, 268288, 8388608, 786432, 32768, 4, 24215552, 131072, 0, 0, 218104676, 0
    .long 1, 32, 32, 8192, 7168, 7424, 8388608, 1048576, 32768, 8, 42057728, 131072, 0, 0, 218104954, 0
    .long 1, 24, 24, 8192, 6656, 6912, 8388608, 1048576, 32768, 8, 25272320, 131072, 0, 0, 218104938, 0
    .long 1, 16, 16, 8192, 6656, 6912, 8388608, 1048576, 32768, 8, 8495104, 131072, 0, 0, 218104938, 0
    .long 1, 24, 24, 8192, 7168, 7424, 8388608, 1048576, 32768, 8, 25280512, 131072, 0, 0, 218104954, 0
    .long 4, 24, 24, 8192, 7936, 270080, 8388608, 786432, 32768, 4, 24244224, 131072, 0, 0, 218104692, 0
    .long 1, 16, 16, 8192, 6144, 6400, 8388608, 1048576, 32768, 8, 8486912, 131072, 0, 0, 218104938, 0
    .long 1, 24, 24, 8192, 6656, 6912, 8388608, 1572864, 32768, 8, 27369472, 131072, 0, 0, 218105194, 0
    .long 1, 32, 32, 8192, 7168, 7424, 8388608, 1572864, 32768, 8, 44154880, 131072, 0, 0, 218105210, 0
    .long 1, 24, 24, 8192, 6144, 6400, 8388608, 1048576, 32768, 8, 25264128, 131072, 0, 0, 218104938, 0
    .long 1, 32, 32, 8192, 6656, 6912, 8388608, 1048576, 32768, 8, 42049536, 131072, 0, 0, 218104938, 0
    .long 1, 16, 16, 8192, 7680, 7936, 8388608, 1572864, 32768, 8, 10608640, 131072, 0, 0, 218105210, 0
    .long 1, 16, 16, 8192, 6144, 6400, 8388608, 0, 32768, 8, 4292608, 131072, 0, 0, 218108010, 0
    .long 1, 24, 24, 8192, 7168, 7424, 8388608, 1572864, 32768, 8, 27377664, 131072, 0, 0, 218105210, 0
    .long 1, 32, 32, 8192, 7680, 7936, 8388608, 1572864, 32768, 8, 44163072, 131072, 0, 0, 218105210, 0
    .long 1, 32, 32, 8192, 6144, 6400, 8388608, 1048576, 32768, 8, 42041344, 131072, 0, 0, 218104938, 0
    .long 1, 16, 16, 8192, 7168, 7424, 8388608, 1572864, 32768, 8, 10600448, 131072, 0, 0, 218105210, 0
    .long 1, 32, 32, 8192, 7680, 7936, 8388608, 1048576, 32768, 8, 42065920, 131072, 0, 0, 218104954, 0
    .long 1, 24, 24, 8192, 7680, 7936, 8388608, 1572864, 32768, 8, 27385856, 131072, 0, 0, 218105210, 0
    .long 1, 16, 16, 8192, 7680, 7936, 8388608, 1048576, 32768, 8, 8511488, 131072, 0, 0, 218104954, 0
    .long 1, 32, 32, 8192, 6144, 6400, 8388608, 1572864, 32768, 8, 44138496, 131072, 0, 0, 218105194, 0
    .long 1, 16, 16, 8192, 7680, 7936, 8388608, 0, 32768, 8, 4317184, 131072, 0, 0, 218108026, 0
    .long 1, 16, 16, 8192, 6656, 6912, 8388608, 2097152, 32768, 8, 12689408, 131072, 0, 0, 218105450, 0
    .long 1, 16, 16, 8192, 7168, 7424, 8388608, 1048576, 32768, 8, 8503296, 131072, 0, 0, 218104954, 0
    .long 1, 16, 16, 8192, 6144, 6400, 8388608, 1572864, 32768, 8, 10584064, 131072, 0, 0, 218105194, 0
    .long 1, 32, 32, 8192, 6144, 6400, 8388608, 2097152, 32768, 8, 46235648, 131072, 0, 0, 218105450, 0
    .long 1, 16, 16, 8192, 6656, 6912, 8388608, 0, 32768, 8, 4300800, 131072, 0, 0, 218108010, 0
    .long 1, 24, 24, 8192, 7680, 7936, 8388608, 1048576, 32768, 8, 25288704, 131072, 0, 0, 218104954, 0
    .long 1, 16, 16, 8192, 6656, 6912, 8388608, 1572864, 32768, 8, 10592256, 131072, 0, 0, 218105194, 0
    .long 1, 16, 16, 8192, 7168, 7424, 8388608, 0, 32768, 8, 4308992, 131072, 0, 0, 218108026, 0
    .long 1, 32, 32, 8192, 6656, 6912, 8388608, 2097152, 32768, 8, 46243840, 131072, 0, 0, 218105450, 0
    .long 1, 32, 32, 8192, 6656, 6912, 8388608, 1572864, 32768, 8, 44146688, 131072, 0, 0, 218105194, 0
    .long 1, 24, 24, 8192, 6144, 6400, 8388608, 1572864, 32768, 8, 27361280, 131072, 0, 0, 218105194, 0
    .long 1, 16, 16, 8192, 6144, 6400, 8388608, 524288, 32768, 8, 6389760, 131072, 0, 0, 218108266, 0
    .long 1, 32, 32, 8192, 7168, 7424, 8388608, 3670016, 32768, 8, 52543488, 131072, 0, 0, 218106234, 0
    .long 1, 16, 16, 8192, 7168, 7424, 8388608, 2621440, 32768, 8, 14794752, 131072, 0, 0, 218105722, 0
    .long 1, 24, 24, 8192, 6656, 6912, 8388608, 3145728, 32768, 8, 33660928, 131072, 0, 0, 218105962, 0
    .long 1, 16, 16, 8192, 6144, 6400, 8388608, 2621440, 32768, 8, 14778368, 131072, 0, 0, 218105706, 0
    .long 1, 32, 32, 8192, 7680, 7936, 8388608, 3670016, 32768, 8, 52551680, 131072, 0, 0, 218106234, 0
    .long 1, 16, 16, 8192, 6144, 6400, 8388608, 3145728, 32768, 8, 16875520, 131072, 0, 0, 218105962, 0
    .long 1, 24, 24, 8192, 7168, 7424, 8388608, 2097152, 32768, 8, 29474816, 131072, 0, 0, 218105466, 0
    .long 1, 16, 16, 8192, 7680, 7936, 8388608, 2097152, 32768, 8, 12705792, 131072, 0, 0, 218105466, 0
    .long 1, 24, 24, 8192, 6656, 6912, 8388608, 3670016, 32768, 8, 35758080, 131072, 0, 0, 218106218, 0
    .long 1, 24, 24, 8192, 7680, 7936, 8388608, 3145728, 32768, 8, 33677312, 131072, 0, 0, 218105978, 0
    .long 1, 32, 32, 8192, 7680, 7936, 8388608, 2621440, 32768, 8, 48357376, 131072, 0, 0, 218105722, 0
    .long 1, 32, 32, 8192, 7680, 7936, 8388608, 2097152, 32768, 8, 46260224, 131072, 0, 0, 218105466, 0
    .long 1, 24, 24, 8192, 7680, 7936, 8388608, 2097152, 32768, 8, 29483008, 131072, 0, 0, 218105466, 0
    .long 1, 24, 24, 8192, 6144, 6400, 8388608, 2097152, 32768, 8, 29458432, 131072, 0, 0, 218105450, 0
    .long 1, 32, 32, 8192, 7680, 7936, 8388608, 3145728, 32768, 8, 50454528, 131072, 0, 0, 218105978, 0
    .long 1, 32, 32, 8192, 6144, 6400, 8388608, 3145728, 32768, 8, 50429952, 131072, 0, 0, 218105962, 0
    .long 1, 16, 16, 8192, 7168, 7424, 8388608, 3145728, 32768, 8, 16891904, 131072, 0, 0, 218105978, 0
    .long 1, 16, 16, 8192, 7168, 7424, 8388608, 2097152, 32768, 8, 12697600, 131072, 0, 0, 218105466, 0
    .long 5, 218108016, 0, 0, 28, 0, 0, 0, 0, 0, 0, 0, 218112384, 4, 218106897, 0
    .long 1, 32, 32, 8192, 7168, 7424, 8388608, 3145728, 32768, 8, 50446336, 131072, 0, 0, 218105978, 0
    .long 1, 24, 24, 8192, 7680, 7936, 8388608, 3670016, 32768, 8, 35774464, 131072, 0, 0, 218106234, 0
    .long 1, 32, 32, 8192, 6144, 6400, 8388608, 2621440, 32768, 8, 48332800, 131072, 0, 0, 218105706, 0
    .long 1, 32, 32, 8192, 7168, 7424, 8388608, 2097152, 32768, 8, 46252032, 131072, 0, 0, 218105466, 0
    .long 1, 24, 24, 8192, 6656, 6912, 8388608, 2621440, 32768, 8, 31563776, 131072, 0, 0, 218105706, 0
    .long 1, 24, 24, 8192, 6656, 6912, 8388608, 2097152, 32768, 8, 29466624, 131072, 0, 0, 218105450, 0
    .long 1, 16, 16, 8192, 7680, 7936, 8388608, 524288, 32768, 8, 6414336, 131072, 0, 0, 218108282, 0
    .long 1, 32, 32, 8192, 7168, 7424, 8388608, 2621440, 32768, 8, 48349184, 131072, 0, 0, 218105722, 0
    .long 1, 16, 16, 8192, 7168, 7424, 8388608, 524288, 32768, 8, 6406144, 131072, 0, 0, 218108282, 0
    .long 1, 24, 24, 8192, 6144, 6400, 8388608, 2621440, 32768, 8, 31555584, 131072, 0, 0, 218105706, 0
    .long 1, 16, 16, 8192, 6144, 6400, 8388608, 2097152, 32768, 8, 12681216, 131072, 0, 0, 218105450, 0
    .long 5, 218108016, 0, 0, 28, 0, 0, 4, 0, 0, 0, 0, 218112384, 8, 218106897, 0
    .long 5, 218108000, 0, 0, 24, 0, 0, 0, 0, 0, 0, 0, 218112384, 4, 218106897, 0
    .long 1, 24, 24, 8192, 7168, 7424, 8388608, 3670016, 32768, 8, 35766272, 131072, 0, 0, 218106234, 0
    .long 2, 64, 72, 7168, 5376, 5376, 7340032, 2097152, 32768, 8, 61952000, 114688, 0, 0, 218104081, 0
    .long 1, 24, 24, 8192, 7680, 7936, 8388608, 2621440, 32768, 8, 31580160, 131072, 0, 0, 218105722, 0
    .long 2, 64, 72, 7168, 5632, 5632, 7340032, 0, 32768, 8, 54616064, 114688, 0, 0, 218103825, 0
    .long 1, 24, 24, 8192, 6144, 6400, 8388608, 3670016, 32768, 8, 35749888, 131072, 0, 0, 218106218, 0
    .long 1, 32, 32, 8192, 6656, 6912, 8388608, 3670016, 32768, 8, 52535296, 131072, 0, 0, 218106218, 0
    .long 2, 64, 72, 7168, 6400, 6400, 7340032, 2621440, 32768, 8, 63803392, 114688, 0, 0, 218104148, 0
    .long 1, 32, 32, 8192, 6656, 6912, 8388608, 2621440, 32768, 8, 48340992, 131072, 0, 0, 218105706, 0
    .long 1, 16, 16, 8192, 6656, 6912, 8388608, 2621440, 32768, 8, 14786560, 131072, 0, 0, 218105706, 0
    .long 2, 64, 72, 7168, 5376, 5376, 7340032, 0, 32768, 8, 54611968, 114688, 0, 0, 218103825, 0
    .long 1, 16, 16, 8192, 7680, 7936, 8388608, 3145728, 32768, 8, 16900096, 131072, 0, 0, 218105978, 0
    .long 1, 24, 24, 8192, 7168, 7424, 8388608, 2621440, 32768, 8, 31571968, 131072, 0, 0, 218105722, 0
    .long 2, 64, 72, 7168, 5632, 5632, 7340032, 524288, 32768, 8, 56451072, 114688, 0, 0, 218103889, 0
    .long 1, 24, 24, 8192, 6144, 6400, 8388608, 3145728, 32768, 8, 33652736, 131072, 0, 0, 218105962, 0
    .long 2, 64, 72, 7168, 6144, 6144, 7340032, 0, 32768, 8, 54624256, 114688, 0, 0, 218103825, 0
    .long 2, 64, 72, 7168, 6144, 6144, 7340032, 524288, 32768, 8, 56459264, 114688, 0, 0, 218103889, 0
    .long 2, 64, 72, 7168, 5888, 5888, 7340032, 2097152, 32768, 8, 61960192, 114688, 0, 0, 218104081, 0
    .long 2, 64, 72, 7168, 6400, 6400, 7340032, 2097152, 32768, 8, 61968384, 114688, 0, 0, 218104081, 0
    .long 1, 16, 16, 8192, 6656, 6912, 8388608, 524288, 32768, 8, 6397952, 131072, 0, 0, 218108266, 0
    .long 1, 16, 16, 8192, 6656, 6912, 8388608, 3145728, 32768, 8, 16883712, 131072, 0, 0, 218105962, 0
    .long 2, 64, 72, 7168, 6400, 6400, 7340032, 0, 32768, 8, 54628352, 114688, 0, 0, 218103825, 0
    .long 2, 64, 72, 7168, 6656, 6656, 7340032, 0, 32768, 8, 54632448, 114688, 0, 0, 218103825, 0
    .long 1, 16, 16, 8192, 7680, 7936, 8388608, 2621440, 32768, 8, 14802944, 131072, 0, 0, 218105722, 0
    .long 1, 24, 24, 8192, 7168, 7424, 8388608, 3145728, 32768, 8, 33669120, 131072, 0, 0, 218105978, 0
    .long 2, 64, 72, 7168, 6656, 6656, 7340032, 3145728, 32768, 8, 65642496, 114688, 0, 0, 218104212, 0
    .long 1, 32, 32, 8192, 6656, 6912, 8388608, 3145728, 32768, 8, 50438144, 131072, 0, 0, 218105962, 0
    .long 1, 16, 16, 8192, 7680, 7936, 8388608, 3670016, 32768, 8, 18997248, 131072, 0, 0, 218106234, 0
    .long 2, 64, 72, 7168, 6912, 6912, 7340032, 0, 32768, 8, 54636544, 114688, 0, 0, 218103825, 0
    .long 2, 64, 72, 7168, 5888, 5888, 7340032, 0, 32768, 8, 54620160, 114688, 0, 0, 218103825, 0
    .long 5, 218108000, 0, 0, 24, 0, 0, 4, 0, 0, 0, 0, 218112384, 8, 218106897, 0
    .long 2, 64, 72, 7168, 6912, 6912, 7340032, 3145728, 32768, 8, 65646592, 114688, 0, 0, 218104212, 0
    .long 2, 64, 72, 7168, 5376, 5376, 7340032, 524288, 32768, 8, 56446976, 114688, 0, 0, 218103889, 0
    .long 2, 64, 72, 7168, 6656, 6656, 7340032, 1572864, 32768, 8, 60137472, 114688, 0, 0, 218104017, 0
    .long 2, 64, 72, 7168, 6912, 6912, 7340032, 524288, 32768, 8, 56471552, 114688, 0, 0, 218103889, 0
    .long 1, 16, 16, 8192, 6144, 6400, 8388608, 3670016, 32768, 8, 18972672, 131072, 0, 0, 218106218, 0
    .long 5, 218108272, 0, 0, 28, 0, 0, 8, 0, 0, 0, 0, 218112384, 12, 218106961, 0
    .long 2, 64, 72, 7168, 5376, 5376, 7340032, 3145728, 32768, 8, 65622016, 114688, 0, 0, 218104212, 0
    .long 2, 64, 72, 7168, 5888, 5888, 7340032, 1572864, 32768, 8, 60125184, 114688, 0, 0, 218104017, 0
    .long 2, 64, 72, 7168, 6144, 6144, 7340032, 2097152, 32768, 8, 61964288, 114688, 0, 0, 218104081, 0
    .long 2, 64, 72, 7168, 5376, 5376, 7340032, 1572864, 32768, 8, 60116992, 114688, 0, 0, 218104017, 0
    .long 2, 64, 72, 7168, 6144, 6144, 7340032, 1572864, 32768, 8, 60129280, 114688, 0, 0, 218104017, 0
    .long 2, 64, 72, 7168, 6912, 6912, 7340032, 1572864, 32768, 8, 60141568, 114688, 0, 0, 218104017, 0
    .long 2, 64, 72, 7168, 5632, 5632, 7340032, 1572864, 32768, 8, 60121088, 114688, 0, 0, 218104017, 0
    .long 2, 64, 72, 7168, 5632, 5632, 7340032, 2097152, 32768, 8, 61956096, 114688, 0, 0, 218104081, 0
    .long 2, 64, 72, 7168, 6656, 6656, 7340032, 2097152, 32768, 8, 61972480, 114688, 0, 0, 218104081, 0
    .long 2, 64, 72, 7168, 5888, 5888, 7340032, 524288, 32768, 8, 56455168, 114688, 0, 0, 218103889, 0
    .long 2, 64, 72, 7168, 6912, 6912, 7340032, 2097152, 32768, 8, 61976576, 114688, 0, 0, 218104081, 0
    .long 2, 64, 72, 7168, 6400, 6400, 7340032, 1572864, 32768, 8, 60133376, 114688, 0, 0, 218104017, 0
    .long 2, 64, 72, 7168, 5632, 5632, 7340032, 1048576, 32768, 8, 58286080, 114688, 0, 0, 218103953, 0
    .long 2, 64, 72, 7168, 6400, 6400, 7340032, 1048576, 32768, 8, 58298368, 114688, 0, 0, 218103953, 0
    .long 2, 64, 72, 7168, 5888, 5888, 7340032, 3145728, 32768, 8, 65630208, 114688, 0, 0, 218104212, 0
    .long 2, 64, 72, 7168, 6656, 6656, 7340032, 1048576, 32768, 8, 58302464, 114688, 0, 0, 218103953, 0
    .long 5, 218108272, 0, 0, 28, 0, 0, 12, 0, 0, 0, 0, 218112384, 16, 218106961, 0
    .long 2, 64, 72, 7168, 6912, 6912, 7340032, 1048576, 32768, 8, 58306560, 114688, 0, 0, 218103953, 0
    .long 2, 64, 72, 7168, 6400, 6400, 7340032, 3145728, 32768, 8, 65638400, 114688, 0, 0, 218104212, 0
    .long 2, 64, 72, 7168, 6656, 6656, 7340032, 524288, 32768, 8, 56467456, 114688, 0, 0, 218103889, 0
    .long 2, 64, 72, 7168, 6144, 6144, 7340032, 1048576, 32768, 8, 58294272, 114688, 0, 0, 218103953, 0
    .long 2, 64, 72, 7168, 5888, 5888, 7340032, 1048576, 32768, 8, 58290176, 114688, 0, 0, 218103953, 0
    .long 2, 64, 72, 7168, 5632, 5632, 7340032, 3145728, 32768, 8, 65626112, 114688, 0, 0, 218104212, 0
    .long 5, 218108256, 0, 0, 24, 0, 0, 12, 0, 0, 0, 0, 218112384, 16, 218106961, 0
    .long 2, 64, 72, 7168, 6144, 6144, 7340032, 3670016, 32768, 8, 67469312, 114688, 0, 0, 218104276, 0
    .long 2, 64, 72, 7168, 6400, 6400, 7340032, 524288, 32768, 8, 56463360, 114688, 0, 0, 218103889, 0
    .long 1, 80, 80, 2048, 3671552, 3671808, 7340032, 54583296, 114688, 14, 121659392, 32768, 218103824, 14, 218106370, 0
    .long 1, 40, 40, 2048, 4195328, 4195584, 8388608, 176226304, 131072, 16, 79708160, 32768, 218106896, 8, 218106376, 0
    .long 5, 218108256, 0, 0, 24, 0, 0, 8, 0, 0, 0, 0, 218112384, 12, 218106961, 0
    .long 1, 32, 32, 8192, 6144, 6400, 8388608, 3670016, 32768, 8, 52527104, 131072, 0, 0, 218106218, 0
    .long 1, 16, 16, 8192, 6656, 6912, 8388608, 3670016, 32768, 8, 18980864, 131072, 0, 0, 218106218, 0
    .long 1, 16, 16, 8192, 7168, 7424, 8388608, 3670016, 32768, 8, 18989056, 131072, 0, 0, 218106234, 0
    .long 1, 40, 40, 2048, 4195840, 4196096, 8388608, 182517760, 131072, 16, 81289216, 32768, 218112384, 33, 218106568, 0
    .long 1, 40, 40, 2048, 4195840, 4196096, 8388608, 176226304, 131072, 16, 79716352, 32768, 218106896, 8, 218106376, 0
    .long 2, 64, 72, 7168, 6144, 6144, 7340032, 3145728, 32768, 8, 65634304, 114688, 0, 0, 218104212, 0
    .long 1, 40, 40, 2048, 4195328, 4195584, 8388608, 180420608, 131072, 16, 80756736, 32768, 218112384, 25, 218106504, 0
    .long 1, 40, 40, 2048, 4195840, 4196096, 8388608, 180420608, 131072, 16, 80764928, 32768, 218112384, 25, 218106504, 0
    .long 2, 64, 72, 7168, 6656, 6656, 7340032, 2621440, 32768, 8, 63807488, 114688, 0, 0, 218104148, 0
    .long 1, 40, 40, 2048, 4195328, 4195584, 8388608, 182517760, 131072, 16, 81281024, 32768, 218112384, 33, 218106568, 0
    .long 2, 64, 72, 7168, 5376, 5376, 7340032, 2621440, 32768, 8, 63787008, 114688, 0, 0, 218104148, 0
    .long 1, 80, 80, 2048, 3671040, 3671296, 7340032, 54583296, 114688, 14, 121651200, 32768, 218103824, 14, 218106370, 0
    .long 2, 64, 72, 7168, 6912, 6912, 7340032, 2621440, 32768, 8, 63811584, 114688, 0, 0, 218104148, 0
    .long 2, 64, 72, 7168, 5632, 5632, 7340032, 2621440, 32768, 8, 63791104, 114688, 0, 0, 218104148, 0
    .long 2, 64, 72, 7168, 5888, 5888, 7340032, 3670016, 32768, 8, 67465216, 114688, 0, 0, 218104276, 0
    .long 2, 64, 72, 7168, 6656, 6656, 7340032, 3670016, 32768, 8, 67477504, 114688, 0, 0, 218104276, 0
    .long 1, 40, 40, 2048, 4195328, 4195584, 8388608, 178323456, 131072, 16, 80232448, 32768, 218106960, 8, 218106440, 0
    .long 1, 40, 40, 2048, 4195840, 4196096, 8388608, 178323456, 131072, 16, 80240640, 32768, 218106960, 8, 218106440, 0
    .long 2, 64, 72, 7168, 6144, 6144, 7340032, 2621440, 32768, 8, 63799296, 114688, 0, 0, 218104148, 0
    .long 2, 64, 72, 7168, 5376, 5376, 7340032, 3670016, 32768, 8, 67457024, 114688, 0, 0, 218104276, 0
    .long 2, 64, 72, 7168, 5888, 5888, 7340032, 2621440, 32768, 8, 63795200, 114688, 0, 0, 218104148, 0
    .long 1, 80, 80, 2048, 3671552, 3671808, 7340032, 61923328, 114688, 14, 123756544, 32768, 218104080, 14, 218106626, 0
    .long 1, 80, 80, 2048, 3671040, 3671296, 7340032, 60088320, 114688, 14, 123224064, 32768, 218104016, 14, 218106562, 0
    .long 1, 80, 80, 2048, 3671040, 3671296, 7340032, 61923328, 114688, 14, 123748352, 32768, 218104080, 14, 218106626, 0
    .long 1, 80, 80, 2048, 3671552, 3671808, 7340032, 60088320, 114688, 14, 123232256, 32768, 218104016, 14, 218106562, 0
    .long 2, 64, 72, 7168, 6400, 6400, 7340032, 3670016, 32768, 8, 67473408, 114688, 0, 0, 218104276, 0
    .long 2, 64, 72, 7168, 5632, 5632, 7340032, 3670016, 32768, 8, 67461120, 114688, 0, 0, 218104276, 0
    .long 1, 80, 80, 2048, 3671040, 3671296, 7340032, 58253312, 114688, 14, 122699776, 32768, 218103952, 14, 218106498, 0
    .long 1, 80, 80, 2048, 3671552, 3671808, 7340032, 58253312, 114688, 14, 122707968, 32768, 218103952, 14, 218106498, 0
    .long 2, 64, 72, 7168, 6912, 6912, 7340032, 3670016, 32768, 8, 67481600, 114688, 0, 0, 218104276, 0
    .long 1, 80, 80, 2048, 3671552, 3671808, 7340032, 56418304, 114688, 14, 122183680, 32768, 218103888, 14, 218106434, 0
    .long 1, 80, 80, 2048, 3671040, 3671296, 7340032, 56418304, 114688, 14, 122175488, 32768, 218103888, 14, 218106434, 0
    .long 1, 40, 40, 2048, 6291968, 6292224, 8388608, 184647680, 131072, 8, 90185728, 32768, 218112384, 41, 218106628, 0
    .long 1, 80, 80, 2048, 5505024, 5505280, 7340032, 65622016, 114688, 7, 133169152, 32768, 218104212, 7, 218106753, 0
    .long 1, 80, 80, 2048, 5505536, 5505792, 7340032, 65622016, 114688, 7, 133177344, 32768, 218104212, 7, 218106753, 0
    .long 1, 40, 40, 2048, 6291456, 6291712, 8388608, 184647680, 131072, 8, 90177536, 32768, 218112384, 41, 218106628, 0
    .long 1, 80, 80, 2048, 5506560, 5506816, 7340032, 65622016, 114688, 7, 133193728, 32768, 218104212, 7, 218106753, 0
    .long 1, 40, 40, 2048, 6292480, 6292736, 8388608, 184647680, 131072, 8, 90193920, 32768, 218112384, 41, 218106628, 0
    .long 1, 40, 40, 2048, 6292992, 6293248, 8388608, 184647680, 131072, 8, 90202112, 32768, 218112384, 41, 218106628, 0
    .long 1, 40, 40, 2048, 6291968, 6292224, 8388608, 186744832, 131072, 8, 90710016, 32768, 218112384, 49, 218106692, 0
    .long 1, 80, 80, 2048, 5506048, 5506304, 7340032, 65622016, 114688, 7, 133185536, 32768, 218104212, 7, 218106753, 0
    .long 1, 40, 40, 2048, 6292480, 6292736, 8388608, 186744832, 131072, 8, 90718208, 32768, 218112384, 49, 218106692, 0
    .long 1, 40, 40, 2048, 6291456, 6291712, 8388608, 186744832, 131072, 8, 90701824, 32768, 218112384, 49, 218106692, 0
    .long 1, 40, 40, 2048, 6292992, 6293248, 8388608, 186744832, 131072, 8, 90726400, 32768, 218112384, 49, 218106692, 0
    .long 1, 80, 80, 2048, 5506048, 5506304, 7340032, 63787008, 114688, 7, 132661248, 32768, 218104148, 7, 218106689, 0
    .long 1, 80, 80, 2048, 5506560, 5506816, 7340032, 63787008, 114688, 7, 132669440, 32768, 218104148, 7, 218106689, 0
    .long 1, 80, 80, 2048, 5505024, 5505280, 7340032, 63787008, 114688, 7, 132644864, 32768, 218104148, 7, 218106689, 0
    .long 1, 80, 80, 2048, 5505536, 5505792, 7340032, 63787008, 114688, 7, 132653056, 32768, 218104148, 7, 218106689, 0
    .long 1, 80, 80, 2048, 5505536, 5505792, 7340032, 67457024, 114688, 7, 133701632, 32768, 218104276, 7, 218106817, 0
    .long 1, 80, 80, 2048, 5506048, 5506304, 7340032, 67457024, 114688, 7, 133709824, 32768, 218104276, 7, 218106817, 0
    .long 1, 80, 80, 2048, 5506560, 5506816, 7340032, 67457024, 114688, 7, 133718016, 32768, 218104276, 7, 218106817, 0
    .long 1, 80, 80, 2048, 5505024, 5505280, 7340032, 67457024, 114688, 7, 133693440, 32768, 218104276, 7, 218106817, 0
    .long 6, 1, 0, 2, 3, 16, 0, 3, 0, 0, 0, 0, 0, 0, 0, 0
    .long 6, 0, 0, 0, 3, 0, 0, 51, 0, 0, 0, 0, 0, 0, 0, 0
    .long 6, 1, 0, 2, 3, 16, 0, 1, 0, 0, 0, 0, 0, 0, 0, 0
    .long 6, 1, 0, 2, 3, 16, 0, 0, 0, 0, 0, 0, 0, 0, 0, 0
    .long 6, 1, 0, 2, 3, 16, 0, 5, 0, 0, 0, 0, 0, 0, 0, 0
    .long 6, 1, 0, 2, 3, 16, 0, 4, 0, 0, 0, 0, 0, 0, 0, 0
    .long 6, 1, 0, 2, 3, 16, 0, 22, 0, 0, 0, 0, 0, 0, 0, 0
    .long 6, 1, 0, 2, 3, 16, 0, 6, 0, 0, 0, 0, 0, 0, 0, 0
    .long 6, 1, 0, 2, 3, 16, 0, 18, 0, 0, 0, 0, 0, 0, 0, 0
    .long 6, 1, 0, 2, 3, 16, 0, 19, 0, 0, 0, 0, 0, 0, 0, 0
    .long 6, 1, 0, 2, 3, 16, 0, 20, 0, 0, 0, 0, 0, 0, 0, 0
    .long 6, 1, 0, 2, 3, 16, 0, 7, 0, 0, 0, 0, 0, 0, 0, 0
    .long 6, 1, 0, 2, 3, 16, 0, 2, 0, 0, 0, 0, 0, 0, 0, 0
    .long 6, 1, 0, 2, 3, 16, 0, 17, 0, 0, 0, 0, 0, 0, 0, 0
    .long 6, 1, 0, 2, 3, 16, 0, 21, 0, 0, 0, 0, 0, 0, 0, 0
    .long 6, 1, 0, 2, 3, 16, 0, 16, 0, 0, 0, 0, 0, 0, 0, 0
    .long 6, 0, 0, 0, 3, 0, 0, 50, 0, 0, 0, 0, 0, 0, 0, 0
    .long 6, 0, 0, 0, 3, 0, 0, 52, 0, 0, 0, 0, 0, 0, 0, 0
    .long 6, 0, 0, 0, 3, 0, 0, 54, 0, 0, 0, 0, 0, 0, 0, 0
    .long 6, 0, 0, 0, 3, 0, 0, 49, 0, 0, 0, 0, 0, 0, 0, 0
    .long 6, 0, 0, 0, 3, 0, 0, 48, 0, 0, 0, 0, 0, 0, 0, 0
    .long 6, 0, 0, 0, 3, 0, 0, 53, 0, 0, 0, 0, 0, 0, 0, 0
    .long 6, 0, 0, 0, 3, 0, 0, 55, 0, 0, 0, 0, 0, 0, 0, 0
    .long 6, 0, 0, 0, 3, 0, 0, 56, 0, 0, 0, 0, 0, 0, 0, 0
    .long 6, 1, 0, 2, 3, 16, 0, 23, 0, 0, 0, 0, 0, 0, 0, 0
    .long 6, 1, 0, 2, 3, 16, 0, 24, 0, 0, 0, 0, 0, 0, 0, 0
    .long 6, 1, 0, 2, 3, 16, 0, 25, 0, 0, 0, 0, 0, 0, 0, 0
    .long 6, 1, 0, 2, 3, 16, 0, 26, 0, 0, 0, 0, 0, 0, 0, 0
    .long 6, 1, 0, 2, 3, 16, 0, 27, 0, 0, 0, 0, 0, 0, 0, 0
    .long 6, 1, 0, 2, 3, 16, 0, 28, 0, 0, 0, 0, 0, 0, 0, 0
    .long 6, 1, 0, 2, 3, 16, 0, 29, 0, 0, 0, 0, 0, 0, 0, 0
    .long 6, 1, 0, 2, 3, 16, 0, 30, 0, 0, 0, 0, 0, 0, 0, 0
    .long 6, 1, 0, 2, 3, 16, 0, 31, 0, 0, 0, 0, 0, 0, 0, 0
    .long 6, 0, 0, 1, 3, 16, 0, 40, 0, 0, 0, 0, 0, 0, 0, 0
    .long 6, 0, 0, 1, 3, 16, 0, 41, 0, 0, 0, 0, 0, 0, 0, 0
    .long 6, 0, 0, 1, 3, 16, 0, 43, 0, 0, 0, 0, 0, 0, 0, 0
    .long 6, 0, 0, 1, 3, 16, 0, 45, 0, 0, 0, 0, 0, 0, 0, 0
    .long 6, 0, 0, 1, 3, 16, 0, 46, 0, 0, 0, 0, 0, 0, 0, 0
    .long 6, 0, 0, 1, 3, 16, 0, 47, 0, 0, 0, 0, 0, 0, 0, 0
    .long 6, 1, 0, 1, 3, 16, 0, 32, 0, 0, 0, 0, 0, 0, 0, 0
    .long 6, 1, 0, 1, 3, 16, 0, 33, 0, 0, 0, 0, 0, 0, 0, 0
    .long 6, 1, 0, 1, 3, 16, 0, 35, 0, 0, 0, 0, 0, 0, 0, 0
    .long 6, 1, 0, 1, 3, 16, 0, 36, 0, 0, 0, 0, 0, 0, 0, 0
    .long 6, 1, 0, 1, 3, 16, 0, 38, 0, 0, 0, 0, 0, 0, 0, 0
    .long 6, 1, 0, 1, 3, 16, 0, 39, 0, 0, 0, 0, 0, 0, 0, 0
    .long 6, 0, 0, 0, 3, 0, 0, 57, 0, 0, 0, 0, 0, 0, 0, 0
    .long 6, 0, 0, 1, 3, 16, 0, 44, 0, 0, 0, 0, 0, 0, 0, 0
    .long 6, 1, 0, 1, 3, 16, 0, 34, 0, 0, 0, 0, 0, 0, 0, 0
    .long 6, 0, 0, 0, 3, 0, 0, 58, 0, 0, 0, 0, 0, 0, 0, 0
    .long 6, 1, 0, 1, 3, 16, 0, 37, 0, 0, 0, 0, 0, 0, 0, 0
    .long 6, 0, 0, 1, 3, 16, 0, 42, 0, 0, 0, 0, 0, 0, 0, 0
    .long 6, 0, 0, 0, 3, 0, 0, 59, 0, 0, 0, 0, 0, 0, 0, 0
    .long 6, 1, 0, 2, 3, 16, 0, 8, 0, 0, 0, 0, 0, 0, 0, 0
    .long 6, 1, 0, 2, 3, 16, 0, 9, 0, 0, 0, 0, 0, 0, 0, 0
    .long 6, 1, 0, 2, 3, 16, 0, 10, 0, 0, 0, 0, 0, 0, 0, 0
    .long 6, 1, 0, 2, 3, 16, 0, 11, 0, 0, 0, 0, 0, 0, 0, 0
    .long 6, 1, 0, 2, 3, 16, 0, 12, 0, 0, 0, 0, 0, 0, 0, 0
    .long 6, 1, 0, 2, 3, 16, 0, 13, 0, 0, 0, 0, 0, 0, 0, 0
    .long 6, 1, 0, 2, 3, 16, 0, 14, 0, 0, 0, 0, 0, 0, 0, 0
    .long 6, 1, 0, 2, 3, 16, 0, 15, 0, 0, 0, 0, 0, 0, 0, 0
    .long 7, 0, 0, 0, 12, 0, 0, 60, 0, 0, 0, 0, 0, 0, 0, 0
    .long 7, 0, 0, 0, 13, 0, 0, 60, 0, 0, 0, 0, 0, 0, 0, 0
    .long 7, 0, 0, 0, 14, 0, 0, 60, 0, 0, 0, 0, 0, 0, 0, 0
    .long 7, 0, 0, 0, 15, 0, 0, 60, 0, 0, 0, 0, 0, 0, 0, 0
    .long 7, 0, 0, 0, 12, 0, 0, 61, 0, 0, 0, 0, 0, 0, 0, 0
    .long 7, 0, 0, 0, 13, 0, 0, 61, 0, 0, 0, 0, 0, 0, 0, 0
    .long 7, 0, 0, 0, 14, 0, 0, 61, 0, 0, 0, 0, 0, 0, 0, 0
    .long 7, 0, 0, 0, 15, 0, 0, 61, 0, 0, 0, 0, 0, 0, 0, 0
    .long 7, 0, 0, 0, 12, 0, 0, 62, 0, 0, 0, 0, 0, 0, 0, 0
    .long 7, 0, 0, 0, 13, 0, 0, 62, 0, 0, 0, 0, 0, 0, 0, 0
    .long 7, 0, 0, 0, 14, 0, 0, 62, 0, 0, 0, 0, 0, 0, 0, 0
    .long 7, 0, 0, 0, 15, 0, 0, 62, 0, 0, 0, 0, 0, 0, 0, 0
    .long 7, 0, 0, 0, 12, 0, 0, 63, 0, 0, 0, 0, 0, 0, 0, 0
    .long 7, 0, 0, 0, 13, 0, 0, 63, 0, 0, 0, 0, 0, 0, 0, 0
    .long 7, 0, 0, 0, 14, 0, 0, 63, 0, 0, 0, 0, 0, 0, 0, 0
    .long 7, 0, 0, 0, 15, 0, 0, 63, 0, 0, 0, 0, 0, 0, 0, 0
    .long 0, 0, 0, 0, 0, 0, 0, 0, 0, 0, 0, 0, 0, 0, 0, 0
.p2align 6
.amdhsa_kernel recurrent_scan__memory_aug_recurrent_mem_tr__glu_gated_glu__prompt_kernel
  .amdhsa_next_free_vgpr 256
  .amdhsa_next_free_sgpr 102
  .amdhsa_accum_offset 256
  .amdhsa_group_segment_fixed_size 0
  .amdhsa_kernarg_size 112
  .amdhsa_user_sgpr_count 2
  .amdhsa_user_sgpr_kernarg_segment_ptr 1
  .amdhsa_system_sgpr_workgroup_id_x 1
  .amdhsa_float_denorm_mode_32 3
.end_amdhsa_kernel
```

```asm
; @launch grid=(256,1,1) block=(512,1,1) lds=163840
.amdgcn_target "amdgcn-amd-amdhsa--gfx950"
.text
.globl recurrent_scan__memory_aug_recurrent_mem_tr__glu_gated_glu__prompt_kernel
.p2align 8
.type recurrent_scan__memory_aug_recurrent_mem_tr__glu_gated_glu__prompt_kernel,@function
recurrent_scan__memory_aug_recurrent_mem_tr__glu_gated_glu__prompt_kernel:
    s_cmp_ge_u32 s2, 256
    s_cbranch_scc1 k_exit
    s_mov_b32 s99, s2
    s_load_dwordx2 s[4:5], s[0:1], 104
    s_load_dwordx2 s[64:65], s[0:1], 96
    v_lshrrev_b32 v2, 6, v0
    s_mov_b32 s6, 268435456
    s_mov_b32 s7, 131072
    s_mov_b32 s66, 256
    s_mov_b32 s67, 131072
    v_readfirstlane_b32 s3, v2
    s_getreg_b32 s14, hwreg(HW_REG_XCC_ID)
    s_waitcnt lgkmcnt(0)
    s_mov_b32 s98, s2
    s_sub_u32 s97, s14, s2
    s_and_b32 s97, s97, 7
    s_or_b32 s15, s2, s3
    s_cmp_lg_u32 s15, 0
    s_cbranch_scc1 k_disp
    s_add_u32 s14, s97, 1
    v_mov_b32 v2, s14
    s_mov_b64 exec, 1
    buffer_store_dword v2, off, s[64:67], 0 offset:224 sc1
    s_mov_b64 exec, -1
    s_branch k_disp
k_restart:
    s_waitcnt vmcnt(0) lgkmcnt(0)
    s_barrier
k_disp:
    s_add_u32 s14, s97, s98
    s_and_b32 s14, s14, 7
    s_andn2_b32 s2, s98, 7
    s_or_b32 s2, s2, s14
    s_mov_b32 s99, s2
    s_lshr_b32 s13, s2, 3
    s_and_b32 s12, s2, 3
    s_waitcnt lgkmcnt(0)
    s_bitcmp0_b32 s2, 2
    s_cbranch_scc1 chain_map
    s_lshl_b32 s63, s13, 2
    s_add_u32 s63, s63, s12
    s_mov_b32 s17, s63
    s_mov_b32 s19, s3
    s_mov_b32 s18, 0
    s_cmp_ge_u32 s3, 4
    s_cbranch_scc1 ln_touch
    s_load_dwordx2 s[8:9], s[0:1], 0
    v_and_b32 v1, 63, v0
    s_mov_b32 s10, 4194304
    s_mov_b32 s11, 131072
    v_and_b32 v3, 15, v1
    v_lshrrev_b32 v4, 4, v1
    v_lshlrev_b32 v5, 11, v3
    v_lshl_add_u32 v5, v4, 4, v5
    s_lshl_b32 s12, s17, 15
    s_lshl_b32 s13, s19, 9
    s_add_u32 s12, s12, s13
    s_waitcnt lgkmcnt(0)
    buffer_load_dwordx4 v[16:19], v5, s[8:11], s12 offen offset:0
    buffer_load_dwordx4 v[20:23], v5, s[8:11], s12 offen offset:64
    buffer_load_dwordx4 v[24:27], v5, s[8:11], s12 offen offset:128
    buffer_load_dwordx4 v[28:31], v5, s[8:11], s12 offen offset:192
    buffer_load_dwordx4 v[32:35], v5, s[8:11], s12 offen offset:256
    buffer_load_dwordx4 v[36:39], v5, s[8:11], s12 offen offset:320
    buffer_load_dwordx4 v[40:43], v5, s[8:11], s12 offen offset:384
    buffer_load_dwordx4 v[44:47], v5, s[8:11], s12 offen offset:448
    v_mov_b32 v14, 0
    s_lshl_b32 s13, s63, 7
    s_add_u32 s13, s13, 218103808
    v_lshlrev_b32 v13, 2, v0
    v_lshlrev_b32 v6, 4, v3
    s_lshl_b32 s14, s18, 10
    v_add_u32 v6, s14, v6
    s_lshl_b32 s14, s19, 2
    v_add_u32 v7, s14, v6
    v_lshlrev_b32 v8, 4, v1
    s_lshl_b32 s15, s17, 15
    s_lshl_b32 s16, s19, 13
    s_add_u32 s15, s15, s16
    s_add_u32 s15, s15, 0
    s_add_u32 s16, s15, 4096
    v_and_b32 v9, 1, v4
    v_cmp_eq_u32 s[20:21], 1, v9
    s_waitcnt vmcnt(0)
    v_lshlrev_b32 v48, 16, v16
    v_and_b32 v49, 0xffff0000, v16
    v_lshlrev_b32 v50, 16, v17
    v_and_b32 v51, 0xffff0000, v17
    v_lshlrev_b32 v52, 16, v18
    v_and_b32 v53, 0xffff0000, v18
    v_lshlrev_b32 v54, 16, v19
    v_and_b32 v55, 0xffff0000, v19
    v_lshlrev_b32 v56, 16, v20
    v_and_b32 v57, 0xffff0000, v20
    v_lshlrev_b32 v58, 16, v21
    v_and_b32 v59, 0xffff0000, v21
    v_lshlrev_b32 v60, 16, v22
    v_and_b32 v61, 0xffff0000, v22
    v_lshlrev_b32 v62, 16, v23
    v_and_b32 v63, 0xffff0000, v23
    v_lshlrev_b32 v64, 16, v24
    v_and_b32 v65, 0xffff0000, v24
    v_lshlrev_b32 v66, 16, v25
    v_and_b32 v67, 0xffff0000, v25
    v_lshlrev_b32 v68, 16, v26
    v_and_b32 v69, 0xffff0000, v26
    v_lshlrev_b32 v70, 16, v27
    v_and_b32 v71, 0xffff0000, v27
    v_lshlrev_b32 v72, 16, v28
    v_and_b32 v73, 0xffff0000, v28
    v_lshlrev_b32 v74, 16, v29
    v_and_b32 v75, 0xffff0000, v29
    v_lshlrev_b32 v76, 16, v30
    v_and_b32 v77, 0xffff0000, v30
    v_lshlrev_b32 v78, 16, v31
    v_and_b32 v79, 0xffff0000, v31
    v_lshlrev_b32 v80, 16, v32
    v_and_b32 v81, 0xffff0000, v32
    v_lshlrev_b32 v82, 16, v33
    v_and_b32 v83, 0xffff0000, v33
    v_lshlrev_b32 v84, 16, v34
    v_and_b32 v85, 0xffff0000, v34
    v_lshlrev_b32 v86, 16, v35
    v_and_b32 v87, 0xffff0000, v35
    v_lshlrev_b32 v88, 16, v36
    v_and_b32 v89, 0xffff0000, v36
    v_lshlrev_b32 v90, 16, v37
    v_and_b32 v91, 0xffff0000, v37
    v_lshlrev_b32 v92, 16, v38
    v_and_b32 v93, 0xffff0000, v38
    v_lshlrev_b32 v94, 16, v39
    v_and_b32 v95, 0xffff0000, v39
    v_lshlrev_b32 v96, 16, v40
    v_and_b32 v97, 0xffff0000, v40
    v_lshlrev_b32 v98, 16, v41
    v_and_b32 v99, 0xffff0000, v41
    v_lshlrev_b32 v100, 16, v42
    v_and_b32 v101, 0xffff0000, v42
    v_lshlrev_b32 v102, 16, v43
    v_and_b32 v103, 0xffff0000, v43
    v_lshlrev_b32 v104, 16, v44
    v_and_b32 v105, 0xffff0000, v44
    v_lshlrev_b32 v106, 16, v45
    v_and_b32 v107, 0xffff0000, v45
    v_lshlrev_b32 v108, 16, v46
    v_and_b32 v109, 0xffff0000, v46
    v_lshlrev_b32 v110, 16, v47
    v_and_b32 v111, 0xffff0000, v47
    v_add_f32 v112, v48, v80
    v_add_f32 v113, v49, v81
    v_add_f32 v114, v50, v82
    v_add_f32 v115, v51, v83
    v_add_f32 v116, v52, v84
    v_add_f32 v117, v53, v85
    v_add_f32 v118, v54, v86
    v_add_f32 v119, v55, v87
    v_add_f32 v120, v56, v88
    v_add_f32 v121, v57, v89
    v_add_f32 v122, v58, v90
    v_add_f32 v123, v59, v91
    v_add_f32 v124, v60, v92
    v_add_f32 v125, v61, v93
    v_add_f32 v126, v62, v94
    v_add_f32 v127, v63, v95
    v_add_f32 v128, v64, v96
    v_add_f32 v129, v65, v97
    v_add_f32 v130, v66, v98
    v_add_f32 v131, v67, v99
    v_add_f32 v132, v68, v100
    v_add_f32 v133, v69, v101
    v_add_f32 v134, v70, v102
    v_add_f32 v135, v71, v103
    v_add_f32 v136, v72, v104
    v_add_f32 v137, v73, v105
    v_add_f32 v138, v74, v106
    v_add_f32 v139, v75, v107
    v_add_f32 v140, v76, v108
    v_add_f32 v141, v77, v109
    v_add_f32 v142, v78, v110
    v_add_f32 v143, v79, v111
    v_add_f32 v112, v112, v128
    v_add_f32 v113, v113, v129
    v_add_f32 v114, v114, v130
    v_add_f32 v115, v115, v131
    v_add_f32 v116, v116, v132
    v_add_f32 v117, v117, v133
    v_add_f32 v118, v118, v134
    v_add_f32 v119, v119, v135
    v_add_f32 v120, v120, v136
    v_add_f32 v121, v121, v137
    v_add_f32 v122, v122, v138
    v_add_f32 v123, v123, v139
    v_add_f32 v124, v124, v140
    v_add_f32 v125, v125, v141
    v_add_f32 v126, v126, v142
    v_add_f32 v127, v127, v143
    v_add_f32 v112, v112, v120
    v_add_f32 v113, v113, v121
    v_add_f32 v114, v114, v122
    v_add_f32 v115, v115, v123
    v_add_f32 v116, v116, v124
    v_add_f32 v117, v117, v125
    v_add_f32 v118, v118, v126
    v_add_f32 v119, v119, v127
    v_add_f32 v112, v112, v116
    v_add_f32 v113, v113, v117
    v_add_f32 v114, v114, v118
    v_add_f32 v115, v115, v119
    v_add_f32 v112, v112, v114
    v_add_f32 v113, v113, v115
    v_add_f32 v112, v112, v113
    v_mov_b32 v113, v112
    s_nop 1
    v_permlane16_swap_b32 v113, v112
    v_add_f32 v112, v112, v113
    v_mov_b32 v113, v112
    s_nop 1
    v_permlane32_swap_b32 v113, v112
    v_add_f32 v112, v112, v113
    ds_write_b32 v7, v112
    s_waitcnt lgkmcnt(0)
    s_barrier
    ds_read_b128 v[112:115], v6
    s_waitcnt lgkmcnt(0)
    v_add_f32 v112, v112, v114
    v_add_f32 v113, v113, v115
    v_add_f32 v112, v112, v113
    v_mul_f32 v10, 0x3a800000, v112
    v_sub_f32 v176, v48, v10
    v_sub_f32 v177, v49, v10
    v_sub_f32 v178, v50, v10
    v_sub_f32 v179, v51, v10
    v_sub_f32 v180, v52, v10
    v_sub_f32 v181, v53, v10
    v_sub_f32 v182, v54, v10
    v_sub_f32 v183, v55, v10
    v_sub_f32 v184, v56, v10
    v_sub_f32 v185, v57, v10
    v_sub_f32 v186, v58, v10
    v_sub_f32 v187, v59, v10
    v_sub_f32 v188, v60, v10
    v_sub_f32 v189, v61, v10
    v_sub_f32 v190, v62, v10
    v_sub_f32 v191, v63, v10
    v_sub_f32 v192, v64, v10
    v_sub_f32 v193, v65, v10
    v_sub_f32 v194, v66, v10
    v_sub_f32 v195, v67, v10
    v_sub_f32 v196, v68, v10
    v_sub_f32 v197, v69, v10
    v_sub_f32 v198, v70, v10
    v_sub_f32 v199, v71, v10
    v_sub_f32 v200, v72, v10
    v_sub_f32 v201, v73, v10
    v_sub_f32 v202, v74, v10
    v_sub_f32 v203, v75, v10
    v_sub_f32 v204, v76, v10
    v_sub_f32 v205, v77, v10
    v_sub_f32 v206, v78, v10
    v_sub_f32 v207, v79, v10
    v_sub_f32 v208, v80, v10
    v_sub_f32 v209, v81, v10
    v_sub_f32 v210, v82, v10
    v_sub_f32 v211, v83, v10
    v_sub_f32 v212, v84, v10
    v_sub_f32 v213, v85, v10
    v_sub_f32 v214, v86, v10
    v_sub_f32 v215, v87, v10
    v_sub_f32 v216, v88, v10
    v_sub_f32 v217, v89, v10
    v_sub_f32 v218, v90, v10
    v_sub_f32 v219, v91, v10
    v_sub_f32 v220, v92, v10
    v_sub_f32 v221, v93, v10
    v_sub_f32 v222, v94, v10
    v_sub_f32 v223, v95, v10
    v_sub_f32 v224, v96, v10
    v_sub_f32 v225, v97, v10
    v_sub_f32 v226, v98, v10
    v_sub_f32 v227, v99, v10
    v_sub_f32 v228, v100, v10
    v_sub_f32 v229, v101, v10
    v_sub_f32 v230, v102, v10
    v_sub_f32 v231, v103, v10
    v_sub_f32 v232, v104, v10
    v_sub_f32 v233, v105, v10
    v_sub_f32 v234, v106, v10
    v_sub_f32 v235, v107, v10
    v_sub_f32 v236, v108, v10
    v_sub_f32 v237, v109, v10
    v_sub_f32 v238, v110, v10
    v_sub_f32 v239, v111, v10
    v_mul_f32 v112, v176, v176
    v_fmac_f32 v112, v208, v208
    v_mul_f32 v113, v177, v177
    v_fmac_f32 v113, v209, v209
    v_mul_f32 v114, v178, v178
    v_fmac_f32 v114, v210, v210
    v_mul_f32 v115, v179, v179
    v_fmac_f32 v115, v211, v211
    v_mul_f32 v116, v180, v180
    v_fmac_f32 v116, v212, v212
    v_mul_f32 v117, v181, v181
    v_fmac_f32 v117, v213, v213
    v_mul_f32 v118, v182, v182
    v_fmac_f32 v118, v214, v214
    v_mul_f32 v119, v183, v183
    v_fmac_f32 v119, v215, v215
    v_mul_f32 v120, v184, v184
    v_fmac_f32 v120, v216, v216
    v_mul_f32 v121, v185, v185
    v_fmac_f32 v121, v217, v217
    v_mul_f32 v122, v186, v186
    v_fmac_f32 v122, v218, v218
    v_mul_f32 v123, v187, v187
    v_fmac_f32 v123, v219, v219
    v_mul_f32 v124, v188, v188
    v_fmac_f32 v124, v220, v220
    v_mul_f32 v125, v189, v189
    v_fmac_f32 v125, v221, v221
    v_mul_f32 v126, v190, v190
    v_fmac_f32 v126, v222, v222
    v_mul_f32 v127, v191, v191
    v_fmac_f32 v127, v223, v223
    v_mul_f32 v128, v192, v192
    v_fmac_f32 v128, v224, v224
    v_mul_f32 v129, v193, v193
    v_fmac_f32 v129, v225, v225
    v_mul_f32 v130, v194, v194
    v_fmac_f32 v130, v226, v226
    v_mul_f32 v131, v195, v195
    v_fmac_f32 v131, v227, v227
    v_mul_f32 v132, v196, v196
    v_fmac_f32 v132, v228, v228
    v_mul_f32 v133, v197, v197
    v_fmac_f32 v133, v229, v229
    v_mul_f32 v134, v198, v198
    v_fmac_f32 v134, v230, v230
    v_mul_f32 v135, v199, v199
    v_fmac_f32 v135, v231, v231
    v_mul_f32 v136, v200, v200
    v_fmac_f32 v136, v232, v232
    v_mul_f32 v137, v201, v201
    v_fmac_f32 v137, v233, v233
    v_mul_f32 v138, v202, v202
    v_fmac_f32 v138, v234, v234
    v_mul_f32 v139, v203, v203
    v_fmac_f32 v139, v235, v235
    v_mul_f32 v140, v204, v204
    v_fmac_f32 v140, v236, v236
    v_mul_f32 v141, v205, v205
    v_fmac_f32 v141, v237, v237
    v_mul_f32 v142, v206, v206
    v_fmac_f32 v142, v238, v238
    v_mul_f32 v143, v207, v207
    v_fmac_f32 v143, v239, v239
    v_add_f32 v112, v112, v128
    v_add_f32 v113, v113, v129
    v_add_f32 v114, v114, v130
    v_add_f32 v115, v115, v131
    v_add_f32 v116, v116, v132
    v_add_f32 v117, v117, v133
    v_add_f32 v118, v118, v134
    v_add_f32 v119, v119, v135
    v_add_f32 v120, v120, v136
    v_add_f32 v121, v121, v137
    v_add_f32 v122, v122, v138
    v_add_f32 v123, v123, v139
    v_add_f32 v124, v124, v140
    v_add_f32 v125, v125, v141
    v_add_f32 v126, v126, v142
    v_add_f32 v127, v127, v143
    v_add_f32 v112, v112, v120
    v_add_f32 v113, v113, v121
    v_add_f32 v114, v114, v122
    v_add_f32 v115, v115, v123
    v_add_f32 v116, v116, v124
    v_add_f32 v117, v117, v125
    v_add_f32 v118, v118, v126
    v_add_f32 v119, v119, v127
    v_add_f32 v112, v112, v116
    v_add_f32 v113, v113, v117
    v_add_f32 v114, v114, v118
    v_add_f32 v115, v115, v119
    v_add_f32 v112, v112, v114
    v_add_f32 v113, v113, v115
    v_add_f32 v112, v112, v113
    v_mov_b32 v113, v112
    s_nop 1
    v_permlane16_swap_b32 v113, v112
    v_add_f32 v112, v112, v113
    v_mov_b32 v113, v112
    s_nop 1
    v_permlane32_swap_b32 v113, v112
    v_add_f32 v112, v112, v113
    ds_write_b32 v7, v112 offset:512
    s_waitcnt lgkmcnt(0)
    s_barrier
    ds_read_b128 v[112:115], v6 offset:512
    v_mov_b32 v12, 2048
    ds_read_b32 v12, v12
    s_mov_b32 s96, s97
    s_waitcnt lgkmcnt(0)
    v_readfirstlane_b32 s97, v12
    s_cmp_lg_u32 s96, s97
    s_cbranch_scc1 k_restart
    s_waitcnt lgkmcnt(0)
    v_cmp_gt_u32 vcc, 32, v0
    s_and_saveexec_b64 s[22:23], vcc
    s_cbranch_execz ln_nz
    buffer_store_dword v14, v13, s[4:7], s13 offen sc1
ln_nz:
    s_mov_b64 exec, -1
    v_add_f32 v112, v112, v114
    v_add_f32 v113, v113, v115
    v_add_f32 v112, v112, v113
    v_mul_f32 v11, 0x3a800000, v112
    v_cvt_pk_bf16_f32 v10, v10, v10
    v_lshlrev_b32 v10, 16, v10
    v_cvt_pk_bf16_f32 v11, v11, v11
    v_lshlrev_b32 v11, 16, v11
    v_add_f32 v11, 0x3727c5ac, v11
    v_cvt_pk_bf16_f32 v11, v11, v11
    v_lshlrev_b32 v11, 16, v11
    v_sqrt_f32 v11, v11
    s_nop 0
    v_cvt_pk_bf16_f32 v11, v11, v11
    v_lshlrev_b32 v11, 16, v11
    v_rcp_f32 v11, v11
    s_nop 0
    v_sub_f32 v48, v48, v10
    v_sub_f32 v49, v49, v10
    v_cvt_pk_bf16_f32 v16, v48, v49
    v_lshlrev_b32 v48, 16, v16
    v_and_b32 v49, 0xffff0000, v16
    v_mul_f32 v48, v48, v11
    v_mul_f32 v49, v49, v11
    v_cvt_pk_bf16_f32 v16, v48, v49
    v_sub_f32 v50, v50, v10
    v_sub_f32 v51, v51, v10
    v_cvt_pk_bf16_f32 v17, v50, v51
    v_lshlrev_b32 v50, 16, v17
    v_and_b32 v51, 0xffff0000, v17
    v_mul_f32 v50, v50, v11
    v_mul_f32 v51, v51, v11
    v_cvt_pk_bf16_f32 v17, v50, v51
    v_sub_f32 v52, v52, v10
    v_sub_f32 v53, v53, v10
    v_cvt_pk_bf16_f32 v18, v52, v53
    v_lshlrev_b32 v52, 16, v18
    v_and_b32 v53, 0xffff0000, v18
    v_mul_f32 v52, v52, v11
    v_mul_f32 v53, v53, v11
    v_cvt_pk_bf16_f32 v18, v52, v53
    v_sub_f32 v54, v54, v10
    v_sub_f32 v55, v55, v10
    v_cvt_pk_bf16_f32 v19, v54, v55
    v_lshlrev_b32 v54, 16, v19
    v_and_b32 v55, 0xffff0000, v19
    v_mul_f32 v54, v54, v11
    v_mul_f32 v55, v55, v11
    v_cvt_pk_bf16_f32 v19, v54, v55
    v_cndmask_b32 v112, v16, v18, s[20:21]
    v_cndmask_b32 v113, v17, v19, s[20:21]
    v_cndmask_b32 v114, v18, v16, s[20:21]
    v_cndmask_b32 v115, v19, v17, s[20:21]
    buffer_store_dwordx4 v[112:115], v8, s[4:7], s15 offen offset:0 sc1
    v_sub_f32 v56, v56, v10
    v_sub_f32 v57, v57, v10
    v_cvt_pk_bf16_f32 v20, v56, v57
    v_lshlrev_b32 v56, 16, v20
    v_and_b32 v57, 0xffff0000, v20
    v_mul_f32 v56, v56, v11
    v_mul_f32 v57, v57, v11
    v_cvt_pk_bf16_f32 v20, v56, v57
    v_sub_f32 v58, v58, v10
    v_sub_f32 v59, v59, v10
    v_cvt_pk_bf16_f32 v21, v58, v59
    v_lshlrev_b32 v58, 16, v21
    v_and_b32 v59, 0xffff0000, v21
    v_mul_f32 v58, v58, v11
    v_mul_f32 v59, v59, v11
    v_cvt_pk_bf16_f32 v21, v58, v59
    v_sub_f32 v60, v60, v10
    v_sub_f32 v61, v61, v10
    v_cvt_pk_bf16_f32 v22, v60, v61
    v_lshlrev_b32 v60, 16, v22
    v_and_b32 v61, 0xffff0000, v22
    v_mul_f32 v60, v60, v11
    v_mul_f32 v61, v61, v11
    v_cvt_pk_bf16_f32 v22, v60, v61
    v_sub_f32 v62, v62, v10
    v_sub_f32 v63, v63, v10
    v_cvt_pk_bf16_f32 v23, v62, v63
    v_lshlrev_b32 v62, 16, v23
    v_and_b32 v63, 0xffff0000, v23
    v_mul_f32 v62, v62, v11
    v_mul_f32 v63, v63, v11
    v_cvt_pk_bf16_f32 v23, v62, v63
    v_cndmask_b32 v116, v20, v22, s[20:21]
    v_cndmask_b32 v117, v21, v23, s[20:21]
    v_cndmask_b32 v118, v22, v20, s[20:21]
    v_cndmask_b32 v119, v23, v21, s[20:21]
    buffer_store_dwordx4 v[116:119], v8, s[4:7], s15 offen offset:1024 sc1
    v_sub_f32 v64, v64, v10
    v_sub_f32 v65, v65, v10
    v_cvt_pk_bf16_f32 v24, v64, v65
    v_lshlrev_b32 v64, 16, v24
    v_and_b32 v65, 0xffff0000, v24
    v_mul_f32 v64, v64, v11
    v_mul_f32 v65, v65, v11
    v_cvt_pk_bf16_f32 v24, v64, v65
    v_sub_f32 v66, v66, v10
    v_sub_f32 v67, v67, v10
    v_cvt_pk_bf16_f32 v25, v66, v67
    v_lshlrev_b32 v66, 16, v25
    v_and_b32 v67, 0xffff0000, v25
    v_mul_f32 v66, v66, v11
    v_mul_f32 v67, v67, v11
    v_cvt_pk_bf16_f32 v25, v66, v67
    v_sub_f32 v68, v68, v10
    v_sub_f32 v69, v69, v10
    v_cvt_pk_bf16_f32 v26, v68, v69
    v_lshlrev_b32 v68, 16, v26
    v_and_b32 v69, 0xffff0000, v26
    v_mul_f32 v68, v68, v11
    v_mul_f32 v69, v69, v11
    v_cvt_pk_bf16_f32 v26, v68, v69
    v_sub_f32 v70, v70, v10
    v_sub_f32 v71, v71, v10
    v_cvt_pk_bf16_f32 v27, v70, v71
    v_lshlrev_b32 v70, 16, v27
    v_and_b32 v71, 0xffff0000, v27
    v_mul_f32 v70, v70, v11
    v_mul_f32 v71, v71, v11
    v_cvt_pk_bf16_f32 v27, v70, v71
    v_cndmask_b32 v120, v24, v26, s[20:21]
    v_cndmask_b32 v121, v25, v27, s[20:21]
    v_cndmask_b32 v122, v26, v24, s[20:21]
    v_cndmask_b32 v123, v27, v25, s[20:21]
    buffer_store_dwordx4 v[120:123], v8, s[4:7], s15 offen offset:2048 sc1
    v_sub_f32 v72, v72, v10
    v_sub_f32 v73, v73, v10
    v_cvt_pk_bf16_f32 v28, v72, v73
    v_lshlrev_b32 v72, 16, v28
    v_and_b32 v73, 0xffff0000, v28
    v_mul_f32 v72, v72, v11
    v_mul_f32 v73, v73, v11
    v_cvt_pk_bf16_f32 v28, v72, v73
    v_sub_f32 v74, v74, v10
    v_sub_f32 v75, v75, v10
    v_cvt_pk_bf16_f32 v29, v74, v75
    v_lshlrev_b32 v74, 16, v29
    v_and_b32 v75, 0xffff0000, v29
    v_mul_f32 v74, v74, v11
    v_mul_f32 v75, v75, v11
    v_cvt_pk_bf16_f32 v29, v74, v75
    v_sub_f32 v76, v76, v10
    v_sub_f32 v77, v77, v10
    v_cvt_pk_bf16_f32 v30, v76, v77
    v_lshlrev_b32 v76, 16, v30
    v_and_b32 v77, 0xffff0000, v30
    v_mul_f32 v76, v76, v11
    v_mul_f32 v77, v77, v11
    v_cvt_pk_bf16_f32 v30, v76, v77
    v_sub_f32 v78, v78, v10
    v_sub_f32 v79, v79, v10
    v_cvt_pk_bf16_f32 v31, v78, v79
    v_lshlrev_b32 v78, 16, v31
    v_and_b32 v79, 0xffff0000, v31
    v_mul_f32 v78, v78, v11
    v_mul_f32 v79, v79, v11
    v_cvt_pk_bf16_f32 v31, v78, v79
    v_cndmask_b32 v124, v28, v30, s[20:21]
    v_cndmask_b32 v125, v29, v31, s[20:21]
    v_cndmask_b32 v126, v30, v28, s[20:21]
    v_cndmask_b32 v127, v31, v29, s[20:21]
    buffer_store_dwordx4 v[124:127], v8, s[4:7], s15 offen offset:3072 sc1
    v_sub_f32 v80, v80, v10
    v_sub_f32 v81, v81, v10
    v_cvt_pk_bf16_f32 v32, v80, v81
    v_lshlrev_b32 v80, 16, v32
    v_and_b32 v81, 0xffff0000, v32
    v_mul_f32 v80, v80, v11
    v_mul_f32 v81, v81, v11
    v_cvt_pk_bf16_f32 v32, v80, v81
    v_sub_f32 v82, v82, v10
    v_sub_f32 v83, v83, v10
    v_cvt_pk_bf16_f32 v33, v82, v83
    v_lshlrev_b32 v82, 16, v33
    v_and_b32 v83, 0xffff0000, v33
    v_mul_f32 v82, v82, v11
    v_mul_f32 v83, v83, v11
    v_cvt_pk_bf16_f32 v33, v82, v83
    v_sub_f32 v84, v84, v10
    v_sub_f32 v85, v85, v10
    v_cvt_pk_bf16_f32 v34, v84, v85
    v_lshlrev_b32 v84, 16, v34
    v_and_b32 v85, 0xffff0000, v34
    v_mul_f32 v84, v84, v11
    v_mul_f32 v85, v85, v11
    v_cvt_pk_bf16_f32 v34, v84, v85
    v_sub_f32 v86, v86, v10
    v_sub_f32 v87, v87, v10
    v_cvt_pk_bf16_f32 v35, v86, v87
    v_lshlrev_b32 v86, 16, v35
    v_and_b32 v87, 0xffff0000, v35
    v_mul_f32 v86, v86, v11
    v_mul_f32 v87, v87, v11
    v_cvt_pk_bf16_f32 v35, v86, v87
    v_cndmask_b32 v128, v32, v34, s[20:21]
    v_cndmask_b32 v129, v33, v35, s[20:21]
    v_cndmask_b32 v130, v34, v32, s[20:21]
    v_cndmask_b32 v131, v35, v33, s[20:21]
    buffer_store_dwordx4 v[128:131], v8, s[4:7], s16 offen offset:0 sc1
    v_sub_f32 v88, v88, v10
    v_sub_f32 v89, v89, v10
    v_cvt_pk_bf16_f32 v36, v88, v89
    v_lshlrev_b32 v88, 16, v36
    v_and_b32 v89, 0xffff0000, v36
    v_mul_f32 v88, v88, v11
    v_mul_f32 v89, v89, v11
    v_cvt_pk_bf16_f32 v36, v88, v89
    v_sub_f32 v90, v90, v10
    v_sub_f32 v91, v91, v10
    v_cvt_pk_bf16_f32 v37, v90, v91
    v_lshlrev_b32 v90, 16, v37
    v_and_b32 v91, 0xffff0000, v37
    v_mul_f32 v90, v90, v11
    v_mul_f32 v91, v91, v11
    v_cvt_pk_bf16_f32 v37, v90, v91
    v_sub_f32 v92, v92, v10
    v_sub_f32 v93, v93, v10
    v_cvt_pk_bf16_f32 v38, v92, v93
    v_lshlrev_b32 v92, 16, v38
    v_and_b32 v93, 0xffff0000, v38
    v_mul_f32 v92, v92, v11
    v_mul_f32 v93, v93, v11
    v_cvt_pk_bf16_f32 v38, v92, v93
    v_sub_f32 v94, v94, v10
    v_sub_f32 v95, v95, v10
    v_cvt_pk_bf16_f32 v39, v94, v95
    v_lshlrev_b32 v94, 16, v39
    v_and_b32 v95, 0xffff0000, v39
    v_mul_f32 v94, v94, v11
    v_mul_f32 v95, v95, v11
    v_cvt_pk_bf16_f32 v39, v94, v95
    v_cndmask_b32 v132, v36, v38, s[20:21]
    v_cndmask_b32 v133, v37, v39, s[20:21]
    v_cndmask_b32 v134, v38, v36, s[20:21]
    v_cndmask_b32 v135, v39, v37, s[20:21]
    buffer_store_dwordx4 v[132:135], v8, s[4:7], s16 offen offset:1024 sc1
    v_sub_f32 v96, v96, v10
    v_sub_f32 v97, v97, v10
    v_cvt_pk_bf16_f32 v40, v96, v97
    v_lshlrev_b32 v96, 16, v40
    v_and_b32 v97, 0xffff0000, v40
    v_mul_f32 v96, v96, v11
    v_mul_f32 v97, v97, v11
    v_cvt_pk_bf16_f32 v40, v96, v97
    v_sub_f32 v98, v98, v10
    v_sub_f32 v99, v99, v10
    v_cvt_pk_bf16_f32 v41, v98, v99
    v_lshlrev_b32 v98, 16, v41
    v_and_b32 v99, 0xffff0000, v41
    v_mul_f32 v98, v98, v11
    v_mul_f32 v99, v99, v11
    v_cvt_pk_bf16_f32 v41, v98, v99
    v_sub_f32 v100, v100, v10
    v_sub_f32 v101, v101, v10
    v_cvt_pk_bf16_f32 v42, v100, v101
    v_lshlrev_b32 v100, 16, v42
    v_and_b32 v101, 0xffff0000, v42
    v_mul_f32 v100, v100, v11
    v_mul_f32 v101, v101, v11
    v_cvt_pk_bf16_f32 v42, v100, v101
    v_sub_f32 v102, v102, v10
    v_sub_f32 v103, v103, v10
    v_cvt_pk_bf16_f32 v43, v102, v103
    v_lshlrev_b32 v102, 16, v43
    v_and_b32 v103, 0xffff0000, v43
    v_mul_f32 v102, v102, v11
    v_mul_f32 v103, v103, v11
    v_cvt_pk_bf16_f32 v43, v102, v103
    v_cndmask_b32 v136, v40, v42, s[20:21]
    v_cndmask_b32 v137, v41, v43, s[20:21]
    v_cndmask_b32 v138, v42, v40, s[20:21]
    v_cndmask_b32 v139, v43, v41, s[20:21]
    buffer_store_dwordx4 v[136:139], v8, s[4:7], s16 offen offset:2048 sc1
    v_sub_f32 v104, v104, v10
    v_sub_f32 v105, v105, v10
    v_cvt_pk_bf16_f32 v44, v104, v105
    v_lshlrev_b32 v104, 16, v44
    v_and_b32 v105, 0xffff0000, v44
    v_mul_f32 v104, v104, v11
    v_mul_f32 v105, v105, v11
    v_cvt_pk_bf16_f32 v44, v104, v105
    v_sub_f32 v106, v106, v10
    v_sub_f32 v107, v107, v10
    v_cvt_pk_bf16_f32 v45, v106, v107
    v_lshlrev_b32 v106, 16, v45
    v_and_b32 v107, 0xffff0000, v45
    v_mul_f32 v106, v106, v11
    v_mul_f32 v107, v107, v11
    v_cvt_pk_bf16_f32 v45, v106, v107
    v_sub_f32 v108, v108, v10
    v_sub_f32 v109, v109, v10
    v_cvt_pk_bf16_f32 v46, v108, v109
    v_lshlrev_b32 v108, 16, v46
    v_and_b32 v109, 0xffff0000, v46
    v_mul_f32 v108, v108, v11
    v_mul_f32 v109, v109, v11
    v_cvt_pk_bf16_f32 v46, v108, v109
    v_sub_f32 v110, v110, v10
    v_sub_f32 v111, v111, v10
    v_cvt_pk_bf16_f32 v47, v110, v111
    v_lshlrev_b32 v110, 16, v47
    v_and_b32 v111, 0xffff0000, v47
    v_mul_f32 v110, v110, v11
    v_mul_f32 v111, v111, v11
    v_cvt_pk_bf16_f32 v47, v110, v111
    v_cndmask_b32 v140, v44, v46, s[20:21]
    v_cndmask_b32 v141, v45, v47, s[20:21]
    v_cndmask_b32 v142, v46, v44, s[20:21]
    v_cndmask_b32 v143, v47, v45, s[20:21]
    buffer_store_dwordx4 v[140:143], v8, s[4:7], s16 offen offset:3072 sc1
    s_waitcnt vmcnt(0)
    s_barrier
    s_cmp_lg_u32 s3, 0
    s_cbranch_scc1 ln_sig
    v_mov_b32 v2, 1
    s_mov_b64 exec, 1
    s_cmp_ge_u32 s63, 8
    s_cbranch_scc1 ln_sb
    buffer_atomic_add v2, off, s[64:67], 0 offset:192 sc1
ln_sb:
    buffer_atomic_add v2, off, s[64:67], 0 offset:0 sc1
    s_mov_b64 exec, -1
    s_branch ln_sig
ln_touch:
    s_getpc_b64 s[24:25]
    s_add_u32 s24, s24, jobtab@rel32@lo+4
    s_addc_u32 s25, s25, jobtab@rel32@hi+12
    s_and_b32 s30, s63, 3
    s_mul_i32 s30, s30, 323
    s_lshr_b32 s31, s63, 2
    s_add_u32 s30, s30, s31
    s_lshl_b32 s30, s30, 6
    s_add_u32 s24, s24, s30
    s_addc_u32 s25, s25, 0
    s_load_dwordx16 s[32:47], s[24:25], 0
    s_mov_b32 s11, 131072
    v_and_b32 v20, 63, v0
    s_waitcnt lgkmcnt(0)
    s_load_dwordx2 s[8:9], s[0:1], s33
    s_mov_b32 s10, s38
    s_lshl_b32 s30, s35, 4
    v_mul_lo_u32 v21, s30, v20
    v_and_b32 v22, 15, v20
    v_mul_lo_u32 v22, s43, v22
    s_waitcnt lgkmcnt(0)
    s_cmp_eq_u32 s3, 4
    s_cbranch_scc0 tlb_1_1
    buffer_load_dword v23, v21, s[8:11], s36 offen
    s_branch tlb_1
tlb_1_1:
    s_cmp_eq_u32 s3, 5
    s_cbranch_scc0 tlb_1
    buffer_load_dword v23, v22, s[4:7], s42 offen
    buffer_load_dword v23, off, s[4:7], s46
tlb_1:
    s_cmp_lg_u32 s3, 7
    s_cbranch_scc1 ln_nrp
    s_mov_b32 s95, 0x10000
rp_2:
    buffer_load_dword v13, off, s[64:67], 0 offset:224 sc1
    s_waitcnt vmcnt(0)
    v_readfirstlane_b32 s96, v13
    s_cmp_lg_u32 s96, 0
    s_cbranch_scc1 rp_2_ok
    s_sleep 2
    s_sub_u32 s95, s95, 1
    s_cbranch_scc0 rp_2
    s_add_u32 s96, s97, 1
rp_2_ok:
    s_sub_u32 s96, s96, 1
    v_mov_b32 v12, 2048
    v_mov_b32 v13, s96
    ds_write_b32 v12, v13
    s_waitcnt lgkmcnt(0)
ln_nrp:
    s_barrier
    s_barrier
    v_mov_b32 v12, 2048
    ds_read_b32 v12, v12
    s_mov_b32 s96, s97
    s_waitcnt lgkmcnt(0)
    v_readfirstlane_b32 s97, v12
    s_cmp_lg_u32 s96, s97
    s_cbranch_scc1 k_restart
    s_barrier
ln_sig:
    s_mov_b32 s29, s63
    v_and_b32 v20, 63, v0
    v_lshlrev_b32 v1, 4, v20
    v_add_u32 v19, 0x1000, v1
    v_lshrrev_b32 v4, 4, v20
    v_mov_b32 v17, 0
    v_mov_b32 v18, 1
    s_lshr_b32 s26, s3, 2
    s_and_b32 s27, s3, 3
    s_lshl_b32 s21, s3, 11
    s_lshl_b32 s22, s3, 10
    s_add_u32 s22, s22, 16384
    s_mov_b32 s11, 131072
    s_mov_b32 s15, 131072
    s_mov_b32 s28, 0
    v_and_b32 v21, 15, v20
    v_lshlrev_b32 v22, 2, v4
    v_xor_b32 v21, v21, v22
    s_lshr_b32 s30, s3, 1
    s_and_b32 s30, s30, 1
    v_xor_b32 v21, s30, v21
    v_lshlrev_b32 v3, 4, v21
    s_lshl_b32 s30, s26, 13
    v_add_u32 v5, s30, v1
    v_add_u32 v6, 0x10000, v5
    v_bfe_u32 v21, v20, 2, 2
    v_and_b32 v22, 3, v20
    v_and_b32 v23, 1, v4
    v_xor_b32 v24, s27, v21
    v_xor_b32 v25, v22, v23
    v_lshl_add_u32 v24, v24, 2, v25
    v_lshlrev_b32 v24, 4, v24
    v_lshl_add_u32 v25, v4, 3, v21
    v_lshl_add_u32 v24, v25, 8, v24
    v_and_b32 v22, 1, v22
    v_xor_b32 v25, 0, v23
    v_lshl_add_u32 v8, v25, 10, v24
    v_xor_b32 v25, 0, v22
    v_lshl_add_u32 v8, v25, 3, v8
    v_add_u32 v12, 0x10000, v8
    v_xor_b32 v25, 1, v23
    v_lshl_add_u32 v9, v25, 10, v24
    v_xor_b32 v25, 0, v22
    v_lshl_add_u32 v9, v25, 3, v9
    v_add_u32 v13, 0x10000, v9
    v_xor_b32 v25, 0, v23
    v_lshl_add_u32 v10, v25, 10, v24
    v_xor_b32 v25, 1, v22
    v_lshl_add_u32 v10, v25, 3, v10
    v_add_u32 v14, 0x10000, v10
    v_xor_b32 v25, 1, v23
    v_lshl_add_u32 v11, v25, 10, v24
    v_xor_b32 v25, 1, v22
    v_lshl_add_u32 v11, v25, 3, v11
    v_add_u32 v15, 0x10000, v11
    s_lshl_b32 s30, s3, 2
    s_add_u32 s30, s30, 131072
    v_mov_b32 v7, s30
    s_cmp_ge_u32 s3, 4
    s_cbranch_scc0 w_np
    s_setprio 1
w_np:
    s_getpc_b64 s[24:25]
    s_add_u32 s24, s24, jobtab@rel32@lo+4
    s_addc_u32 s25, s25, jobtab@rel32@hi+12
    s_and_b32 s31, s29, 3
    s_mul_i32 s30, s31, 20672
    s_add_u32 s24, s24, s30
    s_addc_u32 s25, s25, 0
    s_lshl_b32 s71, s31, 2
    s_add_u32 s71, s71, 64
    s_lshr_b32 s59, s29, 2
    s_lshl_b32 s30, s59, 6
    s_load_dwordx16 s[32:47], s[24:25], s30
    s_waitcnt lgkmcnt(0)
    s_cmp_lg_u32 s32, 4
    s_cbranch_scc1 w_nopre
    s_load_dwordx2 s[8:9], s[0:1], s33
    s_load_dwordx2 s[12:13], s[0:1], s34
    s_mov_b32 s10, s38
    s_mov_b32 s14, s38
    s_cmp_eq_u32 s32, 4
    s_cselect_b32 s31, 0, 1
    s_lshl_b32 s30, s3, s31
    s_mul_i32 s30, s30, s40
    s_add_u32 s16, s39, s30
    s_cmp_eq_u32 s32, 4
    s_cselect_b32 s30, 1024, s40
    s_cselect_b32 s31, 6, 5
    s_lshl_b32 s62, 32, s31
    s_add_u32 s17, s16, s30
    s_lshl_b32 s30, s3, 2
    s_mul_i32 s30, s30, s35
    s_add_u32 s18, s36, s30
    s_add_u32 s19, s37, s30
    s_lshl_b32 s20, s35, s31
    v_mul_u32_u24 v2, s35, v4
    v_add_u32 v2, v2, v3
    s_waitcnt lgkmcnt(0)
    s_add_u32 m0, s22, 0
    s_nop 0
    buffer_load_dwordx4 v2, s[8:11], s18 offen lds
    s_add_u32 s18, s18, s20
    s_add_u32 m0, s22, 8192
    s_nop 0
    buffer_load_dwordx4 v2, s[12:15], s19 offen lds
    s_add_u32 s19, s19, s20
    s_add_u32 m0, s22, 32768
    s_nop 0
    buffer_load_dwordx4 v2, s[8:11], s18 offen lds
    s_add_u32 s18, s18, s20
    s_add_u32 m0, s22, 40960
    s_nop 0
    buffer_load_dwordx4 v2, s[12:15], s19 offen lds
    s_add_u32 s19, s19, s20
    s_add_u32 m0, s22, 65536
    s_nop 0
    buffer_load_dwordx4 v2, s[8:11], s18 offen lds
    s_add_u32 s18, s18, s20
    s_add_u32 m0, s22, 73728
    s_nop 0
    buffer_load_dwordx4 v2, s[12:15], s19 offen lds
    s_add_u32 s19, s19, s20
    s_add_u32 m0, s22, 98304
    s_nop 0
    buffer_load_dwordx4 v2, s[8:11], s18 offen lds
    s_add_u32 s18, s18, s20
    s_add_u32 m0, s22, 106496
    s_nop 0
    buffer_load_dwordx4 v2, s[12:15], s19 offen lds
    s_add_u32 s19, s19, s20
    s_cmp_eq_u32 s32, 4
    s_cselect_b32 s70, 1, 0
    s_cmp_eq_u32 s39, 0
    s_cselect_b32 s70, s70, 0
    s_cmp_lg_u32 s3, 0
    s_cbranch_scc1 lnwp_ok
    s_cmp_eq_u32 s70, 0
    s_cbranch_scc1 lnwp_full
    s_mov_b32 s69, 65536
lnwap:
    buffer_load_dword v20, off, s[64:67], 0 offset:192 sc1
    s_waitcnt vmcnt(0)
    v_readfirstlane_b32 s68, v20
    s_cmp_ge_u32 s68, 8
    s_cbranch_scc1 lnwap_ok
    s_sleep 8
    s_sub_u32 s69, s69, 1
    s_cbranch_scc0 lnwap
lnwap_ok:
    s_branch lnwp_ok
lnwp_full:
    s_mov_b32 s69, 65536
lnwp:
    buffer_load_dword v20, off, s[64:67], 0 offset:0 sc1
    s_waitcnt vmcnt(0)
    v_readfirstlane_b32 s68, v20
    s_cmp_ge_u32 s68, 128
    s_cbranch_scc1 lnwp_ok
    s_sleep 8
    s_sub_u32 s69, s69, 1
    s_cbranch_scc0 lnwp
lnwp_ok:
    s_barrier
    s_add_u32 m0, s21, 0
    s_nop 0
    buffer_load_dwordx4 v1, s[4:7], s16 offen sc1 lds
    s_add_u32 s16, s16, s62
    s_add_u32 m0, s21, 1024
    s_nop 0
    buffer_load_dwordx4 v1, s[4:7], s17 offen sc1 lds
    s_add_u32 s17, s17, s62
    s_add_u32 m0, s21, 32768
    s_nop 0
    buffer_load_dwordx4 v1, s[4:7], s16 offen sc1 lds
    s_add_u32 s16, s16, s62
    s_add_u32 m0, s21, 33792
    s_nop 0
    buffer_load_dwordx4 v1, s[4:7], s17 offen sc1 lds
    s_add_u32 s17, s17, s62
    s_add_u32 m0, s21, 65536
    s_nop 0
    buffer_load_dwordx4 v1, s[4:7], s16 offen sc1 lds
    s_add_u32 s16, s16, s62
    s_add_u32 m0, s21, 66560
    s_nop 0
    buffer_load_dwordx4 v1, s[4:7], s17 offen sc1 lds
    s_add_u32 s17, s17, s62
    s_add_u32 m0, s21, 98304
    s_nop 0
    buffer_load_dwordx4 v1, s[4:7], s16 offen sc1 lds
    s_add_u32 s16, s16, s62
    s_add_u32 m0, s21, 99328
    s_nop 0
    buffer_load_dwordx4 v1, s[4:7], s17 offen sc1 lds
    s_add_u32 s17, s17, s62
    s_branch w_adopt
w_nopre:
    s_cmp_eq_u32 s32, 4
    s_cselect_b32 s70, 1, 0
    s_cmp_eq_u32 s39, 0
    s_cselect_b32 s70, s70, 0
    s_cmp_lg_u32 s3, 0
    s_cbranch_scc1 lnw_ok
    s_cmp_eq_u32 s70, 0
    s_cbranch_scc1 lnw_full
    s_mov_b32 s69, 65536
lnwa:
    buffer_load_dword v20, off, s[64:67], 0 offset:192 sc1
    s_waitcnt vmcnt(0)
    v_readfirstlane_b32 s68, v20
    s_cmp_ge_u32 s68, 8
    s_cbranch_scc1 lnwa_ok
    s_sleep 8
    s_sub_u32 s69, s69, 1
    s_cbranch_scc0 lnwa
lnwa_ok:
    s_branch lnw_ok
lnw_full:
    s_mov_b32 s69, 65536
lnw:
    buffer_load_dword v20, off, s[64:67], 0 offset:0 sc1
    s_waitcnt vmcnt(0)
    v_readfirstlane_b32 s68, v20
    s_cmp_ge_u32 s68, 128
    s_cbranch_scc1 lnw_ok
    s_sleep 8
    s_sub_u32 s69, s69, 1
    s_cbranch_scc0 lnw
lnw_ok:
    s_barrier
w_cold:
    s_cmp_eq_u32 s32, 0
    s_cbranch_scc1 k_end
    s_cmp_ge_u32 s32, 6
    s_cbranch_scc1 w_fin
    s_cmp_lg_u32 s3, 0
    s_cbranch_scc1 w_depok
    s_cmp_eq_u32 s45, 0
    s_cbranch_scc1 w_depok
    s_mov_b32 s31, 0x40000
w_waitdep:
    buffer_load_dword v16, v17, s[4:7], s44 offen sc1
    s_waitcnt vmcnt(0)
    v_readfirstlane_b32 s30, v16
    s_cmp_ge_u32 s30, s45
    s_cbranch_scc1 w_depok
    s_sleep 16
    s_sub_u32 s31, s31, 1
    s_cbranch_scc0 w_waitdep
w_depok:
    s_cmp_eq_u32 s32, 5
    s_cbranch_scc1 w_att
    s_load_dwordx2 s[8:9], s[0:1], s33
    s_load_dwordx2 s[12:13], s[0:1], s34
    s_mov_b32 s10, s38
    s_mov_b32 s14, s38
    s_cmp_eq_u32 s32, 4
    s_cselect_b32 s31, 0, 1
    s_lshl_b32 s30, s3, s31
    s_mul_i32 s30, s30, s40
    s_add_u32 s16, s39, s30
    s_cmp_eq_u32 s32, 4
    s_cselect_b32 s30, 1024, s40
    s_cselect_b32 s31, 6, 5
    s_lshl_b32 s62, 32, s31
    s_add_u32 s17, s16, s30
    s_lshl_b32 s30, s3, 2
    s_mul_i32 s30, s30, s35
    s_add_u32 s18, s36, s30
    s_add_u32 s19, s37, s30
    s_lshl_b32 s20, s35, s31
    v_mul_u32_u24 v2, s35, v4
    v_add_u32 v2, v2, v3
    s_waitcnt lgkmcnt(0)
    s_barrier
    s_add_u32 m0, s21, 0
    s_nop 0
    buffer_load_dwordx4 v1, s[4:7], s16 offen sc1 lds
    s_add_u32 s16, s16, s62
    s_add_u32 m0, s21, 1024
    s_nop 0
    buffer_load_dwordx4 v1, s[4:7], s17 offen sc1 lds
    s_add_u32 s17, s17, s62
    s_add_u32 m0, s22, 0
    s_nop 0
    buffer_load_dwordx4 v2, s[8:11], s18 offen lds
    s_add_u32 s18, s18, s20
    s_add_u32 m0, s22, 8192
    s_nop 0
    buffer_load_dwordx4 v2, s[12:15], s19 offen lds
    s_add_u32 s19, s19, s20
    s_add_u32 m0, s21, 32768
    s_nop 0
    buffer_load_dwordx4 v1, s[4:7], s16 offen sc1 lds
    s_add_u32 s16, s16, s62
    s_add_u32 m0, s21, 33792
    s_nop 0
    buffer_load_dwordx4 v1, s[4:7], s17 offen sc1 lds
    s_add_u32 s17, s17, s62
    s_add_u32 m0, s22, 32768
    s_nop 0
    buffer_load_dwordx4 v2, s[8:11], s18 offen lds
    s_add_u32 s18, s18, s20
    s_add_u32 m0, s22, 40960
    s_nop 0
    buffer_load_dwordx4 v2, s[12:15], s19 offen lds
    s_add_u32 s19, s19, s20
    s_add_u32 m0, s21, 65536
    s_nop 0
    buffer_load_dwordx4 v1, s[4:7], s16 offen sc1 lds
    s_add_u32 s16, s16, s62
    s_add_u32 m0, s21, 66560
    s_nop 0
    buffer_load_dwordx4 v1, s[4:7], s17 offen sc1 lds
    s_add_u32 s17, s17, s62
    s_add_u32 m0, s22, 65536
    s_nop 0
    buffer_load_dwordx4 v2, s[8:11], s18 offen lds
    s_add_u32 s18, s18, s20
    s_add_u32 m0, s22, 73728
    s_nop 0
    buffer_load_dwordx4 v2, s[12:15], s19 offen lds
    s_add_u32 s19, s19, s20
    s_add_u32 m0, s21, 98304
    s_nop 0
    buffer_load_dwordx4 v1, s[4:7], s16 offen sc1 lds
    s_add_u32 s16, s16, s62
    s_add_u32 m0, s21, 99328
    s_nop 0
    buffer_load_dwordx4 v1, s[4:7], s17 offen sc1 lds
    s_add_u32 s17, s17, s62
    s_add_u32 m0, s22, 98304
    s_nop 0
    buffer_load_dwordx4 v2, s[8:11], s18 offen lds
    s_add_u32 s18, s18, s20
    s_add_u32 m0, s22, 106496
    s_nop 0
    buffer_load_dwordx4 v2, s[12:15], s19 offen lds
    s_add_u32 s19, s19, s20
w_adopt:
    s_mov_b32 s48, s32
    s_cmp_eq_u32 s32, 4
    s_cselect_b32 s30, 2, 3
    s_lshl_b32 s30, s26, s30
    s_mul_i32 s30, s30, s43
    s_add_u32 s49, s42, s30
    s_mov_b32 s50, s43
    s_mov_b32 s51, s46
    s_mov_b32 s23, s41
    s_mov_b32 s53, s41
    s_waitcnt vmcnt(0)
    s_barrier
    ds_read_b64_tr_b16 v[64:65], v8 offset:16384
    ds_read_b64_tr_b16 v[66:67], v9 offset:16384
    ds_read_b64_tr_b16 v[68:69], v10 offset:16384
    ds_read_b64_tr_b16 v[70:71], v11 offset:16384
    ds_read_b64_tr_b16 v[72:73], v8 offset:24576
    ds_read_b64_tr_b16 v[74:75], v9 offset:24576
    ds_read_b64_tr_b16 v[76:77], v10 offset:24576
    ds_read_b64_tr_b16 v[78:79], v11 offset:24576
    ds_read_b128 v[32:35], v5 offset:0
    ds_read_b128 v[36:39], v5 offset:1024
    ds_read_b128 v[40:43], v5 offset:2048
    ds_read_b128 v[44:47], v5 offset:3072
    ds_read_b128 v[48:51], v5 offset:4096
    ds_read_b128 v[52:55], v5 offset:5120
    ds_read_b128 v[56:59], v5 offset:6144
    ds_read_b128 v[60:63], v5 offset:7168
    s_waitcnt lgkmcnt(0)
    s_cmp_eq_u32 s48, 4
    s_cbranch_scc1 w_firstH
    s_branch w_first16
w_first4:
    s_waitcnt vmcnt(12)
    s_barrier
    v_mfma_f32_16x16x32_bf16 v[128:131], v[64:67], v[32:35], 0
    s_add_u32 m0, s21, 0
    s_nop 0
    buffer_load_dwordx4 v1, s[4:7], s16 offen sc1 lds
    s_add_u32 s16, s16, s62
    v_mfma_f32_16x16x32_bf16 v[132:135], v[68:71], v[32:35], 0
    ds_read_b64_tr_b16 v[112:113], v8 offset:49152
    v_mfma_f32_16x16x32_bf16 v[136:139], v[72:75], v[32:35], 0
    ds_read_b64_tr_b16 v[114:115], v9 offset:49152
    v_mfma_f32_16x16x32_bf16 v[140:143], v[76:79], v[32:35], 0
    ds_read_b64_tr_b16 v[116:117], v10 offset:49152
    v_mfma_f32_16x16x32_bf16 v[144:147], v[64:67], v[36:39], 0
    s_add_u32 m0, s21, 1024
    s_nop 0
    buffer_load_dwordx4 v1, s[4:7], s17 offen sc1 lds
    s_add_u32 s17, s17, s62
    v_mfma_f32_16x16x32_bf16 v[148:151], v[68:71], v[36:39], 0
    ds_read_b64_tr_b16 v[118:119], v11 offset:49152
    v_mfma_f32_16x16x32_bf16 v[152:155], v[72:75], v[36:39], 0
    ds_read_b64_tr_b16 v[120:121], v8 offset:57344
    v_mfma_f32_16x16x32_bf16 v[156:159], v[76:79], v[36:39], 0
    ds_read_b64_tr_b16 v[122:123], v9 offset:57344
    v_mfma_f32_16x16x32_bf16 v[160:163], v[64:67], v[40:43], 0
    s_add_u32 m0, s22, 0
    s_nop 0
    buffer_load_dwordx4 v2, s[8:11], s18 offen lds
    s_add_u32 s18, s18, s20
    v_mfma_f32_16x16x32_bf16 v[164:167], v[68:71], v[40:43], 0
    ds_read_b64_tr_b16 v[124:125], v10 offset:57344
    v_mfma_f32_16x16x32_bf16 v[168:171], v[72:75], v[40:43], 0
    ds_read_b64_tr_b16 v[126:127], v11 offset:57344
    v_mfma_f32_16x16x32_bf16 v[172:175], v[76:79], v[40:43], 0
    ds_read_b128 v[80:83], v5 offset:32768
    v_mfma_f32_16x16x32_bf16 v[176:179], v[64:67], v[44:47], 0
    s_add_u32 m0, s22, 8192
    s_nop 0
    buffer_load_dwordx4 v2, s[12:15], s19 offen lds
    s_add_u32 s19, s19, s20
    v_mfma_f32_16x16x32_bf16 v[180:183], v[68:71], v[44:47], 0
    ds_read_b128 v[84:87], v5 offset:33792
    v_mfma_f32_16x16x32_bf16 v[184:187], v[72:75], v[44:47], 0
    ds_read_b128 v[88:91], v5 offset:34816
    v_mfma_f32_16x16x32_bf16 v[188:191], v[76:79], v[44:47], 0
    ds_read_b128 v[92:95], v5 offset:35840
    v_mfma_f32_16x16x32_bf16 v[192:195], v[64:67], v[48:51], 0
    ds_read_b128 v[96:99], v5 offset:36864
    v_mfma_f32_16x16x32_bf16 v[196:199], v[68:71], v[48:51], 0
    ds_read_b128 v[100:103], v5 offset:37888
    v_mfma_f32_16x16x32_bf16 v[200:203], v[72:75], v[48:51], 0
    ds_read_b128 v[104:107], v5 offset:38912
    v_mfma_f32_16x16x32_bf16 v[204:207], v[76:79], v[48:51], 0
    ds_read_b128 v[108:111], v5 offset:39936
    v_mfma_f32_16x16x32_bf16 v[208:211], v[64:67], v[52:55], 0
    v_mfma_f32_16x16x32_bf16 v[212:215], v[68:71], v[52:55], 0
    v_mfma_f32_16x16x32_bf16 v[216:219], v[72:75], v[52:55], 0
    v_mfma_f32_16x16x32_bf16 v[220:223], v[76:79], v[52:55], 0
    v_mfma_f32_16x16x32_bf16 v[224:227], v[64:67], v[56:59], 0
    v_mfma_f32_16x16x32_bf16 v[228:231], v[68:71], v[56:59], 0
    v_mfma_f32_16x16x32_bf16 v[232:235], v[72:75], v[56:59], 0
    v_mfma_f32_16x16x32_bf16 v[236:239], v[76:79], v[56:59], 0
    v_mfma_f32_16x16x32_bf16 v[240:243], v[64:67], v[60:63], 0
    v_mfma_f32_16x16x32_bf16 v[244:247], v[68:71], v[60:63], 0
    v_mfma_f32_16x16x32_bf16 v[248:251], v[72:75], v[60:63], 0
    v_mfma_f32_16x16x32_bf16 v[252:255], v[76:79], v[60:63], 0
    s_waitcnt lgkmcnt(0)
w_first4_q1:
    s_waitcnt vmcnt(12)
    s_barrier
    v_mfma_f32_16x16x32_bf16 v[128:131], v[112:115], v[80:83], v[128:131]
    s_add_u32 m0, s21, 32768
    s_nop 0
    buffer_load_dwordx4 v1, s[4:7], s16 offen sc1 lds
    s_add_u32 s16, s16, s62
    v_mfma_f32_16x16x32_bf16 v[132:135], v[116:119], v[80:83], v[132:135]
    ds_read_b64_tr_b16 v[64:65], v12 offset:16384
    v_mfma_f32_16x16x32_bf16 v[136:139], v[120:123], v[80:83], v[136:139]
    ds_read_b64_tr_b16 v[66:67], v13 offset:16384
    v_mfma_f32_16x16x32_bf16 v[140:143], v[124:127], v[80:83], v[140:143]
    ds_read_b64_tr_b16 v[68:69], v14 offset:16384
    v_mfma_f32_16x16x32_bf16 v[144:147], v[112:115], v[84:87], v[144:147]
    s_add_u32 m0, s21, 33792
    s_nop 0
    buffer_load_dwordx4 v1, s[4:7], s17 offen sc1 lds
    s_add_u32 s17, s17, s62
    v_mfma_f32_16x16x32_bf16 v[148:151], v[116:119], v[84:87], v[148:151]
    ds_read_b64_tr_b16 v[70:71], v15 offset:16384
    v_mfma_f32_16x16x32_bf16 v[152:155], v[120:123], v[84:87], v[152:155]
    ds_read_b64_tr_b16 v[72:73], v12 offset:24576
    v_mfma_f32_16x16x32_bf16 v[156:159], v[124:127], v[84:87], v[156:159]
    ds_read_b64_tr_b16 v[74:75], v13 offset:24576
    v_mfma_f32_16x16x32_bf16 v[160:163], v[112:115], v[88:91], v[160:163]
    s_add_u32 m0, s22, 32768
    s_nop 0
    buffer_load_dwordx4 v2, s[8:11], s18 offen lds
    s_add_u32 s18, s18, s20
    v_mfma_f32_16x16x32_bf16 v[164:167], v[116:119], v[88:91], v[164:167]
    ds_read_b64_tr_b16 v[76:77], v14 offset:24576
    v_mfma_f32_16x16x32_bf16 v[168:171], v[120:123], v[88:91], v[168:171]
    ds_read_b64_tr_b16 v[78:79], v15 offset:24576
    v_mfma_f32_16x16x32_bf16 v[172:175], v[124:127], v[88:91], v[172:175]
    ds_read_b128 v[32:35], v6 offset:0
    v_mfma_f32_16x16x32_bf16 v[176:179], v[112:115], v[92:95], v[176:179]
    s_add_u32 m0, s22, 40960
    s_nop 0
    buffer_load_dwordx4 v2, s[12:15], s19 offen lds
    s_add_u32 s19, s19, s20
    v_mfma_f32_16x16x32_bf16 v[180:183], v[116:119], v[92:95], v[180:183]
    ds_read_b128 v[36:39], v6 offset:1024
    v_mfma_f32_16x16x32_bf16 v[184:187], v[120:123], v[92:95], v[184:187]
    ds_read_b128 v[40:43], v6 offset:2048
    v_mfma_f32_16x16x32_bf16 v[188:191], v[124:127], v[92:95], v[188:191]
    ds_read_b128 v[44:47], v6 offset:3072
    v_mfma_f32_16x16x32_bf16 v[192:195], v[112:115], v[96:99], v[192:195]
    ds_read_b128 v[48:51], v6 offset:4096
    v_mfma_f32_16x16x32_bf16 v[196:199], v[116:119], v[96:99], v[196:199]
    ds_read_b128 v[52:55], v6 offset:5120
    v_mfma_f32_16x16x32_bf16 v[200:203], v[120:123], v[96:99], v[200:203]
    ds_read_b128 v[56:59], v6 offset:6144
    v_mfma_f32_16x16x32_bf16 v[204:207], v[124:127], v[96:99], v[204:207]
    ds_read_b128 v[60:63], v6 offset:7168
    v_mfma_f32_16x16x32_bf16 v[208:211], v[112:115], v[100:103], v[208:211]
    v_mfma_f32_16x16x32_bf16 v[212:215], v[116:119], v[100:103], v[212:215]
    v_mfma_f32_16x16x32_bf16 v[216:219], v[120:123], v[100:103], v[216:219]
    v_mfma_f32_16x16x32_bf16 v[220:223], v[124:127], v[100:103], v[220:223]
    v_mfma_f32_16x16x32_bf16 v[224:227], v[112:115], v[104:107], v[224:227]
    v_mfma_f32_16x16x32_bf16 v[228:231], v[116:119], v[104:107], v[228:231]
    v_mfma_f32_16x16x32_bf16 v[232:235], v[120:123], v[104:107], v[232:235]
    v_mfma_f32_16x16x32_bf16 v[236:239], v[124:127], v[104:107], v[236:239]
    v_mfma_f32_16x16x32_bf16 v[240:243], v[112:115], v[108:111], v[240:243]
    v_mfma_f32_16x16x32_bf16 v[244:247], v[116:119], v[108:111], v[244:247]
    v_mfma_f32_16x16x32_bf16 v[248:251], v[120:123], v[108:111], v[248:251]
    v_mfma_f32_16x16x32_bf16 v[252:255], v[124:127], v[108:111], v[252:255]
    s_waitcnt lgkmcnt(0)
    s_waitcnt vmcnt(12)
    s_barrier
    v_mfma_f32_16x16x32_bf16 v[128:131], v[64:67], v[32:35], v[128:131]
    s_add_u32 m0, s21, 65536
    s_nop 0
    buffer_load_dwordx4 v1, s[4:7], s16 offen sc1 lds
    s_add_u32 s16, s16, s62
    v_mfma_f32_16x16x32_bf16 v[132:135], v[68:71], v[32:35], v[132:135]
    ds_read_b64_tr_b16 v[112:113], v12 offset:49152
    v_mfma_f32_16x16x32_bf16 v[136:139], v[72:75], v[32:35], v[136:139]
    ds_read_b64_tr_b16 v[114:115], v13 offset:49152
    v_mfma_f32_16x16x32_bf16 v[140:143], v[76:79], v[32:35], v[140:143]
    ds_read_b64_tr_b16 v[116:117], v14 offset:49152
    v_mfma_f32_16x16x32_bf16 v[144:147], v[64:67], v[36:39], v[144:147]
    s_add_u32 m0, s21, 66560
    s_nop 0
    buffer_load_dwordx4 v1, s[4:7], s17 offen sc1 lds
    s_add_u32 s17, s17, s62
    v_mfma_f32_16x16x32_bf16 v[148:151], v[68:71], v[36:39], v[148:151]
    ds_read_b64_tr_b16 v[118:119], v15 offset:49152
    v_mfma_f32_16x16x32_bf16 v[152:155], v[72:75], v[36:39], v[152:155]
    ds_read_b64_tr_b16 v[120:121], v12 offset:57344
    v_mfma_f32_16x16x32_bf16 v[156:159], v[76:79], v[36:39], v[156:159]
    ds_read_b64_tr_b16 v[122:123], v13 offset:57344
    v_mfma_f32_16x16x32_bf16 v[160:163], v[64:67], v[40:43], v[160:163]
    s_add_u32 m0, s22, 65536
    s_nop 0
    buffer_load_dwordx4 v2, s[8:11], s18 offen lds
    s_add_u32 s18, s18, s20
    v_mfma_f32_16x16x32_bf16 v[164:167], v[68:71], v[40:43], v[164:167]
    ds_read_b64_tr_b16 v[124:125], v14 offset:57344
    v_mfma_f32_16x16x32_bf16 v[168:171], v[72:75], v[40:43], v[168:171]
    ds_read_b64_tr_b16 v[126:127], v15 offset:57344
    v_mfma_f32_16x16x32_bf16 v[172:175], v[76:79], v[40:43], v[172:175]
    ds_read_b128 v[80:83], v6 offset:32768
    v_mfma_f32_16x16x32_bf16 v[176:179], v[64:67], v[44:47], v[176:179]
    s_add_u32 m0, s22, 73728
    s_nop 0
    buffer_load_dwordx4 v2, s[12:15], s19 offen lds
    s_add_u32 s19, s19, s20
    v_mfma_f32_16x16x32_bf16 v[180:183], v[68:71], v[44:47], v[180:183]
    ds_read_b128 v[84:87], v6 offset:33792
    v_mfma_f32_16x16x32_bf16 v[184:187], v[72:75], v[44:47], v[184:187]
    ds_read_b128 v[88:91], v6 offset:34816
    v_mfma_f32_16x16x32_bf16 v[188:191], v[76:79], v[44:47], v[188:191]
    ds_read_b128 v[92:95], v6 offset:35840
    v_mfma_f32_16x16x32_bf16 v[192:195], v[64:67], v[48:51], v[192:195]
    ds_read_b128 v[96:99], v6 offset:36864
    v_mfma_f32_16x16x32_bf16 v[196:199], v[68:71], v[48:51], v[196:199]
    ds_read_b128 v[100:103], v6 offset:37888
    v_mfma_f32_16x16x32_bf16 v[200:203], v[72:75], v[48:51], v[200:203]
    ds_read_b128 v[104:107], v6 offset:38912
    v_mfma_f32_16x16x32_bf16 v[204:207], v[76:79], v[48:51], v[204:207]
    ds_read_b128 v[108:111], v6 offset:39936
    v_mfma_f32_16x16x32_bf16 v[208:211], v[64:67], v[52:55], v[208:211]
    v_mfma_f32_16x16x32_bf16 v[212:215], v[68:71], v[52:55], v[212:215]
    v_mfma_f32_16x16x32_bf16 v[216:219], v[72:75], v[52:55], v[216:219]
    v_mfma_f32_16x16x32_bf16 v[220:223], v[76:79], v[52:55], v[220:223]
    v_mfma_f32_16x16x32_bf16 v[224:227], v[64:67], v[56:59], v[224:227]
    v_mfma_f32_16x16x32_bf16 v[228:231], v[68:71], v[56:59], v[228:231]
    v_mfma_f32_16x16x32_bf16 v[232:235], v[72:75], v[56:59], v[232:235]
    v_mfma_f32_16x16x32_bf16 v[236:239], v[76:79], v[56:59], v[236:239]
    v_mfma_f32_16x16x32_bf16 v[240:243], v[64:67], v[60:63], v[240:243]
    v_mfma_f32_16x16x32_bf16 v[244:247], v[68:71], v[60:63], v[244:247]
    v_mfma_f32_16x16x32_bf16 v[248:251], v[72:75], v[60:63], v[248:251]
    v_mfma_f32_16x16x32_bf16 v[252:255], v[76:79], v[60:63], v[252:255]
    s_waitcnt lgkmcnt(0)
    s_waitcnt vmcnt(8)
    s_barrier
    s_cmp_eq_u32 s28, 0
    s_cbranch_scc1 sig_3
    s_cmp_lg_u32 s3, 0
    s_cbranch_scc1 sig_3
    s_and_b32 s57, s28, 3
    v_mov_b32 v24, s57
    s_bfe_u32 s57, s28, 0x20002
    v_mov_b32 v25, s57
    s_andn2_b32 s28, s28, 15
    s_mov_b64 exec, 1
    buffer_atomic_add_x2 v[24:25], v17, s[4:7], s28 offen sc1
    s_mov_b64 exec, -1
sig_3:
    s_mov_b32 s28, 0
    v_mfma_f32_16x16x32_bf16 v[128:131], v[112:115], v[80:83], v[128:131]
    s_add_u32 m0, s21, 98304
    s_nop 0
    buffer_load_dwordx4 v1, s[4:7], s16 offen sc1 lds
    s_add_u32 s16, s16, s62
    v_mfma_f32_16x16x32_bf16 v[132:135], v[116:119], v[80:83], v[132:135]
    ds_read_b64_tr_b16 v[64:65], v8 offset:16384
    v_mfma_f32_16x16x32_bf16 v[136:139], v[120:123], v[80:83], v[136:139]
    ds_read_b64_tr_b16 v[66:67], v9 offset:16384
    v_mfma_f32_16x16x32_bf16 v[140:143], v[124:127], v[80:83], v[140:143]
    ds_read_b64_tr_b16 v[68:69], v10 offset:16384
    v_mfma_f32_16x16x32_bf16 v[144:147], v[112:115], v[84:87], v[144:147]
    s_add_u32 m0, s21, 99328
    s_nop 0
    buffer_load_dwordx4 v1, s[4:7], s17 offen sc1 lds
    s_add_u32 s17, s17, s62
    v_mfma_f32_16x16x32_bf16 v[148:151], v[116:119], v[84:87], v[148:151]
    ds_read_b64_tr_b16 v[70:71], v11 offset:16384
    v_mfma_f32_16x16x32_bf16 v[152:155], v[120:123], v[84:87], v[152:155]
    ds_read_b64_tr_b16 v[72:73], v8 offset:24576
    v_mfma_f32_16x16x32_bf16 v[156:159], v[124:127], v[84:87], v[156:159]
    ds_read_b64_tr_b16 v[74:75], v9 offset:24576
    v_mfma_f32_16x16x32_bf16 v[160:163], v[112:115], v[88:91], v[160:163]
    s_add_u32 m0, s22, 98304
    s_nop 0
    buffer_load_dwordx4 v2, s[8:11], s18 offen lds
    s_add_u32 s18, s18, s20
    v_mfma_f32_16x16x32_bf16 v[164:167], v[116:119], v[88:91], v[164:167]
    ds_read_b64_tr_b16 v[76:77], v10 offset:24576
    v_mfma_f32_16x16x32_bf16 v[168:171], v[120:123], v[88:91], v[168:171]
    ds_read_b64_tr_b16 v[78:79], v11 offset:24576
    v_mfma_f32_16x16x32_bf16 v[172:175], v[124:127], v[88:91], v[172:175]
    ds_read_b128 v[32:35], v5 offset:0
    v_mfma_f32_16x16x32_bf16 v[176:179], v[112:115], v[92:95], v[176:179]
    s_add_u32 m0, s22, 106496
    s_nop 0
    buffer_load_dwordx4 v2, s[12:15], s19 offen lds
    s_add_u32 s19, s19, s20
    v_mfma_f32_16x16x32_bf16 v[180:183], v[116:119], v[92:95], v[180:183]
    ds_read_b128 v[36:39], v5 offset:1024
    v_mfma_f32_16x16x32_bf16 v[184:187], v[120:123], v[92:95], v[184:187]
    ds_read_b128 v[40:43], v5 offset:2048
    v_mfma_f32_16x16x32_bf16 v[188:191], v[124:127], v[92:95], v[188:191]
    ds_read_b128 v[44:47], v5 offset:3072
    v_mfma_f32_16x16x32_bf16 v[192:195], v[112:115], v[96:99], v[192:195]
    ds_read_b128 v[48:51], v5 offset:4096
    v_mfma_f32_16x16x32_bf16 v[196:199], v[116:119], v[96:99], v[196:199]
    ds_read_b128 v[52:55], v5 offset:5120
    v_mfma_f32_16x16x32_bf16 v[200:203], v[120:123], v[96:99], v[200:203]
    ds_read_b128 v[56:59], v5 offset:6144
    v_mfma_f32_16x16x32_bf16 v[204:207], v[124:127], v[96:99], v[204:207]
    ds_read_b128 v[60:63], v5 offset:7168
    v_mfma_f32_16x16x32_bf16 v[208:211], v[112:115], v[100:103], v[208:211]
    v_mfma_f32_16x16x32_bf16 v[212:215], v[116:119], v[100:103], v[212:215]
    v_mfma_f32_16x16x32_bf16 v[216:219], v[120:123], v[100:103], v[216:219]
    v_mfma_f32_16x16x32_bf16 v[220:223], v[124:127], v[100:103], v[220:223]
    v_mfma_f32_16x16x32_bf16 v[224:227], v[112:115], v[104:107], v[224:227]
    v_mfma_f32_16x16x32_bf16 v[228:231], v[116:119], v[104:107], v[228:231]
    v_mfma_f32_16x16x32_bf16 v[232:235], v[120:123], v[104:107], v[232:235]
    v_mfma_f32_16x16x32_bf16 v[236:239], v[124:127], v[104:107], v[236:239]
    v_mfma_f32_16x16x32_bf16 v[240:243], v[112:115], v[108:111], v[240:243]
    v_mfma_f32_16x16x32_bf16 v[244:247], v[116:119], v[108:111], v[244:247]
    v_mfma_f32_16x16x32_bf16 v[248:251], v[120:123], v[108:111], v[248:251]
    v_mfma_f32_16x16x32_bf16 v[252:255], v[124:127], v[108:111], v[252:255]
    s_waitcnt lgkmcnt(0)
    s_branch w_loop_chk
w_first8:
    s_waitcnt vmcnt(16)
    s_barrier
    v_mfma_f32_16x16x32_bf16 v[128:131], v[64:67], v[32:35], 0
    s_add_u32 m0, s21, 0
    s_nop 0
    buffer_load_dwordx4 v1, s[4:7], s16 offen sc1 lds
    s_add_u32 s16, s16, s62
    v_mfma_f32_16x16x32_bf16 v[132:135], v[68:71], v[32:35], 0
    ds_read_b64_tr_b16 v[112:113], v8 offset:49152
    v_mfma_f32_16x16x32_bf16 v[136:139], v[72:75], v[32:35], 0
    ds_read_b64_tr_b16 v[114:115], v9 offset:49152
    v_mfma_f32_16x16x32_bf16 v[140:143], v[76:79], v[32:35], 0
    ds_read_b64_tr_b16 v[116:117], v10 offset:49152
    v_mfma_f32_16x16x32_bf16 v[144:147], v[64:67], v[36:39], 0
    s_add_u32 m0, s21, 1024
    s_nop 0
    buffer_load_dwordx4 v1, s[4:7], s17 offen sc1 lds
    s_add_u32 s17, s17, s62
    v_mfma_f32_16x16x32_bf16 v[148:151], v[68:71], v[36:39], 0
    ds_read_b64_tr_b16 v[118:119], v11 offset:49152
    v_mfma_f32_16x16x32_bf16 v[152:155], v[72:75], v[36:39], 0
    ds_read_b64_tr_b16 v[120:121], v8 offset:57344
    v_mfma_f32_16x16x32_bf16 v[156:159], v[76:79], v[36:39], 0
    ds_read_b64_tr_b16 v[122:123], v9 offset:57344
    v_mfma_f32_16x16x32_bf16 v[160:163], v[64:67], v[40:43], 0
    s_add_u32 m0, s22, 0
    s_nop 0
    buffer_load_dwordx4 v2, s[8:11], s18 offen lds
    s_add_u32 s18, s18, s20
    v_mfma_f32_16x16x32_bf16 v[164:167], v[68:71], v[40:43], 0
    ds_read_b64_tr_b16 v[124:125], v10 offset:57344
    v_mfma_f32_16x16x32_bf16 v[168:171], v[72:75], v[40:43], 0
    ds_read_b64_tr_b16 v[126:127], v11 offset:57344
    v_mfma_f32_16x16x32_bf16 v[172:175], v[76:79], v[40:43], 0
    ds_read_b128 v[80:83], v5 offset:32768
    v_mfma_f32_16x16x32_bf16 v[176:179], v[64:67], v[44:47], 0
    s_add_u32 m0, s22, 8192
    s_nop 0
    buffer_load_dwordx4 v2, s[12:15], s19 offen lds
    s_add_u32 s19, s19, s20
    v_mfma_f32_16x16x32_bf16 v[180:183], v[68:71], v[44:47], 0
    ds_read_b128 v[84:87], v5 offset:33792
    v_mfma_f32_16x16x32_bf16 v[184:187], v[72:75], v[44:47], 0
    ds_read_b128 v[88:91], v5 offset:34816
    v_mfma_f32_16x16x32_bf16 v[188:191], v[76:79], v[44:47], 0
    ds_read_b128 v[92:95], v5 offset:35840
    v_mfma_f32_16x16x32_bf16 v[192:195], v[64:67], v[48:51], 0
    ds_read_b128 v[96:99], v5 offset:36864
    v_mfma_f32_16x16x32_bf16 v[196:199], v[68:71], v[48:51], 0
    ds_read_b128 v[100:103], v5 offset:37888
    v_mfma_f32_16x16x32_bf16 v[200:203], v[72:75], v[48:51], 0
    ds_read_b128 v[104:107], v5 offset:38912
    v_mfma_f32_16x16x32_bf16 v[204:207], v[76:79], v[48:51], 0
    ds_read_b128 v[108:111], v5 offset:39936
    v_mfma_f32_16x16x32_bf16 v[208:211], v[64:67], v[52:55], 0
    v_mfma_f32_16x16x32_bf16 v[212:215], v[68:71], v[52:55], 0
    v_mfma_f32_16x16x32_bf16 v[216:219], v[72:75], v[52:55], 0
    v_mfma_f32_16x16x32_bf16 v[220:223], v[76:79], v[52:55], 0
    v_mfma_f32_16x16x32_bf16 v[224:227], v[64:67], v[56:59], 0
    v_mfma_f32_16x16x32_bf16 v[228:231], v[68:71], v[56:59], 0
    v_mfma_f32_16x16x32_bf16 v[232:235], v[72:75], v[56:59], 0
    v_mfma_f32_16x16x32_bf16 v[236:239], v[76:79], v[56:59], 0
    v_mfma_f32_16x16x32_bf16 v[240:243], v[64:67], v[60:63], 0
    v_mfma_f32_16x16x32_bf16 v[244:247], v[68:71], v[60:63], 0
    v_mfma_f32_16x16x32_bf16 v[248:251], v[72:75], v[60:63], 0
    v_mfma_f32_16x16x32_bf16 v[252:255], v[76:79], v[60:63], 0
    s_waitcnt lgkmcnt(0)
w_first8_q1:
    s_waitcnt vmcnt(16)
    s_barrier
    v_mfma_f32_16x16x32_bf16 v[128:131], v[112:115], v[80:83], v[128:131]
    s_add_u32 m0, s21, 32768
    s_nop 0
    buffer_load_dwordx4 v1, s[4:7], s16 offen sc1 lds
    s_add_u32 s16, s16, s62
    v_mfma_f32_16x16x32_bf16 v[132:135], v[116:119], v[80:83], v[132:135]
    ds_read_b64_tr_b16 v[64:65], v12 offset:16384
    v_mfma_f32_16x16x32_bf16 v[136:139], v[120:123], v[80:83], v[136:139]
    ds_read_b64_tr_b16 v[66:67], v13 offset:16384
    v_mfma_f32_16x16x32_bf16 v[140:143], v[124:127], v[80:83], v[140:143]
    ds_read_b64_tr_b16 v[68:69], v14 offset:16384
    v_mfma_f32_16x16x32_bf16 v[144:147], v[112:115], v[84:87], v[144:147]
    s_add_u32 m0, s21, 33792
    s_nop 0
    buffer_load_dwordx4 v1, s[4:7], s17 offen sc1 lds
    s_add_u32 s17, s17, s62
    v_mfma_f32_16x16x32_bf16 v[148:151], v[116:119], v[84:87], v[148:151]
    ds_read_b64_tr_b16 v[70:71], v15 offset:16384
    v_mfma_f32_16x16x32_bf16 v[152:155], v[120:123], v[84:87], v[152:155]
    ds_read_b64_tr_b16 v[72:73], v12 offset:24576
    v_mfma_f32_16x16x32_bf16 v[156:159], v[124:127], v[84:87], v[156:159]
    ds_read_b64_tr_b16 v[74:75], v13 offset:24576
    v_mfma_f32_16x16x32_bf16 v[160:163], v[112:115], v[88:91], v[160:163]
    s_add_u32 m0, s22, 32768
    s_nop 0
    buffer_load_dwordx4 v2, s[8:11], s18 offen lds
    s_add_u32 s18, s18, s20
    v_mfma_f32_16x16x32_bf16 v[164:167], v[116:119], v[88:91], v[164:167]
    ds_read_b64_tr_b16 v[76:77], v14 offset:24576
    v_mfma_f32_16x16x32_bf16 v[168:171], v[120:123], v[88:91], v[168:171]
    ds_read_b64_tr_b16 v[78:79], v15 offset:24576
    v_mfma_f32_16x16x32_bf16 v[172:175], v[124:127], v[88:91], v[172:175]
    ds_read_b128 v[32:35], v6 offset:0
    v_mfma_f32_16x16x32_bf16 v[176:179], v[112:115], v[92:95], v[176:179]
    s_add_u32 m0, s22, 40960
    s_nop 0
    buffer_load_dwordx4 v2, s[12:15], s19 offen lds
    s_add_u32 s19, s19, s20
    v_mfma_f32_16x16x32_bf16 v[180:183], v[116:119], v[92:95], v[180:183]
    ds_read_b128 v[36:39], v6 offset:1024
    v_mfma_f32_16x16x32_bf16 v[184:187], v[120:123], v[92:95], v[184:187]
    ds_read_b128 v[40:43], v6 offset:2048
    v_mfma_f32_16x16x32_bf16 v[188:191], v[124:127], v[92:95], v[188:191]
    ds_read_b128 v[44:47], v6 offset:3072
    v_mfma_f32_16x16x32_bf16 v[192:195], v[112:115], v[96:99], v[192:195]
    ds_read_b128 v[48:51], v6 offset:4096
    v_mfma_f32_16x16x32_bf16 v[196:199], v[116:119], v[96:99], v[196:199]
    ds_read_b128 v[52:55], v6 offset:5120
    v_mfma_f32_16x16x32_bf16 v[200:203], v[120:123], v[96:99], v[200:203]
    ds_read_b128 v[56:59], v6 offset:6144
    v_mfma_f32_16x16x32_bf16 v[204:207], v[124:127], v[96:99], v[204:207]
    ds_read_b128 v[60:63], v6 offset:7168
    v_mfma_f32_16x16x32_bf16 v[208:211], v[112:115], v[100:103], v[208:211]
    v_mfma_f32_16x16x32_bf16 v[212:215], v[116:119], v[100:103], v[212:215]
    v_mfma_f32_16x16x32_bf16 v[216:219], v[120:123], v[100:103], v[216:219]
    v_mfma_f32_16x16x32_bf16 v[220:223], v[124:127], v[100:103], v[220:223]
    v_mfma_f32_16x16x32_bf16 v[224:227], v[112:115], v[104:107], v[224:227]
    v_mfma_f32_16x16x32_bf16 v[228:231], v[116:119], v[104:107], v[228:231]
    v_mfma_f32_16x16x32_bf16 v[232:235], v[120:123], v[104:107], v[232:235]
    v_mfma_f32_16x16x32_bf16 v[236:239], v[124:127], v[104:107], v[236:239]
    v_mfma_f32_16x16x32_bf16 v[240:243], v[112:115], v[108:111], v[240:243]
    v_mfma_f32_16x16x32_bf16 v[244:247], v[116:119], v[108:111], v[244:247]
    v_mfma_f32_16x16x32_bf16 v[248:251], v[120:123], v[108:111], v[248:251]
    v_mfma_f32_16x16x32_bf16 v[252:255], v[124:127], v[108:111], v[252:255]
    s_waitcnt lgkmcnt(0)
    s_waitcnt vmcnt(16)
    s_barrier
    v_mfma_f32_16x16x32_bf16 v[128:131], v[64:67], v[32:35], v[128:131]
    s_add_u32 m0, s21, 65536
    s_nop 0
    buffer_load_dwordx4 v1, s[4:7], s16 offen sc1 lds
    s_add_u32 s16, s16, s62
    v_mfma_f32_16x16x32_bf16 v[132:135], v[68:71], v[32:35], v[132:135]
    ds_read_b64_tr_b16 v[112:113], v12 offset:49152
    v_mfma_f32_16x16x32_bf16 v[136:139], v[72:75], v[32:35], v[136:139]
    ds_read_b64_tr_b16 v[114:115], v13 offset:49152
    v_mfma_f32_16x16x32_bf16 v[140:143], v[76:79], v[32:35], v[140:143]
    ds_read_b64_tr_b16 v[116:117], v14 offset:49152
    v_mfma_f32_16x16x32_bf16 v[144:147], v[64:67], v[36:39], v[144:147]
    s_add_u32 m0, s21, 66560
    s_nop 0
    buffer_load_dwordx4 v1, s[4:7], s17 offen sc1 lds
    s_add_u32 s17, s17, s62
    v_mfma_f32_16x16x32_bf16 v[148:151], v[68:71], v[36:39], v[148:151]
    ds_read_b64_tr_b16 v[118:119], v15 offset:49152
    v_mfma_f32_16x16x32_bf16 v[152:155], v[72:75], v[36:39], v[152:155]
    ds_read_b64_tr_b16 v[120:121], v12 offset:57344
    v_mfma_f32_16x16x32_bf16 v[156:159], v[76:79], v[36:39], v[156:159]
    ds_read_b64_tr_b16 v[122:123], v13 offset:57344
    v_mfma_f32_16x16x32_bf16 v[160:163], v[64:67], v[40:43], v[160:163]
    s_add_u32 m0, s22, 65536
    s_nop 0
    buffer_load_dwordx4 v2, s[8:11], s18 offen lds
    s_add_u32 s18, s18, s20
    v_mfma_f32_16x16x32_bf16 v[164:167], v[68:71], v[40:43], v[164:167]
    ds_read_b64_tr_b16 v[124:125], v14 offset:57344
    v_mfma_f32_16x16x32_bf16 v[168:171], v[72:75], v[40:43], v[168:171]
    ds_read_b64_tr_b16 v[126:127], v15 offset:57344
    v_mfma_f32_16x16x32_bf16 v[172:175], v[76:79], v[40:43], v[172:175]
    ds_read_b128 v[80:83], v6 offset:32768
    v_mfma_f32_16x16x32_bf16 v[176:179], v[64:67], v[44:47], v[176:179]
    s_add_u32 m0, s22, 73728
    s_nop 0
    buffer_load_dwordx4 v2, s[12:15], s19 offen lds
    s_add_u32 s19, s19, s20
    v_mfma_f32_16x16x32_bf16 v[180:183], v[68:71], v[44:47], v[180:183]
    ds_read_b128 v[84:87], v6 offset:33792
    v_mfma_f32_16x16x32_bf16 v[184:187], v[72:75], v[44:47], v[184:187]
    ds_read_b128 v[88:91], v6 offset:34816
    v_mfma_f32_16x16x32_bf16 v[188:191], v[76:79], v[44:47], v[188:191]
    ds_read_b128 v[92:95], v6 offset:35840
    v_mfma_f32_16x16x32_bf16 v[192:195], v[64:67], v[48:51], v[192:195]
    ds_read_b128 v[96:99], v6 offset:36864
    v_mfma_f32_16x16x32_bf16 v[196:199], v[68:71], v[48:51], v[196:199]
    ds_read_b128 v[100:103], v6 offset:37888
    v_mfma_f32_16x16x32_bf16 v[200:203], v[72:75], v[48:51], v[200:203]
    ds_read_b128 v[104:107], v6 offset:38912
    v_mfma_f32_16x16x32_bf16 v[204:207], v[76:79], v[48:51], v[204:207]
    ds_read_b128 v[108:111], v6 offset:39936
    v_mfma_f32_16x16x32_bf16 v[208:211], v[64:67], v[52:55], v[208:211]
    v_mfma_f32_16x16x32_bf16 v[212:215], v[68:71], v[52:55], v[212:215]
    v_mfma_f32_16x16x32_bf16 v[216:219], v[72:75], v[52:55], v[216:219]
    v_mfma_f32_16x16x32_bf16 v[220:223], v[76:79], v[52:55], v[220:223]
    v_mfma_f32_16x16x32_bf16 v[224:227], v[64:67], v[56:59], v[224:227]
    v_mfma_f32_16x16x32_bf16 v[228:231], v[68:71], v[56:59], v[228:231]
    v_mfma_f32_16x16x32_bf16 v[232:235], v[72:75], v[56:59], v[232:235]
    v_mfma_f32_16x16x32_bf16 v[236:239], v[76:79], v[56:59], v[236:239]
    v_mfma_f32_16x16x32_bf16 v[240:243], v[64:67], v[60:63], v[240:243]
    v_mfma_f32_16x16x32_bf16 v[244:247], v[68:71], v[60:63], v[244:247]
    v_mfma_f32_16x16x32_bf16 v[248:251], v[72:75], v[60:63], v[248:251]
    v_mfma_f32_16x16x32_bf16 v[252:255], v[76:79], v[60:63], v[252:255]
    s_waitcnt lgkmcnt(0)
    s_waitcnt vmcnt(8)
    s_barrier
    s_cmp_eq_u32 s28, 0
    s_cbranch_scc1 sig_4
    s_cmp_lg_u32 s3, 0
    s_cbranch_scc1 sig_4
    s_and_b32 s57, s28, 3
    v_mov_b32 v24, s57
    s_bfe_u32 s57, s28, 0x20002
    v_mov_b32 v25, s57
    s_andn2_b32 s28, s28, 15
    s_mov_b64 exec, 1
    buffer_atomic_add_x2 v[24:25], v17, s[4:7], s28 offen sc1
    s_mov_b64 exec, -1
sig_4:
    s_mov_b32 s28, 0
    v_mfma_f32_16x16x32_bf16 v[128:131], v[112:115], v[80:83], v[128:131]
    s_add_u32 m0, s21, 98304
    s_nop 0
    buffer_load_dwordx4 v1, s[4:7], s16 offen sc1 lds
    s_add_u32 s16, s16, s62
    v_mfma_f32_16x16x32_bf16 v[132:135], v[116:119], v[80:83], v[132:135]
    ds_read_b64_tr_b16 v[64:65], v8 offset:16384
    v_mfma_f32_16x16x32_bf16 v[136:139], v[120:123], v[80:83], v[136:139]
    ds_read_b64_tr_b16 v[66:67], v9 offset:16384
    v_mfma_f32_16x16x32_bf16 v[140:143], v[124:127], v[80:83], v[140:143]
    ds_read_b64_tr_b16 v[68:69], v10 offset:16384
    v_mfma_f32_16x16x32_bf16 v[144:147], v[112:115], v[84:87], v[144:147]
    s_add_u32 m0, s21, 99328
    s_nop 0
    buffer_load_dwordx4 v1, s[4:7], s17 offen sc1 lds
    s_add_u32 s17, s17, s62
    v_mfma_f32_16x16x32_bf16 v[148:151], v[116:119], v[84:87], v[148:151]
    ds_read_b64_tr_b16 v[70:71], v11 offset:16384
    v_mfma_f32_16x16x32_bf16 v[152:155], v[120:123], v[84:87], v[152:155]
    ds_read_b64_tr_b16 v[72:73], v8 offset:24576
    v_mfma_f32_16x16x32_bf16 v[156:159], v[124:127], v[84:87], v[156:159]
    ds_read_b64_tr_b16 v[74:75], v9 offset:24576
    v_mfma_f32_16x16x32_bf16 v[160:163], v[112:115], v[88:91], v[160:163]
    s_add_u32 m0, s22, 98304
    s_nop 0
    buffer_load_dwordx4 v2, s[8:11], s18 offen lds
    s_add_u32 s18, s18, s20
    v_mfma_f32_16x16x32_bf16 v[164:167], v[116:119], v[88:91], v[164:167]
    ds_read_b64_tr_b16 v[76:77], v10 offset:24576
    v_mfma_f32_16x16x32_bf16 v[168:171], v[120:123], v[88:91], v[168:171]
    ds_read_b64_tr_b16 v[78:79], v11 offset:24576
    v_mfma_f32_16x16x32_bf16 v[172:175], v[124:127], v[88:91], v[172:175]
    ds_read_b128 v[32:35], v5 offset:0
    v_mfma_f32_16x16x32_bf16 v[176:179], v[112:115], v[92:95], v[176:179]
    s_add_u32 m0, s22, 106496
    s_nop 0
    buffer_load_dwordx4 v2, s[12:15], s19 offen lds
    s_add_u32 s19, s19, s20
    v_mfma_f32_16x16x32_bf16 v[180:183], v[116:119], v[92:95], v[180:183]
    ds_read_b128 v[36:39], v5 offset:1024
    v_mfma_f32_16x16x32_bf16 v[184:187], v[120:123], v[92:95], v[184:187]
    ds_read_b128 v[40:43], v5 offset:2048
    v_mfma_f32_16x16x32_bf16 v[188:191], v[124:127], v[92:95], v[188:191]
    ds_read_b128 v[44:47], v5 offset:3072
    v_mfma_f32_16x16x32_bf16 v[192:195], v[112:115], v[96:99], v[192:195]
    ds_read_b128 v[48:51], v5 offset:4096
    v_mfma_f32_16x16x32_bf16 v[196:199], v[116:119], v[96:99], v[196:199]
    ds_read_b128 v[52:55], v5 offset:5120
    v_mfma_f32_16x16x32_bf16 v[200:203], v[120:123], v[96:99], v[200:203]
    ds_read_b128 v[56:59], v5 offset:6144
    v_mfma_f32_16x16x32_bf16 v[204:207], v[124:127], v[96:99], v[204:207]
    ds_read_b128 v[60:63], v5 offset:7168
    v_mfma_f32_16x16x32_bf16 v[208:211], v[112:115], v[100:103], v[208:211]
    v_mfma_f32_16x16x32_bf16 v[212:215], v[116:119], v[100:103], v[212:215]
    v_mfma_f32_16x16x32_bf16 v[216:219], v[120:123], v[100:103], v[216:219]
    v_mfma_f32_16x16x32_bf16 v[220:223], v[124:127], v[100:103], v[220:223]
    v_mfma_f32_16x16x32_bf16 v[224:227], v[112:115], v[104:107], v[224:227]
    v_mfma_f32_16x16x32_bf16 v[228:231], v[116:119], v[104:107], v[228:231]
    v_mfma_f32_16x16x32_bf16 v[232:235], v[120:123], v[104:107], v[232:235]
    v_mfma_f32_16x16x32_bf16 v[236:239], v[124:127], v[104:107], v[236:239]
    v_mfma_f32_16x16x32_bf16 v[240:243], v[112:115], v[108:111], v[240:243]
    v_mfma_f32_16x16x32_bf16 v[244:247], v[116:119], v[108:111], v[244:247]
    v_mfma_f32_16x16x32_bf16 v[248:251], v[120:123], v[108:111], v[248:251]
    v_mfma_f32_16x16x32_bf16 v[252:255], v[124:127], v[108:111], v[252:255]
    s_waitcnt lgkmcnt(0)
    s_branch w_loop_chk
w_first16:
    s_waitcnt vmcnt(24)
    s_barrier
    v_mfma_f32_16x16x32_bf16 v[128:131], v[64:67], v[32:35], 0
    s_add_u32 m0, s21, 0
    s_nop 0
    buffer_load_dwordx4 v1, s[4:7], s16 offen sc1 lds
    s_add_u32 s16, s16, s62
    v_mfma_f32_16x16x32_bf16 v[132:135], v[68:71], v[32:35], 0
    ds_read_b64_tr_b16 v[112:113], v8 offset:49152
    v_mfma_f32_16x16x32_bf16 v[136:139], v[72:75], v[32:35], 0
    ds_read_b64_tr_b16 v[114:115], v9 offset:49152
    v_mfma_f32_16x16x32_bf16 v[140:143], v[76:79], v[32:35], 0
    ds_read_b64_tr_b16 v[116:117], v10 offset:49152
    v_mfma_f32_16x16x32_bf16 v[144:147], v[64:67], v[36:39], 0
    s_add_u32 m0, s21, 1024
    s_nop 0
    buffer_load_dwordx4 v1, s[4:7], s17 offen sc1 lds
    s_add_u32 s17, s17, s62
    v_mfma_f32_16x16x32_bf16 v[148:151], v[68:71], v[36:39], 0
    ds_read_b64_tr_b16 v[118:119], v11 offset:49152
    v_mfma_f32_16x16x32_bf16 v[152:155], v[72:75], v[36:39], 0
    ds_read_b64_tr_b16 v[120:121], v8 offset:57344
    v_mfma_f32_16x16x32_bf16 v[156:159], v[76:79], v[36:39], 0
    ds_read_b64_tr_b16 v[122:123], v9 offset:57344
    v_mfma_f32_16x16x32_bf16 v[160:163], v[64:67], v[40:43], 0
    s_add_u32 m0, s22, 0
    s_nop 0
    buffer_load_dwordx4 v2, s[8:11], s18 offen lds
    s_add_u32 s18, s18, s20
    v_mfma_f32_16x16x32_bf16 v[164:167], v[68:71], v[40:43], 0
    ds_read_b64_tr_b16 v[124:125], v10 offset:57344
    v_mfma_f32_16x16x32_bf16 v[168:171], v[72:75], v[40:43], 0
    ds_read_b64_tr_b16 v[126:127], v11 offset:57344
    v_mfma_f32_16x16x32_bf16 v[172:175], v[76:79], v[40:43], 0
    ds_read_b128 v[80:83], v5 offset:32768
    v_mfma_f32_16x16x32_bf16 v[176:179], v[64:67], v[44:47], 0
    s_add_u32 m0, s22, 8192
    s_nop 0
    buffer_load_dwordx4 v2, s[12:15], s19 offen lds
    s_add_u32 s19, s19, s20
    v_mfma_f32_16x16x32_bf16 v[180:183], v[68:71], v[44:47], 0
    ds_read_b128 v[84:87], v5 offset:33792
    v_mfma_f32_16x16x32_bf16 v[184:187], v[72:75], v[44:47], 0
    ds_read_b128 v[88:91], v5 offset:34816
    v_mfma_f32_16x16x32_bf16 v[188:191], v[76:79], v[44:47], 0
    ds_read_b128 v[92:95], v5 offset:35840
    v_mfma_f32_16x16x32_bf16 v[192:195], v[64:67], v[48:51], 0
    ds_read_b128 v[96:99], v5 offset:36864
    v_mfma_f32_16x16x32_bf16 v[196:199], v[68:71], v[48:51], 0
    ds_read_b128 v[100:103], v5 offset:37888
    v_mfma_f32_16x16x32_bf16 v[200:203], v[72:75], v[48:51], 0
    ds_read_b128 v[104:107], v5 offset:38912
    v_mfma_f32_16x16x32_bf16 v[204:207], v[76:79], v[48:51], 0
    ds_read_b128 v[108:111], v5 offset:39936
    v_mfma_f32_16x16x32_bf16 v[208:211], v[64:67], v[52:55], 0
    v_mfma_f32_16x16x32_bf16 v[212:215], v[68:71], v[52:55], 0
    v_mfma_f32_16x16x32_bf16 v[216:219], v[72:75], v[52:55], 0
    v_mfma_f32_16x16x32_bf16 v[220:223], v[76:79], v[52:55], 0
    v_mfma_f32_16x16x32_bf16 v[224:227], v[64:67], v[56:59], 0
    v_mfma_f32_16x16x32_bf16 v[228:231], v[68:71], v[56:59], 0
    v_mfma_f32_16x16x32_bf16 v[232:235], v[72:75], v[56:59], 0
    v_mfma_f32_16x16x32_bf16 v[236:239], v[76:79], v[56:59], 0
    v_mfma_f32_16x16x32_bf16 v[240:243], v[64:67], v[60:63], 0
    v_mfma_f32_16x16x32_bf16 v[244:247], v[68:71], v[60:63], 0
    v_mfma_f32_16x16x32_bf16 v[248:251], v[72:75], v[60:63], 0
    v_mfma_f32_16x16x32_bf16 v[252:255], v[76:79], v[60:63], 0
    s_waitcnt lgkmcnt(0)
w_first16_q1:
    s_waitcnt vmcnt(24)
    s_barrier
    v_mfma_f32_16x16x32_bf16 v[128:131], v[112:115], v[80:83], v[128:131]
    s_add_u32 m0, s21, 32768
    s_nop 0
    buffer_load_dwordx4 v1, s[4:7], s16 offen sc1 lds
    s_add_u32 s16, s16, s62
    v_mfma_f32_16x16x32_bf16 v[132:135], v[116:119], v[80:83], v[132:135]
    ds_read_b64_tr_b16 v[64:65], v12 offset:16384
    v_mfma_f32_16x16x32_bf16 v[136:139], v[120:123], v[80:83], v[136:139]
    ds_read_b64_tr_b16 v[66:67], v13 offset:16384
    v_mfma_f32_16x16x32_bf16 v[140:143], v[124:127], v[80:83], v[140:143]
    ds_read_b64_tr_b16 v[68:69], v14 offset:16384
    v_mfma_f32_16x16x32_bf16 v[144:147], v[112:115], v[84:87], v[144:147]
    s_add_u32 m0, s21, 33792
    s_nop 0
    buffer_load_dwordx4 v1, s[4:7], s17 offen sc1 lds
    s_add_u32 s17, s17, s62
    v_mfma_f32_16x16x32_bf16 v[148:151], v[116:119], v[84:87], v[148:151]
    ds_read_b64_tr_b16 v[70:71], v15 offset:16384
    v_mfma_f32_16x16x32_bf16 v[152:155], v[120:123], v[84:87], v[152:155]
    ds_read_b64_tr_b16 v[72:73], v12 offset:24576
    v_mfma_f32_16x16x32_bf16 v[156:159], v[124:127], v[84:87], v[156:159]
    ds_read_b64_tr_b16 v[74:75], v13 offset:24576
    v_mfma_f32_16x16x32_bf16 v[160:163], v[112:115], v[88:91], v[160:163]
    s_add_u32 m0, s22, 32768
    s_nop 0
    buffer_load_dwordx4 v2, s[8:11], s18 offen lds
    s_add_u32 s18, s18, s20
    v_mfma_f32_16x16x32_bf16 v[164:167], v[116:119], v[88:91], v[164:167]
    ds_read_b64_tr_b16 v[76:77], v14 offset:24576
    v_mfma_f32_16x16x32_bf16 v[168:171], v[120:123], v[88:91], v[168:171]
    ds_read_b64_tr_b16 v[78:79], v15 offset:24576
    v_mfma_f32_16x16x32_bf16 v[172:175], v[124:127], v[88:91], v[172:175]
    ds_read_b128 v[32:35], v6 offset:0
    v_mfma_f32_16x16x32_bf16 v[176:179], v[112:115], v[92:95], v[176:179]
    s_add_u32 m0, s22, 40960
    s_nop 0
    buffer_load_dwordx4 v2, s[12:15], s19 offen lds
    s_add_u32 s19, s19, s20
    v_mfma_f32_16x16x32_bf16 v[180:183], v[116:119], v[92:95], v[180:183]
    ds_read_b128 v[36:39], v6 offset:1024
    v_mfma_f32_16x16x32_bf16 v[184:187], v[120:123], v[92:95], v[184:187]
    ds_read_b128 v[40:43], v6 offset:2048
    v_mfma_f32_16x16x32_bf16 v[188:191], v[124:127], v[92:95], v[188:191]
    ds_read_b128 v[44:47], v6 offset:3072
    v_mfma_f32_16x16x32_bf16 v[192:195], v[112:115], v[96:99], v[192:195]
    ds_read_b128 v[48:51], v6 offset:4096
    v_mfma_f32_16x16x32_bf16 v[196:199], v[116:119], v[96:99], v[196:199]
    ds_read_b128 v[52:55], v6 offset:5120
    v_mfma_f32_16x16x32_bf16 v[200:203], v[120:123], v[96:99], v[200:203]
    ds_read_b128 v[56:59], v6 offset:6144
    v_mfma_f32_16x16x32_bf16 v[204:207], v[124:127], v[96:99], v[204:207]
    ds_read_b128 v[60:63], v6 offset:7168
    v_mfma_f32_16x16x32_bf16 v[208:211], v[112:115], v[100:103], v[208:211]
    v_mfma_f32_16x16x32_bf16 v[212:215], v[116:119], v[100:103], v[212:215]
    v_mfma_f32_16x16x32_bf16 v[216:219], v[120:123], v[100:103], v[216:219]
    v_mfma_f32_16x16x32_bf16 v[220:223], v[124:127], v[100:103], v[220:223]
    v_mfma_f32_16x16x32_bf16 v[224:227], v[112:115], v[104:107], v[224:227]
    v_mfma_f32_16x16x32_bf16 v[228:231], v[116:119], v[104:107], v[228:231]
    v_mfma_f32_16x16x32_bf16 v[232:235], v[120:123], v[104:107], v[232:235]
    v_mfma_f32_16x16x32_bf16 v[236:239], v[124:127], v[104:107], v[236:239]
    v_mfma_f32_16x16x32_bf16 v[240:243], v[112:115], v[108:111], v[240:243]
    v_mfma_f32_16x16x32_bf16 v[244:247], v[116:119], v[108:111], v[244:247]
    v_mfma_f32_16x16x32_bf16 v[248:251], v[120:123], v[108:111], v[248:251]
    v_mfma_f32_16x16x32_bf16 v[252:255], v[124:127], v[108:111], v[252:255]
    s_waitcnt lgkmcnt(0)
    s_waitcnt vmcnt(24)
    s_barrier
    v_mfma_f32_16x16x32_bf16 v[128:131], v[64:67], v[32:35], v[128:131]
    s_add_u32 m0, s21, 65536
    s_nop 0
    buffer_load_dwordx4 v1, s[4:7], s16 offen sc1 lds
    s_add_u32 s16, s16, s62
    v_mfma_f32_16x16x32_bf16 v[132:135], v[68:71], v[32:35], v[132:135]
    ds_read_b64_tr_b16 v[112:113], v12 offset:49152
    v_mfma_f32_16x16x32_bf16 v[136:139], v[72:75], v[32:35], v[136:139]
    ds_read_b64_tr_b16 v[114:115], v13 offset:49152
    v_mfma_f32_16x16x32_bf16 v[140:143], v[76:79], v[32:35], v[140:143]
    ds_read_b64_tr_b16 v[116:117], v14 offset:49152
    v_mfma_f32_16x16x32_bf16 v[144:147], v[64:67], v[36:39], v[144:147]
    s_add_u32 m0, s21, 66560
    s_nop 0
    buffer_load_dwordx4 v1, s[4:7], s17 offen sc1 lds
    s_add_u32 s17, s17, s62
    v_mfma_f32_16x16x32_bf16 v[148:151], v[68:71], v[36:39], v[148:151]
    ds_read_b64_tr_b16 v[118:119], v15 offset:49152
    v_mfma_f32_16x16x32_bf16 v[152:155], v[72:75], v[36:39], v[152:155]
    ds_read_b64_tr_b16 v[120:121], v12 offset:57344
    v_mfma_f32_16x16x32_bf16 v[156:159], v[76:79], v[36:39], v[156:159]
    ds_read_b64_tr_b16 v[122:123], v13 offset:57344
    v_mfma_f32_16x16x32_bf16 v[160:163], v[64:67], v[40:43], v[160:163]
    s_add_u32 m0, s22, 65536
    s_nop 0
    buffer_load_dwordx4 v2, s[8:11], s18 offen lds
    s_add_u32 s18, s18, s20
    v_mfma_f32_16x16x32_bf16 v[164:167], v[68:71], v[40:43], v[164:167]
    ds_read_b64_tr_b16 v[124:125], v14 offset:57344
    v_mfma_f32_16x16x32_bf16 v[168:171], v[72:75], v[40:43], v[168:171]
    ds_read_b64_tr_b16 v[126:127], v15 offset:57344
    v_mfma_f32_16x16x32_bf16 v[172:175], v[76:79], v[40:43], v[172:175]
    ds_read_b128 v[80:83], v6 offset:32768
    v_mfma_f32_16x16x32_bf16 v[176:179], v[64:67], v[44:47], v[176:179]
    s_add_u32 m0, s22, 73728
    s_nop 0
    buffer_load_dwordx4 v2, s[12:15], s19 offen lds
    s_add_u32 s19, s19, s20
    v_mfma_f32_16x16x32_bf16 v[180:183], v[68:71], v[44:47], v[180:183]
    ds_read_b128 v[84:87], v6 offset:33792
    v_mfma_f32_16x16x32_bf16 v[184:187], v[72:75], v[44:47], v[184:187]
    ds_read_b128 v[88:91], v6 offset:34816
    v_mfma_f32_16x16x32_bf16 v[188:191], v[76:79], v[44:47], v[188:191]
    ds_read_b128 v[92:95], v6 offset:35840
    v_mfma_f32_16x16x32_bf16 v[192:195], v[64:67], v[48:51], v[192:195]
    ds_read_b128 v[96:99], v6 offset:36864
    v_mfma_f32_16x16x32_bf16 v[196:199], v[68:71], v[48:51], v[196:199]
    ds_read_b128 v[100:103], v6 offset:37888
    v_mfma_f32_16x16x32_bf16 v[200:203], v[72:75], v[48:51], v[200:203]
    ds_read_b128 v[104:107], v6 offset:38912
    v_mfma_f32_16x16x32_bf16 v[204:207], v[76:79], v[48:51], v[204:207]
    ds_read_b128 v[108:111], v6 offset:39936
    v_mfma_f32_16x16x32_bf16 v[208:211], v[64:67], v[52:55], v[208:211]
    v_mfma_f32_16x16x32_bf16 v[212:215], v[68:71], v[52:55], v[212:215]
    v_mfma_f32_16x16x32_bf16 v[216:219], v[72:75], v[52:55], v[216:219]
    v_mfma_f32_16x16x32_bf16 v[220:223], v[76:79], v[52:55], v[220:223]
    v_mfma_f32_16x16x32_bf16 v[224:227], v[64:67], v[56:59], v[224:227]
    v_mfma_f32_16x16x32_bf16 v[228:231], v[68:71], v[56:59], v[228:231]
    v_mfma_f32_16x16x32_bf16 v[232:235], v[72:75], v[56:59], v[232:235]
    v_mfma_f32_16x16x32_bf16 v[236:239], v[76:79], v[56:59], v[236:239]
    v_mfma_f32_16x16x32_bf16 v[240:243], v[64:67], v[60:63], v[240:243]
    v_mfma_f32_16x16x32_bf16 v[244:247], v[68:71], v[60:63], v[244:247]
    v_mfma_f32_16x16x32_bf16 v[248:251], v[72:75], v[60:63], v[248:251]
    v_mfma_f32_16x16x32_bf16 v[252:255], v[76:79], v[60:63], v[252:255]
    s_waitcnt lgkmcnt(0)
    s_waitcnt vmcnt(8)
    s_barrier
    s_cmp_eq_u32 s28, 0
    s_cbranch_scc1 sig_5
    s_cmp_lg_u32 s3, 0
    s_cbranch_scc1 sig_5
    s_and_b32 s57, s28, 3
    v_mov_b32 v24, s57
    s_bfe_u32 s57, s28, 0x20002
    v_mov_b32 v25, s57
    s_andn2_b32 s28, s28, 15
    s_mov_b64 exec, 1
    buffer_atomic_add_x2 v[24:25], v17, s[4:7], s28 offen sc1
    s_mov_b64 exec, -1
sig_5:
    s_mov_b32 s28, 0
    v_mfma_f32_16x16x32_bf16 v[128:131], v[112:115], v[80:83], v[128:131]
    s_add_u32 m0, s21, 98304
    s_nop 0
    buffer_load_dwordx4 v1, s[4:7], s16 offen sc1 lds
    s_add_u32 s16, s16, s62
    v_mfma_f32_16x16x32_bf16 v[132:135], v[116:119], v[80:83], v[132:135]
    ds_read_b64_tr_b16 v[64:65], v8 offset:16384
    v_mfma_f32_16x16x32_bf16 v[136:139], v[120:123], v[80:83], v[136:139]
    ds_read_b64_tr_b16 v[66:67], v9 offset:16384
    v_mfma_f32_16x16x32_bf16 v[140:143], v[124:127], v[80:83], v[140:143]
    ds_read_b64_tr_b16 v[68:69], v10 offset:16384
    v_mfma_f32_16x16x32_bf16 v[144:147], v[112:115], v[84:87], v[144:147]
    s_add_u32 m0, s21, 99328
    s_nop 0
    buffer_load_dwordx4 v1, s[4:7], s17 offen sc1 lds
    s_add_u32 s17, s17, s62
    v_mfma_f32_16x16x32_bf16 v[148:151], v[116:119], v[84:87], v[148:151]
    ds_read_b64_tr_b16 v[70:71], v11 offset:16384
    v_mfma_f32_16x16x32_bf16 v[152:155], v[120:123], v[84:87], v[152:155]
    ds_read_b64_tr_b16 v[72:73], v8 offset:24576
    v_mfma_f32_16x16x32_bf16 v[156:159], v[124:127], v[84:87], v[156:159]
    ds_read_b64_tr_b16 v[74:75], v9 offset:24576
    v_mfma_f32_16x16x32_bf16 v[160:163], v[112:115], v[88:91], v[160:163]
    s_add_u32 m0, s22, 98304
    s_nop 0
    buffer_load_dwordx4 v2, s[8:11], s18 offen lds
    s_add_u32 s18, s18, s20
    v_mfma_f32_16x16x32_bf16 v[164:167], v[116:119], v[88:91], v[164:167]
    ds_read_b64_tr_b16 v[76:77], v10 offset:24576
    v_mfma_f32_16x16x32_bf16 v[168:171], v[120:123], v[88:91], v[168:171]
    ds_read_b64_tr_b16 v[78:79], v11 offset:24576
    v_mfma_f32_16x16x32_bf16 v[172:175], v[124:127], v[88:91], v[172:175]
    ds_read_b128 v[32:35], v5 offset:0
    v_mfma_f32_16x16x32_bf16 v[176:179], v[112:115], v[92:95], v[176:179]
    s_add_u32 m0, s22, 106496
    s_nop 0
    buffer_load_dwordx4 v2, s[12:15], s19 offen lds
    s_add_u32 s19, s19, s20
    v_mfma_f32_16x16x32_bf16 v[180:183], v[116:119], v[92:95], v[180:183]
    ds_read_b128 v[36:39], v5 offset:1024
    v_mfma_f32_16x16x32_bf16 v[184:187], v[120:123], v[92:95], v[184:187]
    ds_read_b128 v[40:43], v5 offset:2048
    v_mfma_f32_16x16x32_bf16 v[188:191], v[124:127], v[92:95], v[188:191]
    ds_read_b128 v[44:47], v5 offset:3072
    v_mfma_f32_16x16x32_bf16 v[192:195], v[112:115], v[96:99], v[192:195]
    ds_read_b128 v[48:51], v5 offset:4096
    v_mfma_f32_16x16x32_bf16 v[196:199], v[116:119], v[96:99], v[196:199]
    ds_read_b128 v[52:55], v5 offset:5120
    v_mfma_f32_16x16x32_bf16 v[200:203], v[120:123], v[96:99], v[200:203]
    ds_read_b128 v[56:59], v5 offset:6144
    v_mfma_f32_16x16x32_bf16 v[204:207], v[124:127], v[96:99], v[204:207]
    ds_read_b128 v[60:63], v5 offset:7168
    v_mfma_f32_16x16x32_bf16 v[208:211], v[112:115], v[100:103], v[208:211]
    v_mfma_f32_16x16x32_bf16 v[212:215], v[116:119], v[100:103], v[212:215]
    v_mfma_f32_16x16x32_bf16 v[216:219], v[120:123], v[100:103], v[216:219]
    v_mfma_f32_16x16x32_bf16 v[220:223], v[124:127], v[100:103], v[220:223]
    v_mfma_f32_16x16x32_bf16 v[224:227], v[112:115], v[104:107], v[224:227]
    v_mfma_f32_16x16x32_bf16 v[228:231], v[116:119], v[104:107], v[228:231]
    v_mfma_f32_16x16x32_bf16 v[232:235], v[120:123], v[104:107], v[232:235]
    v_mfma_f32_16x16x32_bf16 v[236:239], v[124:127], v[104:107], v[236:239]
    v_mfma_f32_16x16x32_bf16 v[240:243], v[112:115], v[108:111], v[240:243]
    v_mfma_f32_16x16x32_bf16 v[244:247], v[116:119], v[108:111], v[244:247]
    v_mfma_f32_16x16x32_bf16 v[248:251], v[120:123], v[108:111], v[248:251]
    v_mfma_f32_16x16x32_bf16 v[252:255], v[124:127], v[108:111], v[252:255]
    s_waitcnt lgkmcnt(0)
w_loop_chk:
    s_sub_u32 s23, s23, 1
w_loop:
    s_cmp_gt_u32 s23, 3
    s_cbranch_scc1 w_body
    s_cmp_lg_u32 s23, 3
    s_cbranch_scc1 w_l2
    s_cmp_lg_u32 s3, 0
    s_cbranch_scc1 clm_6
    v_mov_b32 v26, 1
    s_mov_b64 exec, 1
    buffer_atomic_add v26, off, s[64:67], s71 sc0 sc1
    s_mov_b64 exec, -1
clm_6:
    s_branch w_body
w_l2:
    s_cmp_lg_u32 s23, 2
    s_cbranch_scc1 w_l1
    s_cmp_lg_u32 s3, 0
    s_cbranch_scc1 pub_7
    v_mov_b32 v20, 131136
    s_mov_b64 exec, 1
    ds_write_b32 v20, v26
    s_mov_b64 exec, -1
    s_waitcnt lgkmcnt(0)
pub_7:
    s_branch w_body
w_l1:
    s_waitcnt vmcnt(8)
    v_readfirstlane_b32 s30, v16
    s_cmp_ge_u32 s30, s45
    s_cselect_b32 s30, 0, 1
    s_or_b32 s30, s30, s70
    s_cmp_eq_u32 s32, 4
    s_cselect_b32 s30, 1, s30
    s_sub_u32 s57, s32, 1
    s_cmp_ge_u32 s57, 4
    s_cselect_b32 s30, 1, s30
    v_mov_b32 v20, s30
    ds_write_b32 v7, v20
    s_cbranch_scc1 w_body
    s_load_dwordx2 s[8:9], s[0:1], s33
    s_load_dwordx2 s[12:13], s[0:1], s34
    s_mov_b32 s10, s38
    s_mov_b32 s14, s38
    s_cmp_eq_u32 s32, 4
    s_cselect_b32 s31, 0, 1
    s_lshl_b32 s30, s3, s31
    s_mul_i32 s30, s30, s40
    s_add_u32 s16, s39, s30
    s_cmp_eq_u32 s32, 4
    s_cselect_b32 s30, 1024, s40
    s_cselect_b32 s31, 6, 5
    s_lshl_b32 s62, 32, s31
    s_add_u32 s17, s16, s30
    s_lshl_b32 s30, s3, 2
    s_mul_i32 s30, s30, s35
    s_add_u32 s18, s36, s30
    s_add_u32 s19, s37, s30
    s_lshl_b32 s20, s35, s31
    v_mul_u32_u24 v2, s35, v4
    v_add_u32 v2, v2, v3
    s_waitcnt lgkmcnt(0)
w_body:
    s_waitcnt vmcnt(8)
    s_barrier
    s_cmp_lg_u32 s23, 2
    s_cbranch_scc1 w_nf
    v_mov_b32 v20, 131136
    ds_read_b32 v20, v20
    s_waitcnt lgkmcnt(0)
    v_readfirstlane_b32 s59, v20
    s_add_u32 s59, s59, 32
    s_min_u32 s59, s59, 322
    s_lshl_b32 s57, s59, 6
    s_load_dwordx16 s[32:47], s[24:25], s57
w_nf:
    v_mfma_f32_16x16x32_bf16 v[128:131], v[64:67], v[32:35], v[128:131]
    s_add_u32 m0, s21, 0
    s_nop 0
    buffer_load_dwordx4 v1, s[4:7], s16 offen sc1 lds
    s_add_u32 s16, s16, s62
    v_mfma_f32_16x16x32_bf16 v[132:135], v[68:71], v[32:35], v[132:135]
    ds_read_b64_tr_b16 v[112:113], v8 offset:49152
    v_mfma_f32_16x16x32_bf16 v[136:139], v[72:75], v[32:35], v[136:139]
    ds_read_b64_tr_b16 v[114:115], v9 offset:49152
    v_mfma_f32_16x16x32_bf16 v[140:143], v[76:79], v[32:35], v[140:143]
    ds_read_b64_tr_b16 v[116:117], v10 offset:49152
    v_mfma_f32_16x16x32_bf16 v[144:147], v[64:67], v[36:39], v[144:147]
    s_add_u32 m0, s21, 1024
    s_nop 0
    buffer_load_dwordx4 v1, s[4:7], s17 offen sc1 lds
    s_add_u32 s17, s17, s62
    v_mfma_f32_16x16x32_bf16 v[148:151], v[68:71], v[36:39], v[148:151]
    ds_read_b64_tr_b16 v[118:119], v11 offset:49152
    v_mfma_f32_16x16x32_bf16 v[152:155], v[72:75], v[36:39], v[152:155]
    ds_read_b64_tr_b16 v[120:121], v8 offset:57344
    v_mfma_f32_16x16x32_bf16 v[156:159], v[76:79], v[36:39], v[156:159]
    ds_read_b64_tr_b16 v[122:123], v9 offset:57344
    v_mfma_f32_16x16x32_bf16 v[160:163], v[64:67], v[40:43], v[160:163]
    s_add_u32 m0, s22, 0
    s_nop 0
    buffer_load_dwordx4 v2, s[8:11], s18 offen lds
    s_add_u32 s18, s18, s20
    v_mfma_f32_16x16x32_bf16 v[164:167], v[68:71], v[40:43], v[164:167]
    ds_read_b64_tr_b16 v[124:125], v10 offset:57344
    v_mfma_f32_16x16x32_bf16 v[168:171], v[72:75], v[40:43], v[168:171]
    ds_read_b64_tr_b16 v[126:127], v11 offset:57344
    v_mfma_f32_16x16x32_bf16 v[172:175], v[76:79], v[40:43], v[172:175]
    ds_read_b128 v[80:83], v5 offset:32768
    v_mfma_f32_16x16x32_bf16 v[176:179], v[64:67], v[44:47], v[176:179]
    s_add_u32 m0, s22, 8192
    s_nop 0
    buffer_load_dwordx4 v2, s[12:15], s19 offen lds
    s_add_u32 s19, s19, s20
    v_mfma_f32_16x16x32_bf16 v[180:183], v[68:71], v[44:47], v[180:183]
    ds_read_b128 v[84:87], v5 offset:33792
    v_mfma_f32_16x16x32_bf16 v[184:187], v[72:75], v[44:47], v[184:187]
    ds_read_b128 v[88:91], v5 offset:34816
    v_mfma_f32_16x16x32_bf16 v[188:191], v[76:79], v[44:47], v[188:191]
    ds_read_b128 v[92:95], v5 offset:35840
    v_mfma_f32_16x16x32_bf16 v[192:195], v[64:67], v[48:51], v[192:195]
    ds_read_b128 v[96:99], v5 offset:36864
    v_mfma_f32_16x16x32_bf16 v[196:199], v[68:71], v[48:51], v[196:199]
    ds_read_b128 v[100:103], v5 offset:37888
    v_mfma_f32_16x16x32_bf16 v[200:203], v[72:75], v[48:51], v[200:203]
    ds_read_b128 v[104:107], v5 offset:38912
    v_mfma_f32_16x16x32_bf16 v[204:207], v[76:79], v[48:51], v[204:207]
    ds_read_b128 v[108:111], v5 offset:39936
    v_mfma_f32_16x16x32_bf16 v[208:211], v[64:67], v[52:55], v[208:211]
    v_mfma_f32_16x16x32_bf16 v[212:215], v[68:71], v[52:55], v[212:215]
    v_mfma_f32_16x16x32_bf16 v[216:219], v[72:75], v[52:55], v[216:219]
    v_mfma_f32_16x16x32_bf16 v[220:223], v[76:79], v[52:55], v[220:223]
    v_mfma_f32_16x16x32_bf16 v[224:227], v[64:67], v[56:59], v[224:227]
    v_mfma_f32_16x16x32_bf16 v[228:231], v[68:71], v[56:59], v[228:231]
    v_mfma_f32_16x16x32_bf16 v[232:235], v[72:75], v[56:59], v[232:235]
    v_mfma_f32_16x16x32_bf16 v[236:239], v[76:79], v[56:59], v[236:239]
    v_mfma_f32_16x16x32_bf16 v[240:243], v[64:67], v[60:63], v[240:243]
    v_mfma_f32_16x16x32_bf16 v[244:247], v[68:71], v[60:63], v[244:247]
    v_mfma_f32_16x16x32_bf16 v[248:251], v[72:75], v[60:63], v[248:251]
    v_mfma_f32_16x16x32_bf16 v[252:255], v[76:79], v[60:63], v[252:255]
    s_waitcnt lgkmcnt(0)
    s_waitcnt vmcnt(8)
    s_barrier
    buffer_load_dword v16, v17, s[4:7], s44 offen sc1
    v_mfma_f32_16x16x32_bf16 v[128:131], v[112:115], v[80:83], v[128:131]
    s_add_u32 m0, s21, 32768
    s_nop 0
    buffer_load_dwordx4 v1, s[4:7], s16 offen sc1 lds
    s_add_u32 s16, s16, s62
    v_mfma_f32_16x16x32_bf16 v[132:135], v[116:119], v[80:83], v[132:135]
    ds_read_b64_tr_b16 v[64:65], v12 offset:16384
    v_mfma_f32_16x16x32_bf16 v[136:139], v[120:123], v[80:83], v[136:139]
    ds_read_b64_tr_b16 v[66:67], v13 offset:16384
    v_mfma_f32_16x16x32_bf16 v[140:143], v[124:127], v[80:83], v[140:143]
    ds_read_b64_tr_b16 v[68:69], v14 offset:16384
    v_mfma_f32_16x16x32_bf16 v[144:147], v[112:115], v[84:87], v[144:147]
    s_add_u32 m0, s21, 33792
    s_nop 0
    buffer_load_dwordx4 v1, s[4:7], s17 offen sc1 lds
    s_add_u32 s17, s17, s62
    v_mfma_f32_16x16x32_bf16 v[148:151], v[116:119], v[84:87], v[148:151]
    ds_read_b64_tr_b16 v[70:71], v15 offset:16384
    v_mfma_f32_16x16x32_bf16 v[152:155], v[120:123], v[84:87], v[152:155]
    ds_read_b64_tr_b16 v[72:73], v12 offset:24576
    v_mfma_f32_16x16x32_bf16 v[156:159], v[124:127], v[84:87], v[156:159]
    ds_read_b64_tr_b16 v[74:75], v13 offset:24576
    v_mfma_f32_16x16x32_bf16 v[160:163], v[112:115], v[88:91], v[160:163]
    s_add_u32 m0, s22, 32768
    s_nop 0
    buffer_load_dwordx4 v2, s[8:11], s18 offen lds
    s_add_u32 s18, s18, s20
    v_mfma_f32_16x16x32_bf16 v[164:167], v[116:119], v[88:91], v[164:167]
    ds_read_b64_tr_b16 v[76:77], v14 offset:24576
    v_mfma_f32_16x16x32_bf16 v[168:171], v[120:123], v[88:91], v[168:171]
    ds_read_b64_tr_b16 v[78:79], v15 offset:24576
    v_mfma_f32_16x16x32_bf16 v[172:175], v[124:127], v[88:91], v[172:175]
    ds_read_b128 v[32:35], v6 offset:0
    v_mfma_f32_16x16x32_bf16 v[176:179], v[112:115], v[92:95], v[176:179]
    s_add_u32 m0, s22, 40960
    s_nop 0
    buffer_load_dwordx4 v2, s[12:15], s19 offen lds
    s_add_u32 s19, s19, s20
    v_mfma_f32_16x16x32_bf16 v[180:183], v[116:119], v[92:95], v[180:183]
    ds_read_b128 v[36:39], v6 offset:1024
    v_mfma_f32_16x16x32_bf16 v[184:187], v[120:123], v[92:95], v[184:187]
    ds_read_b128 v[40:43], v6 offset:2048
    v_mfma_f32_16x16x32_bf16 v[188:191], v[124:127], v[92:95], v[188:191]
    ds_read_b128 v[44:47], v6 offset:3072
    v_mfma_f32_16x16x32_bf16 v[192:195], v[112:115], v[96:99], v[192:195]
    ds_read_b128 v[48:51], v6 offset:4096
    v_mfma_f32_16x16x32_bf16 v[196:199], v[116:119], v[96:99], v[196:199]
    ds_read_b128 v[52:55], v6 offset:5120
    v_mfma_f32_16x16x32_bf16 v[200:203], v[120:123], v[96:99], v[200:203]
    ds_read_b128 v[56:59], v6 offset:6144
    v_mfma_f32_16x16x32_bf16 v[204:207], v[124:127], v[96:99], v[204:207]
    ds_read_b128 v[60:63], v6 offset:7168
    v_mfma_f32_16x16x32_bf16 v[208:211], v[112:115], v[100:103], v[208:211]
    v_mfma_f32_16x16x32_bf16 v[212:215], v[116:119], v[100:103], v[212:215]
    v_mfma_f32_16x16x32_bf16 v[216:219], v[120:123], v[100:103], v[216:219]
    v_mfma_f32_16x16x32_bf16 v[220:223], v[124:127], v[100:103], v[220:223]
    v_mfma_f32_16x16x32_bf16 v[224:227], v[112:115], v[104:107], v[224:227]
    v_mfma_f32_16x16x32_bf16 v[228:231], v[116:119], v[104:107], v[228:231]
    v_mfma_f32_16x16x32_bf16 v[232:235], v[120:123], v[104:107], v[232:235]
    v_mfma_f32_16x16x32_bf16 v[236:239], v[124:127], v[104:107], v[236:239]
    v_mfma_f32_16x16x32_bf16 v[240:243], v[112:115], v[108:111], v[240:243]
    v_mfma_f32_16x16x32_bf16 v[244:247], v[116:119], v[108:111], v[244:247]
    v_mfma_f32_16x16x32_bf16 v[248:251], v[120:123], v[108:111], v[248:251]
    v_mfma_f32_16x16x32_bf16 v[252:255], v[124:127], v[108:111], v[252:255]
    s_waitcnt lgkmcnt(0)
    s_waitcnt vmcnt(8)
    s_barrier
    v_mfma_f32_16x16x32_bf16 v[128:131], v[64:67], v[32:35], v[128:131]
    s_add_u32 m0, s21, 65536
    s_nop 0
    buffer_load_dwordx4 v1, s[4:7], s16 offen sc1 lds
    s_add_u32 s16, s16, s62
    v_mfma_f32_16x16x32_bf16 v[132:135], v[68:71], v[32:35], v[132:135]
    ds_read_b64_tr_b16 v[112:113], v12 offset:49152
    v_mfma_f32_16x16x32_bf16 v[136:139], v[72:75], v[32:35], v[136:139]
    ds_read_b64_tr_b16 v[114:115], v13 offset:49152
    v_mfma_f32_16x16x32_bf16 v[140:143], v[76:79], v[32:35], v[140:143]
    ds_read_b64_tr_b16 v[116:117], v14 offset:49152
    v_mfma_f32_16x16x32_bf16 v[144:147], v[64:67], v[36:39], v[144:147]
    s_add_u32 m0, s21, 66560
    s_nop 0
    buffer_load_dwordx4 v1, s[4:7], s17 offen sc1 lds
    s_add_u32 s17, s17, s62
    v_mfma_f32_16x16x32_bf16 v[148:151], v[68:71], v[36:39], v[148:151]
    ds_read_b64_tr_b16 v[118:119], v15 offset:49152
    v_mfma_f32_16x16x32_bf16 v[152:155], v[72:75], v[36:39], v[152:155]
    ds_read_b64_tr_b16 v[120:121], v12 offset:57344
    v_mfma_f32_16x16x32_bf16 v[156:159], v[76:79], v[36:39], v[156:159]
    ds_read_b64_tr_b16 v[122:123], v13 offset:57344
    v_mfma_f32_16x16x32_bf16 v[160:163], v[64:67], v[40:43], v[160:163]
    s_add_u32 m0, s22, 65536
    s_nop 0
    buffer_load_dwordx4 v2, s[8:11], s18 offen lds
    s_add_u32 s18, s18, s20
    v_mfma_f32_16x16x32_bf16 v[164:167], v[68:71], v[40:43], v[164:167]
    ds_read_b64_tr_b16 v[124:125], v14 offset:57344
    v_mfma_f32_16x16x32_bf16 v[168:171], v[72:75], v[40:43], v[168:171]
    ds_read_b64_tr_b16 v[126:127], v15 offset:57344
    v_mfma_f32_16x16x32_bf16 v[172:175], v[76:79], v[40:43], v[172:175]
    ds_read_b128 v[80:83], v6 offset:32768
    v_mfma_f32_16x16x32_bf16 v[176:179], v[64:67], v[44:47], v[176:179]
    s_add_u32 m0, s22, 73728
    s_nop 0
    buffer_load_dwordx4 v2, s[12:15], s19 offen lds
    s_add_u32 s19, s19, s20
    v_mfma_f32_16x16x32_bf16 v[180:183], v[68:71], v[44:47], v[180:183]
    ds_read_b128 v[84:87], v6 offset:33792
    v_mfma_f32_16x16x32_bf16 v[184:187], v[72:75], v[44:47], v[184:187]
    ds_read_b128 v[88:91], v6 offset:34816
    v_mfma_f32_16x16x32_bf16 v[188:191], v[76:79], v[44:47], v[188:191]
    ds_read_b128 v[92:95], v6 offset:35840
    v_mfma_f32_16x16x32_bf16 v[192:195], v[64:67], v[48:51], v[192:195]
    ds_read_b128 v[96:99], v6 offset:36864
    v_mfma_f32_16x16x32_bf16 v[196:199], v[68:71], v[48:51], v[196:199]
    ds_read_b128 v[100:103], v6 offset:37888
    v_mfma_f32_16x16x32_bf16 v[200:203], v[72:75], v[48:51], v[200:203]
    ds_read_b128 v[104:107], v6 offset:38912
    v_mfma_f32_16x16x32_bf16 v[204:207], v[76:79], v[48:51], v[204:207]
    ds_read_b128 v[108:111], v6 offset:39936
    v_mfma_f32_16x16x32_bf16 v[208:211], v[64:67], v[52:55], v[208:211]
    v_mfma_f32_16x16x32_bf16 v[212:215], v[68:71], v[52:55], v[212:215]
    v_mfma_f32_16x16x32_bf16 v[216:219], v[72:75], v[52:55], v[216:219]
    v_mfma_f32_16x16x32_bf16 v[220:223], v[76:79], v[52:55], v[220:223]
    v_mfma_f32_16x16x32_bf16 v[224:227], v[64:67], v[56:59], v[224:227]
    v_mfma_f32_16x16x32_bf16 v[228:231], v[68:71], v[56:59], v[228:231]
    v_mfma_f32_16x16x32_bf16 v[232:235], v[72:75], v[56:59], v[232:235]
    v_mfma_f32_16x16x32_bf16 v[236:239], v[76:79], v[56:59], v[236:239]
    v_mfma_f32_16x16x32_bf16 v[240:243], v[64:67], v[60:63], v[240:243]
    v_mfma_f32_16x16x32_bf16 v[244:247], v[68:71], v[60:63], v[244:247]
    v_mfma_f32_16x16x32_bf16 v[248:251], v[72:75], v[60:63], v[248:251]
    v_mfma_f32_16x16x32_bf16 v[252:255], v[76:79], v[60:63], v[252:255]
    s_waitcnt lgkmcnt(0)
    s_waitcnt vmcnt(8)
    s_barrier
    v_mfma_f32_16x16x32_bf16 v[128:131], v[112:115], v[80:83], v[128:131]
    s_add_u32 m0, s21, 98304
    s_nop 0
    buffer_load_dwordx4 v1, s[4:7], s16 offen sc1 lds
    s_add_u32 s16, s16, s62
    v_mfma_f32_16x16x32_bf16 v[132:135], v[116:119], v[80:83], v[132:135]
    ds_read_b64_tr_b16 v[64:65], v8 offset:16384
    v_mfma_f32_16x16x32_bf16 v[136:139], v[120:123], v[80:83], v[136:139]
    ds_read_b64_tr_b16 v[66:67], v9 offset:16384
    v_mfma_f32_16x16x32_bf16 v[140:143], v[124:127], v[80:83], v[140:143]
    ds_read_b64_tr_b16 v[68:69], v10 offset:16384
    v_mfma_f32_16x16x32_bf16 v[144:147], v[112:115], v[84:87], v[144:147]
    s_add_u32 m0, s21, 99328
    s_nop 0
    buffer_load_dwordx4 v1, s[4:7], s17 offen sc1 lds
    s_add_u32 s17, s17, s62
    v_mfma_f32_16x16x32_bf16 v[148:151], v[116:119], v[84:87], v[148:151]
    ds_read_b64_tr_b16 v[70:71], v11 offset:16384
    v_mfma_f32_16x16x32_bf16 v[152:155], v[120:123], v[84:87], v[152:155]
    ds_read_b64_tr_b16 v[72:73], v8 offset:24576
    v_mfma_f32_16x16x32_bf16 v[156:159], v[124:127], v[84:87], v[156:159]
    ds_read_b64_tr_b16 v[74:75], v9 offset:24576
    v_mfma_f32_16x16x32_bf16 v[160:163], v[112:115], v[88:91], v[160:163]
    s_add_u32 m0, s22, 98304
    s_nop 0
    buffer_load_dwordx4 v2, s[8:11], s18 offen lds
    s_add_u32 s18, s18, s20
    v_mfma_f32_16x16x32_bf16 v[164:167], v[116:119], v[88:91], v[164:167]
    ds_read_b64_tr_b16 v[76:77], v10 offset:24576
    v_mfma_f32_16x16x32_bf16 v[168:171], v[120:123], v[88:91], v[168:171]
    ds_read_b64_tr_b16 v[78:79], v11 offset:24576
    v_mfma_f32_16x16x32_bf16 v[172:175], v[124:127], v[88:91], v[172:175]
    ds_read_b128 v[32:35], v5 offset:0
    v_mfma_f32_16x16x32_bf16 v[176:179], v[112:115], v[92:95], v[176:179]
    s_add_u32 m0, s22, 106496
    s_nop 0
    buffer_load_dwordx4 v2, s[12:15], s19 offen lds
    s_add_u32 s19, s19, s20
    v_mfma_f32_16x16x32_bf16 v[180:183], v[116:119], v[92:95], v[180:183]
    ds_read_b128 v[36:39], v5 offset:1024
    v_mfma_f32_16x16x32_bf16 v[184:187], v[120:123], v[92:95], v[184:187]
    ds_read_b128 v[40:43], v5 offset:2048
    v_mfma_f32_16x16x32_bf16 v[188:191], v[124:127], v[92:95], v[188:191]
    ds_read_b128 v[44:47], v5 offset:3072
    v_mfma_f32_16x16x32_bf16 v[192:195], v[112:115], v[96:99], v[192:195]
    ds_read_b128 v[48:51], v5 offset:4096
    v_mfma_f32_16x16x32_bf16 v[196:199], v[116:119], v[96:99], v[196:199]
    ds_read_b128 v[52:55], v5 offset:5120
    v_mfma_f32_16x16x32_bf16 v[200:203], v[120:123], v[96:99], v[200:203]
    ds_read_b128 v[56:59], v5 offset:6144
    v_mfma_f32_16x16x32_bf16 v[204:207], v[124:127], v[96:99], v[204:207]
    ds_read_b128 v[60:63], v5 offset:7168
    v_mfma_f32_16x16x32_bf16 v[208:211], v[112:115], v[100:103], v[208:211]
    v_mfma_f32_16x16x32_bf16 v[212:215], v[116:119], v[100:103], v[212:215]
    v_mfma_f32_16x16x32_bf16 v[216:219], v[120:123], v[100:103], v[216:219]
    v_mfma_f32_16x16x32_bf16 v[220:223], v[124:127], v[100:103], v[220:223]
    v_mfma_f32_16x16x32_bf16 v[224:227], v[112:115], v[104:107], v[224:227]
    v_mfma_f32_16x16x32_bf16 v[228:231], v[116:119], v[104:107], v[228:231]
    v_mfma_f32_16x16x32_bf16 v[232:235], v[120:123], v[104:107], v[232:235]
    v_mfma_f32_16x16x32_bf16 v[236:239], v[124:127], v[104:107], v[236:239]
    v_mfma_f32_16x16x32_bf16 v[240:243], v[112:115], v[108:111], v[240:243]
    v_mfma_f32_16x16x32_bf16 v[244:247], v[116:119], v[108:111], v[244:247]
    v_mfma_f32_16x16x32_bf16 v[248:251], v[120:123], v[108:111], v[248:251]
    v_mfma_f32_16x16x32_bf16 v[252:255], v[124:127], v[108:111], v[252:255]
    s_waitcnt lgkmcnt(0)
    s_sub_u32 s23, s23, 1
    s_cmp_lg_u32 s23, 0
    s_cbranch_scc1 w_loop
    v_mov_b32 v20, 131072
    ds_read_b128 v[24:27], v20
    ds_read_b128 v[28:31], v20 offset:16
    s_cmp_eq_u32 s48, 2
    s_cbranch_scc1 w_epi_glu
    s_lshl_b32 s30, s27, 10
    s_add_u32 s30, s30, s49
    s_nop 7
    v_cvt_pk_bf16_f32 v80, v128, v129
    v_cvt_pk_bf16_f32 v81, v130, v131
    v_cvt_pk_bf16_f32 v82, v132, v133
    v_cvt_pk_bf16_f32 v83, v134, v135
    buffer_store_dwordx4 v[80:83], v1, s[4:7], s30 offen sc1
    v_cvt_pk_bf16_f32 v84, v136, v137
    v_cvt_pk_bf16_f32 v85, v138, v139
    v_cvt_pk_bf16_f32 v86, v140, v141
    v_cvt_pk_bf16_f32 v87, v142, v143
    buffer_store_dwordx4 v[84:87], v19, s[4:7], s30 offen sc1
    s_add_u32 s30, s30, s50
    v_cvt_pk_bf16_f32 v88, v144, v145
    v_cvt_pk_bf16_f32 v89, v146, v147
    v_cvt_pk_bf16_f32 v90, v148, v149
    v_cvt_pk_bf16_f32 v91, v150, v151
    buffer_store_dwordx4 v[88:91], v1, s[4:7], s30 offen sc1
    v_cvt_pk_bf16_f32 v92, v152, v153
    v_cvt_pk_bf16_f32 v93, v154, v155
    v_cvt_pk_bf16_f32 v94, v156, v157
    v_cvt_pk_bf16_f32 v95, v158, v159
    buffer_store_dwordx4 v[92:95], v19, s[4:7], s30 offen sc1
    s_add_u32 s30, s30, s50
    v_cvt_pk_bf16_f32 v80, v160, v161
    v_cvt_pk_bf16_f32 v81, v162, v163
    v_cvt_pk_bf16_f32 v82, v164, v165
    v_cvt_pk_bf16_f32 v83, v166, v167
    buffer_store_dwordx4 v[80:83], v1, s[4:7], s30 offen sc1
    v_cvt_pk_bf16_f32 v84, v168, v169
    v_cvt_pk_bf16_f32 v85, v170, v171
    v_cvt_pk_bf16_f32 v86, v172, v173
    v_cvt_pk_bf16_f32 v87, v174, v175
    buffer_store_dwordx4 v[84:87], v19, s[4:7], s30 offen sc1
    s_add_u32 s30, s30, s50
    v_cvt_pk_bf16_f32 v88, v176, v177
    v_cvt_pk_bf16_f32 v89, v178, v179
    v_cvt_pk_bf16_f32 v90, v180, v181
    v_cvt_pk_bf16_f32 v91, v182, v183
    buffer_store_dwordx4 v[88:91], v1, s[4:7], s30 offen sc1
    v_cvt_pk_bf16_f32 v92, v184, v185
    v_cvt_pk_bf16_f32 v93, v186, v187
    v_cvt_pk_bf16_f32 v94, v188, v189
    v_cvt_pk_bf16_f32 v95, v190, v191
    buffer_store_dwordx4 v[92:95], v19, s[4:7], s30 offen sc1
    s_add_u32 s30, s30, s50
    v_cvt_pk_bf16_f32 v80, v192, v193
    v_cvt_pk_bf16_f32 v81, v194, v195
    v_cvt_pk_bf16_f32 v82, v196, v197
    v_cvt_pk_bf16_f32 v83, v198, v199
    buffer_store_dwordx4 v[80:83], v1, s[4:7], s30 offen sc1
    v_cvt_pk_bf16_f32 v84, v200, v201
    v_cvt_pk_bf16_f32 v85, v202, v203
    v_cvt_pk_bf16_f32 v86, v204, v205
    v_cvt_pk_bf16_f32 v87, v206, v207
    buffer_store_dwordx4 v[84:87], v19, s[4:7], s30 offen sc1
    s_add_u32 s30, s30, s50
    v_cvt_pk_bf16_f32 v88, v208, v209
    v_cvt_pk_bf16_f32 v89, v210, v211
    v_cvt_pk_bf16_f32 v90, v212, v213
    v_cvt_pk_bf16_f32 v91, v214, v215
    buffer_store_dwordx4 v[88:91], v1, s[4:7], s30 offen sc1
    v_cvt_pk_bf16_f32 v92, v216, v217
    v_cvt_pk_bf16_f32 v93, v218, v219
    v_cvt_pk_bf16_f32 v94, v220, v221
    v_cvt_pk_bf16_f32 v95, v222, v223
    buffer_store_dwordx4 v[92:95], v19, s[4:7], s30 offen sc1
    s_add_u32 s30, s30, s50
    v_cvt_pk_bf16_f32 v80, v224, v225
    v_cvt_pk_bf16_f32 v81, v226, v227
    v_cvt_pk_bf16_f32 v82, v228, v229
    v_cvt_pk_bf16_f32 v83, v230, v231
    buffer_store_dwordx4 v[80:83], v1, s[4:7], s30 offen sc1
    v_cvt_pk_bf16_f32 v84, v232, v233
    v_cvt_pk_bf16_f32 v85, v234, v235
    v_cvt_pk_bf16_f32 v86, v236, v237
    v_cvt_pk_bf16_f32 v87, v238, v239
    buffer_store_dwordx4 v[84:87], v19, s[4:7], s30 offen sc1
    s_add_u32 s30, s30, s50
    v_cvt_pk_bf16_f32 v88, v240, v241
    v_cvt_pk_bf16_f32 v89, v242, v243
    v_cvt_pk_bf16_f32 v90, v244, v245
    v_cvt_pk_bf16_f32 v91, v246, v247
    buffer_store_dwordx4 v[88:91], v1, s[4:7], s30 offen sc1
    v_cvt_pk_bf16_f32 v92, v248, v249
    v_cvt_pk_bf16_f32 v93, v250, v251
    v_cvt_pk_bf16_f32 v94, v252, v253
    v_cvt_pk_bf16_f32 v95, v254, v255
    buffer_store_dwordx4 v[92:95], v19, s[4:7], s30 offen sc1
    s_waitcnt lgkmcnt(0)
    v_or3_b32 v24, v24, v25, v26
    v_or3_b32 v28, v28, v29, v30
    v_or3_b32 v24, v24, v27, v31
    v_or_b32 v24, v24, v28
    s_mov_b32 s28, s51
    v_readfirstlane_b32 s30, v24
    s_cmp_lg_u32 s30, 0
    s_cbranch_scc1 w_drain
    s_mov_b32 s48, s32
    s_cmp_eq_u32 s32, 4
    s_cselect_b32 s30, 2, 3
    s_lshl_b32 s30, s26, s30
    s_mul_i32 s30, s30, s43
    s_add_u32 s49, s42, s30
    s_mov_b32 s50, s43
    s_mov_b32 s51, s46
    s_mov_b32 s23, s41
    s_mov_b32 s53, s41
    s_branch w_first16
w_epi_glu:
    s_lshl_b32 s30, s27, 10
    s_add_u32 s30, s30, s49
    s_mov_b32 s54, 0xbfb8aa3b
    s_nop 7
    v_cvt_pk_bf16_f32 v80, v128, v129
    v_cvt_pk_bf16_f32 v81, v130, v131
    v_cvt_pk_bf16_f32 v82, v132, v133
    v_cvt_pk_bf16_f32 v83, v134, v135
    v_lshlrev_b32 v96, 16, v80
    v_and_b32 v97, 0xffff0000, v80
    v_lshlrev_b32 v98, 16, v81
    v_and_b32 v99, 0xffff0000, v81
    v_lshlrev_b32 v100, 16, v82
    v_and_b32 v101, 0xffff0000, v82
    v_lshlrev_b32 v102, 16, v83
    v_and_b32 v103, 0xffff0000, v83
    v_mul_f32 v96, s54, v96
    v_mul_f32 v97, s54, v97
    v_mul_f32 v98, s54, v98
    v_mul_f32 v99, s54, v99
    v_mul_f32 v100, s54, v100
    v_mul_f32 v101, s54, v101
    v_mul_f32 v102, s54, v102
    v_mul_f32 v103, s54, v103
    v_exp_f32 v96, v96
    v_exp_f32 v97, v97
    v_exp_f32 v98, v98
    v_exp_f32 v99, v99
    v_exp_f32 v100, v100
    v_exp_f32 v101, v101
    v_exp_f32 v102, v102
    v_exp_f32 v103, v103
    v_add_f32 v96, 1.0, v96
    v_add_f32 v97, 1.0, v97
    v_add_f32 v98, 1.0, v98
    v_add_f32 v99, 1.0, v99
    v_add_f32 v100, 1.0, v100
    v_add_f32 v101, 1.0, v101
    v_add_f32 v102, 1.0, v102
    v_add_f32 v103, 1.0, v103
    v_rcp_f32 v96, v96
    v_rcp_f32 v97, v97
    v_rcp_f32 v98, v98
    v_rcp_f32 v99, v99
    v_rcp_f32 v100, v100
    v_rcp_f32 v101, v101
    v_rcp_f32 v102, v102
    v_rcp_f32 v103, v103
    v_mul_f32 v96, v96, v136
    v_mul_f32 v97, v97, v137
    v_mul_f32 v98, v98, v138
    v_mul_f32 v99, v99, v139
    v_mul_f32 v100, v100, v140
    v_mul_f32 v101, v101, v141
    v_mul_f32 v102, v102, v142
    v_mul_f32 v103, v103, v143
    v_cvt_pk_bf16_f32 v80, v96, v97
    v_cvt_pk_bf16_f32 v81, v98, v99
    v_cvt_pk_bf16_f32 v82, v100, v101
    v_cvt_pk_bf16_f32 v83, v102, v103
    buffer_store_dwordx4 v[80:83], v1, s[4:7], s30 offen sc1
    s_add_u32 s30, s30, s50
    v_cvt_pk_bf16_f32 v84, v144, v145
    v_cvt_pk_bf16_f32 v85, v146, v147
    v_cvt_pk_bf16_f32 v86, v148, v149
    v_cvt_pk_bf16_f32 v87, v150, v151
    v_lshlrev_b32 v104, 16, v84
    v_and_b32 v105, 0xffff0000, v84
    v_lshlrev_b32 v106, 16, v85
    v_and_b32 v107, 0xffff0000, v85
    v_lshlrev_b32 v108, 16, v86
    v_and_b32 v109, 0xffff0000, v86
    v_lshlrev_b32 v110, 16, v87
    v_and_b32 v111, 0xffff0000, v87
    v_mul_f32 v104, s54, v104
    v_mul_f32 v105, s54, v105
    v_mul_f32 v106, s54, v106
    v_mul_f32 v107, s54, v107
    v_mul_f32 v108, s54, v108
    v_mul_f32 v109, s54, v109
    v_mul_f32 v110, s54, v110
    v_mul_f32 v111, s54, v111
    v_exp_f32 v104, v104
    v_exp_f32 v105, v105
    v_exp_f32 v106, v106
    v_exp_f32 v107, v107
    v_exp_f32 v108, v108
    v_exp_f32 v109, v109
    v_exp_f32 v110, v110
    v_exp_f32 v111, v111
    v_add_f32 v104, 1.0, v104
    v_add_f32 v105, 1.0, v105
    v_add_f32 v106, 1.0, v106
    v_add_f32 v107, 1.0, v107
    v_add_f32 v108, 1.0, v108
    v_add_f32 v109, 1.0, v109
    v_add_f32 v110, 1.0, v110
    v_add_f32 v111, 1.0, v111
    v_rcp_f32 v104, v104
    v_rcp_f32 v105, v105
    v_rcp_f32 v106, v106
    v_rcp_f32 v107, v107
    v_rcp_f32 v108, v108
    v_rcp_f32 v109, v109
    v_rcp_f32 v110, v110
    v_rcp_f32 v111, v111
    v_mul_f32 v104, v104, v152
    v_mul_f32 v105, v105, v153
    v_mul_f32 v106, v106, v154
    v_mul_f32 v107, v107, v155
    v_mul_f32 v108, v108, v156
    v_mul_f32 v109, v109, v157
    v_mul_f32 v110, v110, v158
    v_mul_f32 v111, v111, v159
    v_cvt_pk_bf16_f32 v84, v104, v105
    v_cvt_pk_bf16_f32 v85, v106, v107
    v_cvt_pk_bf16_f32 v86, v108, v109
    v_cvt_pk_bf16_f32 v87, v110, v111
    buffer_store_dwordx4 v[84:87], v1, s[4:7], s30 offen sc1
    s_add_u32 s30, s30, s50
    v_cvt_pk_bf16_f32 v88, v160, v161
    v_cvt_pk_bf16_f32 v89, v162, v163
    v_cvt_pk_bf16_f32 v90, v164, v165
    v_cvt_pk_bf16_f32 v91, v166, v167
    v_lshlrev_b32 v96, 16, v88
    v_and_b32 v97, 0xffff0000, v88
    v_lshlrev_b32 v98, 16, v89
    v_and_b32 v99, 0xffff0000, v89
    v_lshlrev_b32 v100, 16, v90
    v_and_b32 v101, 0xffff0000, v90
    v_lshlrev_b32 v102, 16, v91
    v_and_b32 v103, 0xffff0000, v91
    v_mul_f32 v96, s54, v96
    v_mul_f32 v97, s54, v97
    v_mul_f32 v98, s54, v98
    v_mul_f32 v99, s54, v99
    v_mul_f32 v100, s54, v100
    v_mul_f32 v101, s54, v101
    v_mul_f32 v102, s54, v102
    v_mul_f32 v103, s54, v103
    v_exp_f32 v96, v96
    v_exp_f32 v97, v97
    v_exp_f32 v98, v98
    v_exp_f32 v99, v99
    v_exp_f32 v100, v100
    v_exp_f32 v101, v101
    v_exp_f32 v102, v102
    v_exp_f32 v103, v103
    v_add_f32 v96, 1.0, v96
    v_add_f32 v97, 1.0, v97
    v_add_f32 v98, 1.0, v98
    v_add_f32 v99, 1.0, v99
    v_add_f32 v100, 1.0, v100
    v_add_f32 v101, 1.0, v101
    v_add_f32 v102, 1.0, v102
    v_add_f32 v103, 1.0, v103
    v_rcp_f32 v96, v96
    v_rcp_f32 v97, v97
    v_rcp_f32 v98, v98
    v_rcp_f32 v99, v99
    v_rcp_f32 v100, v100
    v_rcp_f32 v101, v101
    v_rcp_f32 v102, v102
    v_rcp_f32 v103, v103
    v_mul_f32 v96, v96, v168
    v_mul_f32 v97, v97, v169
    v_mul_f32 v98, v98, v170
    v_mul_f32 v99, v99, v171
    v_mul_f32 v100, v100, v172
    v_mul_f32 v101, v101, v173
    v_mul_f32 v102, v102, v174
    v_mul_f32 v103, v103, v175
    v_cvt_pk_bf16_f32 v88, v96, v97
    v_cvt_pk_bf16_f32 v89, v98, v99
    v_cvt_pk_bf16_f32 v90, v100, v101
    v_cvt_pk_bf16_f32 v91, v102, v103
    buffer_store_dwordx4 v[88:91], v1, s[4:7], s30 offen sc1
    s_add_u32 s30, s30, s50
    v_cvt_pk_bf16_f32 v92, v176, v177
    v_cvt_pk_bf16_f32 v93, v178, v179
    v_cvt_pk_bf16_f32 v94, v180, v181
    v_cvt_pk_bf16_f32 v95, v182, v183
    v_lshlrev_b32 v104, 16, v92
    v_and_b32 v105, 0xffff0000, v92
    v_lshlrev_b32 v106, 16, v93
    v_and_b32 v107, 0xffff0000, v93
    v_lshlrev_b32 v108, 16, v94
    v_and_b32 v109, 0xffff0000, v94
    v_lshlrev_b32 v110, 16, v95
    v_and_b32 v111, 0xffff0000, v95
    v_mul_f32 v104, s54, v104
    v_mul_f32 v105, s54, v105
    v_mul_f32 v106, s54, v106
    v_mul_f32 v107, s54, v107
    v_mul_f32 v108, s54, v108
    v_mul_f32 v109, s54, v109
    v_mul_f32 v110, s54, v110
    v_mul_f32 v111, s54, v111
    v_exp_f32 v104, v104
    v_exp_f32 v105, v105
    v_exp_f32 v106, v106
    v_exp_f32 v107, v107
    v_exp_f32 v108, v108
    v_exp_f32 v109, v109
    v_exp_f32 v110, v110
    v_exp_f32 v111, v111
    v_add_f32 v104, 1.0, v104
    v_add_f32 v105, 1.0, v105
    v_add_f32 v106, 1.0, v106
    v_add_f32 v107, 1.0, v107
    v_add_f32 v108, 1.0, v108
    v_add_f32 v109, 1.0, v109
    v_add_f32 v110, 1.0, v110
    v_add_f32 v111, 1.0, v111
    v_rcp_f32 v104, v104
    v_rcp_f32 v105, v105
    v_rcp_f32 v106, v106
    v_rcp_f32 v107, v107
    v_rcp_f32 v108, v108
    v_rcp_f32 v109, v109
    v_rcp_f32 v110, v110
    v_rcp_f32 v111, v111
    v_mul_f32 v104, v104, v184
    v_mul_f32 v105, v105, v185
    v_mul_f32 v106, v106, v186
    v_mul_f32 v107, v107, v187
    v_mul_f32 v108, v108, v188
    v_mul_f32 v109, v109, v189
    v_mul_f32 v110, v110, v190
    v_mul_f32 v111, v111, v191
    v_cvt_pk_bf16_f32 v92, v104, v105
    v_cvt_pk_bf16_f32 v93, v106, v107
    v_cvt_pk_bf16_f32 v94, v108, v109
    v_cvt_pk_bf16_f32 v95, v110, v111
    buffer_store_dwordx4 v[92:95], v1, s[4:7], s30 offen sc1
    s_add_u32 s30, s30, s50
    v_cvt_pk_bf16_f32 v80, v192, v193
    v_cvt_pk_bf16_f32 v81, v194, v195
    v_cvt_pk_bf16_f32 v82, v196, v197
    v_cvt_pk_bf16_f32 v83, v198, v199
    v_lshlrev_b32 v96, 16, v80
    v_and_b32 v97, 0xffff0000, v80
    v_lshlrev_b32 v98, 16, v81
    v_and_b32 v99, 0xffff0000, v81
    v_lshlrev_b32 v100, 16, v82
    v_and_b32 v101, 0xffff0000, v82
    v_lshlrev_b32 v102, 16, v83
    v_and_b32 v103, 0xffff0000, v83
    v_mul_f32 v96, s54, v96
    v_mul_f32 v97, s54, v97
    v_mul_f32 v98, s54, v98
    v_mul_f32 v99, s54, v99
    v_mul_f32 v100, s54, v100
    v_mul_f32 v101, s54, v101
    v_mul_f32 v102, s54, v102
    v_mul_f32 v103, s54, v103
    v_exp_f32 v96, v96
    v_exp_f32 v97, v97
    v_exp_f32 v98, v98
    v_exp_f32 v99, v99
    v_exp_f32 v100, v100
    v_exp_f32 v101, v101
    v_exp_f32 v102, v102
    v_exp_f32 v103, v103
    v_add_f32 v96, 1.0, v96
    v_add_f32 v97, 1.0, v97
    v_add_f32 v98, 1.0, v98
    v_add_f32 v99, 1.0, v99
    v_add_f32 v100, 1.0, v100
    v_add_f32 v101, 1.0, v101
    v_add_f32 v102, 1.0, v102
    v_add_f32 v103, 1.0, v103
    v_rcp_f32 v96, v96
    v_rcp_f32 v97, v97
    v_rcp_f32 v98, v98
    v_rcp_f32 v99, v99
    v_rcp_f32 v100, v100
    v_rcp_f32 v101, v101
    v_rcp_f32 v102, v102
    v_rcp_f32 v103, v103
    v_mul_f32 v96, v96, v200
    v_mul_f32 v97, v97, v201
    v_mul_f32 v98, v98, v202
    v_mul_f32 v99, v99, v203
    v_mul_f32 v100, v100, v204
    v_mul_f32 v101, v101, v205
    v_mul_f32 v102, v102, v206
    v_mul_f32 v103, v103, v207
    v_cvt_pk_bf16_f32 v80, v96, v97
    v_cvt_pk_bf16_f32 v81, v98, v99
    v_cvt_pk_bf16_f32 v82, v100, v101
    v_cvt_pk_bf16_f32 v83, v102, v103
    buffer_store_dwordx4 v[80:83], v1, s[4:7], s30 offen sc1
    s_add_u32 s30, s30, s50
    v_cvt_pk_bf16_f32 v84, v208, v209
    v_cvt_pk_bf16_f32 v85, v210, v211
    v_cvt_pk_bf16_f32 v86, v212, v213
    v_cvt_pk_bf16_f32 v87, v214, v215
    v_lshlrev_b32 v104, 16, v84
    v_and_b32 v105, 0xffff0000, v84
    v_lshlrev_b32 v106, 16, v85
    v_and_b32 v107, 0xffff0000, v85
    v_lshlrev_b32 v108, 16, v86
    v_and_b32 v109, 0xffff0000, v86
    v_lshlrev_b32 v110, 16, v87
    v_and_b32 v111, 0xffff0000, v87
    v_mul_f32 v104, s54, v104
    v_mul_f32 v105, s54, v105
    v_mul_f32 v106, s54, v106
    v_mul_f32 v107, s54, v107
    v_mul_f32 v108, s54, v108
    v_mul_f32 v109, s54, v109
    v_mul_f32 v110, s54, v110
    v_mul_f32 v111, s54, v111
    v_exp_f32 v104, v104
    v_exp_f32 v105, v105
    v_exp_f32 v106, v106
    v_exp_f32 v107, v107
    v_exp_f32 v108, v108
    v_exp_f32 v109, v109
    v_exp_f32 v110, v110
    v_exp_f32 v111, v111
    v_add_f32 v104, 1.0, v104
    v_add_f32 v105, 1.0, v105
    v_add_f32 v106, 1.0, v106
    v_add_f32 v107, 1.0, v107
    v_add_f32 v108, 1.0, v108
    v_add_f32 v109, 1.0, v109
    v_add_f32 v110, 1.0, v110
    v_add_f32 v111, 1.0, v111
    v_rcp_f32 v104, v104
    v_rcp_f32 v105, v105
    v_rcp_f32 v106, v106
    v_rcp_f32 v107, v107
    v_rcp_f32 v108, v108
    v_rcp_f32 v109, v109
    v_rcp_f32 v110, v110
    v_rcp_f32 v111, v111
    v_mul_f32 v104, v104, v216
    v_mul_f32 v105, v105, v217
    v_mul_f32 v106, v106, v218
    v_mul_f32 v107, v107, v219
    v_mul_f32 v108, v108, v220
    v_mul_f32 v109, v109, v221
    v_mul_f32 v110, v110, v222
    v_mul_f32 v111, v111, v223
    v_cvt_pk_bf16_f32 v84, v104, v105
    v_cvt_pk_bf16_f32 v85, v106, v107
    v_cvt_pk_bf16_f32 v86, v108, v109
    v_cvt_pk_bf16_f32 v87, v110, v111
    buffer_store_dwordx4 v[84:87], v1, s[4:7], s30 offen sc1
    s_add_u32 s30, s30, s50
    v_cvt_pk_bf16_f32 v88, v224, v225
    v_cvt_pk_bf16_f32 v89, v226, v227
    v_cvt_pk_bf16_f32 v90, v228, v229
    v_cvt_pk_bf16_f32 v91, v230, v231
    v_lshlrev_b32 v96, 16, v88
    v_and_b32 v97, 0xffff0000, v88
    v_lshlrev_b32 v98, 16, v89
    v_and_b32 v99, 0xffff0000, v89
    v_lshlrev_b32 v100, 16, v90
    v_and_b32 v101, 0xffff0000, v90
    v_lshlrev_b32 v102, 16, v91
    v_and_b32 v103, 0xffff0000, v91
    v_mul_f32 v96, s54, v96
    v_mul_f32 v97, s54, v97
    v_mul_f32 v98, s54, v98
    v_mul_f32 v99, s54, v99
    v_mul_f32 v100, s54, v100
    v_mul_f32 v101, s54, v101
    v_mul_f32 v102, s54, v102
    v_mul_f32 v103, s54, v103
    v_exp_f32 v96, v96
    v_exp_f32 v97, v97
    v_exp_f32 v98, v98
    v_exp_f32 v99, v99
    v_exp_f32 v100, v100
    v_exp_f32 v101, v101
    v_exp_f32 v102, v102
    v_exp_f32 v103, v103
    v_add_f32 v96, 1.0, v96
    v_add_f32 v97, 1.0, v97
    v_add_f32 v98, 1.0, v98
    v_add_f32 v99, 1.0, v99
    v_add_f32 v100, 1.0, v100
    v_add_f32 v101, 1.0, v101
    v_add_f32 v102, 1.0, v102
    v_add_f32 v103, 1.0, v103
    v_rcp_f32 v96, v96
    v_rcp_f32 v97, v97
    v_rcp_f32 v98, v98
    v_rcp_f32 v99, v99
    v_rcp_f32 v100, v100
    v_rcp_f32 v101, v101
    v_rcp_f32 v102, v102
    v_rcp_f32 v103, v103
    v_mul_f32 v96, v96, v232
    v_mul_f32 v97, v97, v233
    v_mul_f32 v98, v98, v234
    v_mul_f32 v99, v99, v235
    v_mul_f32 v100, v100, v236
    v_mul_f32 v101, v101, v237
    v_mul_f32 v102, v102, v238
    v_mul_f32 v103, v103, v239
    v_cvt_pk_bf16_f32 v88, v96, v97
    v_cvt_pk_bf16_f32 v89, v98, v99
    v_cvt_pk_bf16_f32 v90, v100, v101
    v_cvt_pk_bf16_f32 v91, v102, v103
    buffer_store_dwordx4 v[88:91], v1, s[4:7], s30 offen sc1
    s_add_u32 s30, s30, s50
    v_cvt_pk_bf16_f32 v92, v240, v241
    v_cvt_pk_bf16_f32 v93, v242, v243
    v_cvt_pk_bf16_f32 v94, v244, v245
    v_cvt_pk_bf16_f32 v95, v246, v247
    v_lshlrev_b32 v104, 16, v92
    v_and_b32 v105, 0xffff0000, v92
    v_lshlrev_b32 v106, 16, v93
    v_and_b32 v107, 0xffff0000, v93
    v_lshlrev_b32 v108, 16, v94
    v_and_b32 v109, 0xffff0000, v94
    v_lshlrev_b32 v110, 16, v95
    v_and_b32 v111, 0xffff0000, v95
    v_mul_f32 v104, s54, v104
    v_mul_f32 v105, s54, v105
    v_mul_f32 v106, s54, v106
    v_mul_f32 v107, s54, v107
    v_mul_f32 v108, s54, v108
    v_mul_f32 v109, s54, v109
    v_mul_f32 v110, s54, v110
    v_mul_f32 v111, s54, v111
    v_exp_f32 v104, v104
    v_exp_f32 v105, v105
    v_exp_f32 v106, v106
    v_exp_f32 v107, v107
    v_exp_f32 v108, v108
    v_exp_f32 v109, v109
    v_exp_f32 v110, v110
    v_exp_f32 v111, v111
    v_add_f32 v104, 1.0, v104
    v_add_f32 v105, 1.0, v105
    v_add_f32 v106, 1.0, v106
    v_add_f32 v107, 1.0, v107
    v_add_f32 v108, 1.0, v108
    v_add_f32 v109, 1.0, v109
    v_add_f32 v110, 1.0, v110
    v_add_f32 v111, 1.0, v111
    v_rcp_f32 v104, v104
    v_rcp_f32 v105, v105
    v_rcp_f32 v106, v106
    v_rcp_f32 v107, v107
    v_rcp_f32 v108, v108
    v_rcp_f32 v109, v109
    v_rcp_f32 v110, v110
    v_rcp_f32 v111, v111
    v_mul_f32 v104, v104, v248
    v_mul_f32 v105, v105, v249
    v_mul_f32 v106, v106, v250
    v_mul_f32 v107, v107, v251
    v_mul_f32 v108, v108, v252
    v_mul_f32 v109, v109, v253
    v_mul_f32 v110, v110, v254
    v_mul_f32 v111, v111, v255
    v_cvt_pk_bf16_f32 v92, v104, v105
    v_cvt_pk_bf16_f32 v93, v106, v107
    v_cvt_pk_bf16_f32 v94, v108, v109
    v_cvt_pk_bf16_f32 v95, v110, v111
    buffer_store_dwordx4 v[92:95], v1, s[4:7], s30 offen sc1
    s_waitcnt lgkmcnt(0)
    v_or3_b32 v24, v24, v25, v26
    v_or3_b32 v28, v28, v29, v30
    v_or3_b32 v24, v24, v27, v31
    v_or_b32 v24, v24, v28
    s_mov_b32 s28, s51
    v_readfirstlane_b32 s30, v24
    s_cmp_lg_u32 s30, 0
    s_cbranch_scc1 w_drain
    s_mov_b32 s48, s32
    s_cmp_eq_u32 s32, 4
    s_cselect_b32 s30, 2, 3
    s_lshl_b32 s30, s26, s30
    s_mul_i32 s30, s30, s43
    s_add_u32 s49, s42, s30
    s_mov_b32 s50, s43
    s_mov_b32 s51, s46
    s_mov_b32 s23, s41
    s_mov_b32 s53, s41
    s_branch w_first8
w_firstH:
    s_waitcnt vmcnt(8)
    s_barrier
    s_add_u32 m0, s21, 0
    s_nop 0
    buffer_load_dwordx4 v1, s[4:7], s16 offen sc1 lds
    s_add_u32 s16, s16, s62
    s_add_u32 m0, s21, 1024
    s_nop 0
    buffer_load_dwordx4 v1, s[4:7], s17 offen sc1 lds
    s_add_u32 s17, s17, s62
    s_add_u32 m0, s22, 0
    s_nop 0
    buffer_load_dwordx4 v2, s[8:11], s18 offen lds
    s_add_u32 s18, s18, s20
    s_add_u32 m0, s22, 8192
    s_nop 0
    buffer_load_dwordx4 v2, s[12:15], s19 offen lds
    s_add_u32 s19, s19, s20
    v_mfma_f32_16x16x32_bf16 v[128:131], v[64:67], v[32:35], 0
    ds_read_b64_tr_b16 v[112:113], v8 offset:49152
    v_mfma_f32_16x16x32_bf16 v[132:135], v[68:71], v[32:35], 0
    ds_read_b64_tr_b16 v[114:115], v9 offset:49152
    v_mfma_f32_16x16x32_bf16 v[144:147], v[64:67], v[40:43], 0
    ds_read_b64_tr_b16 v[116:117], v10 offset:49152
    v_mfma_f32_16x16x32_bf16 v[148:151], v[68:71], v[40:43], 0
    ds_read_b64_tr_b16 v[118:119], v11 offset:49152
    v_mfma_f32_16x16x32_bf16 v[160:163], v[64:67], v[48:51], 0
    ds_read_b64_tr_b16 v[120:121], v8 offset:57344
    v_mfma_f32_16x16x32_bf16 v[164:167], v[68:71], v[48:51], 0
    ds_read_b64_tr_b16 v[122:123], v9 offset:57344
    v_mfma_f32_16x16x32_bf16 v[176:179], v[64:67], v[56:59], 0
    ds_read_b64_tr_b16 v[124:125], v10 offset:57344
    v_mfma_f32_16x16x32_bf16 v[180:183], v[68:71], v[56:59], 0
    ds_read_b64_tr_b16 v[126:127], v11 offset:57344
    v_mfma_f32_16x16x32_bf16 v[128:131], v[72:75], v[36:39], v[128:131]
    ds_read_b128 v[80:83], v5 offset:32768
    v_mfma_f32_16x16x32_bf16 v[132:135], v[76:79], v[36:39], v[132:135]
    ds_read_b128 v[84:87], v5 offset:33792
    v_mfma_f32_16x16x32_bf16 v[144:147], v[72:75], v[44:47], v[144:147]
    ds_read_b128 v[88:91], v5 offset:34816
    v_mfma_f32_16x16x32_bf16 v[148:151], v[76:79], v[44:47], v[148:151]
    ds_read_b128 v[92:95], v5 offset:35840
    v_mfma_f32_16x16x32_bf16 v[160:163], v[72:75], v[52:55], v[160:163]
    ds_read_b128 v[96:99], v5 offset:36864
    v_mfma_f32_16x16x32_bf16 v[164:167], v[76:79], v[52:55], v[164:167]
    ds_read_b128 v[100:103], v5 offset:37888
    v_mfma_f32_16x16x32_bf16 v[176:179], v[72:75], v[60:63], v[176:179]
    ds_read_b128 v[104:107], v5 offset:38912
    v_mfma_f32_16x16x32_bf16 v[180:183], v[76:79], v[60:63], v[180:183]
    ds_read_b128 v[108:111], v5 offset:39936
    s_waitcnt lgkmcnt(0)
    s_waitcnt vmcnt(8)
    s_barrier
    s_add_u32 m0, s21, 32768
    s_nop 0
    buffer_load_dwordx4 v1, s[4:7], s16 offen sc1 lds
    s_add_u32 s16, s16, s62
    s_add_u32 m0, s21, 33792
    s_nop 0
    buffer_load_dwordx4 v1, s[4:7], s17 offen sc1 lds
    s_add_u32 s17, s17, s62
    s_add_u32 m0, s22, 32768
    s_nop 0
    buffer_load_dwordx4 v2, s[8:11], s18 offen lds
    s_add_u32 s18, s18, s20
    s_add_u32 m0, s22, 40960
    s_nop 0
    buffer_load_dwordx4 v2, s[12:15], s19 offen lds
    s_add_u32 s19, s19, s20
    v_mfma_f32_16x16x32_bf16 v[128:131], v[112:115], v[80:83], v[128:131]
    ds_read_b64_tr_b16 v[64:65], v12 offset:16384
    v_mfma_f32_16x16x32_bf16 v[132:135], v[116:119], v[80:83], v[132:135]
    ds_read_b64_tr_b16 v[66:67], v13 offset:16384
    v_mfma_f32_16x16x32_bf16 v[144:147], v[112:115], v[88:91], v[144:147]
    ds_read_b64_tr_b16 v[68:69], v14 offset:16384
    v_mfma_f32_16x16x32_bf16 v[148:151], v[116:119], v[88:91], v[148:151]
    ds_read_b64_tr_b16 v[70:71], v15 offset:16384
    v_mfma_f32_16x16x32_bf16 v[160:163], v[112:115], v[96:99], v[160:163]
    ds_read_b64_tr_b16 v[72:73], v12 offset:24576
    v_mfma_f32_16x16x32_bf16 v[164:167], v[116:119], v[96:99], v[164:167]
    ds_read_b64_tr_b16 v[74:75], v13 offset:24576
    v_mfma_f32_16x16x32_bf16 v[176:179], v[112:115], v[104:107], v[176:179]
    ds_read_b64_tr_b16 v[76:77], v14 offset:24576
    v_mfma_f32_16x16x32_bf16 v[180:183], v[116:119], v[104:107], v[180:183]
    ds_read_b64_tr_b16 v[78:79], v15 offset:24576
    v_mfma_f32_16x16x32_bf16 v[128:131], v[120:123], v[84:87], v[128:131]
    ds_read_b128 v[32:35], v6 offset:0
    v_mfma_f32_16x16x32_bf16 v[132:135], v[124:127], v[84:87], v[132:135]
    ds_read_b128 v[36:39], v6 offset:1024
    v_mfma_f32_16x16x32_bf16 v[144:147], v[120:123], v[92:95], v[144:147]
    ds_read_b128 v[40:43], v6 offset:2048
    v_mfma_f32_16x16x32_bf16 v[148:151], v[124:127], v[92:95], v[148:151]
    ds_read_b128 v[44:47], v6 offset:3072
    v_mfma_f32_16x16x32_bf16 v[160:163], v[120:123], v[100:103], v[160:163]
    ds_read_b128 v[48:51], v6 offset:4096
    v_mfma_f32_16x16x32_bf16 v[164:167], v[124:127], v[100:103], v[164:167]
    ds_read_b128 v[52:55], v6 offset:5120
    v_mfma_f32_16x16x32_bf16 v[176:179], v[120:123], v[108:111], v[176:179]
    ds_read_b128 v[56:59], v6 offset:6144
    v_mfma_f32_16x16x32_bf16 v[180:183], v[124:127], v[108:111], v[180:183]
    ds_read_b128 v[60:63], v6 offset:7168
    s_waitcnt lgkmcnt(0)
    s_waitcnt vmcnt(8)
    s_barrier
    s_add_u32 m0, s21, 65536
    s_nop 0
    buffer_load_dwordx4 v1, s[4:7], s16 offen sc1 lds
    s_add_u32 s16, s16, s62
    s_add_u32 m0, s21, 66560
    s_nop 0
    buffer_load_dwordx4 v1, s[4:7], s17 offen sc1 lds
    s_add_u32 s17, s17, s62
    s_add_u32 m0, s22, 65536
    s_nop 0
    buffer_load_dwordx4 v2, s[8:11], s18 offen lds
    s_add_u32 s18, s18, s20
    s_add_u32 m0, s22, 73728
    s_nop 0
    buffer_load_dwordx4 v2, s[12:15], s19 offen lds
    s_add_u32 s19, s19, s20
    v_mfma_f32_16x16x32_bf16 v[128:131], v[64:67], v[32:35], v[128:131]
    ds_read_b64_tr_b16 v[112:113], v12 offset:49152
    v_mfma_f32_16x16x32_bf16 v[132:135], v[68:71], v[32:35], v[132:135]
    ds_read_b64_tr_b16 v[114:115], v13 offset:49152
    v_mfma_f32_16x16x32_bf16 v[144:147], v[64:67], v[40:43], v[144:147]
    ds_read_b64_tr_b16 v[116:117], v14 offset:49152
    v_mfma_f32_16x16x32_bf16 v[148:151], v[68:71], v[40:43], v[148:151]
    ds_read_b64_tr_b16 v[118:119], v15 offset:49152
    v_mfma_f32_16x16x32_bf16 v[160:163], v[64:67], v[48:51], v[160:163]
    ds_read_b64_tr_b16 v[120:121], v12 offset:57344
    v_mfma_f32_16x16x32_bf16 v[164:167], v[68:71], v[48:51], v[164:167]
    ds_read_b64_tr_b16 v[122:123], v13 offset:57344
    v_mfma_f32_16x16x32_bf16 v[176:179], v[64:67], v[56:59], v[176:179]
    ds_read_b64_tr_b16 v[124:125], v14 offset:57344
    v_mfma_f32_16x16x32_bf16 v[180:183], v[68:71], v[56:59], v[180:183]
    ds_read_b64_tr_b16 v[126:127], v15 offset:57344
    v_mfma_f32_16x16x32_bf16 v[128:131], v[72:75], v[36:39], v[128:131]
    ds_read_b128 v[80:83], v6 offset:32768
    v_mfma_f32_16x16x32_bf16 v[132:135], v[76:79], v[36:39], v[132:135]
    ds_read_b128 v[84:87], v6 offset:33792
    v_mfma_f32_16x16x32_bf16 v[144:147], v[72:75], v[44:47], v[144:147]
    ds_read_b128 v[88:91], v6 offset:34816
    v_mfma_f32_16x16x32_bf16 v[148:151], v[76:79], v[44:47], v[148:151]
    ds_read_b128 v[92:95], v6 offset:35840
    v_mfma_f32_16x16x32_bf16 v[160:163], v[72:75], v[52:55], v[160:163]
    ds_read_b128 v[96:99], v6 offset:36864
    v_mfma_f32_16x16x32_bf16 v[164:167], v[76:79], v[52:55], v[164:167]
    ds_read_b128 v[100:103], v6 offset:37888
    v_mfma_f32_16x16x32_bf16 v[176:179], v[72:75], v[60:63], v[176:179]
    ds_read_b128 v[104:107], v6 offset:38912
    v_mfma_f32_16x16x32_bf16 v[180:183], v[76:79], v[60:63], v[180:183]
    ds_read_b128 v[108:111], v6 offset:39936
    s_waitcnt lgkmcnt(0)
    s_waitcnt vmcnt(8)
    s_barrier
    s_add_u32 m0, s21, 98304
    s_nop 0
    buffer_load_dwordx4 v1, s[4:7], s16 offen sc1 lds
    s_add_u32 s16, s16, s62
    s_add_u32 m0, s21, 99328
    s_nop 0
    buffer_load_dwordx4 v1, s[4:7], s17 offen sc1 lds
    s_add_u32 s17, s17, s62
    s_add_u32 m0, s22, 98304
    s_nop 0
    buffer_load_dwordx4 v2, s[8:11], s18 offen lds
    s_add_u32 s18, s18, s20
    s_add_u32 m0, s22, 106496
    s_nop 0
    buffer_load_dwordx4 v2, s[12:15], s19 offen lds
    s_add_u32 s19, s19, s20
    v_mfma_f32_16x16x32_bf16 v[128:131], v[112:115], v[80:83], v[128:131]
    ds_read_b64_tr_b16 v[64:65], v8 offset:16384
    v_mfma_f32_16x16x32_bf16 v[132:135], v[116:119], v[80:83], v[132:135]
    ds_read_b64_tr_b16 v[66:67], v9 offset:16384
    v_mfma_f32_16x16x32_bf16 v[144:147], v[112:115], v[88:91], v[144:147]
    ds_read_b64_tr_b16 v[68:69], v10 offset:16384
    v_mfma_f32_16x16x32_bf16 v[148:151], v[116:119], v[88:91], v[148:151]
    ds_read_b64_tr_b16 v[70:71], v11 offset:16384
    v_mfma_f32_16x16x32_bf16 v[160:163], v[112:115], v[96:99], v[160:163]
    ds_read_b64_tr_b16 v[72:73], v8 offset:24576
    v_mfma_f32_16x16x32_bf16 v[164:167], v[116:119], v[96:99], v[164:167]
    ds_read_b64_tr_b16 v[74:75], v9 offset:24576
    v_mfma_f32_16x16x32_bf16 v[176:179], v[112:115], v[104:107], v[176:179]
    ds_read_b64_tr_b16 v[76:77], v10 offset:24576
    v_mfma_f32_16x16x32_bf16 v[180:183], v[116:119], v[104:107], v[180:183]
    ds_read_b64_tr_b16 v[78:79], v11 offset:24576
    v_mfma_f32_16x16x32_bf16 v[128:131], v[120:123], v[84:87], v[128:131]
    ds_read_b128 v[32:35], v5 offset:0
    v_mfma_f32_16x16x32_bf16 v[132:135], v[124:127], v[84:87], v[132:135]
    ds_read_b128 v[36:39], v5 offset:1024
    v_mfma_f32_16x16x32_bf16 v[144:147], v[120:123], v[92:95], v[144:147]
    ds_read_b128 v[40:43], v5 offset:2048
    v_mfma_f32_16x16x32_bf16 v[148:151], v[124:127], v[92:95], v[148:151]
    ds_read_b128 v[44:47], v5 offset:3072
    v_mfma_f32_16x16x32_bf16 v[160:163], v[120:123], v[100:103], v[160:163]
    ds_read_b128 v[48:51], v5 offset:4096
    v_mfma_f32_16x16x32_bf16 v[164:167], v[124:127], v[100:103], v[164:167]
    ds_read_b128 v[52:55], v5 offset:5120
    v_mfma_f32_16x16x32_bf16 v[176:179], v[120:123], v[108:111], v[176:179]
    ds_read_b128 v[56:59], v5 offset:6144
    v_mfma_f32_16x16x32_bf16 v[180:183], v[124:127], v[108:111], v[180:183]
    ds_read_b128 v[60:63], v5 offset:7168
    s_waitcnt lgkmcnt(0)
w_loop_chkH:
    s_sub_u32 s23, s23, 1
w_loopH:
    s_cmp_gt_u32 s23, 3
    s_cbranch_scc1 w_bodyH
    s_cmp_lg_u32 s23, 3
    s_cbranch_scc1 w_l2H
    s_cmp_lg_u32 s3, 0
    s_cbranch_scc1 clm_8
    v_mov_b32 v26, 1
    s_mov_b64 exec, 1
    buffer_atomic_add v26, off, s[64:67], s71 sc0 sc1
    s_mov_b64 exec, -1
clm_8:
    s_branch w_bodyH
w_l2H:
    s_cmp_lg_u32 s23, 2
    s_cbranch_scc1 w_l1H
    s_cmp_lg_u32 s3, 0
    s_cbranch_scc1 pub_9
    v_mov_b32 v20, 131136
    s_mov_b64 exec, 1
    ds_write_b32 v20, v26
    s_mov_b64 exec, -1
    s_waitcnt lgkmcnt(0)
pub_9:
    s_branch w_bodyH
w_l1H:
    s_waitcnt vmcnt(8)
    buffer_load_dword v22, off, s[64:67], 0 sc1
    v_readfirstlane_b32 s30, v16
    s_cmp_ge_u32 s30, s45
    s_cselect_b32 s30, 0, 1
    s_or_b32 s30, s30, s70
    s_cmp_eq_u32 s32, 4
    s_cselect_b32 s30, 1, s30
    s_sub_u32 s57, s32, 1
    s_cmp_ge_u32 s57, 4
    s_cselect_b32 s30, 1, s30
    v_mov_b32 v20, s30
    ds_write_b32 v7, v20
    s_cbranch_scc1 w_bodyH
    s_load_dwordx2 s[8:9], s[0:1], s33
    s_load_dwordx2 s[12:13], s[0:1], s34
    s_mov_b32 s10, s38
    s_mov_b32 s14, s38
    s_cmp_eq_u32 s32, 4
    s_cselect_b32 s31, 0, 1
    s_lshl_b32 s30, s3, s31
    s_mul_i32 s30, s30, s40
    s_add_u32 s16, s39, s30
    s_cmp_eq_u32 s32, 4
    s_cselect_b32 s30, 1024, s40
    s_cselect_b32 s31, 6, 5
    s_lshl_b32 s62, 32, s31
    s_add_u32 s17, s16, s30
    s_lshl_b32 s30, s3, 2
    s_mul_i32 s30, s30, s35
    s_add_u32 s18, s36, s30
    s_add_u32 s19, s37, s30
    s_lshl_b32 s20, s35, s31
    v_mul_u32_u24 v2, s35, v4
    v_add_u32 v2, v2, v3
    s_waitcnt lgkmcnt(0)
w_bodyH:
    s_waitcnt vmcnt(8)
    s_barrier
    s_cmp_lg_u32 s23, 2
    s_cbranch_scc1 w_nfH
    v_mov_b32 v20, 131136
    ds_read_b32 v20, v20
    s_waitcnt lgkmcnt(0)
    v_readfirstlane_b32 s59, v20
    s_add_u32 s59, s59, 32
    s_min_u32 s59, s59, 322
    s_lshl_b32 s57, s59, 6
    s_load_dwordx16 s[32:47], s[24:25], s57
w_nfH:
    s_add_u32 m0, s21, 0
    s_nop 0
    buffer_load_dwordx4 v1, s[4:7], s16 offen sc1 lds
    s_add_u32 s16, s16, s62
    s_add_u32 m0, s21, 1024
    s_nop 0
    buffer_load_dwordx4 v1, s[4:7], s17 offen sc1 lds
    s_add_u32 s17, s17, s62
    s_add_u32 m0, s22, 0
    s_nop 0
    buffer_load_dwordx4 v2, s[8:11], s18 offen lds
    s_add_u32 s18, s18, s20
    s_add_u32 m0, s22, 8192
    s_nop 0
    buffer_load_dwordx4 v2, s[12:15], s19 offen lds
    s_add_u32 s19, s19, s20
    v_mfma_f32_16x16x32_bf16 v[128:131], v[64:67], v[32:35], v[128:131]
    ds_read_b64_tr_b16 v[112:113], v8 offset:49152
    v_mfma_f32_16x16x32_bf16 v[132:135], v[68:71], v[32:35], v[132:135]
    ds_read_b64_tr_b16 v[114:115], v9 offset:49152
    v_mfma_f32_16x16x32_bf16 v[144:147], v[64:67], v[40:43], v[144:147]
    ds_read_b64_tr_b16 v[116:117], v10 offset:49152
    v_mfma_f32_16x16x32_bf16 v[148:151], v[68:71], v[40:43], v[148:151]
    ds_read_b64_tr_b16 v[118:119], v11 offset:49152
    v_mfma_f32_16x16x32_bf16 v[160:163], v[64:67], v[48:51], v[160:163]
    ds_read_b64_tr_b16 v[120:121], v8 offset:57344
    v_mfma_f32_16x16x32_bf16 v[164:167], v[68:71], v[48:51], v[164:167]
    ds_read_b64_tr_b16 v[122:123], v9 offset:57344
    v_mfma_f32_16x16x32_bf16 v[176:179], v[64:67], v[56:59], v[176:179]
    ds_read_b64_tr_b16 v[124:125], v10 offset:57344
    v_mfma_f32_16x16x32_bf16 v[180:183], v[68:71], v[56:59], v[180:183]
    ds_read_b64_tr_b16 v[126:127], v11 offset:57344
    v_mfma_f32_16x16x32_bf16 v[128:131], v[72:75], v[36:39], v[128:131]
    ds_read_b128 v[80:83], v5 offset:32768
    v_mfma_f32_16x16x32_bf16 v[132:135], v[76:79], v[36:39], v[132:135]
    ds_read_b128 v[84:87], v5 offset:33792
    v_mfma_f32_16x16x32_bf16 v[144:147], v[72:75], v[44:47], v[144:147]
    ds_read_b128 v[88:91], v5 offset:34816
    v_mfma_f32_16x16x32_bf16 v[148:151], v[76:79], v[44:47], v[148:151]
    ds_read_b128 v[92:95], v5 offset:35840
    v_mfma_f32_16x16x32_bf16 v[160:163], v[72:75], v[52:55], v[160:163]
    ds_read_b128 v[96:99], v5 offset:36864
    v_mfma_f32_16x16x32_bf16 v[164:167], v[76:79], v[52:55], v[164:167]
    ds_read_b128 v[100:103], v5 offset:37888
    v_mfma_f32_16x16x32_bf16 v[176:179], v[72:75], v[60:63], v[176:179]
    ds_read_b128 v[104:107], v5 offset:38912
    v_mfma_f32_16x16x32_bf16 v[180:183], v[76:79], v[60:63], v[180:183]
    ds_read_b128 v[108:111], v5 offset:39936
    s_waitcnt lgkmcnt(0)
    s_waitcnt vmcnt(8)
    s_barrier
    buffer_load_dword v16, v17, s[4:7], s44 offen sc1
    s_add_u32 m0, s21, 32768
    s_nop 0
    buffer_load_dwordx4 v1, s[4:7], s16 offen sc1 lds
    s_add_u32 s16, s16, s62
    s_add_u32 m0, s21, 33792
    s_nop 0
    buffer_load_dwordx4 v1, s[4:7], s17 offen sc1 lds
    s_add_u32 s17, s17, s62
    s_add_u32 m0, s22, 32768
    s_nop 0
    buffer_load_dwordx4 v2, s[8:11], s18 offen lds
    s_add_u32 s18, s18, s20
    s_add_u32 m0, s22, 40960
    s_nop 0
    buffer_load_dwordx4 v2, s[12:15], s19 offen lds
    s_add_u32 s19, s19, s20
    v_mfma_f32_16x16x32_bf16 v[128:131], v[112:115], v[80:83], v[128:131]
    ds_read_b64_tr_b16 v[64:65], v12 offset:16384
    v_mfma_f32_16x16x32_bf16 v[132:135], v[116:119], v[80:83], v[132:135]
    ds_read_b64_tr_b16 v[66:67], v13 offset:16384
    v_mfma_f32_16x16x32_bf16 v[144:147], v[112:115], v[88:91], v[144:147]
    ds_read_b64_tr_b16 v[68:69], v14 offset:16384
    v_mfma_f32_16x16x32_bf16 v[148:151], v[116:119], v[88:91], v[148:151]
    ds_read_b64_tr_b16 v[70:71], v15 offset:16384
    v_mfma_f32_16x16x32_bf16 v[160:163], v[112:115], v[96:99], v[160:163]
    ds_read_b64_tr_b16 v[72:73], v12 offset:24576
    v_mfma_f32_16x16x32_bf16 v[164:167], v[116:119], v[96:99], v[164:167]
    ds_read_b64_tr_b16 v[74:75], v13 offset:24576
    v_mfma_f32_16x16x32_bf16 v[176:179], v[112:115], v[104:107], v[176:179]
    ds_read_b64_tr_b16 v[76:77], v14 offset:24576
    v_mfma_f32_16x16x32_bf16 v[180:183], v[116:119], v[104:107], v[180:183]
    ds_read_b64_tr_b16 v[78:79], v15 offset:24576
    v_mfma_f32_16x16x32_bf16 v[128:131], v[120:123], v[84:87], v[128:131]
    ds_read_b128 v[32:35], v6 offset:0
    v_mfma_f32_16x16x32_bf16 v[132:135], v[124:127], v[84:87], v[132:135]
    ds_read_b128 v[36:39], v6 offset:1024
    v_mfma_f32_16x16x32_bf16 v[144:147], v[120:123], v[92:95], v[144:147]
    ds_read_b128 v[40:43], v6 offset:2048
    v_mfma_f32_16x16x32_bf16 v[148:151], v[124:127], v[92:95], v[148:151]
    ds_read_b128 v[44:47], v6 offset:3072
    v_mfma_f32_16x16x32_bf16 v[160:163], v[120:123], v[100:103], v[160:163]
    ds_read_b128 v[48:51], v6 offset:4096
    v_mfma_f32_16x16x32_bf16 v[164:167], v[124:127], v[100:103], v[164:167]
    ds_read_b128 v[52:55], v6 offset:5120
    v_mfma_f32_16x16x32_bf16 v[176:179], v[120:123], v[108:111], v[176:179]
    ds_read_b128 v[56:59], v6 offset:6144
    v_mfma_f32_16x16x32_bf16 v[180:183], v[124:127], v[108:111], v[180:183]
    ds_read_b128 v[60:63], v6 offset:7168
    s_waitcnt lgkmcnt(0)
    s_waitcnt vmcnt(8)
    s_barrier
    s_add_u32 m0, s21, 65536
    s_nop 0
    buffer_load_dwordx4 v1, s[4:7], s16 offen sc1 lds
    s_add_u32 s16, s16, s62
    s_add_u32 m0, s21, 66560
    s_nop 0
    buffer_load_dwordx4 v1, s[4:7], s17 offen sc1 lds
    s_add_u32 s17, s17, s62
    s_add_u32 m0, s22, 65536
    s_nop 0
    buffer_load_dwordx4 v2, s[8:11], s18 offen lds
    s_add_u32 s18, s18, s20
    s_add_u32 m0, s22, 73728
    s_nop 0
    buffer_load_dwordx4 v2, s[12:15], s19 offen lds
    s_add_u32 s19, s19, s20
    v_mfma_f32_16x16x32_bf16 v[128:131], v[64:67], v[32:35], v[128:131]
    ds_read_b64_tr_b16 v[112:113], v12 offset:49152
    v_mfma_f32_16x16x32_bf16 v[132:135], v[68:71], v[32:35], v[132:135]
    ds_read_b64_tr_b16 v[114:115], v13 offset:49152
    v_mfma_f32_16x16x32_bf16 v[144:147], v[64:67], v[40:43], v[144:147]
    ds_read_b64_tr_b16 v[116:117], v14 offset:49152
    v_mfma_f32_16x16x32_bf16 v[148:151], v[68:71], v[40:43], v[148:151]
    ds_read_b64_tr_b16 v[118:119], v15 offset:49152
    v_mfma_f32_16x16x32_bf16 v[160:163], v[64:67], v[48:51], v[160:163]
    ds_read_b64_tr_b16 v[120:121], v12 offset:57344
    v_mfma_f32_16x16x32_bf16 v[164:167], v[68:71], v[48:51], v[164:167]
    ds_read_b64_tr_b16 v[122:123], v13 offset:57344
    v_mfma_f32_16x16x32_bf16 v[176:179], v[64:67], v[56:59], v[176:179]
    ds_read_b64_tr_b16 v[124:125], v14 offset:57344
    v_mfma_f32_16x16x32_bf16 v[180:183], v[68:71], v[56:59], v[180:183]
    ds_read_b64_tr_b16 v[126:127], v15 offset:57344
    v_mfma_f32_16x16x32_bf16 v[128:131], v[72:75], v[36:39], v[128:131]
    ds_read_b128 v[80:83], v6 offset:32768
    v_mfma_f32_16x16x32_bf16 v[132:135], v[76:79], v[36:39], v[132:135]
    ds_read_b128 v[84:87], v6 offset:33792
    v_mfma_f32_16x16x32_bf16 v[144:147], v[72:75], v[44:47], v[144:147]
    ds_read_b128 v[88:91], v6 offset:34816
    v_mfma_f32_16x16x32_bf16 v[148:151], v[76:79], v[44:47], v[148:151]
    ds_read_b128 v[92:95], v6 offset:35840
    v_mfma_f32_16x16x32_bf16 v[160:163], v[72:75], v[52:55], v[160:163]
    ds_read_b128 v[96:99], v6 offset:36864
    v_mfma_f32_16x16x32_bf16 v[164:167], v[76:79], v[52:55], v[164:167]
    ds_read_b128 v[100:103], v6 offset:37888
    v_mfma_f32_16x16x32_bf16 v[176:179], v[72:75], v[60:63], v[176:179]
    ds_read_b128 v[104:107], v6 offset:38912
    v_mfma_f32_16x16x32_bf16 v[180:183], v[76:79], v[60:63], v[180:183]
    ds_read_b128 v[108:111], v6 offset:39936
    s_waitcnt lgkmcnt(0)
    s_waitcnt vmcnt(8)
    s_barrier
    s_add_u32 m0, s21, 98304
    s_nop 0
    buffer_load_dwordx4 v1, s[4:7], s16 offen sc1 lds
    s_add_u32 s16, s16, s62
    s_add_u32 m0, s21, 99328
    s_nop 0
    buffer_load_dwordx4 v1, s[4:7], s17 offen sc1 lds
    s_add_u32 s17, s17, s62
    s_add_u32 m0, s22, 98304
    s_nop 0
    buffer_load_dwordx4 v2, s[8:11], s18 offen lds
    s_add_u32 s18, s18, s20
    s_add_u32 m0, s22, 106496
    s_nop 0
    buffer_load_dwordx4 v2, s[12:15], s19 offen lds
    s_add_u32 s19, s19, s20
    v_mfma_f32_16x16x32_bf16 v[128:131], v[112:115], v[80:83], v[128:131]
    ds_read_b64_tr_b16 v[64:65], v8 offset:16384
    v_mfma_f32_16x16x32_bf16 v[132:135], v[116:119], v[80:83], v[132:135]
    ds_read_b64_tr_b16 v[66:67], v9 offset:16384
    v_mfma_f32_16x16x32_bf16 v[144:147], v[112:115], v[88:91], v[144:147]
    ds_read_b64_tr_b16 v[68:69], v10 offset:16384
    v_mfma_f32_16x16x32_bf16 v[148:151], v[116:119], v[88:91], v[148:151]
    ds_read_b64_tr_b16 v[70:71], v11 offset:16384
    v_mfma_f32_16x16x32_bf16 v[160:163], v[112:115], v[96:99], v[160:163]
    ds_read_b64_tr_b16 v[72:73], v8 offset:24576
    v_mfma_f32_16x16x32_bf16 v[164:167], v[116:119], v[96:99], v[164:167]
    ds_read_b64_tr_b16 v[74:75], v9 offset:24576
    v_mfma_f32_16x16x32_bf16 v[176:179], v[112:115], v[104:107], v[176:179]
    ds_read_b64_tr_b16 v[76:77], v10 offset:24576
    v_mfma_f32_16x16x32_bf16 v[180:183], v[116:119], v[104:107], v[180:183]
    ds_read_b64_tr_b16 v[78:79], v11 offset:24576
    v_mfma_f32_16x16x32_bf16 v[128:131], v[120:123], v[84:87], v[128:131]
    ds_read_b128 v[32:35], v5 offset:0
    v_mfma_f32_16x16x32_bf16 v[132:135], v[124:127], v[84:87], v[132:135]
    ds_read_b128 v[36:39], v5 offset:1024
    v_mfma_f32_16x16x32_bf16 v[144:147], v[120:123], v[92:95], v[144:147]
    ds_read_b128 v[40:43], v5 offset:2048
    v_mfma_f32_16x16x32_bf16 v[148:151], v[124:127], v[92:95], v[148:151]
    ds_read_b128 v[44:47], v5 offset:3072
    v_mfma_f32_16x16x32_bf16 v[160:163], v[120:123], v[100:103], v[160:163]
    ds_read_b128 v[48:51], v5 offset:4096
    v_mfma_f32_16x16x32_bf16 v[164:167], v[124:127], v[100:103], v[164:167]
    ds_read_b128 v[52:55], v5 offset:5120
    v_mfma_f32_16x16x32_bf16 v[176:179], v[120:123], v[108:111], v[176:179]
    ds_read_b128 v[56:59], v5 offset:6144
    v_mfma_f32_16x16x32_bf16 v[180:183], v[124:127], v[108:111], v[180:183]
    ds_read_b128 v[60:63], v5 offset:7168
    s_waitcnt lgkmcnt(0)
    s_sub_u32 s23, s23, 1
    s_cmp_lg_u32 s23, 0
    s_cbranch_scc1 w_loopH
    v_mov_b32 v20, 131072
    ds_read_b128 v[24:27], v20
    ds_read_b128 v[28:31], v20 offset:16
    s_lshl_b32 s30, s27, 10
    s_add_u32 s30, s30, s49
    s_nop 7
    v_cvt_pk_bf16_f32 v80, v128, v129
    v_cvt_pk_bf16_f32 v81, v130, v131
    v_cvt_pk_bf16_f32 v82, v132, v133
    v_cvt_pk_bf16_f32 v83, v134, v135
    buffer_store_dwordx4 v[80:83], v1, s[4:7], s30 offen sc1
    s_add_u32 s30, s30, s50
    v_cvt_pk_bf16_f32 v84, v144, v145
    v_cvt_pk_bf16_f32 v85, v146, v147
    v_cvt_pk_bf16_f32 v86, v148, v149
    v_cvt_pk_bf16_f32 v87, v150, v151
    buffer_store_dwordx4 v[84:87], v1, s[4:7], s30 offen sc1
    s_add_u32 s30, s30, s50
    v_cvt_pk_bf16_f32 v88, v160, v161
    v_cvt_pk_bf16_f32 v89, v162, v163
    v_cvt_pk_bf16_f32 v90, v164, v165
    v_cvt_pk_bf16_f32 v91, v166, v167
    buffer_store_dwordx4 v[88:91], v1, s[4:7], s30 offen sc1
    s_add_u32 s30, s30, s50
    v_cvt_pk_bf16_f32 v92, v176, v177
    v_cvt_pk_bf16_f32 v93, v178, v179
    v_cvt_pk_bf16_f32 v94, v180, v181
    v_cvt_pk_bf16_f32 v95, v182, v183
    buffer_store_dwordx4 v[92:95], v1, s[4:7], s30 offen sc1
    s_add_u32 s30, s30, s50
    s_waitcnt lgkmcnt(0)
    v_or3_b32 v24, v24, v25, v26
    v_or3_b32 v28, v28, v29, v30
    v_or3_b32 v24, v24, v27, v31
    v_or_b32 v24, v24, v28
    s_mov_b32 s28, s51
    v_readfirstlane_b32 s30, v24
    s_cmp_lg_u32 s30, 0
    s_cbranch_scc1 w_drain
    s_mov_b32 s48, s32
    s_cmp_eq_u32 s32, 4
    s_cselect_b32 s30, 2, 3
    s_lshl_b32 s30, s26, s30
    s_mul_i32 s30, s30, s43
    s_add_u32 s49, s42, s30
    s_mov_b32 s50, s43
    s_mov_b32 s51, s46
    s_mov_b32 s23, s41
    s_mov_b32 s53, s41
    s_branch w_first4
w_drain:
    s_waitcnt vmcnt(0)
    s_barrier
    s_cmp_eq_u32 s70, 0
    s_cbranch_scc1 drw_ok
    s_mov_b32 s70, 0
    s_cmp_lg_u32 s3, 0
    s_cbranch_scc1 drw_ok
    v_readfirstlane_b32 s68, v22
    s_cmp_ge_u32 s68, 128
    s_cbranch_scc1 drw_ok
    s_mov_b32 s69, 65536
drw:
    buffer_load_dword v20, off, s[64:67], 0 offset:0 sc1
    s_waitcnt vmcnt(0)
    v_readfirstlane_b32 s68, v20
    s_cmp_ge_u32 s68, 128
    s_cbranch_scc1 drw_ok
    s_sleep 8
    s_sub_u32 s69, s69, 1
    s_cbranch_scc0 drw
drw_ok:
    s_cmp_eq_u32 s28, 0
    s_cbranch_scc1 sig_10
    s_cmp_lg_u32 s3, 0
    s_cbranch_scc1 sig_10
    s_and_b32 s57, s28, 3
    v_mov_b32 v24, s57
    s_bfe_u32 s57, s28, 0x20002
    v_mov_b32 v25, s57
    s_andn2_b32 s28, s28, 15
    s_mov_b64 exec, 1
    buffer_atomic_add_x2 v[24:25], v17, s[4:7], s28 offen sc1
    s_mov_b64 exec, -1
sig_10:
    s_mov_b32 s28, 0
    s_cmp_ge_u32 s53, 4
    s_cbranch_scc1 w_cold
    s_cmp_lg_u32 s3, 0
    s_cbranch_scc1 clm_11
    v_mov_b32 v26, 1
    s_mov_b64 exec, 1
    buffer_atomic_add v26, off, s[64:67], s71 sc0 sc1
    s_mov_b64 exec, -1
clm_11:
    s_waitcnt vmcnt(0)
    s_cmp_lg_u32 s3, 0
    s_cbranch_scc1 pub_12
    v_mov_b32 v20, 131136
    s_mov_b64 exec, 1
    ds_write_b32 v20, v26
    s_mov_b64 exec, -1
    s_waitcnt lgkmcnt(0)
pub_12:
    s_barrier
    v_mov_b32 v20, 131136
    ds_read_b32 v20, v20
    s_waitcnt lgkmcnt(0)
    v_readfirstlane_b32 s59, v20
    s_add_u32 s59, s59, 32
    s_min_u32 s59, s59, 322
    s_lshl_b32 s57, s59, 6
    s_load_dwordx16 s[32:47], s[24:25], s57
    s_waitcnt lgkmcnt(0)
    s_barrier
    s_branch w_cold
w_att:
    s_cmp_lg_u32 s3, 0
    s_cbranch_scc1 w_att_go
    s_mov_b32 s31, 0x40000
w_att_w:
    buffer_load_dwordx2 v[20:21], off, s[4:7], s33 sc1
    s_waitcnt vmcnt(0)
    v_add_u32 v20, v20, v21
    s_nop 0
    v_readfirstlane_b32 s30, v20
    s_cmp_ge_u32 s30, 8
    s_cbranch_scc1 w_att_go
    s_sleep 16
    s_sub_u32 s31, s31, 1
    s_cbranch_scc0 w_att_w
w_att_go:
    s_cmp_lg_u32 s3, 0
    s_cbranch_scc1 clm_13
    v_mov_b32 v250, 1
    s_mov_b64 exec, 1
    buffer_atomic_add v250, off, s[64:67], s71 sc0 sc1
    s_mov_b64 exec, -1
clm_13:
    s_barrier
    v_lshrrev_b32 v20, 4, v1
    v_lshrrev_b32 v21, 4, v20
    v_and_b32 v22, 15, v20
    v_lshlrev_b32 v23, 2, v21
    v_add_u32 v24, 0, v23
    v_cmp_gt_u32 s[72:73], v24, v22
    v_add_u32 v24, 1, v23
    v_cmp_gt_u32 s[74:75], v24, v22
    v_add_u32 v24, 2, v23
    v_cmp_gt_u32 s[76:77], v24, v22
    v_add_u32 v24, 3, v23
    v_cmp_gt_u32 s[78:79], v24, v22
    s_mul_i32 s83, s3, 10240
    v_and_b32 v22, 3, v20
    v_bfe_u32 v24, v20, 2, 2
    v_add_u32 v23, v23, v24
    v_lshl_add_u32 v23, v22, 4, v23
    v_lshlrev_b32 v23, 4, v23
    v_add_u32 v25, s83, v23
    v_and_b32 v24, 1, v24
    v_lshl_add_u32 v24, v21, 1, v24
    v_lshl_add_u32 v24, v22, 3, v24
    v_lshlrev_b32 v24, 4, v24
    v_add_u32 v26, s83, v24
    v_mov_b32 v22, 0xff61b1e6
    v_mov_b32 v136, 0
    v_mov_b32 v137, 0
    v_mov_b32 v220, 0
    v_mov_b32 v221, 0
    s_mov_b32 s80, 0x3e0293ee
    s_lshr_b32 s85, s3, 2
    s_add_u32 s85, s85, s39
    s_lshl_b32 s81, s85, 18
    s_and_b32 s85, s3, 3
    s_add_u32 s85, s85, s36
    s_lshl_b32 s82, s85, 13
    s_add_u32 s82, s82, s81
    s_add_u32 s82, s82, 192937984
    s_lshl_b32 s85, s85, 12
    s_add_u32 s81, s81, s85
    v_mov_b32 v28, 0x3f803f80
    v_mov_b32 v29, 0x3f803f80
    v_mov_b32 v30, 0x3f803f80
    v_mov_b32 v31, 0x3f803f80
    s_add_u32 s86, s82, 0
    buffer_load_dwordx4 v[120:123], v1, s[4:7], s86 offen offset:0 sc1
    buffer_load_dwordx4 v[124:127], v1, s[4:7], s86 offen offset:1024 sc1
    buffer_load_dwordx4 v[128:131], v1, s[4:7], s86 offen offset:2048 sc1
    buffer_load_dwordx4 v[132:135], v1, s[4:7], s86 offen offset:3072 sc1
    s_add_u32 s85, s81, 4194304
    buffer_load_dwordx4 v[56:59], v1, s[4:7], s85 offen offset:0 sc1
    buffer_load_dwordx4 v[60:63], v1, s[4:7], s85 offen offset:1024 sc1
    buffer_load_dwordx4 v[64:67], v1, s[4:7], s85 offen offset:2048 sc1
    buffer_load_dwordx4 v[68:71], v1, s[4:7], s85 offen offset:3072 sc1
    s_add_u32 s85, s81, 4325376
    buffer_load_dwordx4 v[72:75], v1, s[4:7], s85 offen offset:0 sc1
    buffer_load_dwordx4 v[76:79], v1, s[4:7], s85 offen offset:1024 sc1
    buffer_load_dwordx4 v[80:83], v1, s[4:7], s85 offen offset:2048 sc1
    buffer_load_dwordx4 v[84:87], v1, s[4:7], s85 offen offset:3072 sc1
    s_add_u32 s85, s81, 20971520
    buffer_load_dwordx4 v[88:91], v1, s[4:7], s85 offen offset:0 sc1
    buffer_load_dwordx4 v[92:95], v1, s[4:7], s85 offen offset:1024 sc1
    buffer_load_dwordx4 v[96:99], v1, s[4:7], s85 offen offset:2048 sc1
    buffer_load_dwordx4 v[100:103], v1, s[4:7], s85 offen offset:3072 sc1
    s_add_u32 s85, s81, 21102592
    buffer_load_dwordx4 v[104:107], v1, s[4:7], s85 offen offset:0 sc1
    buffer_load_dwordx4 v[108:111], v1, s[4:7], s85 offen offset:1024 sc1
    buffer_load_dwordx4 v[112:115], v1, s[4:7], s85 offen offset:2048 sc1
    buffer_load_dwordx4 v[116:119], v1, s[4:7], s85 offen offset:3072 sc1
    s_add_u32 m0, s83, 0
    s_add_u32 s85, s81, 37748736
    buffer_load_dwordx4 v1, s[4:7], s85 offen offset:0 sc1 lds
    buffer_load_dwordx4 v1, s[4:7], s85 offen offset:1024 sc1 lds
    buffer_load_dwordx4 v1, s[4:7], s85 offen offset:2048 sc1 lds
    buffer_load_dwordx4 v1, s[4:7], s85 offen offset:3072 sc1 lds
    s_add_u32 m0, s83, 4096
    s_add_u32 s85, s81, 37879808
    buffer_load_dwordx4 v1, s[4:7], s85 offen offset:0 sc1 lds
    buffer_load_dwordx4 v1, s[4:7], s85 offen offset:1024 sc1 lds
    buffer_load_dwordx4 v1, s[4:7], s85 offen offset:2048 sc1 lds
    buffer_load_dwordx4 v1, s[4:7], s85 offen offset:3072 sc1 lds
    s_add_u32 m0, s83, 8192
    s_add_u32 s85, s82, 4096
    buffer_load_dwordx4 v1, s[4:7], s85 offen offset:0 sc1 lds
    buffer_load_dwordx4 v1, s[4:7], s85 offen offset:1024 sc1 lds
    s_add_u32 s86, s82, 524288
    buffer_load_dwordx4 v[204:207], v1, s[4:7], s86 offen offset:0 sc1
    buffer_load_dwordx4 v[208:211], v1, s[4:7], s86 offen offset:1024 sc1
    buffer_load_dwordx4 v[212:215], v1, s[4:7], s86 offen offset:2048 sc1
    buffer_load_dwordx4 v[216:219], v1, s[4:7], s86 offen offset:3072 sc1
    s_add_u32 s85, s81, 4718592
    buffer_load_dwordx4 v[140:143], v1, s[4:7], s85 offen offset:0 sc1
    buffer_load_dwordx4 v[144:147], v1, s[4:7], s85 offen offset:1024 sc1
    buffer_load_dwordx4 v[148:151], v1, s[4:7], s85 offen offset:2048 sc1
    buffer_load_dwordx4 v[152:155], v1, s[4:7], s85 offen offset:3072 sc1
    s_add_u32 s85, s81, 4849664
    buffer_load_dwordx4 v[156:159], v1, s[4:7], s85 offen offset:0 sc1
    buffer_load_dwordx4 v[160:163], v1, s[4:7], s85 offen offset:1024 sc1
    buffer_load_dwordx4 v[164:167], v1, s[4:7], s85 offen offset:2048 sc1
    buffer_load_dwordx4 v[168:171], v1, s[4:7], s85 offen offset:3072 sc1
    s_add_u32 s85, s81, 21495808
    buffer_load_dwordx4 v[172:175], v1, s[4:7], s85 offen offset:0 sc1
    buffer_load_dwordx4 v[176:179], v1, s[4:7], s85 offen offset:1024 sc1
    buffer_load_dwordx4 v[180:183], v1, s[4:7], s85 offen offset:2048 sc1
    buffer_load_dwordx4 v[184:187], v1, s[4:7], s85 offen offset:3072 sc1
    s_add_u32 s85, s81, 21626880
    buffer_load_dwordx4 v[188:191], v1, s[4:7], s85 offen offset:0 sc1
    buffer_load_dwordx4 v[192:195], v1, s[4:7], s85 offen offset:1024 sc1
    buffer_load_dwordx4 v[196:199], v1, s[4:7], s85 offen offset:2048 sc1
    buffer_load_dwordx4 v[200:203], v1, s[4:7], s85 offen offset:3072 sc1
    s_add_u32 m0, s83, 81920
    s_add_u32 s85, s81, 38273024
    buffer_load_dwordx4 v1, s[4:7], s85 offen offset:0 sc1 lds
    buffer_load_dwordx4 v1, s[4:7], s85 offen offset:1024 sc1 lds
    buffer_load_dwordx4 v1, s[4:7], s85 offen offset:2048 sc1 lds
    buffer_load_dwordx4 v1, s[4:7], s85 offen offset:3072 sc1 lds
    s_add_u32 m0, s83, 86016
    s_add_u32 s85, s81, 38404096
    buffer_load_dwordx4 v1, s[4:7], s85 offen offset:0 sc1 lds
    buffer_load_dwordx4 v1, s[4:7], s85 offen offset:1024 sc1 lds
    buffer_load_dwordx4 v1, s[4:7], s85 offen offset:2048 sc1 lds
    buffer_load_dwordx4 v1, s[4:7], s85 offen offset:3072 sc1 lds
    s_add_u32 m0, s83, 90112
    s_add_u32 s85, s82, 528384
    buffer_load_dwordx4 v1, s[4:7], s85 offen offset:0 sc1 lds
    buffer_load_dwordx4 v1, s[4:7], s85 offen offset:1024 sc1 lds
    s_waitcnt vmcnt(40)
    v_mfma_f32_16x16x32_bf16 v[32:35], v[88:91], v[56:59], 0
    v_mfma_f32_16x16x32_bf16 v[40:43], v[120:123], v[56:59], 0
    v_mfma_f32_16x16x32_bf16 v[32:35], v[92:95], v[60:63], v[32:35]
    v_mfma_f32_16x16x32_bf16 v[40:43], v[124:127], v[60:63], v[40:43]
    v_mfma_f32_16x16x32_bf16 v[32:35], v[96:99], v[64:67], v[32:35]
    v_mfma_f32_16x16x32_bf16 v[40:43], v[128:131], v[64:67], v[40:43]
    v_mfma_f32_16x16x32_bf16 v[32:35], v[100:103], v[68:71], v[32:35]
    v_mfma_f32_16x16x32_bf16 v[40:43], v[132:135], v[68:71], v[40:43]
    v_mfma_f32_16x16x32_bf16 v[44:47], v[88:91], v[72:75], 0
    v_mfma_f32_16x16x32_bf16 v[48:51], v[104:107], v[72:75], 0
    v_mfma_f32_16x16x32_bf16 v[52:55], v[120:123], v[72:75], 0
    v_mfma_f32_16x16x32_bf16 v[44:47], v[92:95], v[76:79], v[44:47]
    v_mfma_f32_16x16x32_bf16 v[48:51], v[108:111], v[76:79], v[48:51]
    v_mfma_f32_16x16x32_bf16 v[52:55], v[124:127], v[76:79], v[52:55]
    v_mfma_f32_16x16x32_bf16 v[44:47], v[96:99], v[80:83], v[44:47]
    v_mfma_f32_16x16x32_bf16 v[48:51], v[112:115], v[80:83], v[48:51]
    v_mfma_f32_16x16x32_bf16 v[52:55], v[128:131], v[80:83], v[52:55]
    v_mfma_f32_16x16x32_bf16 v[44:47], v[100:103], v[84:87], v[44:47]
    v_mfma_f32_16x16x32_bf16 v[48:51], v[116:119], v[84:87], v[48:51]
    v_mfma_f32_16x16x32_bf16 v[52:55], v[132:135], v[84:87], v[52:55]
    v_cndmask_b32 v32, v32, v22, s[72:73]
    v_cndmask_b32 v33, v33, v22, s[74:75]
    v_cndmask_b32 v34, v34, v22, s[76:77]
    v_cndmask_b32 v35, v35, v22, s[78:79]
    v_max3_f32 v20, v32, v33, v34
    v_max3_f32 v21, v35, v40, v41
    v_max_f32 v20, v20, v21
    v_mov_b32 v21, v20
    s_nop 1
    v_permlane16_swap_b32 v21, v20
    v_max_f32 v20, v20, v21
    v_mov_b32 v21, v20
    s_nop 1
    v_permlane32_swap_b32 v21, v20
    v_max_f32 v20, v20, v21
    v_mul_f32 v20, s80, v20
    v_fma_f32 v32, v32, s80, -v20
    v_fma_f32 v33, v33, s80, -v20
    v_fma_f32 v34, v34, s80, -v20
    v_fma_f32 v35, v35, s80, -v20
    v_fma_f32 v40, v40, s80, -v20
    v_fma_f32 v41, v41, s80, -v20
    v_exp_f32 v32, v32
    v_exp_f32 v33, v33
    v_exp_f32 v34, v34
    v_exp_f32 v35, v35
    v_exp_f32 v40, v40
    v_exp_f32 v41, v41
    s_nop 0
    v_cvt_pk_bf16_f32 v32, v32, v33
    v_cvt_pk_bf16_f32 v33, v34, v35
    v_mov_b32 v34, 0
    v_mov_b32 v35, 0
    v_cvt_pk_bf16_f32 v40, v40, v41
    v_mov_b32 v41, 0
    v_mov_b32 v42, 0
    v_mov_b32 v43, 0
    s_nop 1
    s_waitcnt vmcnt(30)
    ds_read_b64_tr_b16 v[56:57], v25 offset:0
    ds_read_b64_tr_b16 v[58:59], v25 offset:4096
    ds_read_b64_tr_b16 v[120:121], v26 offset:8192
    ds_read_b64_tr_b16 v[60:61], v25 offset:8
    ds_read_b64_tr_b16 v[62:63], v25 offset:4104
    ds_read_b64_tr_b16 v[122:123], v26 offset:8200
    ds_read_b64_tr_b16 v[64:65], v25 offset:1024
    ds_read_b64_tr_b16 v[66:67], v25 offset:5120
    ds_read_b64_tr_b16 v[124:125], v26 offset:8704
    ds_read_b64_tr_b16 v[68:69], v25 offset:1032
    ds_read_b64_tr_b16 v[70:71], v25 offset:5128
    ds_read_b64_tr_b16 v[126:127], v26 offset:8712
    ds_read_b64_tr_b16 v[72:73], v25 offset:2048
    ds_read_b64_tr_b16 v[74:75], v25 offset:6144
    ds_read_b64_tr_b16 v[128:129], v26 offset:9216
    ds_read_b64_tr_b16 v[76:77], v25 offset:2056
    ds_read_b64_tr_b16 v[78:79], v25 offset:6152
    ds_read_b64_tr_b16 v[130:131], v26 offset:9224
    ds_read_b64_tr_b16 v[80:81], v25 offset:3072
    ds_read_b64_tr_b16 v[82:83], v25 offset:7168
    ds_read_b64_tr_b16 v[132:133], v26 offset:9728
    ds_read_b64_tr_b16 v[84:85], v25 offset:3080
    ds_read_b64_tr_b16 v[86:87], v25 offset:7176
    ds_read_b64_tr_b16 v[134:135], v26 offset:9736
    v_cndmask_b32 v48, v48, v22, s[72:73]
    v_cndmask_b32 v49, v49, v22, s[74:75]
    v_cndmask_b32 v50, v50, v22, s[76:77]
    v_cndmask_b32 v51, v51, v22, s[78:79]
    v_max3_f32 v20, v44, v45, v46
    v_max3_f32 v21, v47, v48, v49
    v_max3_f32 v20, v20, v50, v51
    v_max3_f32 v21, v21, v52, v53
    v_max_f32 v20, v20, v21
    v_mov_b32 v21, v20
    s_nop 1
    v_permlane16_swap_b32 v21, v20
    v_max_f32 v20, v20, v21
    v_mov_b32 v21, v20
    s_nop 1
    v_permlane32_swap_b32 v21, v20
    v_max_f32 v20, v20, v21
    v_mul_f32 v20, s80, v20
    v_fma_f32 v44, v44, s80, -v20
    v_fma_f32 v45, v45, s80, -v20
    v_fma_f32 v46, v46, s80, -v20
    v_fma_f32 v47, v47, s80, -v20
    v_fma_f32 v48, v48, s80, -v20
    v_fma_f32 v49, v49, s80, -v20
    v_fma_f32 v50, v50, s80, -v20
    v_fma_f32 v51, v51, s80, -v20
    v_fma_f32 v52, v52, s80, -v20
    v_fma_f32 v53, v53, s80, -v20
    v_exp_f32 v44, v44
    v_exp_f32 v45, v45
    v_exp_f32 v46, v46
    v_exp_f32 v47, v47
    v_exp_f32 v48, v48
    v_exp_f32 v49, v49
    v_exp_f32 v50, v50
    v_exp_f32 v51, v51
    v_exp_f32 v52, v52
    v_exp_f32 v53, v53
    s_nop 0
    v_cvt_pk_bf16_f32 v44, v44, v45
    v_cvt_pk_bf16_f32 v45, v46, v47
    v_cvt_pk_bf16_f32 v46, v48, v49
    v_cvt_pk_bf16_f32 v47, v50, v51
    v_cvt_pk_bf16_f32 v52, v52, v53
    v_mov_b32 v53, 0
    v_mov_b32 v54, 0
    v_mov_b32 v55, 0
    s_nop 1
    s_waitcnt lgkmcnt(0)
    v_mfma_f32_16x16x32_bf16 v[36:39], v[28:31], v[32:35], 0
    v_mfma_f32_16x16x32_bf16 v[36:39], v[28:31], v[40:43], v[36:39]
    v_mfma_f32_16x16x32_bf16 v[88:91], v[56:59], v[32:35], 0
    v_mfma_f32_16x16x32_bf16 v[88:91], v[120:123], v[40:43], v[88:91]
    v_mfma_f32_16x16x32_bf16 v[92:95], v[60:63], v[32:35], 0
    v_mfma_f32_16x16x32_bf16 v[92:95], v[122:125], v[40:43], v[92:95]
    v_mfma_f32_16x16x32_bf16 v[96:99], v[64:67], v[32:35], 0
    v_mfma_f32_16x16x32_bf16 v[96:99], v[124:127], v[40:43], v[96:99]
    v_mfma_f32_16x16x32_bf16 v[100:103], v[68:71], v[32:35], 0
    v_mfma_f32_16x16x32_bf16 v[100:103], v[126:129], v[40:43], v[100:103]
    v_mfma_f32_16x16x32_bf16 v[104:107], v[72:75], v[32:35], 0
    v_mfma_f32_16x16x32_bf16 v[104:107], v[128:131], v[40:43], v[104:107]
    v_mfma_f32_16x16x32_bf16 v[108:111], v[76:79], v[32:35], 0
    v_mfma_f32_16x16x32_bf16 v[108:111], v[130:133], v[40:43], v[108:111]
    v_mfma_f32_16x16x32_bf16 v[112:115], v[80:83], v[32:35], 0
    v_mfma_f32_16x16x32_bf16 v[112:115], v[132:135], v[40:43], v[112:115]
    v_mfma_f32_16x16x32_bf16 v[116:119], v[84:87], v[32:35], 0
    v_mfma_f32_16x16x32_bf16 v[116:119], v[134:137], v[40:43], v[116:119]
    v_rcp_f32 v23, v36
    s_add_u32 s85, s81, 176160768
    v_mul_f32 v88, v88, v23
    v_mul_f32 v89, v89, v23
    v_mul_f32 v90, v90, v23
    v_mul_f32 v91, v91, v23
    v_mul_f32 v92, v92, v23
    v_mul_f32 v93, v93, v23
    v_mul_f32 v94, v94, v23
    v_mul_f32 v95, v95, v23
    v_cvt_pk_bf16_f32 v224, v88, v89
    v_cvt_pk_bf16_f32 v225, v90, v91
    v_cvt_pk_bf16_f32 v226, v92, v93
    v_cvt_pk_bf16_f32 v227, v94, v95
    buffer_store_dwordx4 v[224:227], v1, s[4:7], s85 offen offset:0 sc1
    v_mul_f32 v96, v96, v23
    v_mul_f32 v97, v97, v23
    v_mul_f32 v98, v98, v23
    v_mul_f32 v99, v99, v23
    v_mul_f32 v100, v100, v23
    v_mul_f32 v101, v101, v23
    v_mul_f32 v102, v102, v23
    v_mul_f32 v103, v103, v23
    v_cvt_pk_bf16_f32 v228, v96, v97
    v_cvt_pk_bf16_f32 v229, v98, v99
    v_cvt_pk_bf16_f32 v230, v100, v101
    v_cvt_pk_bf16_f32 v231, v102, v103
    buffer_store_dwordx4 v[228:231], v1, s[4:7], s85 offen offset:1024 sc1
    v_mul_f32 v104, v104, v23
    v_mul_f32 v105, v105, v23
    v_mul_f32 v106, v106, v23
    v_mul_f32 v107, v107, v23
    v_mul_f32 v108, v108, v23
    v_mul_f32 v109, v109, v23
    v_mul_f32 v110, v110, v23
    v_mul_f32 v111, v111, v23
    v_cvt_pk_bf16_f32 v232, v104, v105
    v_cvt_pk_bf16_f32 v233, v106, v107
    v_cvt_pk_bf16_f32 v234, v108, v109
    v_cvt_pk_bf16_f32 v235, v110, v111
    buffer_store_dwordx4 v[232:235], v1, s[4:7], s85 offen offset:2048 sc1
    v_mul_f32 v112, v112, v23
    v_mul_f32 v113, v113, v23
    v_mul_f32 v114, v114, v23
    v_mul_f32 v115, v115, v23
    v_mul_f32 v116, v116, v23
    v_mul_f32 v117, v117, v23
    v_mul_f32 v118, v118, v23
    v_mul_f32 v119, v119, v23
    v_cvt_pk_bf16_f32 v236, v112, v113
    v_cvt_pk_bf16_f32 v237, v114, v115
    v_cvt_pk_bf16_f32 v238, v116, v117
    v_cvt_pk_bf16_f32 v239, v118, v119
    buffer_store_dwordx4 v[236:239], v1, s[4:7], s85 offen offset:3072 sc1
    v_mfma_f32_16x16x32_bf16 v[48:51], v[28:31], v[44:47], 0
    v_mfma_f32_16x16x32_bf16 v[48:51], v[28:31], v[52:55], v[48:51]
    v_mfma_f32_16x16x32_bf16 v[88:91], v[56:59], v[44:47], 0
    v_mfma_f32_16x16x32_bf16 v[88:91], v[120:123], v[52:55], v[88:91]
    v_mfma_f32_16x16x32_bf16 v[92:95], v[60:63], v[44:47], 0
    v_mfma_f32_16x16x32_bf16 v[92:95], v[122:125], v[52:55], v[92:95]
    v_mfma_f32_16x16x32_bf16 v[96:99], v[64:67], v[44:47], 0
    v_mfma_f32_16x16x32_bf16 v[96:99], v[124:127], v[52:55], v[96:99]
    v_mfma_f32_16x16x32_bf16 v[100:103], v[68:71], v[44:47], 0
    v_mfma_f32_16x16x32_bf16 v[100:103], v[126:129], v[52:55], v[100:103]
    v_mfma_f32_16x16x32_bf16 v[104:107], v[72:75], v[44:47], 0
    v_mfma_f32_16x16x32_bf16 v[104:107], v[128:131], v[52:55], v[104:107]
    v_mfma_f32_16x16x32_bf16 v[108:111], v[76:79], v[44:47], 0
    v_mfma_f32_16x16x32_bf16 v[108:111], v[130:133], v[52:55], v[108:111]
    v_mfma_f32_16x16x32_bf16 v[112:115], v[80:83], v[44:47], 0
    v_mfma_f32_16x16x32_bf16 v[112:115], v[132:135], v[52:55], v[112:115]
    v_mfma_f32_16x16x32_bf16 v[116:119], v[84:87], v[44:47], 0
    v_mfma_f32_16x16x32_bf16 v[116:119], v[134:137], v[52:55], v[116:119]
    v_rcp_f32 v23, v48
    s_add_u32 s85, s81, 176291840
    v_mul_f32 v88, v88, v23
    v_mul_f32 v89, v89, v23
    v_mul_f32 v90, v90, v23
    v_mul_f32 v91, v91, v23
    v_mul_f32 v92, v92, v23
    v_mul_f32 v93, v93, v23
    v_mul_f32 v94, v94, v23
    v_mul_f32 v95, v95, v23
    v_cvt_pk_bf16_f32 v224, v88, v89
    v_cvt_pk_bf16_f32 v225, v90, v91
    v_cvt_pk_bf16_f32 v226, v92, v93
    v_cvt_pk_bf16_f32 v227, v94, v95
    buffer_store_dwordx4 v[224:227], v1, s[4:7], s85 offen offset:0 sc1
    v_mul_f32 v96, v96, v23
    v_mul_f32 v97, v97, v23
    v_mul_f32 v98, v98, v23
    v_mul_f32 v99, v99, v23
    v_mul_f32 v100, v100, v23
    v_mul_f32 v101, v101, v23
    v_mul_f32 v102, v102, v23
    v_mul_f32 v103, v103, v23
    v_cvt_pk_bf16_f32 v228, v96, v97
    v_cvt_pk_bf16_f32 v229, v98, v99
    v_cvt_pk_bf16_f32 v230, v100, v101
    v_cvt_pk_bf16_f32 v231, v102, v103
    buffer_store_dwordx4 v[228:231], v1, s[4:7], s85 offen offset:1024 sc1
    v_mul_f32 v104, v104, v23
    v_mul_f32 v105, v105, v23
    v_mul_f32 v106, v106, v23
    v_mul_f32 v107, v107, v23
    v_mul_f32 v108, v108, v23
    v_mul_f32 v109, v109, v23
    v_mul_f32 v110, v110, v23
    v_mul_f32 v111, v111, v23
    v_cvt_pk_bf16_f32 v232, v104, v105
    v_cvt_pk_bf16_f32 v233, v106, v107
    v_cvt_pk_bf16_f32 v234, v108, v109
    v_cvt_pk_bf16_f32 v235, v110, v111
    buffer_store_dwordx4 v[232:235], v1, s[4:7], s85 offen offset:2048 sc1
    v_mul_f32 v112, v112, v23
    v_mul_f32 v113, v113, v23
    v_mul_f32 v114, v114, v23
    v_mul_f32 v115, v115, v23
    v_mul_f32 v116, v116, v23
    v_mul_f32 v117, v117, v23
    v_mul_f32 v118, v118, v23
    v_mul_f32 v119, v119, v23
    v_cvt_pk_bf16_f32 v236, v112, v113
    v_cvt_pk_bf16_f32 v237, v114, v115
    v_cvt_pk_bf16_f32 v238, v116, v117
    v_cvt_pk_bf16_f32 v239, v118, v119
    buffer_store_dwordx4 v[236:239], v1, s[4:7], s85 offen offset:3072 sc1
    s_waitcnt vmcnt(18)
    v_mfma_f32_16x16x32_bf16 v[32:35], v[172:175], v[140:143], 0
    v_mfma_f32_16x16x32_bf16 v[40:43], v[204:207], v[140:143], 0
    v_mfma_f32_16x16x32_bf16 v[32:35], v[176:179], v[144:147], v[32:35]
    v_mfma_f32_16x16x32_bf16 v[40:43], v[208:211], v[144:147], v[40:43]
    v_mfma_f32_16x16x32_bf16 v[32:35], v[180:183], v[148:151], v[32:35]
    v_mfma_f32_16x16x32_bf16 v[40:43], v[212:215], v[148:151], v[40:43]
    v_mfma_f32_16x16x32_bf16 v[32:35], v[184:187], v[152:155], v[32:35]
    v_mfma_f32_16x16x32_bf16 v[40:43], v[216:219], v[152:155], v[40:43]
    v_mfma_f32_16x16x32_bf16 v[44:47], v[172:175], v[156:159], 0
    v_mfma_f32_16x16x32_bf16 v[48:51], v[188:191], v[156:159], 0
    v_mfma_f32_16x16x32_bf16 v[52:55], v[204:207], v[156:159], 0
    v_mfma_f32_16x16x32_bf16 v[44:47], v[176:179], v[160:163], v[44:47]
    v_mfma_f32_16x16x32_bf16 v[48:51], v[192:195], v[160:163], v[48:51]
    v_mfma_f32_16x16x32_bf16 v[52:55], v[208:211], v[160:163], v[52:55]
    v_mfma_f32_16x16x32_bf16 v[44:47], v[180:183], v[164:167], v[44:47]
    v_mfma_f32_16x16x32_bf16 v[48:51], v[196:199], v[164:167], v[48:51]
    v_mfma_f32_16x16x32_bf16 v[52:55], v[212:215], v[164:167], v[52:55]
    v_mfma_f32_16x16x32_bf16 v[44:47], v[184:187], v[168:171], v[44:47]
    v_mfma_f32_16x16x32_bf16 v[48:51], v[200:203], v[168:171], v[48:51]
    v_mfma_f32_16x16x32_bf16 v[52:55], v[216:219], v[168:171], v[52:55]
    v_cndmask_b32 v32, v32, v22, s[72:73]
    v_cndmask_b32 v33, v33, v22, s[74:75]
    v_cndmask_b32 v34, v34, v22, s[76:77]
    v_cndmask_b32 v35, v35, v22, s[78:79]
    v_max3_f32 v20, v32, v33, v34
    v_max3_f32 v21, v35, v40, v41
    v_max_f32 v20, v20, v21
    v_mov_b32 v21, v20
    s_nop 1
    v_permlane16_swap_b32 v21, v20
    v_max_f32 v20, v20, v21
    v_mov_b32 v21, v20
    s_nop 1
    v_permlane32_swap_b32 v21, v20
    v_max_f32 v20, v20, v21
    v_mul_f32 v20, s80, v20
    v_fma_f32 v32, v32, s80, -v20
    v_fma_f32 v33, v33, s80, -v20
    v_fma_f32 v34, v34, s80, -v20
    v_fma_f32 v35, v35, s80, -v20
    v_fma_f32 v40, v40, s80, -v20
    v_fma_f32 v41, v41, s80, -v20
    v_exp_f32 v32, v32
    v_exp_f32 v33, v33
    v_exp_f32 v34, v34
    v_exp_f32 v35, v35
    v_exp_f32 v40, v40
    v_exp_f32 v41, v41
    s_nop 0
    v_cvt_pk_bf16_f32 v32, v32, v33
    v_cvt_pk_bf16_f32 v33, v34, v35
    v_mov_b32 v34, 0
    v_mov_b32 v35, 0
    v_cvt_pk_bf16_f32 v40, v40, v41
    v_mov_b32 v41, 0
    v_mov_b32 v42, 0
    v_mov_b32 v43, 0
    s_nop 1
    s_waitcnt vmcnt(8)
    v_add_u32 v25, 81920, v25
    v_add_u32 v26, 81920, v26
    ds_read_b64_tr_b16 v[140:141], v25 offset:0
    ds_read_b64_tr_b16 v[142:143], v25 offset:4096
    ds_read_b64_tr_b16 v[204:205], v26 offset:8192
    ds_read_b64_tr_b16 v[144:145], v25 offset:8
    ds_read_b64_tr_b16 v[146:147], v25 offset:4104
    ds_read_b64_tr_b16 v[206:207], v26 offset:8200
    ds_read_b64_tr_b16 v[148:149], v25 offset:1024
    ds_read_b64_tr_b16 v[150:151], v25 offset:5120
    ds_read_b64_tr_b16 v[208:209], v26 offset:8704
    ds_read_b64_tr_b16 v[152:153], v25 offset:1032
    ds_read_b64_tr_b16 v[154:155], v25 offset:5128
    ds_read_b64_tr_b16 v[210:211], v26 offset:8712
    ds_read_b64_tr_b16 v[156:157], v25 offset:2048
    ds_read_b64_tr_b16 v[158:159], v25 offset:6144
    ds_read_b64_tr_b16 v[212:213], v26 offset:9216
    ds_read_b64_tr_b16 v[160:161], v25 offset:2056
    ds_read_b64_tr_b16 v[162:163], v25 offset:6152
    ds_read_b64_tr_b16 v[214:215], v26 offset:9224
    ds_read_b64_tr_b16 v[164:165], v25 offset:3072
    ds_read_b64_tr_b16 v[166:167], v25 offset:7168
    ds_read_b64_tr_b16 v[216:217], v26 offset:9728
    ds_read_b64_tr_b16 v[168:169], v25 offset:3080
    ds_read_b64_tr_b16 v[170:171], v25 offset:7176
    ds_read_b64_tr_b16 v[218:219], v26 offset:9736
    v_cndmask_b32 v48, v48, v22, s[72:73]
    v_cndmask_b32 v49, v49, v22, s[74:75]
    v_cndmask_b32 v50, v50, v22, s[76:77]
    v_cndmask_b32 v51, v51, v22, s[78:79]
    v_max3_f32 v20, v44, v45, v46
    v_max3_f32 v21, v47, v48, v49
    v_max3_f32 v20, v20, v50, v51
    v_max3_f32 v21, v21, v52, v53
    v_max_f32 v20, v20, v21
    v_mov_b32 v21, v20
    s_nop 1
    v_permlane16_swap_b32 v21, v20
    v_max_f32 v20, v20, v21
    v_mov_b32 v21, v20
    s_nop 1
    v_permlane32_swap_b32 v21, v20
    v_max_f32 v20, v20, v21
    v_mul_f32 v20, s80, v20
    v_fma_f32 v44, v44, s80, -v20
    v_fma_f32 v45, v45, s80, -v20
    v_fma_f32 v46, v46, s80, -v20
    v_fma_f32 v47, v47, s80, -v20
    v_fma_f32 v48, v48, s80, -v20
    v_fma_f32 v49, v49, s80, -v20
    v_fma_f32 v50, v50, s80, -v20
    v_fma_f32 v51, v51, s80, -v20
    v_fma_f32 v52, v52, s80, -v20
    v_fma_f32 v53, v53, s80, -v20
    v_exp_f32 v44, v44
    v_exp_f32 v45, v45
    v_exp_f32 v46, v46
    v_exp_f32 v47, v47
    v_exp_f32 v48, v48
    v_exp_f32 v49, v49
    v_exp_f32 v50, v50
    v_exp_f32 v51, v51
    v_exp_f32 v52, v52
    v_exp_f32 v53, v53
    s_nop 0
    v_cvt_pk_bf16_f32 v44, v44, v45
    v_cvt_pk_bf16_f32 v45, v46, v47
    v_cvt_pk_bf16_f32 v46, v48, v49
    v_cvt_pk_bf16_f32 v47, v50, v51
    v_cvt_pk_bf16_f32 v52, v52, v53
    v_mov_b32 v53, 0
    v_mov_b32 v54, 0
    v_mov_b32 v55, 0
    s_nop 1
    s_waitcnt lgkmcnt(0)
    v_mfma_f32_16x16x32_bf16 v[36:39], v[28:31], v[32:35], 0
    v_mfma_f32_16x16x32_bf16 v[36:39], v[28:31], v[40:43], v[36:39]
    v_mfma_f32_16x16x32_bf16 v[172:175], v[140:143], v[32:35], 0
    v_mfma_f32_16x16x32_bf16 v[172:175], v[204:207], v[40:43], v[172:175]
    v_mfma_f32_16x16x32_bf16 v[176:179], v[144:147], v[32:35], 0
    v_mfma_f32_16x16x32_bf16 v[176:179], v[206:209], v[40:43], v[176:179]
    v_mfma_f32_16x16x32_bf16 v[180:183], v[148:151], v[32:35], 0
    v_mfma_f32_16x16x32_bf16 v[180:183], v[208:211], v[40:43], v[180:183]
    v_mfma_f32_16x16x32_bf16 v[184:187], v[152:155], v[32:35], 0
    v_mfma_f32_16x16x32_bf16 v[184:187], v[210:213], v[40:43], v[184:187]
    v_mfma_f32_16x16x32_bf16 v[188:191], v[156:159], v[32:35], 0
    v_mfma_f32_16x16x32_bf16 v[188:191], v[212:215], v[40:43], v[188:191]
    v_mfma_f32_16x16x32_bf16 v[192:195], v[160:163], v[32:35], 0
    v_mfma_f32_16x16x32_bf16 v[192:195], v[214:217], v[40:43], v[192:195]
    v_mfma_f32_16x16x32_bf16 v[196:199], v[164:167], v[32:35], 0
    v_mfma_f32_16x16x32_bf16 v[196:199], v[216:219], v[40:43], v[196:199]
    v_mfma_f32_16x16x32_bf16 v[200:203], v[168:171], v[32:35], 0
    v_mfma_f32_16x16x32_bf16 v[200:203], v[218:221], v[40:43], v[200:203]
    v_rcp_f32 v23, v36
    s_add_u32 s85, s81, 176685056
    v_mul_f32 v172, v172, v23
    v_mul_f32 v173, v173, v23
    v_mul_f32 v174, v174, v23
    v_mul_f32 v175, v175, v23
    v_mul_f32 v176, v176, v23
    v_mul_f32 v177, v177, v23
    v_mul_f32 v178, v178, v23
    v_mul_f32 v179, v179, v23
    v_cvt_pk_bf16_f32 v224, v172, v173
    v_cvt_pk_bf16_f32 v225, v174, v175
    v_cvt_pk_bf16_f32 v226, v176, v177
    v_cvt_pk_bf16_f32 v227, v178, v179
    buffer_store_dwordx4 v[224:227], v1, s[4:7], s85 offen offset:0 sc1
    v_mul_f32 v180, v180, v23
    v_mul_f32 v181, v181, v23
    v_mul_f32 v182, v182, v23
    v_mul_f32 v183, v183, v23
    v_mul_f32 v184, v184, v23
    v_mul_f32 v185, v185, v23
    v_mul_f32 v186, v186, v23
    v_mul_f32 v187, v187, v23
    v_cvt_pk_bf16_f32 v228, v180, v181
    v_cvt_pk_bf16_f32 v229, v182, v183
    v_cvt_pk_bf16_f32 v230, v184, v185
    v_cvt_pk_bf16_f32 v231, v186, v187
    buffer_store_dwordx4 v[228:231], v1, s[4:7], s85 offen offset:1024 sc1
    v_mul_f32 v188, v188, v23
    v_mul_f32 v189, v189, v23
    v_mul_f32 v190, v190, v23
    v_mul_f32 v191, v191, v23
    v_mul_f32 v192, v192, v23
    v_mul_f32 v193, v193, v23
    v_mul_f32 v194, v194, v23
    v_mul_f32 v195, v195, v23
    v_cvt_pk_bf16_f32 v232, v188, v189
    v_cvt_pk_bf16_f32 v233, v190, v191
    v_cvt_pk_bf16_f32 v234, v192, v193
    v_cvt_pk_bf16_f32 v235, v194, v195
    buffer_store_dwordx4 v[232:235], v1, s[4:7], s85 offen offset:2048 sc1
    v_mul_f32 v196, v196, v23
    v_mul_f32 v197, v197, v23
    v_mul_f32 v198, v198, v23
    v_mul_f32 v199, v199, v23
    v_mul_f32 v200, v200, v23
    v_mul_f32 v201, v201, v23
    v_mul_f32 v202, v202, v23
    v_mul_f32 v203, v203, v23
    v_cvt_pk_bf16_f32 v236, v196, v197
    v_cvt_pk_bf16_f32 v237, v198, v199
    v_cvt_pk_bf16_f32 v238, v200, v201
    v_cvt_pk_bf16_f32 v239, v202, v203
    buffer_store_dwordx4 v[236:239], v1, s[4:7], s85 offen offset:3072 sc1
    v_mfma_f32_16x16x32_bf16 v[48:51], v[28:31], v[44:47], 0
    v_mfma_f32_16x16x32_bf16 v[48:51], v[28:31], v[52:55], v[48:51]
    v_mfma_f32_16x16x32_bf16 v[172:175], v[140:143], v[44:47], 0
    v_mfma_f32_16x16x32_bf16 v[172:175], v[204:207], v[52:55], v[172:175]
    v_mfma_f32_16x16x32_bf16 v[176:179], v[144:147], v[44:47], 0
    v_mfma_f32_16x16x32_bf16 v[176:179], v[206:209], v[52:55], v[176:179]
    v_mfma_f32_16x16x32_bf16 v[180:183], v[148:151], v[44:47], 0
    v_mfma_f32_16x16x32_bf16 v[180:183], v[208:211], v[52:55], v[180:183]
    v_mfma_f32_16x16x32_bf16 v[184:187], v[152:155], v[44:47], 0
    v_mfma_f32_16x16x32_bf16 v[184:187], v[210:213], v[52:55], v[184:187]
    v_mfma_f32_16x16x32_bf16 v[188:191], v[156:159], v[44:47], 0
    v_mfma_f32_16x16x32_bf16 v[188:191], v[212:215], v[52:55], v[188:191]
    v_mfma_f32_16x16x32_bf16 v[192:195], v[160:163], v[44:47], 0
    v_mfma_f32_16x16x32_bf16 v[192:195], v[214:217], v[52:55], v[192:195]
    v_mfma_f32_16x16x32_bf16 v[196:199], v[164:167], v[44:47], 0
    v_mfma_f32_16x16x32_bf16 v[196:199], v[216:219], v[52:55], v[196:199]
    v_mfma_f32_16x16x32_bf16 v[200:203], v[168:171], v[44:47], 0
    v_mfma_f32_16x16x32_bf16 v[200:203], v[218:221], v[52:55], v[200:203]
    v_rcp_f32 v23, v48
    s_add_u32 s85, s81, 176816128
    v_mul_f32 v172, v172, v23
    v_mul_f32 v173, v173, v23
    v_mul_f32 v174, v174, v23
    v_mul_f32 v175, v175, v23
    v_mul_f32 v176, v176, v23
    v_mul_f32 v177, v177, v23
    v_mul_f32 v178, v178, v23
    v_mul_f32 v179, v179, v23
    v_cvt_pk_bf16_f32 v224, v172, v173
    v_cvt_pk_bf16_f32 v225, v174, v175
    v_cvt_pk_bf16_f32 v226, v176, v177
    v_cvt_pk_bf16_f32 v227, v178, v179
    buffer_store_dwordx4 v[224:227], v1, s[4:7], s85 offen offset:0 sc1
    v_mul_f32 v180, v180, v23
    v_mul_f32 v181, v181, v23
    v_mul_f32 v182, v182, v23
    v_mul_f32 v183, v183, v23
    v_mul_f32 v184, v184, v23
    v_mul_f32 v185, v185, v23
    v_mul_f32 v186, v186, v23
    v_mul_f32 v187, v187, v23
    v_cvt_pk_bf16_f32 v228, v180, v181
    v_cvt_pk_bf16_f32 v229, v182, v183
    v_cvt_pk_bf16_f32 v230, v184, v185
    v_cvt_pk_bf16_f32 v231, v186, v187
    buffer_store_dwordx4 v[228:231], v1, s[4:7], s85 offen offset:1024 sc1
    v_mul_f32 v188, v188, v23
    v_mul_f32 v189, v189, v23
    v_mul_f32 v190, v190, v23
    v_mul_f32 v191, v191, v23
    v_mul_f32 v192, v192, v23
    v_mul_f32 v193, v193, v23
    v_mul_f32 v194, v194, v23
    v_mul_f32 v195, v195, v23
    v_cvt_pk_bf16_f32 v232, v188, v189
    v_cvt_pk_bf16_f32 v233, v190, v191
    v_cvt_pk_bf16_f32 v234, v192, v193
    v_cvt_pk_bf16_f32 v235, v194, v195
    buffer_store_dwordx4 v[232:235], v1, s[4:7], s85 offen offset:2048 sc1
    v_mul_f32 v196, v196, v23
    v_mul_f32 v197, v197, v23
    v_mul_f32 v198, v198, v23
    v_mul_f32 v199, v199, v23
    v_mul_f32 v200, v200, v23
    v_mul_f32 v201, v201, v23
    v_mul_f32 v202, v202, v23
    v_mul_f32 v203, v203, v23
    v_cvt_pk_bf16_f32 v236, v196, v197
    v_cvt_pk_bf16_f32 v237, v198, v199
    v_cvt_pk_bf16_f32 v238, v200, v201
    v_cvt_pk_bf16_f32 v239, v202, v203
    buffer_store_dwordx4 v[236:239], v1, s[4:7], s85 offen offset:3072 sc1
    s_mov_b32 s28, s46
    s_waitcnt vmcnt(0)
    s_barrier
    s_cmp_eq_u32 s28, 0
    s_cbranch_scc1 sig_14
    s_cmp_lg_u32 s3, 0
    s_cbranch_scc1 sig_14
    s_and_b32 s57, s28, 3
    v_mov_b32 v24, s57
    s_bfe_u32 s57, s28, 0x20002
    v_mov_b32 v25, s57
    s_andn2_b32 s28, s28, 15
    s_mov_b64 exec, 1
    buffer_atomic_add_x2 v[24:25], v17, s[4:7], s28 offen sc1
    s_mov_b64 exec, -1
sig_14:
    s_mov_b32 s28, 0
    s_cmp_lg_u32 s3, 0
    s_cbranch_scc1 pub_15
    v_mov_b32 v20, 131136
    s_mov_b64 exec, 1
    ds_write_b32 v20, v250
    s_mov_b64 exec, -1
    s_waitcnt lgkmcnt(0)
pub_15:
    s_barrier
    v_mov_b32 v20, 131136
    ds_read_b32 v20, v20
    s_waitcnt lgkmcnt(0)
    v_readfirstlane_b32 s59, v20
    s_add_u32 s59, s59, 32
    s_min_u32 s59, s59, 322
    s_lshl_b32 s57, s59, 6
    s_load_dwordx16 s[32:47], s[24:25], s57
    s_waitcnt lgkmcnt(0)
    s_branch w_cold
w_fin:
    s_load_dwordx2 s[8:9], s[0:1], 0
    s_load_dwordx2 s[12:13], s[0:1], 88
    v_mbcnt_lo_u32_b32 v1, -1, 0
    v_mbcnt_hi_u32_b32 v1, -1, v1
    s_mov_b32 s10, 4194304
    s_mov_b32 s11, 131072
    s_mov_b32 s14, 4194304
    s_mov_b32 s15, 131072
    s_mov_b32 s89, 0xbfb8aa3b
    v_lshlrev_b32 v3, 4, v1
    v_and_b32 v4, 15, v1
    v_lshrrev_b32 v5, 4, v1
    v_lshlrev_b32 v4, 11, v4
    v_lshl_add_u32 v4, v5, 4, v4
    v_and_b32 v5, 1, v5
    v_cmp_eq_u32 s[76:77], 1, v5
    v_and_b32 v6, 3, v1
    v_lshlrev_b32 v6, 7, v6
    s_mov_b32 s80, s39
    s_lshl_b32 s81, s36, 2
    s_and_b32 s82, s3, 3
    s_add_u32 s81, s81, s82
    s_lshr_b32 s82, s3, 2
    s_mov_b32 s84, 65536
    s_mov_b32 s85, 218112000
    s_waitcnt lgkmcnt(0)
    s_cmp_eq_u32 s32, 7
    s_cbranch_scc1 fin_tail
fin_job:
    s_lshl_b32 s72, s80, 1
    s_add_u32 s72, s72, s82
    s_lshl_b32 s74, s72, 15
    s_lshl_b32 s73, s81, 11
    s_add_u32 s73, s73, s74
    s_lshl_b32 s75, s81, 7
    s_add_u32 s74, s74, s75
    s_add_u32 s78, s73, 117440512
    s_add_u32 s79, s73, 75497472
    s_lshr_b32 s83, s80, 3
    s_lshl_b32 s83, s83, 6
    s_add_u32 s83, s83, 218106368
    s_add_u32 s87, s80, 2
    buffer_load_dwordx4 v[88:91], v4, s[8:11], s74 offen offset:0
    buffer_load_dwordx4 v[92:95], v4, s[8:11], s74 offen offset:64
    s_cmp_lg_u32 s80, s39
    s_cbranch_scc1 fin_again
    s_cmp_lg_u32 s3, 0
    s_cbranch_scc1 fin_ws_ok
fin_wd:
    buffer_load_dwordx2 v[8:9], off, s[4:7], s83 sc1
    s_waitcnt vmcnt(0)
    v_readfirstlane_b32 s86, v8
    v_readfirstlane_b32 s88, v9
    s_cmp_ge_u32 s88, s37
    s_cselect_b32 s86, s86, 0
    s_cmp_ge_u32 s86, 16
    s_cbranch_scc1 fin_wd2
    s_sleep 64
    s_sub_u32 s84, s84, 1
    s_cbranch_scc0 fin_wd
    s_mov_b32 s84, 0
fin_wd2:
    s_cmp_lg_u32 s37, 0
    s_cbranch_scc1 fin_ws_ok
fin_ws:
    buffer_load_dword v7, v6, s[4:7], s85 offen sc1
    s_waitcnt vmcnt(0)
    v_cmp_gt_u32 vcc, s87, v7
    s_cbranch_vccz fin_ws_ok
    s_sleep 12
    s_sub_u32 s86, s87, 2
    v_cmp_gt_i32 vcc, s86, v7
    s_cbranch_vccz fin_ws_f
    s_sleep 64
    s_sub_u32 s86, s87, 6
    v_cmp_gt_i32 vcc, s86, v7
    s_cbranch_vccz fin_ws_f
    s_sleep 127
    s_sleep 127
fin_ws_f:
    s_sub_u32 s84, s84, 1
    s_cbranch_scc0 fin_ws
    s_mov_b32 s84, 0
fin_ws_ok:
    s_cmp_lg_u32 s3, 0
    s_cbranch_scc1 clm_16
    v_mov_b32 v250, 1
    s_mov_b64 exec, 1
    buffer_atomic_add v250, off, s[64:67], s71 sc0 sc1
    s_mov_b64 exec, -1
clm_16:
    s_barrier
fin_again:
    buffer_load_dwordx4 v[136:139], v3, s[4:7], s78 offen offset:0 sc1
    buffer_load_dwordx4 v[140:143], v3, s[4:7], s78 offen offset:1024 sc1
    s_add_u32 s78, s78, 4194304
    buffer_load_dwordx4 v[144:147], v3, s[4:7], s78 offen offset:0 sc1
    buffer_load_dwordx4 v[148:151], v3, s[4:7], s78 offen offset:1024 sc1
    s_add_u32 s78, s78, 4194304
    s_cmp_lg_u32 s33, 0
    s_cbranch_scc1 fin_g2
    buffer_load_dwordx4 v[152:155], v3, s[4:7], s78 offen offset:0 sc1
    buffer_load_dwordx4 v[156:159], v3, s[4:7], s78 offen offset:1024 sc1
    s_add_u32 s78, s78, 4194304
    buffer_load_dwordx4 v[160:163], v3, s[4:7], s78 offen offset:0 sc1
    buffer_load_dwordx4 v[164:167], v3, s[4:7], s78 offen offset:1024 sc1
    s_add_u32 s78, s78, 4194304
    s_branch fin_g4
fin_g2:
    v_mov_b32 v152, 0
    v_mov_b32 v153, 0
    v_mov_b32 v154, 0
    v_mov_b32 v155, 0
    v_mov_b32 v156, 0
    v_mov_b32 v157, 0
    v_mov_b32 v158, 0
    v_mov_b32 v159, 0
    v_mov_b32 v160, 0
    v_mov_b32 v161, 0
    v_mov_b32 v162, 0
    v_mov_b32 v163, 0
    v_mov_b32 v164, 0
    v_mov_b32 v165, 0
    v_mov_b32 v166, 0
    v_mov_b32 v167, 0
fin_g4:
    buffer_load_dwordx4 v[16:19], v3, s[4:7], s79 offen offset:0 sc1
    buffer_load_dwordx4 v[48:51], v3, s[4:7], s79 offen offset:1024 sc1
    s_add_u32 s79, s79, 4194304
    buffer_load_dwordx4 v[20:23], v3, s[4:7], s79 offen offset:0 sc1
    buffer_load_dwordx4 v[52:55], v3, s[4:7], s79 offen offset:1024 sc1
    s_add_u32 s79, s79, 4194304
    s_cmp_ge_u32 s35, 2
    s_cbranch_scc1 fin_2p
    buffer_load_dwordx4 v[24:27], v3, s[4:7], s79 offen offset:0 sc1
    buffer_load_dwordx4 v[56:59], v3, s[4:7], s79 offen offset:1024 sc1
    s_add_u32 s79, s79, 4194304
    buffer_load_dwordx4 v[28:31], v3, s[4:7], s79 offen offset:0 sc1
    buffer_load_dwordx4 v[60:63], v3, s[4:7], s79 offen offset:1024 sc1
    s_add_u32 s79, s79, 4194304
    s_cmp_ge_u32 s35, 1
    s_cbranch_scc1 fin_4p
    buffer_load_dwordx4 v[32:35], v3, s[4:7], s79 offen offset:0 sc1
    buffer_load_dwordx4 v[64:67], v3, s[4:7], s79 offen offset:1024 sc1
    s_add_u32 s79, s79, 4194304
    buffer_load_dwordx4 v[36:39], v3, s[4:7], s79 offen offset:0 sc1
    buffer_load_dwordx4 v[68:71], v3, s[4:7], s79 offen offset:1024 sc1
    s_add_u32 s79, s79, 4194304
    buffer_load_dwordx4 v[40:43], v3, s[4:7], s79 offen offset:0 sc1
    buffer_load_dwordx4 v[72:75], v3, s[4:7], s79 offen offset:1024 sc1
    s_add_u32 s79, s79, 4194304
    buffer_load_dwordx4 v[44:47], v3, s[4:7], s79 offen offset:0 sc1
    buffer_load_dwordx4 v[76:79], v3, s[4:7], s79 offen offset:1024 sc1
    s_add_u32 s79, s79, 4194304
    s_waitcnt vmcnt(16)
    s_branch fin_8p
fin_2p:
    v_mov_b32 v24, 0
    v_mov_b32 v25, 0
    v_mov_b32 v26, 0
    v_mov_b32 v27, 0
    v_mov_b32 v28, 0
    v_mov_b32 v29, 0
    v_mov_b32 v30, 0
    v_mov_b32 v31, 0
    v_mov_b32 v32, 0
    v_mov_b32 v33, 0
    v_mov_b32 v34, 0
    v_mov_b32 v35, 0
    v_mov_b32 v36, 0
    v_mov_b32 v37, 0
    v_mov_b32 v38, 0
    v_mov_b32 v39, 0
    v_mov_b32 v40, 0
    v_mov_b32 v41, 0
    v_mov_b32 v42, 0
    v_mov_b32 v43, 0
    v_mov_b32 v44, 0
    v_mov_b32 v45, 0
    v_mov_b32 v46, 0
    v_mov_b32 v47, 0
    v_mov_b32 v56, 0
    v_mov_b32 v57, 0
    v_mov_b32 v58, 0
    v_mov_b32 v59, 0
    v_mov_b32 v60, 0
    v_mov_b32 v61, 0
    v_mov_b32 v62, 0
    v_mov_b32 v63, 0
    v_mov_b32 v64, 0
    v_mov_b32 v65, 0
    v_mov_b32 v66, 0
    v_mov_b32 v67, 0
    v_mov_b32 v68, 0
    v_mov_b32 v69, 0
    v_mov_b32 v70, 0
    v_mov_b32 v71, 0
    v_mov_b32 v72, 0
    v_mov_b32 v73, 0
    v_mov_b32 v74, 0
    v_mov_b32 v75, 0
    v_mov_b32 v76, 0
    v_mov_b32 v77, 0
    v_mov_b32 v78, 0
    v_mov_b32 v79, 0
    s_waitcnt vmcnt(4)
    s_branch fin_8p
fin_4p:
    v_mov_b32 v32, 0
    v_mov_b32 v33, 0
    v_mov_b32 v34, 0
    v_mov_b32 v35, 0
    v_mov_b32 v36, 0
    v_mov_b32 v37, 0
    v_mov_b32 v38, 0
    v_mov_b32 v39, 0
    v_mov_b32 v40, 0
    v_mov_b32 v41, 0
    v_mov_b32 v42, 0
    v_mov_b32 v43, 0
    v_mov_b32 v44, 0
    v_mov_b32 v45, 0
    v_mov_b32 v46, 0
    v_mov_b32 v47, 0
    v_mov_b32 v64, 0
    v_mov_b32 v65, 0
    v_mov_b32 v66, 0
    v_mov_b32 v67, 0
    v_mov_b32 v68, 0
    v_mov_b32 v69, 0
    v_mov_b32 v70, 0
    v_mov_b32 v71, 0
    v_mov_b32 v72, 0
    v_mov_b32 v73, 0
    v_mov_b32 v74, 0
    v_mov_b32 v75, 0
    v_mov_b32 v76, 0
    v_mov_b32 v77, 0
    v_mov_b32 v78, 0
    v_mov_b32 v79, 0
    s_waitcnt vmcnt(8)
fin_8p:
    v_lshlrev_b32 v120, 16, v136
    v_and_b32 v121, 0xffff0000, v136
    v_lshlrev_b32 v136, 16, v144
    v_and_b32 v144, 0xffff0000, v144
    v_add_f32 v120, v120, v136
    v_add_f32 v121, v121, v144
    v_lshlrev_b32 v136, 16, v152
    v_and_b32 v152, 0xffff0000, v152
    v_add_f32 v120, v120, v136
    v_add_f32 v121, v121, v152
    v_lshlrev_b32 v136, 16, v160
    v_and_b32 v160, 0xffff0000, v160
    v_add_f32 v120, v120, v136
    v_add_f32 v121, v121, v160
    v_cvt_pk_bf16_f32 v136, v120, v121
    v_lshlrev_b32 v120, 16, v136
    v_and_b32 v121, 0xffff0000, v136
    v_mul_f32 v136, s89, v120
    v_mul_f32 v144, s89, v121
    v_lshlrev_b32 v122, 16, v137
    v_and_b32 v123, 0xffff0000, v137
    v_lshlrev_b32 v137, 16, v145
    v_and_b32 v145, 0xffff0000, v145
    v_add_f32 v122, v122, v137
    v_add_f32 v123, v123, v145
    v_lshlrev_b32 v137, 16, v153
    v_and_b32 v153, 0xffff0000, v153
    v_add_f32 v122, v122, v137
    v_add_f32 v123, v123, v153
    v_lshlrev_b32 v137, 16, v161
    v_and_b32 v161, 0xffff0000, v161
    v_add_f32 v122, v122, v137
    v_add_f32 v123, v123, v161
    v_cvt_pk_bf16_f32 v137, v122, v123
    v_lshlrev_b32 v122, 16, v137
    v_and_b32 v123, 0xffff0000, v137
    v_mul_f32 v137, s89, v122
    v_mul_f32 v145, s89, v123
    v_lshlrev_b32 v124, 16, v138
    v_and_b32 v125, 0xffff0000, v138
    v_lshlrev_b32 v138, 16, v146
    v_and_b32 v146, 0xffff0000, v146
    v_add_f32 v124, v124, v138
    v_add_f32 v125, v125, v146
    v_lshlrev_b32 v138, 16, v154
    v_and_b32 v154, 0xffff0000, v154
    v_add_f32 v124, v124, v138
    v_add_f32 v125, v125, v154
    v_lshlrev_b32 v138, 16, v162
    v_and_b32 v162, 0xffff0000, v162
    v_add_f32 v124, v124, v138
    v_add_f32 v125, v125, v162
    v_cvt_pk_bf16_f32 v138, v124, v125
    v_lshlrev_b32 v124, 16, v138
    v_and_b32 v125, 0xffff0000, v138
    v_mul_f32 v138, s89, v124
    v_mul_f32 v146, s89, v125
    v_lshlrev_b32 v126, 16, v139
    v_and_b32 v127, 0xffff0000, v139
    v_lshlrev_b32 v139, 16, v147
    v_and_b32 v147, 0xffff0000, v147
    v_add_f32 v126, v126, v139
    v_add_f32 v127, v127, v147
    v_lshlrev_b32 v139, 16, v155
    v_and_b32 v155, 0xffff0000, v155
    v_add_f32 v126, v126, v139
    v_add_f32 v127, v127, v155
    v_lshlrev_b32 v139, 16, v163
    v_and_b32 v163, 0xffff0000, v163
    v_add_f32 v126, v126, v139
    v_add_f32 v127, v127, v163
    v_cvt_pk_bf16_f32 v139, v126, v127
    v_lshlrev_b32 v126, 16, v139
    v_and_b32 v127, 0xffff0000, v139
    v_mul_f32 v139, s89, v126
    v_mul_f32 v147, s89, v127
    v_exp_f32 v136, v136
    v_exp_f32 v144, v144
    v_exp_f32 v137, v137
    v_exp_f32 v145, v145
    v_exp_f32 v138, v138
    v_exp_f32 v146, v146
    v_exp_f32 v139, v139
    v_exp_f32 v147, v147
    s_nop 0
    v_add_f32 v136, 1.0, v136
    v_add_f32 v144, 1.0, v144
    v_add_f32 v137, 1.0, v137
    v_add_f32 v145, 1.0, v145
    v_add_f32 v138, 1.0, v138
    v_add_f32 v146, 1.0, v146
    v_add_f32 v139, 1.0, v139
    v_add_f32 v147, 1.0, v147
    v_rcp_f32 v136, v136
    v_rcp_f32 v144, v144
    v_rcp_f32 v137, v137
    v_rcp_f32 v145, v145
    v_rcp_f32 v138, v138
    v_rcp_f32 v146, v146
    v_rcp_f32 v139, v139
    v_rcp_f32 v147, v147
    s_nop 0
    v_mul_f32 v120, v120, v136
    v_mul_f32 v121, v121, v144
    v_cvt_pk_bf16_f32 v136, v120, v121
    v_mul_f32 v122, v122, v137
    v_mul_f32 v123, v123, v145
    v_cvt_pk_bf16_f32 v137, v122, v123
    v_mul_f32 v124, v124, v138
    v_mul_f32 v125, v125, v146
    v_cvt_pk_bf16_f32 v138, v124, v125
    v_mul_f32 v126, v126, v139
    v_mul_f32 v127, v127, v147
    v_cvt_pk_bf16_f32 v139, v126, v127
    v_lshlrev_b32 v120, 16, v140
    v_and_b32 v121, 0xffff0000, v140
    v_lshlrev_b32 v140, 16, v148
    v_and_b32 v148, 0xffff0000, v148
    v_add_f32 v120, v120, v140
    v_add_f32 v121, v121, v148
    v_lshlrev_b32 v140, 16, v156
    v_and_b32 v156, 0xffff0000, v156
    v_add_f32 v120, v120, v140
    v_add_f32 v121, v121, v156
    v_lshlrev_b32 v140, 16, v164
    v_and_b32 v164, 0xffff0000, v164
    v_add_f32 v120, v120, v140
    v_add_f32 v121, v121, v164
    v_cvt_pk_bf16_f32 v140, v120, v121
    v_lshlrev_b32 v120, 16, v140
    v_and_b32 v121, 0xffff0000, v140
    v_mul_f32 v140, s89, v120
    v_mul_f32 v148, s89, v121
    v_lshlrev_b32 v122, 16, v141
    v_and_b32 v123, 0xffff0000, v141
    v_lshlrev_b32 v141, 16, v149
    v_and_b32 v149, 0xffff0000, v149
    v_add_f32 v122, v122, v141
    v_add_f32 v123, v123, v149
    v_lshlrev_b32 v141, 16, v157
    v_and_b32 v157, 0xffff0000, v157
    v_add_f32 v122, v122, v141
    v_add_f32 v123, v123, v157
    v_lshlrev_b32 v141, 16, v165
    v_and_b32 v165, 0xffff0000, v165
    v_add_f32 v122, v122, v141
    v_add_f32 v123, v123, v165
    v_cvt_pk_bf16_f32 v141, v122, v123
    v_lshlrev_b32 v122, 16, v141
    v_and_b32 v123, 0xffff0000, v141
    v_mul_f32 v141, s89, v122
    v_mul_f32 v149, s89, v123
    v_lshlrev_b32 v124, 16, v142
    v_and_b32 v125, 0xffff0000, v142
    v_lshlrev_b32 v142, 16, v150
    v_and_b32 v150, 0xffff0000, v150
    v_add_f32 v124, v124, v142
    v_add_f32 v125, v125, v150
    v_lshlrev_b32 v142, 16, v158
    v_and_b32 v158, 0xffff0000, v158
    v_add_f32 v124, v124, v142
    v_add_f32 v125, v125, v158
    v_lshlrev_b32 v142, 16, v166
    v_and_b32 v166, 0xffff0000, v166
    v_add_f32 v124, v124, v142
    v_add_f32 v125, v125, v166
    v_cvt_pk_bf16_f32 v142, v124, v125
    v_lshlrev_b32 v124, 16, v142
    v_and_b32 v125, 0xffff0000, v142
    v_mul_f32 v142, s89, v124
    v_mul_f32 v150, s89, v125
    v_lshlrev_b32 v126, 16, v143
    v_and_b32 v127, 0xffff0000, v143
    v_lshlrev_b32 v143, 16, v151
    v_and_b32 v151, 0xffff0000, v151
    v_add_f32 v126, v126, v143
    v_add_f32 v127, v127, v151
    v_lshlrev_b32 v143, 16, v159
    v_and_b32 v159, 0xffff0000, v159
    v_add_f32 v126, v126, v143
    v_add_f32 v127, v127, v159
    v_lshlrev_b32 v143, 16, v167
    v_and_b32 v167, 0xffff0000, v167
    v_add_f32 v126, v126, v143
    v_add_f32 v127, v127, v167
    v_cvt_pk_bf16_f32 v143, v126, v127
    v_lshlrev_b32 v126, 16, v143
    v_and_b32 v127, 0xffff0000, v143
    v_mul_f32 v143, s89, v126
    v_mul_f32 v151, s89, v127
    v_exp_f32 v140, v140
    v_exp_f32 v148, v148
    v_exp_f32 v141, v141
    v_exp_f32 v149, v149
    v_exp_f32 v142, v142
    v_exp_f32 v150, v150
    v_exp_f32 v143, v143
    v_exp_f32 v151, v151
    s_nop 0
    v_add_f32 v140, 1.0, v140
    v_add_f32 v148, 1.0, v148
    v_add_f32 v141, 1.0, v141
    v_add_f32 v149, 1.0, v149
    v_add_f32 v142, 1.0, v142
    v_add_f32 v150, 1.0, v150
    v_add_f32 v143, 1.0, v143
    v_add_f32 v151, 1.0, v151
    v_rcp_f32 v140, v140
    v_rcp_f32 v148, v148
    v_rcp_f32 v141, v141
    v_rcp_f32 v149, v149
    v_rcp_f32 v142, v142
    v_rcp_f32 v150, v150
    v_rcp_f32 v143, v143
    v_rcp_f32 v151, v151
    s_nop 0
    v_mul_f32 v120, v120, v140
    v_mul_f32 v121, v121, v148
    v_cvt_pk_bf16_f32 v140, v120, v121
    v_mul_f32 v122, v122, v141
    v_mul_f32 v123, v123, v149
    v_cvt_pk_bf16_f32 v141, v122, v123
    v_mul_f32 v124, v124, v142
    v_mul_f32 v125, v125, v150
    v_cvt_pk_bf16_f32 v142, v124, v125
    v_mul_f32 v126, v126, v143
    v_mul_f32 v127, v127, v151
    v_cvt_pk_bf16_f32 v143, v126, v127
    s_waitcnt vmcnt(0)
    v_lshlrev_b32 v96, 16, v16
    v_and_b32 v97, 0xffff0000, v16
    v_lshlrev_b32 v98, 16, v17
    v_and_b32 v99, 0xffff0000, v17
    v_lshlrev_b32 v100, 16, v18
    v_and_b32 v101, 0xffff0000, v18
    v_lshlrev_b32 v102, 16, v19
    v_and_b32 v103, 0xffff0000, v19
    v_lshlrev_b32 v120, 16, v20
    v_and_b32 v121, 0xffff0000, v20
    v_lshlrev_b32 v122, 16, v21
    v_and_b32 v123, 0xffff0000, v21
    v_lshlrev_b32 v124, 16, v22
    v_and_b32 v125, 0xffff0000, v22
    v_lshlrev_b32 v126, 16, v23
    v_and_b32 v127, 0xffff0000, v23
    v_add_f32 v96, v96, v120
    v_add_f32 v97, v97, v121
    v_add_f32 v98, v98, v122
    v_add_f32 v99, v99, v123
    v_add_f32 v100, v100, v124
    v_add_f32 v101, v101, v125
    v_add_f32 v102, v102, v126
    v_add_f32 v103, v103, v127
    v_lshlrev_b32 v120, 16, v24
    v_and_b32 v121, 0xffff0000, v24
    v_lshlrev_b32 v122, 16, v25
    v_and_b32 v123, 0xffff0000, v25
    v_lshlrev_b32 v124, 16, v26
    v_and_b32 v125, 0xffff0000, v26
    v_lshlrev_b32 v126, 16, v27
    v_and_b32 v127, 0xffff0000, v27
    v_add_f32 v96, v96, v120
    v_add_f32 v97, v97, v121
    v_add_f32 v98, v98, v122
    v_add_f32 v99, v99, v123
    v_add_f32 v100, v100, v124
    v_add_f32 v101, v101, v125
    v_add_f32 v102, v102, v126
    v_add_f32 v103, v103, v127
    v_lshlrev_b32 v120, 16, v28
    v_and_b32 v121, 0xffff0000, v28
    v_lshlrev_b32 v122, 16, v29
    v_and_b32 v123, 0xffff0000, v29
    v_lshlrev_b32 v124, 16, v30
    v_and_b32 v125, 0xffff0000, v30
    v_lshlrev_b32 v126, 16, v31
    v_and_b32 v127, 0xffff0000, v31
    v_add_f32 v96, v96, v120
    v_add_f32 v97, v97, v121
    v_add_f32 v98, v98, v122
    v_add_f32 v99, v99, v123
    v_add_f32 v100, v100, v124
    v_add_f32 v101, v101, v125
    v_add_f32 v102, v102, v126
    v_add_f32 v103, v103, v127
    v_lshlrev_b32 v120, 16, v32
    v_and_b32 v121, 0xffff0000, v32
    v_lshlrev_b32 v122, 16, v33
    v_and_b32 v123, 0xffff0000, v33
    v_lshlrev_b32 v124, 16, v34
    v_and_b32 v125, 0xffff0000, v34
    v_lshlrev_b32 v126, 16, v35
    v_and_b32 v127, 0xffff0000, v35
    v_add_f32 v96, v96, v120
    v_add_f32 v97, v97, v121
    v_add_f32 v98, v98, v122
    v_add_f32 v99, v99, v123
    v_add_f32 v100, v100, v124
    v_add_f32 v101, v101, v125
    v_add_f32 v102, v102, v126
    v_add_f32 v103, v103, v127
    v_lshlrev_b32 v120, 16, v36
    v_and_b32 v121, 0xffff0000, v36
    v_lshlrev_b32 v122, 16, v37
    v_and_b32 v123, 0xffff0000, v37
    v_lshlrev_b32 v124, 16, v38
    v_and_b32 v125, 0xffff0000, v38
    v_lshlrev_b32 v126, 16, v39
    v_and_b32 v127, 0xffff0000, v39
    v_add_f32 v96, v96, v120
    v_add_f32 v97, v97, v121
    v_add_f32 v98, v98, v122
    v_add_f32 v99, v99, v123
    v_add_f32 v100, v100, v124
    v_add_f32 v101, v101, v125
    v_add_f32 v102, v102, v126
    v_add_f32 v103, v103, v127
    v_lshlrev_b32 v120, 16, v40
    v_and_b32 v121, 0xffff0000, v40
    v_lshlrev_b32 v122, 16, v41
    v_and_b32 v123, 0xffff0000, v41
    v_lshlrev_b32 v124, 16, v42
    v_and_b32 v125, 0xffff0000, v42
    v_lshlrev_b32 v126, 16, v43
    v_and_b32 v127, 0xffff0000, v43
    v_add_f32 v96, v96, v120
    v_add_f32 v97, v97, v121
    v_add_f32 v98, v98, v122
    v_add_f32 v99, v99, v123
    v_add_f32 v100, v100, v124
    v_add_f32 v101, v101, v125
    v_add_f32 v102, v102, v126
    v_add_f32 v103, v103, v127
    v_lshlrev_b32 v120, 16, v44
    v_and_b32 v121, 0xffff0000, v44
    v_lshlrev_b32 v122, 16, v45
    v_and_b32 v123, 0xffff0000, v45
    v_lshlrev_b32 v124, 16, v46
    v_and_b32 v125, 0xffff0000, v46
    v_lshlrev_b32 v126, 16, v47
    v_and_b32 v127, 0xffff0000, v47
    v_add_f32 v96, v96, v120
    v_add_f32 v97, v97, v121
    v_add_f32 v98, v98, v122
    v_add_f32 v99, v99, v123
    v_add_f32 v100, v100, v124
    v_add_f32 v101, v101, v125
    v_add_f32 v102, v102, v126
    v_add_f32 v103, v103, v127
    v_cndmask_b32 v108, v88, v90, s[76:77]
    v_cndmask_b32 v109, v89, v91, s[76:77]
    v_cndmask_b32 v110, v90, v88, s[76:77]
    v_cndmask_b32 v111, v91, v89, s[76:77]
    v_cvt_pk_bf16_f32 v104, v96, v97
    v_lshlrev_b32 v96, 16, v104
    v_and_b32 v97, 0xffff0000, v104
    v_lshlrev_b32 v104, 16, v136
    v_and_b32 v105, 0xffff0000, v136
    v_mul_f32 v96, v96, v104
    v_mul_f32 v97, v97, v105
    v_cvt_pk_bf16_f32 v104, v96, v97
    v_lshlrev_b32 v96, 16, v104
    v_and_b32 v97, 0xffff0000, v104
    v_lshlrev_b32 v104, 16, v108
    v_and_b32 v105, 0xffff0000, v108
    v_add_f32 v96, v96, v104
    v_add_f32 v97, v97, v105
    v_cvt_pk_bf16_f32 v112, v96, v97
    v_cvt_pk_bf16_f32 v104, v98, v99
    v_lshlrev_b32 v98, 16, v104
    v_and_b32 v99, 0xffff0000, v104
    v_lshlrev_b32 v104, 16, v137
    v_and_b32 v105, 0xffff0000, v137
    v_mul_f32 v98, v98, v104
    v_mul_f32 v99, v99, v105
    v_cvt_pk_bf16_f32 v104, v98, v99
    v_lshlrev_b32 v98, 16, v104
    v_and_b32 v99, 0xffff0000, v104
    v_lshlrev_b32 v104, 16, v109
    v_and_b32 v105, 0xffff0000, v109
    v_add_f32 v98, v98, v104
    v_add_f32 v99, v99, v105
    v_cvt_pk_bf16_f32 v113, v98, v99
    v_cvt_pk_bf16_f32 v104, v100, v101
    v_lshlrev_b32 v100, 16, v104
    v_and_b32 v101, 0xffff0000, v104
    v_lshlrev_b32 v104, 16, v138
    v_and_b32 v105, 0xffff0000, v138
    v_mul_f32 v100, v100, v104
    v_mul_f32 v101, v101, v105
    v_cvt_pk_bf16_f32 v104, v100, v101
    v_lshlrev_b32 v100, 16, v104
    v_and_b32 v101, 0xffff0000, v104
    v_lshlrev_b32 v104, 16, v110
    v_and_b32 v105, 0xffff0000, v110
    v_add_f32 v100, v100, v104
    v_add_f32 v101, v101, v105
    v_cvt_pk_bf16_f32 v114, v100, v101
    v_cvt_pk_bf16_f32 v104, v102, v103
    v_lshlrev_b32 v102, 16, v104
    v_and_b32 v103, 0xffff0000, v104
    v_lshlrev_b32 v104, 16, v139
    v_and_b32 v105, 0xffff0000, v139
    v_mul_f32 v102, v102, v104
    v_mul_f32 v103, v103, v105
    v_cvt_pk_bf16_f32 v104, v102, v103
    v_lshlrev_b32 v102, 16, v104
    v_and_b32 v103, 0xffff0000, v104
    v_lshlrev_b32 v104, 16, v111
    v_and_b32 v105, 0xffff0000, v111
    v_add_f32 v102, v102, v104
    v_add_f32 v103, v103, v105
    v_cvt_pk_bf16_f32 v115, v102, v103
    v_cndmask_b32 v128, v112, v114, s[76:77]
    v_cndmask_b32 v129, v113, v115, s[76:77]
    v_cndmask_b32 v130, v114, v112, s[76:77]
    v_cndmask_b32 v131, v115, v113, s[76:77]
    buffer_store_dwordx4 v[128:131], v4, s[12:15], s74 offen offset:0
    v_lshlrev_b32 v96, 16, v48
    v_and_b32 v97, 0xffff0000, v48
    v_lshlrev_b32 v98, 16, v49
    v_and_b32 v99, 0xffff0000, v49
    v_lshlrev_b32 v100, 16, v50
    v_and_b32 v101, 0xffff0000, v50
    v_lshlrev_b32 v102, 16, v51
    v_and_b32 v103, 0xffff0000, v51
    v_lshlrev_b32 v120, 16, v52
    v_and_b32 v121, 0xffff0000, v52
    v_lshlrev_b32 v122, 16, v53
    v_and_b32 v123, 0xffff0000, v53
    v_lshlrev_b32 v124, 16, v54
    v_and_b32 v125, 0xffff0000, v54
    v_lshlrev_b32 v126, 16, v55
    v_and_b32 v127, 0xffff0000, v55
    v_add_f32 v96, v96, v120
    v_add_f32 v97, v97, v121
    v_add_f32 v98, v98, v122
    v_add_f32 v99, v99, v123
    v_add_f32 v100, v100, v124
    v_add_f32 v101, v101, v125
    v_add_f32 v102, v102, v126
    v_add_f32 v103, v103, v127
    v_lshlrev_b32 v120, 16, v56
    v_and_b32 v121, 0xffff0000, v56
    v_lshlrev_b32 v122, 16, v57
    v_and_b32 v123, 0xffff0000, v57
    v_lshlrev_b32 v124, 16, v58
    v_and_b32 v125, 0xffff0000, v58
    v_lshlrev_b32 v126, 16, v59
    v_and_b32 v127, 0xffff0000, v59
    v_add_f32 v96, v96, v120
    v_add_f32 v97, v97, v121
    v_add_f32 v98, v98, v122
    v_add_f32 v99, v99, v123
    v_add_f32 v100, v100, v124
    v_add_f32 v101, v101, v125
    v_add_f32 v102, v102, v126
    v_add_f32 v103, v103, v127
    v_lshlrev_b32 v120, 16, v60
    v_and_b32 v121, 0xffff0000, v60
    v_lshlrev_b32 v122, 16, v61
    v_and_b32 v123, 0xffff0000, v61
    v_lshlrev_b32 v124, 16, v62
    v_and_b32 v125, 0xffff0000, v62
    v_lshlrev_b32 v126, 16, v63
    v_and_b32 v127, 0xffff0000, v63
    v_add_f32 v96, v96, v120
    v_add_f32 v97, v97, v121
    v_add_f32 v98, v98, v122
    v_add_f32 v99, v99, v123
    v_add_f32 v100, v100, v124
    v_add_f32 v101, v101, v125
    v_add_f32 v102, v102, v126
    v_add_f32 v103, v103, v127
    v_lshlrev_b32 v120, 16, v64
    v_and_b32 v121, 0xffff0000, v64
    v_lshlrev_b32 v122, 16, v65
    v_and_b32 v123, 0xffff0000, v65
    v_lshlrev_b32 v124, 16, v66
    v_and_b32 v125, 0xffff0000, v66
    v_lshlrev_b32 v126, 16, v67
    v_and_b32 v127, 0xffff0000, v67
    v_add_f32 v96, v96, v120
    v_add_f32 v97, v97, v121
    v_add_f32 v98, v98, v122
    v_add_f32 v99, v99, v123
    v_add_f32 v100, v100, v124
    v_add_f32 v101, v101, v125
    v_add_f32 v102, v102, v126
    v_add_f32 v103, v103, v127
    v_lshlrev_b32 v120, 16, v68
    v_and_b32 v121, 0xffff0000, v68
    v_lshlrev_b32 v122, 16, v69
    v_and_b32 v123, 0xffff0000, v69
    v_lshlrev_b32 v124, 16, v70
    v_and_b32 v125, 0xffff0000, v70
    v_lshlrev_b32 v126, 16, v71
    v_and_b32 v127, 0xffff0000, v71
    v_add_f32 v96, v96, v120
    v_add_f32 v97, v97, v121
    v_add_f32 v98, v98, v122
    v_add_f32 v99, v99, v123
    v_add_f32 v100, v100, v124
    v_add_f32 v101, v101, v125
    v_add_f32 v102, v102, v126
    v_add_f32 v103, v103, v127
    v_lshlrev_b32 v120, 16, v72
    v_and_b32 v121, 0xffff0000, v72
    v_lshlrev_b32 v122, 16, v73
    v_and_b32 v123, 0xffff0000, v73
    v_lshlrev_b32 v124, 16, v74
    v_and_b32 v125, 0xffff0000, v74
    v_lshlrev_b32 v126, 16, v75
    v_and_b32 v127, 0xffff0000, v75
    v_add_f32 v96, v96, v120
    v_add_f32 v97, v97, v121
    v_add_f32 v98, v98, v122
    v_add_f32 v99, v99, v123
    v_add_f32 v100, v100, v124
    v_add_f32 v101, v101, v125
    v_add_f32 v102, v102, v126
    v_add_f32 v103, v103, v127
    v_lshlrev_b32 v120, 16, v76
    v_and_b32 v121, 0xffff0000, v76
    v_lshlrev_b32 v122, 16, v77
    v_and_b32 v123, 0xffff0000, v77
    v_lshlrev_b32 v124, 16, v78
    v_and_b32 v125, 0xffff0000, v78
    v_lshlrev_b32 v126, 16, v79
    v_and_b32 v127, 0xffff0000, v79
    v_add_f32 v96, v96, v120
    v_add_f32 v97, v97, v121
    v_add_f32 v98, v98, v122
    v_add_f32 v99, v99, v123
    v_add_f32 v100, v100, v124
    v_add_f32 v101, v101, v125
    v_add_f32 v102, v102, v126
    v_add_f32 v103, v103, v127
    v_cndmask_b32 v108, v92, v94, s[76:77]
    v_cndmask_b32 v109, v93, v95, s[76:77]
    v_cndmask_b32 v110, v94, v92, s[76:77]
    v_cndmask_b32 v111, v95, v93, s[76:77]
    v_cvt_pk_bf16_f32 v104, v96, v97
    v_lshlrev_b32 v96, 16, v104
    v_and_b32 v97, 0xffff0000, v104
    v_lshlrev_b32 v104, 16, v140
    v_and_b32 v105, 0xffff0000, v140
    v_mul_f32 v96, v96, v104
    v_mul_f32 v97, v97, v105
    v_cvt_pk_bf16_f32 v104, v96, v97
    v_lshlrev_b32 v96, 16, v104
    v_and_b32 v97, 0xffff0000, v104
    v_lshlrev_b32 v104, 16, v108
    v_and_b32 v105, 0xffff0000, v108
    v_add_f32 v96, v96, v104
    v_add_f32 v97, v97, v105
    v_cvt_pk_bf16_f32 v112, v96, v97
    v_cvt_pk_bf16_f32 v104, v98, v99
    v_lshlrev_b32 v98, 16, v104
    v_and_b32 v99, 0xffff0000, v104
    v_lshlrev_b32 v104, 16, v141
    v_and_b32 v105, 0xffff0000, v141
    v_mul_f32 v98, v98, v104
    v_mul_f32 v99, v99, v105
    v_cvt_pk_bf16_f32 v104, v98, v99
    v_lshlrev_b32 v98, 16, v104
    v_and_b32 v99, 0xffff0000, v104
    v_lshlrev_b32 v104, 16, v109
    v_and_b32 v105, 0xffff0000, v109
    v_add_f32 v98, v98, v104
    v_add_f32 v99, v99, v105
    v_cvt_pk_bf16_f32 v113, v98, v99
    v_cvt_pk_bf16_f32 v104, v100, v101
    v_lshlrev_b32 v100, 16, v104
    v_and_b32 v101, 0xffff0000, v104
    v_lshlrev_b32 v104, 16, v142
    v_and_b32 v105, 0xffff0000, v142
    v_mul_f32 v100, v100, v104
    v_mul_f32 v101, v101, v105
    v_cvt_pk_bf16_f32 v104, v100, v101
    v_lshlrev_b32 v100, 16, v104
    v_and_b32 v101, 0xffff0000, v104
    v_lshlrev_b32 v104, 16, v110
    v_and_b32 v105, 0xffff0000, v110
    v_add_f32 v100, v100, v104
    v_add_f32 v101, v101, v105
    v_cvt_pk_bf16_f32 v114, v100, v101
    v_cvt_pk_bf16_f32 v104, v102, v103
    v_lshlrev_b32 v102, 16, v104
    v_and_b32 v103, 0xffff0000, v104
    v_lshlrev_b32 v104, 16, v143
    v_and_b32 v105, 0xffff0000, v143
    v_mul_f32 v102, v102, v104
    v_mul_f32 v103, v103, v105
    v_cvt_pk_bf16_f32 v104, v102, v103
    v_lshlrev_b32 v102, 16, v104
    v_and_b32 v103, 0xffff0000, v104
    v_lshlrev_b32 v104, 16, v111
    v_and_b32 v105, 0xffff0000, v111
    v_add_f32 v102, v102, v104
    v_add_f32 v103, v103, v105
    v_cvt_pk_bf16_f32 v115, v102, v103
    v_cndmask_b32 v132, v112, v114, s[76:77]
    v_cndmask_b32 v133, v113, v115, s[76:77]
    v_cndmask_b32 v134, v114, v112, s[76:77]
    v_cndmask_b32 v135, v115, v113, s[76:77]
    buffer_store_dwordx4 v[132:135], v4, s[12:15], s74 offen offset:64
    s_add_u32 s80, s80, 1
    s_cmp_le_u32 s80, s34
    s_cbranch_scc1 fin_job
    s_branch w_fin_done
fin_tail:
    s_mov_b32 s81, s36
    s_lshl_b32 s81, s81, 2
    s_and_b32 s82, s3, 3
    s_add_u32 s81, s81, s82
    s_lshr_b32 s82, s81, 5
    s_and_b32 s81, s81, 31
    s_lshl_b32 s72, s80, 1
    s_add_u32 s72, s72, s82
    s_lshl_b32 s74, s72, 15
    s_lshl_b32 s73, s81, 10
    s_add_u32 s73, s73, s74
    s_lshl_b32 s75, s81, 6
    s_add_u32 s74, s74, s75
    s_add_u32 s78, s73, 117440512
    s_add_u32 s79, s73, 75497472
    s_mov_b32 s83, 218106816
    s_mov_b32 s84, 65536
    s_min_u32 s87, s80, 62
    v_and_b32 v8, 7, v1
    v_lshlrev_b32 v8, 22, v8
    s_cmp_lg_u32 s3, 0
    s_cbranch_scc1 ft_ok
ft_wd:
    buffer_load_dword v7, off, s[4:7], s83 sc1
    s_waitcnt vmcnt(0)
    v_readfirstlane_b32 s86, v7
    s_cmp_ge_u32 s86, 16
    s_cbranch_scc1 ft_wdok
    s_sleep 32
    s_sub_u32 s84, s84, 1
    s_cbranch_scc0 ft_wd
    s_mov_b32 s84, 0
ft_wdok:
ft_ok:
    s_barrier
    s_cmp_ge_u32 s3, 4
    s_cbranch_scc1 w_fin_done
    buffer_load_dwordx4 v[88:91], v4, s[8:11], s74 offen
    buffer_load_dwordx4 v[136:139], v3, s[4:7], s78 offen sc1
    s_add_u32 s78, s78, 4194304
    buffer_load_dwordx4 v[144:147], v3, s[4:7], s78 offen sc1
    s_add_u32 s78, s78, 4194304
    buffer_load_dwordx4 v[152:155], v3, s[4:7], s78 offen sc1
    s_add_u32 s78, s78, 4194304
    buffer_load_dwordx4 v[160:163], v3, s[4:7], s78 offen sc1
    s_add_u32 s78, s78, 4194304
    s_waitcnt vmcnt(0)
    v_lshlrev_b32 v120, 16, v136
    v_and_b32 v121, 0xffff0000, v136
    v_lshlrev_b32 v136, 16, v144
    v_and_b32 v144, 0xffff0000, v144
    v_add_f32 v120, v120, v136
    v_add_f32 v121, v121, v144
    v_lshlrev_b32 v136, 16, v152
    v_and_b32 v152, 0xffff0000, v152
    v_add_f32 v120, v120, v136
    v_add_f32 v121, v121, v152
    v_lshlrev_b32 v136, 16, v160
    v_and_b32 v160, 0xffff0000, v160
    v_add_f32 v120, v120, v136
    v_add_f32 v121, v121, v160
    v_cvt_pk_bf16_f32 v136, v120, v121
    v_lshlrev_b32 v120, 16, v136
    v_and_b32 v121, 0xffff0000, v136
    v_mul_f32 v136, s89, v120
    v_mul_f32 v144, s89, v121
    v_lshlrev_b32 v122, 16, v137
    v_and_b32 v123, 0xffff0000, v137
    v_lshlrev_b32 v137, 16, v145
    v_and_b32 v145, 0xffff0000, v145
    v_add_f32 v122, v122, v137
    v_add_f32 v123, v123, v145
    v_lshlrev_b32 v137, 16, v153
    v_and_b32 v153, 0xffff0000, v153
    v_add_f32 v122, v122, v137
    v_add_f32 v123, v123, v153
    v_lshlrev_b32 v137, 16, v161
    v_and_b32 v161, 0xffff0000, v161
    v_add_f32 v122, v122, v137
    v_add_f32 v123, v123, v161
    v_cvt_pk_bf16_f32 v137, v122, v123
    v_lshlrev_b32 v122, 16, v137
    v_and_b32 v123, 0xffff0000, v137
    v_mul_f32 v137, s89, v122
    v_mul_f32 v145, s89, v123
    v_lshlrev_b32 v124, 16, v138
    v_and_b32 v125, 0xffff0000, v138
    v_lshlrev_b32 v138, 16, v146
    v_and_b32 v146, 0xffff0000, v146
    v_add_f32 v124, v124, v138
    v_add_f32 v125, v125, v146
    v_lshlrev_b32 v138, 16, v154
    v_and_b32 v154, 0xffff0000, v154
    v_add_f32 v124, v124, v138
    v_add_f32 v125, v125, v154
    v_lshlrev_b32 v138, 16, v162
    v_and_b32 v162, 0xffff0000, v162
    v_add_f32 v124, v124, v138
    v_add_f32 v125, v125, v162
    v_cvt_pk_bf16_f32 v138, v124, v125
    v_lshlrev_b32 v124, 16, v138
    v_and_b32 v125, 0xffff0000, v138
    v_mul_f32 v138, s89, v124
    v_mul_f32 v146, s89, v125
    v_lshlrev_b32 v126, 16, v139
    v_and_b32 v127, 0xffff0000, v139
    v_lshlrev_b32 v139, 16, v147
    v_and_b32 v147, 0xffff0000, v147
    v_add_f32 v126, v126, v139
    v_add_f32 v127, v127, v147
    v_lshlrev_b32 v139, 16, v155
    v_and_b32 v155, 0xffff0000, v155
    v_add_f32 v126, v126, v139
    v_add_f32 v127, v127, v155
    v_lshlrev_b32 v139, 16, v163
    v_and_b32 v163, 0xffff0000, v163
    v_add_f32 v126, v126, v139
    v_add_f32 v127, v127, v163
    v_cvt_pk_bf16_f32 v139, v126, v127
    v_lshlrev_b32 v126, 16, v139
    v_and_b32 v127, 0xffff0000, v139
    v_mul_f32 v139, s89, v126
    v_mul_f32 v147, s89, v127
    v_exp_f32 v136, v136
    v_exp_f32 v144, v144
    v_exp_f32 v137, v137
    v_exp_f32 v145, v145
    v_exp_f32 v138, v138
    v_exp_f32 v146, v146
    v_exp_f32 v139, v139
    v_exp_f32 v147, v147
    s_nop 0
    v_add_f32 v136, 1.0, v136
    v_add_f32 v144, 1.0, v144
    v_add_f32 v137, 1.0, v137
    v_add_f32 v145, 1.0, v145
    v_add_f32 v138, 1.0, v138
    v_add_f32 v146, 1.0, v146
    v_add_f32 v139, 1.0, v139
    v_add_f32 v147, 1.0, v147
    v_rcp_f32 v136, v136
    v_rcp_f32 v144, v144
    v_rcp_f32 v137, v137
    v_rcp_f32 v145, v145
    v_rcp_f32 v138, v138
    v_rcp_f32 v146, v146
    v_rcp_f32 v139, v139
    v_rcp_f32 v147, v147
    s_nop 0
    v_mul_f32 v120, v120, v136
    v_mul_f32 v121, v121, v144
    v_cvt_pk_bf16_f32 v136, v120, v121
    v_mul_f32 v122, v122, v137
    v_mul_f32 v123, v123, v145
    v_cvt_pk_bf16_f32 v137, v122, v123
    v_mul_f32 v124, v124, v138
    v_mul_f32 v125, v125, v146
    v_cvt_pk_bf16_f32 v138, v124, v125
    v_mul_f32 v126, v126, v139
    v_mul_f32 v127, v127, v147
    v_cvt_pk_bf16_f32 v139, v126, v127
ft_ws:
    buffer_load_dword v7, v6, s[4:7], s85 offen sc1
    s_waitcnt vmcnt(0)
    v_cmp_gt_u32 vcc, s87, v7
    s_cbranch_vccz ft_p
    s_sleep 12
    v_cmp_gt_u32 vcc, 59, v7
    s_cbranch_vccz ft_wsf
    s_sleep 64
    v_cmp_gt_u32 vcc, 56, v7
    s_cbranch_vccz ft_wsf
    s_sleep 127
    s_sleep 127
ft_wsf:
    s_sub_u32 s84, s84, 1
    s_cbranch_scc0 ft_ws
    s_mov_b32 s84, 0
ft_p:
    buffer_load_dword v7, v8, s[4:7], s79 offen offset:1008 sc1
    s_waitcnt vmcnt(0)
    v_cmp_eq_u32 vcc, -1, v7
    s_cbranch_vccz ft_l0
    s_sleep 4
    s_sub_u32 s84, s84, 1
    s_cbranch_scc0 ft_p
    s_mov_b32 s84, 0
ft_l0:
    s_cmp_lg_u32 s3, 0
    s_cbranch_scc1 clm_17
    v_mov_b32 v250, 1
    s_mov_b64 exec, 1
    buffer_atomic_add v250, off, s[64:67], s71 sc0 sc1
    s_mov_b64 exec, -1
clm_17:
ft_l:
    s_mov_b32 s86, s79
    buffer_load_dwordx4 v[16:19], v3, s[4:7], s86 offen sc1
    s_add_u32 s86, s86, 4194304
    buffer_load_dwordx4 v[20:23], v3, s[4:7], s86 offen sc1
    s_add_u32 s86, s86, 4194304
    buffer_load_dwordx4 v[24:27], v3, s[4:7], s86 offen sc1
    s_add_u32 s86, s86, 4194304
    buffer_load_dwordx4 v[28:31], v3, s[4:7], s86 offen sc1
    s_add_u32 s86, s86, 4194304
    buffer_load_dwordx4 v[32:35], v3, s[4:7], s86 offen sc1
    s_add_u32 s86, s86, 4194304
    buffer_load_dwordx4 v[36:39], v3, s[4:7], s86 offen sc1
    s_add_u32 s86, s86, 4194304
    buffer_load_dwordx4 v[40:43], v3, s[4:7], s86 offen sc1
    s_add_u32 s86, s86, 4194304
    buffer_load_dwordx4 v[44:47], v3, s[4:7], s86 offen sc1
    s_waitcnt vmcnt(0)
    v_max3_u32 v7, v16, v20, v24
    v_max3_u32 v7, v7, v28, v32
    v_max3_u32 v7, v7, v36, v40
    v_max_u32 v7, v7, v44
    v_cmp_eq_u32 vcc, -1, v7
    s_cbranch_vccz ft_go
    s_sleep 0
    s_sub_u32 s84, s84, 1
    s_cbranch_scc0 ft_l
ft_go:
    v_lshlrev_b32 v96, 16, v16
    v_and_b32 v97, 0xffff0000, v16
    v_lshlrev_b32 v98, 16, v17
    v_and_b32 v99, 0xffff0000, v17
    v_lshlrev_b32 v100, 16, v18
    v_and_b32 v101, 0xffff0000, v18
    v_lshlrev_b32 v102, 16, v19
    v_and_b32 v103, 0xffff0000, v19
    v_lshlrev_b32 v120, 16, v20
    v_and_b32 v121, 0xffff0000, v20
    v_lshlrev_b32 v122, 16, v21
    v_and_b32 v123, 0xffff0000, v21
    v_lshlrev_b32 v124, 16, v22
    v_and_b32 v125, 0xffff0000, v22
    v_lshlrev_b32 v126, 16, v23
    v_and_b32 v127, 0xffff0000, v23
    v_add_f32 v96, v96, v120
    v_add_f32 v97, v97, v121
    v_add_f32 v98, v98, v122
    v_add_f32 v99, v99, v123
    v_add_f32 v100, v100, v124
    v_add_f32 v101, v101, v125
    v_add_f32 v102, v102, v126
    v_add_f32 v103, v103, v127
    v_lshlrev_b32 v120, 16, v24
    v_and_b32 v121, 0xffff0000, v24
    v_lshlrev_b32 v122, 16, v25
    v_and_b32 v123, 0xffff0000, v25
    v_lshlrev_b32 v124, 16, v26
    v_and_b32 v125, 0xffff0000, v26
    v_lshlrev_b32 v126, 16, v27
    v_and_b32 v127, 0xffff0000, v27
    v_add_f32 v96, v96, v120
    v_add_f32 v97, v97, v121
    v_add_f32 v98, v98, v122
    v_add_f32 v99, v99, v123
    v_add_f32 v100, v100, v124
    v_add_f32 v101, v101, v125
    v_add_f32 v102, v102, v126
    v_add_f32 v103, v103, v127
    v_lshlrev_b32 v120, 16, v28
    v_and_b32 v121, 0xffff0000, v28
    v_lshlrev_b32 v122, 16, v29
    v_and_b32 v123, 0xffff0000, v29
    v_lshlrev_b32 v124, 16, v30
    v_and_b32 v125, 0xffff0000, v30
    v_lshlrev_b32 v126, 16, v31
    v_and_b32 v127, 0xffff0000, v31
    v_add_f32 v96, v96, v120
    v_add_f32 v97, v97, v121
    v_add_f32 v98, v98, v122
    v_add_f32 v99, v99, v123
    v_add_f32 v100, v100, v124
    v_add_f32 v101, v101, v125
    v_add_f32 v102, v102, v126
    v_add_f32 v103, v103, v127
    v_lshlrev_b32 v120, 16, v32
    v_and_b32 v121, 0xffff0000, v32
    v_lshlrev_b32 v122, 16, v33
    v_and_b32 v123, 0xffff0000, v33
    v_lshlrev_b32 v124, 16, v34
    v_and_b32 v125, 0xffff0000, v34
    v_lshlrev_b32 v126, 16, v35
    v_and_b32 v127, 0xffff0000, v35
    v_add_f32 v96, v96, v120
    v_add_f32 v97, v97, v121
    v_add_f32 v98, v98, v122
    v_add_f32 v99, v99, v123
    v_add_f32 v100, v100, v124
    v_add_f32 v101, v101, v125
    v_add_f32 v102, v102, v126
    v_add_f32 v103, v103, v127
    v_lshlrev_b32 v120, 16, v36
    v_and_b32 v121, 0xffff0000, v36
    v_lshlrev_b32 v122, 16, v37
    v_and_b32 v123, 0xffff0000, v37
    v_lshlrev_b32 v124, 16, v38
    v_and_b32 v125, 0xffff0000, v38
    v_lshlrev_b32 v126, 16, v39
    v_and_b32 v127, 0xffff0000, v39
    v_add_f32 v96, v96, v120
    v_add_f32 v97, v97, v121
    v_add_f32 v98, v98, v122
    v_add_f32 v99, v99, v123
    v_add_f32 v100, v100, v124
    v_add_f32 v101, v101, v125
    v_add_f32 v102, v102, v126
    v_add_f32 v103, v103, v127
    v_lshlrev_b32 v120, 16, v40
    v_and_b32 v121, 0xffff0000, v40
    v_lshlrev_b32 v122, 16, v41
    v_and_b32 v123, 0xffff0000, v41
    v_lshlrev_b32 v124, 16, v42
    v_and_b32 v125, 0xffff0000, v42
    v_lshlrev_b32 v126, 16, v43
    v_and_b32 v127, 0xffff0000, v43
    v_add_f32 v96, v96, v120
    v_add_f32 v97, v97, v121
    v_add_f32 v98, v98, v122
    v_add_f32 v99, v99, v123
    v_add_f32 v100, v100, v124
    v_add_f32 v101, v101, v125
    v_add_f32 v102, v102, v126
    v_add_f32 v103, v103, v127
    v_lshlrev_b32 v120, 16, v44
    v_and_b32 v121, 0xffff0000, v44
    v_lshlrev_b32 v122, 16, v45
    v_and_b32 v123, 0xffff0000, v45
    v_lshlrev_b32 v124, 16, v46
    v_and_b32 v125, 0xffff0000, v46
    v_lshlrev_b32 v126, 16, v47
    v_and_b32 v127, 0xffff0000, v47
    v_add_f32 v96, v96, v120
    v_add_f32 v97, v97, v121
    v_add_f32 v98, v98, v122
    v_add_f32 v99, v99, v123
    v_add_f32 v100, v100, v124
    v_add_f32 v101, v101, v125
    v_add_f32 v102, v102, v126
    v_add_f32 v103, v103, v127
    v_cndmask_b32 v108, v88, v90, s[76:77]
    v_cndmask_b32 v109, v89, v91, s[76:77]
    v_cndmask_b32 v110, v90, v88, s[76:77]
    v_cndmask_b32 v111, v91, v89, s[76:77]
    v_cvt_pk_bf16_f32 v104, v96, v97
    v_lshlrev_b32 v96, 16, v104
    v_and_b32 v97, 0xffff0000, v104
    v_lshlrev_b32 v104, 16, v136
    v_and_b32 v105, 0xffff0000, v136
    v_mul_f32 v96, v96, v104
    v_mul_f32 v97, v97, v105
    v_cvt_pk_bf16_f32 v104, v96, v97
    v_lshlrev_b32 v96, 16, v104
    v_and_b32 v97, 0xffff0000, v104
    v_lshlrev_b32 v104, 16, v108
    v_and_b32 v105, 0xffff0000, v108
    v_add_f32 v96, v96, v104
    v_add_f32 v97, v97, v105
    v_cvt_pk_bf16_f32 v112, v96, v97
    v_cvt_pk_bf16_f32 v104, v98, v99
    v_lshlrev_b32 v98, 16, v104
    v_and_b32 v99, 0xffff0000, v104
    v_lshlrev_b32 v104, 16, v137
    v_and_b32 v105, 0xffff0000, v137
    v_mul_f32 v98, v98, v104
    v_mul_f32 v99, v99, v105
    v_cvt_pk_bf16_f32 v104, v98, v99
    v_lshlrev_b32 v98, 16, v104
    v_and_b32 v99, 0xffff0000, v104
    v_lshlrev_b32 v104, 16, v109
    v_and_b32 v105, 0xffff0000, v109
    v_add_f32 v98, v98, v104
    v_add_f32 v99, v99, v105
    v_cvt_pk_bf16_f32 v113, v98, v99
    v_cvt_pk_bf16_f32 v104, v100, v101
    v_lshlrev_b32 v100, 16, v104
    v_and_b32 v101, 0xffff0000, v104
    v_lshlrev_b32 v104, 16, v138
    v_and_b32 v105, 0xffff0000, v138
    v_mul_f32 v100, v100, v104
    v_mul_f32 v101, v101, v105
    v_cvt_pk_bf16_f32 v104, v100, v101
    v_lshlrev_b32 v100, 16, v104
    v_and_b32 v101, 0xffff0000, v104
    v_lshlrev_b32 v104, 16, v110
    v_and_b32 v105, 0xffff0000, v110
    v_add_f32 v100, v100, v104
    v_add_f32 v101, v101, v105
    v_cvt_pk_bf16_f32 v114, v100, v101
    v_cvt_pk_bf16_f32 v104, v102, v103
    v_lshlrev_b32 v102, 16, v104
    v_and_b32 v103, 0xffff0000, v104
    v_lshlrev_b32 v104, 16, v139
    v_and_b32 v105, 0xffff0000, v139
    v_mul_f32 v102, v102, v104
    v_mul_f32 v103, v103, v105
    v_cvt_pk_bf16_f32 v104, v102, v103
    v_lshlrev_b32 v102, 16, v104
    v_and_b32 v103, 0xffff0000, v104
    v_lshlrev_b32 v104, 16, v111
    v_and_b32 v105, 0xffff0000, v111
    v_add_f32 v102, v102, v104
    v_add_f32 v103, v103, v105
    v_cvt_pk_bf16_f32 v115, v102, v103
    v_cndmask_b32 v128, v112, v114, s[76:77]
    v_cndmask_b32 v129, v113, v115, s[76:77]
    v_cndmask_b32 v130, v114, v112, s[76:77]
    v_cndmask_b32 v131, v115, v113, s[76:77]
    buffer_store_dwordx4 v[128:131], v4, s[12:15], s74 offen offset:0
    s_branch w_fin_done
w_fin_done:
    s_cmp_lg_u32 s3, 0
    s_cbranch_scc1 pub_18
    v_mov_b32 v20, 131136
    s_mov_b64 exec, 1
    ds_write_b32 v20, v250
    s_mov_b64 exec, -1
    s_waitcnt lgkmcnt(0)
pub_18:
    s_barrier
    v_mov_b32 v20, 131136
    ds_read_b32 v20, v20
    s_waitcnt lgkmcnt(0)
    v_readfirstlane_b32 s59, v20
    s_add_u32 s59, s59, 32
    s_min_u32 s59, s59, 322
    s_lshl_b32 s57, s59, 6
    s_load_dwordx16 s[32:47], s[24:25], s57
    s_waitcnt lgkmcnt(0)
    s_barrier
    s_sub_u32 s57, s32, 1
    s_cmp_ge_u32 s57, 5
    s_cbranch_scc1 w_cold
    v_and_b32 v20, 63, v0
    v_lshlrev_b32 v1, 4, v20
    v_add_u32 v19, 0x1000, v1
    v_lshrrev_b32 v4, 4, v20
    v_mov_b32 v17, 0
    v_mov_b32 v18, 1
    s_lshr_b32 s26, s3, 2
    s_and_b32 s27, s3, 3
    s_lshl_b32 s21, s3, 11
    s_lshl_b32 s22, s3, 10
    s_add_u32 s22, s22, 16384
    s_mov_b32 s11, 131072
    s_mov_b32 s15, 131072
    s_mov_b32 s28, 0
    v_and_b32 v21, 15, v20
    v_lshlrev_b32 v22, 2, v4
    v_xor_b32 v21, v21, v22
    s_lshr_b32 s30, s3, 1
    s_and_b32 s30, s30, 1
    v_xor_b32 v21, s30, v21
    v_lshlrev_b32 v3, 4, v21
    s_lshl_b32 s30, s26, 13
    v_add_u32 v5, s30, v1
    v_add_u32 v6, 0x10000, v5
    v_bfe_u32 v21, v20, 2, 2
    v_and_b32 v22, 3, v20
    v_and_b32 v23, 1, v4
    v_xor_b32 v24, s27, v21
    v_xor_b32 v25, v22, v23
    v_lshl_add_u32 v24, v24, 2, v25
    v_lshlrev_b32 v24, 4, v24
    v_lshl_add_u32 v25, v4, 3, v21
    v_lshl_add_u32 v24, v25, 8, v24
    v_and_b32 v22, 1, v22
    v_xor_b32 v25, 0, v23
    v_lshl_add_u32 v8, v25, 10, v24
    v_xor_b32 v25, 0, v22
    v_lshl_add_u32 v8, v25, 3, v8
    v_add_u32 v12, 0x10000, v8
    v_xor_b32 v25, 1, v23
    v_lshl_add_u32 v9, v25, 10, v24
    v_xor_b32 v25, 0, v22
    v_lshl_add_u32 v9, v25, 3, v9
    v_add_u32 v13, 0x10000, v9
    v_xor_b32 v25, 0, v23
    v_lshl_add_u32 v10, v25, 10, v24
    v_xor_b32 v25, 1, v22
    v_lshl_add_u32 v10, v25, 3, v10
    v_add_u32 v14, 0x10000, v10
    v_xor_b32 v25, 1, v23
    v_lshl_add_u32 v11, v25, 10, v24
    v_xor_b32 v25, 1, v22
    v_lshl_add_u32 v11, v25, 3, v11
    v_add_u32 v15, 0x10000, v11
    s_lshl_b32 s30, s3, 2
    s_add_u32 s30, s30, 131072
    v_mov_b32 v7, s30
    s_branch w_cold
chain_map:
    s_lshl_b32 s52, s12, 5
    s_add_u32 s52, s52, s13
    s_lshr_b32 s15, s52, 2
    s_lshr_b32 s14, s52, 4
    s_and_b32 s34, s13, 15
    s_and_b32 s53, s13, 3
    s_mov_b32 s16, 0
    s_mov_b32 s22, 131072
    s_mov_b32 s100, 131072
    s_getreg_b32 s40, hwreg(HW_REG_XCC_ID)
    s_and_b32 s40, s40, 15
    s_mul_i32 s19, s40, s40
    s_lshl_b32 s19, s19, 18
    s_lshl_b32 s40, s40, 8
    s_add_u32 s40, s40, s19
    s_add_u32 s40, s40, 1
    s_lshl_b32 s35, s14, 4
    s_add_u32 s35, s35, 218104320
    s_and_b32 s21, s3, 3
    s_mul_i32 s42, s21, 24576
    s_add_u32 s42, s42, 65536
    s_lshl_b32 s41, s14, 2
    s_add_u32 s41, s41, s21
    s_lshl_b32 s41, s41, 12
    s_add_u32 s101, s42, 8192
    s_bfe_u32 s17, s34, 0x20001
    s_cmp_eq_u32 s17, s21
    s_cselect_b32 s68, 20480, s42
    s_xor_b32 s68, s68, s101
    s_lshl_b32 s43, s21, 13
    s_add_u32 s43, s43, 138412032
    s_lshl_b32 s69, s21, 24
    s_lshl_b32 s17, s52, 10
    s_add_u32 s69, s69, s17
    s_add_u32 s69, s69, 20971520
    s_cmp_ge_u32 s3, 4
    s_cbranch_scc1 ch_a_pro
    s_add_u32 s41, s41, 262144
    s_lshl_b32 s38, s15, 13
    s_add_u32 s38, s38, 214958080
    s_lshl_b32 s17, s13, 1
    s_and_b32 s18, s3, 1
    s_add_u32 s17, s17, s18
    s_lshl_b32 s17, s17, 1
    s_cmp_lt_u32 s3, 2
    s_cselect_b32 s56, 0xffff, 0
    s_mov_b32 s57, 0
    s_lshr_b32 s18, s17, 1
    s_and_b32 s19, s17, 1
    s_lshl_b32 s20, s12, 14
    s_add_u32 s20, s20, 213909504
    s_lshl_b32 s36, s3, 12
    s_add_u32 s36, s36, s20
    s_lshl_b32 s37, s18, 8
    s_add_u32 s37, s37, s20
    s_lshl_b32 s20, s19, 5
    s_add_u32 s37, s37, s20
    s_lshr_b32 s39, s17, 3
    s_lshl_b32 s39, s39, 14
    s_and_b32 s20, s17, 7
    s_lshl_b32 s20, s20, 10
    s_add_u32 s39, s39, s20
    s_add_u32 s39, s39, 209715200
    s_lshl_b32 s30, s14, 22
    s_lshl_b32 s20, s34, 11
    s_add_u32 s30, s30, s20
    s_lshl_b32 s20, s3, 9
    s_add_u32 s30, s30, s20
    s_add_u32 s30, s30, 78643200
    s_lshl_b32 s55, s15, 13
    s_add_u32 s55, s55, 192937984
    s_mov_b32 s26, s38
    s_mov_b32 s54, s30
    s_mov_b32 s29, 2
    s_mov_b32 s58, 0
    s_mov_b32 s59, 0
    s_bfe_u32 s17, s34, 0x20001
    s_lshl_b32 s60, s14, 2
    s_add_u32 s60, s60, s17
    s_lshl_b32 s60, s60, 2
    s_add_u32 s60, s60, s3
    s_lshl_b32 s60, s60, 10
    s_and_b32 s17, s34, 1
    s_lshl_b32 s17, s17, 17
    s_add_u32 s60, s60, s17
    s_add_u32 s60, s60, 175898624
    s_mov_b32 s31, 786432
    v_and_b32 v20, 63, v0
    v_lshlrev_b32 v1, 4, v20
    v_mov_b32 v10, -1
    v_mov_b32 v11, -1
    v_lshrrev_b32 v21, 2, v20
    v_and_b32 v22, 3, v20
    v_lshlrev_b32 v21, 13, v21
    v_lshl_add_u32 v21, v22, 4, v21
    s_lshl_b32 s17, s3, 21
    s_lshl_b32 s18, s52, 6
    s_add_u32 s17, s17, s18
    s_lshl_b32 s19, s3, 15
    s_mov_b32 s10, 8388608
    s_mov_b32 s11, 131072
    v_lshrrev_b32 v24, 5, v20
    v_bfe_u32 v25, v20, 3, 1
    v_lshl_add_u32 v24, v24, 1, v25
    v_bfe_u32 v26, v20, 4, 1
    v_xor_b32 v26, v26, v25
    v_lshl_add_u32 v24, v24, 1, v26
    v_bfe_u32 v25, v20, 2, 1
    v_lshl_add_u32 v24, v24, 2, v25
    v_lshlrev_b32 v24, 6, v24
    v_lshl_add_u32 v24, v22, 3, v24
    v_add_u32 v24, s19, v24
    s_and_b32 s70, s13, 0
    s_lshl_b32 s72, s70, 20
    s_lshl_b32 s73, s70, 21
    s_lshl_b32 s70, s70, 13
    s_sub_u32 s71, s19, s70
    s_add_u32 s70, s19, s70
    s_load_dwordx2 s[8:9], s[0:1], 16
    s_add_u32 s20, s17, s72
    s_waitcnt lgkmcnt(0)
    s_add_u32 m0, s70, 0
    s_nop 0
    buffer_load_dwordx4 v21, s[8:11], s20 offen lds
    s_add_u32 s20, s20, 131072
    s_add_u32 m0, s70, 1024
    s_nop 0
    buffer_load_dwordx4 v21, s[8:11], s20 offen lds
    s_add_u32 s20, s20, 131072
    s_barrier
    v_mov_b32 v27, 131136
    ds_read_b32 v27, v27
    s_mov_b32 s96, s97
    s_waitcnt lgkmcnt(0)
    v_readfirstlane_b32 s97, v27
    s_cmp_lg_u32 s96, s97
    s_cbranch_scc1 k_restart
    s_add_u32 m0, s70, 2048
    s_nop 0
    buffer_load_dwordx4 v21, s[8:11], s20 offen lds
    s_add_u32 s20, s20, 131072
    s_add_u32 m0, s70, 3072
    s_nop 0
    buffer_load_dwordx4 v21, s[8:11], s20 offen lds
    s_add_u32 s20, s20, 131072
    s_add_u32 m0, s70, 4096
    s_nop 0
    buffer_load_dwordx4 v21, s[8:11], s20 offen lds
    s_add_u32 s20, s20, 131072
    s_add_u32 m0, s70, 5120
    s_nop 0
    buffer_load_dwordx4 v21, s[8:11], s20 offen lds
    s_add_u32 s20, s20, 131072
    s_add_u32 m0, s70, 6144
    s_nop 0
    buffer_load_dwordx4 v21, s[8:11], s20 offen lds
    s_add_u32 s20, s20, 131072
    s_add_u32 m0, s70, 7168
    s_nop 0
    buffer_load_dwordx4 v21, s[8:11], s20 offen lds
    s_add_u32 s20, s20, 131072
    s_sub_u32 s20, s20, s73
    s_add_u32 m0, s71, 8192
    s_nop 0
    buffer_load_dwordx4 v21, s[8:11], s20 offen lds
    s_add_u32 s20, s20, 131072
    s_add_u32 m0, s71, 9216
    s_nop 0
    buffer_load_dwordx4 v21, s[8:11], s20 offen lds
    s_add_u32 s20, s20, 131072
    s_add_u32 m0, s71, 10240
    s_nop 0
    buffer_load_dwordx4 v21, s[8:11], s20 offen lds
    s_add_u32 s20, s20, 131072
    s_add_u32 m0, s71, 11264
    s_nop 0
    buffer_load_dwordx4 v21, s[8:11], s20 offen lds
    s_add_u32 s20, s20, 131072
    s_add_u32 m0, s71, 12288
    s_nop 0
    buffer_load_dwordx4 v21, s[8:11], s20 offen lds
    s_add_u32 s20, s20, 131072
    s_add_u32 m0, s71, 13312
    s_nop 0
    buffer_load_dwordx4 v21, s[8:11], s20 offen lds
    s_add_u32 s20, s20, 131072
    s_add_u32 m0, s71, 14336
    s_nop 0
    buffer_load_dwordx4 v21, s[8:11], s20 offen lds
    s_add_u32 s20, s20, 131072
    s_add_u32 m0, s71, 15360
    s_nop 0
    buffer_load_dwordx4 v21, s[8:11], s20 offen lds
    s_add_u32 s20, s20, 131072
    s_load_dwordx2 s[8:9], s[0:1], 24
    s_add_u32 s20, s17, s72
    s_waitcnt lgkmcnt(0)
    s_add_u32 m0, s70, 16384
    s_nop 0
    buffer_load_dwordx4 v21, s[8:11], s20 offen lds
    s_add_u32 s20, s20, 131072
    s_add_u32 m0, s70, 17408
    s_nop 0
    buffer_load_dwordx4 v21, s[8:11], s20 offen lds
    s_add_u32 s20, s20, 131072
    s_add_u32 m0, s70, 18432
    s_nop 0
    buffer_load_dwordx4 v21, s[8:11], s20 offen lds
    s_add_u32 s20, s20, 131072
    s_add_u32 m0, s70, 19456
    s_nop 0
    buffer_load_dwordx4 v21, s[8:11], s20 offen lds
    s_add_u32 s20, s20, 131072
    s_add_u32 m0, s70, 20480
    s_nop 0
    buffer_load_dwordx4 v21, s[8:11], s20 offen lds
    s_add_u32 s20, s20, 131072
    s_add_u32 m0, s70, 21504
    s_nop 0
    buffer_load_dwordx4 v21, s[8:11], s20 offen lds
    s_add_u32 s20, s20, 131072
    s_add_u32 m0, s70, 22528
    s_nop 0
    buffer_load_dwordx4 v21, s[8:11], s20 offen lds
    s_add_u32 s20, s20, 131072
    s_add_u32 m0, s70, 23552
    s_nop 0
    buffer_load_dwordx4 v21, s[8:11], s20 offen lds
    s_add_u32 s20, s20, 131072
    s_sub_u32 s20, s20, s73
    s_add_u32 m0, s71, 24576
    s_nop 0
    buffer_load_dwordx4 v21, s[8:11], s20 offen lds
    s_add_u32 s20, s20, 131072
    s_add_u32 m0, s71, 25600
    s_nop 0
    buffer_load_dwordx4 v21, s[8:11], s20 offen lds
    s_add_u32 s20, s20, 131072
    s_add_u32 m0, s71, 26624
    s_nop 0
    buffer_load_dwordx4 v21, s[8:11], s20 offen lds
    s_add_u32 s20, s20, 131072
    s_add_u32 m0, s71, 27648
    s_nop 0
    buffer_load_dwordx4 v21, s[8:11], s20 offen lds
    s_add_u32 s20, s20, 131072
    s_add_u32 m0, s71, 28672
    s_nop 0
    buffer_load_dwordx4 v21, s[8:11], s20 offen lds
    s_add_u32 s20, s20, 131072
    s_add_u32 m0, s71, 29696
    s_nop 0
    buffer_load_dwordx4 v21, s[8:11], s20 offen lds
    s_add_u32 s20, s20, 131072
    s_add_u32 m0, s71, 30720
    s_nop 0
    buffer_load_dwordx4 v21, s[8:11], s20 offen lds
    s_add_u32 s20, s20, 131072
    s_add_u32 m0, s71, 31744
    s_nop 0
    buffer_load_dwordx4 v21, s[8:11], s20 offen lds
    s_add_u32 s20, s20, 131072
    s_load_dwordx2 s[8:9], s[0:1], 32
    s_add_u32 s20, s17, s72
    s_waitcnt lgkmcnt(0)
    buffer_load_dwordx4 v[96:99], v21, s[8:11], s20 offen
    s_add_u32 s20, s20, 131072
    buffer_load_dwordx4 v[100:103], v21, s[8:11], s20 offen
    s_add_u32 s20, s20, 131072
    buffer_load_dwordx4 v[104:107], v21, s[8:11], s20 offen
    s_add_u32 s20, s20, 131072
    buffer_load_dwordx4 v[108:111], v21, s[8:11], s20 offen
    s_add_u32 s20, s20, 131072
    buffer_load_dwordx4 v[144:147], v21, s[8:11], s20 offen
    s_add_u32 s20, s20, 131072
    buffer_load_dwordx4 v[148:151], v21, s[8:11], s20 offen
    s_add_u32 s20, s20, 131072
    buffer_load_dwordx4 v[152:155], v21, s[8:11], s20 offen
    s_add_u32 s20, s20, 131072
    buffer_load_dwordx4 v[156:159], v21, s[8:11], s20 offen
    s_add_u32 s20, s20, 131072
    s_sub_u32 s20, s20, s73
    buffer_load_dwordx4 v[192:195], v21, s[8:11], s20 offen
    s_add_u32 s20, s20, 131072
    buffer_load_dwordx4 v[196:199], v21, s[8:11], s20 offen
    s_add_u32 s20, s20, 131072
    buffer_load_dwordx4 v[200:203], v21, s[8:11], s20 offen
    s_add_u32 s20, s20, 131072
    buffer_load_dwordx4 v[204:207], v21, s[8:11], s20 offen
    s_add_u32 s20, s20, 131072
    buffer_load_dwordx4 v[240:243], v21, s[8:11], s20 offen
    s_add_u32 s20, s20, 131072
    buffer_load_dwordx4 v[244:247], v21, s[8:11], s20 offen
    s_add_u32 s20, s20, 131072
    buffer_load_dwordx4 v[248:251], v21, s[8:11], s20 offen
    s_add_u32 s20, s20, 131072
    buffer_load_dwordx4 v[252:255], v21, s[8:11], s20 offen
    s_add_u32 s20, s20, 131072
    s_load_dwordx2 s[8:9], s[0:1], 8
    s_mov_b32 s10, 16384
    v_bfe_u32 v57, v20, 2, 2
    v_and_b32 v58, 1, v20
    v_lshl_add_u32 v57, v57, 1, v58
    v_lshlrev_b32 v57, 11, v57
    v_lshrrev_b32 v58, 4, v20
    v_lshl_add_u32 v57, v58, 5, v57
    v_bfe_u32 v58, v20, 1, 1
    v_lshl_add_u32 v57, v58, 4, v57
    v_lshl_add_u32 v59, v58, 3, v57
    v_xor_b32 v60, 8, v59
    s_lshl_b32 s20, s3, 9
    s_waitcnt lgkmcnt(0)
    buffer_load_dwordx2 v[32:33], v59, s[8:11], s20 offen offset:0
    buffer_load_dwordx2 v[34:35], v60, s[8:11], s20 offen offset:0
    buffer_load_dwordx2 v[36:37], v59, s[8:11], s20 offen offset:128
    buffer_load_dwordx2 v[38:39], v60, s[8:11], s20 offen offset:128
    buffer_load_dwordx2 v[40:41], v59, s[8:11], s20 offen offset:256
    buffer_load_dwordx2 v[42:43], v60, s[8:11], s20 offen offset:256
    buffer_load_dwordx2 v[44:45], v59, s[8:11], s20 offen offset:384
    buffer_load_dwordx2 v[46:47], v60, s[8:11], s20 offen offset:384
    s_barrier
    v_add_u32 v56, s70, v1
    v_add_u32 v26, s71, v1
    s_waitcnt vmcnt(40)
    ds_read_b64_tr_b16 v[64:65], v24 offset:0
    ds_read_b64_tr_b16 v[66:67], v24 offset:128
    ds_read_b64_tr_b16 v[68:69], v24 offset:2048
    ds_read_b64_tr_b16 v[70:71], v24 offset:2176
    ds_read_b64_tr_b16 v[72:73], v24 offset:32
    ds_read_b64_tr_b16 v[74:75], v24 offset:160
    ds_read_b64_tr_b16 v[76:77], v24 offset:2080
    ds_read_b64_tr_b16 v[78:79], v24 offset:2208
    s_waitcnt lgkmcnt(0)
    ds_read_b64_tr_b16 v[112:113], v24 offset:4096
    ds_read_b64_tr_b16 v[114:115], v24 offset:4224
    ds_read_b64_tr_b16 v[116:117], v24 offset:6144
    ds_read_b64_tr_b16 v[118:119], v24 offset:6272
    ds_read_b64_tr_b16 v[120:121], v24 offset:4128
    ds_read_b64_tr_b16 v[122:123], v24 offset:4256
    ds_read_b64_tr_b16 v[124:125], v24 offset:6176
    ds_read_b64_tr_b16 v[126:127], v24 offset:6304
    s_waitcnt lgkmcnt(0)
    ds_read_b64_tr_b16 v[160:161], v24 offset:8192
    ds_read_b64_tr_b16 v[162:163], v24 offset:8320
    ds_read_b64_tr_b16 v[164:165], v24 offset:10240
    ds_read_b64_tr_b16 v[166:167], v24 offset:10368
    ds_read_b64_tr_b16 v[168:169], v24 offset:8224
    ds_read_b64_tr_b16 v[170:171], v24 offset:8352
    ds_read_b64_tr_b16 v[172:173], v24 offset:10272
    ds_read_b64_tr_b16 v[174:175], v24 offset:10400
    s_waitcnt lgkmcnt(0)
    ds_read_b64_tr_b16 v[208:209], v24 offset:12288
    ds_read_b64_tr_b16 v[210:211], v24 offset:12416
    ds_read_b64_tr_b16 v[212:213], v24 offset:14336
    ds_read_b64_tr_b16 v[214:215], v24 offset:14464
    ds_read_b64_tr_b16 v[216:217], v24 offset:12320
    ds_read_b64_tr_b16 v[218:219], v24 offset:12448
    ds_read_b64_tr_b16 v[220:221], v24 offset:14368
    ds_read_b64_tr_b16 v[222:223], v24 offset:14496
    s_waitcnt lgkmcnt(0)
    s_waitcnt vmcnt(24)
    ds_read_b64_tr_b16 v[80:81], v24 offset:16384
    ds_read_b64_tr_b16 v[82:83], v24 offset:16512
    ds_read_b64_tr_b16 v[84:85], v24 offset:18432
    ds_read_b64_tr_b16 v[86:87], v24 offset:18560
    ds_read_b64_tr_b16 v[88:89], v24 offset:16416
    ds_read_b64_tr_b16 v[90:91], v24 offset:16544
    ds_read_b64_tr_b16 v[92:93], v24 offset:18464
    ds_read_b64_tr_b16 v[94:95], v24 offset:18592
    s_waitcnt lgkmcnt(0)
    ds_read_b64_tr_b16 v[128:129], v24 offset:20480
    ds_read_b64_tr_b16 v[130:131], v24 offset:20608
    ds_read_b64_tr_b16 v[132:133], v24 offset:22528
    ds_read_b64_tr_b16 v[134:135], v24 offset:22656
    ds_read_b64_tr_b16 v[136:137], v24 offset:20512
    ds_read_b64_tr_b16 v[138:139], v24 offset:20640
    ds_read_b64_tr_b16 v[140:141], v24 offset:22560
    ds_read_b64_tr_b16 v[142:143], v24 offset:22688
    s_waitcnt lgkmcnt(0)
    ds_read_b64_tr_b16 v[176:177], v24 offset:24576
    ds_read_b64_tr_b16 v[178:179], v24 offset:24704
    ds_read_b64_tr_b16 v[180:181], v24 offset:26624
    ds_read_b64_tr_b16 v[182:183], v24 offset:26752
    ds_read_b64_tr_b16 v[184:185], v24 offset:24608
    ds_read_b64_tr_b16 v[186:187], v24 offset:24736
    ds_read_b64_tr_b16 v[188:189], v24 offset:26656
    ds_read_b64_tr_b16 v[190:191], v24 offset:26784
    s_waitcnt lgkmcnt(0)
    ds_read_b64_tr_b16 v[224:225], v24 offset:28672
    ds_read_b64_tr_b16 v[226:227], v24 offset:28800
    ds_read_b64_tr_b16 v[228:229], v24 offset:30720
    ds_read_b64_tr_b16 v[230:231], v24 offset:30848
    ds_read_b64_tr_b16 v[232:233], v24 offset:28704
    ds_read_b64_tr_b16 v[234:235], v24 offset:28832
    ds_read_b64_tr_b16 v[236:237], v24 offset:30752
    ds_read_b64_tr_b16 v[238:239], v24 offset:30880
    s_waitcnt lgkmcnt(0)
    s_waitcnt vmcnt(8)
    ds_write_b128 v56, v[96:99] offset:0
    ds_write_b128 v56, v[100:103] offset:1024
    ds_write_b128 v56, v[104:107] offset:2048
    ds_write_b128 v56, v[108:111] offset:3072
    ds_write_b128 v56, v[144:147] offset:4096
    ds_write_b128 v56, v[148:151] offset:5120
    ds_write_b128 v56, v[152:155] offset:6144
    ds_write_b128 v56, v[156:159] offset:7168
    ds_write_b128 v26, v[192:195] offset:8192
    ds_write_b128 v26, v[196:199] offset:9216
    ds_write_b128 v26, v[200:203] offset:10240
    ds_write_b128 v26, v[204:207] offset:11264
    ds_write_b128 v26, v[240:243] offset:12288
    ds_write_b128 v26, v[244:247] offset:13312
    ds_write_b128 v26, v[248:251] offset:14336
    ds_write_b128 v26, v[252:255] offset:15360
    s_waitcnt lgkmcnt(0)
    ds_read_b64_tr_b16 v[96:97], v24 offset:0
    ds_read_b64_tr_b16 v[98:99], v24 offset:128
    ds_read_b64_tr_b16 v[100:101], v24 offset:2048
    ds_read_b64_tr_b16 v[102:103], v24 offset:2176
    ds_read_b64_tr_b16 v[104:105], v24 offset:32
    ds_read_b64_tr_b16 v[106:107], v24 offset:160
    ds_read_b64_tr_b16 v[108:109], v24 offset:2080
    ds_read_b64_tr_b16 v[110:111], v24 offset:2208
    s_waitcnt lgkmcnt(0)
    ds_read_b64_tr_b16 v[144:145], v24 offset:4096
    ds_read_b64_tr_b16 v[146:147], v24 offset:4224
    ds_read_b64_tr_b16 v[148:149], v24 offset:6144
    ds_read_b64_tr_b16 v[150:151], v24 offset:6272
    ds_read_b64_tr_b16 v[152:153], v24 offset:4128
    ds_read_b64_tr_b16 v[154:155], v24 offset:4256
    ds_read_b64_tr_b16 v[156:157], v24 offset:6176
    ds_read_b64_tr_b16 v[158:159], v24 offset:6304
    s_waitcnt lgkmcnt(0)
    ds_read_b64_tr_b16 v[192:193], v24 offset:8192
    ds_read_b64_tr_b16 v[194:195], v24 offset:8320
    ds_read_b64_tr_b16 v[196:197], v24 offset:10240
    ds_read_b64_tr_b16 v[198:199], v24 offset:10368
    ds_read_b64_tr_b16 v[200:201], v24 offset:8224
    ds_read_b64_tr_b16 v[202:203], v24 offset:8352
    ds_read_b64_tr_b16 v[204:205], v24 offset:10272
    ds_read_b64_tr_b16 v[206:207], v24 offset:10400
    s_waitcnt lgkmcnt(0)
    ds_read_b64_tr_b16 v[240:241], v24 offset:12288
    ds_read_b64_tr_b16 v[242:243], v24 offset:12416
    ds_read_b64_tr_b16 v[244:245], v24 offset:14336
    ds_read_b64_tr_b16 v[246:247], v24 offset:14464
    ds_read_b64_tr_b16 v[248:249], v24 offset:12320
    ds_read_b64_tr_b16 v[250:251], v24 offset:12448
    ds_read_b64_tr_b16 v[252:253], v24 offset:14368
    ds_read_b64_tr_b16 v[254:255], v24 offset:14496
    s_waitcnt lgkmcnt(0)
    v_mov_b32 v21, 0x44444444
    v_mov_b32 v22, 0xeeeeeeee
    v_and_b32 v23, 2, v20
    v_cmp_eq_u32 vcc, 0, v23
    s_nop 1
    v_cndmask_b32 v8, v22, v21, vcc
    v_bfe_u32 v21, v20, 2, 3
    v_lshrrev_b32 v22, 5, v20
    v_mul_u32_u24 v23, 160, v21
    v_mul_u32_u24 v24, 1280, v22
    v_add_u32 v23, v23, v24
    v_and_b32 v24, 3, v20
    v_lshl_add_u32 v27, v24, 4, v23
    v_lshrrev_b32 v23, 1, v21
    v_and_b32 v21, 1, v21
    v_lshl_add_u32 v21, v23, 2, v21
    v_xor_b32 v22, 1, v22
    v_lshl_add_u32 v21, v22, 1, v21
    v_bfe_u32 v22, v20, 1, 1
    v_lshl_add_u32 v21, v22, 4, v21
    v_xor_b32 v22, v20, v22
    v_and_b32 v22, 1, v22
    v_lshlrev_b32 v21, 4, v21
    v_lshl_add_u32 v25, v22, 3, v21
    v_lshrrev_b32 v21, 3, v20
    v_mul_u32_u24 v23, 160, v21
    v_and_b32 v24, 7, v20
    v_lshl_add_u32 v28, v24, 4, v23
    v_lshrrev_b32 v23, 1, v21
    v_and_b32 v21, 1, v21
    v_lshl_add_u32 v21, v23, 2, v21
    v_and_b32 v22, 1, v20
    v_lshl_add_u32 v21, v22, 1, v21
    v_bfe_u32 v22, v20, 2, 1
    v_lshl_add_u32 v21, v22, 4, v21
    v_bfe_u32 v22, v20, 1, 1
    v_lshlrev_b32 v21, 4, v21
    v_lshl_add_u32 v26, v22, 3, v21
    s_lshl_b32 s17, s53, 10
    s_lshl_b32 s18, s3, 9
    s_add_u32 s17, s17, s18
    s_lshl_b32 s18, s3, 6
    s_lshl_b32 s19, s53, 9
    s_add_u32 s19, s19, 4096
    s_cmp_ge_u32 s3, 2
    s_cselect_b32 s17, s19, s17
    s_cselect_b32 s18, 2560, s18
    s_cselect_b64 vcc, -1, 0
    v_cndmask_b32 v22, v25, v26, vcc
    v_cndmask_b32 v23, v27, v28, vcc
    v_add_u32 v2, s17, v22
    v_add_u32 v4, s18, v23
    v_lshrrev_b32 v21, 4, v20
    v_and_b32 v22, 15, v20
    v_mul_u32_u24 v23, 320, v21
    v_lshl_add_u32 v23, v22, 2, v23
    s_mul_i32 s17, s3, 3840
    v_add_u32 v3, s17, v23
    v_add_u32 v61, 1280, v3
    v_bfe_u32 v24, v20, 3, 1
    v_bfe_u32 v25, v20, 2, 1
    v_xor_b32 v25, v25, v24
    v_bfe_u32 v26, v20, 1, 1
    v_lshl_add_u32 v25, v26, 1, v25
    v_lshl_add_u32 v25, v24, 2, v25
    v_and_b32 v26, 1, v20
    v_lshl_add_u32 v25, v25, 1, v26
    v_sub_u32 v25, v25, v22
    v_lshl_add_u32 v25, v25, 2, v3
    v_add_u32 v62, 2560, v25
    v_lshlrev_b32 v23, 4, v22
    v_lshl_add_u32 v6, v21, 12, v23
    s_lshl_b32 s17, s3, 10
    s_add_u32 s17, s17, 32768
    v_add_u32 v6, s17, v6
    v_lshrrev_b32 v24, 1, v21
    v_lshl_add_u32 v23, v24, 15, v23
    v_and_b32 v24, 1, v21
    v_lshl_add_u32 v7, v24, 8, v23
    v_mov_b32 v58, 15872
    v_bfe_u32 v23, v20, 1, 2
    v_lshlrev_b32 v23, 6, v23
    v_and_b32 v25, 1, v20
    v_lshl_add_u32 v23, v25, 4, v23
    v_bfe_u32 v24, v20, 3, 1
    v_lshl_add_u32 v5, v24, 5, v23
    v_and_b32 v23, 7, v20
    v_lshlrev_b32 v23, 7, v23
    v_bfe_u32 v24, v20, 3, 1
    v_lshl_add_u32 v23, v24, 17, v23
    v_lshrrev_b32 v24, 4, v20
    v_add_u32 v24, 1, v24
    v_cmp_le_u32 vcc, 3, v24
    s_nop 1
    v_cndmask_b32 v24, v24, 0, vcc
    v_lshl_add_u32 v23, v24, 24, v23
    s_lshl_b32 s17, s14, 14
    s_lshl_b32 s18, s34, 10
    s_add_u32 s17, s17, s18
    s_add_u32 s17, s17, 4194304
    v_add_u32 v0, s17, v23
    s_lshl_b32 s17, s3, 2
    s_add_u32 s17, s17, 15872
    v_mov_b32 v63, s17
    v_and_b32 v21, 15, v20
    v_and_b32 v22, 1, v21
    v_lshlrev_b32 v22, 4, v22
    v_mov_b32 v12, 0x3f80
    v_lshlrev_b32 v22, v22, v12
    v_lshrrev_b32 v21, 1, v21
    v_cmp_eq_u32 vcc, 0, v21
    s_nop 1
    v_cndmask_b32 v12, 0, v22, vcc
    v_cmp_eq_u32 vcc, 1, v21
    s_nop 1
    v_cndmask_b32 v13, 0, v22, vcc
    v_cmp_eq_u32 vcc, 2, v21
    s_nop 1
    v_cndmask_b32 v14, 0, v22, vcc
    v_cmp_eq_u32 vcc, 3, v21
    s_nop 1
    v_cndmask_b32 v15, 0, v22, vcc
    s_waitcnt vmcnt(0)
    v_mov_b32 v16, v32
    v_mov_b32 v17, v33
    v_mov_b32 v18, v34
    v_mov_b32 v19, v35
    v_mov_b32 v20, v36
    v_mov_b32 v21, v37
    v_mov_b32 v22, v38
    v_mov_b32 v23, v39
    v_mov_b32 v24, v40
    v_mov_b32 v25, v41
    v_mov_b32 v26, v42
    v_mov_b32 v27, v43
    v_mov_b32 v28, v44
    v_mov_b32 v29, v45
    v_mov_b32 v30, v46
    v_mov_b32 v31, v47
    v_mov_b32 v52, -1
    v_mov_b32 v53, -1
    v_mov_b32 v54, -1
    v_mov_b32 v55, -1
    s_add_u32 s17, s30, 786432
    buffer_store_dwordx4 v[52:55], v7, s[4:7], s17 offen sc1
    s_add_u32 s17, s30, 851968
    buffer_store_dwordx4 v[52:55], v7, s[4:7], s17 offen sc1
    s_add_u32 s17, s30, 917504
    buffer_store_dwordx4 v[52:55], v7, s[4:7], s17 offen sc1
    s_add_u32 s17, s30, 983040
    buffer_store_dwordx4 v[52:55], v7, s[4:7], s17 offen sc1
    s_lshl_b32 s40, s40, 5
    s_barrier
    ds_write_b32 v63, v10
    ds_write_b32 v63, v10 offset:16
    ds_write_b32 v63, v10 offset:32
    ds_write_b32 v63, v10 offset:48
    v_mov_b32 v60, 12
    v_mov_b32 v56, 15968
    s_waitcnt lgkmcnt(0)
    s_barrier
    ds_read_b64 v[32:33], v56
    s_waitcnt lgkmcnt(0)
    v_cmp_ne_u32 vcc, s40, v32
    s_setprio 3
    v_readfirstlane_b32 s17, v33
    s_add_u32 s39, s39, s17
    s_cbranch_vccnz ch_p_slow
    v_mov_b32 v32, 0
    v_mov_b32 v33, 0
    v_mov_b32 v34, 0
    v_mov_b32 v35, 0
    v_mov_b32 v36, 0
    v_mov_b32 v37, 0
    v_mov_b32 v38, 0
    v_mov_b32 v39, 0
    v_mov_b32 v40, 0
    v_mov_b32 v41, 0
    v_mov_b32 v42, 0
    v_mov_b32 v43, 0
    v_mov_b32 v44, 0
    v_mov_b32 v45, 0
    v_mov_b32 v46, 0
    v_mov_b32 v47, 0
    v_mov_b32 v48, 0
    v_mov_b32 v49, 0
    v_mov_b32 v50, 0
    v_mov_b32 v51, 0
    v_mov_b32 v52, 0
    v_mov_b32 v53, 0
    v_mov_b32 v54, 0
    v_mov_b32 v55, 0
    v_mov_b32 v59, 0
    s_nop 1
    s_branch ploopL_20_nc
.p2align 6
    s_nop 0
    s_nop 0
    s_nop 0
    s_nop 0
    s_nop 0
    s_nop 0
    s_nop 0
    s_nop 0
    s_nop 0
    s_nop 0
    s_nop 0
ploopL_20:
    v_mov_b32 v32, 0
    v_mov_b32 v33, 0
    v_mov_b32 v34, 0
    v_mov_b32 v35, 0
    v_mov_b32 v36, 0
    v_mov_b32 v37, 0
    v_mov_b32 v38, 0
    v_mov_b32 v39, 0
    v_mov_b32 v40, 0
    v_mov_b32 v41, 0
    v_mov_b32 v42, 0
    v_mov_b32 v43, 0
    v_mov_b32 v44, 0
    v_mov_b32 v45, 0
    v_mov_b32 v46, 0
    v_mov_b32 v47, 0
    v_mov_b32 v48, 0
    v_mov_b32 v49, 0
    v_mov_b32 v50, 0
    v_mov_b32 v51, 0
    v_mov_b32 v52, 0
    v_mov_b32 v53, 0
    v_mov_b32 v54, 0
    v_mov_b32 v55, 0
    s_bitcmp1_b32 s29, 0
    s_cbranch_scc1 gate_21_ok
    s_add_u32 s21, s16, 1
    s_min_u32 s21, s21, 63
    s_cmp_ge_u32 s21, 16
    s_cselect_b32 s19, 12, 8
    s_and_b32 s32, s21, 4
    s_lshr_b32 s21, s21, 3
    s_lshl_b32 s21, s21, 8
    s_add_u32 s32, s32, s21
    s_add_u32 s32, s32, s35
gate_21:
    buffer_load_dword v9, off, s[4:7], s32 sc1
    s_waitcnt vmcnt(0)
    v_readfirstlane_b32 s21, v9
    s_cmp_ge_u32 s21, s19
    s_cbranch_scc1 gate_21_set
    s_sleep 8
    s_sub_u32 s22, s22, 1
    s_cbranch_scc0 gate_21
    s_mov_b32 s22, 0
gate_21_set:
    s_bitset1_b32 s29, 0
gate_21_ok:
    s_sleep 1
    buffer_load_dwordx4 v[16:19], v1, s[4:7], s23 offen offset:0 sc1
    buffer_load_dwordx4 v[20:23], v1, s[4:7], s23 offen offset:1024 sc1
    buffer_load_dwordx4 v[24:27], v1, s[4:7], s23 offen offset:2048 sc1
    buffer_load_dwordx4 v[28:31], v1, s[4:7], s23 offen offset:3072 sc1
    s_waitcnt vmcnt(3)
    v_cmp_eq_u32 vcc, -1, v16
    s_cbranch_vccnz ploopL_20_rm_0
ploopL_20_rm_0ok:
    v_smfmac_f32_16x16x64_bf16 v[32:35], v[16:19], v[64:71], v8
    v_smfmac_f32_16x16x64_bf16 v[36:39], v[16:19], v[72:79], v8
    s_waitcnt vmcnt(2)
    v_cmp_eq_u32 vcc, -1, v20
    v_smfmac_f32_16x16x64_bf16 v[40:43], v[16:19], v[80:87], v8
    v_smfmac_f32_16x16x64_bf16 v[44:47], v[16:19], v[88:95], v8
    v_smfmac_f32_16x16x64_bf16 v[48:51], v[16:19], v[96:103], v8
    v_smfmac_f32_16x16x64_bf16 v[52:55], v[16:19], v[104:111], v8
    s_cbranch_vccnz ploopL_20_rm_1
ploopL_20_rm_1ok:
    v_smfmac_f32_16x16x64_bf16 v[32:35], v[20:23], v[112:119], v8
    v_smfmac_f32_16x16x64_bf16 v[36:39], v[20:23], v[120:127], v8
    s_waitcnt vmcnt(1)
    v_cmp_eq_u32 vcc, -1, v24
    v_smfmac_f32_16x16x64_bf16 v[40:43], v[20:23], v[128:135], v8
    v_smfmac_f32_16x16x64_bf16 v[44:47], v[20:23], v[136:143], v8
    v_smfmac_f32_16x16x64_bf16 v[48:51], v[20:23], v[144:151], v8
    v_smfmac_f32_16x16x64_bf16 v[52:55], v[20:23], v[152:159], v8
    s_cbranch_vccnz ploopL_20_rm_2
ploopL_20_rm_2ok:
    v_smfmac_f32_16x16x64_bf16 v[32:35], v[24:27], v[160:167], v8
    v_smfmac_f32_16x16x64_bf16 v[36:39], v[24:27], v[168:175], v8
    s_waitcnt vmcnt(0)
    v_cmp_eq_u32 vcc, -1, v28
    v_smfmac_f32_16x16x64_bf16 v[40:43], v[24:27], v[176:183], v8
    v_smfmac_f32_16x16x64_bf16 v[44:47], v[24:27], v[184:191], v8
    v_smfmac_f32_16x16x64_bf16 v[48:51], v[24:27], v[192:199], v8
    v_smfmac_f32_16x16x64_bf16 v[52:55], v[24:27], v[200:207], v8
    s_cbranch_vccnz ploopL_20_rm_3
ploopL_20_rm_3ok:
    v_smfmac_f32_16x16x64_bf16 v[32:35], v[28:31], v[208:215], v8
    ds_write_b32 v63, v59 offset:32
    v_smfmac_f32_16x16x64_bf16 v[36:39], v[28:31], v[216:223], v8
    v_smfmac_f32_16x16x64_bf16 v[40:43], v[28:31], v[224:231], v8
    v_smfmac_f32_16x16x64_bf16 v[44:47], v[28:31], v[232:239], v8
    v_smfmac_f32_16x16x64_bf16 v[48:51], v[28:31], v[240:247], v8
    v_smfmac_f32_16x16x64_bf16 v[52:55], v[28:31], v[248:255], v8
    s_branch ploopL_20_mmd
ploopL_20_nc:
    v_smfmac_f32_16x16x64_bf16 v[32:35], v[16:19], v[64:71], v8
    v_smfmac_f32_16x16x64_bf16 v[36:39], v[16:19], v[72:79], v8
    v_smfmac_f32_16x16x64_bf16 v[40:43], v[16:19], v[80:87], v8
    v_smfmac_f32_16x16x64_bf16 v[44:47], v[16:19], v[88:95], v8
    v_smfmac_f32_16x16x64_bf16 v[48:51], v[16:19], v[96:103], v8
    v_smfmac_f32_16x16x64_bf16 v[52:55], v[16:19], v[104:111], v8
    v_smfmac_f32_16x16x64_bf16 v[32:35], v[20:23], v[112:119], v8
    v_smfmac_f32_16x16x64_bf16 v[36:39], v[20:23], v[120:127], v8
    v_smfmac_f32_16x16x64_bf16 v[40:43], v[20:23], v[128:135], v8
    v_smfmac_f32_16x16x64_bf16 v[44:47], v[20:23], v[136:143], v8
    v_smfmac_f32_16x16x64_bf16 v[48:51], v[20:23], v[144:151], v8
    v_smfmac_f32_16x16x64_bf16 v[52:55], v[20:23], v[152:159], v8
    v_smfmac_f32_16x16x64_bf16 v[32:35], v[24:27], v[160:167], v8
    v_smfmac_f32_16x16x64_bf16 v[36:39], v[24:27], v[168:175], v8
    v_smfmac_f32_16x16x64_bf16 v[40:43], v[24:27], v[176:183], v8
    v_smfmac_f32_16x16x64_bf16 v[44:47], v[24:27], v[184:191], v8
    v_smfmac_f32_16x16x64_bf16 v[48:51], v[24:27], v[192:199], v8
    v_smfmac_f32_16x16x64_bf16 v[52:55], v[24:27], v[200:207], v8
    v_smfmac_f32_16x16x64_bf16 v[32:35], v[28:31], v[208:215], v8
    ds_write_b32 v63, v59 offset:32
    v_smfmac_f32_16x16x64_bf16 v[36:39], v[28:31], v[216:223], v8
    v_smfmac_f32_16x16x64_bf16 v[40:43], v[28:31], v[224:231], v8
    v_smfmac_f32_16x16x64_bf16 v[44:47], v[28:31], v[232:239], v8
    v_smfmac_f32_16x16x64_bf16 v[48:51], v[28:31], v[240:247], v8
    v_smfmac_f32_16x16x64_bf16 v[52:55], v[28:31], v[248:255], v8
ploopL_20_mmd:
    s_cmp_eq_u32 s3, 3
    s_nop 1
    v_add_f32 v32, v32, v34
    v_add_f32 v33, v33, v35
    ds_write2_b32 v3, v32, v33 offset0:0 offset1:40
    v_add_f32 v36, v36, v38
    v_add_f32 v37, v37, v39
    ds_write2_b32 v3, v36, v37 offset0:16 offset1:56
    v_add_f32 v40, v40, v42
    v_add_f32 v41, v41, v43
    ds_write2_b32 v61, v40, v41 offset0:0 offset1:40
    v_add_f32 v44, v44, v46
    v_add_f32 v45, v45, v47
    ds_write2_b32 v61, v44, v45 offset0:16 offset1:56
    v_add_f32 v48, v48, v50
    v_add_f32 v49, v49, v51
    ds_write2_b32 v62, v48, v49 offset0:0 offset1:40
    v_add_f32 v52, v52, v54
    v_add_f32 v53, v53, v55
    ds_write2_b32 v62, v52, v53 offset0:16 offset1:56
    s_waitcnt lgkmcnt(0)
    s_barrier
    s_cbranch_scc1 ploopL_20_sk1
    ds_read_b128 v[32:35], v4 offset:0
    ds_read_b128 v[36:39], v4 offset:3840
    ds_read_b128 v[40:43], v4 offset:7680
    ds_read_b128 v[44:47], v4 offset:11520
    s_waitcnt lgkmcnt(2)
    v_add_f32 v32, v32, v36
    v_add_f32 v33, v33, v37
    v_add_f32 v34, v34, v38
    v_add_f32 v35, v35, v39
    s_waitcnt lgkmcnt(0)
    v_add_f32 v40, v40, v44
    v_add_f32 v41, v41, v45
    v_add_f32 v42, v42, v46
    v_add_f32 v43, v43, v47
    v_add_f32 v32, v32, v40
    v_add_f32 v33, v33, v41
    v_add_f32 v34, v34, v42
    v_add_f32 v35, v35, v43
    v_cvt_pk_bf16_f32 v56, v32, v33
    v_cvt_pk_bf16_f32 v57, v34, v35
    v_min_u32 v56, -2, v56
    buffer_store_dwordx2 v[56:57], v2, s[4:7], s26 offen
    s_add_u32 s27, s16, 2
    s_and_b32 s27, s27, 3
    s_lshl_b32 s27, s27, 18
    s_add_u32 s27, s27, s38
    buffer_store_dwordx2 v[10:11], v2, s[4:7], s27 offen
ploopL_20_sk1:
    s_setprio 0
    s_add_u32 s25, s16, 3
    s_and_b32 s25, s25, 3
    s_lshl_b32 s25, s25, 16
    s_add_u32 s25, s25, s37
    v_mov_b32 v44, -1
    v_mov_b32 v45, -1
    v_mov_b32 v46, -1
    v_mov_b32 v47, -1
    s_mov_b64 exec, s[56:57]
    buffer_store_dwordx4 v[44:47], v5, s[4:7], s25 offen
    s_mov_b64 exec, -1
    s_and_b32 s28, s16, 3
    s_lshl_b32 s28, s28, 18
    s_add_u32 s28, s28, s39
    s_add_u32 s24, s16, 1
    s_and_b32 s24, s24, 3
    s_lshl_b32 s24, s24, 16
    s_add_u32 s24, s24, s37
    s_add_u32 s23, s16, 1
    s_and_b32 s23, s23, 3
    s_lshl_b32 s23, s23, 16
    s_add_u32 s23, s23, s36
    s_add_u32 s26, s16, 1
    s_and_b32 s26, s26, 3
    s_lshl_b32 s26, s26, 18
    s_add_u32 s26, s26, s38
    s_cmp_eq_u32 s59, 0
    s_cbranch_scc1 ofl_22
    s_lshl_b32 s17, s3, 10
    v_add_u32 v39, s17, v1
    ds_read_b128 v[40:43], v39 offset:32768
ofl_22:
    s_cmp_ge_u32 s16, 16
    s_cbranch_scc1 ploopL_20_nx
    v_mov_b32 v40, v2
    v_mov_b32 v42, v56
    v_mov_b32 v43, v57
    s_cmp_lg_u32 s3, 2
    s_cbranch_scc1 ploopL_20_nx
    v_and_b32 v40, 0x60, v1
    v_lshlrev_b32 v40, 2, v40
    v_lshrrev_b32 v41, 3, v1
    v_and_b32 v41, 0x70, v41
    v_or_b32 v40, v40, v41
    v_bfe_u32 v41, v1, 4, 1
    v_lshl_or_b32 v40, v41, 3, v40
    s_lshl_b32 s17, s53, 9
    s_add_u32 s17, s17, 4096
    v_add_u32 v40, s17, v40
    s_mov_b32 vcc_lo, 0x55555555
    s_mov_b32 vcc_hi, 0x55555555
    v_cndmask_b32_dpp v42, v57, v56, vcc quad_perm:[1,0,3,2] row_mask:0xf bank_mask:0xf
    s_not_b64 vcc, vcc
    v_cndmask_b32_dpp v43, v56, v57, vcc quad_perm:[1,0,3,2] row_mask:0xf bank_mask:0xf
ploopL_20_nx:
    v_readfirstlane_b32 s21, v60
    s_lshr_b32 s29, s29, 1
    s_cmp_ge_u32 s21, s58
    s_cselect_b32 s21, 2, 0
    s_or_b32 s29, s29, s21
    s_cmp_eq_u32 s3, 3
    s_cselect_b32 s20, s21, 0
    s_add_u32 s21, s16, 4
    s_min_u32 s21, s21, 63
    s_cmp_ge_u32 s21, 16
    s_cselect_b32 s58, 12, 8
    s_and_b32 s33, s21, 4
    s_lshr_b32 s21, s21, 3
    s_lshl_b32 s21, s21, 8
    s_add_u32 s33, s33, s21
    s_add_u32 s33, s33, s35
    s_setprio 3
ploopL_20_fs:
    ds_read_b128 v[32:35], v58 offset:0
    s_waitcnt lgkmcnt(0)
    v_min3_i32 v32, v32, v33, v34
    v_min_i32 v32, v32, v35
    s_nop 0
    v_readfirstlane_b32 s18, v32
    s_cmp_ge_i32 s18, s16
    s_cbranch_scc1 ploopL_20_fsok
    s_sleep 1
    s_branch ploopL_20_fs
ploopL_20_fsok:
    s_setprio 1
    s_sleep 4
ploopL_20_nofd:
    s_cmp_eq_u32 s20, 0
    s_cbranch_scc1 ploopL_20_nt
    s_cmp_ge_u32 s16, 13
    s_cselect_b32 exec_hi, 0xffff, 0
    buffer_load_dword v60, v0, s[4:7], s31 offen sc1
    s_mov_b32 exec_hi, -1
ploopL_20_nt:
    s_cmp_eq_u32 s59, 0
    s_cbranch_scc1 ofl_23
    s_lshl_b32 s17, s16, 18
    s_add_u32 s17, s17, s60
    buffer_store_dwordx4 v[40:43], v1, s[4:7], s17 offen sc1
    s_mov_b32 s59, 0
ofl_23:
    s_lshr_b32 s17, s34, 3
    s_xor_b32 s17, s17, s16
    s_andn2_b32 s59, 1, s17
    s_cmp_ge_u32 s16, 16
    s_cselect_b32 s59, s59, 0
    s_cbranch_scc1 ploopL_20_nx2
    s_cmp_eq_u32 s3, 3
    s_cbranch_scc1 ploopL_20_nx2
    buffer_store_dwordx2 v[42:43], v40, s[4:7], s55 offen sc1
ploopL_20_nx2:
    s_add_u32 s55, s55, 262144
    s_or_b32 s17, s13, s3
    s_cmp_lg_u32 s17, 0
    s_cbranch_scc1 ploopL_20_npg
    s_sub_u32 s21, s16, 1
    s_cbranch_scc1 ploopL_20_npg
    s_sub_u32 s17, s21, 1
    s_and_b32 s17, s17, 3
    s_cmp_ge_u32 s16, 58
    s_cselect_b32 s17, 0, s17
    s_cmp_lg_u32 s17, 0
    s_cbranch_scc1 ploopL_20_npg
    s_lshl_b32 s17, s12, 7
    s_add_u32 s17, s17, 218112000
    v_mov_b32 v9, s21
    s_mov_b64 exec, 1
    buffer_store_dword v9, off, s[4:7], s17 sc1
    s_mov_b64 exec, -1
ploopL_20_npg:
    s_barrier
    buffer_load_dword v60, off, s[4:7], s33 sc1
    s_add_u32 s16, s16, 1
    v_mov_b32 v59, s16
    s_add_u32 s41, s41, 262144
    s_add_u32 s31, s31, 262144
    s_setprio 3
    s_sleep 13
ploopL_20_pagain:
    buffer_load_dwordx4 v[16:19], v1, s[4:7], s28 offen offset:0 sc1
    buffer_load_dwordx4 v[20:23], v1, s[4:7], s28 offen offset:1024 sc1
    s_waitcnt vmcnt(1)
    v_mfma_f32_16x16x32_bf16 v[32:35], v[12:15], v[16:19], 0
    s_waitcnt vmcnt(0)
    v_mfma_f32_16x16x32_bf16 v[32:35], v[12:15], v[20:23], v[32:35]
    v_max_u32 v9, v16, v20
    v_cmp_eq_u32 vcc, -1, v9
    s_cbranch_vccnz ploopL_20_rp
ploopL_20_pgo:
    s_cmp_lt_u32 s16, 48
    s_nop 3
    v_cvt_pk_bf16_f32 v52, v32, v33
    v_cvt_pk_bf16_f32 v53, v34, v35
    s_nop 0
    v_permlane16_swap_b32 v52, v54
    v_permlane16_swap_b32 v53, v55
    s_mov_b64 exec, s[56:57]
    v_min_u32 v52, -2, v52
    buffer_store_dwordx4 v[52:55], v5, s[4:7], s24 offen
    s_mov_b64 exec, -1
    ds_write_b32 v63, v59 offset:16
    s_cbranch_scc1 ploopL_20
    s_branch ploopH_19
ploopL_20_rm_0:
    s_sub_u32 s22, s22, 1
    s_cbranch_scc1 ploopL_20_rm_0_g
    buffer_load_dwordx4 v[16:19], v1, s[4:7], s23 offen offset:0 sc1
    buffer_load_dwordx4 v[20:23], v1, s[4:7], s23 offen offset:1024 sc1
    buffer_load_dwordx4 v[24:27], v1, s[4:7], s23 offen offset:2048 sc1
    buffer_load_dwordx4 v[28:31], v1, s[4:7], s23 offen offset:3072 sc1
    s_waitcnt vmcnt(3)
    v_cmp_eq_u32 vcc, -1, v16
    s_cbranch_vccnz ploopL_20_rm_0
    s_branch ploopL_20_rm_0ok
ploopL_20_rm_0_g:
    s_mov_b32 s22, 0
    s_waitcnt vmcnt(0)
    s_branch ploopL_20_rm_0ok
ploopL_20_rm_1:
    s_sub_u32 s22, s22, 1
    s_cbranch_scc1 ploopL_20_rm_1_g
    buffer_load_dwordx4 v[20:23], v1, s[4:7], s23 offen offset:1024 sc1
    buffer_load_dwordx4 v[24:27], v1, s[4:7], s23 offen offset:2048 sc1
    buffer_load_dwordx4 v[28:31], v1, s[4:7], s23 offen offset:3072 sc1
    s_waitcnt vmcnt(2)
    v_cmp_eq_u32 vcc, -1, v20
    s_cbranch_vccnz ploopL_20_rm_1
    s_branch ploopL_20_rm_1ok
ploopL_20_rm_1_g:
    s_mov_b32 s22, 0
    s_waitcnt vmcnt(0)
    s_branch ploopL_20_rm_1ok
ploopL_20_rm_2:
    s_sub_u32 s22, s22, 1
    s_cbranch_scc1 ploopL_20_rm_2_g
    buffer_load_dwordx4 v[24:27], v1, s[4:7], s23 offen offset:2048 sc1
    buffer_load_dwordx4 v[28:31], v1, s[4:7], s23 offen offset:3072 sc1
    s_waitcnt vmcnt(1)
    v_cmp_eq_u32 vcc, -1, v24
    s_cbranch_vccnz ploopL_20_rm_2
    s_branch ploopL_20_rm_2ok
ploopL_20_rm_2_g:
    s_mov_b32 s22, 0
    s_waitcnt vmcnt(0)
    s_branch ploopL_20_rm_2ok
ploopL_20_rm_3:
    s_sub_u32 s22, s22, 1
    s_cbranch_scc1 ploopL_20_rm_3_g
    buffer_load_dwordx4 v[28:31], v1, s[4:7], s23 offen offset:3072 sc1
    s_waitcnt vmcnt(0)
    v_cmp_eq_u32 vcc, -1, v28
    s_cbranch_vccnz ploopL_20_rm_3
    s_branch ploopL_20_rm_3ok
ploopL_20_rm_3_g:
    s_mov_b32 s22, 0
    s_waitcnt vmcnt(0)
    s_branch ploopL_20_rm_3ok
ploopL_20_rp:
    s_sub_u32 s22, s22, 1
    s_cbranch_scc0 ploopL_20_pagain
    s_mov_b32 s22, 0
    s_branch ploopL_20_pgo
.p2align 6
    s_nop 0
    s_nop 0
    s_nop 0
    s_nop 0
    s_nop 0
    s_nop 0
    s_nop 0
    s_nop 0
    s_nop 0
    s_nop 0
    s_nop 0
ploopH_19:
    v_mov_b32 v32, 0
    v_mov_b32 v33, 0
    v_mov_b32 v34, 0
    v_mov_b32 v35, 0
    v_mov_b32 v36, 0
    v_mov_b32 v37, 0
    v_mov_b32 v38, 0
    v_mov_b32 v39, 0
    v_mov_b32 v40, 0
    v_mov_b32 v41, 0
    v_mov_b32 v42, 0
    v_mov_b32 v43, 0
    v_mov_b32 v44, 0
    v_mov_b32 v45, 0
    v_mov_b32 v46, 0
    v_mov_b32 v47, 0
    v_mov_b32 v48, 0
    v_mov_b32 v49, 0
    v_mov_b32 v50, 0
    v_mov_b32 v51, 0
    v_mov_b32 v52, 0
    v_mov_b32 v53, 0
    v_mov_b32 v54, 0
    v_mov_b32 v55, 0
    s_sleep 1
    buffer_load_dwordx4 v[16:19], v1, s[4:7], s23 offen offset:0 sc1
    buffer_load_dwordx4 v[20:23], v1, s[4:7], s23 offen offset:1024 sc1
    buffer_load_dwordx4 v[24:27], v1, s[4:7], s23 offen offset:2048 sc1
    buffer_load_dwordx4 v[28:31], v1, s[4:7], s23 offen offset:3072 sc1
    s_waitcnt vmcnt(3)
    v_cmp_eq_u32 vcc, -1, v16
    s_cbranch_vccnz ploopH_19_rm_0
ploopH_19_rm_0ok:
    v_smfmac_f32_16x16x64_bf16 v[32:35], v[16:19], v[64:71], v8
    v_smfmac_f32_16x16x64_bf16 v[36:39], v[16:19], v[72:79], v8
    s_waitcnt vmcnt(2)
    v_cmp_eq_u32 vcc, -1, v20
    v_smfmac_f32_16x16x64_bf16 v[40:43], v[16:19], v[80:87], v8
    v_smfmac_f32_16x16x64_bf16 v[44:47], v[16:19], v[88:95], v8
    v_smfmac_f32_16x16x64_bf16 v[48:51], v[16:19], v[96:103], v8
    v_smfmac_f32_16x16x64_bf16 v[52:55], v[16:19], v[104:111], v8
    s_cbranch_vccnz ploopH_19_rm_1
ploopH_19_rm_1ok:
    v_smfmac_f32_16x16x64_bf16 v[32:35], v[20:23], v[112:119], v8
    v_smfmac_f32_16x16x64_bf16 v[36:39], v[20:23], v[120:127], v8
    s_waitcnt vmcnt(1)
    v_cmp_eq_u32 vcc, -1, v24
    v_smfmac_f32_16x16x64_bf16 v[40:43], v[20:23], v[128:135], v8
    v_smfmac_f32_16x16x64_bf16 v[44:47], v[20:23], v[136:143], v8
    v_smfmac_f32_16x16x64_bf16 v[48:51], v[20:23], v[144:151], v8
    v_smfmac_f32_16x16x64_bf16 v[52:55], v[20:23], v[152:159], v8
    s_cbranch_vccnz ploopH_19_rm_2
ploopH_19_rm_2ok:
    v_smfmac_f32_16x16x64_bf16 v[32:35], v[24:27], v[160:167], v8
    v_smfmac_f32_16x16x64_bf16 v[36:39], v[24:27], v[168:175], v8
    s_waitcnt vmcnt(0)
    v_cmp_eq_u32 vcc, -1, v28
    v_smfmac_f32_16x16x64_bf16 v[40:43], v[24:27], v[176:183], v8
    v_smfmac_f32_16x16x64_bf16 v[44:47], v[24:27], v[184:191], v8
    v_smfmac_f32_16x16x64_bf16 v[48:51], v[24:27], v[192:199], v8
    v_smfmac_f32_16x16x64_bf16 v[52:55], v[24:27], v[200:207], v8
    s_cbranch_vccnz ploopH_19_rm_3
ploopH_19_rm_3ok:
    v_smfmac_f32_16x16x64_bf16 v[32:35], v[28:31], v[208:215], v8
    ds_write_b32 v63, v59 offset:32
    v_smfmac_f32_16x16x64_bf16 v[36:39], v[28:31], v[216:223], v8
    v_smfmac_f32_16x16x64_bf16 v[40:43], v[28:31], v[224:231], v8
    v_smfmac_f32_16x16x64_bf16 v[44:47], v[28:31], v[232:239], v8
    v_smfmac_f32_16x16x64_bf16 v[48:51], v[28:31], v[240:247], v8
    v_smfmac_f32_16x16x64_bf16 v[52:55], v[28:31], v[248:255], v8
    s_cmp_eq_u32 s3, 3
    s_nop 1
    v_add_f32 v32, v32, v34
    v_add_f32 v33, v33, v35
    ds_write2_b32 v3, v32, v33 offset0:0 offset1:40
    v_add_f32 v36, v36, v38
    v_add_f32 v37, v37, v39
    ds_write2_b32 v3, v36, v37 offset0:16 offset1:56
    v_add_f32 v40, v40, v42
    v_add_f32 v41, v41, v43
    ds_write2_b32 v61, v40, v41 offset0:0 offset1:40
    v_add_f32 v44, v44, v46
    v_add_f32 v45, v45, v47
    ds_write2_b32 v61, v44, v45 offset0:16 offset1:56
    v_add_f32 v48, v48, v50
    v_add_f32 v49, v49, v51
    ds_write2_b32 v62, v48, v49 offset0:0 offset1:40
    v_add_f32 v52, v52, v54
    v_add_f32 v53, v53, v55
    ds_write2_b32 v62, v52, v53 offset0:16 offset1:56
    s_waitcnt lgkmcnt(0)
    s_barrier
    s_cbranch_scc1 ploopH_19_sk1
    ds_read_b128 v[32:35], v4 offset:0
    ds_read_b128 v[36:39], v4 offset:3840
    ds_read_b128 v[40:43], v4 offset:7680
    ds_read_b128 v[44:47], v4 offset:11520
    s_waitcnt lgkmcnt(2)
    v_add_f32 v32, v32, v36
    v_add_f32 v33, v33, v37
    v_add_f32 v34, v34, v38
    v_add_f32 v35, v35, v39
    s_waitcnt lgkmcnt(0)
    v_add_f32 v40, v40, v44
    v_add_f32 v41, v41, v45
    v_add_f32 v42, v42, v46
    v_add_f32 v43, v43, v47
    v_add_f32 v32, v32, v40
    v_add_f32 v33, v33, v41
    v_add_f32 v34, v34, v42
    v_add_f32 v35, v35, v43
    v_cvt_pk_bf16_f32 v56, v32, v33
    v_cvt_pk_bf16_f32 v57, v34, v35
    v_min_u32 v56, -2, v56
    buffer_store_dwordx2 v[56:57], v2, s[4:7], s26 offen
    s_add_u32 s27, s16, 2
    s_and_b32 s27, s27, 3
    s_lshl_b32 s27, s27, 18
    s_add_u32 s27, s27, s38
    buffer_store_dwordx2 v[10:11], v2, s[4:7], s27 offen
ploopH_19_sk1:
    s_setprio 0
    s_add_u32 s25, s16, 3
    s_and_b32 s25, s25, 3
    s_lshl_b32 s25, s25, 16
    s_add_u32 s25, s25, s37
    v_mov_b32 v44, -1
    v_mov_b32 v45, -1
    v_mov_b32 v46, -1
    v_mov_b32 v47, -1
    s_mov_b64 exec, s[56:57]
    buffer_store_dwordx4 v[44:47], v5, s[4:7], s25 offen
    s_mov_b64 exec, -1
    v_mov_b32_dpp v48, v12 row_ror:8 row_mask:0xf bank_mask:0xf
    v_mov_b32_dpp v49, v13 row_ror:8 row_mask:0xf bank_mask:0xf
    v_mov_b32_dpp v50, v14 row_ror:8 row_mask:0xf bank_mask:0xf
    v_mov_b32_dpp v51, v15 row_ror:8 row_mask:0xf bank_mask:0xf
    s_and_b32 s28, s16, 3
    s_lshl_b32 s28, s28, 18
    s_add_u32 s28, s28, s39
    s_add_u32 s24, s16, 1
    s_and_b32 s24, s24, 3
    s_lshl_b32 s24, s24, 16
    s_add_u32 s24, s24, s37
    s_add_u32 s23, s16, 1
    s_and_b32 s23, s23, 3
    s_lshl_b32 s23, s23, 16
    s_add_u32 s23, s23, s36
    s_add_u32 s26, s16, 1
    s_and_b32 s26, s26, 3
    s_lshl_b32 s26, s26, 18
    s_add_u32 s26, s26, s38
    s_cmp_eq_u32 s59, 0
    s_cbranch_scc1 ofl_24
    s_lshl_b32 s17, s3, 10
    v_add_u32 v39, s17, v1
    ds_read_b128 v[40:43], v39 offset:32768
ofl_24:
    s_cmp_eq_u32 s16, 63
    s_cbranch_scc1 ploopH_19_tail
    s_cmp_eq_u32 s30, s54
    s_cbranch_scc1 pnoseg_25
    ds_read_b128 v[16:19], v6 offset:0
    ds_read_b128 v[20:23], v6 offset:256
    ds_read_b128 v[24:27], v6 offset:512
    ds_read_b128 v[28:31], v6 offset:768
    v_xor_b32 v6, 0x4000, v6
    s_waitcnt lgkmcnt(2)
    v_mfma_f32_16x16x32_bf16 v[40:43], v[12:15], v[16:19], 0
    v_mfma_f32_16x16x32_bf16 v[40:43], v[48:51], v[20:23], v[40:43]
    s_waitcnt lgkmcnt(0)
    v_mfma_f32_16x16x32_bf16 v[44:47], v[12:15], v[24:27], 0
    v_mfma_f32_16x16x32_bf16 v[44:47], v[48:51], v[28:31], v[44:47]
    s_nop 7
    v_cvt_pk_bf16_f32 v40, v40, v41
    v_cvt_pk_bf16_f32 v41, v42, v43
    v_cvt_pk_bf16_f32 v42, v44, v45
    v_cvt_pk_bf16_f32 v43, v46, v47
    s_nop 1
    v_permlane16_swap_b32 v40, v42
    v_permlane16_swap_b32 v41, v43
    s_nop 1
    v_min_u32 v40, -2, v40
pnoseg_25:
    s_bitcmp1_b32 s29, 0
    s_cbranch_scc1 gate_26_ok
    s_add_u32 s21, s16, 1
    s_min_u32 s21, s21, 63
    s_cmp_ge_u32 s21, 16
    s_cselect_b32 s19, 12, 8
    s_and_b32 s32, s21, 4
    s_lshr_b32 s21, s21, 3
    s_lshl_b32 s21, s21, 8
    s_add_u32 s32, s32, s21
    s_add_u32 s32, s32, s35
gate_26:
    buffer_load_dword v9, off, s[4:7], s32 sc1
    s_waitcnt vmcnt(0)
    v_readfirstlane_b32 s21, v9
    s_cmp_ge_u32 s21, s19
    s_cbranch_scc1 gate_26_set
    s_sleep 8
    s_sub_u32 s22, s22, 1
    s_cbranch_scc0 gate_26
    s_mov_b32 s22, 0
gate_26_set:
    s_bitset1_b32 s29, 0
gate_26_ok:
    v_readfirstlane_b32 s21, v60
    s_lshr_b32 s29, s29, 1
    s_cmp_ge_u32 s21, s58
    s_cselect_b32 s21, 2, 0
    s_or_b32 s29, s29, s21
    s_cmp_eq_u32 s3, 3
    s_cselect_b32 s20, s21, 0
    s_add_u32 s21, s16, 4
    s_min_u32 s21, s21, 63
    s_cmp_ge_u32 s21, 16
    s_cselect_b32 s58, 12, 8
    s_and_b32 s33, s21, 4
    s_lshr_b32 s21, s21, 3
    s_lshl_b32 s21, s21, 8
    s_add_u32 s33, s33, s21
    s_add_u32 s33, s33, s35
    s_setprio 3
ploopH_19_fs:
    ds_read_b128 v[32:35], v58 offset:0
    s_waitcnt lgkmcnt(0)
    v_min3_i32 v32, v32, v33, v34
    v_min_i32 v32, v32, v35
    s_nop 0
    v_readfirstlane_b32 s18, v32
    s_cmp_ge_i32 s18, s16
    s_cbranch_scc1 ploopH_19_fsok
    s_sleep 1
    s_branch ploopH_19_fs
ploopH_19_fsok:
    s_setprio 1
    s_add_u32 m0, s42, 8192
    s_add_u32 s17, s41, 37748736
    buffer_load_dwordx4 v1, s[4:7], s17 offen offset:0 sc1 lds
    buffer_load_dwordx4 v1, s[4:7], s17 offen offset:1024 sc1 lds
    buffer_load_dwordx4 v1, s[4:7], s17 offen offset:2048 sc1 lds
    buffer_load_dwordx4 v1, s[4:7], s17 offen offset:3072 sc1 lds
    s_add_u32 m0, s42, 12288
    s_add_u32 s17, s41, 37879808
    buffer_load_dwordx4 v1, s[4:7], s17 offen offset:0 sc1 lds
    buffer_load_dwordx4 v1, s[4:7], s17 offen offset:1024 sc1 lds
    buffer_load_dwordx4 v1, s[4:7], s17 offen offset:2048 sc1 lds
    buffer_load_dwordx4 v1, s[4:7], s17 offen offset:3072 sc1 lds
    s_cmp_eq_u32 s20, 0
    s_cbranch_scc1 ploopH_19_nt
    s_mov_b32 exec_hi, 0xffff
    buffer_load_dword v60, v0, s[4:7], s31 offen sc1
    s_mov_b32 exec_hi, -1
ploopH_19_nt:
    s_cmp_eq_u32 s59, 0
    s_cbranch_scc1 ofl_27
    s_lshl_b32 s17, s16, 18
    s_add_u32 s17, s17, s60
    buffer_store_dwordx4 v[40:43], v1, s[4:7], s17 offen sc1
    s_mov_b32 s59, 0
ofl_27:
    s_cmp_eq_u32 s30, s54
    s_cbranch_scc1 pnoseg_28
    buffer_store_dwordx4 v[40:43], v7, s[4:7], s30 offen sc1
    s_add_u32 s30, s30, 65536
pnoseg_28:
    s_or_b32 s17, s13, s3
    s_cmp_lg_u32 s17, 0
    s_cbranch_scc1 ploopH_19_npg
    s_sub_u32 s21, s16, 1
    s_cbranch_scc1 ploopH_19_npg
    s_sub_u32 s17, s21, 1
    s_and_b32 s17, s17, 3
    s_cmp_ge_u32 s16, 58
    s_cselect_b32 s17, 0, s17
    s_cmp_lg_u32 s17, 0
    s_cbranch_scc1 ploopH_19_npg
    s_lshl_b32 s17, s12, 7
    s_add_u32 s17, s17, 218112000
    v_mov_b32 v9, s21
    s_mov_b64 exec, 1
    buffer_store_dword v9, off, s[4:7], s17 sc1
    s_mov_b64 exec, -1
ploopH_19_npg:
    s_barrier
    buffer_load_dword v60, off, s[4:7], s33 sc1
    s_add_u32 s16, s16, 1
    v_mov_b32 v59, s16
    s_add_u32 s41, s41, 262144
    s_add_u32 s31, s31, 262144
    s_mov_b32 s54, 0
    s_setprio 3
    s_sleep 13
ploopH_19_pagain:
    buffer_load_dwordx4 v[16:19], v1, s[4:7], s28 offen offset:0 sc1
    buffer_load_dwordx4 v[20:23], v1, s[4:7], s28 offen offset:1024 sc1
    s_waitcnt vmcnt(1)
    v_mfma_f32_16x16x32_bf16 v[32:35], v[12:15], v[16:19], 0
    s_waitcnt vmcnt(0)
    v_mfma_f32_16x16x32_bf16 v[32:35], v[12:15], v[20:23], v[32:35]
    v_max_u32 v9, v16, v20
    v_cmp_eq_u32 vcc, -1, v9
    s_cbranch_vccnz ploopH_19_rp
ploopH_19_pgo:
    s_nop 4
    v_cvt_pk_bf16_f32 v52, v32, v33
    v_cvt_pk_bf16_f32 v53, v34, v35
    s_nop 0
    v_permlane16_swap_b32 v52, v54
    v_permlane16_swap_b32 v53, v55
    s_mov_b64 exec, s[56:57]
    v_min_u32 v52, -2, v52
    buffer_store_dwordx4 v[52:55], v5, s[4:7], s24 offen
    s_mov_b64 exec, -1
    ds_write_b32 v63, v59 offset:16
    s_branch ploopH_19
ploopH_19_rm_0:
    s_sub_u32 s22, s22, 1
    s_cbranch_scc1 ploopH_19_rm_0_g
    buffer_load_dwordx4 v[16:19], v1, s[4:7], s23 offen offset:0 sc1
    buffer_load_dwordx4 v[20:23], v1, s[4:7], s23 offen offset:1024 sc1
    buffer_load_dwordx4 v[24:27], v1, s[4:7], s23 offen offset:2048 sc1
    buffer_load_dwordx4 v[28:31], v1, s[4:7], s23 offen offset:3072 sc1
    s_waitcnt vmcnt(3)
    v_cmp_eq_u32 vcc, -1, v16
    s_cbranch_vccnz ploopH_19_rm_0
    s_branch ploopH_19_rm_0ok
ploopH_19_rm_0_g:
    s_mov_b32 s22, 0
    s_waitcnt vmcnt(0)
    s_branch ploopH_19_rm_0ok
ploopH_19_rm_1:
    s_sub_u32 s22, s22, 1
    s_cbranch_scc1 ploopH_19_rm_1_g
    buffer_load_dwordx4 v[20:23], v1, s[4:7], s23 offen offset:1024 sc1
    buffer_load_dwordx4 v[24:27], v1, s[4:7], s23 offen offset:2048 sc1
    buffer_load_dwordx4 v[28:31], v1, s[4:7], s23 offen offset:3072 sc1
    s_waitcnt vmcnt(2)
    v_cmp_eq_u32 vcc, -1, v20
    s_cbranch_vccnz ploopH_19_rm_1
    s_branch ploopH_19_rm_1ok
ploopH_19_rm_1_g:
    s_mov_b32 s22, 0
    s_waitcnt vmcnt(0)
    s_branch ploopH_19_rm_1ok
ploopH_19_rm_2:
    s_sub_u32 s22, s22, 1
    s_cbranch_scc1 ploopH_19_rm_2_g
    buffer_load_dwordx4 v[24:27], v1, s[4:7], s23 offen offset:2048 sc1
    buffer_load_dwordx4 v[28:31], v1, s[4:7], s23 offen offset:3072 sc1
    s_waitcnt vmcnt(1)
    v_cmp_eq_u32 vcc, -1, v24
    s_cbranch_vccnz ploopH_19_rm_2
    s_branch ploopH_19_rm_2ok
ploopH_19_rm_2_g:
    s_mov_b32 s22, 0
    s_waitcnt vmcnt(0)
    s_branch ploopH_19_rm_2ok
ploopH_19_rm_3:
    s_sub_u32 s22, s22, 1
    s_cbranch_scc1 ploopH_19_rm_3_g
    buffer_load_dwordx4 v[28:31], v1, s[4:7], s23 offen offset:3072 sc1
    s_waitcnt vmcnt(0)
    v_cmp_eq_u32 vcc, -1, v28
    s_cbranch_vccnz ploopH_19_rm_3
    s_branch ploopH_19_rm_3ok
ploopH_19_rm_3_g:
    s_mov_b32 s22, 0
    s_waitcnt vmcnt(0)
    s_branch ploopH_19_rm_3ok
ploopH_19_rp:
    s_sub_u32 s22, s22, 1
    s_cbranch_scc0 ploopH_19_pagain
    s_mov_b32 s22, 0
    s_branch ploopH_19_pgo
ploopH_19_tail:
    ds_read_b128 v[16:19], v6 offset:0
    ds_read_b128 v[20:23], v6 offset:256
    ds_read_b128 v[24:27], v6 offset:512
    ds_read_b128 v[28:31], v6 offset:768
    v_xor_b32 v6, 0x4000, v6
    s_waitcnt lgkmcnt(2)
    v_mfma_f32_16x16x32_bf16 v[40:43], v[12:15], v[16:19], 0
    v_mfma_f32_16x16x32_bf16 v[40:43], v[48:51], v[20:23], v[40:43]
    s_waitcnt lgkmcnt(0)
    v_mfma_f32_16x16x32_bf16 v[44:47], v[12:15], v[24:27], 0
    v_mfma_f32_16x16x32_bf16 v[44:47], v[48:51], v[28:31], v[44:47]
    s_nop 7
    v_cvt_pk_bf16_f32 v40, v40, v41
    v_cvt_pk_bf16_f32 v41, v42, v43
    v_cvt_pk_bf16_f32 v42, v44, v45
    v_cvt_pk_bf16_f32 v43, v46, v47
    s_nop 1
    v_permlane16_swap_b32 v40, v42
    v_permlane16_swap_b32 v41, v43
    s_nop 1
    v_min_u32 v40, -2, v40
    buffer_store_dwordx4 v[40:43], v7, s[4:7], s30 offen sc1
    s_add_u32 s30, s30, 65536
    s_barrier
    ds_read_b128 v[16:19], v6 offset:0
    ds_read_b128 v[20:23], v6 offset:256
    ds_read_b128 v[24:27], v6 offset:512
    ds_read_b128 v[28:31], v6 offset:768
    v_xor_b32 v6, 0x4000, v6
    s_waitcnt lgkmcnt(2)
    v_mfma_f32_16x16x32_bf16 v[40:43], v[12:15], v[16:19], 0
    v_mfma_f32_16x16x32_bf16 v[40:43], v[48:51], v[20:23], v[40:43]
    s_waitcnt lgkmcnt(0)
    v_mfma_f32_16x16x32_bf16 v[44:47], v[12:15], v[24:27], 0
    v_mfma_f32_16x16x32_bf16 v[44:47], v[48:51], v[28:31], v[44:47]
    s_nop 7
    v_cvt_pk_bf16_f32 v40, v40, v41
    v_cvt_pk_bf16_f32 v41, v42, v43
    v_cvt_pk_bf16_f32 v42, v44, v45
    v_cvt_pk_bf16_f32 v43, v46, v47
    s_nop 1
    v_permlane16_swap_b32 v40, v42
    v_permlane16_swap_b32 v41, v43
    s_nop 1
    v_min_u32 v40, -2, v40
    buffer_store_dwordx4 v[40:43], v7, s[4:7], s30 offen sc1
    s_add_u32 s30, s30, 65536
    s_branch k_end
ch_p_slow:
    v_mov_b32 v32, 0
    v_mov_b32 v33, 0
    v_mov_b32 v34, 0
    v_mov_b32 v35, 0
    v_mov_b32 v36, 0
    v_mov_b32 v37, 0
    v_mov_b32 v38, 0
    v_mov_b32 v39, 0
    v_mov_b32 v40, 0
    v_mov_b32 v41, 0
    v_mov_b32 v42, 0
    v_mov_b32 v43, 0
    v_mov_b32 v44, 0
    v_mov_b32 v45, 0
    v_mov_b32 v46, 0
    v_mov_b32 v47, 0
    v_mov_b32 v48, 0
    v_mov_b32 v49, 0
    v_mov_b32 v50, 0
    v_mov_b32 v51, 0
    v_mov_b32 v52, 0
    v_mov_b32 v53, 0
    v_mov_b32 v54, 0
    v_mov_b32 v55, 0
    v_mov_b32 v59, 0
    s_nop 1
    s_branch ploopL_30_nc
.p2align 6
    s_nop 0
    s_nop 0
    s_nop 0
    s_nop 0
    s_nop 0
    s_nop 0
    s_nop 0
    s_nop 0
    s_nop 0
    s_nop 0
    s_nop 0
ploopL_30:
    v_mov_b32 v32, 0
    v_mov_b32 v33, 0
    v_mov_b32 v34, 0
    v_mov_b32 v35, 0
    v_mov_b32 v36, 0
    v_mov_b32 v37, 0
    v_mov_b32 v38, 0
    v_mov_b32 v39, 0
    v_mov_b32 v40, 0
    v_mov_b32 v41, 0
    v_mov_b32 v42, 0
    v_mov_b32 v43, 0
    v_mov_b32 v44, 0
    v_mov_b32 v45, 0
    v_mov_b32 v46, 0
    v_mov_b32 v47, 0
    v_mov_b32 v48, 0
    v_mov_b32 v49, 0
    v_mov_b32 v50, 0
    v_mov_b32 v51, 0
    v_mov_b32 v52, 0
    v_mov_b32 v53, 0
    v_mov_b32 v54, 0
    v_mov_b32 v55, 0
    s_bitcmp1_b32 s29, 0
    s_cbranch_scc1 gate_31_ok
    s_add_u32 s21, s16, 1
    s_min_u32 s21, s21, 63
    s_cmp_ge_u32 s21, 16
    s_cselect_b32 s19, 12, 8
    s_and_b32 s32, s21, 4
    s_lshr_b32 s21, s21, 3
    s_lshl_b32 s21, s21, 8
    s_add_u32 s32, s32, s21
    s_add_u32 s32, s32, s35
gate_31:
    buffer_load_dword v9, off, s[4:7], s32 sc1
    s_waitcnt vmcnt(0)
    v_readfirstlane_b32 s21, v9
    s_cmp_ge_u32 s21, s19
    s_cbranch_scc1 gate_31_set
    s_sleep 8
    s_sub_u32 s22, s22, 1
    s_cbranch_scc0 gate_31
    s_mov_b32 s22, 0
gate_31_set:
    s_bitset1_b32 s29, 0
gate_31_ok:
    s_sleep 1
    buffer_load_dwordx4 v[16:19], v1, s[4:7], s23 offen offset:0 sc1
    buffer_load_dwordx4 v[20:23], v1, s[4:7], s23 offen offset:1024 sc1
    buffer_load_dwordx4 v[24:27], v1, s[4:7], s23 offen offset:2048 sc1
    buffer_load_dwordx4 v[28:31], v1, s[4:7], s23 offen offset:3072 sc1
    s_waitcnt vmcnt(3)
    v_cmp_eq_u32 vcc, -1, v16
    s_cbranch_vccnz ploopL_30_rm_0
ploopL_30_rm_0ok:
    v_smfmac_f32_16x16x64_bf16 v[32:35], v[16:19], v[64:71], v8
    v_smfmac_f32_16x16x64_bf16 v[36:39], v[16:19], v[72:79], v8
    s_waitcnt vmcnt(2)
    v_cmp_eq_u32 vcc, -1, v20
    v_smfmac_f32_16x16x64_bf16 v[40:43], v[16:19], v[80:87], v8
    v_smfmac_f32_16x16x64_bf16 v[44:47], v[16:19], v[88:95], v8
    v_smfmac_f32_16x16x64_bf16 v[48:51], v[16:19], v[96:103], v8
    v_smfmac_f32_16x16x64_bf16 v[52:55], v[16:19], v[104:111], v8
    s_cbranch_vccnz ploopL_30_rm_1
ploopL_30_rm_1ok:
    v_smfmac_f32_16x16x64_bf16 v[32:35], v[20:23], v[112:119], v8
    v_smfmac_f32_16x16x64_bf16 v[36:39], v[20:23], v[120:127], v8
    s_waitcnt vmcnt(1)
    v_cmp_eq_u32 vcc, -1, v24
    v_smfmac_f32_16x16x64_bf16 v[40:43], v[20:23], v[128:135], v8
    v_smfmac_f32_16x16x64_bf16 v[44:47], v[20:23], v[136:143], v8
    v_smfmac_f32_16x16x64_bf16 v[48:51], v[20:23], v[144:151], v8
    v_smfmac_f32_16x16x64_bf16 v[52:55], v[20:23], v[152:159], v8
    s_cbranch_vccnz ploopL_30_rm_2
ploopL_30_rm_2ok:
    v_smfmac_f32_16x16x64_bf16 v[32:35], v[24:27], v[160:167], v8
    v_smfmac_f32_16x16x64_bf16 v[36:39], v[24:27], v[168:175], v8
    s_waitcnt vmcnt(0)
    v_cmp_eq_u32 vcc, -1, v28
    v_smfmac_f32_16x16x64_bf16 v[40:43], v[24:27], v[176:183], v8
    v_smfmac_f32_16x16x64_bf16 v[44:47], v[24:27], v[184:191], v8
    v_smfmac_f32_16x16x64_bf16 v[48:51], v[24:27], v[192:199], v8
    v_smfmac_f32_16x16x64_bf16 v[52:55], v[24:27], v[200:207], v8
    s_cbranch_vccnz ploopL_30_rm_3
ploopL_30_rm_3ok:
    v_smfmac_f32_16x16x64_bf16 v[32:35], v[28:31], v[208:215], v8
    ds_write_b32 v63, v59 offset:32
    v_smfmac_f32_16x16x64_bf16 v[36:39], v[28:31], v[216:223], v8
    v_smfmac_f32_16x16x64_bf16 v[40:43], v[28:31], v[224:231], v8
    v_smfmac_f32_16x16x64_bf16 v[44:47], v[28:31], v[232:239], v8
    v_smfmac_f32_16x16x64_bf16 v[48:51], v[28:31], v[240:247], v8
    v_smfmac_f32_16x16x64_bf16 v[52:55], v[28:31], v[248:255], v8
    s_branch ploopL_30_mmd
ploopL_30_nc:
    v_smfmac_f32_16x16x64_bf16 v[32:35], v[16:19], v[64:71], v8
    v_smfmac_f32_16x16x64_bf16 v[36:39], v[16:19], v[72:79], v8
    v_smfmac_f32_16x16x64_bf16 v[40:43], v[16:19], v[80:87], v8
    v_smfmac_f32_16x16x64_bf16 v[44:47], v[16:19], v[88:95], v8
    v_smfmac_f32_16x16x64_bf16 v[48:51], v[16:19], v[96:103], v8
    v_smfmac_f32_16x16x64_bf16 v[52:55], v[16:19], v[104:111], v8
    v_smfmac_f32_16x16x64_bf16 v[32:35], v[20:23], v[112:119], v8
    v_smfmac_f32_16x16x64_bf16 v[36:39], v[20:23], v[120:127], v8
    v_smfmac_f32_16x16x64_bf16 v[40:43], v[20:23], v[128:135], v8
    v_smfmac_f32_16x16x64_bf16 v[44:47], v[20:23], v[136:143], v8
    v_smfmac_f32_16x16x64_bf16 v[48:51], v[20:23], v[144:151], v8
    v_smfmac_f32_16x16x64_bf16 v[52:55], v[20:23], v[152:159], v8
    v_smfmac_f32_16x16x64_bf16 v[32:35], v[24:27], v[160:167], v8
    v_smfmac_f32_16x16x64_bf16 v[36:39], v[24:27], v[168:175], v8
    v_smfmac_f32_16x16x64_bf16 v[40:43], v[24:27], v[176:183], v8
    v_smfmac_f32_16x16x64_bf16 v[44:47], v[24:27], v[184:191], v8
    v_smfmac_f32_16x16x64_bf16 v[48:51], v[24:27], v[192:199], v8
    v_smfmac_f32_16x16x64_bf16 v[52:55], v[24:27], v[200:207], v8
    v_smfmac_f32_16x16x64_bf16 v[32:35], v[28:31], v[208:215], v8
    ds_write_b32 v63, v59 offset:32
    v_smfmac_f32_16x16x64_bf16 v[36:39], v[28:31], v[216:223], v8
    v_smfmac_f32_16x16x64_bf16 v[40:43], v[28:31], v[224:231], v8
    v_smfmac_f32_16x16x64_bf16 v[44:47], v[28:31], v[232:239], v8
    v_smfmac_f32_16x16x64_bf16 v[48:51], v[28:31], v[240:247], v8
    v_smfmac_f32_16x16x64_bf16 v[52:55], v[28:31], v[248:255], v8
ploopL_30_mmd:
    s_cmp_eq_u32 s3, 3
    s_nop 1
    v_add_f32 v32, v32, v34
    v_add_f32 v33, v33, v35
    ds_write2_b32 v3, v32, v33 offset0:0 offset1:40
    v_add_f32 v36, v36, v38
    v_add_f32 v37, v37, v39
    ds_write2_b32 v3, v36, v37 offset0:16 offset1:56
    v_add_f32 v40, v40, v42
    v_add_f32 v41, v41, v43
    ds_write2_b32 v61, v40, v41 offset0:0 offset1:40
    v_add_f32 v44, v44, v46
    v_add_f32 v45, v45, v47
    ds_write2_b32 v61, v44, v45 offset0:16 offset1:56
    v_add_f32 v48, v48, v50
    v_add_f32 v49, v49, v51
    ds_write2_b32 v62, v48, v49 offset0:0 offset1:40
    v_add_f32 v52, v52, v54
    v_add_f32 v53, v53, v55
    ds_write2_b32 v62, v52, v53 offset0:16 offset1:56
    s_waitcnt lgkmcnt(0)
    s_barrier
    s_cbranch_scc1 ploopL_30_sk1
    ds_read_b128 v[32:35], v4 offset:0
    ds_read_b128 v[36:39], v4 offset:3840
    ds_read_b128 v[40:43], v4 offset:7680
    ds_read_b128 v[44:47], v4 offset:11520
    s_waitcnt lgkmcnt(2)
    v_add_f32 v32, v32, v36
    v_add_f32 v33, v33, v37
    v_add_f32 v34, v34, v38
    v_add_f32 v35, v35, v39
    s_waitcnt lgkmcnt(0)
    v_add_f32 v40, v40, v44
    v_add_f32 v41, v41, v45
    v_add_f32 v42, v42, v46
    v_add_f32 v43, v43, v47
    v_add_f32 v32, v32, v40
    v_add_f32 v33, v33, v41
    v_add_f32 v34, v34, v42
    v_add_f32 v35, v35, v43
    v_cvt_pk_bf16_f32 v56, v32, v33
    v_cvt_pk_bf16_f32 v57, v34, v35
    v_min_u32 v56, -2, v56
    buffer_store_dwordx2 v[56:57], v2, s[4:7], s26 offen sc1
    s_add_u32 s27, s16, 2
    s_and_b32 s27, s27, 3
    s_lshl_b32 s27, s27, 18
    s_add_u32 s27, s27, s38
    buffer_store_dwordx2 v[10:11], v2, s[4:7], s27 offen sc1
ploopL_30_sk1:
    s_setprio 0
    s_add_u32 s25, s16, 3
    s_and_b32 s25, s25, 3
    s_lshl_b32 s25, s25, 16
    s_add_u32 s25, s25, s37
    v_mov_b32 v44, -1
    v_mov_b32 v45, -1
    v_mov_b32 v46, -1
    v_mov_b32 v47, -1
    s_mov_b64 exec, s[56:57]
    buffer_store_dwordx4 v[44:47], v5, s[4:7], s25 offen sc1
    s_mov_b64 exec, -1
    s_and_b32 s28, s16, 3
    s_lshl_b32 s28, s28, 18
    s_add_u32 s28, s28, s39
    s_add_u32 s24, s16, 1
    s_and_b32 s24, s24, 3
    s_lshl_b32 s24, s24, 16
    s_add_u32 s24, s24, s37
    s_add_u32 s23, s16, 1
    s_and_b32 s23, s23, 3
    s_lshl_b32 s23, s23, 16
    s_add_u32 s23, s23, s36
    s_add_u32 s26, s16, 1
    s_and_b32 s26, s26, 3
    s_lshl_b32 s26, s26, 18
    s_add_u32 s26, s26, s38
    s_cmp_eq_u32 s59, 0
    s_cbranch_scc1 ofl_32
    s_lshl_b32 s17, s3, 10
    v_add_u32 v39, s17, v1
    ds_read_b128 v[40:43], v39 offset:32768
ofl_32:
    s_cmp_ge_u32 s16, 16
    s_cbranch_scc1 ploopL_30_nx
    v_mov_b32 v40, v2
    v_mov_b32 v42, v56
    v_mov_b32 v43, v57
    s_cmp_lg_u32 s3, 2
    s_cbranch_scc1 ploopL_30_nx
    v_and_b32 v40, 0x60, v1
    v_lshlrev_b32 v40, 2, v40
    v_lshrrev_b32 v41, 3, v1
    v_and_b32 v41, 0x70, v41
    v_or_b32 v40, v40, v41
    v_bfe_u32 v41, v1, 4, 1
    v_lshl_or_b32 v40, v41, 3, v40
    s_lshl_b32 s17, s53, 9
    s_add_u32 s17, s17, 4096
    v_add_u32 v40, s17, v40
    s_mov_b32 vcc_lo, 0x55555555
    s_mov_b32 vcc_hi, 0x55555555
    v_cndmask_b32_dpp v42, v57, v56, vcc quad_perm:[1,0,3,2] row_mask:0xf bank_mask:0xf
    s_not_b64 vcc, vcc
    v_cndmask_b32_dpp v43, v56, v57, vcc quad_perm:[1,0,3,2] row_mask:0xf bank_mask:0xf
ploopL_30_nx:
    v_readfirstlane_b32 s21, v60
    s_lshr_b32 s29, s29, 1
    s_cmp_ge_u32 s21, s58
    s_cselect_b32 s21, 2, 0
    s_or_b32 s29, s29, s21
    s_cmp_eq_u32 s3, 3
    s_cselect_b32 s20, s21, 0
    s_add_u32 s21, s16, 4
    s_min_u32 s21, s21, 63
    s_cmp_ge_u32 s21, 16
    s_cselect_b32 s58, 12, 8
    s_and_b32 s33, s21, 4
    s_lshr_b32 s21, s21, 3
    s_lshl_b32 s21, s21, 8
    s_add_u32 s33, s33, s21
    s_add_u32 s33, s33, s35
    s_setprio 3
ploopL_30_fs:
    ds_read_b128 v[32:35], v58 offset:0
    s_waitcnt lgkmcnt(0)
    v_min3_i32 v32, v32, v33, v34
    v_min_i32 v32, v32, v35
    s_nop 0
    v_readfirstlane_b32 s18, v32
    s_cmp_ge_i32 s18, s16
    s_cbranch_scc1 ploopL_30_fsok
    s_sleep 1
    s_branch ploopL_30_fs
ploopL_30_fsok:
    s_setprio 1
    s_sleep 4
ploopL_30_nofd:
    s_cmp_eq_u32 s20, 0
    s_cbranch_scc1 ploopL_30_nt
    s_cmp_ge_u32 s16, 13
    s_cselect_b32 exec_hi, 0xffff, 0
    buffer_load_dword v60, v0, s[4:7], s31 offen sc1
    s_mov_b32 exec_hi, -1
ploopL_30_nt:
    s_cmp_eq_u32 s59, 0
    s_cbranch_scc1 ofl_33
    s_lshl_b32 s17, s16, 18
    s_add_u32 s17, s17, s60
    buffer_store_dwordx4 v[40:43], v1, s[4:7], s17 offen sc1
    s_mov_b32 s59, 0
ofl_33:
    s_lshr_b32 s17, s34, 3
    s_xor_b32 s17, s17, s16
    s_andn2_b32 s59, 1, s17
    s_cmp_ge_u32 s16, 16
    s_cselect_b32 s59, s59, 0
    s_cbranch_scc1 ploopL_30_nx2
    s_cmp_eq_u32 s3, 3
    s_cbranch_scc1 ploopL_30_nx2
    buffer_store_dwordx2 v[42:43], v40, s[4:7], s55 offen sc1
ploopL_30_nx2:
    s_add_u32 s55, s55, 262144
    s_or_b32 s17, s13, s3
    s_cmp_lg_u32 s17, 0
    s_cbranch_scc1 ploopL_30_npg
    s_sub_u32 s21, s16, 1
    s_cbranch_scc1 ploopL_30_npg
    s_sub_u32 s17, s21, 1
    s_and_b32 s17, s17, 3
    s_cmp_ge_u32 s16, 58
    s_cselect_b32 s17, 0, s17
    s_cmp_lg_u32 s17, 0
    s_cbranch_scc1 ploopL_30_npg
    s_lshl_b32 s17, s12, 7
    s_add_u32 s17, s17, 218112000
    v_mov_b32 v9, s21
    s_mov_b64 exec, 1
    buffer_store_dword v9, off, s[4:7], s17 sc1
    s_mov_b64 exec, -1
ploopL_30_npg:
    s_barrier
    buffer_load_dword v60, off, s[4:7], s33 sc1
    s_add_u32 s16, s16, 1
    v_mov_b32 v59, s16
    s_add_u32 s41, s41, 262144
    s_add_u32 s31, s31, 262144
    s_setprio 3
    s_sleep 13
ploopL_30_pagain:
    buffer_load_dwordx4 v[16:19], v1, s[4:7], s28 offen offset:0 sc1
    buffer_load_dwordx4 v[20:23], v1, s[4:7], s28 offen offset:1024 sc1
    s_waitcnt vmcnt(1)
    v_mfma_f32_16x16x32_bf16 v[32:35], v[12:15], v[16:19], 0
    s_waitcnt vmcnt(0)
    v_mfma_f32_16x16x32_bf16 v[32:35], v[12:15], v[20:23], v[32:35]
    v_max_u32 v9, v16, v20
    v_cmp_eq_u32 vcc, -1, v9
    s_cbranch_vccnz ploopL_30_rp
ploopL_30_pgo:
    s_cmp_lt_u32 s16, 48
    s_nop 3
    v_cvt_pk_bf16_f32 v52, v32, v33
    v_cvt_pk_bf16_f32 v53, v34, v35
    s_nop 0
    v_permlane16_swap_b32 v52, v54
    v_permlane16_swap_b32 v53, v55
    s_mov_b64 exec, s[56:57]
    v_min_u32 v52, -2, v52
    buffer_store_dwordx4 v[52:55], v5, s[4:7], s24 offen sc1
    s_mov_b64 exec, -1
    ds_write_b32 v63, v59 offset:16
    s_cbranch_scc1 ploopL_30
    s_branch ploopH_29
ploopL_30_rm_0:
    s_sub_u32 s22, s22, 1
    s_cbranch_scc1 ploopL_30_rm_0_g
    buffer_load_dwordx4 v[16:19], v1, s[4:7], s23 offen offset:0 sc1
    buffer_load_dwordx4 v[20:23], v1, s[4:7], s23 offen offset:1024 sc1
    buffer_load_dwordx4 v[24:27], v1, s[4:7], s23 offen offset:2048 sc1
    buffer_load_dwordx4 v[28:31], v1, s[4:7], s23 offen offset:3072 sc1
    s_waitcnt vmcnt(3)
    v_cmp_eq_u32 vcc, -1, v16
    s_cbranch_vccnz ploopL_30_rm_0
    s_branch ploopL_30_rm_0ok
ploopL_30_rm_0_g:
    s_mov_b32 s22, 0
    s_waitcnt vmcnt(0)
    s_branch ploopL_30_rm_0ok
ploopL_30_rm_1:
    s_sub_u32 s22, s22, 1
    s_cbranch_scc1 ploopL_30_rm_1_g
    buffer_load_dwordx4 v[20:23], v1, s[4:7], s23 offen offset:1024 sc1
    buffer_load_dwordx4 v[24:27], v1, s[4:7], s23 offen offset:2048 sc1
    buffer_load_dwordx4 v[28:31], v1, s[4:7], s23 offen offset:3072 sc1
    s_waitcnt vmcnt(2)
    v_cmp_eq_u32 vcc, -1, v20
    s_cbranch_vccnz ploopL_30_rm_1
    s_branch ploopL_30_rm_1ok
ploopL_30_rm_1_g:
    s_mov_b32 s22, 0
    s_waitcnt vmcnt(0)
    s_branch ploopL_30_rm_1ok
ploopL_30_rm_2:
    s_sub_u32 s22, s22, 1
    s_cbranch_scc1 ploopL_30_rm_2_g
    buffer_load_dwordx4 v[24:27], v1, s[4:7], s23 offen offset:2048 sc1
    buffer_load_dwordx4 v[28:31], v1, s[4:7], s23 offen offset:3072 sc1
    s_waitcnt vmcnt(1)
    v_cmp_eq_u32 vcc, -1, v24
    s_cbranch_vccnz ploopL_30_rm_2
    s_branch ploopL_30_rm_2ok
ploopL_30_rm_2_g:
    s_mov_b32 s22, 0
    s_waitcnt vmcnt(0)
    s_branch ploopL_30_rm_2ok
ploopL_30_rm_3:
    s_sub_u32 s22, s22, 1
    s_cbranch_scc1 ploopL_30_rm_3_g
    buffer_load_dwordx4 v[28:31], v1, s[4:7], s23 offen offset:3072 sc1
    s_waitcnt vmcnt(0)
    v_cmp_eq_u32 vcc, -1, v28
    s_cbranch_vccnz ploopL_30_rm_3
    s_branch ploopL_30_rm_3ok
ploopL_30_rm_3_g:
    s_mov_b32 s22, 0
    s_waitcnt vmcnt(0)
    s_branch ploopL_30_rm_3ok
ploopL_30_rp:
    s_sub_u32 s22, s22, 1
    s_cbranch_scc0 ploopL_30_pagain
    s_mov_b32 s22, 0
    s_branch ploopL_30_pgo
.p2align 6
    s_nop 0
    s_nop 0
    s_nop 0
    s_nop 0
    s_nop 0
    s_nop 0
    s_nop 0
    s_nop 0
    s_nop 0
    s_nop 0
    s_nop 0
ploopH_29:
    v_mov_b32 v32, 0
    v_mov_b32 v33, 0
    v_mov_b32 v34, 0
    v_mov_b32 v35, 0
    v_mov_b32 v36, 0
    v_mov_b32 v37, 0
    v_mov_b32 v38, 0
    v_mov_b32 v39, 0
    v_mov_b32 v40, 0
    v_mov_b32 v41, 0
    v_mov_b32 v42, 0
    v_mov_b32 v43, 0
    v_mov_b32 v44, 0
    v_mov_b32 v45, 0
    v_mov_b32 v46, 0
    v_mov_b32 v47, 0
    v_mov_b32 v48, 0
    v_mov_b32 v49, 0
    v_mov_b32 v50, 0
    v_mov_b32 v51, 0
    v_mov_b32 v52, 0
    v_mov_b32 v53, 0
    v_mov_b32 v54, 0
    v_mov_b32 v55, 0
    s_sleep 1
    buffer_load_dwordx4 v[16:19], v1, s[4:7], s23 offen offset:0 sc1
    buffer_load_dwordx4 v[20:23], v1, s[4:7], s23 offen offset:1024 sc1
    buffer_load_dwordx4 v[24:27], v1, s[4:7], s23 offen offset:2048 sc1
    buffer_load_dwordx4 v[28:31], v1, s[4:7], s23 offen offset:3072 sc1
    s_waitcnt vmcnt(3)
    v_cmp_eq_u32 vcc, -1, v16
    s_cbranch_vccnz ploopH_29_rm_0
ploopH_29_rm_0ok:
    v_smfmac_f32_16x16x64_bf16 v[32:35], v[16:19], v[64:71], v8
    v_smfmac_f32_16x16x64_bf16 v[36:39], v[16:19], v[72:79], v8
    s_waitcnt vmcnt(2)
    v_cmp_eq_u32 vcc, -1, v20
    v_smfmac_f32_16x16x64_bf16 v[40:43], v[16:19], v[80:87], v8
    v_smfmac_f32_16x16x64_bf16 v[44:47], v[16:19], v[88:95], v8
    v_smfmac_f32_16x16x64_bf16 v[48:51], v[16:19], v[96:103], v8
    v_smfmac_f32_16x16x64_bf16 v[52:55], v[16:19], v[104:111], v8
    s_cbranch_vccnz ploopH_29_rm_1
ploopH_29_rm_1ok:
    v_smfmac_f32_16x16x64_bf16 v[32:35], v[20:23], v[112:119], v8
    v_smfmac_f32_16x16x64_bf16 v[36:39], v[20:23], v[120:127], v8
    s_waitcnt vmcnt(1)
    v_cmp_eq_u32 vcc, -1, v24
    v_smfmac_f32_16x16x64_bf16 v[40:43], v[20:23], v[128:135], v8
    v_smfmac_f32_16x16x64_bf16 v[44:47], v[20:23], v[136:143], v8
    v_smfmac_f32_16x16x64_bf16 v[48:51], v[20:23], v[144:151], v8
    v_smfmac_f32_16x16x64_bf16 v[52:55], v[20:23], v[152:159], v8
    s_cbranch_vccnz ploopH_29_rm_2
ploopH_29_rm_2ok:
    v_smfmac_f32_16x16x64_bf16 v[32:35], v[24:27], v[160:167], v8
    v_smfmac_f32_16x16x64_bf16 v[36:39], v[24:27], v[168:175], v8
    s_waitcnt vmcnt(0)
    v_cmp_eq_u32 vcc, -1, v28
    v_smfmac_f32_16x16x64_bf16 v[40:43], v[24:27], v[176:183], v8
    v_smfmac_f32_16x16x64_bf16 v[44:47], v[24:27], v[184:191], v8
    v_smfmac_f32_16x16x64_bf16 v[48:51], v[24:27], v[192:199], v8
    v_smfmac_f32_16x16x64_bf16 v[52:55], v[24:27], v[200:207], v8
    s_cbranch_vccnz ploopH_29_rm_3
ploopH_29_rm_3ok:
    v_smfmac_f32_16x16x64_bf16 v[32:35], v[28:31], v[208:215], v8
    ds_write_b32 v63, v59 offset:32
    v_smfmac_f32_16x16x64_bf16 v[36:39], v[28:31], v[216:223], v8
    v_smfmac_f32_16x16x64_bf16 v[40:43], v[28:31], v[224:231], v8
    v_smfmac_f32_16x16x64_bf16 v[44:47], v[28:31], v[232:239], v8
    v_smfmac_f32_16x16x64_bf16 v[48:51], v[28:31], v[240:247], v8
    v_smfmac_f32_16x16x64_bf16 v[52:55], v[28:31], v[248:255], v8
    s_cmp_eq_u32 s3, 3
    s_nop 1
    v_add_f32 v32, v32, v34
    v_add_f32 v33, v33, v35
    ds_write2_b32 v3, v32, v33 offset0:0 offset1:40
    v_add_f32 v36, v36, v38
    v_add_f32 v37, v37, v39
    ds_write2_b32 v3, v36, v37 offset0:16 offset1:56
    v_add_f32 v40, v40, v42
    v_add_f32 v41, v41, v43
    ds_write2_b32 v61, v40, v41 offset0:0 offset1:40
    v_add_f32 v44, v44, v46
    v_add_f32 v45, v45, v47
    ds_write2_b32 v61, v44, v45 offset0:16 offset1:56
    v_add_f32 v48, v48, v50
    v_add_f32 v49, v49, v51
    ds_write2_b32 v62, v48, v49 offset0:0 offset1:40
    v_add_f32 v52, v52, v54
    v_add_f32 v53, v53, v55
    ds_write2_b32 v62, v52, v53 offset0:16 offset1:56
    s_waitcnt lgkmcnt(0)
    s_barrier
    s_cbranch_scc1 ploopH_29_sk1
    ds_read_b128 v[32:35], v4 offset:0
    ds_read_b128 v[36:39], v4 offset:3840
    ds_read_b128 v[40:43], v4 offset:7680
    ds_read_b128 v[44:47], v4 offset:11520
    s_waitcnt lgkmcnt(2)
    v_add_f32 v32, v32, v36
    v_add_f32 v33, v33, v37
    v_add_f32 v34, v34, v38
    v_add_f32 v35, v35, v39
    s_waitcnt lgkmcnt(0)
    v_add_f32 v40, v40, v44
    v_add_f32 v41, v41, v45
    v_add_f32 v42, v42, v46
    v_add_f32 v43, v43, v47
    v_add_f32 v32, v32, v40
    v_add_f32 v33, v33, v41
    v_add_f32 v34, v34, v42
    v_add_f32 v35, v35, v43
    v_cvt_pk_bf16_f32 v56, v32, v33
    v_cvt_pk_bf16_f32 v57, v34, v35
    v_min_u32 v56, -2, v56
    buffer_store_dwordx2 v[56:57], v2, s[4:7], s26 offen sc1
    s_add_u32 s27, s16, 2
    s_and_b32 s27, s27, 3
    s_lshl_b32 s27, s27, 18
    s_add_u32 s27, s27, s38
    buffer_store_dwordx2 v[10:11], v2, s[4:7], s27 offen sc1
ploopH_29_sk1:
    s_setprio 0
    s_add_u32 s25, s16, 3
    s_and_b32 s25, s25, 3
    s_lshl_b32 s25, s25, 16
    s_add_u32 s25, s25, s37
    v_mov_b32 v44, -1
    v_mov_b32 v45, -1
    v_mov_b32 v46, -1
    v_mov_b32 v47, -1
    s_mov_b64 exec, s[56:57]
    buffer_store_dwordx4 v[44:47], v5, s[4:7], s25 offen sc1
    s_mov_b64 exec, -1
    v_mov_b32_dpp v48, v12 row_ror:8 row_mask:0xf bank_mask:0xf
    v_mov_b32_dpp v49, v13 row_ror:8 row_mask:0xf bank_mask:0xf
    v_mov_b32_dpp v50, v14 row_ror:8 row_mask:0xf bank_mask:0xf
    v_mov_b32_dpp v51, v15 row_ror:8 row_mask:0xf bank_mask:0xf
    s_and_b32 s28, s16, 3
    s_lshl_b32 s28, s28, 18
    s_add_u32 s28, s28, s39
    s_add_u32 s24, s16, 1
    s_and_b32 s24, s24, 3
    s_lshl_b32 s24, s24, 16
    s_add_u32 s24, s24, s37
    s_add_u32 s23, s16, 1
    s_and_b32 s23, s23, 3
    s_lshl_b32 s23, s23, 16
    s_add_u32 s23, s23, s36
    s_add_u32 s26, s16, 1
    s_and_b32 s26, s26, 3
    s_lshl_b32 s26, s26, 18
    s_add_u32 s26, s26, s38
    s_cmp_eq_u32 s59, 0
    s_cbranch_scc1 ofl_34
    s_lshl_b32 s17, s3, 10
    v_add_u32 v39, s17, v1
    ds_read_b128 v[40:43], v39 offset:32768
ofl_34:
    s_cmp_eq_u32 s16, 63
    s_cbranch_scc1 ploopH_29_tail
    s_cmp_eq_u32 s30, s54
    s_cbranch_scc1 pnoseg_35
    ds_read_b128 v[16:19], v6 offset:0
    ds_read_b128 v[20:23], v6 offset:256
    ds_read_b128 v[24:27], v6 offset:512
    ds_read_b128 v[28:31], v6 offset:768
    v_xor_b32 v6, 0x4000, v6
    s_waitcnt lgkmcnt(2)
    v_mfma_f32_16x16x32_bf16 v[40:43], v[12:15], v[16:19], 0
    v_mfma_f32_16x16x32_bf16 v[40:43], v[48:51], v[20:23], v[40:43]
    s_waitcnt lgkmcnt(0)
    v_mfma_f32_16x16x32_bf16 v[44:47], v[12:15], v[24:27], 0
    v_mfma_f32_16x16x32_bf16 v[44:47], v[48:51], v[28:31], v[44:47]
    s_nop 7
    v_cvt_pk_bf16_f32 v40, v40, v41
    v_cvt_pk_bf16_f32 v41, v42, v43
    v_cvt_pk_bf16_f32 v42, v44, v45
    v_cvt_pk_bf16_f32 v43, v46, v47
    s_nop 1
    v_permlane16_swap_b32 v40, v42
    v_permlane16_swap_b32 v41, v43
    s_nop 1
    v_min_u32 v40, -2, v40
pnoseg_35:
    s_bitcmp1_b32 s29, 0
    s_cbranch_scc1 gate_36_ok
    s_add_u32 s21, s16, 1
    s_min_u32 s21, s21, 63
    s_cmp_ge_u32 s21, 16
    s_cselect_b32 s19, 12, 8
    s_and_b32 s32, s21, 4
    s_lshr_b32 s21, s21, 3
    s_lshl_b32 s21, s21, 8
    s_add_u32 s32, s32, s21
    s_add_u32 s32, s32, s35
gate_36:
    buffer_load_dword v9, off, s[4:7], s32 sc1
    s_waitcnt vmcnt(0)
    v_readfirstlane_b32 s21, v9
    s_cmp_ge_u32 s21, s19
    s_cbranch_scc1 gate_36_set
    s_sleep 8
    s_sub_u32 s22, s22, 1
    s_cbranch_scc0 gate_36
    s_mov_b32 s22, 0
gate_36_set:
    s_bitset1_b32 s29, 0
gate_36_ok:
    v_readfirstlane_b32 s21, v60
    s_lshr_b32 s29, s29, 1
    s_cmp_ge_u32 s21, s58
    s_cselect_b32 s21, 2, 0
    s_or_b32 s29, s29, s21
    s_cmp_eq_u32 s3, 3
    s_cselect_b32 s20, s21, 0
    s_add_u32 s21, s16, 4
    s_min_u32 s21, s21, 63
    s_cmp_ge_u32 s21, 16
    s_cselect_b32 s58, 12, 8
    s_and_b32 s33, s21, 4
    s_lshr_b32 s21, s21, 3
    s_lshl_b32 s21, s21, 8
    s_add_u32 s33, s33, s21
    s_add_u32 s33, s33, s35
    s_setprio 3
ploopH_29_fs:
    ds_read_b128 v[32:35], v58 offset:0
    s_waitcnt lgkmcnt(0)
    v_min3_i32 v32, v32, v33, v34
    v_min_i32 v32, v32, v35
    s_nop 0
    v_readfirstlane_b32 s18, v32
    s_cmp_ge_i32 s18, s16
    s_cbranch_scc1 ploopH_29_fsok
    s_sleep 1
    s_branch ploopH_29_fs
ploopH_29_fsok:
    s_setprio 1
    s_add_u32 m0, s42, 8192
    s_add_u32 s17, s41, 37748736
    buffer_load_dwordx4 v1, s[4:7], s17 offen offset:0 sc1 lds
    buffer_load_dwordx4 v1, s[4:7], s17 offen offset:1024 sc1 lds
    buffer_load_dwordx4 v1, s[4:7], s17 offen offset:2048 sc1 lds
    buffer_load_dwordx4 v1, s[4:7], s17 offen offset:3072 sc1 lds
    s_add_u32 m0, s42, 12288
    s_add_u32 s17, s41, 37879808
    buffer_load_dwordx4 v1, s[4:7], s17 offen offset:0 sc1 lds
    buffer_load_dwordx4 v1, s[4:7], s17 offen offset:1024 sc1 lds
    buffer_load_dwordx4 v1, s[4:7], s17 offen offset:2048 sc1 lds
    buffer_load_dwordx4 v1, s[4:7], s17 offen offset:3072 sc1 lds
    s_cmp_eq_u32 s20, 0
    s_cbranch_scc1 ploopH_29_nt
    s_mov_b32 exec_hi, 0xffff
    buffer_load_dword v60, v0, s[4:7], s31 offen sc1
    s_mov_b32 exec_hi, -1
ploopH_29_nt:
    s_cmp_eq_u32 s59, 0
    s_cbranch_scc1 ofl_37
    s_lshl_b32 s17, s16, 18
    s_add_u32 s17, s17, s60
    buffer_store_dwordx4 v[40:43], v1, s[4:7], s17 offen sc1
    s_mov_b32 s59, 0
ofl_37:
    s_cmp_eq_u32 s30, s54
    s_cbranch_scc1 pnoseg_38
    buffer_store_dwordx4 v[40:43], v7, s[4:7], s30 offen sc1
    s_add_u32 s30, s30, 65536
pnoseg_38:
    s_or_b32 s17, s13, s3
    s_cmp_lg_u32 s17, 0
    s_cbranch_scc1 ploopH_29_npg
    s_sub_u32 s21, s16, 1
    s_cbranch_scc1 ploopH_29_npg
    s_sub_u32 s17, s21, 1
    s_and_b32 s17, s17, 3
    s_cmp_ge_u32 s16, 58
    s_cselect_b32 s17, 0, s17
    s_cmp_lg_u32 s17, 0
    s_cbranch_scc1 ploopH_29_npg
    s_lshl_b32 s17, s12, 7
    s_add_u32 s17, s17, 218112000
    v_mov_b32 v9, s21
    s_mov_b64 exec, 1
    buffer_store_dword v9, off, s[4:7], s17 sc1
    s_mov_b64 exec, -1
ploopH_29_npg:
    s_barrier
    buffer_load_dword v60, off, s[4:7], s33 sc1
    s_add_u32 s16, s16, 1
    v_mov_b32 v59, s16
    s_add_u32 s41, s41, 262144
    s_add_u32 s31, s31, 262144
    s_mov_b32 s54, 0
    s_setprio 3
    s_sleep 13
ploopH_29_pagain:
    buffer_load_dwordx4 v[16:19], v1, s[4:7], s28 offen offset:0 sc1
    buffer_load_dwordx4 v[20:23], v1, s[4:7], s28 offen offset:1024 sc1
    s_waitcnt vmcnt(1)
    v_mfma_f32_16x16x32_bf16 v[32:35], v[12:15], v[16:19], 0
    s_waitcnt vmcnt(0)
    v_mfma_f32_16x16x32_bf16 v[32:35], v[12:15], v[20:23], v[32:35]
    v_max_u32 v9, v16, v20
    v_cmp_eq_u32 vcc, -1, v9
    s_cbranch_vccnz ploopH_29_rp
ploopH_29_pgo:
    s_nop 4
    v_cvt_pk_bf16_f32 v52, v32, v33
    v_cvt_pk_bf16_f32 v53, v34, v35
    s_nop 0
    v_permlane16_swap_b32 v52, v54
    v_permlane16_swap_b32 v53, v55
    s_mov_b64 exec, s[56:57]
    v_min_u32 v52, -2, v52
    buffer_store_dwordx4 v[52:55], v5, s[4:7], s24 offen sc1
    s_mov_b64 exec, -1
    ds_write_b32 v63, v59 offset:16
    s_branch ploopH_29
ploopH_29_rm_0:
    s_sub_u32 s22, s22, 1
    s_cbranch_scc1 ploopH_29_rm_0_g
    buffer_load_dwordx4 v[16:19], v1, s[4:7], s23 offen offset:0 sc1
    buffer_load_dwordx4 v[20:23], v1, s[4:7], s23 offen offset:1024 sc1
    buffer_load_dwordx4 v[24:27], v1, s[4:7], s23 offen offset:2048 sc1
    buffer_load_dwordx4 v[28:31], v1, s[4:7], s23 offen offset:3072 sc1
    s_waitcnt vmcnt(3)
    v_cmp_eq_u32 vcc, -1, v16
    s_cbranch_vccnz ploopH_29_rm_0
    s_branch ploopH_29_rm_0ok
ploopH_29_rm_0_g:
    s_mov_b32 s22, 0
    s_waitcnt vmcnt(0)
    s_branch ploopH_29_rm_0ok
ploopH_29_rm_1:
    s_sub_u32 s22, s22, 1
    s_cbranch_scc1 ploopH_29_rm_1_g
    buffer_load_dwordx4 v[20:23], v1, s[4:7], s23 offen offset:1024 sc1
    buffer_load_dwordx4 v[24:27], v1, s[4:7], s23 offen offset:2048 sc1
    buffer_load_dwordx4 v[28:31], v1, s[4:7], s23 offen offset:3072 sc1
    s_waitcnt vmcnt(2)
    v_cmp_eq_u32 vcc, -1, v20
    s_cbranch_vccnz ploopH_29_rm_1
    s_branch ploopH_29_rm_1ok
ploopH_29_rm_1_g:
    s_mov_b32 s22, 0
    s_waitcnt vmcnt(0)
    s_branch ploopH_29_rm_1ok
ploopH_29_rm_2:
    s_sub_u32 s22, s22, 1
    s_cbranch_scc1 ploopH_29_rm_2_g
    buffer_load_dwordx4 v[24:27], v1, s[4:7], s23 offen offset:2048 sc1
    buffer_load_dwordx4 v[28:31], v1, s[4:7], s23 offen offset:3072 sc1
    s_waitcnt vmcnt(1)
    v_cmp_eq_u32 vcc, -1, v24
    s_cbranch_vccnz ploopH_29_rm_2
    s_branch ploopH_29_rm_2ok
ploopH_29_rm_2_g:
    s_mov_b32 s22, 0
    s_waitcnt vmcnt(0)
    s_branch ploopH_29_rm_2ok
ploopH_29_rm_3:
    s_sub_u32 s22, s22, 1
    s_cbranch_scc1 ploopH_29_rm_3_g
    buffer_load_dwordx4 v[28:31], v1, s[4:7], s23 offen offset:3072 sc1
    s_waitcnt vmcnt(0)
    v_cmp_eq_u32 vcc, -1, v28
    s_cbranch_vccnz ploopH_29_rm_3
    s_branch ploopH_29_rm_3ok
ploopH_29_rm_3_g:
    s_mov_b32 s22, 0
    s_waitcnt vmcnt(0)
    s_branch ploopH_29_rm_3ok
ploopH_29_rp:
    s_sub_u32 s22, s22, 1
    s_cbranch_scc0 ploopH_29_pagain
    s_mov_b32 s22, 0
    s_branch ploopH_29_pgo
ploopH_29_tail:
    ds_read_b128 v[16:19], v6 offset:0
    ds_read_b128 v[20:23], v6 offset:256
    ds_read_b128 v[24:27], v6 offset:512
    ds_read_b128 v[28:31], v6 offset:768
    v_xor_b32 v6, 0x4000, v6
    s_waitcnt lgkmcnt(2)
    v_mfma_f32_16x16x32_bf16 v[40:43], v[12:15], v[16:19], 0
    v_mfma_f32_16x16x32_bf16 v[40:43], v[48:51], v[20:23], v[40:43]
    s_waitcnt lgkmcnt(0)
    v_mfma_f32_16x16x32_bf16 v[44:47], v[12:15], v[24:27], 0
    v_mfma_f32_16x16x32_bf16 v[44:47], v[48:51], v[28:31], v[44:47]
    s_nop 7
    v_cvt_pk_bf16_f32 v40, v40, v41
    v_cvt_pk_bf16_f32 v41, v42, v43
    v_cvt_pk_bf16_f32 v42, v44, v45
    v_cvt_pk_bf16_f32 v43, v46, v47
    s_nop 1
    v_permlane16_swap_b32 v40, v42
    v_permlane16_swap_b32 v41, v43
    s_nop 1
    v_min_u32 v40, -2, v40
    buffer_store_dwordx4 v[40:43], v7, s[4:7], s30 offen sc1
    s_add_u32 s30, s30, 65536
    s_barrier
    ds_read_b128 v[16:19], v6 offset:0
    ds_read_b128 v[20:23], v6 offset:256
    ds_read_b128 v[24:27], v6 offset:512
    ds_read_b128 v[28:31], v6 offset:768
    v_xor_b32 v6, 0x4000, v6
    s_waitcnt lgkmcnt(2)
    v_mfma_f32_16x16x32_bf16 v[40:43], v[12:15], v[16:19], 0
    v_mfma_f32_16x16x32_bf16 v[40:43], v[48:51], v[20:23], v[40:43]
    s_waitcnt lgkmcnt(0)
    v_mfma_f32_16x16x32_bf16 v[44:47], v[12:15], v[24:27], 0
    v_mfma_f32_16x16x32_bf16 v[44:47], v[48:51], v[28:31], v[44:47]
    s_nop 7
    v_cvt_pk_bf16_f32 v40, v40, v41
    v_cvt_pk_bf16_f32 v41, v42, v43
    v_cvt_pk_bf16_f32 v42, v44, v45
    v_cvt_pk_bf16_f32 v43, v46, v47
    s_nop 1
    v_permlane16_swap_b32 v40, v42
    v_permlane16_swap_b32 v41, v43
    s_nop 1
    v_min_u32 v40, -2, v40
    buffer_store_dwordx4 v[40:43], v7, s[4:7], s30 offen sc1
    s_add_u32 s30, s30, 65536
    s_branch k_end
ch_a_pro:
    s_sub_u32 s21, s3, 4
    s_lshl_b32 s15, s14, 2
    s_add_u32 s15, s15, s21
    s_lshl_b32 s38, s15, 13
    s_add_u32 s38, s38, 214958080
    s_cmp_lg_u32 s3, 7
    s_cbranch_scc1 ch_nrp
    s_mov_b32 s95, 0x10000
rp_39:
    buffer_load_dword v28, off, s[64:67], 0 offset:224 sc1
    s_waitcnt vmcnt(0)
    v_readfirstlane_b32 s96, v28
    s_cmp_lg_u32 s96, 0
    s_cbranch_scc1 rp_39_ok
    s_sleep 2
    s_sub_u32 s95, s95, 1
    s_cbranch_scc0 rp_39
    s_add_u32 s96, s97, 1
rp_39_ok:
    s_sub_u32 s96, s96, 1
    v_mov_b32 v27, 131136
    v_mov_b32 v28, s96
    ds_write_b32 v27, v28
    s_waitcnt lgkmcnt(0)
ch_nrp:
    s_barrier
    v_mov_b32 v27, 131136
    ds_read_b32 v27, v27
    s_mov_b32 s96, s97
    s_waitcnt lgkmcnt(0)
    v_readfirstlane_b32 s97, v27
    s_cmp_lg_u32 s96, s97
    s_cbranch_scc1 k_restart
    s_min_u32 s20, s21, 2
    s_lshl_b32 s18, s20, 3
    s_add_u32 s18, s18, 16
    s_load_dwordx2 s[8:9], s[0:1], s18
    s_mov_b32 s10, 8388608
    s_mov_b32 s11, 131072
    v_and_b32 v20, 63, v0
    v_lshlrev_b32 v21, 13, v20
    s_lshl_b32 s17, s34, 19
    s_lshl_b32 s18, s14, 10
    s_add_u32 s17, s17, s18
    s_waitcnt lgkmcnt(0)
    buffer_load_dword v26, v21, s[8:11], s17 offen offset:384
    v_and_b32 v20, 63, v0
    v_lshrrev_b32 v21, 4, v20
    v_bfe_u32 v22, v20, 1, 1
    v_xor_b32 v22, 1, v22
    v_lshl_add_u32 v23, v22, 2, v21
    v_bfe_u32 v22, v20, 2, 2
    v_and_b32 v24, 1, v20
    v_lshl_add_u32 v22, v22, 1, v24
    v_lshl_add_u32 v23, v23, 3, v22
    v_and_b32 v22, 7, v20
    v_lshlrev_b32 v23, 4, v23
    s_lshl_b32 s17, s21, 10
    s_add_u32 s17, s17, 16384
    v_add_u32 v160, s17, v23
    v_and_b32 v24, 15, v20
    v_lshlrev_b32 v24, 4, v24
    v_lshl_add_u32 v23, v21, 10, v24
    s_lshl_b32 s17, s21, 8
    s_add_u32 s17, s17, 16384
    v_add_u32 v161, s17, v23
    v_lshl_add_u32 v23, v21, 9, v24
    s_lshl_b32 s17, s21, 12
    s_add_u32 s17, s17, 32768
    v_add_u32 v162, s17, v23
    v_bfe_u32 v23, v20, 3, 1
    v_lshlrev_b32 v23, 10, v23
    v_lshl_add_u32 v23, v22, 4, v23
    v_lshlrev_b32 v1, 4, v20
    s_lshl_b32 s39, s34, 14
    s_lshl_b32 s17, s21, 11
    s_add_u32 s39, s39, s17
    s_lshl_b32 s17, s14, 8
    s_add_u32 s39, s39, s17
    s_add_u32 s39, s39, 209715200
    v_mov_b32 v176, -1
    v_mov_b32 v177, -1
    v_mov_b32 v178, -1
    v_mov_b32 v179, -1
    v_lshlrev_b32 v24, 4, v0
    s_lshl_b32 s17, s52, 13
    s_add_u32 s19, s17, 209711104
    s_add_u32 s17, s17, 214953984
    s_lshl_b32 s18, s52, 12
    s_add_u32 s18, s18, 213905408
    buffer_store_dwordx4 v[176:179], v24, s[4:7], s19 offen sc1
    s_add_u32 s19, s19, 4096
    buffer_store_dwordx4 v[176:179], v24, s[4:7], s19 offen sc1
    buffer_store_dwordx4 v[176:179], v24, s[4:7], s17 offen sc1
    s_add_u32 s17, s17, 4096
    buffer_store_dwordx4 v[176:179], v24, s[4:7], s17 offen sc1
    buffer_store_dwordx4 v[176:179], v24, s[4:7], s18 offen sc1
    s_and_b32 s17, s13, 7
    s_sub_u32 s18, s21, 1
    s_cmp_lt_u32 s18, 2
    s_cselect_b32 s54, s17, 1
    s_lshr_b32 s19, s52, 3
    s_lshl_b32 s19, s19, 8
    s_lshl_b32 s18, s18, 7
    s_add_u32 s19, s19, s18
    s_add_u32 s55, s19, 210763776
    s_cmp_lg_u32 s54, 0
    s_cbranch_scc1 ch_nv0
    v_lshlrev_b32 v24, 13, v20
    s_mov_b64 exec, 0xffff
    buffer_store_dword v176, v24, s[4:7], s55 offen sc1
    s_mov_b64 exec, -1
ch_nv0:
    v_mov_b32 v2, s40
    s_lshl_b32 s17, s12, 2
    s_add_u32 s17, s17, 128
    s_waitcnt vmcnt(0)
    s_barrier
    s_cmp_lg_u32 s3, 4
    s_cbranch_scc1 ch_nox
    s_mov_b64 exec, 1
    buffer_atomic_add v2, off, s[64:67], s17 sc1
    s_mov_b64 exec, -1
ch_nox:
    v_and_b32 v20, 63, v0
    v_lshlrev_b32 v0, 4, v20
    s_lshl_b32 s17, s15, 18
    s_lshl_b32 s18, s34, 7
    s_add_u32 s17, s17, s18
    s_lshl_b32 s19, s21, 13
    s_add_u32 s19, s19, 131072
    s_load_dwordx2 s[8:9], s[0:1], 40
    s_mov_b32 s10, 8388608
    s_mov_b32 s11, 131072
    v_lshrrev_b32 v21, 3, v20
    v_and_b32 v22, 7, v20
    v_lshlrev_b32 v21, 11, v21
    v_lshl_add_u32 v21, v22, 4, v21
    v_lshrrev_b32 v28, 4, v20
    v_and_b32 v29, 1, v28
    v_xor_b32 v29, 0, v29
    v_lshlrev_b32 v29, 2, v29
    v_lshl_add_u32 v29, v28, 3, v29
    v_bfe_u32 v28, v20, 2, 2
    v_add_u32 v29, v29, v28
    v_lshlrev_b32 v29, 7, v29
    v_and_b32 v28, 3, v20
    v_lshl_add_u32 v29, v28, 4, v29
    v_and_b32 v28, 1, v28
    v_xor_b32 v28, 0, v28
    v_lshl_add_u32 v24, v28, 3, v29
    v_add_u32 v24, s19, v24
    v_lshrrev_b32 v28, 4, v20
    v_and_b32 v29, 1, v28
    v_xor_b32 v29, 1, v29
    v_lshlrev_b32 v29, 2, v29
    v_lshl_add_u32 v29, v28, 3, v29
    v_bfe_u32 v28, v20, 2, 2
    v_add_u32 v29, v29, v28
    v_lshlrev_b32 v29, 7, v29
    v_and_b32 v28, 3, v20
    v_lshl_add_u32 v29, v28, 4, v29
    v_and_b32 v28, 1, v28
    v_xor_b32 v28, 0, v28
    v_lshl_add_u32 v25, v28, 3, v29
    v_add_u32 v25, s19, v25
    v_lshrrev_b32 v28, 4, v20
    v_and_b32 v29, 1, v28
    v_xor_b32 v29, 0, v29
    v_lshlrev_b32 v29, 2, v29
    v_lshl_add_u32 v29, v28, 3, v29
    v_bfe_u32 v28, v20, 2, 2
    v_add_u32 v29, v29, v28
    v_lshlrev_b32 v29, 7, v29
    v_and_b32 v28, 3, v20
    v_lshl_add_u32 v29, v28, 4, v29
    v_and_b32 v28, 1, v28
    v_xor_b32 v28, 1, v28
    v_lshl_add_u32 v26, v28, 3, v29
    v_add_u32 v26, s19, v26
    v_lshrrev_b32 v28, 4, v20
    v_and_b32 v29, 1, v28
    v_xor_b32 v29, 1, v29
    v_lshlrev_b32 v29, 2, v29
    v_lshl_add_u32 v29, v28, 3, v29
    v_bfe_u32 v28, v20, 2, 2
    v_add_u32 v29, v29, v28
    v_lshlrev_b32 v29, 7, v29
    v_and_b32 v28, 3, v20
    v_lshl_add_u32 v29, v28, 4, v29
    v_and_b32 v28, 1, v28
    v_xor_b32 v28, 1, v28
    v_lshl_add_u32 v27, v28, 3, v29
    v_add_u32 v27, s19, v27
    s_waitcnt lgkmcnt(0)
    s_add_u32 m0, s19, 0
    s_nop 0
    buffer_load_dwordx4 v21, s[8:11], s17 offen lds
    s_add_u32 s17, s17, 16384
    s_add_u32 m0, s19, 1024
    s_nop 0
    buffer_load_dwordx4 v21, s[8:11], s17 offen lds
    s_add_u32 s17, s17, 16384
    s_add_u32 m0, s19, 2048
    s_nop 0
    buffer_load_dwordx4 v21, s[8:11], s17 offen lds
    s_add_u32 s17, s17, 16384
    s_add_u32 m0, s19, 3072
    s_nop 0
    buffer_load_dwordx4 v21, s[8:11], s17 offen lds
    s_add_u32 s17, s17, 16384
    s_add_u32 m0, s19, 4096
    s_nop 0
    buffer_load_dwordx4 v21, s[8:11], s17 offen lds
    s_add_u32 s17, s17, 16384
    s_add_u32 m0, s19, 5120
    s_nop 0
    buffer_load_dwordx4 v21, s[8:11], s17 offen lds
    s_add_u32 s17, s17, 16384
    s_add_u32 m0, s19, 6144
    s_nop 0
    buffer_load_dwordx4 v21, s[8:11], s17 offen lds
    s_add_u32 s17, s17, 16384
    s_add_u32 m0, s19, 7168
    s_nop 0
    buffer_load_dwordx4 v21, s[8:11], s17 offen lds
    s_add_u32 s17, s17, 16384
    buffer_load_dwordx4 v[96:99], v21, s[8:11], s17 offen
    s_add_u32 s17, s17, 16384
    buffer_load_dwordx4 v[100:103], v21, s[8:11], s17 offen
    s_add_u32 s17, s17, 16384
    buffer_load_dwordx4 v[104:107], v21, s[8:11], s17 offen
    s_add_u32 s17, s17, 16384
    buffer_load_dwordx4 v[108:111], v21, s[8:11], s17 offen
    s_add_u32 s17, s17, 16384
    buffer_load_dwordx4 v[112:115], v21, s[8:11], s17 offen
    s_add_u32 s17, s17, 16384
    buffer_load_dwordx4 v[116:119], v21, s[8:11], s17 offen
    s_add_u32 s17, s17, 16384
    buffer_load_dwordx4 v[120:123], v21, s[8:11], s17 offen
    s_add_u32 s17, s17, 16384
    buffer_load_dwordx4 v[124:127], v21, s[8:11], s17 offen
    s_add_u32 s17, s17, 16384
    s_cmp_lg_u32 s54, 0
    s_cbranch_scc1 ch_nv1
    s_mov_b32 s58, -1
    s_mov_b32 s59, -1
    s_memtime s[60:61]
    s_add_u32 s56, s55, 0
    s_waitcnt lgkmcnt(0)
    s_load_dword s57, s[4:5], s56 glc
    s_waitcnt lgkmcnt(0)
    s_memtime s[62:63]
    s_waitcnt lgkmcnt(0)
    s_sub_u32 s57, s62, s60
    s_min_u32 s58, s58, s57
    s_memtime s[60:61]
    s_add_u32 s56, s55, 8192
    s_waitcnt lgkmcnt(0)
    s_load_dword s57, s[4:5], s56 glc
    s_waitcnt lgkmcnt(0)
    s_memtime s[62:63]
    s_waitcnt lgkmcnt(0)
    s_sub_u32 s57, s62, s60
    s_min_u32 s59, s59, s57
    s_memtime s[60:61]
    s_add_u32 s56, s55, 16384
    s_waitcnt lgkmcnt(0)
    s_load_dword s57, s[4:5], s56 glc
    s_waitcnt lgkmcnt(0)
    s_memtime s[62:63]
    s_waitcnt lgkmcnt(0)
    s_sub_u32 s57, s62, s60
    s_min_u32 s58, s58, s57
    s_memtime s[60:61]
    s_add_u32 s56, s55, 24576
    s_waitcnt lgkmcnt(0)
    s_load_dword s57, s[4:5], s56 glc
    s_waitcnt lgkmcnt(0)
    s_memtime s[62:63]
    s_waitcnt lgkmcnt(0)
    s_sub_u32 s57, s62, s60
    s_min_u32 s59, s59, s57
    s_memtime s[60:61]
    s_add_u32 s56, s55, 32768
    s_waitcnt lgkmcnt(0)
    s_load_dword s57, s[4:5], s56 glc
    s_waitcnt lgkmcnt(0)
    s_memtime s[62:63]
    s_waitcnt lgkmcnt(0)
    s_sub_u32 s57, s62, s60
    s_min_u32 s58, s58, s57
    s_memtime s[60:61]
    s_add_u32 s56, s55, 40960
    s_waitcnt lgkmcnt(0)
    s_load_dword s57, s[4:5], s56 glc
    s_waitcnt lgkmcnt(0)
    s_memtime s[62:63]
    s_waitcnt lgkmcnt(0)
    s_sub_u32 s57, s62, s60
    s_min_u32 s59, s59, s57
    s_memtime s[60:61]
    s_add_u32 s56, s55, 49152
    s_waitcnt lgkmcnt(0)
    s_load_dword s57, s[4:5], s56 glc
    s_waitcnt lgkmcnt(0)
    s_memtime s[62:63]
    s_waitcnt lgkmcnt(0)
    s_sub_u32 s57, s62, s60
    s_min_u32 s58, s58, s57
    s_memtime s[60:61]
    s_add_u32 s56, s55, 57344
    s_waitcnt lgkmcnt(0)
    s_load_dword s57, s[4:5], s56 glc
    s_waitcnt lgkmcnt(0)
    s_memtime s[62:63]
    s_waitcnt lgkmcnt(0)
    s_sub_u32 s57, s62, s60
    s_min_u32 s59, s59, s57
    s_memtime s[60:61]
    s_add_u32 s56, s55, 65536
    s_waitcnt lgkmcnt(0)
    s_load_dword s57, s[4:5], s56 glc
    s_waitcnt lgkmcnt(0)
    s_memtime s[62:63]
    s_waitcnt lgkmcnt(0)
    s_sub_u32 s57, s62, s60
    s_min_u32 s58, s58, s57
    s_memtime s[60:61]
    s_add_u32 s56, s55, 73728
    s_waitcnt lgkmcnt(0)
    s_load_dword s57, s[4:5], s56 glc
    s_waitcnt lgkmcnt(0)
    s_memtime s[62:63]
    s_waitcnt lgkmcnt(0)
    s_sub_u32 s57, s62, s60
    s_min_u32 s59, s59, s57
    s_memtime s[60:61]
    s_add_u32 s56, s55, 81920
    s_waitcnt lgkmcnt(0)
    s_load_dword s57, s[4:5], s56 glc
    s_waitcnt lgkmcnt(0)
    s_memtime s[62:63]
    s_waitcnt lgkmcnt(0)
    s_sub_u32 s57, s62, s60
    s_min_u32 s58, s58, s57
    s_memtime s[60:61]
    s_add_u32 s56, s55, 90112
    s_waitcnt lgkmcnt(0)
    s_load_dword s57, s[4:5], s56 glc
    s_waitcnt lgkmcnt(0)
    s_memtime s[62:63]
    s_waitcnt lgkmcnt(0)
    s_sub_u32 s57, s62, s60
    s_min_u32 s59, s59, s57
    s_memtime s[60:61]
    s_add_u32 s56, s55, 98304
    s_waitcnt lgkmcnt(0)
    s_load_dword s57, s[4:5], s56 glc
    s_waitcnt lgkmcnt(0)
    s_memtime s[62:63]
    s_waitcnt lgkmcnt(0)
    s_sub_u32 s57, s62, s60
    s_min_u32 s58, s58, s57
    s_memtime s[60:61]
    s_add_u32 s56, s55, 106496
    s_waitcnt lgkmcnt(0)
    s_load_dword s57, s[4:5], s56 glc
    s_waitcnt lgkmcnt(0)
    s_memtime s[62:63]
    s_waitcnt lgkmcnt(0)
    s_sub_u32 s57, s62, s60
    s_min_u32 s59, s59, s57
    s_memtime s[60:61]
    s_add_u32 s56, s55, 114688
    s_waitcnt lgkmcnt(0)
    s_load_dword s57, s[4:5], s56 glc
    s_waitcnt lgkmcnt(0)
    s_memtime s[62:63]
    s_waitcnt lgkmcnt(0)
    s_sub_u32 s57, s62, s60
    s_min_u32 s58, s58, s57
    s_memtime s[60:61]
    s_add_u32 s56, s55, 122880
    s_waitcnt lgkmcnt(0)
    s_load_dword s57, s[4:5], s56 glc
    s_waitcnt lgkmcnt(0)
    s_memtime s[62:63]
    s_waitcnt lgkmcnt(0)
    s_sub_u32 s57, s62, s60
    s_min_u32 s59, s59, s57
    s_sub_i32 s57, s58, s59
    s_min_i32 s57, s57, 400
    s_max_i32 s57, s57, -400
    s_add_u32 s57, s57, 16777616
    s_getreg_b32 s56, hwreg(HW_REG_XCC_ID)
    s_and_b32 s56, s56, 0
    v_mov_b32 v2, s57
    s_mov_b64 exec, 1
    buffer_atomic_add v2, off, s[64:67], s56 offset:160 sc1
    s_mov_b64 exec, -1
    s_waitcnt vmcnt(0)
ch_nv1:
    s_lshl_b32 s19, s21, 13
    s_add_u32 s19, s19, 131072
    v_add_u32 v30, s19, v0
    s_waitcnt vmcnt(8)
    ds_read_b64_tr_b16 v[192:193], v24 offset:0
    ds_read_b64_tr_b16 v[194:195], v25 offset:0
    ds_read_b64_tr_b16 v[208:209], v26 offset:0
    ds_read_b64_tr_b16 v[210:211], v27 offset:0
    ds_read_b64_tr_b16 v[224:225], v24 offset:64
    ds_read_b64_tr_b16 v[226:227], v25 offset:64
    ds_read_b64_tr_b16 v[240:241], v26 offset:64
    ds_read_b64_tr_b16 v[242:243], v27 offset:64
    s_waitcnt lgkmcnt(0)
    ds_read_b64_tr_b16 v[196:197], v24 offset:4096
    ds_read_b64_tr_b16 v[198:199], v25 offset:4096
    ds_read_b64_tr_b16 v[212:213], v26 offset:4096
    ds_read_b64_tr_b16 v[214:215], v27 offset:4096
    ds_read_b64_tr_b16 v[228:229], v24 offset:4160
    ds_read_b64_tr_b16 v[230:231], v25 offset:4160
    ds_read_b64_tr_b16 v[244:245], v26 offset:4160
    ds_read_b64_tr_b16 v[246:247], v27 offset:4160
    s_waitcnt lgkmcnt(0)
    s_waitcnt vmcnt(0)
    ds_write_b128 v30, v[96:99] offset:0
    ds_write_b128 v30, v[100:103] offset:1024
    ds_write_b128 v30, v[104:107] offset:2048
    ds_write_b128 v30, v[108:111] offset:3072
    ds_write_b128 v30, v[112:115] offset:4096
    ds_write_b128 v30, v[116:119] offset:5120
    ds_write_b128 v30, v[120:123] offset:6144
    ds_write_b128 v30, v[124:127] offset:7168
    s_waitcnt lgkmcnt(0)
    ds_read_b64_tr_b16 v[200:201], v24 offset:0
    ds_read_b64_tr_b16 v[202:203], v25 offset:0
    ds_read_b64_tr_b16 v[216:217], v26 offset:0
    ds_read_b64_tr_b16 v[218:219], v27 offset:0
    ds_read_b64_tr_b16 v[232:233], v24 offset:64
    ds_read_b64_tr_b16 v[234:235], v25 offset:64
    ds_read_b64_tr_b16 v[248:249], v26 offset:64
    ds_read_b64_tr_b16 v[250:251], v27 offset:64
    s_waitcnt lgkmcnt(0)
    ds_read_b64_tr_b16 v[204:205], v24 offset:4096
    ds_read_b64_tr_b16 v[206:207], v25 offset:4096
    ds_read_b64_tr_b16 v[220:221], v26 offset:4096
    ds_read_b64_tr_b16 v[222:223], v27 offset:4096
    ds_read_b64_tr_b16 v[236:237], v24 offset:4160
    ds_read_b64_tr_b16 v[238:239], v25 offset:4160
    ds_read_b64_tr_b16 v[252:253], v26 offset:4160
    ds_read_b64_tr_b16 v[254:255], v27 offset:4160
    s_waitcnt lgkmcnt(0)
    v_lshrrev_b32 v21, 4, v20
    v_and_b32 v22, 2, v20
    v_cmp_eq_u32 s[56:57], 2, v22
    v_and_b32 v23, 15, v20
    v_lshlrev_b32 v21, 2, v21
    v_mov_b32 v8, 0x44444444
    v_mov_b32 v9, 0xeeeeeeee
    v_cndmask_b32 v166, v8, v9, s[56:57]
    v_mov_b32 v8, 0x3f803f80
    v_mov_b32 v9, 0
    v_mov_b32 v10, 0
    v_mov_b32 v11, 0
    v_mov_b32 v4, 0x3f803f80
    v_mov_b32 v5, 0x3f803f80
    v_mov_b32 v6, 0x3f803f80
    v_mov_b32 v7, 0x3f803f80
    s_mov_b32 s29, 0x3e0293ee
    s_lshl_b32 s27, s13, 2
    s_add_u32 s27, s27, s21
    s_lshl_b32 s28, s12, 7
    s_add_u32 s28, s28, 218112000
    v_add_u32 v163, s42, v0
    s_lshl_b32 s17, s21, 2
    s_add_u32 s17, s17, 15872
    v_mov_b32 v164, s17
    v_mov_b32 v167, 15872
    v_and_b32 v24, 15, v20
    v_and_b32 v25, 1, v24
    v_lshlrev_b32 v25, 4, v25
    v_mov_b32 v184, 0x3f80
    v_lshlrev_b32 v25, v25, v184
    v_lshrrev_b32 v24, 1, v24
    v_cmp_eq_u32 vcc, 0, v24
    s_nop 1
    v_cndmask_b32 v184, 0, v25, vcc
    v_cmp_eq_u32 vcc, 1, v24
    s_nop 1
    v_cndmask_b32 v185, 0, v25, vcc
    v_cmp_eq_u32 vcc, 2, v24
    s_nop 1
    v_cndmask_b32 v186, 0, v25, vcc
    v_cmp_eq_u32 vcc, 3, v24
    s_nop 1
    v_cndmask_b32 v187, 0, v25, vcc
    v_lshrrev_b32 v24, 4, v20
    v_bfe_u32 v25, v20, 2, 2
    v_and_b32 v26, 1, v20
    v_lshl_add_u32 v26, v25, 1, v26
    v_lshlrev_b32 v26, 4, v26
    v_lshl_add_u32 v26, v24, 8, v26
    v_bfe_u32 v27, v20, 1, 1
    v_lshl_add_u32 v26, v27, 2, v26
    s_add_u32 s17, s42, 20480
    v_add_u32 v180, s17, v26
    v_and_b32 v26, 3, v20
    v_lshl_add_u32 v27, v24, 2, v25
    v_lshl_add_u32 v27, v26, 4, v27
    v_lshlrev_b32 v27, 4, v27
    v_add_u32 v181, s42, v27
    v_and_b32 v25, 1, v25
    v_lshl_add_u32 v25, v24, 1, v25
    v_lshl_add_u32 v25, v26, 3, v25
    v_lshlrev_b32 v25, 4, v25
    v_add_u32 v182, s17, v25
    s_bfe_u32 s17, s34, 0x20001
    s_lshr_b32 s30, s34, 3
    s_cmp_eq_u32 s17, s21
    s_cselect_b32 s30, s30, 2
    s_and_b32 s33, s34, 1
    s_lshl_b32 s33, s33, 17
    s_mov_b32 s32, 0
    v_add_u32 v24, 0, v21
    v_cmp_gt_u32 s[44:45], v24, v23
    v_add_u32 v24, 1, v21
    v_cmp_gt_u32 s[46:47], v24, v23
    v_add_u32 v24, 2, v21
    v_cmp_gt_u32 s[48:49], v24, v23
    v_add_u32 v24, 3, v21
    v_cmp_gt_u32 s[50:51], v24, v23
    s_cmp_lg_u32 s3, 4
    s_cbranch_scc1 ch_xcc_skip
    v_lshrrev_b32 v56, 2, v0
    v_add_u32 v56, 128, v56
    v_writelane_b32 v56, 0, 10
    v_mov_b32 v59, 63
    v_mov_b32 v60, 32
    v_writelane_b32 v59, 0, 8
    v_writelane_b32 v60, 0, 8
    v_writelane_b32 v59, 0, 9
    v_writelane_b32 v60, 0, 9
    v_writelane_b32 v59, -1, 10
    s_movk_i32 s17, 128
    v_writelane_b32 v60, s17, 10
    s_mov_b64 exec, 0x70f
ch_xcc:
    buffer_load_dword v57, v56, s[64:67], 0 offen sc1
    s_waitcnt vmcnt(0)
    v_and_b32 v62, v59, v57
    v_cmp_ne_u32 vcc, v62, v60
    v_readlane_b32 s18, v57, 8
    v_readlane_b32 s19, v57, 9
    s_add_u32 s17, s18, s19
    s_lshr_b32 s17, s17, 24
    s_cmp_lg_u32 s17, 32
    s_cbranch_scc1 ch_xcc_w
    s_cbranch_vccz ch_xcc_ok
ch_xcc_w:
    s_sleep 16
    s_sub_u32 s22, s22, 1
    s_cbranch_scc0 ch_xcc
    s_mov_b32 s22, 0
ch_xcc_ok:
    s_getreg_b32 s17, hwreg(HW_REG_XCC_ID)
    s_bitcmp1_b32 s17, 2
    s_cselect_b32 s18, s18, s18
    v_readlane_b32 s17, v57, s12
    s_mov_b64 exec, -1
    s_lshr_b32 s19, s18, 24
    s_mul_i32 s19, s19, 400
    s_and_b32 s18, s18, 0xffffff
    s_cmp_gt_u32 s18, s19
    s_cselect_b32 s18, 8192, 0
    v_mov_b32 v58, 15968
    v_mov_b32 v60, s17
    v_mov_b32 v61, s18
    s_barrier
    ds_write_b64 v58, v[60:61]
    s_waitcnt lgkmcnt(0)
    s_branch ch_xcc_b3
ch_xcc_skip:
    s_barrier
ch_xcc_b3:
    s_barrier
    v_mov_b32 v58, 15968
    ds_read_b64 v[60:61], v58
    v_and_b32 v23, 7, v20
    v_lshlrev_b32 v23, 7, v23
    v_bfe_u32 v24, v20, 3, 1
    v_lshl_add_u32 v23, v24, 17, v23
    v_lshrrev_b32 v24, 4, v20
    v_lshl_add_u32 v23, v24, 24, v23
    s_lshl_b32 s19, s14, 14
    s_lshl_b32 s18, s34, 10
    s_add_u32 s19, s19, s18
    s_and_b32 s18, s21, 1
    s_lshl_b32 s18, s18, 18
    s_add_u32 s19, s19, s18
    s_add_u32 s19, s19, 4456448
    s_waitcnt lgkmcnt(0)
    v_readfirstlane_b32 s17, v61
    s_add_u32 s39, s39, s17
ch_g0:
    buffer_load_dword v57, off, s[4:7], s35 sc1
    s_waitcnt vmcnt(0)
    v_readfirstlane_b32 s17, v57
    s_cmp_ge_u32 s17, 8
    s_cbranch_scc1 ch_g0b
    s_sleep 3
    s_sub_u32 s22, s22, 1
    s_cbranch_scc0 ch_g0
    s_mov_b32 s22, 0
ch_g0b:
    s_add_u32 s23, s41, 37748736
    buffer_load_dwordx4 v[128:131], v0, s[4:7], s23 offen offset:0 sc1
    buffer_load_dwordx4 v[132:135], v0, s[4:7], s23 offen offset:1024 sc1
    buffer_load_dwordx4 v[136:139], v0, s[4:7], s23 offen offset:2048 sc1
    buffer_load_dwordx4 v[140:143], v0, s[4:7], s23 offen offset:3072 sc1
    s_add_u32 s24, s41, 37879808
    buffer_load_dwordx4 v[144:147], v0, s[4:7], s24 offen offset:0 sc1
    buffer_load_dwordx4 v[148:151], v0, s[4:7], s24 offen offset:1024 sc1
    buffer_load_dwordx4 v[152:155], v0, s[4:7], s24 offen offset:2048 sc1
    buffer_load_dwordx4 v[156:159], v0, s[4:7], s24 offen offset:3072 sc1
    s_add_u32 s23, s41, 20971520
    buffer_load_dwordx4 v[96:99], v0, s[4:7], s23 offen offset:0 sc1
    buffer_load_dwordx4 v[100:103], v0, s[4:7], s23 offen offset:1024 sc1
    buffer_load_dwordx4 v[104:107], v0, s[4:7], s23 offen offset:2048 sc1
    buffer_load_dwordx4 v[108:111], v0, s[4:7], s23 offen offset:3072 sc1
    s_add_u32 s24, s41, 21102592
    buffer_load_dwordx4 v[112:115], v0, s[4:7], s24 offen offset:0 sc1
    buffer_load_dwordx4 v[116:119], v0, s[4:7], s24 offen offset:1024 sc1
    buffer_load_dwordx4 v[120:123], v0, s[4:7], s24 offen offset:2048 sc1
    buffer_load_dwordx4 v[124:127], v0, s[4:7], s24 offen offset:3072 sc1
    s_mov_b32 exec_hi, 0xffff
    buffer_load_dword v175, v23, s[4:7], s19 offen sc1
    s_mov_b32 exec_hi, -1
    v_mov_b32 v165, 0
    s_waitcnt vmcnt(1)
    ds_write_b32 v164, v165 offset:16
.p2align 6
aloopL_41:
    s_and_b32 s23, s16, 3
    s_lshl_b32 s23, s23, 18
    s_add_u32 s23, s23, s38
    s_add_u32 s24, s23, 4096
    s_and_b32 s25, s16, 3
    s_lshl_b32 s25, s25, 18
    s_add_u32 s25, s25, s39
    s_add_u32 s26, s16, 2
    s_and_b32 s26, s26, 3
    s_lshl_b32 s26, s26, 18
    s_add_u32 s26, s26, s39
    v_mov_b32 v165, s16
    s_waitcnt vmcnt(8)
    s_and_b32 s31, s16, 1
    s_cmp_lt_u32 s16, 16
    s_cselect_b32 s31, 3, s31
    s_cmp_lg_u32 s31, s30
    s_cbranch_scc1 aloopL_41_nd0
    ds_write_b128 v163, v[128:131] offset:0
    ds_write_b128 v163, v[132:135] offset:1024
    ds_write_b128 v163, v[136:139] offset:2048
    ds_write_b128 v163, v[140:143] offset:3072
    ds_write_b128 v163, v[144:147] offset:4096
    ds_write_b128 v163, v[148:151] offset:5120
    ds_write_b128 v163, v[152:155] offset:6144
    ds_write_b128 v163, v[156:159] offset:7168
aloopL_41_nd0:
    v_mfma_f32_16x16x32_bf16 v[48:51], v[128:131], v[192:195], 0
    v_mfma_f32_16x16x32_bf16 v[52:55], v[128:131], v[208:211], 0
    v_mfma_f32_16x16x32_bf16 v[56:59], v[128:131], v[224:227], 0
    v_mfma_f32_16x16x32_bf16 v[60:63], v[128:131], v[240:243], 0
    v_mfma_f32_16x16x32_bf16 v[64:67], v[144:147], v[192:195], 0
    v_mfma_f32_16x16x32_bf16 v[68:71], v[144:147], v[208:211], 0
    v_mfma_f32_16x16x32_bf16 v[72:75], v[144:147], v[224:227], 0
    v_mfma_f32_16x16x32_bf16 v[76:79], v[144:147], v[240:243], 0
    v_mfma_f32_16x16x32_bf16 v[48:51], v[132:135], v[196:199], v[48:51]
    v_mfma_f32_16x16x32_bf16 v[52:55], v[132:135], v[212:215], v[52:55]
    v_mfma_f32_16x16x32_bf16 v[56:59], v[132:135], v[228:231], v[56:59]
    v_mfma_f32_16x16x32_bf16 v[60:63], v[132:135], v[244:247], v[60:63]
    v_mfma_f32_16x16x32_bf16 v[64:67], v[148:151], v[196:199], v[64:67]
    v_mfma_f32_16x16x32_bf16 v[68:71], v[148:151], v[212:215], v[68:71]
    v_mfma_f32_16x16x32_bf16 v[72:75], v[148:151], v[228:231], v[72:75]
    v_mfma_f32_16x16x32_bf16 v[76:79], v[148:151], v[244:247], v[76:79]
    v_mfma_f32_16x16x32_bf16 v[48:51], v[136:139], v[200:203], v[48:51]
    v_mfma_f32_16x16x32_bf16 v[52:55], v[136:139], v[216:219], v[52:55]
    v_mfma_f32_16x16x32_bf16 v[56:59], v[136:139], v[232:235], v[56:59]
    v_mfma_f32_16x16x32_bf16 v[60:63], v[136:139], v[248:251], v[60:63]
    v_mfma_f32_16x16x32_bf16 v[64:67], v[152:155], v[200:203], v[64:67]
    v_mfma_f32_16x16x32_bf16 v[68:71], v[152:155], v[216:219], v[68:71]
    v_mfma_f32_16x16x32_bf16 v[72:75], v[152:155], v[232:235], v[72:75]
    v_mfma_f32_16x16x32_bf16 v[76:79], v[152:155], v[248:251], v[76:79]
    v_mfma_f32_16x16x32_bf16 v[48:51], v[140:143], v[204:207], v[48:51]
    v_mfma_f32_16x16x32_bf16 v[52:55], v[140:143], v[220:223], v[52:55]
    v_mfma_f32_16x16x32_bf16 v[56:59], v[140:143], v[236:239], v[56:59]
    v_mfma_f32_16x16x32_bf16 v[60:63], v[140:143], v[252:255], v[60:63]
    v_mfma_f32_16x16x32_bf16 v[64:67], v[156:159], v[204:207], v[64:67]
    v_mfma_f32_16x16x32_bf16 v[68:71], v[156:159], v[220:223], v[68:71]
    v_mfma_f32_16x16x32_bf16 v[72:75], v[156:159], v[236:239], v[72:75]
    v_mfma_f32_16x16x32_bf16 v[76:79], v[156:159], v[252:255], v[76:79]
    s_nop 2
    v_cvt_pk_bf16_f32 v80, v48, v49
    v_cvt_pk_bf16_f32 v81, v50, v51
    v_cvt_pk_bf16_f32 v82, v64, v65
    v_cvt_pk_bf16_f32 v83, v66, v67
    v_cvt_pk_bf16_f32 v84, v52, v53
    v_cvt_pk_bf16_f32 v85, v54, v55
    v_cvt_pk_bf16_f32 v86, v68, v69
    v_cvt_pk_bf16_f32 v87, v70, v71
    v_cvt_pk_bf16_f32 v88, v56, v57
    v_cvt_pk_bf16_f32 v89, v58, v59
    v_cvt_pk_bf16_f32 v90, v72, v73
    v_cvt_pk_bf16_f32 v91, v74, v75
    v_cvt_pk_bf16_f32 v92, v60, v61
    v_cvt_pk_bf16_f32 v93, v62, v63
    v_cvt_pk_bf16_f32 v94, v76, v77
    v_cvt_pk_bf16_f32 v95, v78, v79
    v_mov_b32 v24, 0
    v_mov_b32 v25, 0
    v_mov_b32 v26, 0
    v_mov_b32 v27, 0
    v_mov_b32 v28, 0
    v_mov_b32 v29, 0
    v_mov_b32 v30, 0
    v_mov_b32 v31, 0
    v_mov_b32 v32, 0
    v_mov_b32 v33, 0
    v_mov_b32 v34, 0
    v_mov_b32 v35, 0
    v_mov_b32 v36, 0
    v_mov_b32 v37, 0
    v_mov_b32 v38, 0
    v_mov_b32 v39, 0
    s_setprio 2
    s_add_u32 s41, s41, 262144
    s_waitcnt lgkmcnt(0)
    s_barrier
    s_cmp_lg_u32 s31, s30
    s_cbranch_scc1 aloopL_41_nd1
    s_add_u32 m0, s42, 16384
    s_add_u32 s17, s41, s33
    s_add_u32 s17, s17, 3932160
    buffer_load_dwordx4 v0, s[4:7], s17 offen offset:0 sc1 lds
    buffer_load_dwordx4 v0, s[4:7], s17 offen offset:1024 sc1 lds
    buffer_load_dwordx4 v0, s[4:7], s17 offen offset:2048 sc1 lds
    buffer_load_dwordx4 v0, s[4:7], s17 offen offset:3072 sc1 lds
aloopL_41_nd1:
    s_sleep 9
    s_waitcnt lgkmcnt(0)
    buffer_load_dwordx4 v[48:51], v0, s[4:7], s23 offen offset:0 sc1
    buffer_load_dwordx4 v[52:55], v0, s[4:7], s23 offen offset:1024 sc1
    buffer_load_dwordx4 v[56:59], v0, s[4:7], s23 offen offset:2048 sc1
    buffer_load_dwordx4 v[60:63], v0, s[4:7], s23 offen offset:3072 sc1
    s_sleep 2
    buffer_load_dwordx4 v[64:67], v0, s[4:7], s24 offen offset:0 sc1
    buffer_load_dwordx4 v[68:71], v0, s[4:7], s24 offen offset:1024 sc1
    s_waitcnt vmcnt(5)
    v_mfma_f32_16x16x32_bf16 v[12:15], v[96:99], v[48:51], 0
    v_mfma_f32_16x16x32_bf16 v[16:19], v[112:115], v[48:51], 0
    v_max_u32 v3, v48, v50
    v_cmp_eq_u32 vcc, -1, v3
    v_mfma_f32_16x16x32_bf16 v[20:23], v[48:51], v[48:51], 0
    s_cbranch_vccnz aloopL_41_rq_0
    s_waitcnt vmcnt(4)
    v_mfma_f32_16x16x32_bf16 v[12:15], v[100:103], v[52:55], v[12:15]
    v_mfma_f32_16x16x32_bf16 v[16:19], v[116:119], v[52:55], v[16:19]
    v_max_u32 v3, v52, v54
    v_cmp_eq_u32 vcc, -1, v3
    v_mfma_f32_16x16x32_bf16 v[20:23], v[52:55], v[52:55], v[20:23]
    s_cbranch_vccnz aloopL_41_rq_1
    s_waitcnt vmcnt(3)
    v_mfma_f32_16x16x32_bf16 v[12:15], v[104:107], v[56:59], v[12:15]
    v_mfma_f32_16x16x32_bf16 v[16:19], v[120:123], v[56:59], v[16:19]
    v_max_u32 v3, v56, v58
    v_cmp_eq_u32 vcc, -1, v3
    v_mfma_f32_16x16x32_bf16 v[20:23], v[56:59], v[56:59], v[20:23]
    s_cbranch_vccnz aloopL_41_rq_2
    s_waitcnt vmcnt(2)
    v_mfma_f32_16x16x32_bf16 v[12:15], v[108:111], v[60:63], v[12:15]
    v_mfma_f32_16x16x32_bf16 v[16:19], v[124:127], v[60:63], v[16:19]
    v_max_u32 v3, v60, v62
    v_cmp_eq_u32 vcc, -1, v3
    v_mfma_f32_16x16x32_bf16 v[20:23], v[60:63], v[60:63], v[20:23]
    s_cbranch_vccnz aloopL_41_rq_3
aloopL_41_sdone:
    s_nop 1
    ds_write_b32 v164, v165
    s_nop 0
    v_max3_f32 v2, v12, v13, v14
    v_max3_f32 v3, v15, v16, v17
    v_max3_f32 v2, v2, v18, v19
    v_max3_f32 v3, v3, v20, v21
    v_max_f32 v2, v2, v3
    v_mov_b32 v3, v2
    s_nop 1
    v_permlane16_swap_b32 v3, v2
    v_max_f32 v2, v2, v3
    v_mov_b32 v3, v2
    s_waitcnt vmcnt(0)
    v_max3_u32 v188, v64, v66, v68
    v_permlane32_swap_b32 v3, v2
    v_max_f32 v2, v2, v3
    v_max_u32 v188, v188, v70
    v_mul_f32 v2, s29, v2
    v_cmp_eq_u32 vcc, -1, v188
    v_fma_f32 v12, v12, s29, -v2
    v_fma_f32 v13, v13, s29, -v2
    s_cbranch_vccnz aloopL_41_rq_v
aloopL_41_vok:
    v_smfmac_f32_16x16x64_bf16 v[24:27], v[64:67], v[192:199], v166
    v_fma_f32 v14, v14, s29, -v2
    v_exp_f32 v12, v12
    v_smfmac_f32_16x16x64_bf16 v[32:35], v[64:67], v[224:231], v166
    s_add_u32 s17, s41, 37748736
    buffer_load_dwordx4 v[128:131], v0, s[4:7], s17 offen offset:0 sc1
    v_fma_f32 v15, v15, s29, -v2
    v_exp_f32 v13, v13
    v_smfmac_f32_16x16x64_bf16 v[28:31], v[64:67], v[208:215], v166
    buffer_load_dwordx4 v[132:135], v0, s[4:7], s17 offen offset:1024 sc1
    v_fma_f32 v16, v16, s29, -v2
    v_exp_f32 v14, v14
    v_smfmac_f32_16x16x64_bf16 v[36:39], v[64:67], v[240:247], v166
    buffer_load_dwordx4 v[136:139], v0, s[4:7], s17 offen offset:2048 sc1
    v_fma_f32 v17, v17, s29, -v2
    v_exp_f32 v15, v15
    v_smfmac_f32_16x16x64_bf16 v[24:27], v[68:71], v[200:207], v166
    buffer_load_dwordx4 v[140:143], v0, s[4:7], s17 offen offset:3072 sc1
    v_fma_f32 v18, v18, s29, -v2
    v_exp_f32 v16, v16
    v_smfmac_f32_16x16x64_bf16 v[32:35], v[68:71], v[232:239], v166
    s_add_u32 s18, s41, 37879808
    buffer_load_dwordx4 v[144:147], v0, s[4:7], s18 offen offset:0 sc1
    v_fma_f32 v19, v19, s29, -v2
    v_exp_f32 v17, v17
    v_smfmac_f32_16x16x64_bf16 v[28:31], v[68:71], v[216:223], v166
    buffer_load_dwordx4 v[148:151], v0, s[4:7], s18 offen offset:1024 sc1
    v_fma_f32 v20, v20, s29, -v2
    v_exp_f32 v18, v18
    v_smfmac_f32_16x16x64_bf16 v[36:39], v[68:71], v[248:255], v166
    buffer_load_dwordx4 v[152:155], v0, s[4:7], s18 offen offset:2048 sc1
    v_fma_f32 v21, v21, s29, -v2
    v_exp_f32 v19, v19
    buffer_load_dwordx4 v[156:159], v0, s[4:7], s18 offen offset:3072 sc1
    v_exp_f32 v20, v20
    v_exp_f32 v21, v21
    v_cvt_pk_bf16_f32 v12, v12, v13
    v_cvt_pk_bf16_f32 v13, v14, v15
    v_cvt_pk_bf16_f32 v14, v16, v17
    v_cvt_pk_bf16_f32 v15, v18, v19
    v_cvt_pk_bf16_f32 v20, v20, v21
    v_mov_b32 v22, 0
    v_mfma_f32_16x16x32_bf16 v[16:19], v[4:7], v[12:15], 0
    v_mov_b32 v21, v20
    v_mov_b32 v23, 0
    v_cvt_pk_bf16_f32 v40, v24, v25
    v_cvt_pk_bf16_f32 v41, v26, v27
    v_mfma_f32_16x16x32_bf16 v[16:19], v[8:11], v[20:23], v[16:19]
    v_mfma_f32_16x16x32_bf16 v[24:27], v[80:83], v[12:15], 0
    v_cvt_pk_bf16_f32 v44, v32, v33
    v_cvt_pk_bf16_f32 v45, v34, v35
    v_mfma_f32_16x16x32_bf16 v[32:35], v[88:91], v[12:15], 0
    v_cvt_pk_bf16_f32 v42, v28, v29
    v_cvt_pk_bf16_f32 v43, v30, v31
    v_mfma_f32_16x16x32_bf16 v[28:31], v[84:87], v[12:15], 0
    v_cvt_pk_bf16_f32 v46, v36, v37
    v_cvt_pk_bf16_f32 v47, v38, v39
    v_mfma_f32_16x16x32_bf16 v[36:39], v[92:95], v[12:15], 0
aloopL_41_midE:
    s_mov_b64 vcc, s[56:57]
    v_rcp_f32 v3, v16
    v_mfma_f32_16x16x32_bf16 v[24:27], v[40:43], v[20:23], v[24:27]
    v_mfma_f32_16x16x32_bf16 v[32:35], v[44:47], v[20:23], v[32:35]
    v_mfma_f32_16x16x32_bf16 v[28:31], v[42:45], v[20:23], v[28:31]
    v_mfma_f32_16x16x32_bf16 v[36:39], v[46:49], v[20:23], v[36:39]
    v_mov_b32_dpp v3, v3 quad_perm:[2,3,2,3] row_mask:0xf bank_mask:0xf
    s_nop 4
    v_cndmask_b32_dpp v24, v32, v24, vcc quad_perm:[2,3,2,3] row_mask:0xf bank_mask:0xf
    v_cndmask_b32_dpp v25, v33, v25, vcc quad_perm:[2,3,2,3] row_mask:0xf bank_mask:0xf
    v_cndmask_b32_dpp v26, v34, v26, vcc quad_perm:[2,3,2,3] row_mask:0xf bank_mask:0xf
    v_cndmask_b32_dpp v27, v35, v27, vcc quad_perm:[2,3,2,3] row_mask:0xf bank_mask:0xf
    v_cndmask_b32_dpp v28, v36, v28, vcc quad_perm:[2,3,2,3] row_mask:0xf bank_mask:0xf
    v_cndmask_b32_dpp v29, v37, v29, vcc quad_perm:[2,3,2,3] row_mask:0xf bank_mask:0xf
    v_cndmask_b32_dpp v30, v38, v30, vcc quad_perm:[2,3,2,3] row_mask:0xf bank_mask:0xf
    v_cndmask_b32_dpp v31, v39, v31, vcc quad_perm:[2,3,2,3] row_mask:0xf bank_mask:0xf
    v_mul_f32 v24, v24, v3
    v_mul_f32 v25, v25, v3
    v_mul_f32 v26, v26, v3
    v_mul_f32 v27, v27, v3
    v_mul_f32 v28, v28, v3
    v_mul_f32 v29, v29, v3
    v_mul_f32 v30, v30, v3
    v_mul_f32 v31, v31, v3
    v_cvt_pk_bf16_f32 v168, v24, v25
    v_cvt_pk_bf16_f32 v169, v26, v27
    v_cvt_pk_bf16_f32 v170, v28, v29
    v_cvt_pk_bf16_f32 v171, v30, v31
    ds_write_b128 v160, v[168:171]
    s_waitcnt lgkmcnt(0)
    s_barrier
    ds_read_b128 v[172:175], v161
    s_waitcnt lgkmcnt(0)
    v_mfma_f32_16x16x32_bf16 v[24:27], v[184:187], v[172:175], 0
    s_nop 7
    v_cvt_pk_bf16_f32 v168, v24, v25
    v_cvt_pk_bf16_f32 v169, v26, v27
    s_nop 0
    v_permlane16_swap_b32 v168, v170
    v_permlane16_swap_b32 v169, v171
    s_mov_b64 exec, 0xffff
    v_min_u32 v168, -2, v168
    buffer_store_dwordx4 v[168:171], v1, s[4:7], s25 offen sc1
    s_setprio 0
    buffer_store_dwordx4 v[176:179], v1, s[4:7], s26 offen sc1
    s_mov_b64 exec, -1
    s_branch pg_42
    s_cmp_lg_u32 s27, 0
    s_cbranch_scc1 pg_42
    s_sub_u32 s21, s16, 1
    s_cbranch_scc1 pg_42
    s_sub_u32 s17, s21, 1
    s_and_b32 s17, s17, 3
    s_cmp_ge_u32 s16, 58
    s_cselect_b32 s17, 0, s17
    s_cmp_lg_u32 s17, 0
    s_cbranch_scc1 pg_42
    v_mov_b32 v3, s21
    s_mov_b64 exec, 1
    buffer_store_dword v3, off, s[4:7], s28 sc1
    s_mov_b64 exec, -1
pg_42:
    s_cmp_lg_u32 s31, s30
    s_cbranch_scc1 aloopL_41_nd2
    ds_read_b128 v[24:27], v163 offset:16384
    ds_read_b128 v[28:31], v163 offset:17408
    ds_read_b128 v[32:35], v163 offset:18432
    ds_read_b128 v[36:39], v163 offset:19456
    ds_write_b32 v180, v64 offset:0
    ds_write_b32 v180, v65 offset:8
    ds_write_b32 v180, v66 offset:128
    ds_write_b32 v180, v67 offset:136
    ds_write_b32 v180, v68 offset:1024
    ds_write_b32 v180, v69 offset:1032
    ds_write_b32 v180, v70 offset:1152
    ds_write_b32 v180, v71 offset:1160
    s_mov_b32 s32, 1
    s_waitcnt lgkmcnt(11)
    v_mfma_f32_16x16x32_bf16 v[12:15], v[96:99], v[24:27], 0
    v_mfma_f32_16x16x32_bf16 v[16:19], v[112:115], v[24:27], 0
    v_mfma_f32_16x16x32_bf16 v[20:23], v[48:51], v[24:27], 0
    s_waitcnt lgkmcnt(10)
    v_mfma_f32_16x16x32_bf16 v[12:15], v[100:103], v[28:31], v[12:15]
    v_mfma_f32_16x16x32_bf16 v[16:19], v[116:119], v[28:31], v[16:19]
    v_mfma_f32_16x16x32_bf16 v[20:23], v[52:55], v[28:31], v[20:23]
    s_waitcnt lgkmcnt(9)
    v_mfma_f32_16x16x32_bf16 v[12:15], v[104:107], v[32:35], v[12:15]
    v_mfma_f32_16x16x32_bf16 v[16:19], v[120:123], v[32:35], v[16:19]
    v_mfma_f32_16x16x32_bf16 v[20:23], v[56:59], v[32:35], v[20:23]
    s_waitcnt lgkmcnt(8)
    v_mfma_f32_16x16x32_bf16 v[12:15], v[108:111], v[36:39], v[12:15]
    v_mfma_f32_16x16x32_bf16 v[16:19], v[124:127], v[36:39], v[16:19]
    v_mfma_f32_16x16x32_bf16 v[20:23], v[60:63], v[36:39], v[20:23]
    s_waitcnt lgkmcnt(0)
    s_nop 3
    s_nop 3
    s_cmp_eq_u32 s32, 0
    s_cbranch_scc1 aloopL_41_p2e
    s_mov_b32 s32, 0
    ds_read_b64_tr_b16 v[96:97], v181 offset:0
    ds_read_b64_tr_b16 v[98:99], v181 offset:4096
    ds_read_b64_tr_b16 v[64:65], v182 offset:0
    ds_read_b64_tr_b16 v[100:101], v181 offset:8
    ds_read_b64_tr_b16 v[102:103], v181 offset:4104
    ds_read_b64_tr_b16 v[66:67], v182 offset:8
    ds_read_b64_tr_b16 v[104:105], v181 offset:1024
    ds_read_b64_tr_b16 v[106:107], v181 offset:5120
    ds_read_b64_tr_b16 v[68:69], v182 offset:512
    ds_read_b64_tr_b16 v[108:109], v181 offset:1032
    ds_read_b64_tr_b16 v[110:111], v181 offset:5128
    ds_read_b64_tr_b16 v[70:71], v182 offset:520
    ds_read_b64_tr_b16 v[112:113], v181 offset:2048
    ds_read_b64_tr_b16 v[114:115], v181 offset:6144
    ds_read_b64_tr_b16 v[72:73], v182 offset:1024
    ds_read_b64_tr_b16 v[116:117], v181 offset:2056
    ds_read_b64_tr_b16 v[118:119], v181 offset:6152
    ds_read_b64_tr_b16 v[74:75], v182 offset:1032
    ds_read_b64_tr_b16 v[120:121], v181 offset:3072
    ds_read_b64_tr_b16 v[122:123], v181 offset:7168
    ds_read_b64_tr_b16 v[76:77], v182 offset:1536
    ds_read_b64_tr_b16 v[124:125], v181 offset:3080
    ds_read_b64_tr_b16 v[126:127], v181 offset:7176
    ds_read_b64_tr_b16 v[78:79], v182 offset:1544
    v_mov_b32 v188, 0xff61b1e6
    s_cmp_eq_u32 s33, 0
    s_cselect_b64 vcc, s[44:45], 0
    v_cndmask_b32 v12, v12, v188, vcc
    s_cselect_b64 vcc, -1, s[44:45]
    v_cndmask_b32 v16, v16, v188, vcc
    s_cselect_b64 vcc, s[46:47], 0
    v_cndmask_b32 v13, v13, v188, vcc
    s_cselect_b64 vcc, -1, s[46:47]
    v_cndmask_b32 v17, v17, v188, vcc
    s_cselect_b64 vcc, s[48:49], 0
    v_cndmask_b32 v14, v14, v188, vcc
    s_cselect_b64 vcc, -1, s[48:49]
    v_cndmask_b32 v18, v18, v188, vcc
    s_cselect_b64 vcc, s[50:51], 0
    v_cndmask_b32 v15, v15, v188, vcc
    s_cselect_b64 vcc, -1, s[50:51]
    v_cndmask_b32 v19, v19, v188, vcc
    v_max3_f32 v2, v12, v13, v14
    v_max3_f32 v3, v15, v16, v17
    v_max3_f32 v2, v2, v18, v19
    v_max3_f32 v3, v3, v20, v21
    v_max_f32 v2, v2, v3
    v_mov_b32 v3, v2
    s_nop 1
    v_permlane16_swap_b32 v3, v2
    v_max_f32 v2, v2, v3
    v_mov_b32 v3, v2
    s_nop 1
    v_permlane32_swap_b32 v3, v2
    v_max_f32 v2, v2, v3
    v_mul_f32 v2, s29, v2
    v_fma_f32 v12, v12, s29, -v2
    v_fma_f32 v13, v13, s29, -v2
    v_fma_f32 v14, v14, s29, -v2
    v_exp_f32 v12, v12
    v_fma_f32 v15, v15, s29, -v2
    v_exp_f32 v13, v13
    v_fma_f32 v16, v16, s29, -v2
    v_exp_f32 v14, v14
    v_fma_f32 v17, v17, s29, -v2
    v_exp_f32 v15, v15
    v_fma_f32 v18, v18, s29, -v2
    v_exp_f32 v16, v16
    v_fma_f32 v19, v19, s29, -v2
    v_exp_f32 v17, v17
    v_fma_f32 v20, v20, s29, -v2
    v_exp_f32 v18, v18
    v_fma_f32 v21, v21, s29, -v2
    v_exp_f32 v19, v19
    v_exp_f32 v20, v20
    v_exp_f32 v21, v21
    v_cvt_pk_bf16_f32 v12, v12, v13
    v_cvt_pk_bf16_f32 v13, v14, v15
    v_cvt_pk_bf16_f32 v14, v16, v17
    v_cvt_pk_bf16_f32 v15, v18, v19
    v_cvt_pk_bf16_f32 v20, v20, v21
    v_mov_b32 v22, 0
    v_mov_b32 v21, 0
    v_mov_b32 v23, 0
    s_waitcnt lgkmcnt(0)
    s_nop 0
    v_mfma_f32_16x16x32_bf16 v[16:19], v[4:7], v[12:15], 0
    v_mfma_f32_16x16x32_bf16 v[16:19], v[4:7], v[20:23], v[16:19]
    v_mfma_f32_16x16x32_bf16 v[24:27], v[96:99], v[12:15], 0
    v_mfma_f32_16x16x32_bf16 v[24:27], v[64:67], v[20:23], v[24:27]
    v_mfma_f32_16x16x32_bf16 v[28:31], v[100:103], v[12:15], 0
    v_mfma_f32_16x16x32_bf16 v[28:31], v[66:69], v[20:23], v[28:31]
    v_mfma_f32_16x16x32_bf16 v[32:35], v[104:107], v[12:15], 0
    v_mfma_f32_16x16x32_bf16 v[32:35], v[68:71], v[20:23], v[32:35]
    v_mfma_f32_16x16x32_bf16 v[36:39], v[108:111], v[12:15], 0
    v_mfma_f32_16x16x32_bf16 v[36:39], v[70:73], v[20:23], v[36:39]
    v_mfma_f32_16x16x32_bf16 v[48:51], v[112:115], v[12:15], 0
    v_mfma_f32_16x16x32_bf16 v[48:51], v[72:75], v[20:23], v[48:51]
    v_mfma_f32_16x16x32_bf16 v[52:55], v[116:119], v[12:15], 0
    v_mfma_f32_16x16x32_bf16 v[52:55], v[74:77], v[20:23], v[52:55]
    v_mfma_f32_16x16x32_bf16 v[56:59], v[120:123], v[12:15], 0
    v_mfma_f32_16x16x32_bf16 v[56:59], v[76:79], v[20:23], v[56:59]
    v_mfma_f32_16x16x32_bf16 v[60:63], v[124:127], v[12:15], 0
    v_mfma_f32_16x16x32_bf16 v[60:63], v[78:81], v[20:23], v[60:63]
    v_rcp_f32 v3, v16
    s_nop 0
    v_mul_f32 v24, v24, v3
    v_mul_f32 v25, v25, v3
    v_mul_f32 v26, v26, v3
    v_mul_f32 v27, v27, v3
    v_mul_f32 v28, v28, v3
    v_mul_f32 v29, v29, v3
    v_mul_f32 v30, v30, v3
    v_mul_f32 v31, v31, v3
    v_cvt_pk_bf16_f32 v24, v24, v25
    v_cvt_pk_bf16_f32 v25, v26, v27
    v_cvt_pk_bf16_f32 v26, v28, v29
    v_cvt_pk_bf16_f32 v27, v30, v31
    ds_write_b128 v0, v[24:27] offset:32768
    v_mul_f32 v32, v32, v3
    v_mul_f32 v33, v33, v3
    v_mul_f32 v34, v34, v3
    v_mul_f32 v35, v35, v3
    v_mul_f32 v36, v36, v3
    v_mul_f32 v37, v37, v3
    v_mul_f32 v38, v38, v3
    v_mul_f32 v39, v39, v3
    v_cvt_pk_bf16_f32 v32, v32, v33
    v_cvt_pk_bf16_f32 v33, v34, v35
    v_cvt_pk_bf16_f32 v34, v36, v37
    v_cvt_pk_bf16_f32 v35, v38, v39
    ds_write_b128 v0, v[32:35] offset:33792
    v_mul_f32 v48, v48, v3
    v_mul_f32 v49, v49, v3
    v_mul_f32 v50, v50, v3
    v_mul_f32 v51, v51, v3
    v_mul_f32 v52, v52, v3
    v_mul_f32 v53, v53, v3
    v_mul_f32 v54, v54, v3
    v_mul_f32 v55, v55, v3
    v_cvt_pk_bf16_f32 v48, v48, v49
    v_cvt_pk_bf16_f32 v49, v50, v51
    v_cvt_pk_bf16_f32 v50, v52, v53
    v_cvt_pk_bf16_f32 v51, v54, v55
    ds_write_b128 v0, v[48:51] offset:34816
    v_mul_f32 v56, v56, v3
    v_mul_f32 v57, v57, v3
    v_mul_f32 v58, v58, v3
    v_mul_f32 v59, v59, v3
    v_mul_f32 v60, v60, v3
    v_mul_f32 v61, v61, v3
    v_mul_f32 v62, v62, v3
    v_mul_f32 v63, v63, v3
    v_cvt_pk_bf16_f32 v56, v56, v57
    v_cvt_pk_bf16_f32 v57, v58, v59
    v_cvt_pk_bf16_f32 v58, v60, v61
    v_cvt_pk_bf16_f32 v59, v62, v63
    ds_write_b128 v0, v[56:59] offset:35840
aloopL_41_p2e:
    s_nop 3
aloopL_41_nd2:
    s_add_u32 s19, s41, 20971520
    buffer_load_dwordx4 v[96:99], v0, s[4:7], s19 offen offset:0 sc1
    buffer_load_dwordx4 v[100:103], v0, s[4:7], s19 offen offset:1024 sc1
    buffer_load_dwordx4 v[104:107], v0, s[4:7], s19 offen offset:2048 sc1
    buffer_load_dwordx4 v[108:111], v0, s[4:7], s19 offen offset:3072 sc1
    s_add_u32 s20, s41, 21102592
    buffer_load_dwordx4 v[112:115], v0, s[4:7], s20 offen offset:0 sc1
    buffer_load_dwordx4 v[116:119], v0, s[4:7], s20 offen offset:1024 sc1
    buffer_load_dwordx4 v[120:123], v0, s[4:7], s20 offen offset:2048 sc1
    buffer_load_dwordx4 v[124:127], v0, s[4:7], s20 offen offset:3072 sc1
    s_add_u32 s16, s16, 1
    s_cmp_lt_u32 s16, 48
    s_cbranch_scc1 aloopL_41
    s_waitcnt vmcnt(0)
    ds_write_b128 v163, v[128:131] offset:8192
    ds_write_b128 v163, v[132:135] offset:9216
    ds_write_b128 v163, v[136:139] offset:10240
    ds_write_b128 v163, v[140:143] offset:11264
    ds_write_b128 v163, v[144:147] offset:12288
    ds_write_b128 v163, v[148:151] offset:13312
    ds_write_b128 v163, v[152:155] offset:14336
    ds_write_b128 v163, v[156:159] offset:15360
    s_waitcnt lgkmcnt(0)
    s_branch aloopH_40
aloopL_41_rq_0:
    s_sub_u32 s22, s22, 1
    s_cbranch_scc1 aloopL_41_rq_0_g
    buffer_load_dwordx4 v[48:51], v0, s[4:7], s23 offen offset:0 sc1
    buffer_load_dwordx4 v[52:55], v0, s[4:7], s23 offen offset:1024 sc1
    buffer_load_dwordx4 v[56:59], v0, s[4:7], s23 offen offset:2048 sc1
    buffer_load_dwordx4 v[60:63], v0, s[4:7], s23 offen offset:3072 sc1
    buffer_load_dwordx4 v[64:67], v0, s[4:7], s24 offen offset:0 sc1
    buffer_load_dwordx4 v[68:71], v0, s[4:7], s24 offen offset:1024 sc1
    s_waitcnt vmcnt(5)
    v_max_u32 v3, v48, v50
    v_cmp_eq_u32 vcc, -1, v3
    s_cbranch_vccnz aloopL_41_rq_0
    s_branch aloopL_41_again
aloopL_41_rq_0_g:
    s_mov_b32 s22, 0
    s_waitcnt vmcnt(0)
    s_branch aloopL_41_nochk
aloopL_41_rq_1:
    s_sub_u32 s22, s22, 1
    s_cbranch_scc1 aloopL_41_rq_1_g
    buffer_load_dwordx4 v[52:55], v0, s[4:7], s23 offen offset:1024 sc1
    buffer_load_dwordx4 v[56:59], v0, s[4:7], s23 offen offset:2048 sc1
    buffer_load_dwordx4 v[60:63], v0, s[4:7], s23 offen offset:3072 sc1
    buffer_load_dwordx4 v[64:67], v0, s[4:7], s24 offen offset:0 sc1
    buffer_load_dwordx4 v[68:71], v0, s[4:7], s24 offen offset:1024 sc1
    s_waitcnt vmcnt(4)
    v_max_u32 v3, v52, v54
    v_cmp_eq_u32 vcc, -1, v3
    s_cbranch_vccnz aloopL_41_rq_1
    s_branch aloopL_41_again
aloopL_41_rq_1_g:
    s_mov_b32 s22, 0
    s_waitcnt vmcnt(0)
    s_branch aloopL_41_nochk
aloopL_41_rq_2:
    s_sub_u32 s22, s22, 1
    s_cbranch_scc1 aloopL_41_rq_2_g
    buffer_load_dwordx4 v[56:59], v0, s[4:7], s23 offen offset:2048 sc1
    buffer_load_dwordx4 v[60:63], v0, s[4:7], s23 offen offset:3072 sc1
    buffer_load_dwordx4 v[64:67], v0, s[4:7], s24 offen offset:0 sc1
    buffer_load_dwordx4 v[68:71], v0, s[4:7], s24 offen offset:1024 sc1
    s_waitcnt vmcnt(3)
    v_max_u32 v3, v56, v58
    v_cmp_eq_u32 vcc, -1, v3
    s_cbranch_vccnz aloopL_41_rq_2
    s_branch aloopL_41_again
aloopL_41_rq_2_g:
    s_mov_b32 s22, 0
    s_waitcnt vmcnt(0)
    s_branch aloopL_41_nochk
aloopL_41_rq_3:
    s_sub_u32 s22, s22, 1
    s_cbranch_scc1 aloopL_41_rq_3_g
    buffer_load_dwordx4 v[60:63], v0, s[4:7], s23 offen offset:3072 sc1
    buffer_load_dwordx4 v[64:67], v0, s[4:7], s24 offen offset:0 sc1
    buffer_load_dwordx4 v[68:71], v0, s[4:7], s24 offen offset:1024 sc1
    s_waitcnt vmcnt(2)
    v_max_u32 v3, v60, v62
    v_cmp_eq_u32 vcc, -1, v3
    s_cbranch_vccnz aloopL_41_rq_3
    s_branch aloopL_41_again
aloopL_41_rq_3_g:
    s_mov_b32 s22, 0
    s_waitcnt vmcnt(0)
    s_branch aloopL_41_nochk
aloopL_41_again:
    s_waitcnt vmcnt(5)
    v_mfma_f32_16x16x32_bf16 v[12:15], v[96:99], v[48:51], 0
    v_mfma_f32_16x16x32_bf16 v[16:19], v[112:115], v[48:51], 0
    v_max_u32 v3, v48, v50
    v_cmp_eq_u32 vcc, -1, v3
    v_mfma_f32_16x16x32_bf16 v[20:23], v[48:51], v[48:51], 0
    s_cbranch_vccnz aloopL_41_rq_0
    s_waitcnt vmcnt(4)
    v_mfma_f32_16x16x32_bf16 v[12:15], v[100:103], v[52:55], v[12:15]
    v_mfma_f32_16x16x32_bf16 v[16:19], v[116:119], v[52:55], v[16:19]
    v_max_u32 v3, v52, v54
    v_cmp_eq_u32 vcc, -1, v3
    v_mfma_f32_16x16x32_bf16 v[20:23], v[52:55], v[52:55], v[20:23]
    s_cbranch_vccnz aloopL_41_rq_1
    s_waitcnt vmcnt(3)
    v_mfma_f32_16x16x32_bf16 v[12:15], v[104:107], v[56:59], v[12:15]
    v_mfma_f32_16x16x32_bf16 v[16:19], v[120:123], v[56:59], v[16:19]
    v_max_u32 v3, v56, v58
    v_cmp_eq_u32 vcc, -1, v3
    v_mfma_f32_16x16x32_bf16 v[20:23], v[56:59], v[56:59], v[20:23]
    s_cbranch_vccnz aloopL_41_rq_2
    s_waitcnt vmcnt(2)
    v_mfma_f32_16x16x32_bf16 v[12:15], v[108:111], v[60:63], v[12:15]
    v_mfma_f32_16x16x32_bf16 v[16:19], v[124:127], v[60:63], v[16:19]
    v_max_u32 v3, v60, v62
    v_cmp_eq_u32 vcc, -1, v3
    v_mfma_f32_16x16x32_bf16 v[20:23], v[60:63], v[60:63], v[20:23]
    s_cbranch_vccnz aloopL_41_rq_3
    s_branch aloopL_41_sdone
aloopL_41_rq_v:
    s_sub_u32 s22, s22, 1
    s_cbranch_scc1 aloopL_41_rq_vg
    buffer_load_dwordx4 v[64:67], v0, s[4:7], s24 offen offset:0 sc1
    buffer_load_dwordx4 v[68:71], v0, s[4:7], s24 offen offset:1024 sc1
    s_waitcnt vmcnt(0)
    v_max3_u32 v188, v64, v66, v68
    v_max_u32 v188, v188, v70
    v_cmp_eq_u32 vcc, -1, v188
    s_cbranch_vccnz aloopL_41_rq_v
    s_branch aloopL_41_vok
aloopL_41_rq_vg:
    s_mov_b32 s22, 0
    s_branch aloopL_41_vok
aloopL_41_nochk:
    v_mfma_f32_16x16x32_bf16 v[12:15], v[96:99], v[48:51], 0
    v_mfma_f32_16x16x32_bf16 v[16:19], v[112:115], v[48:51], 0
    v_mfma_f32_16x16x32_bf16 v[20:23], v[48:51], v[48:51], 0
    v_mfma_f32_16x16x32_bf16 v[12:15], v[100:103], v[52:55], v[12:15]
    v_mfma_f32_16x16x32_bf16 v[16:19], v[116:119], v[52:55], v[16:19]
    v_mfma_f32_16x16x32_bf16 v[20:23], v[52:55], v[52:55], v[20:23]
    v_mfma_f32_16x16x32_bf16 v[12:15], v[104:107], v[56:59], v[12:15]
    v_mfma_f32_16x16x32_bf16 v[16:19], v[120:123], v[56:59], v[16:19]
    v_mfma_f32_16x16x32_bf16 v[20:23], v[56:59], v[56:59], v[20:23]
    v_mfma_f32_16x16x32_bf16 v[12:15], v[108:111], v[60:63], v[12:15]
    v_mfma_f32_16x16x32_bf16 v[16:19], v[124:127], v[60:63], v[16:19]
    v_mfma_f32_16x16x32_bf16 v[20:23], v[60:63], v[60:63], v[20:23]
    s_nop 1
    s_branch aloopL_41_sdone
ct_aH:
.p2align 6
aloopH_40:
    s_and_b32 s23, s16, 3
    s_lshl_b32 s23, s23, 18
    s_add_u32 s23, s23, s38
    s_add_u32 s24, s23, 4096
    s_and_b32 s25, s16, 3
    s_lshl_b32 s25, s25, 18
    s_add_u32 s25, s25, s39
    s_add_u32 s26, s16, 2
    s_and_b32 s26, s26, 3
    s_lshl_b32 s26, s26, 18
    s_add_u32 s26, s26, s39
    v_mov_b32 v165, s16
aloopH_40_wkv:
    ds_read_b32 v188, v164 offset:16
    s_waitcnt lgkmcnt(0)
    v_readfirstlane_b32 s19, v188
    s_cmp_ge_i32 s19, s16
    s_cbranch_scc1 aloopH_40_wkvok
    s_sleep 1
    s_branch aloopH_40_wkv
aloopH_40_wkvok:
    ds_read_b128 v[128:131], v163 offset:8192
    ds_read_b128 v[144:147], v163 offset:12288
    ds_read_b128 v[132:135], v163 offset:9216
    ds_read_b128 v[148:151], v163 offset:13312
    ds_read_b128 v[136:139], v163 offset:10240
    ds_read_b128 v[152:155], v163 offset:14336
    ds_read_b128 v[140:143], v163 offset:11264
    ds_read_b128 v[156:159], v163 offset:15360
    s_waitcnt lgkmcnt(6)
    v_mfma_f32_16x16x32_bf16 v[48:51], v[128:131], v[192:195], 0
    v_mfma_f32_16x16x32_bf16 v[52:55], v[128:131], v[208:211], 0
    v_mfma_f32_16x16x32_bf16 v[56:59], v[128:131], v[224:227], 0
    v_mfma_f32_16x16x32_bf16 v[60:63], v[128:131], v[240:243], 0
    v_mfma_f32_16x16x32_bf16 v[64:67], v[144:147], v[192:195], 0
    v_mfma_f32_16x16x32_bf16 v[68:71], v[144:147], v[208:211], 0
    v_mfma_f32_16x16x32_bf16 v[72:75], v[144:147], v[224:227], 0
    v_mfma_f32_16x16x32_bf16 v[76:79], v[144:147], v[240:243], 0
    s_setprio 2
aloopH_40_wm:
    ds_read_b32 v188, v164 offset:32
    s_waitcnt lgkmcnt(0)
    v_readfirstlane_b32 s19, v188
    s_cmp_ge_i32 s19, s16
    s_cbranch_scc1 aloopH_40_wmok
    s_sleep 1
    s_branch aloopH_40_wm
aloopH_40_wmok:
    s_add_u32 m0, s42, 16384
    s_add_u32 s17, s41, 4194304
    buffer_load_dwordx4 v0, s[4:7], s17 offen offset:0 sc1 lds
    buffer_load_dwordx4 v0, s[4:7], s17 offen offset:1024 sc1 lds
    buffer_load_dwordx4 v0, s[4:7], s17 offen offset:2048 sc1 lds
    buffer_load_dwordx4 v0, s[4:7], s17 offen offset:3072 sc1 lds
    s_add_u32 m0, s42, 20480
    s_add_u32 s17, s41, 4325376
    buffer_load_dwordx4 v0, s[4:7], s17 offen offset:0 sc1 lds
    buffer_load_dwordx4 v0, s[4:7], s17 offen offset:1024 sc1 lds
    buffer_load_dwordx4 v0, s[4:7], s17 offen offset:2048 sc1 lds
    buffer_load_dwordx4 v0, s[4:7], s17 offen offset:3072 sc1 lds
    s_add_u32 s41, s41, 262144
    s_barrier
    s_waitcnt lgkmcnt(4)
    v_mfma_f32_16x16x32_bf16 v[48:51], v[132:135], v[196:199], v[48:51]
    v_mfma_f32_16x16x32_bf16 v[52:55], v[132:135], v[212:215], v[52:55]
    v_mfma_f32_16x16x32_bf16 v[56:59], v[132:135], v[228:231], v[56:59]
    v_mfma_f32_16x16x32_bf16 v[60:63], v[132:135], v[244:247], v[60:63]
    v_mfma_f32_16x16x32_bf16 v[64:67], v[148:151], v[196:199], v[64:67]
    v_mfma_f32_16x16x32_bf16 v[68:71], v[148:151], v[212:215], v[68:71]
    v_mfma_f32_16x16x32_bf16 v[72:75], v[148:151], v[228:231], v[72:75]
    v_mfma_f32_16x16x32_bf16 v[76:79], v[148:151], v[244:247], v[76:79]
    s_waitcnt lgkmcnt(2)
    v_mfma_f32_16x16x32_bf16 v[48:51], v[136:139], v[200:203], v[48:51]
    v_mfma_f32_16x16x32_bf16 v[52:55], v[136:139], v[216:219], v[52:55]
    v_mfma_f32_16x16x32_bf16 v[56:59], v[136:139], v[232:235], v[56:59]
    v_mfma_f32_16x16x32_bf16 v[60:63], v[136:139], v[248:251], v[60:63]
    v_mfma_f32_16x16x32_bf16 v[64:67], v[152:155], v[200:203], v[64:67]
    v_mfma_f32_16x16x32_bf16 v[68:71], v[152:155], v[216:219], v[68:71]
    v_mfma_f32_16x16x32_bf16 v[72:75], v[152:155], v[232:235], v[72:75]
    v_mfma_f32_16x16x32_bf16 v[76:79], v[152:155], v[248:251], v[76:79]
    s_waitcnt lgkmcnt(0)
    v_mfma_f32_16x16x32_bf16 v[48:51], v[140:143], v[204:207], v[48:51]
    v_mfma_f32_16x16x32_bf16 v[52:55], v[140:143], v[220:223], v[52:55]
    v_mfma_f32_16x16x32_bf16 v[56:59], v[140:143], v[236:239], v[56:59]
    v_mfma_f32_16x16x32_bf16 v[60:63], v[140:143], v[252:255], v[60:63]
    v_mfma_f32_16x16x32_bf16 v[64:67], v[156:159], v[204:207], v[64:67]
    v_mfma_f32_16x16x32_bf16 v[68:71], v[156:159], v[220:223], v[68:71]
    v_mfma_f32_16x16x32_bf16 v[72:75], v[156:159], v[236:239], v[72:75]
    v_mfma_f32_16x16x32_bf16 v[76:79], v[156:159], v[252:255], v[76:79]
    s_nop 2
    v_cvt_pk_bf16_f32 v80, v48, v49
    v_cvt_pk_bf16_f32 v81, v50, v51
    v_cvt_pk_bf16_f32 v82, v64, v65
    v_cvt_pk_bf16_f32 v83, v66, v67
    v_cvt_pk_bf16_f32 v84, v52, v53
    v_cvt_pk_bf16_f32 v85, v54, v55
    v_cvt_pk_bf16_f32 v86, v68, v69
    v_cvt_pk_bf16_f32 v87, v70, v71
    v_cvt_pk_bf16_f32 v88, v56, v57
    v_cvt_pk_bf16_f32 v89, v58, v59
    v_cvt_pk_bf16_f32 v90, v72, v73
    v_cvt_pk_bf16_f32 v91, v74, v75
    v_cvt_pk_bf16_f32 v92, v60, v61
    v_cvt_pk_bf16_f32 v93, v62, v63
    v_cvt_pk_bf16_f32 v94, v76, v77
    v_cvt_pk_bf16_f32 v95, v78, v79
    v_mov_b32 v24, 0
    v_mov_b32 v25, 0
    v_mov_b32 v26, 0
    v_mov_b32 v27, 0
    v_mov_b32 v28, 0
    v_mov_b32 v29, 0
    v_mov_b32 v30, 0
    v_mov_b32 v31, 0
    v_mov_b32 v32, 0
    v_mov_b32 v33, 0
    v_mov_b32 v34, 0
    v_mov_b32 v35, 0
    v_mov_b32 v36, 0
    v_mov_b32 v37, 0
    v_mov_b32 v38, 0
    v_mov_b32 v39, 0
    s_waitcnt lgkmcnt(0)
    buffer_load_dwordx4 v[48:51], v0, s[4:7], s23 offen offset:0 sc1
    buffer_load_dwordx4 v[52:55], v0, s[4:7], s23 offen offset:1024 sc1
    buffer_load_dwordx4 v[56:59], v0, s[4:7], s23 offen offset:2048 sc1
    buffer_load_dwordx4 v[60:63], v0, s[4:7], s23 offen offset:3072 sc1
    s_sleep 2
    buffer_load_dwordx4 v[64:67], v0, s[4:7], s24 offen offset:0 sc1
    buffer_load_dwordx4 v[68:71], v0, s[4:7], s24 offen offset:1024 sc1
    s_waitcnt vmcnt(5)
    v_mfma_f32_16x16x32_bf16 v[12:15], v[96:99], v[48:51], 0
    v_mfma_f32_16x16x32_bf16 v[16:19], v[112:115], v[48:51], 0
    v_max_u32 v3, v48, v50
    v_cmp_eq_u32 vcc, -1, v3
    v_mfma_f32_16x16x32_bf16 v[20:23], v[48:51], v[48:51], 0
    s_cbranch_vccnz aloopH_40_rq_0
    s_waitcnt vmcnt(4)
    v_mfma_f32_16x16x32_bf16 v[12:15], v[100:103], v[52:55], v[12:15]
    v_mfma_f32_16x16x32_bf16 v[16:19], v[116:119], v[52:55], v[16:19]
    v_max_u32 v3, v52, v54
    v_cmp_eq_u32 vcc, -1, v3
    v_mfma_f32_16x16x32_bf16 v[20:23], v[52:55], v[52:55], v[20:23]
    s_cbranch_vccnz aloopH_40_rq_1
    s_waitcnt vmcnt(3)
    v_mfma_f32_16x16x32_bf16 v[12:15], v[104:107], v[56:59], v[12:15]
    v_mfma_f32_16x16x32_bf16 v[16:19], v[120:123], v[56:59], v[16:19]
    v_max_u32 v3, v56, v58
    v_cmp_eq_u32 vcc, -1, v3
    v_mfma_f32_16x16x32_bf16 v[20:23], v[56:59], v[56:59], v[20:23]
    s_cbranch_vccnz aloopH_40_rq_2
    s_waitcnt vmcnt(2)
    v_mfma_f32_16x16x32_bf16 v[12:15], v[108:111], v[60:63], v[12:15]
    v_mfma_f32_16x16x32_bf16 v[16:19], v[124:127], v[60:63], v[16:19]
    v_max_u32 v3, v60, v62
    v_cmp_eq_u32 vcc, -1, v3
    v_mfma_f32_16x16x32_bf16 v[20:23], v[60:63], v[60:63], v[20:23]
    s_cbranch_vccnz aloopH_40_rq_3
aloopH_40_sdone:
    s_cmp_eq_u32 s16, 63
    s_cbranch_scc1 aloopH_40_lsk
    ds_write_b32 v164, v165
    s_nop 0
    v_max3_f32 v2, v12, v13, v14
    v_max3_f32 v3, v15, v16, v17
    v_max3_f32 v2, v2, v18, v19
    v_max3_f32 v3, v3, v20, v21
    v_max_f32 v2, v2, v3
    v_mov_b32 v3, v2
    s_nop 1
    v_permlane16_swap_b32 v3, v2
    v_max_f32 v2, v2, v3
    v_mov_b32 v3, v2
    s_waitcnt vmcnt(0)
    v_max3_u32 v188, v64, v66, v68
    v_permlane32_swap_b32 v3, v2
    v_max_f32 v2, v2, v3
    v_max_u32 v188, v188, v70
    v_mul_f32 v2, s29, v2
    v_cmp_eq_u32 vcc, -1, v188
    v_fma_f32 v12, v12, s29, -v2
    v_fma_f32 v13, v13, s29, -v2
    s_cbranch_vccnz aloopH_40_rq_v
aloopH_40_vok:
    v_smfmac_f32_16x16x64_bf16 v[24:27], v[64:67], v[192:199], v166
    v_fma_f32 v14, v14, s29, -v2
    v_exp_f32 v12, v12
    v_smfmac_f32_16x16x64_bf16 v[32:35], v[64:67], v[224:231], v166
    v_fma_f32 v15, v15, s29, -v2
    v_exp_f32 v13, v13
    v_smfmac_f32_16x16x64_bf16 v[28:31], v[64:67], v[208:215], v166
    v_fma_f32 v16, v16, s29, -v2
    v_exp_f32 v14, v14
    v_smfmac_f32_16x16x64_bf16 v[36:39], v[64:67], v[240:247], v166
    v_fma_f32 v17, v17, s29, -v2
    v_exp_f32 v15, v15
    v_smfmac_f32_16x16x64_bf16 v[24:27], v[68:71], v[200:207], v166
    v_fma_f32 v18, v18, s29, -v2
    v_exp_f32 v16, v16
    v_smfmac_f32_16x16x64_bf16 v[32:35], v[68:71], v[232:239], v166
    v_fma_f32 v19, v19, s29, -v2
    v_exp_f32 v17, v17
    v_smfmac_f32_16x16x64_bf16 v[28:31], v[68:71], v[216:223], v166
    v_fma_f32 v20, v20, s29, -v2
    v_exp_f32 v18, v18
    v_smfmac_f32_16x16x64_bf16 v[36:39], v[68:71], v[248:255], v166
    v_fma_f32 v21, v21, s29, -v2
    v_exp_f32 v19, v19
    v_exp_f32 v20, v20
    v_exp_f32 v21, v21
    v_cvt_pk_bf16_f32 v12, v12, v13
    v_cvt_pk_bf16_f32 v13, v14, v15
    v_cvt_pk_bf16_f32 v14, v16, v17
    v_cvt_pk_bf16_f32 v15, v18, v19
    v_cvt_pk_bf16_f32 v20, v20, v21
    v_mov_b32 v22, 0
    v_mfma_f32_16x16x32_bf16 v[16:19], v[4:7], v[12:15], 0
    v_mov_b32 v21, v20
    v_mov_b32 v23, 0
    v_cvt_pk_bf16_f32 v40, v24, v25
    v_cvt_pk_bf16_f32 v41, v26, v27
    v_mfma_f32_16x16x32_bf16 v[16:19], v[8:11], v[20:23], v[16:19]
    v_mfma_f32_16x16x32_bf16 v[24:27], v[80:83], v[12:15], 0
    v_cvt_pk_bf16_f32 v44, v32, v33
    v_cvt_pk_bf16_f32 v45, v34, v35
    v_mfma_f32_16x16x32_bf16 v[32:35], v[88:91], v[12:15], 0
    v_cvt_pk_bf16_f32 v42, v28, v29
    v_cvt_pk_bf16_f32 v43, v30, v31
    v_mfma_f32_16x16x32_bf16 v[28:31], v[84:87], v[12:15], 0
    v_cvt_pk_bf16_f32 v46, v36, v37
    v_cvt_pk_bf16_f32 v47, v38, v39
    v_mfma_f32_16x16x32_bf16 v[36:39], v[92:95], v[12:15], 0
aloopH_40_midE:
    s_mov_b64 vcc, s[56:57]
    v_rcp_f32 v3, v16
    v_mfma_f32_16x16x32_bf16 v[24:27], v[40:43], v[20:23], v[24:27]
    v_mfma_f32_16x16x32_bf16 v[32:35], v[44:47], v[20:23], v[32:35]
    v_mfma_f32_16x16x32_bf16 v[28:31], v[42:45], v[20:23], v[28:31]
    v_mfma_f32_16x16x32_bf16 v[36:39], v[46:49], v[20:23], v[36:39]
    v_mov_b32_dpp v3, v3 quad_perm:[2,3,2,3] row_mask:0xf bank_mask:0xf
    s_nop 4
    v_cndmask_b32_dpp v24, v32, v24, vcc quad_perm:[2,3,2,3] row_mask:0xf bank_mask:0xf
    v_cndmask_b32_dpp v25, v33, v25, vcc quad_perm:[2,3,2,3] row_mask:0xf bank_mask:0xf
    v_cndmask_b32_dpp v26, v34, v26, vcc quad_perm:[2,3,2,3] row_mask:0xf bank_mask:0xf
    v_cndmask_b32_dpp v27, v35, v27, vcc quad_perm:[2,3,2,3] row_mask:0xf bank_mask:0xf
    v_cndmask_b32_dpp v28, v36, v28, vcc quad_perm:[2,3,2,3] row_mask:0xf bank_mask:0xf
    v_cndmask_b32_dpp v29, v37, v29, vcc quad_perm:[2,3,2,3] row_mask:0xf bank_mask:0xf
    v_cndmask_b32_dpp v30, v38, v30, vcc quad_perm:[2,3,2,3] row_mask:0xf bank_mask:0xf
    v_cndmask_b32_dpp v31, v39, v31, vcc quad_perm:[2,3,2,3] row_mask:0xf bank_mask:0xf
    v_mul_f32 v24, v24, v3
    v_mul_f32 v25, v25, v3
    v_mul_f32 v26, v26, v3
    v_mul_f32 v27, v27, v3
    v_mul_f32 v28, v28, v3
    v_mul_f32 v29, v29, v3
    v_mul_f32 v30, v30, v3
    v_mul_f32 v31, v31, v3
    v_cvt_pk_bf16_f32 v168, v24, v25
    v_cvt_pk_bf16_f32 v169, v26, v27
    v_cvt_pk_bf16_f32 v170, v28, v29
    v_cvt_pk_bf16_f32 v171, v30, v31
    ds_write_b128 v160, v[168:171]
    s_waitcnt lgkmcnt(0)
    s_barrier
    ds_read_b128 v[172:175], v161
    s_waitcnt lgkmcnt(0)
    v_mfma_f32_16x16x32_bf16 v[24:27], v[184:187], v[172:175], 0
    s_nop 7
    v_cvt_pk_bf16_f32 v168, v24, v25
    v_cvt_pk_bf16_f32 v169, v26, v27
    s_nop 0
    v_permlane16_swap_b32 v168, v170
    v_permlane16_swap_b32 v169, v171
    s_mov_b64 exec, 0xffff
    v_min_u32 v168, -2, v168
    buffer_store_dwordx4 v[168:171], v1, s[4:7], s25 offen sc1
    s_setprio 0
    buffer_store_dwordx4 v[176:179], v1, s[4:7], s26 offen sc1
    s_mov_b64 exec, -1
    s_branch pg_43
    s_cmp_lg_u32 s27, 0
    s_cbranch_scc1 pg_43
    s_sub_u32 s21, s16, 1
    s_cbranch_scc1 pg_43
    s_sub_u32 s17, s21, 1
    s_and_b32 s17, s17, 3
    s_cmp_ge_u32 s16, 58
    s_cselect_b32 s17, 0, s17
    s_cmp_lg_u32 s17, 0
    s_cbranch_scc1 pg_43
    v_mov_b32 v3, s21
    s_mov_b64 exec, 1
    buffer_store_dword v3, off, s[4:7], s28 sc1
    s_mov_b64 exec, -1
pg_43:
aloopH_40_lskb:
    v_mov_b32 v64, 0xff61b1e6
    ds_read_b128 v[128:131], v163 offset:16384
    ds_read_b128 v[132:135], v163 offset:17408
    ds_read_b128 v[136:139], v163 offset:18432
    ds_read_b128 v[140:143], v163 offset:19456
    ds_read_b128 v[144:147], v163 offset:20480
    ds_read_b128 v[148:151], v163 offset:21504
    ds_read_b128 v[152:155], v163 offset:22528
    ds_read_b128 v[156:159], v163 offset:23552
    s_waitcnt lgkmcnt(4)
    v_mfma_f32_16x16x32_bf16 v[12:15], v[96:99], v[128:131], 0
    v_mfma_f32_16x16x32_bf16 v[20:23], v[48:51], v[128:131], 0
    v_mfma_f32_16x16x32_bf16 v[12:15], v[100:103], v[132:135], v[12:15]
    v_mfma_f32_16x16x32_bf16 v[20:23], v[52:55], v[132:135], v[20:23]
    v_mfma_f32_16x16x32_bf16 v[12:15], v[104:107], v[136:139], v[12:15]
    v_mfma_f32_16x16x32_bf16 v[20:23], v[56:59], v[136:139], v[20:23]
    v_mfma_f32_16x16x32_bf16 v[12:15], v[108:111], v[140:143], v[12:15]
    v_mfma_f32_16x16x32_bf16 v[20:23], v[60:63], v[140:143], v[20:23]
    s_waitcnt lgkmcnt(0)
    v_mfma_f32_16x16x32_bf16 v[68:71], v[96:99], v[144:147], 0
    v_mfma_f32_16x16x32_bf16 v[72:75], v[112:115], v[144:147], 0
    v_mfma_f32_16x16x32_bf16 v[76:79], v[48:51], v[144:147], 0
    v_mfma_f32_16x16x32_bf16 v[68:71], v[100:103], v[148:151], v[68:71]
    v_mfma_f32_16x16x32_bf16 v[72:75], v[116:119], v[148:151], v[72:75]
    v_mfma_f32_16x16x32_bf16 v[76:79], v[52:55], v[148:151], v[76:79]
    v_mfma_f32_16x16x32_bf16 v[68:71], v[104:107], v[152:155], v[68:71]
    v_mfma_f32_16x16x32_bf16 v[72:75], v[120:123], v[152:155], v[72:75]
    v_mfma_f32_16x16x32_bf16 v[76:79], v[56:59], v[152:155], v[76:79]
    v_mfma_f32_16x16x32_bf16 v[68:71], v[108:111], v[156:159], v[68:71]
    v_mfma_f32_16x16x32_bf16 v[72:75], v[124:127], v[156:159], v[72:75]
    v_mfma_f32_16x16x32_bf16 v[76:79], v[60:63], v[156:159], v[76:79]
    v_cndmask_b32 v12, v12, v64, s[44:45]
    v_cndmask_b32 v13, v13, v64, s[46:47]
    v_cndmask_b32 v14, v14, v64, s[48:49]
    v_cndmask_b32 v15, v15, v64, s[50:51]
    s_add_u32 s17, s41, 20971520
    buffer_load_dwordx4 v[96:99], v0, s[4:7], s17 offen offset:0 sc1
    v_max3_f32 v2, v12, v13, v14
    buffer_load_dwordx4 v[100:103], v0, s[4:7], s17 offen offset:1024 sc1
    v_max3_f32 v3, v15, v20, v21
    buffer_load_dwordx4 v[104:107], v0, s[4:7], s17 offen offset:2048 sc1
    v_max_f32 v2, v2, v3
    buffer_load_dwordx4 v[108:111], v0, s[4:7], s17 offen offset:3072 sc1
    v_mov_b32 v3, v2
    s_add_u32 s18, s41, 21102592
    buffer_load_dwordx4 v[112:115], v0, s[4:7], s18 offen offset:0 sc1
    s_nop 1
    buffer_load_dwordx4 v[116:119], v0, s[4:7], s18 offen offset:1024 sc1
    v_permlane16_swap_b32 v3, v2
    buffer_load_dwordx4 v[120:123], v0, s[4:7], s18 offen offset:2048 sc1
    v_max_f32 v2, v2, v3
    buffer_load_dwordx4 v[124:127], v0, s[4:7], s18 offen offset:3072 sc1
    v_mov_b32 v3, v2
    s_nop 1
    v_permlane32_swap_b32 v3, v2
    v_max_f32 v2, v2, v3
    v_mul_f32 v2, s29, v2
    v_fma_f32 v12, v12, s29, -v2
    v_fma_f32 v13, v13, s29, -v2
    v_fma_f32 v14, v14, s29, -v2
    v_exp_f32 v12, v12
    v_fma_f32 v15, v15, s29, -v2
    v_exp_f32 v13, v13
    v_fma_f32 v20, v20, s29, -v2
    v_exp_f32 v14, v14
    v_fma_f32 v21, v21, s29, -v2
    v_exp_f32 v15, v15
    v_exp_f32 v20, v20
    v_exp_f32 v21, v21
    v_cvt_pk_bf16_f32 v12, v12, v13
    v_cvt_pk_bf16_f32 v13, v14, v15
    v_mov_b32 v14, 0
    v_mov_b32 v15, 0
    v_cvt_pk_bf16_f32 v20, v20, v21
    v_mov_b32 v22, 0
    v_mov_b32 v21, v20
    v_mov_b32 v23, 0
    s_nop 1
    v_cndmask_b32 v72, v72, v64, s[44:45]
    v_mfma_f32_16x16x32_bf16 v[16:19], v[4:7], v[12:15], 0
    v_cndmask_b32 v73, v73, v64, s[46:47]
    v_cndmask_b32 v74, v74, v64, s[48:49]
    v_mfma_f32_16x16x32_bf16 v[16:19], v[8:11], v[20:23], v[16:19]
    v_cndmask_b32 v75, v75, v64, s[50:51]
    v_max3_f32 v2, v68, v69, v70
    v_mfma_f32_16x16x32_bf16 v[24:27], v[80:83], v[12:15], 0
    v_max3_f32 v3, v71, v72, v73
    v_max3_f32 v2, v2, v74, v75
    v_mfma_f32_16x16x32_bf16 v[24:27], v[40:43], v[20:23], v[24:27]
    v_max3_f32 v3, v3, v76, v77
    v_max_f32 v2, v2, v3
    v_mfma_f32_16x16x32_bf16 v[28:31], v[84:87], v[12:15], 0
    v_mov_b32 v3, v2
    s_nop 1
    v_mfma_f32_16x16x32_bf16 v[28:31], v[42:45], v[20:23], v[28:31]
    v_permlane16_swap_b32 v3, v2
    v_max_f32 v2, v2, v3
    v_mfma_f32_16x16x32_bf16 v[32:35], v[88:91], v[12:15], 0
    v_mov_b32 v3, v2
    s_nop 1
    v_mfma_f32_16x16x32_bf16 v[32:35], v[44:47], v[20:23], v[32:35]
    v_permlane32_swap_b32 v3, v2
    v_max_f32 v2, v2, v3
    v_mfma_f32_16x16x32_bf16 v[36:39], v[92:95], v[12:15], 0
    v_mul_f32 v2, s29, v2
    v_fma_f32 v68, v68, s29, -v2
    v_mfma_f32_16x16x32_bf16 v[36:39], v[46:49], v[20:23], v[36:39]
    v_fma_f32 v69, v69, s29, -v2
    v_fma_f32 v70, v70, s29, -v2
    v_exp_f32 v68, v68
    v_fma_f32 v71, v71, s29, -v2
    v_exp_f32 v69, v69
    v_fma_f32 v72, v72, s29, -v2
    v_exp_f32 v70, v70
    v_fma_f32 v73, v73, s29, -v2
    v_exp_f32 v71, v71
    v_fma_f32 v74, v74, s29, -v2
    v_exp_f32 v72, v72
    v_fma_f32 v75, v75, s29, -v2
    v_exp_f32 v73, v73
    v_fma_f32 v76, v76, s29, -v2
    v_exp_f32 v74, v74
    v_fma_f32 v77, v77, s29, -v2
    v_exp_f32 v75, v75
    v_exp_f32 v76, v76
    v_exp_f32 v77, v77
    v_cvt_pk_bf16_f32 v68, v68, v69
    v_cvt_pk_bf16_f32 v69, v70, v71
    v_cvt_pk_bf16_f32 v70, v72, v73
    v_cvt_pk_bf16_f32 v71, v74, v75
    v_cvt_pk_bf16_f32 v76, v76, v77
    v_mov_b32 v78, 0
    v_mov_b32 v77, v76
    v_mov_b32 v79, 0
    v_rcp_f32 v66, v16
    s_nop 0
    v_mul_f32 v24, v24, v66
    v_mul_f32 v25, v25, v66
    v_mul_f32 v26, v26, v66
    v_mul_f32 v27, v27, v66
    v_cvt_pk_bf16_f32 v168, v24, v25
    v_cvt_pk_bf16_f32 v169, v26, v27
    v_mul_f32 v28, v28, v66
    v_mul_f32 v29, v29, v66
    v_mul_f32 v30, v30, v66
    v_mul_f32 v31, v31, v66
    v_cvt_pk_bf16_f32 v170, v28, v29
    v_cvt_pk_bf16_f32 v171, v30, v31
    v_mul_f32 v32, v32, v66
    v_mul_f32 v33, v33, v66
    v_mul_f32 v34, v34, v66
    v_mul_f32 v35, v35, v66
    v_cvt_pk_bf16_f32 v172, v32, v33
    v_cvt_pk_bf16_f32 v173, v34, v35
    v_mul_f32 v36, v36, v66
    v_mul_f32 v37, v37, v66
    v_mul_f32 v38, v38, v66
    v_mul_f32 v39, v39, v66
    v_cvt_pk_bf16_f32 v174, v36, v37
    v_cvt_pk_bf16_f32 v175, v38, v39
    ds_write_b128 v162, v[168:171] offset:0
    ds_write_b128 v162, v[172:175] offset:2048
    v_mfma_f32_16x16x32_bf16 v[72:75], v[4:7], v[68:71], 0
    v_mfma_f32_16x16x32_bf16 v[72:75], v[8:11], v[76:79], v[72:75]
    v_mfma_f32_16x16x32_bf16 v[24:27], v[80:83], v[68:71], 0
    v_mfma_f32_16x16x32_bf16 v[24:27], v[40:43], v[76:79], v[24:27]
    v_mfma_f32_16x16x32_bf16 v[28:31], v[84:87], v[68:71], 0
    v_mfma_f32_16x16x32_bf16 v[28:31], v[42:45], v[76:79], v[28:31]
    v_mfma_f32_16x16x32_bf16 v[32:35], v[88:91], v[68:71], 0
    v_mfma_f32_16x16x32_bf16 v[32:35], v[44:47], v[76:79], v[32:35]
    v_mfma_f32_16x16x32_bf16 v[36:39], v[92:95], v[68:71], 0
    v_mfma_f32_16x16x32_bf16 v[36:39], v[46:49], v[76:79], v[36:39]
    v_rcp_f32 v3, v72
    s_nop 0
    v_mul_f32 v24, v24, v3
    v_mul_f32 v25, v25, v3
    v_mul_f32 v26, v26, v3
    v_mul_f32 v27, v27, v3
    v_cvt_pk_bf16_f32 v168, v24, v25
    v_cvt_pk_bf16_f32 v169, v26, v27
    v_mul_f32 v28, v28, v3
    v_mul_f32 v29, v29, v3
    v_mul_f32 v30, v30, v3
    v_mul_f32 v31, v31, v3
    v_cvt_pk_bf16_f32 v170, v28, v29
    v_cvt_pk_bf16_f32 v171, v30, v31
    v_mul_f32 v32, v32, v3
    v_mul_f32 v33, v33, v3
    v_mul_f32 v34, v34, v3
    v_mul_f32 v35, v35, v3
    v_cvt_pk_bf16_f32 v172, v32, v33
    v_cvt_pk_bf16_f32 v173, v34, v35
    v_mul_f32 v36, v36, v3
    v_mul_f32 v37, v37, v3
    v_mul_f32 v38, v38, v3
    v_mul_f32 v39, v39, v3
    v_cvt_pk_bf16_f32 v174, v36, v37
    v_cvt_pk_bf16_f32 v175, v38, v39
    ds_write_b128 v162, v[168:171] offset:256
    ds_write_b128 v162, v[172:175] offset:2304
    v_xor_b32 v162, 0x4000, v162
    s_add_u32 s16, s16, 1
    s_cmp_le_u32 s16, 63
    s_cbranch_scc1 aloopH_40
    s_waitcnt lgkmcnt(0)
    s_barrier
    s_waitcnt vmcnt(0)
    s_branch k_end
aloopH_40_rq_0:
    s_sub_u32 s22, s22, 1
    s_cbranch_scc1 aloopH_40_rq_0_g
    buffer_load_dwordx4 v[48:51], v0, s[4:7], s23 offen offset:0 sc1
    buffer_load_dwordx4 v[52:55], v0, s[4:7], s23 offen offset:1024 sc1
    buffer_load_dwordx4 v[56:59], v0, s[4:7], s23 offen offset:2048 sc1
    buffer_load_dwordx4 v[60:63], v0, s[4:7], s23 offen offset:3072 sc1
    buffer_load_dwordx4 v[64:67], v0, s[4:7], s24 offen offset:0 sc1
    buffer_load_dwordx4 v[68:71], v0, s[4:7], s24 offen offset:1024 sc1
    s_waitcnt vmcnt(5)
    v_max_u32 v3, v48, v50
    v_cmp_eq_u32 vcc, -1, v3
    s_cbranch_vccnz aloopH_40_rq_0
    s_branch aloopH_40_again
aloopH_40_rq_0_g:
    s_mov_b32 s22, 0
    s_waitcnt vmcnt(0)
    s_branch aloopH_40_nochk
aloopH_40_rq_1:
    s_sub_u32 s22, s22, 1
    s_cbranch_scc1 aloopH_40_rq_1_g
    buffer_load_dwordx4 v[52:55], v0, s[4:7], s23 offen offset:1024 sc1
    buffer_load_dwordx4 v[56:59], v0, s[4:7], s23 offen offset:2048 sc1
    buffer_load_dwordx4 v[60:63], v0, s[4:7], s23 offen offset:3072 sc1
    buffer_load_dwordx4 v[64:67], v0, s[4:7], s24 offen offset:0 sc1
    buffer_load_dwordx4 v[68:71], v0, s[4:7], s24 offen offset:1024 sc1
    s_waitcnt vmcnt(4)
    v_max_u32 v3, v52, v54
    v_cmp_eq_u32 vcc, -1, v3
    s_cbranch_vccnz aloopH_40_rq_1
    s_branch aloopH_40_again
aloopH_40_rq_1_g:
    s_mov_b32 s22, 0
    s_waitcnt vmcnt(0)
    s_branch aloopH_40_nochk
aloopH_40_rq_2:
    s_sub_u32 s22, s22, 1
    s_cbranch_scc1 aloopH_40_rq_2_g
    buffer_load_dwordx4 v[56:59], v0, s[4:7], s23 offen offset:2048 sc1
    buffer_load_dwordx4 v[60:63], v0, s[4:7], s23 offen offset:3072 sc1
    buffer_load_dwordx4 v[64:67], v0, s[4:7], s24 offen offset:0 sc1
    buffer_load_dwordx4 v[68:71], v0, s[4:7], s24 offen offset:1024 sc1
    s_waitcnt vmcnt(3)
    v_max_u32 v3, v56, v58
    v_cmp_eq_u32 vcc, -1, v3
    s_cbranch_vccnz aloopH_40_rq_2
    s_branch aloopH_40_again
aloopH_40_rq_2_g:
    s_mov_b32 s22, 0
    s_waitcnt vmcnt(0)
    s_branch aloopH_40_nochk
aloopH_40_rq_3:
    s_sub_u32 s22, s22, 1
    s_cbranch_scc1 aloopH_40_rq_3_g
    buffer_load_dwordx4 v[60:63], v0, s[4:7], s23 offen offset:3072 sc1
    buffer_load_dwordx4 v[64:67], v0, s[4:7], s24 offen offset:0 sc1
    buffer_load_dwordx4 v[68:71], v0, s[4:7], s24 offen offset:1024 sc1
    s_waitcnt vmcnt(2)
    v_max_u32 v3, v60, v62
    v_cmp_eq_u32 vcc, -1, v3
    s_cbranch_vccnz aloopH_40_rq_3
    s_branch aloopH_40_again
aloopH_40_rq_3_g:
    s_mov_b32 s22, 0
    s_waitcnt vmcnt(0)
    s_branch aloopH_40_nochk
aloopH_40_again:
    s_waitcnt vmcnt(5)
    v_mfma_f32_16x16x32_bf16 v[12:15], v[96:99], v[48:51], 0
    v_mfma_f32_16x16x32_bf16 v[16:19], v[112:115], v[48:51], 0
    v_max_u32 v3, v48, v50
    v_cmp_eq_u32 vcc, -1, v3
    v_mfma_f32_16x16x32_bf16 v[20:23], v[48:51], v[48:51], 0
    s_cbranch_vccnz aloopH_40_rq_0
    s_waitcnt vmcnt(4)
    v_mfma_f32_16x16x32_bf16 v[12:15], v[100:103], v[52:55], v[12:15]
    v_mfma_f32_16x16x32_bf16 v[16:19], v[116:119], v[52:55], v[16:19]
    v_max_u32 v3, v52, v54
    v_cmp_eq_u32 vcc, -1, v3
    v_mfma_f32_16x16x32_bf16 v[20:23], v[52:55], v[52:55], v[20:23]
    s_cbranch_vccnz aloopH_40_rq_1
    s_waitcnt vmcnt(3)
    v_mfma_f32_16x16x32_bf16 v[12:15], v[104:107], v[56:59], v[12:15]
    v_mfma_f32_16x16x32_bf16 v[16:19], v[120:123], v[56:59], v[16:19]
    v_max_u32 v3, v56, v58
    v_cmp_eq_u32 vcc, -1, v3
    v_mfma_f32_16x16x32_bf16 v[20:23], v[56:59], v[56:59], v[20:23]
    s_cbranch_vccnz aloopH_40_rq_2
    s_waitcnt vmcnt(2)
    v_mfma_f32_16x16x32_bf16 v[12:15], v[108:111], v[60:63], v[12:15]
    v_mfma_f32_16x16x32_bf16 v[16:19], v[124:127], v[60:63], v[16:19]
    v_max_u32 v3, v60, v62
    v_cmp_eq_u32 vcc, -1, v3
    v_mfma_f32_16x16x32_bf16 v[20:23], v[60:63], v[60:63], v[20:23]
    s_cbranch_vccnz aloopH_40_rq_3
    s_branch aloopH_40_sdone
aloopH_40_rq_v:
    s_sub_u32 s22, s22, 1
    s_cbranch_scc1 aloopH_40_rq_vg
    buffer_load_dwordx4 v[64:67], v0, s[4:7], s24 offen offset:0 sc1
    buffer_load_dwordx4 v[68:71], v0, s[4:7], s24 offen offset:1024 sc1
    s_waitcnt vmcnt(0)
    v_max3_u32 v188, v64, v66, v68
    v_max_u32 v188, v188, v70
    v_cmp_eq_u32 vcc, -1, v188
    s_cbranch_vccnz aloopH_40_rq_v
    s_branch aloopH_40_vok
aloopH_40_rq_vg:
    s_mov_b32 s22, 0
    s_branch aloopH_40_vok
aloopH_40_nochk:
    v_mfma_f32_16x16x32_bf16 v[12:15], v[96:99], v[48:51], 0
    v_mfma_f32_16x16x32_bf16 v[16:19], v[112:115], v[48:51], 0
    v_mfma_f32_16x16x32_bf16 v[20:23], v[48:51], v[48:51], 0
    v_mfma_f32_16x16x32_bf16 v[12:15], v[100:103], v[52:55], v[12:15]
    v_mfma_f32_16x16x32_bf16 v[16:19], v[116:119], v[52:55], v[16:19]
    v_mfma_f32_16x16x32_bf16 v[20:23], v[52:55], v[52:55], v[20:23]
    v_mfma_f32_16x16x32_bf16 v[12:15], v[104:107], v[56:59], v[12:15]
    v_mfma_f32_16x16x32_bf16 v[16:19], v[120:123], v[56:59], v[16:19]
    v_mfma_f32_16x16x32_bf16 v[20:23], v[56:59], v[56:59], v[20:23]
    v_mfma_f32_16x16x32_bf16 v[12:15], v[108:111], v[60:63], v[12:15]
    v_mfma_f32_16x16x32_bf16 v[16:19], v[124:127], v[60:63], v[16:19]
    v_mfma_f32_16x16x32_bf16 v[20:23], v[60:63], v[60:63], v[20:23]
    s_nop 1
    s_branch aloopH_40_sdone
aloopH_40_rq_v2:
    s_sub_u32 s22, s22, 1
    s_cbranch_scc1 aloopH_40_rq_v2g
    buffer_load_dwordx4 v[64:67], v0, s[4:7], s24 offen offset:0 sc1
    buffer_load_dwordx4 v[68:71], v0, s[4:7], s24 offen offset:1024 sc1
    s_waitcnt vmcnt(0)
    v_max3_u32 v188, v64, v66, v68
    v_max_u32 v188, v188, v70
    v_cmp_eq_u32 vcc, -1, v188
    s_cbranch_vccnz aloopH_40_rq_v2
    s_branch aloopH_40_lsk3
aloopH_40_rq_v2g:
    s_mov_b32 s22, 0
    s_branch aloopH_40_lsk3
ct_tail:
aloopH_40_lsk:
    s_cmp_lg_u32 s27, 0
    s_cbranch_scc1 aloopH_40_lsk2
    v_mov_b32 v3, 62
    s_mov_b64 exec, 1
    buffer_store_dword v3, off, s[4:7], s28 sc1
    s_mov_b64 exec, -1
aloopH_40_lsk2:
    s_waitcnt vmcnt(0)
    v_max3_u32 v188, v64, v66, v68
    v_max_u32 v188, v188, v70
    v_cmp_eq_u32 vcc, -1, v188
    s_cbranch_vccnz aloopH_40_rq_v2
aloopH_40_lsk3:
    v_smfmac_f32_16x16x64_bf16 v[24:27], v[64:67], v[192:199], v166
    v_smfmac_f32_16x16x64_bf16 v[32:35], v[64:67], v[224:231], v166
    v_smfmac_f32_16x16x64_bf16 v[28:31], v[64:67], v[208:215], v166
    v_smfmac_f32_16x16x64_bf16 v[36:39], v[64:67], v[240:247], v166
    v_smfmac_f32_16x16x64_bf16 v[24:27], v[68:71], v[200:207], v166
    v_smfmac_f32_16x16x64_bf16 v[32:35], v[68:71], v[232:239], v166
    v_smfmac_f32_16x16x64_bf16 v[28:31], v[68:71], v[216:223], v166
    v_smfmac_f32_16x16x64_bf16 v[36:39], v[68:71], v[248:255], v166
    s_nop 7
    s_nop 1
    v_cvt_pk_bf16_f32 v40, v24, v25
    v_cvt_pk_bf16_f32 v41, v26, v27
    v_cvt_pk_bf16_f32 v42, v28, v29
    v_cvt_pk_bf16_f32 v43, v30, v31
    v_cvt_pk_bf16_f32 v44, v32, v33
    v_cvt_pk_bf16_f32 v45, v34, v35
    v_cvt_pk_bf16_f32 v46, v36, v37
    v_cvt_pk_bf16_f32 v47, v38, v39
    s_waitcnt lgkmcnt(0)
    s_branch aloopH_40_lskb
k_end:
k_exit:
    s_endpgm
.section .rodata,"a"
.p2align 6
jobtab:
    .long 4, 24, 24, 8192, 0, 262144, 8388608, 0, 32768, 4, 20971520, 131072, 0, 0, 218104321, 0
    .long 4, 24, 24, 8192, 256, 262400, 8388608, 0, 32768, 4, 20975616, 131072, 0, 0, 218104321, 0
    .long 4, 24, 24, 8192, 512, 262656, 8388608, 0, 32768, 4, 20979712, 131072, 0, 0, 218104321, 0
    .long 4, 24, 24, 8192, 768, 262912, 8388608, 0, 32768, 4, 20983808, 131072, 0, 0, 218104321, 0
    .long 4, 24, 24, 8192, 1024, 263168, 8388608, 0, 32768, 4, 20987904, 131072, 0, 0, 218104337, 0
    .long 4, 24, 24, 8192, 1280, 263424, 8388608, 0, 32768, 4, 20992000, 131072, 0, 0, 218104337, 0
    .long 4, 24, 24, 8192, 1536, 263680, 8388608, 0, 32768, 4, 20996096, 131072, 0, 0, 218104337, 0
    .long 4, 24, 24, 8192, 1792, 263936, 8388608, 0, 32768, 4, 21000192, 131072, 0, 0, 218104337, 0
    .long 4, 32, 32, 8192, 0, 262144, 8388608, 0, 32768, 4, 37748736, 131072, 0, 0, 218104321, 0
    .long 4, 32, 32, 8192, 256, 262400, 8388608, 0, 32768, 4, 37752832, 131072, 0, 0, 218104321, 0
    .long 4, 32, 32, 8192, 512, 262656, 8388608, 0, 32768, 4, 37756928, 131072, 0, 0, 218104321, 0
    .long 4, 32, 32, 8192, 768, 262912, 8388608, 0, 32768, 4, 37761024, 131072, 0, 0, 218104321, 0
    .long 4, 32, 32, 8192, 1024, 263168, 8388608, 0, 32768, 4, 37765120, 131072, 0, 0, 218104337, 0
    .long 4, 32, 32, 8192, 1280, 263424, 8388608, 0, 32768, 4, 37769216, 131072, 0, 0, 218104337, 0
    .long 4, 32, 32, 8192, 1536, 263680, 8388608, 0, 32768, 4, 37773312, 131072, 0, 0, 218104337, 0
    .long 4, 32, 32, 8192, 1792, 263936, 8388608, 0, 32768, 4, 37777408, 131072, 0, 0, 218104337, 0
    .long 4, 24, 24, 8192, 0, 262144, 8388608, 262144, 32768, 4, 22020096, 131072, 0, 0, 218104324, 0
    .long 4, 24, 24, 8192, 256, 262400, 8388608, 262144, 32768, 4, 22024192, 131072, 0, 0, 218104324, 0
    .long 4, 24, 24, 8192, 512, 262656, 8388608, 262144, 32768, 4, 22028288, 131072, 0, 0, 218104324, 0
    .long 4, 24, 24, 8192, 768, 262912, 8388608, 262144, 32768, 4, 22032384, 131072, 0, 0, 218104324, 0
    .long 4, 24, 24, 8192, 1024, 263168, 8388608, 262144, 32768, 4, 22036480, 131072, 0, 0, 218104340, 0
    .long 4, 24, 24, 8192, 1280, 263424, 8388608, 262144, 32768, 4, 22040576, 131072, 0, 0, 218104340, 0
    .long 4, 24, 24, 8192, 1536, 263680, 8388608, 262144, 32768, 4, 22044672, 131072, 0, 0, 218104340, 0
    .long 4, 24, 24, 8192, 1792, 263936, 8388608, 262144, 32768, 4, 22048768, 131072, 0, 0, 218104340, 0
    .long 4, 32, 32, 8192, 0, 262144, 8388608, 262144, 32768, 4, 38797312, 131072, 0, 0, 218104324, 0
    .long 4, 32, 32, 8192, 256, 262400, 8388608, 262144, 32768, 4, 38801408, 131072, 0, 0, 218104324, 0
    .long 4, 32, 32, 8192, 512, 262656, 8388608, 262144, 32768, 4, 38805504, 131072, 0, 0, 218104324, 0
    .long 4, 32, 32, 8192, 768, 262912, 8388608, 262144, 32768, 4, 38809600, 131072, 0, 0, 218104324, 0
    .long 4, 32, 32, 8192, 1024, 263168, 8388608, 262144, 32768, 4, 38813696, 131072, 0, 0, 218104340, 0
    .long 4, 32, 32, 8192, 1280, 263424, 8388608, 262144, 32768, 4, 38817792, 131072, 0, 0, 218104340, 0
    .long 4, 32, 32, 8192, 1536, 263680, 8388608, 262144, 32768, 4, 38821888, 131072, 0, 0, 218104340, 0
    .long 4, 32, 32, 8192, 1792, 263936, 8388608, 262144, 32768, 4, 38825984, 131072, 0, 0, 218104340, 0
    .long 4, 32, 32, 8192, 256, 262400, 8388608, 786432, 32768, 4, 40898560, 131072, 0, 0, 218104580, 0
    .long 4, 24, 24, 8192, 512, 262656, 8388608, 786432, 32768, 4, 24125440, 131072, 0, 0, 218104580, 0
    .long 4, 24, 24, 8192, 1536, 263680, 8388608, 786432, 32768, 4, 24141824, 131072, 0, 0, 218104596, 0
    .long 4, 32, 32, 8192, 768, 262912, 8388608, 524288, 32768, 4, 39858176, 131072, 0, 0, 218104577, 0
    .long 4, 32, 32, 8192, 1536, 263680, 8388608, 786432, 32768, 4, 40919040, 131072, 0, 0, 218104596, 0
    .long 4, 32, 32, 8192, 1280, 263424, 8388608, 524288, 32768, 4, 39866368, 131072, 0, 0, 218104593, 0
    .long 4, 24, 24, 8192, 1024, 263168, 8388608, 786432, 32768, 4, 24133632, 131072, 0, 0, 218104596, 0
    .long 4, 32, 32, 8192, 1792, 263936, 8388608, 524288, 32768, 4, 39874560, 131072, 0, 0, 218104593, 0
    .long 4, 32, 32, 8192, 512, 262656, 8388608, 786432, 32768, 4, 40902656, 131072, 0, 0, 218104580, 0
    .long 4, 32, 32, 8192, 512, 262656, 8388608, 524288, 32768, 4, 39854080, 131072, 0, 0, 218104577, 0
    .long 4, 32, 32, 8192, 1024, 263168, 8388608, 786432, 32768, 4, 40910848, 131072, 0, 0, 218104596, 0
    .long 4, 24, 24, 8192, 768, 262912, 8388608, 524288, 32768, 4, 23080960, 131072, 0, 0, 218104577, 0
    .long 2, 64, 72, 7168, 0, 0, 7340032, 1048576, 32768, 8, 58195968, 114688, 0, 0, 218103937, 0
    .long 4, 24, 24, 8192, 256, 262400, 8388608, 786432, 32768, 4, 24121344, 131072, 0, 0, 218104580, 0
    .long 4, 24, 24, 8192, 1280, 263424, 8388608, 524288, 32768, 4, 23089152, 131072, 0, 0, 218104593, 0
    .long 4, 32, 32, 8192, 256, 262400, 8388608, 524288, 32768, 4, 39849984, 131072, 0, 0, 218104577, 0
    .long 4, 32, 32, 8192, 1792, 263936, 8388608, 786432, 32768, 4, 40923136, 131072, 0, 0, 218104596, 0
    .long 4, 24, 24, 8192, 0, 262144, 8388608, 524288, 32768, 4, 23068672, 131072, 0, 0, 218104577, 0
    .long 4, 24, 24, 8192, 1536, 263680, 8388608, 524288, 32768, 4, 23093248, 131072, 0, 0, 218104593, 0
    .long 4, 32, 32, 8192, 0, 262144, 8388608, 524288, 32768, 4, 39845888, 131072, 0, 0, 218104577, 0
    .long 4, 24, 24, 8192, 1792, 263936, 8388608, 524288, 32768, 4, 23097344, 131072, 0, 0, 218104593, 0
    .long 4, 32, 32, 8192, 0, 262144, 8388608, 786432, 32768, 4, 40894464, 131072, 0, 0, 218104580, 0
    .long 4, 24, 24, 8192, 768, 262912, 8388608, 786432, 32768, 4, 24129536, 131072, 0, 0, 218104580, 0
    .long 4, 32, 32, 8192, 768, 262912, 8388608, 786432, 32768, 4, 40906752, 131072, 0, 0, 218104580, 0
    .long 4, 32, 32, 8192, 1536, 263680, 8388608, 524288, 32768, 4, 39870464, 131072, 0, 0, 218104593, 0
    .long 4, 24, 24, 8192, 1024, 263168, 8388608, 524288, 32768, 4, 23085056, 131072, 0, 0, 218104593, 0
    .long 4, 32, 32, 8192, 1280, 263424, 8388608, 786432, 32768, 4, 40914944, 131072, 0, 0, 218104596, 0
    .long 4, 24, 24, 8192, 256, 262400, 8388608, 524288, 32768, 4, 23072768, 131072, 0, 0, 218104577, 0
    .long 4, 32, 32, 8192, 1024, 263168, 8388608, 524288, 32768, 4, 39862272, 131072, 0, 0, 218104593, 0
    .long 4, 24, 24, 8192, 512, 262656, 8388608, 524288, 32768, 4, 23076864, 131072, 0, 0, 218104577, 0
    .long 4, 24, 24, 8192, 1280, 263424, 8388608, 786432, 32768, 4, 24137728, 131072, 0, 0, 218104596, 0
    .long 4, 24, 24, 8192, 0, 262144, 8388608, 786432, 32768, 4, 24117248, 131072, 0, 0, 218104580, 0
    .long 1, 32, 32, 8192, 1024, 1280, 8388608, 1048576, 32768, 8, 41959424, 131072, 0, 0, 218104858, 0
    .long 1, 24, 24, 8192, 512, 768, 8388608, 1048576, 32768, 8, 25174016, 131072, 0, 0, 218104842, 0
    .long 1, 16, 16, 8192, 512, 768, 8388608, 1048576, 32768, 8, 8396800, 131072, 0, 0, 218104842, 0
    .long 1, 24, 24, 8192, 1024, 1280, 8388608, 1048576, 32768, 8, 25182208, 131072, 0, 0, 218104858, 0
    .long 4, 24, 24, 8192, 1792, 263936, 8388608, 786432, 32768, 4, 24145920, 131072, 0, 0, 218104596, 0
    .long 1, 16, 16, 8192, 0, 256, 8388608, 1048576, 32768, 8, 8388608, 131072, 0, 0, 218104842, 0
    .long 1, 24, 24, 8192, 512, 768, 8388608, 1572864, 32768, 8, 27271168, 131072, 0, 0, 218105098, 0
    .long 1, 32, 32, 8192, 1024, 1280, 8388608, 1572864, 32768, 8, 44056576, 131072, 0, 0, 218105114, 0
    .long 1, 24, 24, 8192, 0, 256, 8388608, 1048576, 32768, 8, 25165824, 131072, 0, 0, 218104842, 0
    .long 1, 32, 32, 8192, 512, 768, 8388608, 1048576, 32768, 8, 41951232, 131072, 0, 0, 218104842, 0
    .long 1, 16, 16, 8192, 1536, 1792, 8388608, 1572864, 32768, 8, 10510336, 131072, 0, 0, 218105114, 0
    .long 1, 16, 16, 8192, 0, 256, 8388608, 0, 32768, 8, 4194304, 131072, 0, 0, 218107914, 0
    .long 1, 24, 24, 8192, 1024, 1280, 8388608, 1572864, 32768, 8, 27279360, 131072, 0, 0, 218105114, 0
    .long 1, 32, 32, 8192, 1536, 1792, 8388608, 1572864, 32768, 8, 44064768, 131072, 0, 0, 218105114, 0
    .long 1, 32, 32, 8192, 0, 256, 8388608, 1048576, 32768, 8, 41943040, 131072, 0, 0, 218104842, 0
    .long 1, 16, 16, 8192, 1024, 1280, 8388608, 1572864, 32768, 8, 10502144, 131072, 0, 0, 218105114, 0
    .long 1, 32, 32, 8192, 1536, 1792, 8388608, 1048576, 32768, 8, 41967616, 131072, 0, 0, 218104858, 0
    .long 1, 24, 24, 8192, 1536, 1792, 8388608, 1572864, 32768, 8, 27287552, 131072, 0, 0, 218105114, 0
    .long 1, 16, 16, 8192, 1536, 1792, 8388608, 1048576, 32768, 8, 8413184, 131072, 0, 0, 218104858, 0
    .long 1, 32, 32, 8192, 0, 256, 8388608, 1572864, 32768, 8, 44040192, 131072, 0, 0, 218105098, 0
    .long 1, 16, 16, 8192, 1536, 1792, 8388608, 0, 32768, 8, 4218880, 131072, 0, 0, 218107930, 0
    .long 1, 16, 16, 8192, 512, 768, 8388608, 2097152, 32768, 8, 12591104, 131072, 0, 0, 218105354, 0
    .long 1, 16, 16, 8192, 1024, 1280, 8388608, 1048576, 32768, 8, 8404992, 131072, 0, 0, 218104858, 0
    .long 1, 16, 16, 8192, 0, 256, 8388608, 1572864, 32768, 8, 10485760, 131072, 0, 0, 218105098, 0
    .long 1, 32, 32, 8192, 0, 256, 8388608, 2097152, 32768, 8, 46137344, 131072, 0, 0, 218105354, 0
    .long 1, 16, 16, 8192, 512, 768, 8388608, 0, 32768, 8, 4202496, 131072, 0, 0, 218107914, 0
    .long 1, 24, 24, 8192, 1536, 1792, 8388608, 1048576, 32768, 8, 25190400, 131072, 0, 0, 218104858, 0
    .long 1, 16, 16, 8192, 512, 768, 8388608, 1572864, 32768, 8, 10493952, 131072, 0, 0, 218105098, 0
    .long 1, 16, 16, 8192, 1024, 1280, 8388608, 0, 32768, 8, 4210688, 131072, 0, 0, 218107930, 0
    .long 1, 32, 32, 8192, 512, 768, 8388608, 2097152, 32768, 8, 46145536, 131072, 0, 0, 218105354, 0
    .long 1, 32, 32, 8192, 512, 768, 8388608, 1572864, 32768, 8, 44048384, 131072, 0, 0, 218105098, 0
    .long 1, 24, 24, 8192, 0, 256, 8388608, 1572864, 32768, 8, 27262976, 131072, 0, 0, 218105098, 0
    .long 1, 16, 16, 8192, 0, 256, 8388608, 524288, 32768, 8, 6291456, 131072, 0, 0, 218108170, 0
    .long 1, 32, 32, 8192, 1024, 1280, 8388608, 3670016, 32768, 8, 52445184, 131072, 0, 0, 218106138, 0
    .long 1, 16, 16, 8192, 1024, 1280, 8388608, 2621440, 32768, 8, 14696448, 131072, 0, 0, 218105626, 0
    .long 1, 24, 24, 8192, 512, 768, 8388608, 3145728, 32768, 8, 33562624, 131072, 0, 0, 218105866, 0
    .long 1, 16, 16, 8192, 0, 256, 8388608, 2621440, 32768, 8, 14680064, 131072, 0, 0, 218105610, 0
    .long 1, 32, 32, 8192, 1536, 1792, 8388608, 3670016, 32768, 8, 52453376, 131072, 0, 0, 218106138, 0
    .long 1, 16, 16, 8192, 0, 256, 8388608, 3145728, 32768, 8, 16777216, 131072, 0, 0, 218105866, 0
    .long 1, 24, 24, 8192, 1024, 1280, 8388608, 2097152, 32768, 8, 29376512, 131072, 0, 0, 218105370, 0
    .long 1, 16, 16, 8192, 1536, 1792, 8388608, 2097152, 32768, 8, 12607488, 131072, 0, 0, 218105370, 0
    .long 1, 24, 24, 8192, 512, 768, 8388608, 3670016, 32768, 8, 35659776, 131072, 0, 0, 218106122, 0
    .long 1, 24, 24, 8192, 1536, 1792, 8388608, 3145728, 32768, 8, 33579008, 131072, 0, 0, 218105882, 0
    .long 1, 32, 32, 8192, 1536, 1792, 8388608, 2621440, 32768, 8, 48259072, 131072, 0, 0, 218105626, 0
    .long 1, 32, 32, 8192, 1536, 1792, 8388608, 2097152, 32768, 8, 46161920, 131072, 0, 0, 218105370, 0
    .long 1, 24, 24, 8192, 1536, 1792, 8388608, 2097152, 32768, 8, 29384704, 131072, 0, 0, 218105370, 0
    .long 1, 24, 24, 8192, 0, 256, 8388608, 2097152, 32768, 8, 29360128, 131072, 0, 0, 218105354, 0
    .long 1, 32, 32, 8192, 1536, 1792, 8388608, 3145728, 32768, 8, 50356224, 131072, 0, 0, 218105882, 0
    .long 1, 32, 32, 8192, 0, 256, 8388608, 3145728, 32768, 8, 50331648, 131072, 0, 0, 218105866, 0
    .long 1, 16, 16, 8192, 1024, 1280, 8388608, 3145728, 32768, 8, 16793600, 131072, 0, 0, 218105882, 0
    .long 1, 16, 16, 8192, 1024, 1280, 8388608, 2097152, 32768, 8, 12599296, 131072, 0, 0, 218105370, 0
    .long 5, 218107920, 0, 0, 4, 0, 0, 0, 0, 0, 0, 0, 218112000, 4, 218106881, 0
    .long 1, 32, 32, 8192, 1024, 1280, 8388608, 3145728, 32768, 8, 50348032, 131072, 0, 0, 218105882, 0
    .long 1, 24, 24, 8192, 1536, 1792, 8388608, 3670016, 32768, 8, 35676160, 131072, 0, 0, 218106138, 0
    .long 1, 32, 32, 8192, 0, 256, 8388608, 2621440, 32768, 8, 48234496, 131072, 0, 0, 218105610, 0
    .long 1, 32, 32, 8192, 1024, 1280, 8388608, 2097152, 32768, 8, 46153728, 131072, 0, 0, 218105370, 0
    .long 1, 24, 24, 8192, 512, 768, 8388608, 2621440, 32768, 8, 31465472, 131072, 0, 0, 218105610, 0
    .long 1, 24, 24, 8192, 512, 768, 8388608, 2097152, 32768, 8, 29368320, 131072, 0, 0, 218105354, 0
    .long 1, 16, 16, 8192, 1536, 1792, 8388608, 524288, 32768, 8, 6316032, 131072, 0, 0, 218108186, 0
    .long 1, 32, 32, 8192, 1024, 1280, 8388608, 2621440, 32768, 8, 48250880, 131072, 0, 0, 218105626, 0
    .long 1, 16, 16, 8192, 1024, 1280, 8388608, 524288, 32768, 8, 6307840, 131072, 0, 0, 218108186, 0
    .long 1, 24, 24, 8192, 0, 256, 8388608, 2621440, 32768, 8, 31457280, 131072, 0, 0, 218105610, 0
    .long 1, 16, 16, 8192, 0, 256, 8388608, 2097152, 32768, 8, 12582912, 131072, 0, 0, 218105354, 0
    .long 5, 218107920, 0, 0, 4, 0, 0, 4, 0, 0, 0, 0, 218112000, 8, 218106881, 0
    .long 5, 218107904, 0, 0, 0, 0, 0, 0, 0, 0, 0, 0, 218112000, 4, 218106881, 0
    .long 1, 24, 24, 8192, 1024, 1280, 8388608, 3670016, 32768, 8, 35667968, 131072, 0, 0, 218106138, 0
    .long 2, 64, 72, 7168, 0, 0, 7340032, 2097152, 32768, 8, 61865984, 114688, 0, 0, 218104065, 0
    .long 1, 24, 24, 8192, 1536, 1792, 8388608, 2621440, 32768, 8, 31481856, 131072, 0, 0, 218105626, 0
    .long 2, 64, 72, 7168, 256, 256, 7340032, 0, 32768, 8, 54530048, 114688, 0, 0, 218103809, 0
    .long 1, 24, 24, 8192, 0, 256, 8388608, 3670016, 32768, 8, 35651584, 131072, 0, 0, 218106122, 0
    .long 1, 32, 32, 8192, 512, 768, 8388608, 3670016, 32768, 8, 52436992, 131072, 0, 0, 218106122, 0
    .long 2, 64, 72, 7168, 1024, 1024, 7340032, 2621440, 32768, 8, 63717376, 114688, 0, 0, 218104129, 0
    .long 1, 32, 32, 8192, 512, 768, 8388608, 2621440, 32768, 8, 48242688, 131072, 0, 0, 218105610, 0
    .long 1, 16, 16, 8192, 512, 768, 8388608, 2621440, 32768, 8, 14688256, 131072, 0, 0, 218105610, 0
    .long 2, 64, 72, 7168, 0, 0, 7340032, 0, 32768, 8, 54525952, 114688, 0, 0, 218103809, 0
    .long 1, 16, 16, 8192, 1536, 1792, 8388608, 3145728, 32768, 8, 16801792, 131072, 0, 0, 218105882, 0
    .long 1, 24, 24, 8192, 1024, 1280, 8388608, 2621440, 32768, 8, 31473664, 131072, 0, 0, 218105626, 0
    .long 2, 64, 72, 7168, 256, 256, 7340032, 524288, 32768, 8, 56365056, 114688, 0, 0, 218103873, 0
    .long 1, 24, 24, 8192, 0, 256, 8388608, 3145728, 32768, 8, 33554432, 131072, 0, 0, 218105866, 0
    .long 2, 64, 72, 7168, 768, 768, 7340032, 0, 32768, 8, 54538240, 114688, 0, 0, 218103809, 0
    .long 2, 64, 72, 7168, 768, 768, 7340032, 524288, 32768, 8, 56373248, 114688, 0, 0, 218103873, 0
    .long 2, 64, 72, 7168, 512, 512, 7340032, 2097152, 32768, 8, 61874176, 114688, 0, 0, 218104065, 0
    .long 2, 64, 72, 7168, 1024, 1024, 7340032, 2097152, 32768, 8, 61882368, 114688, 0, 0, 218104065, 0
    .long 1, 16, 16, 8192, 512, 768, 8388608, 524288, 32768, 8, 6299648, 131072, 0, 0, 218108170, 0
    .long 1, 16, 16, 8192, 512, 768, 8388608, 3145728, 32768, 8, 16785408, 131072, 0, 0, 218105866, 0
    .long 2, 64, 72, 7168, 1024, 1024, 7340032, 0, 32768, 8, 54542336, 114688, 0, 0, 218103809, 0
    .long 2, 64, 72, 7168, 1280, 1280, 7340032, 0, 32768, 8, 54546432, 114688, 0, 0, 218103809, 0
    .long 1, 16, 16, 8192, 1536, 1792, 8388608, 2621440, 32768, 8, 14704640, 131072, 0, 0, 218105626, 0
    .long 1, 24, 24, 8192, 1024, 1280, 8388608, 3145728, 32768, 8, 33570816, 131072, 0, 0, 218105882, 0
    .long 2, 64, 72, 7168, 1280, 1280, 7340032, 3145728, 32768, 8, 65556480, 114688, 0, 0, 218104193, 0
    .long 1, 32, 32, 8192, 512, 768, 8388608, 3145728, 32768, 8, 50339840, 131072, 0, 0, 218105866, 0
    .long 1, 16, 16, 8192, 1536, 1792, 8388608, 3670016, 32768, 8, 18898944, 131072, 0, 0, 218106138, 0
    .long 2, 64, 72, 7168, 1536, 1536, 7340032, 0, 32768, 8, 54550528, 114688, 0, 0, 218103809, 0
    .long 2, 64, 72, 7168, 512, 512, 7340032, 0, 32768, 8, 54534144, 114688, 0, 0, 218103809, 0
    .long 5, 218107904, 0, 0, 0, 0, 0, 4, 0, 0, 0, 0, 218112000, 8, 218106881, 0
    .long 2, 64, 72, 7168, 1536, 1536, 7340032, 3145728, 32768, 8, 65560576, 114688, 0, 0, 218104193, 0
    .long 2, 64, 72, 7168, 0, 0, 7340032, 524288, 32768, 8, 56360960, 114688, 0, 0, 218103873, 0
    .long 2, 64, 72, 7168, 1280, 1280, 7340032, 1572864, 32768, 8, 60051456, 114688, 0, 0, 218104001, 0
    .long 2, 64, 72, 7168, 1536, 1536, 7340032, 524288, 32768, 8, 56385536, 114688, 0, 0, 218103873, 0
    .long 1, 16, 16, 8192, 0, 256, 8388608, 3670016, 32768, 8, 18874368, 131072, 0, 0, 218106122, 0
    .long 5, 218108176, 0, 0, 4, 0, 0, 8, 0, 0, 0, 0, 218112000, 12, 218106945, 0
    .long 2, 64, 72, 7168, 0, 0, 7340032, 3145728, 32768, 8, 65536000, 114688, 0, 0, 218104193, 0
    .long 2, 64, 72, 7168, 512, 512, 7340032, 1572864, 32768, 8, 60039168, 114688, 0, 0, 218104001, 0
    .long 2, 64, 72, 7168, 768, 768, 7340032, 2097152, 32768, 8, 61878272, 114688, 0, 0, 218104065, 0
    .long 2, 64, 72, 7168, 0, 0, 7340032, 1572864, 32768, 8, 60030976, 114688, 0, 0, 218104001, 0
    .long 2, 64, 72, 7168, 768, 768, 7340032, 1572864, 32768, 8, 60043264, 114688, 0, 0, 218104001, 0
    .long 2, 64, 72, 7168, 1536, 1536, 7340032, 1572864, 32768, 8, 60055552, 114688, 0, 0, 218104001, 0
    .long 2, 64, 72, 7168, 256, 256, 7340032, 1572864, 32768, 8, 60035072, 114688, 0, 0, 218104001, 0
    .long 2, 64, 72, 7168, 256, 256, 7340032, 2097152, 32768, 8, 61870080, 114688, 0, 0, 218104065, 0
    .long 2, 64, 72, 7168, 1280, 1280, 7340032, 2097152, 32768, 8, 61886464, 114688, 0, 0, 218104065, 0
    .long 2, 64, 72, 7168, 512, 512, 7340032, 524288, 32768, 8, 56369152, 114688, 0, 0, 218103873, 0
    .long 2, 64, 72, 7168, 1536, 1536, 7340032, 2097152, 32768, 8, 61890560, 114688, 0, 0, 218104065, 0
    .long 2, 64, 72, 7168, 1024, 1024, 7340032, 1572864, 32768, 8, 60047360, 114688, 0, 0, 218104001, 0
    .long 2, 64, 72, 7168, 256, 256, 7340032, 1048576, 32768, 8, 58200064, 114688, 0, 0, 218103937, 0
    .long 2, 64, 72, 7168, 1024, 1024, 7340032, 1048576, 32768, 8, 58212352, 114688, 0, 0, 218103937, 0
    .long 2, 64, 72, 7168, 512, 512, 7340032, 3145728, 32768, 8, 65544192, 114688, 0, 0, 218104193, 0
    .long 2, 64, 72, 7168, 1280, 1280, 7340032, 1048576, 32768, 8, 58216448, 114688, 0, 0, 218103937, 0
    .long 5, 218108176, 0, 0, 4, 0, 0, 12, 0, 0, 0, 0, 218112000, 16, 218106945, 0
    .long 2, 64, 72, 7168, 1536, 1536, 7340032, 1048576, 32768, 8, 58220544, 114688, 0, 0, 218103937, 0
    .long 2, 64, 72, 7168, 1024, 1024, 7340032, 3145728, 32768, 8, 65552384, 114688, 0, 0, 218104193, 0
    .long 2, 64, 72, 7168, 1280, 1280, 7340032, 524288, 32768, 8, 56381440, 114688, 0, 0, 218103873, 0
    .long 2, 64, 72, 7168, 768, 768, 7340032, 1048576, 32768, 8, 58208256, 114688, 0, 0, 218103937, 0
    .long 2, 64, 72, 7168, 512, 512, 7340032, 1048576, 32768, 8, 58204160, 114688, 0, 0, 218103937, 0
    .long 2, 64, 72, 7168, 256, 256, 7340032, 3145728, 32768, 8, 65540096, 114688, 0, 0, 218104193, 0
    .long 5, 218108160, 0, 0, 0, 0, 0, 12, 0, 0, 0, 0, 218112000, 16, 218106945, 0
    .long 2, 64, 72, 7168, 768, 768, 7340032, 3670016, 32768, 8, 67383296, 114688, 0, 0, 218104257, 0
    .long 2, 64, 72, 7168, 1024, 1024, 7340032, 524288, 32768, 8, 56377344, 114688, 0, 0, 218103873, 0
    .long 1, 80, 80, 2048, 512, 768, 7340032, 54525952, 114688, 14, 117448704, 32768, 218103808, 14, 218106370, 0
    .long 1, 40, 40, 2048, 0, 256, 8388608, 176160768, 131072, 16, 75497472, 32768, 218106880, 8, 218106376, 0
    .long 5, 218108160, 0, 0, 0, 0, 0, 8, 0, 0, 0, 0, 218112000, 12, 218106945, 0
    .long 1, 32, 32, 8192, 0, 256, 8388608, 3670016, 32768, 8, 52428800, 131072, 0, 0, 218106122, 0
    .long 1, 16, 16, 8192, 512, 768, 8388608, 3670016, 32768, 8, 18882560, 131072, 0, 0, 218106122, 0
    .long 1, 16, 16, 8192, 1024, 1280, 8388608, 3670016, 32768, 8, 18890752, 131072, 0, 0, 218106138, 0
    .long 1, 40, 40, 2048, 512, 768, 8388608, 182452224, 131072, 16, 77078528, 32768, 218112000, 33, 218106568, 0
    .long 1, 40, 40, 2048, 512, 768, 8388608, 176160768, 131072, 16, 75505664, 32768, 218106880, 8, 218106376, 0
    .long 2, 64, 72, 7168, 768, 768, 7340032, 3145728, 32768, 8, 65548288, 114688, 0, 0, 218104193, 0
    .long 1, 40, 40, 2048, 0, 256, 8388608, 180355072, 131072, 16, 76546048, 32768, 218112000, 25, 218106504, 0
    .long 1, 40, 40, 2048, 512, 768, 8388608, 180355072, 131072, 16, 76554240, 32768, 218112000, 25, 218106504, 0
    .long 2, 64, 72, 7168, 1280, 1280, 7340032, 2621440, 32768, 8, 63721472, 114688, 0, 0, 218104129, 0
    .long 1, 40, 40, 2048, 0, 256, 8388608, 182452224, 131072, 16, 77070336, 32768, 218112000, 33, 218106568, 0
    .long 2, 64, 72, 7168, 0, 0, 7340032, 2621440, 32768, 8, 63700992, 114688, 0, 0, 218104129, 0
    .long 1, 80, 80, 2048, 0, 256, 7340032, 54525952, 114688, 14, 117440512, 32768, 218103808, 14, 218106370, 0
    .long 2, 64, 72, 7168, 1536, 1536, 7340032, 2621440, 32768, 8, 63725568, 114688, 0, 0, 218104129, 0
    .long 2, 64, 72, 7168, 256, 256, 7340032, 2621440, 32768, 8, 63705088, 114688, 0, 0, 218104129, 0
    .long 2, 64, 72, 7168, 512, 512, 7340032, 3670016, 32768, 8, 67379200, 114688, 0, 0, 218104257, 0
    .long 2, 64, 72, 7168, 1280, 1280, 7340032, 3670016, 32768, 8, 67391488, 114688, 0, 0, 218104257, 0
    .long 1, 40, 40, 2048, 0, 256, 8388608, 178257920, 131072, 16, 76021760, 32768, 218106944, 8, 218106440, 0
    .long 1, 40, 40, 2048, 512, 768, 8388608, 178257920, 131072, 16, 76029952, 32768, 218106944, 8, 218106440, 0
    .long 2, 64, 72, 7168, 768, 768, 7340032, 2621440, 32768, 8, 63713280, 114688, 0, 0, 218104129, 0
    .long 2, 64, 72, 7168, 0, 0, 7340032, 3670016, 32768, 8, 67371008, 114688, 0, 0, 218104257, 0
    .long 2, 64, 72, 7168, 512, 512, 7340032, 2621440, 32768, 8, 63709184, 114688, 0, 0, 218104129, 0
    .long 1, 80, 80, 2048, 512, 768, 7340032, 61865984, 114688, 14, 119545856, 32768, 218104064, 14, 218106626, 0
    .long 1, 80, 80, 2048, 0, 256, 7340032, 60030976, 114688, 14, 119013376, 32768, 218104000, 14, 218106562, 0
    .long 1, 80, 80, 2048, 0, 256, 7340032, 61865984, 114688, 14, 119537664, 32768, 218104064, 14, 218106626, 0
    .long 1, 80, 80, 2048, 512, 768, 7340032, 60030976, 114688, 14, 119021568, 32768, 218104000, 14, 218106562, 0
    .long 2, 64, 72, 7168, 1024, 1024, 7340032, 3670016, 32768, 8, 67387392, 114688, 0, 0, 218104257, 0
    .long 2, 64, 72, 7168, 256, 256, 7340032, 3670016, 32768, 8, 67375104, 114688, 0, 0, 218104257, 0
    .long 1, 80, 80, 2048, 0, 256, 7340032, 58195968, 114688, 14, 118489088, 32768, 218103936, 14, 218106498, 0
    .long 1, 80, 80, 2048, 512, 768, 7340032, 58195968, 114688, 14, 118497280, 32768, 218103936, 14, 218106498, 0
    .long 2, 64, 72, 7168, 1536, 1536, 7340032, 3670016, 32768, 8, 67395584, 114688, 0, 0, 218104257, 0
    .long 1, 80, 80, 2048, 512, 768, 7340032, 56360960, 114688, 14, 117972992, 32768, 218103872, 14, 218106434, 0
    .long 1, 80, 80, 2048, 0, 256, 7340032, 56360960, 114688, 14, 117964800, 32768, 218103872, 14, 218106434, 0
    .long 1, 40, 40, 2048, 512, 768, 8388608, 184549376, 131072, 8, 77602816, 32768, 218112000, 41, 218106628, 0
    .long 1, 80, 80, 2048, 0, 256, 7340032, 65536000, 114688, 7, 120586240, 32768, 218104192, 7, 218106753, 0
    .long 1, 80, 80, 2048, 512, 768, 7340032, 65536000, 114688, 7, 120594432, 32768, 218104192, 7, 218106753, 0
    .long 1, 40, 40, 2048, 0, 256, 8388608, 184549376, 131072, 8, 77594624, 32768, 218112000, 41, 218106628, 0
    .long 1, 80, 80, 2048, 1536, 1792, 7340032, 65536000, 114688, 7, 120610816, 32768, 218104192, 7, 218106753, 0
    .long 1, 40, 40, 2048, 1024, 1280, 8388608, 184549376, 131072, 8, 77611008, 32768, 218112000, 41, 218106628, 0
    .long 1, 40, 40, 2048, 1536, 1792, 8388608, 184549376, 131072, 8, 77619200, 32768, 218112000, 41, 218106628, 0
    .long 1, 40, 40, 2048, 512, 768, 8388608, 186646528, 131072, 8, 78127104, 32768, 218112000, 49, 218106692, 0
    .long 1, 80, 80, 2048, 1024, 1280, 7340032, 65536000, 114688, 7, 120602624, 32768, 218104192, 7, 218106753, 0
    .long 1, 40, 40, 2048, 1024, 1280, 8388608, 186646528, 131072, 8, 78135296, 32768, 218112000, 49, 218106692, 0
    .long 1, 40, 40, 2048, 0, 256, 8388608, 186646528, 131072, 8, 78118912, 32768, 218112000, 49, 218106692, 0
    .long 1, 40, 40, 2048, 1536, 1792, 8388608, 186646528, 131072, 8, 78143488, 32768, 218112000, 49, 218106692, 0
    .long 1, 80, 80, 2048, 1024, 1280, 7340032, 63700992, 114688, 7, 120078336, 32768, 218104128, 7, 218106689, 0
    .long 1, 80, 80, 2048, 1536, 1792, 7340032, 63700992, 114688, 7, 120086528, 32768, 218104128, 7, 218106689, 0
    .long 1, 80, 80, 2048, 0, 256, 7340032, 63700992, 114688, 7, 120061952, 32768, 218104128, 7, 218106689, 0
    .long 1, 80, 80, 2048, 512, 768, 7340032, 63700992, 114688, 7, 120070144, 32768, 218104128, 7, 218106689, 0
    .long 1, 80, 80, 2048, 512, 768, 7340032, 67371008, 114688, 7, 121118720, 32768, 218104256, 7, 218106817, 0
    .long 1, 80, 80, 2048, 1024, 1280, 7340032, 67371008, 114688, 7, 121126912, 32768, 218104256, 7, 218106817, 0
    .long 1, 80, 80, 2048, 1536, 1792, 7340032, 67371008, 114688, 7, 121135104, 32768, 218104256, 7, 218106817, 0
    .long 1, 80, 80, 2048, 0, 256, 7340032, 67371008, 114688, 7, 121110528, 32768, 218104256, 7, 218106817, 0
    .long 6, 1, 3, 2, 0, 16, 0, 3, 0, 0, 0, 0, 0, 0, 0, 0
    .long 6, 0, 51, 0, 0, 0, 0, 51, 0, 0, 0, 0, 0, 0, 0, 0
    .long 6, 1, 1, 2, 0, 16, 0, 1, 0, 0, 0, 0, 0, 0, 0, 0
    .long 6, 1, 0, 2, 0, 16, 0, 0, 0, 0, 0, 0, 0, 0, 0, 0
    .long 6, 1, 5, 2, 0, 16, 0, 5, 0, 0, 0, 0, 0, 0, 0, 0
    .long 6, 1, 4, 2, 0, 16, 0, 4, 0, 0, 0, 0, 0, 0, 0, 0
    .long 6, 1, 22, 2, 0, 16, 0, 22, 0, 0, 0, 0, 0, 0, 0, 0
    .long 6, 1, 6, 2, 0, 16, 0, 6, 0, 0, 0, 0, 0, 0, 0, 0
    .long 6, 1, 18, 2, 0, 16, 0, 18, 0, 0, 0, 0, 0, 0, 0, 0
    .long 6, 1, 19, 2, 0, 16, 0, 19, 0, 0, 0, 0, 0, 0, 0, 0
    .long 6, 1, 20, 2, 0, 16, 0, 20, 0, 0, 0, 0, 0, 0, 0, 0
    .long 6, 1, 7, 2, 0, 16, 0, 7, 0, 0, 0, 0, 0, 0, 0, 0
    .long 6, 1, 2, 2, 0, 16, 0, 2, 0, 0, 0, 0, 0, 0, 0, 0
    .long 6, 1, 17, 2, 0, 16, 0, 17, 0, 0, 0, 0, 0, 0, 0, 0
    .long 6, 1, 21, 2, 0, 16, 0, 21, 0, 0, 0, 0, 0, 0, 0, 0
    .long 6, 1, 16, 2, 0, 16, 0, 16, 0, 0, 0, 0, 0, 0, 0, 0
    .long 6, 0, 50, 0, 0, 0, 0, 50, 0, 0, 0, 0, 0, 0, 0, 0
    .long 6, 0, 52, 0, 0, 0, 0, 52, 0, 0, 0, 0, 0, 0, 0, 0
    .long 6, 0, 54, 0, 0, 0, 0, 54, 0, 0, 0, 0, 0, 0, 0, 0
    .long 6, 0, 49, 0, 0, 0, 0, 49, 0, 0, 0, 0, 0, 0, 0, 0
    .long 6, 0, 48, 0, 0, 0, 0, 48, 0, 0, 0, 0, 0, 0, 0, 0
    .long 6, 0, 53, 0, 0, 0, 0, 53, 0, 0, 0, 0, 0, 0, 0, 0
    .long 6, 0, 55, 0, 0, 0, 0, 55, 0, 0, 0, 0, 0, 0, 0, 0
    .long 6, 0, 56, 0, 0, 0, 0, 56, 0, 0, 0, 0, 0, 0, 0, 0
    .long 6, 1, 23, 2, 0, 16, 0, 23, 0, 0, 0, 0, 0, 0, 0, 0
    .long 6, 1, 24, 2, 0, 16, 0, 24, 0, 0, 0, 0, 0, 0, 0, 0
    .long 6, 1, 25, 2, 0, 16, 0, 25, 0, 0, 0, 0, 0, 0, 0, 0
    .long 6, 1, 26, 2, 0, 16, 0, 26, 0, 0, 0, 0, 0, 0, 0, 0
    .long 6, 1, 27, 2, 0, 16, 0, 27, 0, 0, 0, 0, 0, 0, 0, 0
    .long 6, 1, 28, 2, 0, 16, 0, 28, 0, 0, 0, 0, 0, 0, 0, 0
    .long 6, 1, 29, 2, 0, 16, 0, 29, 0, 0, 0, 0, 0, 0, 0, 0
    .long 6, 1, 30, 2, 0, 16, 0, 30, 0, 0, 0, 0, 0, 0, 0, 0
    .long 6, 1, 31, 2, 0, 16, 0, 31, 0, 0, 0, 0, 0, 0, 0, 0
    .long 6, 0, 40, 1, 0, 16, 0, 40, 0, 0, 0, 0, 0, 0, 0, 0
    .long 6, 0, 41, 1, 0, 16, 0, 41, 0, 0, 0, 0, 0, 0, 0, 0
    .long 6, 0, 43, 1, 0, 16, 0, 43, 0, 0, 0, 0, 0, 0, 0, 0
    .long 6, 0, 45, 1, 0, 16, 0, 45, 0, 0, 0, 0, 0, 0, 0, 0
    .long 6, 0, 46, 1, 0, 16, 0, 46, 0, 0, 0, 0, 0, 0, 0, 0
    .long 6, 0, 47, 1, 0, 16, 0, 47, 0, 0, 0, 0, 0, 0, 0, 0
    .long 6, 1, 32, 1, 0, 16, 0, 32, 0, 0, 0, 0, 0, 0, 0, 0
    .long 6, 1, 33, 1, 0, 16, 0, 33, 0, 0, 0, 0, 0, 0, 0, 0
    .long 6, 1, 35, 1, 0, 16, 0, 35, 0, 0, 0, 0, 0, 0, 0, 0
    .long 6, 1, 36, 1, 0, 16, 0, 36, 0, 0, 0, 0, 0, 0, 0, 0
    .long 6, 1, 38, 1, 0, 16, 0, 38, 0, 0, 0, 0, 0, 0, 0, 0
    .long 6, 1, 39, 1, 0, 16, 0, 39, 0, 0, 0, 0, 0, 0, 0, 0
    .long 6, 0, 57, 0, 0, 0, 0, 57, 0, 0, 0, 0, 0, 0, 0, 0
    .long 6, 0, 44, 1, 0, 16, 0, 44, 0, 0, 0, 0, 0, 0, 0, 0
    .long 6, 1, 34, 1, 0, 16, 0, 34, 0, 0, 0, 0, 0, 0, 0, 0
    .long 6, 0, 58, 0, 0, 0, 0, 58, 0, 0, 0, 0, 0, 0, 0, 0
    .long 6, 1, 37, 1, 0, 16, 0, 37, 0, 0, 0, 0, 0, 0, 0, 0
    .long 6, 0, 42, 1, 0, 16, 0, 42, 0, 0, 0, 0, 0, 0, 0, 0
    .long 6, 0, 59, 0, 0, 0, 0, 59, 0, 0, 0, 0, 0, 0, 0, 0
    .long 6, 1, 8, 2, 0, 16, 0, 8, 0, 0, 0, 0, 0, 0, 0, 0
    .long 6, 1, 9, 2, 0, 16, 0, 9, 0, 0, 0, 0, 0, 0, 0, 0
    .long 6, 1, 10, 2, 0, 16, 0, 10, 0, 0, 0, 0, 0, 0, 0, 0
    .long 6, 1, 11, 2, 0, 16, 0, 11, 0, 0, 0, 0, 0, 0, 0, 0
    .long 6, 1, 12, 2, 0, 16, 0, 12, 0, 0, 0, 0, 0, 0, 0, 0
    .long 6, 1, 13, 2, 0, 16, 0, 13, 0, 0, 0, 0, 0, 0, 0, 0
    .long 6, 1, 14, 2, 0, 16, 0, 14, 0, 0, 0, 0, 0, 0, 0, 0
    .long 6, 1, 15, 2, 0, 16, 0, 15, 0, 0, 0, 0, 0, 0, 0, 0
    .long 7, 0, 60, 0, 0, 0, 0, 60, 0, 0, 0, 0, 0, 0, 0, 0
    .long 7, 0, 60, 0, 1, 0, 0, 60, 0, 0, 0, 0, 0, 0, 0, 0
    .long 7, 0, 60, 0, 2, 0, 0, 60, 0, 0, 0, 0, 0, 0, 0, 0
    .long 7, 0, 60, 0, 3, 0, 0, 60, 0, 0, 0, 0, 0, 0, 0, 0
    .long 7, 0, 61, 0, 0, 0, 0, 61, 0, 0, 0, 0, 0, 0, 0, 0
    .long 7, 0, 61, 0, 1, 0, 0, 61, 0, 0, 0, 0, 0, 0, 0, 0
    .long 7, 0, 61, 0, 2, 0, 0, 61, 0, 0, 0, 0, 0, 0, 0, 0
    .long 7, 0, 61, 0, 3, 0, 0, 61, 0, 0, 0, 0, 0, 0, 0, 0
    .long 7, 0, 62, 0, 0, 0, 0, 62, 0, 0, 0, 0, 0, 0, 0, 0
    .long 7, 0, 62, 0, 1, 0, 0, 62, 0, 0, 0, 0, 0, 0, 0, 0
    .long 7, 0, 62, 0, 2, 0, 0, 62, 0, 0, 0, 0, 0, 0, 0, 0
    .long 7, 0, 62, 0, 3, 0, 0, 62, 0, 0, 0, 0, 0, 0, 0, 0
    .long 7, 0, 63, 0, 0, 0, 0, 63, 0, 0, 0, 0, 0, 0, 0, 0
    .long 7, 0, 63, 0, 1, 0, 0, 63, 0, 0, 0, 0, 0, 0, 0, 0
    .long 7, 0, 63, 0, 2, 0, 0, 63, 0, 0, 0, 0, 0, 0, 0, 0
    .long 7, 0, 63, 0, 3, 0, 0, 63, 0, 0, 0, 0, 0, 0, 0, 0
    .long 0, 0, 0, 0, 0, 0, 0, 0, 0, 0, 0, 0, 0, 0, 0, 0
    .long 4, 24, 24, 8192, 2048, 264192, 8388608, 0, 32768, 4, 21004288, 131072, 0, 0, 218104353, 0
    .long 4, 24, 24, 8192, 2304, 264448, 8388608, 0, 32768, 4, 21008384, 131072, 0, 0, 218104353, 0
    .long 4, 24, 24, 8192, 2560, 264704, 8388608, 0, 32768, 4, 21012480, 131072, 0, 0, 218104353, 0
    .long 4, 24, 24, 8192, 2816, 264960, 8388608, 0, 32768, 4, 21016576, 131072, 0, 0, 218104353, 0
    .long 4, 24, 24, 8192, 3072, 265216, 8388608, 0, 32768, 4, 21020672, 131072, 0, 0, 218104369, 0
    .long 4, 24, 24, 8192, 3328, 265472, 8388608, 0, 32768, 4, 21024768, 131072, 0, 0, 218104369, 0
    .long 4, 24, 24, 8192, 3584, 265728, 8388608, 0, 32768, 4, 21028864, 131072, 0, 0, 218104369, 0
    .long 4, 24, 24, 8192, 3840, 265984, 8388608, 0, 32768, 4, 21032960, 131072, 0, 0, 218104369, 0
    .long 4, 32, 32, 8192, 2048, 264192, 8388608, 0, 32768, 4, 37781504, 131072, 0, 0, 218104353, 0
    .long 4, 32, 32, 8192, 2304, 264448, 8388608, 0, 32768, 4, 37785600, 131072, 0, 0, 218104353, 0
    .long 4, 32, 32, 8192, 2560, 264704, 8388608, 0, 32768, 4, 37789696, 131072, 0, 0, 218104353, 0
    .long 4, 32, 32, 8192, 2816, 264960, 8388608, 0, 32768, 4, 37793792, 131072, 0, 0, 218104353, 0
    .long 4, 32, 32, 8192, 3072, 265216, 8388608, 0, 32768, 4, 37797888, 131072, 0, 0, 218104369, 0
    .long 4, 32, 32, 8192, 3328, 265472, 8388608, 0, 32768, 4, 37801984, 131072, 0, 0, 218104369, 0
    .long 4, 32, 32, 8192, 3584, 265728, 8388608, 0, 32768, 4, 37806080, 131072, 0, 0, 218104369, 0
    .long 4, 32, 32, 8192, 3840, 265984, 8388608, 0, 32768, 4, 37810176, 131072, 0, 0, 218104369, 0
    .long 4, 24, 24, 8192, 2048, 264192, 8388608, 262144, 32768, 4, 22052864, 131072, 0, 0, 218104356, 0
    .long 4, 24, 24, 8192, 2304, 264448, 8388608, 262144, 32768, 4, 22056960, 131072, 0, 0, 218104356, 0
    .long 4, 24, 24, 8192, 2560, 264704, 8388608, 262144, 32768, 4, 22061056, 131072, 0, 0, 218104356, 0
    .long 4, 24, 24, 8192, 2816, 264960, 8388608, 262144, 32768, 4, 22065152, 131072, 0, 0, 218104356, 0
    .long 4, 24, 24, 8192, 3072, 265216, 8388608, 262144, 32768, 4, 22069248, 131072, 0, 0, 218104372, 0
    .long 4, 24, 24, 8192, 3328, 265472, 8388608, 262144, 32768, 4, 22073344, 131072, 0, 0, 218104372, 0
    .long 4, 24, 24, 8192, 3584, 265728, 8388608, 262144, 32768, 4, 22077440, 131072, 0, 0, 218104372, 0
    .long 4, 24, 24, 8192, 3840, 265984, 8388608, 262144, 32768, 4, 22081536, 131072, 0, 0, 218104372, 0
    .long 4, 32, 32, 8192, 2048, 264192, 8388608, 262144, 32768, 4, 38830080, 131072, 0, 0, 218104356, 0
    .long 4, 32, 32, 8192, 2304, 264448, 8388608, 262144, 32768, 4, 38834176, 131072, 0, 0, 218104356, 0
    .long 4, 32, 32, 8192, 2560, 264704, 8388608, 262144, 32768, 4, 38838272, 131072, 0, 0, 218104356, 0
    .long 4, 32, 32, 8192, 2816, 264960, 8388608, 262144, 32768, 4, 38842368, 131072, 0, 0, 218104356, 0
    .long 4, 32, 32, 8192, 3072, 265216, 8388608, 262144, 32768, 4, 38846464, 131072, 0, 0, 218104372, 0
    .long 4, 32, 32, 8192, 3328, 265472, 8388608, 262144, 32768, 4, 38850560, 131072, 0, 0, 218104372, 0
    .long 4, 32, 32, 8192, 3584, 265728, 8388608, 262144, 32768, 4, 38854656, 131072, 0, 0, 218104372, 0
    .long 4, 32, 32, 8192, 3840, 265984, 8388608, 262144, 32768, 4, 38858752, 131072, 0, 0, 218104372, 0
    .long 4, 32, 32, 8192, 2304, 264448, 8388608, 786432, 32768, 4, 40931328, 131072, 0, 0, 218104612, 0
    .long 4, 24, 24, 8192, 2560, 264704, 8388608, 786432, 32768, 4, 24158208, 131072, 0, 0, 218104612, 0
    .long 4, 24, 24, 8192, 3584, 265728, 8388608, 786432, 32768, 4, 24174592, 131072, 0, 0, 218104628, 0
    .long 4, 32, 32, 8192, 2816, 264960, 8388608, 524288, 32768, 4, 39890944, 131072, 0, 0, 218104609, 0
    .long 4, 32, 32, 8192, 3584, 265728, 8388608, 786432, 32768, 4, 40951808, 131072, 0, 0, 218104628, 0
    .long 4, 32, 32, 8192, 3328, 265472, 8388608, 524288, 32768, 4, 39899136, 131072, 0, 0, 218104625, 0
    .long 4, 24, 24, 8192, 3072, 265216, 8388608, 786432, 32768, 4, 24166400, 131072, 0, 0, 218104628, 0
    .long 4, 32, 32, 8192, 3840, 265984, 8388608, 524288, 32768, 4, 39907328, 131072, 0, 0, 218104625, 0
    .long 4, 32, 32, 8192, 2560, 264704, 8388608, 786432, 32768, 4, 40935424, 131072, 0, 0, 218104612, 0
    .long 4, 32, 32, 8192, 2560, 264704, 8388608, 524288, 32768, 4, 39886848, 131072, 0, 0, 218104609, 0
    .long 4, 32, 32, 8192, 3072, 265216, 8388608, 786432, 32768, 4, 40943616, 131072, 0, 0, 218104628, 0
    .long 4, 24, 24, 8192, 2816, 264960, 8388608, 524288, 32768, 4, 23113728, 131072, 0, 0, 218104609, 0
    .long 2, 64, 72, 7168, 1792, 1792, 7340032, 1048576, 32768, 8, 58224640, 114688, 0, 0, 218103937, 0
    .long 4, 24, 24, 8192, 2304, 264448, 8388608, 786432, 32768, 4, 24154112, 131072, 0, 0, 218104612, 0
    .long 4, 24, 24, 8192, 3328, 265472, 8388608, 524288, 32768, 4, 23121920, 131072, 0, 0, 218104625, 0
    .long 4, 32, 32, 8192, 2304, 264448, 8388608, 524288, 32768, 4, 39882752, 131072, 0, 0, 218104609, 0
    .long 4, 32, 32, 8192, 3840, 265984, 8388608, 786432, 32768, 4, 40955904, 131072, 0, 0, 218104628, 0
    .long 4, 24, 24, 8192, 2048, 264192, 8388608, 524288, 32768, 4, 23101440, 131072, 0, 0, 218104609, 0
    .long 4, 24, 24, 8192, 3584, 265728, 8388608, 524288, 32768, 4, 23126016, 131072, 0, 0, 218104625, 0
    .long 4, 32, 32, 8192, 2048, 264192, 8388608, 524288, 32768, 4, 39878656, 131072, 0, 0, 218104609, 0
    .long 4, 24, 24, 8192, 3840, 265984, 8388608, 524288, 32768, 4, 23130112, 131072, 0, 0, 218104625, 0
    .long 4, 32, 32, 8192, 2048, 264192, 8388608, 786432, 32768, 4, 40927232, 131072, 0, 0, 218104612, 0
    .long 4, 24, 24, 8192, 2816, 264960, 8388608, 786432, 32768, 4, 24162304, 131072, 0, 0, 218104612, 0
    .long 4, 32, 32, 8192, 2816, 264960, 8388608, 786432, 32768, 4, 40939520, 131072, 0, 0, 218104612, 0
    .long 4, 32, 32, 8192, 3584, 265728, 8388608, 524288, 32768, 4, 39903232, 131072, 0, 0, 218104625, 0
    .long 4, 24, 24, 8192, 3072, 265216, 8388608, 524288, 32768, 4, 23117824, 131072, 0, 0, 218104625, 0
    .long 4, 32, 32, 8192, 3328, 265472, 8388608, 786432, 32768, 4, 40947712, 131072, 0, 0, 218104628, 0
    .long 4, 24, 24, 8192, 2304, 264448, 8388608, 524288, 32768, 4, 23105536, 131072, 0, 0, 218104609, 0
    .long 4, 32, 32, 8192, 3072, 265216, 8388608, 524288, 32768, 4, 39895040, 131072, 0, 0, 218104625, 0
    .long 4, 24, 24, 8192, 2560, 264704, 8388608, 524288, 32768, 4, 23109632, 131072, 0, 0, 218104609, 0
    .long 4, 24, 24, 8192, 3328, 265472, 8388608, 786432, 32768, 4, 24170496, 131072, 0, 0, 218104628, 0
    .long 4, 24, 24, 8192, 2048, 264192, 8388608, 786432, 32768, 4, 24150016, 131072, 0, 0, 218104612, 0
    .long 1, 32, 32, 8192, 3072, 3328, 8388608, 1048576, 32768, 8, 41992192, 131072, 0, 0, 218104890, 0
    .long 1, 24, 24, 8192, 2560, 2816, 8388608, 1048576, 32768, 8, 25206784, 131072, 0, 0, 218104874, 0
    .long 1, 16, 16, 8192, 2560, 2816, 8388608, 1048576, 32768, 8, 8429568, 131072, 0, 0, 218104874, 0
    .long 1, 24, 24, 8192, 3072, 3328, 8388608, 1048576, 32768, 8, 25214976, 131072, 0, 0, 218104890, 0
    .long 4, 24, 24, 8192, 3840, 265984, 8388608, 786432, 32768, 4, 24178688, 131072, 0, 0, 218104628, 0
    .long 1, 16, 16, 8192, 2048, 2304, 8388608, 1048576, 32768, 8, 8421376, 131072, 0, 0, 218104874, 0
    .long 1, 24, 24, 8192, 2560, 2816, 8388608, 1572864, 32768, 8, 27303936, 131072, 0, 0, 218105130, 0
    .long 1, 32, 32, 8192, 3072, 3328, 8388608, 1572864, 32768, 8, 44089344, 131072, 0, 0, 218105146, 0
    .long 1, 24, 24, 8192, 2048, 2304, 8388608, 1048576, 32768, 8, 25198592, 131072, 0, 0, 218104874, 0
    .long 1, 32, 32, 8192, 2560, 2816, 8388608, 1048576, 32768, 8, 41984000, 131072, 0, 0, 218104874, 0
    .long 1, 16, 16, 8192, 3584, 3840, 8388608, 1572864, 32768, 8, 10543104, 131072, 0, 0, 218105146, 0
    .long 1, 16, 16, 8192, 2048, 2304, 8388608, 0, 32768, 8, 4227072, 131072, 0, 0, 218107946, 0
    .long 1, 24, 24, 8192, 3072, 3328, 8388608, 1572864, 32768, 8, 27312128, 131072, 0, 0, 218105146, 0
    .long 1, 32, 32, 8192, 3584, 3840, 8388608, 1572864, 32768, 8, 44097536, 131072, 0, 0, 218105146, 0
    .long 1, 32, 32, 8192, 2048, 2304, 8388608, 1048576, 32768, 8, 41975808, 131072, 0, 0, 218104874, 0
    .long 1, 16, 16, 8192, 3072, 3328, 8388608, 1572864, 32768, 8, 10534912, 131072, 0, 0, 218105146, 0
    .long 1, 32, 32, 8192, 3584, 3840, 8388608, 1048576, 32768, 8, 42000384, 131072, 0, 0, 218104890, 0
    .long 1, 24, 24, 8192, 3584, 3840, 8388608, 1572864, 32768, 8, 27320320, 131072, 0, 0, 218105146, 0
    .long 1, 16, 16, 8192, 3584, 3840, 8388608, 1048576, 32768, 8, 8445952, 131072, 0, 0, 218104890, 0
    .long 1, 32, 32, 8192, 2048, 2304, 8388608, 1572864, 32768, 8, 44072960, 131072, 0, 0, 218105130, 0
    .long 1, 16, 16, 8192, 3584, 3840, 8388608, 0, 32768, 8, 4251648, 131072, 0, 0, 218107962, 0
    .long 1, 16, 16, 8192, 2560, 2816, 8388608, 2097152, 32768, 8, 12623872, 131072, 0, 0, 218105386, 0
    .long 1, 16, 16, 8192, 3072, 3328, 8388608, 1048576, 32768, 8, 8437760, 131072, 0, 0, 218104890, 0
    .long 1, 16, 16, 8192, 2048, 2304, 8388608, 1572864, 32768, 8, 10518528, 131072, 0, 0, 218105130, 0
    .long 1, 32, 32, 8192, 2048, 2304, 8388608, 2097152, 32768, 8, 46170112, 131072, 0, 0, 218105386, 0
    .long 1, 16, 16, 8192, 2560, 2816, 8388608, 0, 32768, 8, 4235264, 131072, 0, 0, 218107946, 0
    .long 1, 24, 24, 8192, 3584, 3840, 8388608, 1048576, 32768, 8, 25223168, 131072, 0, 0, 218104890, 0
    .long 1, 16, 16, 8192, 2560, 2816, 8388608, 1572864, 32768, 8, 10526720, 131072, 0, 0, 218105130, 0
    .long 1, 16, 16, 8192, 3072, 3328, 8388608, 0, 32768, 8, 4243456, 131072, 0, 0, 218107962, 0
    .long 1, 32, 32, 8192, 2560, 2816, 8388608, 2097152, 32768, 8, 46178304, 131072, 0, 0, 218105386, 0
    .long 1, 32, 32, 8192, 2560, 2816, 8388608, 1572864, 32768, 8, 44081152, 131072, 0, 0, 218105130, 0
    .long 1, 24, 24, 8192, 2048, 2304, 8388608, 1572864, 32768, 8, 27295744, 131072, 0, 0, 218105130, 0
    .long 1, 16, 16, 8192, 2048, 2304, 8388608, 524288, 32768, 8, 6324224, 131072, 0, 0, 218108202, 0
    .long 1, 32, 32, 8192, 3072, 3328, 8388608, 3670016, 32768, 8, 52477952, 131072, 0, 0, 218106170, 0
    .long 1, 16, 16, 8192, 3072, 3328, 8388608, 2621440, 32768, 8, 14729216, 131072, 0, 0, 218105658, 0
    .long 1, 24, 24, 8192, 2560, 2816, 8388608, 3145728, 32768, 8, 33595392, 131072, 0, 0, 218105898, 0
    .long 1, 16, 16, 8192, 2048, 2304, 8388608, 2621440, 32768, 8, 14712832, 131072, 0, 0, 218105642, 0
    .long 1, 32, 32, 8192, 3584, 3840, 8388608, 3670016, 32768, 8, 52486144, 131072, 0, 0, 218106170, 0
    .long 1, 16, 16, 8192, 2048, 2304, 8388608, 3145728, 32768, 8, 16809984, 131072, 0, 0, 218105898, 0
    .long 1, 24, 24, 8192, 3072, 3328, 8388608, 2097152, 32768, 8, 29409280, 131072, 0, 0, 218105402, 0
    .long 1, 16, 16, 8192, 3584, 3840, 8388608, 2097152, 32768, 8, 12640256, 131072, 0, 0, 218105402, 0
    .long 1, 24, 24, 8192, 2560, 2816, 8388608, 3670016, 32768, 8, 35692544, 131072, 0, 0, 218106154, 0
    .long 1, 24, 24, 8192, 3584, 3840, 8388608, 3145728, 32768, 8, 33611776, 131072, 0, 0, 218105914, 0
    .long 1, 32, 32, 8192, 3584, 3840, 8388608, 2621440, 32768, 8, 48291840, 131072, 0, 0, 218105658, 0
    .long 1, 32, 32, 8192, 3584, 3840, 8388608, 2097152, 32768, 8, 46194688, 131072, 0, 0, 218105402, 0
    .long 1, 24, 24, 8192, 3584, 3840, 8388608, 2097152, 32768, 8, 29417472, 131072, 0, 0, 218105402, 0
    .long 1, 24, 24, 8192, 2048, 2304, 8388608, 2097152, 32768, 8, 29392896, 131072, 0, 0, 218105386, 0
    .long 1, 32, 32, 8192, 3584, 3840, 8388608, 3145728, 32768, 8, 50388992, 131072, 0, 0, 218105914, 0
    .long 1, 32, 32, 8192, 2048, 2304, 8388608, 3145728, 32768, 8, 50364416, 131072, 0, 0, 218105898, 0
    .long 1, 16, 16, 8192, 3072, 3328, 8388608, 3145728, 32768, 8, 16826368, 131072, 0, 0, 218105914, 0
    .long 1, 16, 16, 8192, 3072, 3328, 8388608, 2097152, 32768, 8, 12632064, 131072, 0, 0, 218105402, 0
    .long 5, 218107952, 0, 0, 12, 0, 0, 0, 0, 0, 0, 0, 218112128, 4, 218106881, 0
    .long 1, 32, 32, 8192, 3072, 3328, 8388608, 3145728, 32768, 8, 50380800, 131072, 0, 0, 218105914, 0
    .long 1, 24, 24, 8192, 3584, 3840, 8388608, 3670016, 32768, 8, 35708928, 131072, 0, 0, 218106170, 0
    .long 1, 32, 32, 8192, 2048, 2304, 8388608, 2621440, 32768, 8, 48267264, 131072, 0, 0, 218105642, 0
    .long 1, 32, 32, 8192, 3072, 3328, 8388608, 2097152, 32768, 8, 46186496, 131072, 0, 0, 218105402, 0
    .long 1, 24, 24, 8192, 2560, 2816, 8388608, 2621440, 32768, 8, 31498240, 131072, 0, 0, 218105642, 0
    .long 1, 24, 24, 8192, 2560, 2816, 8388608, 2097152, 32768, 8, 29401088, 131072, 0, 0, 218105386, 0
    .long 1, 16, 16, 8192, 3584, 3840, 8388608, 524288, 32768, 8, 6348800, 131072, 0, 0, 218108218, 0
    .long 1, 32, 32, 8192, 3072, 3328, 8388608, 2621440, 32768, 8, 48283648, 131072, 0, 0, 218105658, 0
    .long 1, 16, 16, 8192, 3072, 3328, 8388608, 524288, 32768, 8, 6340608, 131072, 0, 0, 218108218, 0
    .long 1, 24, 24, 8192, 2048, 2304, 8388608, 2621440, 32768, 8, 31490048, 131072, 0, 0, 218105642, 0
    .long 1, 16, 16, 8192, 2048, 2304, 8388608, 2097152, 32768, 8, 12615680, 131072, 0, 0, 218105386, 0
    .long 5, 218107952, 0, 0, 12, 0, 0, 4, 0, 0, 0, 0, 218112128, 8, 218106881, 0
    .long 5, 218107936, 0, 0, 8, 0, 0, 0, 0, 0, 0, 0, 218112128, 4, 218106881, 0
    .long 1, 24, 24, 8192, 3072, 3328, 8388608, 3670016, 32768, 8, 35700736, 131072, 0, 0, 218106170, 0
    .long 2, 64, 72, 7168, 1792, 1792, 7340032, 2097152, 32768, 8, 61894656, 114688, 0, 0, 218104065, 0
    .long 1, 24, 24, 8192, 3584, 3840, 8388608, 2621440, 32768, 8, 31514624, 131072, 0, 0, 218105658, 0
    .long 2, 64, 72, 7168, 2048, 2048, 7340032, 0, 32768, 8, 54558720, 114688, 0, 0, 218103809, 0
    .long 1, 24, 24, 8192, 2048, 2304, 8388608, 3670016, 32768, 8, 35684352, 131072, 0, 0, 218106154, 0
    .long 1, 32, 32, 8192, 2560, 2816, 8388608, 3670016, 32768, 8, 52469760, 131072, 0, 0, 218106154, 0
    .long 2, 64, 72, 7168, 2816, 2816, 7340032, 2621440, 32768, 8, 63746048, 114688, 0, 0, 218104132, 0
    .long 1, 32, 32, 8192, 2560, 2816, 8388608, 2621440, 32768, 8, 48275456, 131072, 0, 0, 218105642, 0
    .long 1, 16, 16, 8192, 2560, 2816, 8388608, 2621440, 32768, 8, 14721024, 131072, 0, 0, 218105642, 0
    .long 2, 64, 72, 7168, 1792, 1792, 7340032, 0, 32768, 8, 54554624, 114688, 0, 0, 218103809, 0
    .long 1, 16, 16, 8192, 3584, 3840, 8388608, 3145728, 32768, 8, 16834560, 131072, 0, 0, 218105914, 0
    .long 1, 24, 24, 8192, 3072, 3328, 8388608, 2621440, 32768, 8, 31506432, 131072, 0, 0, 218105658, 0
    .long 2, 64, 72, 7168, 2048, 2048, 7340032, 524288, 32768, 8, 56393728, 114688, 0, 0, 218103873, 0
    .long 1, 24, 24, 8192, 2048, 2304, 8388608, 3145728, 32768, 8, 33587200, 131072, 0, 0, 218105898, 0
    .long 2, 64, 72, 7168, 2560, 2560, 7340032, 0, 32768, 8, 54566912, 114688, 0, 0, 218103809, 0
    .long 2, 64, 72, 7168, 2560, 2560, 7340032, 524288, 32768, 8, 56401920, 114688, 0, 0, 218103873, 0
    .long 2, 64, 72, 7168, 2304, 2304, 7340032, 2097152, 32768, 8, 61902848, 114688, 0, 0, 218104065, 0
    .long 2, 64, 72, 7168, 2816, 2816, 7340032, 2097152, 32768, 8, 61911040, 114688, 0, 0, 218104065, 0
    .long 1, 16, 16, 8192, 2560, 2816, 8388608, 524288, 32768, 8, 6332416, 131072, 0, 0, 218108202, 0
    .long 1, 16, 16, 8192, 2560, 2816, 8388608, 3145728, 32768, 8, 16818176, 131072, 0, 0, 218105898, 0
    .long 2, 64, 72, 7168, 2816, 2816, 7340032, 0, 32768, 8, 54571008, 114688, 0, 0, 218103809, 0
    .long 2, 64, 72, 7168, 3072, 3072, 7340032, 0, 32768, 8, 54575104, 114688, 0, 0, 218103809, 0
    .long 1, 16, 16, 8192, 3584, 3840, 8388608, 2621440, 32768, 8, 14737408, 131072, 0, 0, 218105658, 0
    .long 1, 24, 24, 8192, 3072, 3328, 8388608, 3145728, 32768, 8, 33603584, 131072, 0, 0, 218105914, 0
    .long 2, 64, 72, 7168, 3072, 3072, 7340032, 3145728, 32768, 8, 65585152, 114688, 0, 0, 218104196, 0
    .long 1, 32, 32, 8192, 2560, 2816, 8388608, 3145728, 32768, 8, 50372608, 131072, 0, 0, 218105898, 0
    .long 1, 16, 16, 8192, 3584, 3840, 8388608, 3670016, 32768, 8, 18931712, 131072, 0, 0, 218106170, 0
    .long 2, 64, 72, 7168, 3328, 3328, 7340032, 0, 32768, 8, 54579200, 114688, 0, 0, 218103809, 0
    .long 2, 64, 72, 7168, 2304, 2304, 7340032, 0, 32768, 8, 54562816, 114688, 0, 0, 218103809, 0
    .long 5, 218107936, 0, 0, 8, 0, 0, 4, 0, 0, 0, 0, 218112128, 8, 218106881, 0
    .long 2, 64, 72, 7168, 3328, 3328, 7340032, 3145728, 32768, 8, 65589248, 114688, 0, 0, 218104196, 0
    .long 2, 64, 72, 7168, 1792, 1792, 7340032, 524288, 32768, 8, 56389632, 114688, 0, 0, 218103873, 0
    .long 2, 64, 72, 7168, 3072, 3072, 7340032, 1572864, 32768, 8, 60080128, 114688, 0, 0, 218104001, 0
    .long 2, 64, 72, 7168, 3328, 3328, 7340032, 524288, 32768, 8, 56414208, 114688, 0, 0, 218103873, 0
    .long 1, 16, 16, 8192, 2048, 2304, 8388608, 3670016, 32768, 8, 18907136, 131072, 0, 0, 218106154, 0
    .long 5, 218108208, 0, 0, 12, 0, 0, 8, 0, 0, 0, 0, 218112128, 12, 218106945, 0
    .long 2, 64, 72, 7168, 1792, 1792, 7340032, 3145728, 32768, 8, 65564672, 114688, 0, 0, 218104196, 0
    .long 2, 64, 72, 7168, 2304, 2304, 7340032, 1572864, 32768, 8, 60067840, 114688, 0, 0, 218104001, 0
    .long 2, 64, 72, 7168, 2560, 2560, 7340032, 2097152, 32768, 8, 61906944, 114688, 0, 0, 218104065, 0
    .long 2, 64, 72, 7168, 1792, 1792, 7340032, 1572864, 32768, 8, 60059648, 114688, 0, 0, 218104001, 0
    .long 2, 64, 72, 7168, 2560, 2560, 7340032, 1572864, 32768, 8, 60071936, 114688, 0, 0, 218104001, 0
    .long 2, 64, 72, 7168, 3328, 3328, 7340032, 1572864, 32768, 8, 60084224, 114688, 0, 0, 218104001, 0
    .long 2, 64, 72, 7168, 2048, 2048, 7340032, 1572864, 32768, 8, 60063744, 114688, 0, 0, 218104001, 0
    .long 2, 64, 72, 7168, 2048, 2048, 7340032, 2097152, 32768, 8, 61898752, 114688, 0, 0, 218104065, 0
    .long 2, 64, 72, 7168, 3072, 3072, 7340032, 2097152, 32768, 8, 61915136, 114688, 0, 0, 218104065, 0
    .long 2, 64, 72, 7168, 2304, 2304, 7340032, 524288, 32768, 8, 56397824, 114688, 0, 0, 218103873, 0
    .long 2, 64, 72, 7168, 3328, 3328, 7340032, 2097152, 32768, 8, 61919232, 114688, 0, 0, 218104065, 0
    .long 2, 64, 72, 7168, 2816, 2816, 7340032, 1572864, 32768, 8, 60076032, 114688, 0, 0, 218104001, 0
    .long 2, 64, 72, 7168, 2048, 2048, 7340032, 1048576, 32768, 8, 58228736, 114688, 0, 0, 218103937, 0
    .long 2, 64, 72, 7168, 2816, 2816, 7340032, 1048576, 32768, 8, 58241024, 114688, 0, 0, 218103937, 0
    .long 2, 64, 72, 7168, 2304, 2304, 7340032, 3145728, 32768, 8, 65572864, 114688, 0, 0, 218104196, 0
    .long 2, 64, 72, 7168, 3072, 3072, 7340032, 1048576, 32768, 8, 58245120, 114688, 0, 0, 218103937, 0
    .long 5, 218108208, 0, 0, 12, 0, 0, 12, 0, 0, 0, 0, 218112128, 16, 218106945, 0
    .long 2, 64, 72, 7168, 3328, 3328, 7340032, 1048576, 32768, 8, 58249216, 114688, 0, 0, 218103937, 0
    .long 2, 64, 72, 7168, 2816, 2816, 7340032, 3145728, 32768, 8, 65581056, 114688, 0, 0, 218104196, 0
    .long 2, 64, 72, 7168, 3072, 3072, 7340032, 524288, 32768, 8, 56410112, 114688, 0, 0, 218103873, 0
    .long 2, 64, 72, 7168, 2560, 2560, 7340032, 1048576, 32768, 8, 58236928, 114688, 0, 0, 218103937, 0
    .long 2, 64, 72, 7168, 2304, 2304, 7340032, 1048576, 32768, 8, 58232832, 114688, 0, 0, 218103937, 0
    .long 2, 64, 72, 7168, 2048, 2048, 7340032, 3145728, 32768, 8, 65568768, 114688, 0, 0, 218104196, 0
    .long 5, 218108192, 0, 0, 8, 0, 0, 12, 0, 0, 0, 0, 218112128, 16, 218106945, 0
    .long 2, 64, 72, 7168, 2560, 2560, 7340032, 3670016, 32768, 8, 67411968, 114688, 0, 0, 218104260, 0
    .long 2, 64, 72, 7168, 2816, 2816, 7340032, 524288, 32768, 8, 56406016, 114688, 0, 0, 218103873, 0
    .long 1, 80, 80, 2048, 1536, 1792, 7340032, 54525952, 114688, 14, 117465088, 32768, 218103808, 14, 218106370, 0
    .long 1, 40, 40, 2048, 1024, 1280, 8388608, 176160768, 131072, 16, 75513856, 32768, 218106880, 8, 218106376, 0
    .long 5, 218108192, 0, 0, 8, 0, 0, 8, 0, 0, 0, 0, 218112128, 12, 218106945, 0
    .long 1, 32, 32, 8192, 2048, 2304, 8388608, 3670016, 32768, 8, 52461568, 131072, 0, 0, 218106154, 0
    .long 1, 16, 16, 8192, 2560, 2816, 8388608, 3670016, 32768, 8, 18915328, 131072, 0, 0, 218106154, 0
    .long 1, 16, 16, 8192, 3072, 3328, 8388608, 3670016, 32768, 8, 18923520, 131072, 0, 0, 218106170, 0
    .long 1, 40, 40, 2048, 1536, 1792, 8388608, 182452224, 131072, 16, 77094912, 32768, 218112128, 33, 218106568, 0
    .long 1, 40, 40, 2048, 1536, 1792, 8388608, 176160768, 131072, 16, 75522048, 32768, 218106880, 8, 218106376, 0
    .long 2, 64, 72, 7168, 2560, 2560, 7340032, 3145728, 32768, 8, 65576960, 114688, 0, 0, 218104196, 0
    .long 1, 40, 40, 2048, 1024, 1280, 8388608, 180355072, 131072, 16, 76562432, 32768, 218112128, 25, 218106504, 0
    .long 1, 40, 40, 2048, 1536, 1792, 8388608, 180355072, 131072, 16, 76570624, 32768, 218112128, 25, 218106504, 0
    .long 2, 64, 72, 7168, 3072, 3072, 7340032, 2621440, 32768, 8, 63750144, 114688, 0, 0, 218104132, 0
    .long 1, 40, 40, 2048, 1024, 1280, 8388608, 182452224, 131072, 16, 77086720, 32768, 218112128, 33, 218106568, 0
    .long 2, 64, 72, 7168, 1792, 1792, 7340032, 2621440, 32768, 8, 63729664, 114688, 0, 0, 218104132, 0
    .long 1, 80, 80, 2048, 1024, 1280, 7340032, 54525952, 114688, 14, 117456896, 32768, 218103808, 14, 218106370, 0
    .long 2, 64, 72, 7168, 3328, 3328, 7340032, 2621440, 32768, 8, 63754240, 114688, 0, 0, 218104132, 0
    .long 2, 64, 72, 7168, 2048, 2048, 7340032, 2621440, 32768, 8, 63733760, 114688, 0, 0, 218104132, 0
    .long 2, 64, 72, 7168, 2304, 2304, 7340032, 3670016, 32768, 8, 67407872, 114688, 0, 0, 218104260, 0
    .long 2, 64, 72, 7168, 3072, 3072, 7340032, 3670016, 32768, 8, 67420160, 114688, 0, 0, 218104260, 0
    .long 1, 40, 40, 2048, 1024, 1280, 8388608, 178257920, 131072, 16, 76038144, 32768, 218106944, 8, 218106440, 0
    .long 1, 40, 40, 2048, 1536, 1792, 8388608, 178257920, 131072, 16, 76046336, 32768, 218106944, 8, 218106440, 0
    .long 2, 64, 72, 7168, 2560, 2560, 7340032, 2621440, 32768, 8, 63741952, 114688, 0, 0, 218104132, 0
    .long 2, 64, 72, 7168, 1792, 1792, 7340032, 3670016, 32768, 8, 67399680, 114688, 0, 0, 218104260, 0
    .long 2, 64, 72, 7168, 2304, 2304, 7340032, 2621440, 32768, 8, 63737856, 114688, 0, 0, 218104132, 0
    .long 1, 80, 80, 2048, 1536, 1792, 7340032, 61865984, 114688, 14, 119562240, 32768, 218104064, 14, 218106626, 0
    .long 1, 80, 80, 2048, 1024, 1280, 7340032, 60030976, 114688, 14, 119029760, 32768, 218104000, 14, 218106562, 0
    .long 1, 80, 80, 2048, 1024, 1280, 7340032, 61865984, 114688, 14, 119554048, 32768, 218104064, 14, 218106626, 0
    .long 1, 80, 80, 2048, 1536, 1792, 7340032, 60030976, 114688, 14, 119037952, 32768, 218104000, 14, 218106562, 0
    .long 2, 64, 72, 7168, 2816, 2816, 7340032, 3670016, 32768, 8, 67416064, 114688, 0, 0, 218104260, 0
    .long 2, 64, 72, 7168, 2048, 2048, 7340032, 3670016, 32768, 8, 67403776, 114688, 0, 0, 218104260, 0
    .long 1, 80, 80, 2048, 1024, 1280, 7340032, 58195968, 114688, 14, 118505472, 32768, 218103936, 14, 218106498, 0
    .long 1, 80, 80, 2048, 1536, 1792, 7340032, 58195968, 114688, 14, 118513664, 32768, 218103936, 14, 218106498, 0
    .long 2, 64, 72, 7168, 3328, 3328, 7340032, 3670016, 32768, 8, 67424256, 114688, 0, 0, 218104260, 0
    .long 1, 80, 80, 2048, 1536, 1792, 7340032, 56360960, 114688, 14, 117989376, 32768, 218103872, 14, 218106434, 0
    .long 1, 80, 80, 2048, 1024, 1280, 7340032, 56360960, 114688, 14, 117981184, 32768, 218103872, 14, 218106434, 0
    .long 1, 40, 40, 2048, 2097664, 2097920, 8388608, 184582144, 131072, 8, 81797120, 32768, 218112128, 41, 218106628, 0
    .long 1, 80, 80, 2048, 1835008, 1835264, 7340032, 65564672, 114688, 7, 124780544, 32768, 218104196, 7, 218106753, 0
    .long 1, 80, 80, 2048, 1835520, 1835776, 7340032, 65564672, 114688, 7, 124788736, 32768, 218104196, 7, 218106753, 0
    .long 1, 40, 40, 2048, 2097152, 2097408, 8388608, 184582144, 131072, 8, 81788928, 32768, 218112128, 41, 218106628, 0
    .long 1, 80, 80, 2048, 1836544, 1836800, 7340032, 65564672, 114688, 7, 124805120, 32768, 218104196, 7, 218106753, 0
    .long 1, 40, 40, 2048, 2098176, 2098432, 8388608, 184582144, 131072, 8, 81805312, 32768, 218112128, 41, 218106628, 0
    .long 1, 40, 40, 2048, 2098688, 2098944, 8388608, 184582144, 131072, 8, 81813504, 32768, 218112128, 41, 218106628, 0
    .long 1, 40, 40, 2048, 2097664, 2097920, 8388608, 186679296, 131072, 8, 82321408, 32768, 218112128, 49, 218106692, 0
    .long 1, 80, 80, 2048, 1836032, 1836288, 7340032, 65564672, 114688, 7, 124796928, 32768, 218104196, 7, 218106753, 0
    .long 1, 40, 40, 2048, 2098176, 2098432, 8388608, 186679296, 131072, 8, 82329600, 32768, 218112128, 49, 218106692, 0
    .long 1, 40, 40, 2048, 2097152, 2097408, 8388608, 186679296, 131072, 8, 82313216, 32768, 218112128, 49, 218106692, 0
    .long 1, 40, 40, 2048, 2098688, 2098944, 8388608, 186679296, 131072, 8, 82337792, 32768, 218112128, 49, 218106692, 0
    .long 1, 80, 80, 2048, 1836032, 1836288, 7340032, 63729664, 114688, 7, 124272640, 32768, 218104132, 7, 218106689, 0
    .long 1, 80, 80, 2048, 1836544, 1836800, 7340032, 63729664, 114688, 7, 124280832, 32768, 218104132, 7, 218106689, 0
    .long 1, 80, 80, 2048, 1835008, 1835264, 7340032, 63729664, 114688, 7, 124256256, 32768, 218104132, 7, 218106689, 0
    .long 1, 80, 80, 2048, 1835520, 1835776, 7340032, 63729664, 114688, 7, 124264448, 32768, 218104132, 7, 218106689, 0
    .long 1, 80, 80, 2048, 1835520, 1835776, 7340032, 67399680, 114688, 7, 125313024, 32768, 218104260, 7, 218106817, 0
    .long 1, 80, 80, 2048, 1836032, 1836288, 7340032, 67399680, 114688, 7, 125321216, 32768, 218104260, 7, 218106817, 0
    .long 1, 80, 80, 2048, 1836544, 1836800, 7340032, 67399680, 114688, 7, 125329408, 32768, 218104260, 7, 218106817, 0
    .long 1, 80, 80, 2048, 1835008, 1835264, 7340032, 67399680, 114688, 7, 125304832, 32768, 218104260, 7, 218106817, 0
    .long 6, 1, 3, 2, 1, 16, 0, 3, 0, 0, 0, 0, 0, 0, 0, 0
    .long 6, 0, 51, 0, 1, 0, 0, 51, 0, 0, 0, 0, 0, 0, 0, 0
    .long 6, 1, 1, 2, 1, 16, 0, 1, 0, 0, 0, 0, 0, 0, 0, 0
    .long 6, 1, 0, 2, 1, 16, 0, 0, 0, 0, 0, 0, 0, 0, 0, 0
    .long 6, 1, 5, 2, 1, 16, 0, 5, 0, 0, 0, 0, 0, 0, 0, 0
    .long 6, 1, 4, 2, 1, 16, 0, 4, 0, 0, 0, 0, 0, 0, 0, 0
    .long 6, 1, 22, 2, 1, 16, 0, 22, 0, 0, 0, 0, 0, 0, 0, 0
    .long 6, 1, 6, 2, 1, 16, 0, 6, 0, 0, 0, 0, 0, 0, 0, 0
    .long 6, 1, 18, 2, 1, 16, 0, 18, 0, 0, 0, 0, 0, 0, 0, 0
    .long 6, 1, 19, 2, 1, 16, 0, 19, 0, 0, 0, 0, 0, 0, 0, 0
    .long 6, 1, 20, 2, 1, 16, 0, 20, 0, 0, 0, 0, 0, 0, 0, 0
    .long 6, 1, 7, 2, 1, 16, 0, 7, 0, 0, 0, 0, 0, 0, 0, 0
    .long 6, 1, 2, 2, 1, 16, 0, 2, 0, 0, 0, 0, 0, 0, 0, 0
    .long 6, 1, 17, 2, 1, 16, 0, 17, 0, 0, 0, 0, 0, 0, 0, 0
    .long 6, 1, 21, 2, 1, 16, 0, 21, 0, 0, 0, 0, 0, 0, 0, 0
    .long 6, 1, 16, 2, 1, 16, 0, 16, 0, 0, 0, 0, 0, 0, 0, 0
    .long 6, 0, 50, 0, 1, 0, 0, 50, 0, 0, 0, 0, 0, 0, 0, 0
    .long 6, 0, 52, 0, 1, 0, 0, 52, 0, 0, 0, 0, 0, 0, 0, 0
    .long 6, 0, 54, 0, 1, 0, 0, 54, 0, 0, 0, 0, 0, 0, 0, 0
    .long 6, 0, 49, 0, 1, 0, 0, 49, 0, 0, 0, 0, 0, 0, 0, 0
    .long 6, 0, 48, 0, 1, 0, 0, 48, 0, 0, 0, 0, 0, 0, 0, 0
    .long 6, 0, 53, 0, 1, 0, 0, 53, 0, 0, 0, 0, 0, 0, 0, 0
    .long 6, 0, 55, 0, 1, 0, 0, 55, 0, 0, 0, 0, 0, 0, 0, 0
    .long 6, 0, 56, 0, 1, 0, 0, 56, 0, 0, 0, 0, 0, 0, 0, 0
    .long 6, 1, 23, 2, 1, 16, 0, 23, 0, 0, 0, 0, 0, 0, 0, 0
    .long 6, 1, 24, 2, 1, 16, 0, 24, 0, 0, 0, 0, 0, 0, 0, 0
    .long 6, 1, 25, 2, 1, 16, 0, 25, 0, 0, 0, 0, 0, 0, 0, 0
    .long 6, 1, 26, 2, 1, 16, 0, 26, 0, 0, 0, 0, 0, 0, 0, 0
    .long 6, 1, 27, 2, 1, 16, 0, 27, 0, 0, 0, 0, 0, 0, 0, 0
    .long 6, 1, 28, 2, 1, 16, 0, 28, 0, 0, 0, 0, 0, 0, 0, 0
    .long 6, 1, 29, 2, 1, 16, 0, 29, 0, 0, 0, 0, 0, 0, 0, 0
    .long 6, 1, 30, 2, 1, 16, 0, 30, 0, 0, 0, 0, 0, 0, 0, 0
    .long 6, 1, 31, 2, 1, 16, 0, 31, 0, 0, 0, 0, 0, 0, 0, 0
    .long 6, 0, 40, 1, 1, 16, 0, 40, 0, 0, 0, 0, 0, 0, 0, 0
    .long 6, 0, 41, 1, 1, 16, 0, 41, 0, 0, 0, 0, 0, 0, 0, 0
    .long 6, 0, 43, 1, 1, 16, 0, 43, 0, 0, 0, 0, 0, 0, 0, 0
    .long 6, 0, 45, 1, 1, 16, 0, 45, 0, 0, 0, 0, 0, 0, 0, 0
    .long 6, 0, 46, 1, 1, 16, 0, 46, 0, 0, 0, 0, 0, 0, 0, 0
    .long 6, 0, 47, 1, 1, 16, 0, 47, 0, 0, 0, 0, 0, 0, 0, 0
    .long 6, 1, 32, 1, 1, 16, 0, 32, 0, 0, 0, 0, 0, 0, 0, 0
    .long 6, 1, 33, 1, 1, 16, 0, 33, 0, 0, 0, 0, 0, 0, 0, 0
    .long 6, 1, 35, 1, 1, 16, 0, 35, 0, 0, 0, 0, 0, 0, 0, 0
    .long 6, 1, 36, 1, 1, 16, 0, 36, 0, 0, 0, 0, 0, 0, 0, 0
    .long 6, 1, 38, 1, 1, 16, 0, 38, 0, 0, 0, 0, 0, 0, 0, 0
    .long 6, 1, 39, 1, 1, 16, 0, 39, 0, 0, 0, 0, 0, 0, 0, 0
    .long 6, 0, 57, 0, 1, 0, 0, 57, 0, 0, 0, 0, 0, 0, 0, 0
    .long 6, 0, 44, 1, 1, 16, 0, 44, 0, 0, 0, 0, 0, 0, 0, 0
    .long 6, 1, 34, 1, 1, 16, 0, 34, 0, 0, 0, 0, 0, 0, 0, 0
    .long 6, 0, 58, 0, 1, 0, 0, 58, 0, 0, 0, 0, 0, 0, 0, 0
    .long 6, 1, 37, 1, 1, 16, 0, 37, 0, 0, 0, 0, 0, 0, 0, 0
    .long 6, 0, 42, 1, 1, 16, 0, 42, 0, 0, 0, 0, 0, 0, 0, 0
    .long 6, 0, 59, 0, 1, 0, 0, 59, 0, 0, 0, 0, 0, 0, 0, 0
    .long 6, 1, 8, 2, 1, 16, 0, 8, 0, 0, 0, 0, 0, 0, 0, 0
    .long 6, 1, 9, 2, 1, 16, 0, 9, 0, 0, 0, 0, 0, 0, 0, 0
    .long 6, 1, 10, 2, 1, 16, 0, 10, 0, 0, 0, 0, 0, 0, 0, 0
    .long 6, 1, 11, 2, 1, 16, 0, 11, 0, 0, 0, 0, 0, 0, 0, 0
    .long 6, 1, 12, 2, 1, 16, 0, 12, 0, 0, 0, 0, 0, 0, 0, 0
    .long 6, 1, 13, 2, 1, 16, 0, 13, 0, 0, 0, 0, 0, 0, 0, 0
    .long 6, 1, 14, 2, 1, 16, 0, 14, 0, 0, 0, 0, 0, 0, 0, 0
    .long 6, 1, 15, 2, 1, 16, 0, 15, 0, 0, 0, 0, 0, 0, 0, 0
    .long 7, 0, 60, 0, 4, 0, 0, 60, 0, 0, 0, 0, 0, 0, 0, 0
    .long 7, 0, 60, 0, 5, 0, 0, 60, 0, 0, 0, 0, 0, 0, 0, 0
    .long 7, 0, 60, 0, 6, 0, 0, 60, 0, 0, 0, 0, 0, 0, 0, 0
    .long 7, 0, 60, 0, 7, 0, 0, 60, 0, 0, 0, 0, 0, 0, 0, 0
    .long 7, 0, 61, 0, 4, 0, 0, 61, 0, 0, 0, 0, 0, 0, 0, 0
    .long 7, 0, 61, 0, 5, 0, 0, 61, 0, 0, 0, 0, 0, 0, 0, 0
    .long 7, 0, 61, 0, 6, 0, 0, 61, 0, 0, 0, 0, 0, 0, 0, 0
    .long 7, 0, 61, 0, 7, 0, 0, 61, 0, 0, 0, 0, 0, 0, 0, 0
    .long 7, 0, 62, 0, 4, 0, 0, 62, 0, 0, 0, 0, 0, 0, 0, 0
    .long 7, 0, 62, 0, 5, 0, 0, 62, 0, 0, 0, 0, 0, 0, 0, 0
    .long 7, 0, 62, 0, 6, 0, 0, 62, 0, 0, 0, 0, 0, 0, 0, 0
    .long 7, 0, 62, 0, 7, 0, 0, 62, 0, 0, 0, 0, 0, 0, 0, 0
    .long 7, 0, 63, 0, 4, 0, 0, 63, 0, 0, 0, 0, 0, 0, 0, 0
    .long 7, 0, 63, 0, 5, 0, 0, 63, 0, 0, 0, 0, 0, 0, 0, 0
    .long 7, 0, 63, 0, 6, 0, 0, 63, 0, 0, 0, 0, 0, 0, 0, 0
    .long 7, 0, 63, 0, 7, 0, 0, 63, 0, 0, 0, 0, 0, 0, 0, 0
    .long 0, 0, 0, 0, 0, 0, 0, 0, 0, 0, 0, 0, 0, 0, 0, 0
    .long 4, 24, 24, 8192, 4096, 266240, 8388608, 0, 32768, 4, 21037056, 131072, 0, 0, 218104385, 0
    .long 4, 24, 24, 8192, 4352, 266496, 8388608, 0, 32768, 4, 21041152, 131072, 0, 0, 218104385, 0
    .long 4, 24, 24, 8192, 4608, 266752, 8388608, 0, 32768, 4, 21045248, 131072, 0, 0, 218104385, 0
    .long 4, 24, 24, 8192, 4864, 267008, 8388608, 0, 32768, 4, 21049344, 131072, 0, 0, 218104385, 0
    .long 4, 24, 24, 8192, 5120, 267264, 8388608, 0, 32768, 4, 21053440, 131072, 0, 0, 218104401, 0
    .long 4, 24, 24, 8192, 5376, 267520, 8388608, 0, 32768, 4, 21057536, 131072, 0, 0, 218104401, 0
    .long 4, 24, 24, 8192, 5632, 267776, 8388608, 0, 32768, 4, 21061632, 131072, 0, 0, 218104401, 0
    .long 4, 24, 24, 8192, 5888, 268032, 8388608, 0, 32768, 4, 21065728, 131072, 0, 0, 218104401, 0
    .long 4, 32, 32, 8192, 4096, 266240, 8388608, 0, 32768, 4, 37814272, 131072, 0, 0, 218104385, 0
    .long 4, 32, 32, 8192, 4352, 266496, 8388608, 0, 32768, 4, 37818368, 131072, 0, 0, 218104385, 0
    .long 4, 32, 32, 8192, 4608, 266752, 8388608, 0, 32768, 4, 37822464, 131072, 0, 0, 218104385, 0
    .long 4, 32, 32, 8192, 4864, 267008, 8388608, 0, 32768, 4, 37826560, 131072, 0, 0, 218104385, 0
    .long 4, 32, 32, 8192, 5120, 267264, 8388608, 0, 32768, 4, 37830656, 131072, 0, 0, 218104401, 0
    .long 4, 32, 32, 8192, 5376, 267520, 8388608, 0, 32768, 4, 37834752, 131072, 0, 0, 218104401, 0
    .long 4, 32, 32, 8192, 5632, 267776, 8388608, 0, 32768, 4, 37838848, 131072, 0, 0, 218104401, 0
    .long 4, 32, 32, 8192, 5888, 268032, 8388608, 0, 32768, 4, 37842944, 131072, 0, 0, 218104401, 0
    .long 4, 24, 24, 8192, 4096, 266240, 8388608, 262144, 32768, 4, 22085632, 131072, 0, 0, 218104388, 0
    .long 4, 24, 24, 8192, 4352, 266496, 8388608, 262144, 32768, 4, 22089728, 131072, 0, 0, 218104388, 0
    .long 4, 24, 24, 8192, 4608, 266752, 8388608, 262144, 32768, 4, 22093824, 131072, 0, 0, 218104388, 0
    .long 4, 24, 24, 8192, 4864, 267008, 8388608, 262144, 32768, 4, 22097920, 131072, 0, 0, 218104388, 0
    .long 4, 24, 24, 8192, 5120, 267264, 8388608, 262144, 32768, 4, 22102016, 131072, 0, 0, 218104404, 0
    .long 4, 24, 24, 8192, 5376, 267520, 8388608, 262144, 32768, 4, 22106112, 131072, 0, 0, 218104404, 0
    .long 4, 24, 24, 8192, 5632, 267776, 8388608, 262144, 32768, 4, 22110208, 131072, 0, 0, 218104404, 0
    .long 4, 24, 24, 8192, 5888, 268032, 8388608, 262144, 32768, 4, 22114304, 131072, 0, 0, 218104404, 0
    .long 4, 32, 32, 8192, 4096, 266240, 8388608, 262144, 32768, 4, 38862848, 131072, 0, 0, 218104388, 0
    .long 4, 32, 32, 8192, 4352, 266496, 8388608, 262144, 32768, 4, 38866944, 131072, 0, 0, 218104388, 0
    .long 4, 32, 32, 8192, 4608, 266752, 8388608, 262144, 32768, 4, 38871040, 131072, 0, 0, 218104388, 0
    .long 4, 32, 32, 8192, 4864, 267008, 8388608, 262144, 32768, 4, 38875136, 131072, 0, 0, 218104388, 0
    .long 4, 32, 32, 8192, 5120, 267264, 8388608, 262144, 32768, 4, 38879232, 131072, 0, 0, 218104404, 0
    .long 4, 32, 32, 8192, 5376, 267520, 8388608, 262144, 32768, 4, 38883328, 131072, 0, 0, 218104404, 0
    .long 4, 32, 32, 8192, 5632, 267776, 8388608, 262144, 32768, 4, 38887424, 131072, 0, 0, 218104404, 0
    .long 4, 32, 32, 8192, 5888, 268032, 8388608, 262144, 32768, 4, 38891520, 131072, 0, 0, 218104404, 0
    .long 4, 32, 32, 8192, 4352, 266496, 8388608, 786432, 32768, 4, 40964096, 131072, 0, 0, 218104644, 0
    .long 4, 24, 24, 8192, 4608, 266752, 8388608, 786432, 32768, 4, 24190976, 131072, 0, 0, 218104644, 0
    .long 4, 24, 24, 8192, 5632, 267776, 8388608, 786432, 32768, 4, 24207360, 131072, 0, 0, 218104660, 0
    .long 4, 32, 32, 8192, 4864, 267008, 8388608, 524288, 32768, 4, 39923712, 131072, 0, 0, 218104641, 0
    .long 4, 32, 32, 8192, 5632, 267776, 8388608, 786432, 32768, 4, 40984576, 131072, 0, 0, 218104660, 0
    .long 4, 32, 32, 8192, 5376, 267520, 8388608, 524288, 32768, 4, 39931904, 131072, 0, 0, 218104657, 0
    .long 4, 24, 24, 8192, 5120, 267264, 8388608, 786432, 32768, 4, 24199168, 131072, 0, 0, 218104660, 0
    .long 4, 32, 32, 8192, 5888, 268032, 8388608, 524288, 32768, 4, 39940096, 131072, 0, 0, 218104657, 0
    .long 4, 32, 32, 8192, 4608, 266752, 8388608, 786432, 32768, 4, 40968192, 131072, 0, 0, 218104644, 0
    .long 4, 32, 32, 8192, 4608, 266752, 8388608, 524288, 32768, 4, 39919616, 131072, 0, 0, 218104641, 0
    .long 4, 32, 32, 8192, 5120, 267264, 8388608, 786432, 32768, 4, 40976384, 131072, 0, 0, 218104660, 0
    .long 4, 24, 24, 8192, 4864, 267008, 8388608, 524288, 32768, 4, 23146496, 131072, 0, 0, 218104641, 0
    .long 2, 64, 72, 7168, 3584, 3584, 7340032, 1048576, 32768, 8, 58253312, 114688, 0, 0, 218103953, 0
    .long 4, 24, 24, 8192, 4352, 266496, 8388608, 786432, 32768, 4, 24186880, 131072, 0, 0, 218104644, 0
    .long 4, 24, 24, 8192, 5376, 267520, 8388608, 524288, 32768, 4, 23154688, 131072, 0, 0, 218104657, 0
    .long 4, 32, 32, 8192, 4352, 266496, 8388608, 524288, 32768, 4, 39915520, 131072, 0, 0, 218104641, 0
    .long 4, 32, 32, 8192, 5888, 268032, 8388608, 786432, 32768, 4, 40988672, 131072, 0, 0, 218104660, 0
    .long 4, 24, 24, 8192, 4096, 266240, 8388608, 524288, 32768, 4, 23134208, 131072, 0, 0, 218104641, 0
    .long 4, 24, 24, 8192, 5632, 267776, 8388608, 524288, 32768, 4, 23158784, 131072, 0, 0, 218104657, 0
    .long 4, 32, 32, 8192, 4096, 266240, 8388608, 524288, 32768, 4, 39911424, 131072, 0, 0, 218104641, 0
    .long 4, 24, 24, 8192, 5888, 268032, 8388608, 524288, 32768, 4, 23162880, 131072, 0, 0, 218104657, 0
    .long 4, 32, 32, 8192, 4096, 266240, 8388608, 786432, 32768, 4, 40960000, 131072, 0, 0, 218104644, 0
    .long 4, 24, 24, 8192, 4864, 267008, 8388608, 786432, 32768, 4, 24195072, 131072, 0, 0, 218104644, 0
    .long 4, 32, 32, 8192, 4864, 267008, 8388608, 786432, 32768, 4, 40972288, 131072, 0, 0, 218104644, 0
    .long 4, 32, 32, 8192, 5632, 267776, 8388608, 524288, 32768, 4, 39936000, 131072, 0, 0, 218104657, 0
    .long 4, 24, 24, 8192, 5120, 267264, 8388608, 524288, 32768, 4, 23150592, 131072, 0, 0, 218104657, 0
    .long 4, 32, 32, 8192, 5376, 267520, 8388608, 786432, 32768, 4, 40980480, 131072, 0, 0, 218104660, 0
    .long 4, 24, 24, 8192, 4352, 266496, 8388608, 524288, 32768, 4, 23138304, 131072, 0, 0, 218104641, 0
    .long 4, 32, 32, 8192, 5120, 267264, 8388608, 524288, 32768, 4, 39927808, 131072, 0, 0, 218104657, 0
    .long 4, 24, 24, 8192, 4608, 266752, 8388608, 524288, 32768, 4, 23142400, 131072, 0, 0, 218104641, 0
    .long 4, 24, 24, 8192, 5376, 267520, 8388608, 786432, 32768, 4, 24203264, 131072, 0, 0, 218104660, 0
    .long 4, 24, 24, 8192, 4096, 266240, 8388608, 786432, 32768, 4, 24182784, 131072, 0, 0, 218104644, 0
    .long 1, 32, 32, 8192, 5120, 5376, 8388608, 1048576, 32768, 8, 42024960, 131072, 0, 0, 218104922, 0
    .long 1, 24, 24, 8192, 4608, 4864, 8388608, 1048576, 32768, 8, 25239552, 131072, 0, 0, 218104906, 0
    .long 1, 16, 16, 8192, 4608, 4864, 8388608, 1048576, 32768, 8, 8462336, 131072, 0, 0, 218104906, 0
    .long 1, 24, 24, 8192, 5120, 5376, 8388608, 1048576, 32768, 8, 25247744, 131072, 0, 0, 218104922, 0
    .long 4, 24, 24, 8192, 5888, 268032, 8388608, 786432, 32768, 4, 24211456, 131072, 0, 0, 218104660, 0
    .long 1, 16, 16, 8192, 4096, 4352, 8388608, 1048576, 32768, 8, 8454144, 131072, 0, 0, 218104906, 0
    .long 1, 24, 24, 8192, 4608, 4864, 8388608, 1572864, 32768, 8, 27336704, 131072, 0, 0, 218105162, 0
    .long 1, 32, 32, 8192, 5120, 5376, 8388608, 1572864, 32768, 8, 44122112, 131072, 0, 0, 218105178, 0
    .long 1, 24, 24, 8192, 4096, 4352, 8388608, 1048576, 32768, 8, 25231360, 131072, 0, 0, 218104906, 0
    .long 1, 32, 32, 8192, 4608, 4864, 8388608, 1048576, 32768, 8, 42016768, 131072, 0, 0, 218104906, 0
    .long 1, 16, 16, 8192, 5632, 5888, 8388608, 1572864, 32768, 8, 10575872, 131072, 0, 0, 218105178, 0
    .long 1, 16, 16, 8192, 4096, 4352, 8388608, 0, 32768, 8, 4259840, 131072, 0, 0, 218107978, 0
    .long 1, 24, 24, 8192, 5120, 5376, 8388608, 1572864, 32768, 8, 27344896, 131072, 0, 0, 218105178, 0
    .long 1, 32, 32, 8192, 5632, 5888, 8388608, 1572864, 32768, 8, 44130304, 131072, 0, 0, 218105178, 0
    .long 1, 32, 32, 8192, 4096, 4352, 8388608, 1048576, 32768, 8, 42008576, 131072, 0, 0, 218104906, 0
    .long 1, 16, 16, 8192, 5120, 5376, 8388608, 1572864, 32768, 8, 10567680, 131072, 0, 0, 218105178, 0
    .long 1, 32, 32, 8192, 5632, 5888, 8388608, 1048576, 32768, 8, 42033152, 131072, 0, 0, 218104922, 0
    .long 1, 24, 24, 8192, 5632, 5888, 8388608, 1572864, 32768, 8, 27353088, 131072, 0, 0, 218105178, 0
    .long 1, 16, 16, 8192, 5632, 5888, 8388608, 1048576, 32768, 8, 8478720, 131072, 0, 0, 218104922, 0
    .long 1, 32, 32, 8192, 4096, 4352, 8388608, 1572864, 32768, 8, 44105728, 131072, 0, 0, 218105162, 0
    .long 1, 16, 16, 8192, 5632, 5888, 8388608, 0, 32768, 8, 4284416, 131072, 0, 0, 218107994, 0
    .long 1, 16, 16, 8192, 4608, 4864, 8388608, 2097152, 32768, 8, 12656640, 131072, 0, 0, 218105418, 0
    .long 1, 16, 16, 8192, 5120, 5376, 8388608, 1048576, 32768, 8, 8470528, 131072, 0, 0, 218104922, 0
    .long 1, 16, 16, 8192, 4096, 4352, 8388608, 1572864, 32768, 8, 10551296, 131072, 0, 0, 218105162, 0
    .long 1, 32, 32, 8192, 4096, 4352, 8388608, 2097152, 32768, 8, 46202880, 131072, 0, 0, 218105418, 0
    .long 1, 16, 16, 8192, 4608, 4864, 8388608, 0, 32768, 8, 4268032, 131072, 0, 0, 218107978, 0
    .long 1, 24, 24, 8192, 5632, 5888, 8388608, 1048576, 32768, 8, 25255936, 131072, 0, 0, 218104922, 0
    .long 1, 16, 16, 8192, 4608, 4864, 8388608, 1572864, 32768, 8, 10559488, 131072, 0, 0, 218105162, 0
    .long 1, 16, 16, 8192, 5120, 5376, 8388608, 0, 32768, 8, 4276224, 131072, 0, 0, 218107994, 0
    .long 1, 32, 32, 8192, 4608, 4864, 8388608, 2097152, 32768, 8, 46211072, 131072, 0, 0, 218105418, 0
    .long 1, 32, 32, 8192, 4608, 4864, 8388608, 1572864, 32768, 8, 44113920, 131072, 0, 0, 218105162, 0
    .long 1, 24, 24, 8192, 4096, 4352, 8388608, 1572864, 32768, 8, 27328512, 131072, 0, 0, 218105162, 0
    .long 1, 16, 16, 8192, 4096, 4352, 8388608, 524288, 32768, 8, 6356992, 131072, 0, 0, 218108234, 0
    .long 1, 32, 32, 8192, 5120, 5376, 8388608, 3670016, 32768, 8, 52510720, 131072, 0, 0, 218106202, 0
    .long 1, 16, 16, 8192, 5120, 5376, 8388608, 2621440, 32768, 8, 14761984, 131072, 0, 0, 218105690, 0
    .long 1, 24, 24, 8192, 4608, 4864, 8388608, 3145728, 32768, 8, 33628160, 131072, 0, 0, 218105930, 0
    .long 1, 16, 16, 8192, 4096, 4352, 8388608, 2621440, 32768, 8, 14745600, 131072, 0, 0, 218105674, 0
    .long 1, 32, 32, 8192, 5632, 5888, 8388608, 3670016, 32768, 8, 52518912, 131072, 0, 0, 218106202, 0
    .long 1, 16, 16, 8192, 4096, 4352, 8388608, 3145728, 32768, 8, 16842752, 131072, 0, 0, 218105930, 0
    .long 1, 24, 24, 8192, 5120, 5376, 8388608, 2097152, 32768, 8, 29442048, 131072, 0, 0, 218105434, 0
    .long 1, 16, 16, 8192, 5632, 5888, 8388608, 2097152, 32768, 8, 12673024, 131072, 0, 0, 218105434, 0
    .long 1, 24, 24, 8192, 4608, 4864, 8388608, 3670016, 32768, 8, 35725312, 131072, 0, 0, 218106186, 0
    .long 1, 24, 24, 8192, 5632, 5888, 8388608, 3145728, 32768, 8, 33644544, 131072, 0, 0, 218105946, 0
    .long 1, 32, 32, 8192, 5632, 5888, 8388608, 2621440, 32768, 8, 48324608, 131072, 0, 0, 218105690, 0
    .long 1, 32, 32, 8192, 5632, 5888, 8388608, 2097152, 32768, 8, 46227456, 131072, 0, 0, 218105434, 0
    .long 1, 24, 24, 8192, 5632, 5888, 8388608, 2097152, 32768, 8, 29450240, 131072, 0, 0, 218105434, 0
    .long 1, 24, 24, 8192, 4096, 4352, 8388608, 2097152, 32768, 8, 29425664, 131072, 0, 0, 218105418, 0
    .long 1, 32, 32, 8192, 5632, 5888, 8388608, 3145728, 32768, 8, 50421760, 131072, 0, 0, 218105946, 0
    .long 1, 32, 32, 8192, 4096, 4352, 8388608, 3145728, 32768, 8, 50397184, 131072, 0, 0, 218105930, 0
    .long 1, 16, 16, 8192, 5120, 5376, 8388608, 3145728, 32768, 8, 16859136, 131072, 0, 0, 218105946, 0
    .long 1, 16, 16, 8192, 5120, 5376, 8388608, 2097152, 32768, 8, 12664832, 131072, 0, 0, 218105434, 0
    .long 5, 218107984, 0, 0, 20, 0, 0, 0, 0, 0, 0, 0, 218112256, 4, 218106897, 0
    .long 1, 32, 32, 8192, 5120, 5376, 8388608, 3145728, 32768, 8, 50413568, 131072, 0, 0, 218105946, 0
    .long 1, 24, 24, 8192, 5632, 5888, 8388608, 3670016, 32768, 8, 35741696, 131072, 0, 0, 218106202, 0
    .long 1, 32, 32, 8192, 4096, 4352, 8388608, 2621440, 32768, 8, 48300032, 131072, 0, 0, 218105674, 0
    .long 1, 32, 32, 8192, 5120, 5376, 8388608, 2097152, 32768, 8, 46219264, 131072, 0, 0, 218105434, 0
    .long 1, 24, 24, 8192, 4608, 4864, 8388608, 2621440, 32768, 8, 31531008, 131072, 0, 0, 218105674, 0
    .long 1, 24, 24, 8192, 4608, 4864, 8388608, 2097152, 32768, 8, 29433856, 131072, 0, 0, 218105418, 0
    .long 1, 16, 16, 8192, 5632, 5888, 8388608, 524288, 32768, 8, 6381568, 131072, 0, 0, 218108250, 0
    .long 1, 32, 32, 8192, 5120, 5376, 8388608, 2621440, 32768, 8, 48316416, 131072, 0, 0, 218105690, 0
    .long 1, 16, 16, 8192, 5120, 5376, 8388608, 524288, 32768, 8, 6373376, 131072, 0, 0, 218108250, 0
    .long 1, 24, 24, 8192, 4096, 4352, 8388608, 2621440, 32768, 8, 31522816, 131072, 0, 0, 218105674, 0
    .long 1, 16, 16, 8192, 4096, 4352, 8388608, 2097152, 32768, 8, 12648448, 131072, 0, 0, 218105418, 0
    .long 5, 218107984, 0, 0, 20, 0, 0, 4, 0, 0, 0, 0, 218112256, 8, 218106897, 0
    .long 5, 218107968, 0, 0, 16, 0, 0, 0, 0, 0, 0, 0, 218112256, 4, 218106897, 0
    .long 1, 24, 24, 8192, 5120, 5376, 8388608, 3670016, 32768, 8, 35733504, 131072, 0, 0, 218106202, 0
    .long 2, 64, 72, 7168, 3584, 3584, 7340032, 2097152, 32768, 8, 61923328, 114688, 0, 0, 218104081, 0
    .long 1, 24, 24, 8192, 5632, 5888, 8388608, 2621440, 32768, 8, 31547392, 131072, 0, 0, 218105690, 0
    .long 2, 64, 72, 7168, 3840, 3840, 7340032, 0, 32768, 8, 54587392, 114688, 0, 0, 218103825, 0
    .long 1, 24, 24, 8192, 4096, 4352, 8388608, 3670016, 32768, 8, 35717120, 131072, 0, 0, 218106186, 0
    .long 1, 32, 32, 8192, 4608, 4864, 8388608, 3670016, 32768, 8, 52502528, 131072, 0, 0, 218106186, 0
    .long 2, 64, 72, 7168, 4608, 4608, 7340032, 2621440, 32768, 8, 63774720, 114688, 0, 0, 218104145, 0
    .long 1, 32, 32, 8192, 4608, 4864, 8388608, 2621440, 32768, 8, 48308224, 131072, 0, 0, 218105674, 0
    .long 1, 16, 16, 8192, 4608, 4864, 8388608, 2621440, 32768, 8, 14753792, 131072, 0, 0, 218105674, 0
    .long 2, 64, 72, 7168, 3584, 3584, 7340032, 0, 32768, 8, 54583296, 114688, 0, 0, 218103825, 0
    .long 1, 16, 16, 8192, 5632, 5888, 8388608, 3145728, 32768, 8, 16867328, 131072, 0, 0, 218105946, 0
    .long 1, 24, 24, 8192, 5120, 5376, 8388608, 2621440, 32768, 8, 31539200, 131072, 0, 0, 218105690, 0
    .long 2, 64, 72, 7168, 3840, 3840, 7340032, 524288, 32768, 8, 56422400, 114688, 0, 0, 218103889, 0
    .long 1, 24, 24, 8192, 4096, 4352, 8388608, 3145728, 32768, 8, 33619968, 131072, 0, 0, 218105930, 0
    .long 2, 64, 72, 7168, 4352, 4352, 7340032, 0, 32768, 8, 54595584, 114688, 0, 0, 218103825, 0
    .long 2, 64, 72, 7168, 4352, 4352, 7340032, 524288, 32768, 8, 56430592, 114688, 0, 0, 218103889, 0
    .long 2, 64, 72, 7168, 4096, 4096, 7340032, 2097152, 32768, 8, 61931520, 114688, 0, 0, 218104081, 0
    .long 2, 64, 72, 7168, 4608, 4608, 7340032, 2097152, 32768, 8, 61939712, 114688, 0, 0, 218104081, 0
    .long 1, 16, 16, 8192, 4608, 4864, 8388608, 524288, 32768, 8, 6365184, 131072, 0, 0, 218108234, 0
    .long 1, 16, 16, 8192, 4608, 4864, 8388608, 3145728, 32768, 8, 16850944, 131072, 0, 0, 218105930, 0
    .long 2, 64, 72, 7168, 4608, 4608, 7340032, 0, 32768, 8, 54599680, 114688, 0, 0, 218103825, 0
    .long 2, 64, 72, 7168, 4864, 4864, 7340032, 0, 32768, 8, 54603776, 114688, 0, 0, 218103825, 0
    .long 1, 16, 16, 8192, 5632, 5888, 8388608, 2621440, 32768, 8, 14770176, 131072, 0, 0, 218105690, 0
    .long 1, 24, 24, 8192, 5120, 5376, 8388608, 3145728, 32768, 8, 33636352, 131072, 0, 0, 218105946, 0
    .long 2, 64, 72, 7168, 4864, 4864, 7340032, 3145728, 32768, 8, 65613824, 114688, 0, 0, 218104209, 0
    .long 1, 32, 32, 8192, 4608, 4864, 8388608, 3145728, 32768, 8, 50405376, 131072, 0, 0, 218105930, 0
    .long 1, 16, 16, 8192, 5632, 5888, 8388608, 3670016, 32768, 8, 18964480, 131072, 0, 0, 218106202, 0
    .long 2, 64, 72, 7168, 5120, 5120, 7340032, 0, 32768, 8, 54607872, 114688, 0, 0, 218103825, 0
    .long 2, 64, 72, 7168, 4096, 4096, 7340032, 0, 32768, 8, 54591488, 114688, 0, 0, 218103825, 0
    .long 5, 218107968, 0, 0, 16, 0, 0, 4, 0, 0, 0, 0, 218112256, 8, 218106897, 0
    .long 2, 64, 72, 7168, 5120, 5120, 7340032, 3145728, 32768, 8, 65617920, 114688, 0, 0, 218104209, 0
    .long 2, 64, 72, 7168, 3584, 3584, 7340032, 524288, 32768, 8, 56418304, 114688, 0, 0, 218103889, 0
    .long 2, 64, 72, 7168, 4864, 4864, 7340032, 1572864, 32768, 8, 60108800, 114688, 0, 0, 218104017, 0
    .long 2, 64, 72, 7168, 5120, 5120, 7340032, 524288, 32768, 8, 56442880, 114688, 0, 0, 218103889, 0
    .long 1, 16, 16, 8192, 4096, 4352, 8388608, 3670016, 32768, 8, 18939904, 131072, 0, 0, 218106186, 0
    .long 5, 218108240, 0, 0, 20, 0, 0, 8, 0, 0, 0, 0, 218112256, 12, 218106961, 0
    .long 2, 64, 72, 7168, 3584, 3584, 7340032, 3145728, 32768, 8, 65593344, 114688, 0, 0, 218104209, 0
    .long 2, 64, 72, 7168, 4096, 4096, 7340032, 1572864, 32768, 8, 60096512, 114688, 0, 0, 218104017, 0
    .long 2, 64, 72, 7168, 4352, 4352, 7340032, 2097152, 32768, 8, 61935616, 114688, 0, 0, 218104081, 0
    .long 2, 64, 72, 7168, 3584, 3584, 7340032, 1572864, 32768, 8, 60088320, 114688, 0, 0, 218104017, 0
    .long 2, 64, 72, 7168, 4352, 4352, 7340032, 1572864, 32768, 8, 60100608, 114688, 0, 0, 218104017, 0
    .long 2, 64, 72, 7168, 5120, 5120, 7340032, 1572864, 32768, 8, 60112896, 114688, 0, 0, 218104017, 0
    .long 2, 64, 72, 7168, 3840, 3840, 7340032, 1572864, 32768, 8, 60092416, 114688, 0, 0, 218104017, 0
    .long 2, 64, 72, 7168, 3840, 3840, 7340032, 2097152, 32768, 8, 61927424, 114688, 0, 0, 218104081, 0
    .long 2, 64, 72, 7168, 4864, 4864, 7340032, 2097152, 32768, 8, 61943808, 114688, 0, 0, 218104081, 0
    .long 2, 64, 72, 7168, 4096, 4096, 7340032, 524288, 32768, 8, 56426496, 114688, 0, 0, 218103889, 0
    .long 2, 64, 72, 7168, 5120, 5120, 7340032, 2097152, 32768, 8, 61947904, 114688, 0, 0, 218104081, 0
    .long 2, 64, 72, 7168, 4608, 4608, 7340032, 1572864, 32768, 8, 60104704, 114688, 0, 0, 218104017, 0
    .long 2, 64, 72, 7168, 3840, 3840, 7340032, 1048576, 32768, 8, 58257408, 114688, 0, 0, 218103953, 0
    .long 2, 64, 72, 7168, 4608, 4608, 7340032, 1048576, 32768, 8, 58269696, 114688, 0, 0, 218103953, 0
    .long 2, 64, 72, 7168, 4096, 4096, 7340032, 3145728, 32768, 8, 65601536, 114688, 0, 0, 218104209, 0
    .long 2, 64, 72, 7168, 4864, 4864, 7340032, 1048576, 32768, 8, 58273792, 114688, 0, 0, 218103953, 0
    .long 5, 218108240, 0, 0, 20, 0, 0, 12, 0, 0, 0, 0, 218112256, 16, 218106961, 0
    .long 2, 64, 72, 7168, 5120, 5120, 7340032, 1048576, 32768, 8, 58277888, 114688, 0, 0, 218103953, 0
    .long 2, 64, 72, 7168, 4608, 4608, 7340032, 3145728, 32768, 8, 65609728, 114688, 0, 0, 218104209, 0
    .long 2, 64, 72, 7168, 4864, 4864, 7340032, 524288, 32768, 8, 56438784, 114688, 0, 0, 218103889, 0
    .long 2, 64, 72, 7168, 4352, 4352, 7340032, 1048576, 32768, 8, 58265600, 114688, 0, 0, 218103953, 0
    .long 2, 64, 72, 7168, 4096, 4096, 7340032, 1048576, 32768, 8, 58261504, 114688, 0, 0, 218103953, 0
    .long 2, 64, 72, 7168, 3840, 3840, 7340032, 3145728, 32768, 8, 65597440, 114688, 0, 0, 218104209, 0
    .long 5, 218108224, 0, 0, 16, 0, 0, 12, 0, 0, 0, 0, 218112256, 16, 218106961, 0
    .long 2, 64, 72, 7168, 4352, 4352, 7340032, 3670016, 32768, 8, 67440640, 114688, 0, 0, 218104273, 0
    .long 2, 64, 72, 7168, 4608, 4608, 7340032, 524288, 32768, 8, 56434688, 114688, 0, 0, 218103889, 0
    .long 1, 80, 80, 2048, 3670528, 3670784, 7340032, 54583296, 114688, 14, 121643008, 32768, 218103824, 14, 218106370, 0
    .long 1, 40, 40, 2048, 4194304, 4194560, 8388608, 176226304, 131072, 16, 79691776, 32768, 218106896, 8, 218106376, 0
    .long 5, 218108224, 0, 0, 16, 0, 0, 8, 0, 0, 0, 0, 218112256, 12, 218106961, 0
    .long 1, 32, 32, 8192, 4096, 4352, 8388608, 3670016, 32768, 8, 52494336, 131072, 0, 0, 218106186, 0
    .long 1, 16, 16, 8192, 4608, 4864, 8388608, 3670016, 32768, 8, 18948096, 131072, 0, 0, 218106186, 0
    .long 1, 16, 16, 8192, 5120, 5376, 8388608, 3670016, 32768, 8, 18956288, 131072, 0, 0, 218106202, 0
    .long 1, 40, 40, 2048, 4194816, 4195072, 8388608, 182517760, 131072, 16, 81272832, 32768, 218112256, 33, 218106568, 0
    .long 1, 40, 40, 2048, 4194816, 4195072, 8388608, 176226304, 131072, 16, 79699968, 32768, 218106896, 8, 218106376, 0
    .long 2, 64, 72, 7168, 4352, 4352, 7340032, 3145728, 32768, 8, 65605632, 114688, 0, 0, 218104209, 0
    .long 1, 40, 40, 2048, 4194304, 4194560, 8388608, 180420608, 131072, 16, 80740352, 32768, 218112256, 25, 218106504, 0
    .long 1, 40, 40, 2048, 4194816, 4195072, 8388608, 180420608, 131072, 16, 80748544, 32768, 218112256, 25, 218106504, 0
    .long 2, 64, 72, 7168, 4864, 4864, 7340032, 2621440, 32768, 8, 63778816, 114688, 0, 0, 218104145, 0
    .long 1, 40, 40, 2048, 4194304, 4194560, 8388608, 182517760, 131072, 16, 81264640, 32768, 218112256, 33, 218106568, 0
    .long 2, 64, 72, 7168, 3584, 3584, 7340032, 2621440, 32768, 8, 63758336, 114688, 0, 0, 218104145, 0
    .long 1, 80, 80, 2048, 3670016, 3670272, 7340032, 54583296, 114688, 14, 121634816, 32768, 218103824, 14, 218106370, 0
    .long 2, 64, 72, 7168, 5120, 5120, 7340032, 2621440, 32768, 8, 63782912, 114688, 0, 0, 218104145, 0
    .long 2, 64, 72, 7168, 3840, 3840, 7340032, 2621440, 32768, 8, 63762432, 114688, 0, 0, 218104145, 0
    .long 2, 64, 72, 7168, 4096, 4096, 7340032, 3670016, 32768, 8, 67436544, 114688, 0, 0, 218104273, 0
    .long 2, 64, 72, 7168, 4864, 4864, 7340032, 3670016, 32768, 8, 67448832, 114688, 0, 0, 218104273, 0
    .long 1, 40, 40, 2048, 4194304, 4194560, 8388608, 178323456, 131072, 16, 80216064, 32768, 218106960, 8, 218106440, 0
    .long 1, 40, 40, 2048, 4194816, 4195072, 8388608, 178323456, 131072, 16, 80224256, 32768, 218106960, 8, 218106440, 0
    .long 2, 64, 72, 7168, 4352, 4352, 7340032, 2621440, 32768, 8, 63770624, 114688, 0, 0, 218104145, 0
    .long 2, 64, 72, 7168, 3584, 3584, 7340032, 3670016, 32768, 8, 67428352, 114688, 0, 0, 218104273, 0
    .long 2, 64, 72, 7168, 4096, 4096, 7340032, 2621440, 32768, 8, 63766528, 114688, 0, 0, 218104145, 0
    .long 1, 80, 80, 2048, 3670528, 3670784, 7340032, 61923328, 114688, 14, 123740160, 32768, 218104080, 14, 218106626, 0
    .long 1, 80, 80, 2048, 3670016, 3670272, 7340032, 60088320, 114688, 14, 123207680, 32768, 218104016, 14, 218106562, 0
    .long 1, 80, 80, 2048, 3670016, 3670272, 7340032, 61923328, 114688, 14, 123731968, 32768, 218104080, 14, 218106626, 0
    .long 1, 80, 80, 2048, 3670528, 3670784, 7340032, 60088320, 114688, 14, 123215872, 32768, 218104016, 14, 218106562, 0
    .long 2, 64, 72, 7168, 4608, 4608, 7340032, 3670016, 32768, 8, 67444736, 114688, 0, 0, 218104273, 0
    .long 2, 64, 72, 7168, 3840, 3840, 7340032, 3670016, 32768, 8, 67432448, 114688, 0, 0, 218104273, 0
    .long 1, 80, 80, 2048, 3670016, 3670272, 7340032, 58253312, 114688, 14, 122683392, 32768, 218103952, 14, 218106498, 0
    .long 1, 80, 80, 2048, 3670528, 3670784, 7340032, 58253312, 114688, 14, 122691584, 32768, 218103952, 14, 218106498, 0
    .long 2, 64, 72, 7168, 5120, 5120, 7340032, 3670016, 32768, 8, 67452928, 114688, 0, 0, 218104273, 0
    .long 1, 80, 80, 2048, 3670528, 3670784, 7340032, 56418304, 114688, 14, 122167296, 32768, 218103888, 14, 218106434, 0
    .long 1, 80, 80, 2048, 3670016, 3670272, 7340032, 56418304, 114688, 14, 122159104, 32768, 218103888, 14, 218106434, 0
    .long 1, 40, 40, 2048, 4194816, 4195072, 8388608, 184614912, 131072, 8, 85991424, 32768, 218112256, 41, 218106628, 0
    .long 1, 80, 80, 2048, 3670016, 3670272, 7340032, 65593344, 114688, 7, 128974848, 32768, 218104208, 7, 218106753, 0
    .long 1, 80, 80, 2048, 3670528, 3670784, 7340032, 65593344, 114688, 7, 128983040, 32768, 218104208, 7, 218106753, 0
    .long 1, 40, 40, 2048, 4194304, 4194560, 8388608, 184614912, 131072, 8, 85983232, 32768, 218112256, 41, 218106628, 0
    .long 1, 80, 80, 2048, 3671552, 3671808, 7340032, 65593344, 114688, 7, 128999424, 32768, 218104208, 7, 218106753, 0
    .long 1, 40, 40, 2048, 4195328, 4195584, 8388608, 184614912, 131072, 8, 85999616, 32768, 218112256, 41, 218106628, 0
    .long 1, 40, 40, 2048, 4195840, 4196096, 8388608, 184614912, 131072, 8, 86007808, 32768, 218112256, 41, 218106628, 0
    .long 1, 40, 40, 2048, 4194816, 4195072, 8388608, 186712064, 131072, 8, 86515712, 32768, 218112256, 49, 218106692, 0
    .long 1, 80, 80, 2048, 3671040, 3671296, 7340032, 65593344, 114688, 7, 128991232, 32768, 218104208, 7, 218106753, 0
    .long 1, 40, 40, 2048, 4195328, 4195584, 8388608, 186712064, 131072, 8, 86523904, 32768, 218112256, 49, 218106692, 0
    .long 1, 40, 40, 2048, 4194304, 4194560, 8388608, 186712064, 131072, 8, 86507520, 32768, 218112256, 49, 218106692, 0
    .long 1, 40, 40, 2048, 4195840, 4196096, 8388608, 186712064, 131072, 8, 86532096, 32768, 218112256, 49, 218106692, 0
    .long 1, 80, 80, 2048, 3671040, 3671296, 7340032, 63758336, 114688, 7, 128466944, 32768, 218104144, 7, 218106689, 0
    .long 1, 80, 80, 2048, 3671552, 3671808, 7340032, 63758336, 114688, 7, 128475136, 32768, 218104144, 7, 218106689, 0
    .long 1, 80, 80, 2048, 3670016, 3670272, 7340032, 63758336, 114688, 7, 128450560, 32768, 218104144, 7, 218106689, 0
    .long 1, 80, 80, 2048, 3670528, 3670784, 7340032, 63758336, 114688, 7, 128458752, 32768, 218104144, 7, 218106689, 0
    .long 1, 80, 80, 2048, 3670528, 3670784, 7340032, 67428352, 114688, 7, 129507328, 32768, 218104272, 7, 218106817, 0
    .long 1, 80, 80, 2048, 3671040, 3671296, 7340032, 67428352, 114688, 7, 129515520, 32768, 218104272, 7, 218106817, 0
    .long 1, 80, 80, 2048, 3671552, 3671808, 7340032, 67428352, 114688, 7, 129523712, 32768, 218104272, 7, 218106817, 0
    .long 1, 80, 80, 2048, 3670016, 3670272, 7340032, 67428352, 114688, 7, 129499136, 32768, 218104272, 7, 218106817, 0
    .long 6, 1, 3, 2, 2, 16, 0, 3, 0, 0, 0, 0, 0, 0, 0, 0
    .long 6, 0, 51, 0, 2, 0, 0, 51, 0, 0, 0, 0, 0, 0, 0, 0
    .long 6, 1, 1, 2, 2, 16, 0, 1, 0, 0, 0, 0, 0, 0, 0, 0
    .long 6, 1, 0, 2, 2, 16, 0, 0, 0, 0, 0, 0, 0, 0, 0, 0
    .long 6, 1, 5, 2, 2, 16, 0, 5, 0, 0, 0, 0, 0, 0, 0, 0
    .long 6, 1, 4, 2, 2, 16, 0, 4, 0, 0, 0, 0, 0, 0, 0, 0
    .long 6, 1, 22, 2, 2, 16, 0, 22, 0, 0, 0, 0, 0, 0, 0, 0
    .long 6, 1, 6, 2, 2, 16, 0, 6, 0, 0, 0, 0, 0, 0, 0, 0
    .long 6, 1, 18, 2, 2, 16, 0, 18, 0, 0, 0, 0, 0, 0, 0, 0
    .long 6, 1, 19, 2, 2, 16, 0, 19, 0, 0, 0, 0, 0, 0, 0, 0
    .long 6, 1, 20, 2, 2, 16, 0, 20, 0, 0, 0, 0, 0, 0, 0, 0
    .long 6, 1, 7, 2, 2, 16, 0, 7, 0, 0, 0, 0, 0, 0, 0, 0
    .long 6, 1, 2, 2, 2, 16, 0, 2, 0, 0, 0, 0, 0, 0, 0, 0
    .long 6, 1, 17, 2, 2, 16, 0, 17, 0, 0, 0, 0, 0, 0, 0, 0
    .long 6, 1, 21, 2, 2, 16, 0, 21, 0, 0, 0, 0, 0, 0, 0, 0
    .long 6, 1, 16, 2, 2, 16, 0, 16, 0, 0, 0, 0, 0, 0, 0, 0
    .long 6, 0, 50, 0, 2, 0, 0, 50, 0, 0, 0, 0, 0, 0, 0, 0
    .long 6, 0, 52, 0, 2, 0, 0, 52, 0, 0, 0, 0, 0, 0, 0, 0
    .long 6, 0, 54, 0, 2, 0, 0, 54, 0, 0, 0, 0, 0, 0, 0, 0
    .long 6, 0, 49, 0, 2, 0, 0, 49, 0, 0, 0, 0, 0, 0, 0, 0
    .long 6, 0, 48, 0, 2, 0, 0, 48, 0, 0, 0, 0, 0, 0, 0, 0
    .long 6, 0, 53, 0, 2, 0, 0, 53, 0, 0, 0, 0, 0, 0, 0, 0
    .long 6, 0, 55, 0, 2, 0, 0, 55, 0, 0, 0, 0, 0, 0, 0, 0
    .long 6, 0, 56, 0, 2, 0, 0, 56, 0, 0, 0, 0, 0, 0, 0, 0
    .long 6, 1, 23, 2, 2, 16, 0, 23, 0, 0, 0, 0, 0, 0, 0, 0
    .long 6, 1, 24, 2, 2, 16, 0, 24, 0, 0, 0, 0, 0, 0, 0, 0
    .long 6, 1, 25, 2, 2, 16, 0, 25, 0, 0, 0, 0, 0, 0, 0, 0
    .long 6, 1, 26, 2, 2, 16, 0, 26, 0, 0, 0, 0, 0, 0, 0, 0
    .long 6, 1, 27, 2, 2, 16, 0, 27, 0, 0, 0, 0, 0, 0, 0, 0
    .long 6, 1, 28, 2, 2, 16, 0, 28, 0, 0, 0, 0, 0, 0, 0, 0
    .long 6, 1, 29, 2, 2, 16, 0, 29, 0, 0, 0, 0, 0, 0, 0, 0
    .long 6, 1, 30, 2, 2, 16, 0, 30, 0, 0, 0, 0, 0, 0, 0, 0
    .long 6, 1, 31, 2, 2, 16, 0, 31, 0, 0, 0, 0, 0, 0, 0, 0
    .long 6, 0, 40, 1, 2, 16, 0, 40, 0, 0, 0, 0, 0, 0, 0, 0
    .long 6, 0, 41, 1, 2, 16, 0, 41, 0, 0, 0, 0, 0, 0, 0, 0
    .long 6, 0, 43, 1, 2, 16, 0, 43, 0, 0, 0, 0, 0, 0, 0, 0
    .long 6, 0, 45, 1, 2, 16, 0, 45, 0, 0, 0, 0, 0, 0, 0, 0
    .long 6, 0, 46, 1, 2, 16, 0, 46, 0, 0, 0, 0, 0, 0, 0, 0
    .long 6, 0, 47, 1, 2, 16, 0, 47, 0, 0, 0, 0, 0, 0, 0, 0
    .long 6, 1, 32, 1, 2, 16, 0, 32, 0, 0, 0, 0, 0, 0, 0, 0
    .long 6, 1, 33, 1, 2, 16, 0, 33, 0, 0, 0, 0, 0, 0, 0, 0
    .long 6, 1, 35, 1, 2, 16, 0, 35, 0, 0, 0, 0, 0, 0, 0, 0
    .long 6, 1, 36, 1, 2, 16, 0, 36, 0, 0, 0, 0, 0, 0, 0, 0
    .long 6, 1, 38, 1, 2, 16, 0, 38, 0, 0, 0, 0, 0, 0, 0, 0
    .long 6, 1, 39, 1, 2, 16, 0, 39, 0, 0, 0, 0, 0, 0, 0, 0
    .long 6, 0, 57, 0, 2, 0, 0, 57, 0, 0, 0, 0, 0, 0, 0, 0
    .long 6, 0, 44, 1, 2, 16, 0, 44, 0, 0, 0, 0, 0, 0, 0, 0
    .long 6, 1, 34, 1, 2, 16, 0, 34, 0, 0, 0, 0, 0, 0, 0, 0
    .long 6, 0, 58, 0, 2, 0, 0, 58, 0, 0, 0, 0, 0, 0, 0, 0
    .long 6, 1, 37, 1, 2, 16, 0, 37, 0, 0, 0, 0, 0, 0, 0, 0
    .long 6, 0, 42, 1, 2, 16, 0, 42, 0, 0, 0, 0, 0, 0, 0, 0
    .long 6, 0, 59, 0, 2, 0, 0, 59, 0, 0, 0, 0, 0, 0, 0, 0
    .long 6, 1, 8, 2, 2, 16, 0, 8, 0, 0, 0, 0, 0, 0, 0, 0
    .long 6, 1, 9, 2, 2, 16, 0, 9, 0, 0, 0, 0, 0, 0, 0, 0
    .long 6, 1, 10, 2, 2, 16, 0, 10, 0, 0, 0, 0, 0, 0, 0, 0
    .long 6, 1, 11, 2, 2, 16, 0, 11, 0, 0, 0, 0, 0, 0, 0, 0
    .long 6, 1, 12, 2, 2, 16, 0, 12, 0, 0, 0, 0, 0, 0, 0, 0
    .long 6, 1, 13, 2, 2, 16, 0, 13, 0, 0, 0, 0, 0, 0, 0, 0
    .long 6, 1, 14, 2, 2, 16, 0, 14, 0, 0, 0, 0, 0, 0, 0, 0
    .long 6, 1, 15, 2, 2, 16, 0, 15, 0, 0, 0, 0, 0, 0, 0, 0
    .long 7, 0, 60, 0, 8, 0, 0, 60, 0, 0, 0, 0, 0, 0, 0, 0
    .long 7, 0, 60, 0, 9, 0, 0, 60, 0, 0, 0, 0, 0, 0, 0, 0
    .long 7, 0, 60, 0, 10, 0, 0, 60, 0, 0, 0, 0, 0, 0, 0, 0
    .long 7, 0, 60, 0, 11, 0, 0, 60, 0, 0, 0, 0, 0, 0, 0, 0
    .long 7, 0, 61, 0, 8, 0, 0, 61, 0, 0, 0, 0, 0, 0, 0, 0
    .long 7, 0, 61, 0, 9, 0, 0, 61, 0, 0, 0, 0, 0, 0, 0, 0
    .long 7, 0, 61, 0, 10, 0, 0, 61, 0, 0, 0, 0, 0, 0, 0, 0
    .long 7, 0, 61, 0, 11, 0, 0, 61, 0, 0, 0, 0, 0, 0, 0, 0
    .long 7, 0, 62, 0, 8, 0, 0, 62, 0, 0, 0, 0, 0, 0, 0, 0
    .long 7, 0, 62, 0, 9, 0, 0, 62, 0, 0, 0, 0, 0, 0, 0, 0
    .long 7, 0, 62, 0, 10, 0, 0, 62, 0, 0, 0, 0, 0, 0, 0, 0
    .long 7, 0, 62, 0, 11, 0, 0, 62, 0, 0, 0, 0, 0, 0, 0, 0
    .long 7, 0, 63, 0, 8, 0, 0, 63, 0, 0, 0, 0, 0, 0, 0, 0
    .long 7, 0, 63, 0, 9, 0, 0, 63, 0, 0, 0, 0, 0, 0, 0, 0
    .long 7, 0, 63, 0, 10, 0, 0, 63, 0, 0, 0, 0, 0, 0, 0, 0
    .long 7, 0, 63, 0, 11, 0, 0, 63, 0, 0, 0, 0, 0, 0, 0, 0
    .long 0, 0, 0, 0, 0, 0, 0, 0, 0, 0, 0, 0, 0, 0, 0, 0
    .long 4, 24, 24, 8192, 6144, 268288, 8388608, 0, 32768, 4, 21069824, 131072, 0, 0, 218104417, 0
    .long 4, 24, 24, 8192, 6400, 268544, 8388608, 0, 32768, 4, 21073920, 131072, 0, 0, 218104417, 0
    .long 4, 24, 24, 8192, 6656, 268800, 8388608, 0, 32768, 4, 21078016, 131072, 0, 0, 218104417, 0
    .long 4, 24, 24, 8192, 6912, 269056, 8388608, 0, 32768, 4, 21082112, 131072, 0, 0, 218104417, 0
    .long 4, 24, 24, 8192, 7168, 269312, 8388608, 0, 32768, 4, 21086208, 131072, 0, 0, 218104433, 0
    .long 4, 24, 24, 8192, 7424, 269568, 8388608, 0, 32768, 4, 21090304, 131072, 0, 0, 218104433, 0
    .long 4, 24, 24, 8192, 7680, 269824, 8388608, 0, 32768, 4, 21094400, 131072, 0, 0, 218104433, 0
    .long 4, 24, 24, 8192, 7936, 270080, 8388608, 0, 32768, 4, 21098496, 131072, 0, 0, 218104433, 0
    .long 4, 32, 32, 8192, 6144, 268288, 8388608, 0, 32768, 4, 37847040, 131072, 0, 0, 218104417, 0
    .long 4, 32, 32, 8192, 6400, 268544, 8388608, 0, 32768, 4, 37851136, 131072, 0, 0, 218104417, 0
    .long 4, 32, 32, 8192, 6656, 268800, 8388608, 0, 32768, 4, 37855232, 131072, 0, 0, 218104417, 0
    .long 4, 32, 32, 8192, 6912, 269056, 8388608, 0, 32768, 4, 37859328, 131072, 0, 0, 218104417, 0
    .long 4, 32, 32, 8192, 7168, 269312, 8388608, 0, 32768, 4, 37863424, 131072, 0, 0, 218104433, 0
    .long 4, 32, 32, 8192, 7424, 269568, 8388608, 0, 32768, 4, 37867520, 131072, 0, 0, 218104433, 0
    .long 4, 32, 32, 8192, 7680, 269824, 8388608, 0, 32768, 4, 37871616, 131072, 0, 0, 218104433, 0
    .long 4, 32, 32, 8192, 7936, 270080, 8388608, 0, 32768, 4, 37875712, 131072, 0, 0, 218104433, 0
    .long 4, 24, 24, 8192, 6144, 268288, 8388608, 262144, 32768, 4, 22118400, 131072, 0, 0, 218104420, 0
    .long 4, 24, 24, 8192, 6400, 268544, 8388608, 262144, 32768, 4, 22122496, 131072, 0, 0, 218104420, 0
    .long 4, 24, 24, 8192, 6656, 268800, 8388608, 262144, 32768, 4, 22126592, 131072, 0, 0, 218104420, 0
    .long 4, 24, 24, 8192, 6912, 269056, 8388608, 262144, 32768, 4, 22130688, 131072, 0, 0, 218104420, 0
    .long 4, 24, 24, 8192, 7168, 269312, 8388608, 262144, 32768, 4, 22134784, 131072, 0, 0, 218104436, 0
    .long 4, 24, 24, 8192, 7424, 269568, 8388608, 262144, 32768, 4, 22138880, 131072, 0, 0, 218104436, 0
    .long 4, 24, 24, 8192, 7680, 269824, 8388608, 262144, 32768, 4, 22142976, 131072, 0, 0, 218104436, 0
    .long 4, 24, 24, 8192, 7936, 270080, 8388608, 262144, 32768, 4, 22147072, 131072, 0, 0, 218104436, 0
    .long 4, 32, 32, 8192, 6144, 268288, 8388608, 262144, 32768, 4, 38895616, 131072, 0, 0, 218104420, 0
    .long 4, 32, 32, 8192, 6400, 268544, 8388608, 262144, 32768, 4, 38899712, 131072, 0, 0, 218104420, 0
    .long 4, 32, 32, 8192, 6656, 268800, 8388608, 262144, 32768, 4, 38903808, 131072, 0, 0, 218104420, 0
    .long 4, 32, 32, 8192, 6912, 269056, 8388608, 262144, 32768, 4, 38907904, 131072, 0, 0, 218104420, 0
    .long 4, 32, 32, 8192, 7168, 269312, 8388608, 262144, 32768, 4, 38912000, 131072, 0, 0, 218104436, 0
    .long 4, 32, 32, 8192, 7424, 269568, 8388608, 262144, 32768, 4, 38916096, 131072, 0, 0, 218104436, 0
    .long 4, 32, 32, 8192, 7680, 269824, 8388608, 262144, 32768, 4, 38920192, 131072, 0, 0, 218104436, 0
    .long 4, 32, 32, 8192, 7936, 270080, 8388608, 262144, 32768, 4, 38924288, 131072, 0, 0, 218104436, 0
    .long 4, 32, 32, 8192, 6400, 268544, 8388608, 786432, 32768, 4, 40996864, 131072, 0, 0, 218104676, 0
    .long 4, 24, 24, 8192, 6656, 268800, 8388608, 786432, 32768, 4, 24223744, 131072, 0, 0, 218104676, 0
    .long 4, 24, 24, 8192, 7680, 269824, 8388608, 786432, 32768, 4, 24240128, 131072, 0, 0, 218104692, 0
    .long 4, 32, 32, 8192, 6912, 269056, 8388608, 524288, 32768, 4, 39956480, 131072, 0, 0, 218104673, 0
    .long 4, 32, 32, 8192, 7680, 269824, 8388608, 786432, 32768, 4, 41017344, 131072, 0, 0, 218104692, 0
    .long 4, 32, 32, 8192, 7424, 269568, 8388608, 524288, 32768, 4, 39964672, 131072, 0, 0, 218104689, 0
    .long 4, 24, 24, 8192, 7168, 269312, 8388608, 786432, 32768, 4, 24231936, 131072, 0, 0, 218104692, 0
    .long 4, 32, 32, 8192, 7936, 270080, 8388608, 524288, 32768, 4, 39972864, 131072, 0, 0, 218104689, 0
    .long 4, 32, 32, 8192, 6656, 268800, 8388608, 786432, 32768, 4, 41000960, 131072, 0, 0, 218104676, 0
    .long 4, 32, 32, 8192, 6656, 268800, 8388608, 524288, 32768, 4, 39952384, 131072, 0, 0, 218104673, 0
    .long 4, 32, 32, 8192, 7168, 269312, 8388608, 786432, 32768, 4, 41009152, 131072, 0, 0, 218104692, 0
    .long 4, 24, 24, 8192, 6912, 269056, 8388608, 524288, 32768, 4, 23179264, 131072, 0, 0, 218104673, 0
    .long 2, 64, 72, 7168, 5376, 5376, 7340032, 1048576, 32768, 8, 58281984, 114688, 0, 0, 218103953, 0
    .long 4, 24, 24, 8192, 6400, 268544, 8388608, 786432, 32768, 4, 24219648, 131072, 0, 0, 218104676, 0
    .long 4, 24, 24, 8192, 7424, 269568, 8388608, 524288, 32768, 4, 23187456, 131072, 0, 0, 218104689, 0
    .long 4, 32, 32, 8192, 6400, 268544, 8388608, 524288, 32768, 4, 39948288, 131072, 0, 0, 218104673, 0
    .long 4, 32, 32, 8192, 7936, 270080, 8388608, 786432, 32768, 4, 41021440, 131072, 0, 0, 218104692, 0
    .long 4, 24, 24, 8192, 6144, 268288, 8388608, 524288, 32768, 4, 23166976, 131072, 0, 0, 218104673, 0
    .long 4, 24, 24, 8192, 7680, 269824, 8388608, 524288, 32768, 4, 23191552, 131072, 0, 0, 218104689, 0
    .long 4, 32, 32, 8192, 6144, 268288, 8388608, 524288, 32768, 4, 39944192, 131072, 0, 0, 218104673, 0
    .long 4, 24, 24, 8192, 7936, 270080, 8388608, 524288, 32768, 4, 23195648, 131072, 0, 0, 218104689, 0
    .long 4, 32, 32, 8192, 6144, 268288, 8388608, 786432, 32768, 4, 40992768, 131072, 0, 0, 218104676, 0
    .long 4, 24, 24, 8192, 6912, 269056, 8388608, 786432, 32768, 4, 24227840, 131072, 0, 0, 218104676, 0
    .long 4, 32, 32, 8192, 6912, 269056, 8388608, 786432, 32768, 4, 41005056, 131072, 0, 0, 218104676, 0
    .long 4, 32, 32, 8192, 7680, 269824, 8388608, 524288, 32768, 4, 39968768, 131072, 0, 0, 218104689, 0
    .long 4, 24, 24, 8192, 7168, 269312, 8388608, 524288, 32768, 4, 23183360, 131072, 0, 0, 218104689, 0
    .long 4, 32, 32, 8192, 7424, 269568, 8388608, 786432, 32768, 4, 41013248, 131072, 0, 0, 218104692, 0
    .long 4, 24, 24, 8192, 6400, 268544, 8388608, 524288, 32768, 4, 23171072, 131072, 0, 0, 218104673, 0
    .long 4, 32, 32, 8192, 7168, 269312, 8388608, 524288, 32768, 4, 39960576, 131072, 0, 0, 218104689, 0
    .long 4, 24, 24, 8192, 6656, 268800, 8388608, 524288, 32768, 4, 23175168, 131072, 0, 0, 218104673, 0
    .long 4, 24, 24, 8192, 7424, 269568, 8388608, 786432, 32768, 4, 24236032, 131072, 0, 0, 218104692, 0
    .long 4, 24, 24, 8192, 6144, 268288, 8388608, 786432, 32768, 4, 24215552, 131072, 0, 0, 218104676, 0
    .long 1, 32, 32, 8192, 7168, 7424, 8388608, 1048576, 32768, 8, 42057728, 131072, 0, 0, 218104954, 0
    .long 1, 24, 24, 8192, 6656, 6912, 8388608, 1048576, 32768, 8, 25272320, 131072, 0, 0, 218104938, 0
    .long 1, 16, 16, 8192, 6656, 6912, 8388608, 1048576, 32768, 8, 8495104, 131072, 0, 0, 218104938, 0
    .long 1, 24, 24, 8192, 7168, 7424, 8388608, 1048576, 32768, 8, 25280512, 131072, 0, 0, 218104954, 0
    .long 4, 24, 24, 8192, 7936, 270080, 8388608, 786432, 32768, 4, 24244224, 131072, 0, 0, 218104692, 0
    .long 1, 16, 16, 8192, 6144, 6400, 8388608, 1048576, 32768, 8, 8486912, 131072, 0, 0, 218104938, 0
    .long 1, 24, 24, 8192, 6656, 6912, 8388608, 1572864, 32768, 8, 27369472, 131072, 0, 0, 218105194, 0
    .long 1, 32, 32, 8192, 7168, 7424, 8388608, 1572864, 32768, 8, 44154880, 131072, 0, 0, 218105210, 0
    .long 1, 24, 24, 8192, 6144, 6400, 8388608, 1048576, 32768, 8, 25264128, 131072, 0, 0, 218104938, 0
    .long 1, 32, 32, 8192, 6656, 6912, 8388608, 1048576, 32768, 8, 42049536, 131072, 0, 0, 218104938, 0
    .long 1, 16, 16, 8192, 7680, 7936, 8388608, 1572864, 32768, 8, 10608640, 131072, 0, 0, 218105210, 0
    .long 1, 16, 16, 8192, 6144, 6400, 8388608, 0, 32768, 8, 4292608, 131072, 0, 0, 218108010, 0
    .long 1, 24, 24, 8192, 7168, 7424, 8388608, 1572864, 32768, 8, 27377664, 131072, 0, 0, 218105210, 0
    .long 1, 32, 32, 8192, 7680, 7936, 8388608, 1572864, 32768, 8, 44163072, 131072, 0, 0, 218105210, 0
    .long 1, 32, 32, 8192, 6144, 6400, 8388608, 1048576, 32768, 8, 42041344, 131072, 0, 0, 218104938, 0
    .long 1, 16, 16, 8192, 7168, 7424, 8388608, 1572864, 32768, 8, 10600448, 131072, 0, 0, 218105210, 0
    .long 1, 32, 32, 8192, 7680, 7936, 8388608, 1048576, 32768, 8, 42065920, 131072, 0, 0, 218104954, 0
    .long 1, 24, 24, 8192, 7680, 7936, 8388608, 1572864, 32768, 8, 27385856, 131072, 0, 0, 218105210, 0
    .long 1, 16, 16, 8192, 7680, 7936, 8388608, 1048576, 32768, 8, 8511488, 131072, 0, 0, 218104954, 0
    .long 1, 32, 32, 8192, 6144, 6400, 8388608, 1572864, 32768, 8, 44138496, 131072, 0, 0, 218105194, 0
    .long 1, 16, 16, 8192, 7680, 7936, 8388608, 0, 32768, 8, 4317184, 131072, 0, 0, 218108026, 0
    .long 1, 16, 16, 8192, 6656, 6912, 8388608, 2097152, 32768, 8, 12689408, 131072, 0, 0, 218105450, 0
    .long 1, 16, 16, 8192, 7168, 7424, 8388608, 1048576, 32768, 8, 8503296, 131072, 0, 0, 218104954, 0
    .long 1, 16, 16, 8192, 6144, 6400, 8388608, 1572864, 32768, 8, 10584064, 131072, 0, 0, 218105194, 0
    .long 1, 32, 32, 8192, 6144, 6400, 8388608, 2097152, 32768, 8, 46235648, 131072, 0, 0, 218105450, 0
    .long 1, 16, 16, 8192, 6656, 6912, 8388608, 0, 32768, 8, 4300800, 131072, 0, 0, 218108010, 0
    .long 1, 24, 24, 8192, 7680, 7936, 8388608, 1048576, 32768, 8, 25288704, 131072, 0, 0, 218104954, 0
    .long 1, 16, 16, 8192, 6656, 6912, 8388608, 1572864, 32768, 8, 10592256, 131072, 0, 0, 218105194, 0
    .long 1, 16, 16, 8192, 7168, 7424, 8388608, 0, 32768, 8, 4308992, 131072, 0, 0, 218108026, 0
    .long 1, 32, 32, 8192, 6656, 6912, 8388608, 2097152, 32768, 8, 46243840, 131072, 0, 0, 218105450, 0
    .long 1, 32, 32, 8192, 6656, 6912, 8388608, 1572864, 32768, 8, 44146688, 131072, 0, 0, 218105194, 0
    .long 1, 24, 24, 8192, 6144, 6400, 8388608, 1572864, 32768, 8, 27361280, 131072, 0, 0, 218105194, 0
    .long 1, 16, 16, 8192, 6144, 6400, 8388608, 524288, 32768, 8, 6389760, 131072, 0, 0, 218108266, 0
    .long 1, 32, 32, 8192, 7168, 7424, 8388608, 3670016, 32768, 8, 52543488, 131072, 0, 0, 218106234, 0
    .long 1, 16, 16, 8192, 7168, 7424, 8388608, 2621440, 32768, 8, 14794752, 131072, 0, 0, 218105722, 0
    .long 1, 24, 24, 8192, 6656, 6912, 8388608, 3145728, 32768, 8, 33660928, 131072, 0, 0, 218105962, 0
    .long 1, 16, 16, 8192, 6144, 6400, 8388608, 2621440, 32768, 8, 14778368, 131072, 0, 0, 218105706, 0
    .long 1, 32, 32, 8192, 7680, 7936, 8388608, 3670016, 32768, 8, 52551680, 131072, 0, 0, 218106234, 0
    .long 1, 16, 16, 8192, 6144, 6400, 8388608, 3145728, 32768, 8, 16875520, 131072, 0, 0, 218105962, 0
    .long 1, 24, 24, 8192, 7168, 7424, 8388608, 2097152, 32768, 8, 29474816, 131072, 0, 0, 218105466, 0
    .long 1, 16, 16, 8192, 7680, 7936, 8388608, 2097152, 32768, 8, 12705792, 131072, 0, 0, 218105466, 0
    .long 1, 24, 24, 8192, 6656, 6912, 8388608, 3670016, 32768, 8, 35758080, 131072, 0, 0, 218106218, 0
    .long 1, 24, 24, 8192, 7680, 7936, 8388608, 3145728, 32768, 8, 33677312, 131072, 0, 0, 218105978, 0
    .long 1, 32, 32, 8192, 7680, 7936, 8388608, 2621440, 32768, 8, 48357376, 131072, 0, 0, 218105722, 0
    .long 1, 32, 32, 8192, 7680, 7936, 8388608, 2097152, 32768, 8, 46260224, 131072, 0, 0, 218105466, 0
    .long 1, 24, 24, 8192, 7680, 7936, 8388608, 2097152, 32768, 8, 29483008, 131072, 0, 0, 218105466, 0
    .long 1, 24, 24, 8192, 6144, 6400, 8388608, 2097152, 32768, 8, 29458432, 131072, 0, 0, 218105450, 0
    .long 1, 32, 32, 8192, 7680, 7936, 8388608, 3145728, 32768, 8, 50454528, 131072, 0, 0, 218105978, 0
    .long 1, 32, 32, 8192, 6144, 6400, 8388608, 3145728, 32768, 8, 50429952, 131072, 0, 0, 218105962, 0
    .long 1, 16, 16, 8192, 7168, 7424, 8388608, 3145728, 32768, 8, 16891904, 131072, 0, 0, 218105978, 0
    .long 1, 16, 16, 8192, 7168, 7424, 8388608, 2097152, 32768, 8, 12697600, 131072, 0, 0, 218105466, 0
    .long 5, 218108016, 0, 0, 28, 0, 0, 0, 0, 0, 0, 0, 218112384, 4, 218106897, 0
    .long 1, 32, 32, 8192, 7168, 7424, 8388608, 3145728, 32768, 8, 50446336, 131072, 0, 0, 218105978, 0
    .long 1, 24, 24, 8192, 7680, 7936, 8388608, 3670016, 32768, 8, 35774464, 131072, 0, 0, 218106234, 0
    .long 1, 32, 32, 8192, 6144, 6400, 8388608, 2621440, 32768, 8, 48332800, 131072, 0, 0, 218105706, 0
    .long 1, 32, 32, 8192, 7168, 7424, 8388608, 2097152, 32768, 8, 46252032, 131072, 0, 0, 218105466, 0
    .long 1, 24, 24, 8192, 6656, 6912, 8388608, 2621440, 32768, 8, 31563776, 131072, 0, 0, 218105706, 0
    .long 1, 24, 24, 8192, 6656, 6912, 8388608, 2097152, 32768, 8, 29466624, 131072, 0, 0, 218105450, 0
    .long 1, 16, 16, 8192, 7680, 7936, 8388608, 524288, 32768, 8, 6414336, 131072, 0, 0, 218108282, 0
    .long 1, 32, 32, 8192, 7168, 7424, 8388608, 2621440, 32768, 8, 48349184, 131072, 0, 0, 218105722, 0
    .long 1, 16, 16, 8192, 7168, 7424, 8388608, 524288, 32768, 8, 6406144, 131072, 0, 0, 218108282, 0
    .long 1, 24, 24, 8192, 6144, 6400, 8388608, 2621440, 32768, 8, 31555584, 131072, 0, 0, 218105706, 0
    .long 1, 16, 16, 8192, 6144, 6400, 8388608, 2097152, 32768, 8, 12681216, 131072, 0, 0, 218105450, 0
    .long 5, 218108016, 0, 0, 28, 0, 0, 4, 0, 0, 0, 0, 218112384, 8, 218106897, 0
    .long 5, 218108000, 0, 0, 24, 0, 0, 0, 0, 0, 0, 0, 218112384, 4, 218106897, 0
    .long 1, 24, 24, 8192, 7168, 7424, 8388608, 3670016, 32768, 8, 35766272, 131072, 0, 0, 218106234, 0
    .long 2, 64, 72, 7168, 5376, 5376, 7340032, 2097152, 32768, 8, 61952000, 114688, 0, 0, 218104081, 0
    .long 1, 24, 24, 8192, 7680, 7936, 8388608, 2621440, 32768, 8, 31580160, 131072, 0, 0, 218105722, 0
    .long 2, 64, 72, 7168, 5632, 5632, 7340032, 0, 32768, 8, 54616064, 114688, 0, 0, 218103825, 0
    .long 1, 24, 24, 8192, 6144, 6400, 8388608, 3670016, 32768, 8, 35749888, 131072, 0, 0, 218106218, 0
    .long 1, 32, 32, 8192, 6656, 6912, 8388608, 3670016, 32768, 8, 52535296, 131072, 0, 0, 218106218, 0
    .long 2, 64, 72, 7168, 6400, 6400, 7340032, 2621440, 32768, 8, 63803392, 114688, 0, 0, 218104148, 0
    .long 1, 32, 32, 8192, 6656, 6912, 8388608, 2621440, 32768, 8, 48340992, 131072, 0, 0, 218105706, 0
    .long 1, 16, 16, 8192, 6656, 6912, 8388608, 2621440, 32768, 8, 14786560, 131072, 0, 0, 218105706, 0
    .long 2, 64, 72, 7168, 5376, 5376, 7340032, 0, 32768, 8, 54611968, 114688, 0, 0, 218103825, 0
    .long 1, 16, 16, 8192, 7680, 7936, 8388608, 3145728, 32768, 8, 16900096, 131072, 0, 0, 218105978, 0
    .long 1, 24, 24, 8192, 7168, 7424, 8388608, 2621440, 32768, 8, 31571968, 131072, 0, 0, 218105722, 0
    .long 2, 64, 72, 7168, 5632, 5632, 7340032, 524288, 32768, 8, 56451072, 114688, 0, 0, 218103889, 0
    .long 1, 24, 24, 8192, 6144, 6400, 8388608, 3145728, 32768, 8, 33652736, 131072, 0, 0, 218105962, 0
    .long 2, 64, 72, 7168, 6144, 6144, 7340032, 0, 32768, 8, 54624256, 114688, 0, 0, 218103825, 0
    .long 2, 64, 72, 7168, 6144, 6144, 7340032, 524288, 32768, 8, 56459264, 114688, 0, 0, 218103889, 0
    .long 2, 64, 72, 7168, 5888, 5888, 7340032, 2097152, 32768, 8, 61960192, 114688, 0, 0, 218104081, 0
    .long 2, 64, 72, 7168, 6400, 6400, 7340032, 2097152, 32768, 8, 61968384, 114688, 0, 0, 218104081, 0
    .long 1, 16, 16, 8192, 6656, 6912, 8388608, 524288, 32768, 8, 6397952, 131072, 0, 0, 218108266, 0
    .long 1, 16, 16, 8192, 6656, 6912, 8388608, 3145728, 32768, 8, 16883712, 131072, 0, 0, 218105962, 0
    .long 2, 64, 72, 7168, 6400, 6400, 7340032, 0, 32768, 8, 54628352, 114688, 0, 0, 218103825, 0
    .long 2, 64, 72, 7168, 6656, 6656, 7340032, 0, 32768, 8, 54632448, 114688, 0, 0, 218103825, 0
    .long 1, 16, 16, 8192, 7680, 7936, 8388608, 2621440, 32768, 8, 14802944, 131072, 0, 0, 218105722, 0
    .long 1, 24, 24, 8192, 7168, 7424, 8388608, 3145728, 32768, 8, 33669120, 131072, 0, 0, 218105978, 0
    .long 2, 64, 72, 7168, 6656, 6656, 7340032, 3145728, 32768, 8, 65642496, 114688, 0, 0, 218104212, 0
    .long 1, 32, 32, 8192, 6656, 6912, 8388608, 3145728, 32768, 8, 50438144, 131072, 0, 0, 218105962, 0
    .long 1, 16, 16, 8192, 7680, 7936, 8388608, 3670016, 32768, 8, 18997248, 131072, 0, 0, 218106234, 0
    .long 2, 64, 72, 7168, 6912, 6912, 7340032, 0, 32768, 8, 54636544, 114688, 0, 0, 218103825, 0
    .long 2, 64, 72, 7168, 5888, 5888, 7340032, 0, 32768, 8, 54620160, 114688, 0, 0, 218103825, 0
    .long 5, 218108000, 0, 0, 24, 0, 0, 4, 0, 0, 0, 0, 218112384, 8, 218106897, 0
    .long 2, 64, 72, 7168, 6912, 6912, 7340032, 3145728, 32768, 8, 65646592, 114688, 0, 0, 218104212, 0
    .long 2, 64, 72, 7168, 5376, 5376, 7340032, 524288, 32768, 8, 56446976, 114688, 0, 0, 218103889, 0
    .long 2, 64, 72, 7168, 6656, 6656, 7340032, 1572864, 32768, 8, 60137472, 114688, 0, 0, 218104017, 0
    .long 2, 64, 72, 7168, 6912, 6912, 7340032, 524288, 32768, 8, 56471552, 114688, 0, 0, 218103889, 0
    .long 1, 16, 16, 8192, 6144, 6400, 8388608, 3670016, 32768, 8, 18972672, 131072, 0, 0, 218106218, 0
    .long 5, 218108272, 0, 0, 28, 0, 0, 8, 0, 0, 0, 0, 218112384, 12, 218106961, 0
    .long 2, 64, 72, 7168, 5376, 5376, 7340032, 3145728, 32768, 8, 65622016, 114688, 0, 0, 218104212, 0
    .long 2, 64, 72, 7168, 5888, 5888, 7340032, 1572864, 32768, 8, 60125184, 114688, 0, 0, 218104017, 0
    .long 2, 64, 72, 7168, 6144, 6144, 7340032, 2097152, 32768, 8, 61964288, 114688, 0, 0, 218104081, 0
    .long 2, 64, 72, 7168, 5376, 5376, 7340032, 1572864, 32768, 8, 60116992, 114688, 0, 0, 218104017, 0
    .long 2, 64, 72, 7168, 6144, 6144, 7340032, 1572864, 32768, 8, 60129280, 114688, 0, 0, 218104017, 0
    .long 2, 64, 72, 7168, 6912, 6912, 7340032, 1572864, 32768, 8, 60141568, 114688, 0, 0, 218104017, 0
    .long 2, 64, 72, 7168, 5632, 5632, 7340032, 1572864, 32768, 8, 60121088, 114688, 0, 0, 218104017, 0
    .long 2, 64, 72, 7168, 5632, 5632, 7340032, 2097152, 32768, 8, 61956096, 114688, 0, 0, 218104081, 0
    .long 2, 64, 72, 7168, 6656, 6656, 7340032, 2097152, 32768, 8, 61972480, 114688, 0, 0, 218104081, 0
    .long 2, 64, 72, 7168, 5888, 5888, 7340032, 524288, 32768, 8, 56455168, 114688, 0, 0, 218103889, 0
    .long 2, 64, 72, 7168, 6912, 6912, 7340032, 2097152, 32768, 8, 61976576, 114688, 0, 0, 218104081, 0
    .long 2, 64, 72, 7168, 6400, 6400, 7340032, 1572864, 32768, 8, 60133376, 114688, 0, 0, 218104017, 0
    .long 2, 64, 72, 7168, 5632, 5632, 7340032, 1048576, 32768, 8, 58286080, 114688, 0, 0, 218103953, 0
    .long 2, 64, 72, 7168, 6400, 6400, 7340032, 1048576, 32768, 8, 58298368, 114688, 0, 0, 218103953, 0
    .long 2, 64, 72, 7168, 5888, 5888, 7340032, 3145728, 32768, 8, 65630208, 114688, 0, 0, 218104212, 0
    .long 2, 64, 72, 7168, 6656, 6656, 7340032, 1048576, 32768, 8, 58302464, 114688, 0, 0, 218103953, 0
    .long 5, 218108272, 0, 0, 28, 0, 0, 12, 0, 0, 0, 0, 218112384, 16, 218106961, 0
    .long 2, 64, 72, 7168, 6912, 6912, 7340032, 1048576, 32768, 8, 58306560, 114688, 0, 0, 218103953, 0
    .long 2, 64, 72, 7168, 6400, 6400, 7340032, 3145728, 32768, 8, 65638400, 114688, 0, 0, 218104212, 0
    .long 2, 64, 72, 7168, 6656, 6656, 7340032, 524288, 32768, 8, 56467456, 114688, 0, 0, 218103889, 0
    .long 2, 64, 72, 7168, 6144, 6144, 7340032, 1048576, 32768, 8, 58294272, 114688, 0, 0, 218103953, 0
    .long 2, 64, 72, 7168, 5888, 5888, 7340032, 1048576, 32768, 8, 58290176, 114688, 0, 0, 218103953, 0
    .long 2, 64, 72, 7168, 5632, 5632, 7340032, 3145728, 32768, 8, 65626112, 114688, 0, 0, 218104212, 0
    .long 5, 218108256, 0, 0, 24, 0, 0, 12, 0, 0, 0, 0, 218112384, 16, 218106961, 0
    .long 2, 64, 72, 7168, 6144, 6144, 7340032, 3670016, 32768, 8, 67469312, 114688, 0, 0, 218104276, 0
    .long 2, 64, 72, 7168, 6400, 6400, 7340032, 524288, 32768, 8, 56463360, 114688, 0, 0, 218103889, 0
    .long 1, 80, 80, 2048, 3671552, 3671808, 7340032, 54583296, 114688, 14, 121659392, 32768, 218103824, 14, 218106370, 0
    .long 1, 40, 40, 2048, 4195328, 4195584, 8388608, 176226304, 131072, 16, 79708160, 32768, 218106896, 8, 218106376, 0
    .long 5, 218108256, 0, 0, 24, 0, 0, 8, 0, 0, 0, 0, 218112384, 12, 218106961, 0
    .long 1, 32, 32, 8192, 6144, 6400, 8388608, 3670016, 32768, 8, 52527104, 131072, 0, 0, 218106218, 0
    .long 1, 16, 16, 8192, 6656, 6912, 8388608, 3670016, 32768, 8, 18980864, 131072, 0, 0, 218106218, 0
    .long 1, 16, 16, 8192, 7168, 7424, 8388608, 3670016, 32768, 8, 18989056, 131072, 0, 0, 218106234, 0
    .long 1, 40, 40, 2048, 4195840, 4196096, 8388608, 182517760, 131072, 16, 81289216, 32768, 218112384, 33, 218106568, 0
    .long 1, 40, 40, 2048, 4195840, 4196096, 8388608, 176226304, 131072, 16, 79716352, 32768, 218106896, 8, 218106376, 0
    .long 2, 64, 72, 7168, 6144, 6144, 7340032, 3145728, 32768, 8, 65634304, 114688, 0, 0, 218104212, 0
    .long 1, 40, 40, 2048, 4195328, 4195584, 8388608, 180420608, 131072, 16, 80756736, 32768, 218112384, 25, 218106504, 0
    .long 1, 40, 40, 2048, 4195840, 4196096, 8388608, 180420608, 131072, 16, 80764928, 32768, 218112384, 25, 218106504, 0
    .long 2, 64, 72, 7168, 6656, 6656, 7340032, 2621440, 32768, 8, 63807488, 114688, 0, 0, 218104148, 0
    .long 1, 40, 40, 2048, 4195328, 4195584, 8388608, 182517760, 131072, 16, 81281024, 32768, 218112384, 33, 218106568, 0
    .long 2, 64, 72, 7168, 5376, 5376, 7340032, 2621440, 32768, 8, 63787008, 114688, 0, 0, 218104148, 0
    .long 1, 80, 80, 2048, 3671040, 3671296, 7340032, 54583296, 114688, 14, 121651200, 32768, 218103824, 14, 218106370, 0
    .long 2, 64, 72, 7168, 6912, 6912, 7340032, 2621440, 32768, 8, 63811584, 114688, 0, 0, 218104148, 0
    .long 2, 64, 72, 7168, 5632, 5632, 7340032, 2621440, 32768, 8, 63791104, 114688, 0, 0, 218104148, 0
    .long 2, 64, 72, 7168, 5888, 5888, 7340032, 3670016, 32768, 8, 67465216, 114688, 0, 0, 218104276, 0
    .long 2, 64, 72, 7168, 6656, 6656, 7340032, 3670016, 32768, 8, 67477504, 114688, 0, 0, 218104276, 0
    .long 1, 40, 40, 2048, 4195328, 4195584, 8388608, 178323456, 131072, 16, 80232448, 32768, 218106960, 8, 218106440, 0
    .long 1, 40, 40, 2048, 4195840, 4196096, 8388608, 178323456, 131072, 16, 80240640, 32768, 218106960, 8, 218106440, 0
    .long 2, 64, 72, 7168, 6144, 6144, 7340032, 2621440, 32768, 8, 63799296, 114688, 0, 0, 218104148, 0
    .long 2, 64, 72, 7168, 5376, 5376, 7340032, 3670016, 32768, 8, 67457024, 114688, 0, 0, 218104276, 0
    .long 2, 64, 72, 7168, 5888, 5888, 7340032, 2621440, 32768, 8, 63795200, 114688, 0, 0, 218104148, 0
    .long 1, 80, 80, 2048, 3671552, 3671808, 7340032, 61923328, 114688, 14, 123756544, 32768, 218104080, 14, 218106626, 0
    .long 1, 80, 80, 2048, 3671040, 3671296, 7340032, 60088320, 114688, 14, 123224064, 32768, 218104016, 14, 218106562, 0
    .long 1, 80, 80, 2048, 3671040, 3671296, 7340032, 61923328, 114688, 14, 123748352, 32768, 218104080, 14, 218106626, 0
    .long 1, 80, 80, 2048, 3671552, 3671808, 7340032, 60088320, 114688, 14, 123232256, 32768, 218104016, 14, 218106562, 0
    .long 2, 64, 72, 7168, 6400, 6400, 7340032, 3670016, 32768, 8, 67473408, 114688, 0, 0, 218104276, 0
    .long 2, 64, 72, 7168, 5632, 5632, 7340032, 3670016, 32768, 8, 67461120, 114688, 0, 0, 218104276, 0
    .long 1, 80, 80, 2048, 3671040, 3671296, 7340032, 58253312, 114688, 14, 122699776, 32768, 218103952, 14, 218106498, 0
    .long 1, 80, 80, 2048, 3671552, 3671808, 7340032, 58253312, 114688, 14, 122707968, 32768, 218103952, 14, 218106498, 0
    .long 2, 64, 72, 7168, 6912, 6912, 7340032, 3670016, 32768, 8, 67481600, 114688, 0, 0, 218104276, 0
    .long 1, 80, 80, 2048, 3671552, 3671808, 7340032, 56418304, 114688, 14, 122183680, 32768, 218103888, 14, 218106434, 0
    .long 1, 80, 80, 2048, 3671040, 3671296, 7340032, 56418304, 114688, 14, 122175488, 32768, 218103888, 14, 218106434, 0
    .long 1, 40, 40, 2048, 6291968, 6292224, 8388608, 184647680, 131072, 8, 90185728, 32768, 218112384, 41, 218106628, 0
    .long 1, 80, 80, 2048, 5505024, 5505280, 7340032, 65622016, 114688, 7, 133169152, 32768, 218104212, 7, 218106753, 0
    .long 1, 80, 80, 2048, 5505536, 5505792, 7340032, 65622016, 114688, 7, 133177344, 32768, 218104212, 7, 218106753, 0
    .long 1, 40, 40, 2048, 6291456, 6291712, 8388608, 184647680, 131072, 8, 90177536, 32768, 218112384, 41, 218106628, 0
    .long 1, 80, 80, 2048, 5506560, 5506816, 7340032, 65622016, 114688, 7, 133193728, 32768, 218104212, 7, 218106753, 0
    .long 1, 40, 40, 2048, 6292480, 6292736, 8388608, 184647680, 131072, 8, 90193920, 32768, 218112384, 41, 218106628, 0
    .long 1, 40, 40, 2048, 6292992, 6293248, 8388608, 184647680, 131072, 8, 90202112, 32768, 218112384, 41, 218106628, 0
    .long 1, 40, 40, 2048, 6291968, 6292224, 8388608, 186744832, 131072, 8, 90710016, 32768, 218112384, 49, 218106692, 0
    .long 1, 80, 80, 2048, 5506048, 5506304, 7340032, 65622016, 114688, 7, 133185536, 32768, 218104212, 7, 218106753, 0
    .long 1, 40, 40, 2048, 6292480, 6292736, 8388608, 186744832, 131072, 8, 90718208, 32768, 218112384, 49, 218106692, 0
    .long 1, 40, 40, 2048, 6291456, 6291712, 8388608, 186744832, 131072, 8, 90701824, 32768, 218112384, 49, 218106692, 0
    .long 1, 40, 40, 2048, 6292992, 6293248, 8388608, 186744832, 131072, 8, 90726400, 32768, 218112384, 49, 218106692, 0
    .long 1, 80, 80, 2048, 5506048, 5506304, 7340032, 63787008, 114688, 7, 132661248, 32768, 218104148, 7, 218106689, 0
    .long 1, 80, 80, 2048, 5506560, 5506816, 7340032, 63787008, 114688, 7, 132669440, 32768, 218104148, 7, 218106689, 0
    .long 1, 80, 80, 2048, 5505024, 5505280, 7340032, 63787008, 114688, 7, 132644864, 32768, 218104148, 7, 218106689, 0
    .long 1, 80, 80, 2048, 5505536, 5505792, 7340032, 63787008, 114688, 7, 132653056, 32768, 218104148, 7, 218106689, 0
    .long 1, 80, 80, 2048, 5505536, 5505792, 7340032, 67457024, 114688, 7, 133701632, 32768, 218104276, 7, 218106817, 0
    .long 1, 80, 80, 2048, 5506048, 5506304, 7340032, 67457024, 114688, 7, 133709824, 32768, 218104276, 7, 218106817, 0
    .long 1, 80, 80, 2048, 5506560, 5506816, 7340032, 67457024, 114688, 7, 133718016, 32768, 218104276, 7, 218106817, 0
    .long 1, 80, 80, 2048, 5505024, 5505280, 7340032, 67457024, 114688, 7, 133693440, 32768, 218104276, 7, 218106817, 0
    .long 6, 1, 3, 2, 3, 16, 0, 3, 0, 0, 0, 0, 0, 0, 0, 0
    .long 6, 0, 51, 0, 3, 0, 0, 51, 0, 0, 0, 0, 0, 0, 0, 0
    .long 6, 1, 1, 2, 3, 16, 0, 1, 0, 0, 0, 0, 0, 0, 0, 0
    .long 6, 1, 0, 2, 3, 16, 0, 0, 0, 0, 0, 0, 0, 0, 0, 0
    .long 6, 1, 5, 2, 3, 16, 0, 5, 0, 0, 0, 0, 0, 0, 0, 0
    .long 6, 1, 4, 2, 3, 16, 0, 4, 0, 0, 0, 0, 0, 0, 0, 0
    .long 6, 1, 22, 2, 3, 16, 0, 22, 0, 0, 0, 0, 0, 0, 0, 0
    .long 6, 1, 6, 2, 3, 16, 0, 6, 0, 0, 0, 0, 0, 0, 0, 0
    .long 6, 1, 18, 2, 3, 16, 0, 18, 0, 0, 0, 0, 0, 0, 0, 0
    .long 6, 1, 19, 2, 3, 16, 0, 19, 0, 0, 0, 0, 0, 0, 0, 0
    .long 6, 1, 20, 2, 3, 16, 0, 20, 0, 0, 0, 0, 0, 0, 0, 0
    .long 6, 1, 7, 2, 3, 16, 0, 7, 0, 0, 0, 0, 0, 0, 0, 0
    .long 6, 1, 2, 2, 3, 16, 0, 2, 0, 0, 0, 0, 0, 0, 0, 0
    .long 6, 1, 17, 2, 3, 16, 0, 17, 0, 0, 0, 0, 0, 0, 0, 0
    .long 6, 1, 21, 2, 3, 16, 0, 21, 0, 0, 0, 0, 0, 0, 0, 0
    .long 6, 1, 16, 2, 3, 16, 0, 16, 0, 0, 0, 0, 0, 0, 0, 0
    .long 6, 0, 50, 0, 3, 0, 0, 50, 0, 0, 0, 0, 0, 0, 0, 0
    .long 6, 0, 52, 0, 3, 0, 0, 52, 0, 0, 0, 0, 0, 0, 0, 0
    .long 6, 0, 54, 0, 3, 0, 0, 54, 0, 0, 0, 0, 0, 0, 0, 0
    .long 6, 0, 49, 0, 3, 0, 0, 49, 0, 0, 0, 0, 0, 0, 0, 0
    .long 6, 0, 48, 0, 3, 0, 0, 48, 0, 0, 0, 0, 0, 0, 0, 0
    .long 6, 0, 53, 0, 3, 0, 0, 53, 0, 0, 0, 0, 0, 0, 0, 0
    .long 6, 0, 55, 0, 3, 0, 0, 55, 0, 0, 0, 0, 0, 0, 0, 0
    .long 6, 0, 56, 0, 3, 0, 0, 56, 0, 0, 0, 0, 0, 0, 0, 0
    .long 6, 1, 23, 2, 3, 16, 0, 23, 0, 0, 0, 0, 0, 0, 0, 0
    .long 6, 1, 24, 2, 3, 16, 0, 24, 0, 0, 0, 0, 0, 0, 0, 0
    .long 6, 1, 25, 2, 3, 16, 0, 25, 0, 0, 0, 0, 0, 0, 0, 0
    .long 6, 1, 26, 2, 3, 16, 0, 26, 0, 0, 0, 0, 0, 0, 0, 0
    .long 6, 1, 27, 2, 3, 16, 0, 27, 0, 0, 0, 0, 0, 0, 0, 0
    .long 6, 1, 28, 2, 3, 16, 0, 28, 0, 0, 0, 0, 0, 0, 0, 0
    .long 6, 1, 29, 2, 3, 16, 0, 29, 0, 0, 0, 0, 0, 0, 0, 0
    .long 6, 1, 30, 2, 3, 16, 0, 30, 0, 0, 0, 0, 0, 0, 0, 0
    .long 6, 1, 31, 2, 3, 16, 0, 31, 0, 0, 0, 0, 0, 0, 0, 0
    .long 6, 0, 40, 1, 3, 16, 0, 40, 0, 0, 0, 0, 0, 0, 0, 0
    .long 6, 0, 41, 1, 3, 16, 0, 41, 0, 0, 0, 0, 0, 0, 0, 0
    .long 6, 0, 43, 1, 3, 16, 0, 43, 0, 0, 0, 0, 0, 0, 0, 0
    .long 6, 0, 45, 1, 3, 16, 0, 45, 0, 0, 0, 0, 0, 0, 0, 0
    .long 6, 0, 46, 1, 3, 16, 0, 46, 0, 0, 0, 0, 0, 0, 0, 0
    .long 6, 0, 47, 1, 3, 16, 0, 47, 0, 0, 0, 0, 0, 0, 0, 0
    .long 6, 1, 32, 1, 3, 16, 0, 32, 0, 0, 0, 0, 0, 0, 0, 0
    .long 6, 1, 33, 1, 3, 16, 0, 33, 0, 0, 0, 0, 0, 0, 0, 0
    .long 6, 1, 35, 1, 3, 16, 0, 35, 0, 0, 0, 0, 0, 0, 0, 0
    .long 6, 1, 36, 1, 3, 16, 0, 36, 0, 0, 0, 0, 0, 0, 0, 0
    .long 6, 1, 38, 1, 3, 16, 0, 38, 0, 0, 0, 0, 0, 0, 0, 0
    .long 6, 1, 39, 1, 3, 16, 0, 39, 0, 0, 0, 0, 0, 0, 0, 0
    .long 6, 0, 57, 0, 3, 0, 0, 57, 0, 0, 0, 0, 0, 0, 0, 0
    .long 6, 0, 44, 1, 3, 16, 0, 44, 0, 0, 0, 0, 0, 0, 0, 0
    .long 6, 1, 34, 1, 3, 16, 0, 34, 0, 0, 0, 0, 0, 0, 0, 0
    .long 6, 0, 58, 0, 3, 0, 0, 58, 0, 0, 0, 0, 0, 0, 0, 0
    .long 6, 1, 37, 1, 3, 16, 0, 37, 0, 0, 0, 0, 0, 0, 0, 0
    .long 6, 0, 42, 1, 3, 16, 0, 42, 0, 0, 0, 0, 0, 0, 0, 0
    .long 6, 0, 59, 0, 3, 0, 0, 59, 0, 0, 0, 0, 0, 0, 0, 0
    .long 6, 1, 8, 2, 3, 16, 0, 8, 0, 0, 0, 0, 0, 0, 0, 0
    .long 6, 1, 9, 2, 3, 16, 0, 9, 0, 0, 0, 0, 0, 0, 0, 0
    .long 6, 1, 10, 2, 3, 16, 0, 10, 0, 0, 0, 0, 0, 0, 0, 0
    .long 6, 1, 11, 2, 3, 16, 0, 11, 0, 0, 0, 0, 0, 0, 0, 0
    .long 6, 1, 12, 2, 3, 16, 0, 12, 0, 0, 0, 0, 0, 0, 0, 0
    .long 6, 1, 13, 2, 3, 16, 0, 13, 0, 0, 0, 0, 0, 0, 0, 0
    .long 6, 1, 14, 2, 3, 16, 0, 14, 0, 0, 0, 0, 0, 0, 0, 0
    .long 6, 1, 15, 2, 3, 16, 0, 15, 0, 0, 0, 0, 0, 0, 0, 0
    .long 7, 0, 60, 0, 12, 0, 0, 60, 0, 0, 0, 0, 0, 0, 0, 0
    .long 7, 0, 60, 0, 13, 0, 0, 60, 0, 0, 0, 0, 0, 0, 0, 0
    .long 7, 0, 60, 0, 14, 0, 0, 60, 0, 0, 0, 0, 0, 0, 0, 0
    .long 7, 0, 60, 0, 15, 0, 0, 60, 0, 0, 0, 0, 0, 0, 0, 0
    .long 7, 0, 61, 0, 12, 0, 0, 61, 0, 0, 0, 0, 0, 0, 0, 0
    .long 7, 0, 61, 0, 13, 0, 0, 61, 0, 0, 0, 0, 0, 0, 0, 0
    .long 7, 0, 61, 0, 14, 0, 0, 61, 0, 0, 0, 0, 0, 0, 0, 0
    .long 7, 0, 61, 0, 15, 0, 0, 61, 0, 0, 0, 0, 0, 0, 0, 0
    .long 7, 0, 62, 0, 12, 0, 0, 62, 0, 0, 0, 0, 0, 0, 0, 0
    .long 7, 0, 62, 0, 13, 0, 0, 62, 0, 0, 0, 0, 0, 0, 0, 0
    .long 7, 0, 62, 0, 14, 0, 0, 62, 0, 0, 0, 0, 0, 0, 0, 0
    .long 7, 0, 62, 0, 15, 0, 0, 62, 0, 0, 0, 0, 0, 0, 0, 0
    .long 7, 0, 63, 0, 12, 0, 0, 63, 0, 0, 0, 0, 0, 0, 0, 0
    .long 7, 0, 63, 0, 13, 0, 0, 63, 0, 0, 0, 0, 0, 0, 0, 0
    .long 7, 0, 63, 0, 14, 0, 0, 63, 0, 0, 0, 0, 0, 0, 0, 0
    .long 7, 0, 63, 0, 15, 0, 0, 63, 0, 0, 0, 0, 0, 0, 0, 0
    .long 0, 0, 0, 0, 0, 0, 0, 0, 0, 0, 0, 0, 0, 0, 0, 0
.p2align 6
.amdhsa_kernel recurrent_scan__memory_aug_recurrent_mem_tr__glu_gated_glu__prompt_kernel
  .amdhsa_next_free_vgpr 256
  .amdhsa_next_free_sgpr 102
  .amdhsa_accum_offset 256
  .amdhsa_group_segment_fixed_size 0
  .amdhsa_kernarg_size 112
  .amdhsa_user_sgpr_count 2
  .amdhsa_user_sgpr_kernarg_segment_ptr 1
  .amdhsa_system_sgpr_workgroup_id_x 1
  .amdhsa_float_denorm_mode_32 3
.end_amdhsa_kernel
```

```asm
; @launch grid=(256,1,1) block=(512,1,1) lds=163840
.amdgcn_target "amdgcn-amd-amdhsa--gfx950"
.text
.globl recurrent_scan__memory_aug_recurrent_mem_tr__glu_gated_glu__prompt_kernel
.p2align 8
.type recurrent_scan__memory_aug_recurrent_mem_tr__glu_gated_glu__prompt_kernel,@function
recurrent_scan__memory_aug_recurrent_mem_tr__glu_gated_glu__prompt_kernel:
    s_cmp_ge_u32 s2, 256
    s_cbranch_scc1 k_exit
    s_mov_b32 s99, s2
    s_load_dwordx2 s[4:5], s[0:1], 104
    s_load_dwordx2 s[64:65], s[0:1], 96
    v_lshrrev_b32 v2, 6, v0
    s_mov_b32 s6, 268435456
    s_mov_b32 s7, 131072
    s_mov_b32 s66, 256
    s_mov_b32 s67, 131072
    v_readfirstlane_b32 s3, v2
    s_getreg_b32 s14, hwreg(HW_REG_XCC_ID)
    s_waitcnt lgkmcnt(0)
    s_mov_b32 s98, s2
    s_sub_u32 s97, s14, s2
    s_and_b32 s97, s97, 7
    s_or_b32 s15, s2, s3
    s_cmp_lg_u32 s15, 0
    s_cbranch_scc1 k_disp
    s_add_u32 s14, s97, 1
    v_mov_b32 v2, s14
    s_mov_b64 exec, 1
    buffer_store_dword v2, off, s[64:67], 0 offset:224 sc1
    s_mov_b64 exec, -1
    s_branch k_disp
k_restart:
    s_waitcnt vmcnt(0) lgkmcnt(0)
    s_barrier
k_disp:
    s_add_u32 s14, s97, s98
    s_and_b32 s14, s14, 7
    s_andn2_b32 s2, s98, 7
    s_or_b32 s2, s2, s14
    s_mov_b32 s99, s2
    s_lshr_b32 s13, s2, 3
    s_and_b32 s12, s2, 3
    s_waitcnt lgkmcnt(0)
    s_bitcmp0_b32 s2, 2
    s_cbranch_scc1 chain_map
    s_lshl_b32 s63, s13, 2
    s_add_u32 s63, s63, s12
    s_mov_b32 s17, s63
    s_mov_b32 s19, s3
    s_mov_b32 s18, 0
    s_cmp_ge_u32 s3, 4
    s_cbranch_scc1 ln_touch
    s_load_dwordx2 s[8:9], s[0:1], 0
    v_and_b32 v1, 63, v0
    s_mov_b32 s10, 4194304
    s_mov_b32 s11, 131072
    v_and_b32 v3, 15, v1
    v_lshrrev_b32 v4, 4, v1
    v_lshlrev_b32 v5, 11, v3
    v_lshl_add_u32 v5, v4, 4, v5
    s_lshl_b32 s12, s17, 15
    s_lshl_b32 s13, s19, 9
    s_add_u32 s12, s12, s13
    s_waitcnt lgkmcnt(0)
    buffer_load_dwordx4 v[16:19], v5, s[8:11], s12 offen offset:0
    buffer_load_dwordx4 v[20:23], v5, s[8:11], s12 offen offset:64
    buffer_load_dwordx4 v[24:27], v5, s[8:11], s12 offen offset:128
    buffer_load_dwordx4 v[28:31], v5, s[8:11], s12 offen offset:192
    buffer_load_dwordx4 v[32:35], v5, s[8:11], s12 offen offset:256
    buffer_load_dwordx4 v[36:39], v5, s[8:11], s12 offen offset:320
    buffer_load_dwordx4 v[40:43], v5, s[8:11], s12 offen offset:384
    buffer_load_dwordx4 v[44:47], v5, s[8:11], s12 offen offset:448
    v_mov_b32 v14, 0
    s_lshl_b32 s13, s63, 7
    s_add_u32 s13, s13, 218103808
    v_lshlrev_b32 v13, 2, v0
    v_lshlrev_b32 v6, 4, v3
    s_lshl_b32 s14, s18, 10
    v_add_u32 v6, s14, v6
    s_lshl_b32 s14, s19, 2
    v_add_u32 v7, s14, v6
    v_lshlrev_b32 v8, 4, v1
    s_lshl_b32 s15, s17, 15
    s_lshl_b32 s16, s19, 13
    s_add_u32 s15, s15, s16
    s_add_u32 s15, s15, 0
    s_add_u32 s16, s15, 4096
    v_and_b32 v9, 1, v4
    v_cmp_eq_u32 s[20:21], 1, v9
    s_waitcnt vmcnt(0)
    v_lshlrev_b32 v48, 16, v16
    v_and_b32 v49, 0xffff0000, v16
    v_lshlrev_b32 v50, 16, v17
    v_and_b32 v51, 0xffff0000, v17
    v_lshlrev_b32 v52, 16, v18
    v_and_b32 v53, 0xffff0000, v18
    v_lshlrev_b32 v54, 16, v19
    v_and_b32 v55, 0xffff0000, v19
    v_lshlrev_b32 v56, 16, v20
    v_and_b32 v57, 0xffff0000, v20
    v_lshlrev_b32 v58, 16, v21
    v_and_b32 v59, 0xffff0000, v21
    v_lshlrev_b32 v60, 16, v22
    v_and_b32 v61, 0xffff0000, v22
    v_lshlrev_b32 v62, 16, v23
    v_and_b32 v63, 0xffff0000, v23
    v_lshlrev_b32 v64, 16, v24
    v_and_b32 v65, 0xffff0000, v24
    v_lshlrev_b32 v66, 16, v25
    v_and_b32 v67, 0xffff0000, v25
    v_lshlrev_b32 v68, 16, v26
    v_and_b32 v69, 0xffff0000, v26
    v_lshlrev_b32 v70, 16, v27
    v_and_b32 v71, 0xffff0000, v27
    v_lshlrev_b32 v72, 16, v28
    v_and_b32 v73, 0xffff0000, v28
    v_lshlrev_b32 v74, 16, v29
    v_and_b32 v75, 0xffff0000, v29
    v_lshlrev_b32 v76, 16, v30
    v_and_b32 v77, 0xffff0000, v30
    v_lshlrev_b32 v78, 16, v31
    v_and_b32 v79, 0xffff0000, v31
    v_lshlrev_b32 v80, 16, v32
    v_and_b32 v81, 0xffff0000, v32
    v_lshlrev_b32 v82, 16, v33
    v_and_b32 v83, 0xffff0000, v33
    v_lshlrev_b32 v84, 16, v34
    v_and_b32 v85, 0xffff0000, v34
    v_lshlrev_b32 v86, 16, v35
    v_and_b32 v87, 0xffff0000, v35
    v_lshlrev_b32 v88, 16, v36
    v_and_b32 v89, 0xffff0000, v36
    v_lshlrev_b32 v90, 16, v37
    v_and_b32 v91, 0xffff0000, v37
    v_lshlrev_b32 v92, 16, v38
    v_and_b32 v93, 0xffff0000, v38
    v_lshlrev_b32 v94, 16, v39
    v_and_b32 v95, 0xffff0000, v39
    v_lshlrev_b32 v96, 16, v40
    v_and_b32 v97, 0xffff0000, v40
    v_lshlrev_b32 v98, 16, v41
    v_and_b32 v99, 0xffff0000, v41
    v_lshlrev_b32 v100, 16, v42
    v_and_b32 v101, 0xffff0000, v42
    v_lshlrev_b32 v102, 16, v43
    v_and_b32 v103, 0xffff0000, v43
    v_lshlrev_b32 v104, 16, v44
    v_and_b32 v105, 0xffff0000, v44
    v_lshlrev_b32 v106, 16, v45
    v_and_b32 v107, 0xffff0000, v45
    v_lshlrev_b32 v108, 16, v46
    v_and_b32 v109, 0xffff0000, v46
    v_lshlrev_b32 v110, 16, v47
    v_and_b32 v111, 0xffff0000, v47
    v_add_f32 v112, v48, v80
    v_add_f32 v113, v49, v81
    v_add_f32 v114, v50, v82
    v_add_f32 v115, v51, v83
    v_add_f32 v116, v52, v84
    v_add_f32 v117, v53, v85
    v_add_f32 v118, v54, v86
    v_add_f32 v119, v55, v87
    v_add_f32 v120, v56, v88
    v_add_f32 v121, v57, v89
    v_add_f32 v122, v58, v90
    v_add_f32 v123, v59, v91
    v_add_f32 v124, v60, v92
    v_add_f32 v125, v61, v93
    v_add_f32 v126, v62, v94
    v_add_f32 v127, v63, v95
    v_add_f32 v128, v64, v96
    v_add_f32 v129, v65, v97
    v_add_f32 v130, v66, v98
    v_add_f32 v131, v67, v99
    v_add_f32 v132, v68, v100
    v_add_f32 v133, v69, v101
    v_add_f32 v134, v70, v102
    v_add_f32 v135, v71, v103
    v_add_f32 v136, v72, v104
    v_add_f32 v137, v73, v105
    v_add_f32 v138, v74, v106
    v_add_f32 v139, v75, v107
    v_add_f32 v140, v76, v108
    v_add_f32 v141, v77, v109
    v_add_f32 v142, v78, v110
    v_add_f32 v143, v79, v111
    v_add_f32 v112, v112, v128
    v_add_f32 v113, v113, v129
    v_add_f32 v114, v114, v130
    v_add_f32 v115, v115, v131
    v_add_f32 v116, v116, v132
    v_add_f32 v117, v117, v133
    v_add_f32 v118, v118, v134
    v_add_f32 v119, v119, v135
    v_add_f32 v120, v120, v136
    v_add_f32 v121, v121, v137
    v_add_f32 v122, v122, v138
    v_add_f32 v123, v123, v139
    v_add_f32 v124, v124, v140
    v_add_f32 v125, v125, v141
    v_add_f32 v126, v126, v142
    v_add_f32 v127, v127, v143
    v_add_f32 v112, v112, v120
    v_add_f32 v113, v113, v121
    v_add_f32 v114, v114, v122
    v_add_f32 v115, v115, v123
    v_add_f32 v116, v116, v124
    v_add_f32 v117, v117, v125
    v_add_f32 v118, v118, v126
    v_add_f32 v119, v119, v127
    v_add_f32 v112, v112, v116
    v_add_f32 v113, v113, v117
    v_add_f32 v114, v114, v118
    v_add_f32 v115, v115, v119
    v_add_f32 v112, v112, v114
    v_add_f32 v113, v113, v115
    v_add_f32 v112, v112, v113
    v_mov_b32 v113, v112
    s_nop 1
    v_permlane16_swap_b32 v113, v112
    v_add_f32 v112, v112, v113
    v_mov_b32 v113, v112
    s_nop 1
    v_permlane32_swap_b32 v113, v112
    v_add_f32 v112, v112, v113
    ds_write_b32 v7, v112
    s_waitcnt lgkmcnt(0)
    s_barrier
    ds_read_b128 v[112:115], v6
    s_waitcnt lgkmcnt(0)
    v_add_f32 v112, v112, v114
    v_add_f32 v113, v113, v115
    v_add_f32 v112, v112, v113
    v_mul_f32 v10, 0x3a800000, v112
    v_sub_f32 v176, v48, v10
    v_sub_f32 v177, v49, v10
    v_sub_f32 v178, v50, v10
    v_sub_f32 v179, v51, v10
    v_sub_f32 v180, v52, v10
    v_sub_f32 v181, v53, v10
    v_sub_f32 v182, v54, v10
    v_sub_f32 v183, v55, v10
    v_sub_f32 v184, v56, v10
    v_sub_f32 v185, v57, v10
    v_sub_f32 v186, v58, v10
    v_sub_f32 v187, v59, v10
    v_sub_f32 v188, v60, v10
    v_sub_f32 v189, v61, v10
    v_sub_f32 v190, v62, v10
    v_sub_f32 v191, v63, v10
    v_sub_f32 v192, v64, v10
    v_sub_f32 v193, v65, v10
    v_sub_f32 v194, v66, v10
    v_sub_f32 v195, v67, v10
    v_sub_f32 v196, v68, v10
    v_sub_f32 v197, v69, v10
    v_sub_f32 v198, v70, v10
    v_sub_f32 v199, v71, v10
    v_sub_f32 v200, v72, v10
    v_sub_f32 v201, v73, v10
    v_sub_f32 v202, v74, v10
    v_sub_f32 v203, v75, v10
    v_sub_f32 v204, v76, v10
    v_sub_f32 v205, v77, v10
    v_sub_f32 v206, v78, v10
    v_sub_f32 v207, v79, v10
    v_sub_f32 v208, v80, v10
    v_sub_f32 v209, v81, v10
    v_sub_f32 v210, v82, v10
    v_sub_f32 v211, v83, v10
    v_sub_f32 v212, v84, v10
    v_sub_f32 v213, v85, v10
    v_sub_f32 v214, v86, v10
    v_sub_f32 v215, v87, v10
    v_sub_f32 v216, v88, v10
    v_sub_f32 v217, v89, v10
    v_sub_f32 v218, v90, v10
    v_sub_f32 v219, v91, v10
    v_sub_f32 v220, v92, v10
    v_sub_f32 v221, v93, v10
    v_sub_f32 v222, v94, v10
    v_sub_f32 v223, v95, v10
    v_sub_f32 v224, v96, v10
    v_sub_f32 v225, v97, v10
    v_sub_f32 v226, v98, v10
    v_sub_f32 v227, v99, v10
    v_sub_f32 v228, v100, v10
    v_sub_f32 v229, v101, v10
    v_sub_f32 v230, v102, v10
    v_sub_f32 v231, v103, v10
    v_sub_f32 v232, v104, v10
    v_sub_f32 v233, v105, v10
    v_sub_f32 v234, v106, v10
    v_sub_f32 v235, v107, v10
    v_sub_f32 v236, v108, v10
    v_sub_f32 v237, v109, v10
    v_sub_f32 v238, v110, v10
    v_sub_f32 v239, v111, v10
    v_mul_f32 v112, v176, v176
    v_fmac_f32 v112, v208, v208
    v_mul_f32 v113, v177, v177
    v_fmac_f32 v113, v209, v209
    v_mul_f32 v114, v178, v178
    v_fmac_f32 v114, v210, v210
    v_mul_f32 v115, v179, v179
    v_fmac_f32 v115, v211, v211
    v_mul_f32 v116, v180, v180
    v_fmac_f32 v116, v212, v212
    v_mul_f32 v117, v181, v181
    v_fmac_f32 v117, v213, v213
    v_mul_f32 v118, v182, v182
    v_fmac_f32 v118, v214, v214
    v_mul_f32 v119, v183, v183
    v_fmac_f32 v119, v215, v215
    v_mul_f32 v120, v184, v184
    v_fmac_f32 v120, v216, v216
    v_mul_f32 v121, v185, v185
    v_fmac_f32 v121, v217, v217
    v_mul_f32 v122, v186, v186
    v_fmac_f32 v122, v218, v218
    v_mul_f32 v123, v187, v187
    v_fmac_f32 v123, v219, v219
    v_mul_f32 v124, v188, v188
    v_fmac_f32 v124, v220, v220
    v_mul_f32 v125, v189, v189
    v_fmac_f32 v125, v221, v221
    v_mul_f32 v126, v190, v190
    v_fmac_f32 v126, v222, v222
    v_mul_f32 v127, v191, v191
    v_fmac_f32 v127, v223, v223
    v_mul_f32 v128, v192, v192
    v_fmac_f32 v128, v224, v224
    v_mul_f32 v129, v193, v193
    v_fmac_f32 v129, v225, v225
    v_mul_f32 v130, v194, v194
    v_fmac_f32 v130, v226, v226
    v_mul_f32 v131, v195, v195
    v_fmac_f32 v131, v227, v227
    v_mul_f32 v132, v196, v196
    v_fmac_f32 v132, v228, v228
    v_mul_f32 v133, v197, v197
    v_fmac_f32 v133, v229, v229
    v_mul_f32 v134, v198, v198
    v_fmac_f32 v134, v230, v230
    v_mul_f32 v135, v199, v199
    v_fmac_f32 v135, v231, v231
    v_mul_f32 v136, v200, v200
    v_fmac_f32 v136, v232, v232
    v_mul_f32 v137, v201, v201
    v_fmac_f32 v137, v233, v233
    v_mul_f32 v138, v202, v202
    v_fmac_f32 v138, v234, v234
    v_mul_f32 v139, v203, v203
    v_fmac_f32 v139, v235, v235
    v_mul_f32 v140, v204, v204
    v_fmac_f32 v140, v236, v236
    v_mul_f32 v141, v205, v205
    v_fmac_f32 v141, v237, v237
    v_mul_f32 v142, v206, v206
    v_fmac_f32 v142, v238, v238
    v_mul_f32 v143, v207, v207
    v_fmac_f32 v143, v239, v239
    v_add_f32 v112, v112, v128
    v_add_f32 v113, v113, v129
    v_add_f32 v114, v114, v130
    v_add_f32 v115, v115, v131
    v_add_f32 v116, v116, v132
    v_add_f32 v117, v117, v133
    v_add_f32 v118, v118, v134
    v_add_f32 v119, v119, v135
    v_add_f32 v120, v120, v136
    v_add_f32 v121, v121, v137
    v_add_f32 v122, v122, v138
    v_add_f32 v123, v123, v139
    v_add_f32 v124, v124, v140
    v_add_f32 v125, v125, v141
    v_add_f32 v126, v126, v142
    v_add_f32 v127, v127, v143
    v_add_f32 v112, v112, v120
    v_add_f32 v113, v113, v121
    v_add_f32 v114, v114, v122
    v_add_f32 v115, v115, v123
    v_add_f32 v116, v116, v124
    v_add_f32 v117, v117, v125
    v_add_f32 v118, v118, v126
    v_add_f32 v119, v119, v127
    v_add_f32 v112, v112, v116
    v_add_f32 v113, v113, v117
    v_add_f32 v114, v114, v118
    v_add_f32 v115, v115, v119
    v_add_f32 v112, v112, v114
    v_add_f32 v113, v113, v115
    v_add_f32 v112, v112, v113
    v_mov_b32 v113, v112
    s_nop 1
    v_permlane16_swap_b32 v113, v112
    v_add_f32 v112, v112, v113
    v_mov_b32 v113, v112
    s_nop 1
    v_permlane32_swap_b32 v113, v112
    v_add_f32 v112, v112, v113
    ds_write_b32 v7, v112 offset:512
    s_waitcnt lgkmcnt(0)
    s_barrier
    ds_read_b128 v[112:115], v6 offset:512
    v_mov_b32 v12, 2048
    ds_read_b32 v12, v12
    s_mov_b32 s96, s97
    s_waitcnt lgkmcnt(0)
    v_readfirstlane_b32 s97, v12
    s_cmp_lg_u32 s96, s97
    s_cbranch_scc1 k_restart
    s_waitcnt lgkmcnt(0)
    v_cmp_gt_u32 vcc, 32, v0
    s_and_saveexec_b64 s[22:23], vcc
    s_cbranch_execz ln_nz
    buffer_store_dword v14, v13, s[4:7], s13 offen sc1
ln_nz:
    s_mov_b64 exec, -1
    v_add_f32 v112, v112, v114
    v_add_f32 v113, v113, v115
    v_add_f32 v112, v112, v113
    v_mul_f32 v11, 0x3a800000, v112
    v_cvt_pk_bf16_f32 v10, v10, v10
    v_lshlrev_b32 v10, 16, v10
    v_cvt_pk_bf16_f32 v11, v11, v11
    v_lshlrev_b32 v11, 16, v11
    v_add_f32 v11, 0x3727c5ac, v11
    v_cvt_pk_bf16_f32 v11, v11, v11
    v_lshlrev_b32 v11, 16, v11
    v_sqrt_f32 v11, v11
    s_nop 0
    v_cvt_pk_bf16_f32 v11, v11, v11
    v_lshlrev_b32 v11, 16, v11
    v_rcp_f32 v11, v11
    s_nop 0
    v_sub_f32 v48, v48, v10
    v_sub_f32 v49, v49, v10
    v_cvt_pk_bf16_f32 v16, v48, v49
    v_lshlrev_b32 v48, 16, v16
    v_and_b32 v49, 0xffff0000, v16
    v_mul_f32 v48, v48, v11
    v_mul_f32 v49, v49, v11
    v_cvt_pk_bf16_f32 v16, v48, v49
    v_sub_f32 v50, v50, v10
    v_sub_f32 v51, v51, v10
    v_cvt_pk_bf16_f32 v17, v50, v51
    v_lshlrev_b32 v50, 16, v17
    v_and_b32 v51, 0xffff0000, v17
    v_mul_f32 v50, v50, v11
    v_mul_f32 v51, v51, v11
    v_cvt_pk_bf16_f32 v17, v50, v51
    v_sub_f32 v52, v52, v10
    v_sub_f32 v53, v53, v10
    v_cvt_pk_bf16_f32 v18, v52, v53
    v_lshlrev_b32 v52, 16, v18
    v_and_b32 v53, 0xffff0000, v18
    v_mul_f32 v52, v52, v11
    v_mul_f32 v53, v53, v11
    v_cvt_pk_bf16_f32 v18, v52, v53
    v_sub_f32 v54, v54, v10
    v_sub_f32 v55, v55, v10
    v_cvt_pk_bf16_f32 v19, v54, v55
    v_lshlrev_b32 v54, 16, v19
    v_and_b32 v55, 0xffff0000, v19
    v_mul_f32 v54, v54, v11
    v_mul_f32 v55, v55, v11
    v_cvt_pk_bf16_f32 v19, v54, v55
    v_cndmask_b32 v112, v16, v18, s[20:21]
    v_cndmask_b32 v113, v17, v19, s[20:21]
    v_cndmask_b32 v114, v18, v16, s[20:21]
    v_cndmask_b32 v115, v19, v17, s[20:21]
    buffer_store_dwordx4 v[112:115], v8, s[4:7], s15 offen offset:0 sc1
    v_sub_f32 v56, v56, v10
    v_sub_f32 v57, v57, v10
    v_cvt_pk_bf16_f32 v20, v56, v57
    v_lshlrev_b32 v56, 16, v20
    v_and_b32 v57, 0xffff0000, v20
    v_mul_f32 v56, v56, v11
    v_mul_f32 v57, v57, v11
    v_cvt_pk_bf16_f32 v20, v56, v57
    v_sub_f32 v58, v58, v10
    v_sub_f32 v59, v59, v10
    v_cvt_pk_bf16_f32 v21, v58, v59
    v_lshlrev_b32 v58, 16, v21
    v_and_b32 v59, 0xffff0000, v21
    v_mul_f32 v58, v58, v11
    v_mul_f32 v59, v59, v11
    v_cvt_pk_bf16_f32 v21, v58, v59
    v_sub_f32 v60, v60, v10
    v_sub_f32 v61, v61, v10
    v_cvt_pk_bf16_f32 v22, v60, v61
    v_lshlrev_b32 v60, 16, v22
    v_and_b32 v61, 0xffff0000, v22
    v_mul_f32 v60, v60, v11
    v_mul_f32 v61, v61, v11
    v_cvt_pk_bf16_f32 v22, v60, v61
    v_sub_f32 v62, v62, v10
    v_sub_f32 v63, v63, v10
    v_cvt_pk_bf16_f32 v23, v62, v63
    v_lshlrev_b32 v62, 16, v23
    v_and_b32 v63, 0xffff0000, v23
    v_mul_f32 v62, v62, v11
    v_mul_f32 v63, v63, v11
    v_cvt_pk_bf16_f32 v23, v62, v63
    v_cndmask_b32 v116, v20, v22, s[20:21]
    v_cndmask_b32 v117, v21, v23, s[20:21]
    v_cndmask_b32 v118, v22, v20, s[20:21]
    v_cndmask_b32 v119, v23, v21, s[20:21]
    buffer_store_dwordx4 v[116:119], v8, s[4:7], s15 offen offset:1024 sc1
    v_sub_f32 v64, v64, v10
    v_sub_f32 v65, v65, v10
    v_cvt_pk_bf16_f32 v24, v64, v65
    v_lshlrev_b32 v64, 16, v24
    v_and_b32 v65, 0xffff0000, v24
    v_mul_f32 v64, v64, v11
    v_mul_f32 v65, v65, v11
    v_cvt_pk_bf16_f32 v24, v64, v65
    v_sub_f32 v66, v66, v10
    v_sub_f32 v67, v67, v10
    v_cvt_pk_bf16_f32 v25, v66, v67
    v_lshlrev_b32 v66, 16, v25
    v_and_b32 v67, 0xffff0000, v25
    v_mul_f32 v66, v66, v11
    v_mul_f32 v67, v67, v11
    v_cvt_pk_bf16_f32 v25, v66, v67
    v_sub_f32 v68, v68, v10
    v_sub_f32 v69, v69, v10
    v_cvt_pk_bf16_f32 v26, v68, v69
    v_lshlrev_b32 v68, 16, v26
    v_and_b32 v69, 0xffff0000, v26
    v_mul_f32 v68, v68, v11
    v_mul_f32 v69, v69, v11
    v_cvt_pk_bf16_f32 v26, v68, v69
    v_sub_f32 v70, v70, v10
    v_sub_f32 v71, v71, v10
    v_cvt_pk_bf16_f32 v27, v70, v71
    v_lshlrev_b32 v70, 16, v27
    v_and_b32 v71, 0xffff0000, v27
    v_mul_f32 v70, v70, v11
    v_mul_f32 v71, v71, v11
    v_cvt_pk_bf16_f32 v27, v70, v71
    v_cndmask_b32 v120, v24, v26, s[20:21]
    v_cndmask_b32 v121, v25, v27, s[20:21]
    v_cndmask_b32 v122, v26, v24, s[20:21]
    v_cndmask_b32 v123, v27, v25, s[20:21]
    buffer_store_dwordx4 v[120:123], v8, s[4:7], s15 offen offset:2048 sc1
    v_sub_f32 v72, v72, v10
    v_sub_f32 v73, v73, v10
    v_cvt_pk_bf16_f32 v28, v72, v73
    v_lshlrev_b32 v72, 16, v28
    v_and_b32 v73, 0xffff0000, v28
    v_mul_f32 v72, v72, v11
    v_mul_f32 v73, v73, v11
    v_cvt_pk_bf16_f32 v28, v72, v73
    v_sub_f32 v74, v74, v10
    v_sub_f32 v75, v75, v10
    v_cvt_pk_bf16_f32 v29, v74, v75
    v_lshlrev_b32 v74, 16, v29
    v_and_b32 v75, 0xffff0000, v29
    v_mul_f32 v74, v74, v11
    v_mul_f32 v75, v75, v11
    v_cvt_pk_bf16_f32 v29, v74, v75
    v_sub_f32 v76, v76, v10
    v_sub_f32 v77, v77, v10
    v_cvt_pk_bf16_f32 v30, v76, v77
    v_lshlrev_b32 v76, 16, v30
    v_and_b32 v77, 0xffff0000, v30
    v_mul_f32 v76, v76, v11
    v_mul_f32 v77, v77, v11
    v_cvt_pk_bf16_f32 v30, v76, v77
    v_sub_f32 v78, v78, v10
    v_sub_f32 v79, v79, v10
    v_cvt_pk_bf16_f32 v31, v78, v79
    v_lshlrev_b32 v78, 16, v31
    v_and_b32 v79, 0xffff0000, v31
    v_mul_f32 v78, v78, v11
    v_mul_f32 v79, v79, v11
    v_cvt_pk_bf16_f32 v31, v78, v79
    v_cndmask_b32 v124, v28, v30, s[20:21]
    v_cndmask_b32 v125, v29, v31, s[20:21]
    v_cndmask_b32 v126, v30, v28, s[20:21]
    v_cndmask_b32 v127, v31, v29, s[20:21]
    buffer_store_dwordx4 v[124:127], v8, s[4:7], s15 offen offset:3072 sc1
    v_sub_f32 v80, v80, v10
    v_sub_f32 v81, v81, v10
    v_cvt_pk_bf16_f32 v32, v80, v81
    v_lshlrev_b32 v80, 16, v32
    v_and_b32 v81, 0xffff0000, v32
    v_mul_f32 v80, v80, v11
    v_mul_f32 v81, v81, v11
    v_cvt_pk_bf16_f32 v32, v80, v81
    v_sub_f32 v82, v82, v10
    v_sub_f32 v83, v83, v10
    v_cvt_pk_bf16_f32 v33, v82, v83
    v_lshlrev_b32 v82, 16, v33
    v_and_b32 v83, 0xffff0000, v33
    v_mul_f32 v82, v82, v11
    v_mul_f32 v83, v83, v11
    v_cvt_pk_bf16_f32 v33, v82, v83
    v_sub_f32 v84, v84, v10
    v_sub_f32 v85, v85, v10
    v_cvt_pk_bf16_f32 v34, v84, v85
    v_lshlrev_b32 v84, 16, v34
    v_and_b32 v85, 0xffff0000, v34
    v_mul_f32 v84, v84, v11
    v_mul_f32 v85, v85, v11
    v_cvt_pk_bf16_f32 v34, v84, v85
    v_sub_f32 v86, v86, v10
    v_sub_f32 v87, v87, v10
    v_cvt_pk_bf16_f32 v35, v86, v87
    v_lshlrev_b32 v86, 16, v35
    v_and_b32 v87, 0xffff0000, v35
    v_mul_f32 v86, v86, v11
    v_mul_f32 v87, v87, v11
    v_cvt_pk_bf16_f32 v35, v86, v87
    v_cndmask_b32 v128, v32, v34, s[20:21]
    v_cndmask_b32 v129, v33, v35, s[20:21]
    v_cndmask_b32 v130, v34, v32, s[20:21]
    v_cndmask_b32 v131, v35, v33, s[20:21]
    buffer_store_dwordx4 v[128:131], v8, s[4:7], s16 offen offset:0 sc1
    v_sub_f32 v88, v88, v10
    v_sub_f32 v89, v89, v10
    v_cvt_pk_bf16_f32 v36, v88, v89
    v_lshlrev_b32 v88, 16, v36
    v_and_b32 v89, 0xffff0000, v36
    v_mul_f32 v88, v88, v11
    v_mul_f32 v89, v89, v11
    v_cvt_pk_bf16_f32 v36, v88, v89
    v_sub_f32 v90, v90, v10
    v_sub_f32 v91, v91, v10
    v_cvt_pk_bf16_f32 v37, v90, v91
    v_lshlrev_b32 v90, 16, v37
    v_and_b32 v91, 0xffff0000, v37
    v_mul_f32 v90, v90, v11
    v_mul_f32 v91, v91, v11
    v_cvt_pk_bf16_f32 v37, v90, v91
    v_sub_f32 v92, v92, v10
    v_sub_f32 v93, v93, v10
    v_cvt_pk_bf16_f32 v38, v92, v93
    v_lshlrev_b32 v92, 16, v38
    v_and_b32 v93, 0xffff0000, v38
    v_mul_f32 v92, v92, v11
    v_mul_f32 v93, v93, v11
    v_cvt_pk_bf16_f32 v38, v92, v93
    v_sub_f32 v94, v94, v10
    v_sub_f32 v95, v95, v10
    v_cvt_pk_bf16_f32 v39, v94, v95
    v_lshlrev_b32 v94, 16, v39
    v_and_b32 v95, 0xffff0000, v39
    v_mul_f32 v94, v94, v11
    v_mul_f32 v95, v95, v11
    v_cvt_pk_bf16_f32 v39, v94, v95
    v_cndmask_b32 v132, v36, v38, s[20:21]
    v_cndmask_b32 v133, v37, v39, s[20:21]
    v_cndmask_b32 v134, v38, v36, s[20:21]
    v_cndmask_b32 v135, v39, v37, s[20:21]
    buffer_store_dwordx4 v[132:135], v8, s[4:7], s16 offen offset:1024 sc1
    v_sub_f32 v96, v96, v10
    v_sub_f32 v97, v97, v10
    v_cvt_pk_bf16_f32 v40, v96, v97
    v_lshlrev_b32 v96, 16, v40
    v_and_b32 v97, 0xffff0000, v40
    v_mul_f32 v96, v96, v11
    v_mul_f32 v97, v97, v11
    v_cvt_pk_bf16_f32 v40, v96, v97
    v_sub_f32 v98, v98, v10
    v_sub_f32 v99, v99, v10
    v_cvt_pk_bf16_f32 v41, v98, v99
    v_lshlrev_b32 v98, 16, v41
    v_and_b32 v99, 0xffff0000, v41
    v_mul_f32 v98, v98, v11
    v_mul_f32 v99, v99, v11
    v_cvt_pk_bf16_f32 v41, v98, v99
    v_sub_f32 v100, v100, v10
    v_sub_f32 v101, v101, v10
    v_cvt_pk_bf16_f32 v42, v100, v101
    v_lshlrev_b32 v100, 16, v42
    v_and_b32 v101, 0xffff0000, v42
    v_mul_f32 v100, v100, v11
    v_mul_f32 v101, v101, v11
    v_cvt_pk_bf16_f32 v42, v100, v101
    v_sub_f32 v102, v102, v10
    v_sub_f32 v103, v103, v10
    v_cvt_pk_bf16_f32 v43, v102, v103
    v_lshlrev_b32 v102, 16, v43
    v_and_b32 v103, 0xffff0000, v43
    v_mul_f32 v102, v102, v11
    v_mul_f32 v103, v103, v11
    v_cvt_pk_bf16_f32 v43, v102, v103
    v_cndmask_b32 v136, v40, v42, s[20:21]
    v_cndmask_b32 v137, v41, v43, s[20:21]
    v_cndmask_b32 v138, v42, v40, s[20:21]
    v_cndmask_b32 v139, v43, v41, s[20:21]
    buffer_store_dwordx4 v[136:139], v8, s[4:7], s16 offen offset:2048 sc1
    v_sub_f32 v104, v104, v10
    v_sub_f32 v105, v105, v10
    v_cvt_pk_bf16_f32 v44, v104, v105
    v_lshlrev_b32 v104, 16, v44
    v_and_b32 v105, 0xffff0000, v44
    v_mul_f32 v104, v104, v11
    v_mul_f32 v105, v105, v11
    v_cvt_pk_bf16_f32 v44, v104, v105
    v_sub_f32 v106, v106, v10
    v_sub_f32 v107, v107, v10
    v_cvt_pk_bf16_f32 v45, v106, v107
    v_lshlrev_b32 v106, 16, v45
    v_and_b32 v107, 0xffff0000, v45
    v_mul_f32 v106, v106, v11
    v_mul_f32 v107, v107, v11
    v_cvt_pk_bf16_f32 v45, v106, v107
    v_sub_f32 v108, v108, v10
    v_sub_f32 v109, v109, v10
    v_cvt_pk_bf16_f32 v46, v108, v109
    v_lshlrev_b32 v108, 16, v46
    v_and_b32 v109, 0xffff0000, v46
    v_mul_f32 v108, v108, v11
    v_mul_f32 v109, v109, v11
    v_cvt_pk_bf16_f32 v46, v108, v109
    v_sub_f32 v110, v110, v10
    v_sub_f32 v111, v111, v10
    v_cvt_pk_bf16_f32 v47, v110, v111
    v_lshlrev_b32 v110, 16, v47
    v_and_b32 v111, 0xffff0000, v47
    v_mul_f32 v110, v110, v11
    v_mul_f32 v111, v111, v11
    v_cvt_pk_bf16_f32 v47, v110, v111
    v_cndmask_b32 v140, v44, v46, s[20:21]
    v_cndmask_b32 v141, v45, v47, s[20:21]
    v_cndmask_b32 v142, v46, v44, s[20:21]
    v_cndmask_b32 v143, v47, v45, s[20:21]
    buffer_store_dwordx4 v[140:143], v8, s[4:7], s16 offen offset:3072 sc1
    s_waitcnt vmcnt(0)
    s_barrier
    s_cmp_lg_u32 s3, 0
    s_cbranch_scc1 ln_sig
    v_mov_b32 v2, 1
    s_mov_b64 exec, 1
    s_cmp_ge_u32 s63, 8
    s_cbranch_scc1 ln_sb
    buffer_atomic_add v2, off, s[64:67], 0 offset:192 sc1
ln_sb:
    buffer_atomic_add v2, off, s[64:67], 0 offset:0 sc1
    s_mov_b64 exec, -1
    s_branch ln_sig
ln_touch:
    s_getpc_b64 s[24:25]
    s_add_u32 s24, s24, jobtab@rel32@lo+4
    s_addc_u32 s25, s25, jobtab@rel32@hi+12
    s_and_b32 s30, s63, 3
    s_mul_i32 s30, s30, 323
    s_lshr_b32 s31, s63, 2
    s_add_u32 s30, s30, s31
    s_lshl_b32 s30, s30, 6
    s_add_u32 s24, s24, s30
    s_addc_u32 s25, s25, 0
    s_load_dwordx16 s[32:47], s[24:25], 0
    s_mov_b32 s11, 131072
    v_and_b32 v20, 63, v0
    s_waitcnt lgkmcnt(0)
    s_load_dwordx2 s[8:9], s[0:1], s33
    s_mov_b32 s10, s38
    s_lshl_b32 s30, s35, 4
    v_mul_lo_u32 v21, s30, v20
    v_and_b32 v22, 15, v20
    v_mul_lo_u32 v22, s43, v22
    s_waitcnt lgkmcnt(0)
    s_cmp_eq_u32 s3, 4
    s_cbranch_scc0 tlb_1_1
    buffer_load_dword v23, v21, s[8:11], s36 offen
    s_branch tlb_1
tlb_1_1:
    s_cmp_eq_u32 s3, 5
    s_cbranch_scc0 tlb_1
    buffer_load_dword v23, v22, s[4:7], s42 offen
    buffer_load_dword v23, off, s[4:7], s46
tlb_1:
    s_cmp_lg_u32 s3, 7
    s_cbranch_scc1 ln_nrp
    s_mov_b32 s95, 0x10000
rp_2:
    buffer_load_dword v13, off, s[64:67], 0 offset:224 sc1
    s_waitcnt vmcnt(0)
    v_readfirstlane_b32 s96, v13
    s_cmp_lg_u32 s96, 0
    s_cbranch_scc1 rp_2_ok
    s_sleep 2
    s_sub_u32 s95, s95, 1
    s_cbranch_scc0 rp_2
    s_add_u32 s96, s97, 1
rp_2_ok:
    s_sub_u32 s96, s96, 1
    v_mov_b32 v12, 2048
    v_mov_b32 v13, s96
    ds_write_b32 v12, v13
    s_waitcnt lgkmcnt(0)
ln_nrp:
    s_barrier
    s_barrier
    v_mov_b32 v12, 2048
    ds_read_b32 v12, v12
    s_mov_b32 s96, s97
    s_waitcnt lgkmcnt(0)
    v_readfirstlane_b32 s97, v12
    s_cmp_lg_u32 s96, s97
    s_cbranch_scc1 k_restart
    s_barrier
ln_sig:
    s_mov_b32 s29, s63
    v_and_b32 v20, 63, v0
    v_lshlrev_b32 v1, 4, v20
    v_add_u32 v19, 0x1000, v1
    v_lshrrev_b32 v4, 4, v20
    v_mov_b32 v17, 0
    v_mov_b32 v18, 1
    s_lshr_b32 s26, s3, 2
    s_and_b32 s27, s3, 3
    s_lshl_b32 s21, s3, 11
    s_lshl_b32 s22, s3, 10
    s_add_u32 s22, s22, 16384
    s_mov_b32 s11, 131072
    s_mov_b32 s15, 131072
    s_mov_b32 s28, 0
    v_and_b32 v21, 15, v20
    v_lshlrev_b32 v22, 2, v4
    v_xor_b32 v21, v21, v22
    s_lshr_b32 s30, s3, 1
    s_and_b32 s30, s30, 1
    v_xor_b32 v21, s30, v21
    v_lshlrev_b32 v3, 4, v21
    s_lshl_b32 s30, s26, 13
    v_add_u32 v5, s30, v1
    v_add_u32 v6, 0x10000, v5
    v_bfe_u32 v21, v20, 2, 2
    v_and_b32 v22, 3, v20
    v_and_b32 v23, 1, v4
    v_xor_b32 v24, s27, v21
    v_xor_b32 v25, v22, v23
    v_lshl_add_u32 v24, v24, 2, v25
    v_lshlrev_b32 v24, 4, v24
    v_lshl_add_u32 v25, v4, 3, v21
    v_lshl_add_u32 v24, v25, 8, v24
    v_and_b32 v22, 1, v22
    v_xor_b32 v25, 0, v23
    v_lshl_add_u32 v8, v25, 10, v24
    v_xor_b32 v25, 0, v22
    v_lshl_add_u32 v8, v25, 3, v8
    v_add_u32 v12, 0x10000, v8
    v_xor_b32 v25, 1, v23
    v_lshl_add_u32 v9, v25, 10, v24
    v_xor_b32 v25, 0, v22
    v_lshl_add_u32 v9, v25, 3, v9
    v_add_u32 v13, 0x10000, v9
    v_xor_b32 v25, 0, v23
    v_lshl_add_u32 v10, v25, 10, v24
    v_xor_b32 v25, 1, v22
    v_lshl_add_u32 v10, v25, 3, v10
    v_add_u32 v14, 0x10000, v10
    v_xor_b32 v25, 1, v23
    v_lshl_add_u32 v11, v25, 10, v24
    v_xor_b32 v25, 1, v22
    v_lshl_add_u32 v11, v25, 3, v11
    v_add_u32 v15, 0x10000, v11
    s_lshl_b32 s30, s3, 2
    s_add_u32 s30, s30, 131072
    v_mov_b32 v7, s30
    s_cmp_ge_u32 s3, 4
    s_cbranch_scc0 w_np
    s_setprio 1
w_np:
    s_getpc_b64 s[24:25]
    s_add_u32 s24, s24, jobtab@rel32@lo+4
    s_addc_u32 s25, s25, jobtab@rel32@hi+12
    s_and_b32 s31, s29, 3
    s_mul_i32 s30, s31, 20672
    s_add_u32 s24, s24, s30
    s_addc_u32 s25, s25, 0
    s_lshl_b32 s71, s31, 2
    s_add_u32 s71, s71, 64
    s_lshr_b32 s59, s29, 2
    s_lshl_b32 s30, s59, 6
    s_load_dwordx16 s[32:47], s[24:25], s30
    s_waitcnt lgkmcnt(0)
    s_sub_u32 s57, s32, 3
    s_cmp_ge_u32 s57, 2
    s_cbranch_scc1 w_nopre
    s_load_dwordx2 s[8:9], s[0:1], s33
    s_load_dwordx2 s[12:13], s[0:1], s34
    s_mov_b32 s10, s38
    s_mov_b32 s14, s38
    s_cmp_eq_u32 s32, 4
    s_cselect_b32 s31, 0, 1
    s_lshl_b32 s30, s3, s31
    s_mul_i32 s30, s30, s40
    s_add_u32 s16, s39, s30
    s_cmp_eq_u32 s32, 4
    s_cselect_b32 s30, 1024, s40
    s_cselect_b32 s31, 6, 5
    s_lshl_b32 s62, 32, s31
    s_add_u32 s17, s16, s30
    s_lshl_b32 s30, s3, 2
    s_mul_i32 s30, s30, s35
    s_add_u32 s18, s36, s30
    s_add_u32 s19, s37, s30
    s_lshl_b32 s20, s35, s31
    v_mul_u32_u24 v2, s35, v4
    v_add_u32 v2, v2, v3
    s_waitcnt lgkmcnt(0)
    s_add_u32 m0, s22, 0
    s_nop 0
    buffer_load_dwordx4 v2, s[8:11], s18 offen lds
    s_add_u32 s18, s18, s20
    s_add_u32 m0, s22, 8192
    s_nop 0
    buffer_load_dwordx4 v2, s[12:15], s19 offen lds
    s_add_u32 s19, s19, s20
    s_add_u32 m0, s22, 32768
    s_nop 0
    buffer_load_dwordx4 v2, s[8:11], s18 offen lds
    s_add_u32 s18, s18, s20
    s_add_u32 m0, s22, 40960
    s_nop 0
    buffer_load_dwordx4 v2, s[12:15], s19 offen lds
    s_add_u32 s19, s19, s20
    s_add_u32 m0, s22, 65536
    s_nop 0
    buffer_load_dwordx4 v2, s[8:11], s18 offen lds
    s_add_u32 s18, s18, s20
    s_add_u32 m0, s22, 73728
    s_nop 0
    buffer_load_dwordx4 v2, s[12:15], s19 offen lds
    s_add_u32 s19, s19, s20
    s_add_u32 m0, s22, 98304
    s_nop 0
    buffer_load_dwordx4 v2, s[8:11], s18 offen lds
    s_add_u32 s18, s18, s20
    s_add_u32 m0, s22, 106496
    s_nop 0
    buffer_load_dwordx4 v2, s[12:15], s19 offen lds
    s_add_u32 s19, s19, s20
    s_cmp_eq_u32 s32, 4
    s_cselect_b32 s70, 1, 0
    s_cmp_eq_u32 s39, 0
    s_cselect_b32 s70, s70, 0
    s_cmp_lg_u32 s3, 0
    s_cbranch_scc1 lnwp_ok
    s_cmp_eq_u32 s70, 0
    s_cbranch_scc1 lnwp_full
    s_mov_b32 s69, 65536
lnwap:
    buffer_load_dword v20, off, s[64:67], 0 offset:192 sc1
    s_waitcnt vmcnt(0)
    v_readfirstlane_b32 s68, v20
    s_cmp_ge_u32 s68, 8
    s_cbranch_scc1 lnwap_ok
    s_sleep 8
    s_sub_u32 s69, s69, 1
    s_cbranch_scc0 lnwap
lnwap_ok:
    s_branch lnwp_ok
lnwp_full:
    s_mov_b32 s69, 65536
lnwp:
    buffer_load_dword v20, off, s[64:67], 0 offset:0 sc1
    s_waitcnt vmcnt(0)
    v_readfirstlane_b32 s68, v20
    s_cmp_ge_u32 s68, 128
    s_cbranch_scc1 lnwp_ok
    s_sleep 8
    s_sub_u32 s69, s69, 1
    s_cbranch_scc0 lnwp
lnwp_ok:
    s_barrier
    s_add_u32 m0, s21, 0
    s_nop 0
    buffer_load_dwordx4 v1, s[4:7], s16 offen sc1 lds
    s_add_u32 s16, s16, s62
    s_add_u32 m0, s21, 1024
    s_nop 0
    buffer_load_dwordx4 v1, s[4:7], s17 offen sc1 lds
    s_add_u32 s17, s17, s62
    s_add_u32 m0, s21, 32768
    s_nop 0
    buffer_load_dwordx4 v1, s[4:7], s16 offen sc1 lds
    s_add_u32 s16, s16, s62
    s_add_u32 m0, s21, 33792
    s_nop 0
    buffer_load_dwordx4 v1, s[4:7], s17 offen sc1 lds
    s_add_u32 s17, s17, s62
    s_add_u32 m0, s21, 65536
    s_nop 0
    buffer_load_dwordx4 v1, s[4:7], s16 offen sc1 lds
    s_add_u32 s16, s16, s62
    s_add_u32 m0, s21, 66560
    s_nop 0
    buffer_load_dwordx4 v1, s[4:7], s17 offen sc1 lds
    s_add_u32 s17, s17, s62
    s_add_u32 m0, s21, 98304
    s_nop 0
    buffer_load_dwordx4 v1, s[4:7], s16 offen sc1 lds
    s_add_u32 s16, s16, s62
    s_add_u32 m0, s21, 99328
    s_nop 0
    buffer_load_dwordx4 v1, s[4:7], s17 offen sc1 lds
    s_add_u32 s17, s17, s62
    s_branch w_adopt
w_nopre:
    s_cmp_eq_u32 s32, 4
    s_cselect_b32 s70, 1, 0
    s_cmp_eq_u32 s39, 0
    s_cselect_b32 s70, s70, 0
    s_cmp_lg_u32 s3, 0
    s_cbranch_scc1 lnw_ok
    s_cmp_eq_u32 s70, 0
    s_cbranch_scc1 lnw_full
    s_mov_b32 s69, 65536
lnwa:
    buffer_load_dword v20, off, s[64:67], 0 offset:192 sc1
    s_waitcnt vmcnt(0)
    v_readfirstlane_b32 s68, v20
    s_cmp_ge_u32 s68, 8
    s_cbranch_scc1 lnwa_ok
    s_sleep 8
    s_sub_u32 s69, s69, 1
    s_cbranch_scc0 lnwa
lnwa_ok:
    s_branch lnw_ok
lnw_full:
    s_mov_b32 s69, 65536
lnw:
    buffer_load_dword v20, off, s[64:67], 0 offset:0 sc1
    s_waitcnt vmcnt(0)
    v_readfirstlane_b32 s68, v20
    s_cmp_ge_u32 s68, 128
    s_cbranch_scc1 lnw_ok
    s_sleep 8
    s_sub_u32 s69, s69, 1
    s_cbranch_scc0 lnw
lnw_ok:
    s_barrier
w_cold:
    s_cmp_eq_u32 s32, 0
    s_cbranch_scc1 k_end
    s_cmp_ge_u32 s32, 6
    s_cbranch_scc1 w_fin
    s_cmp_lg_u32 s3, 0
    s_cbranch_scc1 w_depok
    s_cmp_eq_u32 s45, 0
    s_cbranch_scc1 w_depok
    s_mov_b32 s31, 0x40000
w_waitdep:
    buffer_load_dword v16, v17, s[4:7], s44 offen sc1
    s_waitcnt vmcnt(0)
    v_readfirstlane_b32 s30, v16
    s_cmp_ge_u32 s30, s45
    s_cbranch_scc1 w_depok
    s_sleep 16
    s_sub_u32 s31, s31, 1
    s_cbranch_scc0 w_waitdep
w_depok:
    s_cmp_eq_u32 s32, 5
    s_cbranch_scc1 w_att
    s_load_dwordx2 s[8:9], s[0:1], s33
    s_load_dwordx2 s[12:13], s[0:1], s34
    s_mov_b32 s10, s38
    s_mov_b32 s14, s38
    s_cmp_eq_u32 s32, 4
    s_cselect_b32 s31, 0, 1
    s_lshl_b32 s30, s3, s31
    s_mul_i32 s30, s30, s40
    s_add_u32 s16, s39, s30
    s_cmp_eq_u32 s32, 4
    s_cselect_b32 s30, 1024, s40
    s_cselect_b32 s31, 6, 5
    s_lshl_b32 s62, 32, s31
    s_add_u32 s17, s16, s30
    s_lshl_b32 s30, s3, 2
    s_mul_i32 s30, s30, s35
    s_add_u32 s18, s36, s30
    s_add_u32 s19, s37, s30
    s_lshl_b32 s20, s35, s31
    v_mul_u32_u24 v2, s35, v4
    v_add_u32 v2, v2, v3
    s_waitcnt lgkmcnt(0)
    s_barrier
    s_add_u32 m0, s21, 0
    s_nop 0
    buffer_load_dwordx4 v1, s[4:7], s16 offen sc1 lds
    s_add_u32 s16, s16, s62
    s_add_u32 m0, s21, 1024
    s_nop 0
    buffer_load_dwordx4 v1, s[4:7], s17 offen sc1 lds
    s_add_u32 s17, s17, s62
    s_add_u32 m0, s22, 0
    s_nop 0
    buffer_load_dwordx4 v2, s[8:11], s18 offen lds
    s_add_u32 s18, s18, s20
    s_add_u32 m0, s22, 8192
    s_nop 0
    buffer_load_dwordx4 v2, s[12:15], s19 offen lds
    s_add_u32 s19, s19, s20
    s_add_u32 m0, s21, 32768
    s_nop 0
    buffer_load_dwordx4 v1, s[4:7], s16 offen sc1 lds
    s_add_u32 s16, s16, s62
    s_add_u32 m0, s21, 33792
    s_nop 0
    buffer_load_dwordx4 v1, s[4:7], s17 offen sc1 lds
    s_add_u32 s17, s17, s62
    s_add_u32 m0, s22, 32768
    s_nop 0
    buffer_load_dwordx4 v2, s[8:11], s18 offen lds
    s_add_u32 s18, s18, s20
    s_add_u32 m0, s22, 40960
    s_nop 0
    buffer_load_dwordx4 v2, s[12:15], s19 offen lds
    s_add_u32 s19, s19, s20
    s_add_u32 m0, s21, 65536
    s_nop 0
    buffer_load_dwordx4 v1, s[4:7], s16 offen sc1 lds
    s_add_u32 s16, s16, s62
    s_add_u32 m0, s21, 66560
    s_nop 0
    buffer_load_dwordx4 v1, s[4:7], s17 offen sc1 lds
    s_add_u32 s17, s17, s62
    s_add_u32 m0, s22, 65536
    s_nop 0
    buffer_load_dwordx4 v2, s[8:11], s18 offen lds
    s_add_u32 s18, s18, s20
    s_add_u32 m0, s22, 73728
    s_nop 0
    buffer_load_dwordx4 v2, s[12:15], s19 offen lds
    s_add_u32 s19, s19, s20
    s_add_u32 m0, s21, 98304
    s_nop 0
    buffer_load_dwordx4 v1, s[4:7], s16 offen sc1 lds
    s_add_u32 s16, s16, s62
    s_add_u32 m0, s21, 99328
    s_nop 0
    buffer_load_dwordx4 v1, s[4:7], s17 offen sc1 lds
    s_add_u32 s17, s17, s62
    s_add_u32 m0, s22, 98304
    s_nop 0
    buffer_load_dwordx4 v2, s[8:11], s18 offen lds
    s_add_u32 s18, s18, s20
    s_add_u32 m0, s22, 106496
    s_nop 0
    buffer_load_dwordx4 v2, s[12:15], s19 offen lds
    s_add_u32 s19, s19, s20
w_adopt:
    s_mov_b32 s48, s32
    s_cmp_eq_u32 s32, 4
    s_cselect_b32 s30, 2, 3
    s_lshl_b32 s30, s26, s30
    s_mul_i32 s30, s30, s43
    s_add_u32 s49, s42, s30
    s_mov_b32 s50, s43
    s_mov_b32 s51, s46
    s_mov_b32 s23, s41
    s_mov_b32 s53, s41
    s_waitcnt vmcnt(0)
    s_barrier
    ds_read_b64_tr_b16 v[64:65], v8 offset:16384
    ds_read_b64_tr_b16 v[66:67], v9 offset:16384
    ds_read_b64_tr_b16 v[68:69], v10 offset:16384
    ds_read_b64_tr_b16 v[70:71], v11 offset:16384
    ds_read_b64_tr_b16 v[72:73], v8 offset:24576
    ds_read_b64_tr_b16 v[74:75], v9 offset:24576
    ds_read_b64_tr_b16 v[76:77], v10 offset:24576
    ds_read_b64_tr_b16 v[78:79], v11 offset:24576
    ds_read_b128 v[32:35], v5 offset:0
    ds_read_b128 v[36:39], v5 offset:1024
    ds_read_b128 v[40:43], v5 offset:2048
    ds_read_b128 v[44:47], v5 offset:3072
    ds_read_b128 v[48:51], v5 offset:4096
    ds_read_b128 v[52:55], v5 offset:5120
    ds_read_b128 v[56:59], v5 offset:6144
    ds_read_b128 v[60:63], v5 offset:7168
    s_waitcnt lgkmcnt(0)
    s_cmp_eq_u32 s48, 4
    s_cbranch_scc1 w_firstH
    s_branch w_first16
w_first4:
    s_waitcnt vmcnt(12)
    s_barrier
    v_mfma_f32_16x16x32_bf16 v[128:131], v[64:67], v[32:35], 0
    s_add_u32 m0, s21, 0
    s_nop 0
    buffer_load_dwordx4 v1, s[4:7], s16 offen sc1 lds
    s_add_u32 s16, s16, s62
    v_mfma_f32_16x16x32_bf16 v[132:135], v[68:71], v[32:35], 0
    ds_read_b64_tr_b16 v[112:113], v8 offset:49152
    v_mfma_f32_16x16x32_bf16 v[136:139], v[72:75], v[32:35], 0
    ds_read_b64_tr_b16 v[114:115], v9 offset:49152
    v_mfma_f32_16x16x32_bf16 v[140:143], v[76:79], v[32:35], 0
    ds_read_b64_tr_b16 v[116:117], v10 offset:49152
    v_mfma_f32_16x16x32_bf16 v[144:147], v[64:67], v[36:39], 0
    s_add_u32 m0, s21, 1024
    s_nop 0
    buffer_load_dwordx4 v1, s[4:7], s17 offen sc1 lds
    s_add_u32 s17, s17, s62
    v_mfma_f32_16x16x32_bf16 v[148:151], v[68:71], v[36:39], 0
    ds_read_b64_tr_b16 v[118:119], v11 offset:49152
    v_mfma_f32_16x16x32_bf16 v[152:155], v[72:75], v[36:39], 0
    ds_read_b64_tr_b16 v[120:121], v8 offset:57344
    v_mfma_f32_16x16x32_bf16 v[156:159], v[76:79], v[36:39], 0
    ds_read_b64_tr_b16 v[122:123], v9 offset:57344
    v_mfma_f32_16x16x32_bf16 v[160:163], v[64:67], v[40:43], 0
    s_add_u32 m0, s22, 0
    s_nop 0
    buffer_load_dwordx4 v2, s[8:11], s18 offen lds
    s_add_u32 s18, s18, s20
    v_mfma_f32_16x16x32_bf16 v[164:167], v[68:71], v[40:43], 0
    ds_read_b64_tr_b16 v[124:125], v10 offset:57344
    v_mfma_f32_16x16x32_bf16 v[168:171], v[72:75], v[40:43], 0
    ds_read_b64_tr_b16 v[126:127], v11 offset:57344
    v_mfma_f32_16x16x32_bf16 v[172:175], v[76:79], v[40:43], 0
    ds_read_b128 v[80:83], v5 offset:32768
    v_mfma_f32_16x16x32_bf16 v[176:179], v[64:67], v[44:47], 0
    s_add_u32 m0, s22, 8192
    s_nop 0
    buffer_load_dwordx4 v2, s[12:15], s19 offen lds
    s_add_u32 s19, s19, s20
    v_mfma_f32_16x16x32_bf16 v[180:183], v[68:71], v[44:47], 0
    ds_read_b128 v[84:87], v5 offset:33792
    v_mfma_f32_16x16x32_bf16 v[184:187], v[72:75], v[44:47], 0
    ds_read_b128 v[88:91], v5 offset:34816
    v_mfma_f32_16x16x32_bf16 v[188:191], v[76:79], v[44:47], 0
    ds_read_b128 v[92:95], v5 offset:35840
    v_mfma_f32_16x16x32_bf16 v[192:195], v[64:67], v[48:51], 0
    ds_read_b128 v[96:99], v5 offset:36864
    v_mfma_f32_16x16x32_bf16 v[196:199], v[68:71], v[48:51], 0
    ds_read_b128 v[100:103], v5 offset:37888
    v_mfma_f32_16x16x32_bf16 v[200:203], v[72:75], v[48:51], 0
    ds_read_b128 v[104:107], v5 offset:38912
    v_mfma_f32_16x16x32_bf16 v[204:207], v[76:79], v[48:51], 0
    ds_read_b128 v[108:111], v5 offset:39936
    v_mfma_f32_16x16x32_bf16 v[208:211], v[64:67], v[52:55], 0
    v_mfma_f32_16x16x32_bf16 v[212:215], v[68:71], v[52:55], 0
    v_mfma_f32_16x16x32_bf16 v[216:219], v[72:75], v[52:55], 0
    v_mfma_f32_16x16x32_bf16 v[220:223], v[76:79], v[52:55], 0
    v_mfma_f32_16x16x32_bf16 v[224:227], v[64:67], v[56:59], 0
    v_mfma_f32_16x16x32_bf16 v[228:231], v[68:71], v[56:59], 0
    v_mfma_f32_16x16x32_bf16 v[232:235], v[72:75], v[56:59], 0
    v_mfma_f32_16x16x32_bf16 v[236:239], v[76:79], v[56:59], 0
    v_mfma_f32_16x16x32_bf16 v[240:243], v[64:67], v[60:63], 0
    v_mfma_f32_16x16x32_bf16 v[244:247], v[68:71], v[60:63], 0
    v_mfma_f32_16x16x32_bf16 v[248:251], v[72:75], v[60:63], 0
    v_mfma_f32_16x16x32_bf16 v[252:255], v[76:79], v[60:63], 0
    s_waitcnt lgkmcnt(0)
w_first4_q1:
    s_waitcnt vmcnt(12)
    s_barrier
    v_mfma_f32_16x16x32_bf16 v[128:131], v[112:115], v[80:83], v[128:131]
    s_add_u32 m0, s21, 32768
    s_nop 0
    buffer_load_dwordx4 v1, s[4:7], s16 offen sc1 lds
    s_add_u32 s16, s16, s62
    v_mfma_f32_16x16x32_bf16 v[132:135], v[116:119], v[80:83], v[132:135]
    ds_read_b64_tr_b16 v[64:65], v12 offset:16384
    v_mfma_f32_16x16x32_bf16 v[136:139], v[120:123], v[80:83], v[136:139]
    ds_read_b64_tr_b16 v[66:67], v13 offset:16384
    v_mfma_f32_16x16x32_bf16 v[140:143], v[124:127], v[80:83], v[140:143]
    ds_read_b64_tr_b16 v[68:69], v14 offset:16384
    v_mfma_f32_16x16x32_bf16 v[144:147], v[112:115], v[84:87], v[144:147]
    s_add_u32 m0, s21, 33792
    s_nop 0
    buffer_load_dwordx4 v1, s[4:7], s17 offen sc1 lds
    s_add_u32 s17, s17, s62
    v_mfma_f32_16x16x32_bf16 v[148:151], v[116:119], v[84:87], v[148:151]
    ds_read_b64_tr_b16 v[70:71], v15 offset:16384
    v_mfma_f32_16x16x32_bf16 v[152:155], v[120:123], v[84:87], v[152:155]
    ds_read_b64_tr_b16 v[72:73], v12 offset:24576
    v_mfma_f32_16x16x32_bf16 v[156:159], v[124:127], v[84:87], v[156:159]
    ds_read_b64_tr_b16 v[74:75], v13 offset:24576
    v_mfma_f32_16x16x32_bf16 v[160:163], v[112:115], v[88:91], v[160:163]
    s_add_u32 m0, s22, 32768
    s_nop 0
    buffer_load_dwordx4 v2, s[8:11], s18 offen lds
    s_add_u32 s18, s18, s20
    v_mfma_f32_16x16x32_bf16 v[164:167], v[116:119], v[88:91], v[164:167]
    ds_read_b64_tr_b16 v[76:77], v14 offset:24576
    v_mfma_f32_16x16x32_bf16 v[168:171], v[120:123], v[88:91], v[168:171]
    ds_read_b64_tr_b16 v[78:79], v15 offset:24576
    v_mfma_f32_16x16x32_bf16 v[172:175], v[124:127], v[88:91], v[172:175]
    ds_read_b128 v[32:35], v6 offset:0
    v_mfma_f32_16x16x32_bf16 v[176:179], v[112:115], v[92:95], v[176:179]
    s_add_u32 m0, s22, 40960
    s_nop 0
    buffer_load_dwordx4 v2, s[12:15], s19 offen lds
    s_add_u32 s19, s19, s20
    v_mfma_f32_16x16x32_bf16 v[180:183], v[116:119], v[92:95], v[180:183]
    ds_read_b128 v[36:39], v6 offset:1024
    v_mfma_f32_16x16x32_bf16 v[184:187], v[120:123], v[92:95], v[184:187]
    ds_read_b128 v[40:43], v6 offset:2048
    v_mfma_f32_16x16x32_bf16 v[188:191], v[124:127], v[92:95], v[188:191]
    ds_read_b128 v[44:47], v6 offset:3072
    v_mfma_f32_16x16x32_bf16 v[192:195], v[112:115], v[96:99], v[192:195]
    ds_read_b128 v[48:51], v6 offset:4096
    v_mfma_f32_16x16x32_bf16 v[196:199], v[116:119], v[96:99], v[196:199]
    ds_read_b128 v[52:55], v6 offset:5120
    v_mfma_f32_16x16x32_bf16 v[200:203], v[120:123], v[96:99], v[200:203]
    ds_read_b128 v[56:59], v6 offset:6144
    v_mfma_f32_16x16x32_bf16 v[204:207], v[124:127], v[96:99], v[204:207]
    ds_read_b128 v[60:63], v6 offset:7168
    v_mfma_f32_16x16x32_bf16 v[208:211], v[112:115], v[100:103], v[208:211]
    v_mfma_f32_16x16x32_bf16 v[212:215], v[116:119], v[100:103], v[212:215]
    v_mfma_f32_16x16x32_bf16 v[216:219], v[120:123], v[100:103], v[216:219]
    v_mfma_f32_16x16x32_bf16 v[220:223], v[124:127], v[100:103], v[220:223]
    v_mfma_f32_16x16x32_bf16 v[224:227], v[112:115], v[104:107], v[224:227]
    v_mfma_f32_16x16x32_bf16 v[228:231], v[116:119], v[104:107], v[228:231]
    v_mfma_f32_16x16x32_bf16 v[232:235], v[120:123], v[104:107], v[232:235]
    v_mfma_f32_16x16x32_bf16 v[236:239], v[124:127], v[104:107], v[236:239]
    v_mfma_f32_16x16x32_bf16 v[240:243], v[112:115], v[108:111], v[240:243]
    v_mfma_f32_16x16x32_bf16 v[244:247], v[116:119], v[108:111], v[244:247]
    v_mfma_f32_16x16x32_bf16 v[248:251], v[120:123], v[108:111], v[248:251]
    v_mfma_f32_16x16x32_bf16 v[252:255], v[124:127], v[108:111], v[252:255]
    s_waitcnt lgkmcnt(0)
    s_waitcnt vmcnt(12)
    s_barrier
    v_mfma_f32_16x16x32_bf16 v[128:131], v[64:67], v[32:35], v[128:131]
    s_add_u32 m0, s21, 65536
    s_nop 0
    buffer_load_dwordx4 v1, s[4:7], s16 offen sc1 lds
    s_add_u32 s16, s16, s62
    v_mfma_f32_16x16x32_bf16 v[132:135], v[68:71], v[32:35], v[132:135]
    ds_read_b64_tr_b16 v[112:113], v12 offset:49152
    v_mfma_f32_16x16x32_bf16 v[136:139], v[72:75], v[32:35], v[136:139]
    ds_read_b64_tr_b16 v[114:115], v13 offset:49152
    v_mfma_f32_16x16x32_bf16 v[140:143], v[76:79], v[32:35], v[140:143]
    ds_read_b64_tr_b16 v[116:117], v14 offset:49152
    v_mfma_f32_16x16x32_bf16 v[144:147], v[64:67], v[36:39], v[144:147]
    s_add_u32 m0, s21, 66560
    s_nop 0
    buffer_load_dwordx4 v1, s[4:7], s17 offen sc1 lds
    s_add_u32 s17, s17, s62
    v_mfma_f32_16x16x32_bf16 v[148:151], v[68:71], v[36:39], v[148:151]
    ds_read_b64_tr_b16 v[118:119], v15 offset:49152
    v_mfma_f32_16x16x32_bf16 v[152:155], v[72:75], v[36:39], v[152:155]
    ds_read_b64_tr_b16 v[120:121], v12 offset:57344
    v_mfma_f32_16x16x32_bf16 v[156:159], v[76:79], v[36:39], v[156:159]
    ds_read_b64_tr_b16 v[122:123], v13 offset:57344
    v_mfma_f32_16x16x32_bf16 v[160:163], v[64:67], v[40:43], v[160:163]
    s_add_u32 m0, s22, 65536
    s_nop 0
    buffer_load_dwordx4 v2, s[8:11], s18 offen lds
    s_add_u32 s18, s18, s20
    v_mfma_f32_16x16x32_bf16 v[164:167], v[68:71], v[40:43], v[164:167]
    ds_read_b64_tr_b16 v[124:125], v14 offset:57344
    v_mfma_f32_16x16x32_bf16 v[168:171], v[72:75], v[40:43], v[168:171]
    ds_read_b64_tr_b16 v[126:127], v15 offset:57344
    v_mfma_f32_16x16x32_bf16 v[172:175], v[76:79], v[40:43], v[172:175]
    ds_read_b128 v[80:83], v6 offset:32768
    v_mfma_f32_16x16x32_bf16 v[176:179], v[64:67], v[44:47], v[176:179]
    s_add_u32 m0, s22, 73728
    s_nop 0
    buffer_load_dwordx4 v2, s[12:15], s19 offen lds
    s_add_u32 s19, s19, s20
    v_mfma_f32_16x16x32_bf16 v[180:183], v[68:71], v[44:47], v[180:183]
    ds_read_b128 v[84:87], v6 offset:33792
    v_mfma_f32_16x16x32_bf16 v[184:187], v[72:75], v[44:47], v[184:187]
    ds_read_b128 v[88:91], v6 offset:34816
    v_mfma_f32_16x16x32_bf16 v[188:191], v[76:79], v[44:47], v[188:191]
    ds_read_b128 v[92:95], v6 offset:35840
    v_mfma_f32_16x16x32_bf16 v[192:195], v[64:67], v[48:51], v[192:195]
    ds_read_b128 v[96:99], v6 offset:36864
    v_mfma_f32_16x16x32_bf16 v[196:199], v[68:71], v[48:51], v[196:199]
    ds_read_b128 v[100:103], v6 offset:37888
    v_mfma_f32_16x16x32_bf16 v[200:203], v[72:75], v[48:51], v[200:203]
    ds_read_b128 v[104:107], v6 offset:38912
    v_mfma_f32_16x16x32_bf16 v[204:207], v[76:79], v[48:51], v[204:207]
    ds_read_b128 v[108:111], v6 offset:39936
    v_mfma_f32_16x16x32_bf16 v[208:211], v[64:67], v[52:55], v[208:211]
    v_mfma_f32_16x16x32_bf16 v[212:215], v[68:71], v[52:55], v[212:215]
    v_mfma_f32_16x16x32_bf16 v[216:219], v[72:75], v[52:55], v[216:219]
    v_mfma_f32_16x16x32_bf16 v[220:223], v[76:79], v[52:55], v[220:223]
    v_mfma_f32_16x16x32_bf16 v[224:227], v[64:67], v[56:59], v[224:227]
    v_mfma_f32_16x16x32_bf16 v[228:231], v[68:71], v[56:59], v[228:231]
    v_mfma_f32_16x16x32_bf16 v[232:235], v[72:75], v[56:59], v[232:235]
    v_mfma_f32_16x16x32_bf16 v[236:239], v[76:79], v[56:59], v[236:239]
    v_mfma_f32_16x16x32_bf16 v[240:243], v[64:67], v[60:63], v[240:243]
    v_mfma_f32_16x16x32_bf16 v[244:247], v[68:71], v[60:63], v[244:247]
    v_mfma_f32_16x16x32_bf16 v[248:251], v[72:75], v[60:63], v[248:251]
    v_mfma_f32_16x16x32_bf16 v[252:255], v[76:79], v[60:63], v[252:255]
    s_waitcnt lgkmcnt(0)
    s_waitcnt vmcnt(8)
    s_barrier
    s_cmp_eq_u32 s28, 0
    s_cbranch_scc1 sig_3
    s_cmp_lg_u32 s3, 0
    s_cbranch_scc1 sig_3
    s_and_b32 s57, s28, 3
    v_mov_b32 v24, s57
    s_bfe_u32 s57, s28, 0x20002
    v_mov_b32 v25, s57
    s_andn2_b32 s28, s28, 15
    s_mov_b64 exec, 1
    buffer_atomic_add_x2 v[24:25], v17, s[4:7], s28 offen sc1
    s_mov_b64 exec, -1
sig_3:
    s_mov_b32 s28, 0
    v_mfma_f32_16x16x32_bf16 v[128:131], v[112:115], v[80:83], v[128:131]
    s_add_u32 m0, s21, 98304
    s_nop 0
    buffer_load_dwordx4 v1, s[4:7], s16 offen sc1 lds
    s_add_u32 s16, s16, s62
    v_mfma_f32_16x16x32_bf16 v[132:135], v[116:119], v[80:83], v[132:135]
    ds_read_b64_tr_b16 v[64:65], v8 offset:16384
    v_mfma_f32_16x16x32_bf16 v[136:139], v[120:123], v[80:83], v[136:139]
    ds_read_b64_tr_b16 v[66:67], v9 offset:16384
    v_mfma_f32_16x16x32_bf16 v[140:143], v[124:127], v[80:83], v[140:143]
    ds_read_b64_tr_b16 v[68:69], v10 offset:16384
    v_mfma_f32_16x16x32_bf16 v[144:147], v[112:115], v[84:87], v[144:147]
    s_add_u32 m0, s21, 99328
    s_nop 0
    buffer_load_dwordx4 v1, s[4:7], s17 offen sc1 lds
    s_add_u32 s17, s17, s62
    v_mfma_f32_16x16x32_bf16 v[148:151], v[116:119], v[84:87], v[148:151]
    ds_read_b64_tr_b16 v[70:71], v11 offset:16384
    v_mfma_f32_16x16x32_bf16 v[152:155], v[120:123], v[84:87], v[152:155]
    ds_read_b64_tr_b16 v[72:73], v8 offset:24576
    v_mfma_f32_16x16x32_bf16 v[156:159], v[124:127], v[84:87], v[156:159]
    ds_read_b64_tr_b16 v[74:75], v9 offset:24576
    v_mfma_f32_16x16x32_bf16 v[160:163], v[112:115], v[88:91], v[160:163]
    s_add_u32 m0, s22, 98304
    s_nop 0
    buffer_load_dwordx4 v2, s[8:11], s18 offen lds
    s_add_u32 s18, s18, s20
    v_mfma_f32_16x16x32_bf16 v[164:167], v[116:119], v[88:91], v[164:167]
    ds_read_b64_tr_b16 v[76:77], v10 offset:24576
    v_mfma_f32_16x16x32_bf16 v[168:171], v[120:123], v[88:91], v[168:171]
    ds_read_b64_tr_b16 v[78:79], v11 offset:24576
    v_mfma_f32_16x16x32_bf16 v[172:175], v[124:127], v[88:91], v[172:175]
    ds_read_b128 v[32:35], v5 offset:0
    v_mfma_f32_16x16x32_bf16 v[176:179], v[112:115], v[92:95], v[176:179]
    s_add_u32 m0, s22, 106496
    s_nop 0
    buffer_load_dwordx4 v2, s[12:15], s19 offen lds
    s_add_u32 s19, s19, s20
    v_mfma_f32_16x16x32_bf16 v[180:183], v[116:119], v[92:95], v[180:183]
    ds_read_b128 v[36:39], v5 offset:1024
    v_mfma_f32_16x16x32_bf16 v[184:187], v[120:123], v[92:95], v[184:187]
    ds_read_b128 v[40:43], v5 offset:2048
    v_mfma_f32_16x16x32_bf16 v[188:191], v[124:127], v[92:95], v[188:191]
    ds_read_b128 v[44:47], v5 offset:3072
    v_mfma_f32_16x16x32_bf16 v[192:195], v[112:115], v[96:99], v[192:195]
    ds_read_b128 v[48:51], v5 offset:4096
    v_mfma_f32_16x16x32_bf16 v[196:199], v[116:119], v[96:99], v[196:199]
    ds_read_b128 v[52:55], v5 offset:5120
    v_mfma_f32_16x16x32_bf16 v[200:203], v[120:123], v[96:99], v[200:203]
    ds_read_b128 v[56:59], v5 offset:6144
    v_mfma_f32_16x16x32_bf16 v[204:207], v[124:127], v[96:99], v[204:207]
    ds_read_b128 v[60:63], v5 offset:7168
    v_mfma_f32_16x16x32_bf16 v[208:211], v[112:115], v[100:103], v[208:211]
    v_mfma_f32_16x16x32_bf16 v[212:215], v[116:119], v[100:103], v[212:215]
    v_mfma_f32_16x16x32_bf16 v[216:219], v[120:123], v[100:103], v[216:219]
    v_mfma_f32_16x16x32_bf16 v[220:223], v[124:127], v[100:103], v[220:223]
    v_mfma_f32_16x16x32_bf16 v[224:227], v[112:115], v[104:107], v[224:227]
    v_mfma_f32_16x16x32_bf16 v[228:231], v[116:119], v[104:107], v[228:231]
    v_mfma_f32_16x16x32_bf16 v[232:235], v[120:123], v[104:107], v[232:235]
    v_mfma_f32_16x16x32_bf16 v[236:239], v[124:127], v[104:107], v[236:239]
    v_mfma_f32_16x16x32_bf16 v[240:243], v[112:115], v[108:111], v[240:243]
    v_mfma_f32_16x16x32_bf16 v[244:247], v[116:119], v[108:111], v[244:247]
    v_mfma_f32_16x16x32_bf16 v[248:251], v[120:123], v[108:111], v[248:251]
    v_mfma_f32_16x16x32_bf16 v[252:255], v[124:127], v[108:111], v[252:255]
    s_waitcnt lgkmcnt(0)
    s_branch w_loop_chk
w_first8:
    s_waitcnt vmcnt(16)
    s_barrier
    v_mfma_f32_16x16x32_bf16 v[128:131], v[64:67], v[32:35], 0
    s_add_u32 m0, s21, 0
    s_nop 0
    buffer_load_dwordx4 v1, s[4:7], s16 offen sc1 lds
    s_add_u32 s16, s16, s62
    v_mfma_f32_16x16x32_bf16 v[132:135], v[68:71], v[32:35], 0
    ds_read_b64_tr_b16 v[112:113], v8 offset:49152
    v_mfma_f32_16x16x32_bf16 v[136:139], v[72:75], v[32:35], 0
    ds_read_b64_tr_b16 v[114:115], v9 offset:49152
    v_mfma_f32_16x16x32_bf16 v[140:143], v[76:79], v[32:35], 0
    ds_read_b64_tr_b16 v[116:117], v10 offset:49152
    v_mfma_f32_16x16x32_bf16 v[144:147], v[64:67], v[36:39], 0
    s_add_u32 m0, s21, 1024
    s_nop 0
    buffer_load_dwordx4 v1, s[4:7], s17 offen sc1 lds
    s_add_u32 s17, s17, s62
    v_mfma_f32_16x16x32_bf16 v[148:151], v[68:71], v[36:39], 0
    ds_read_b64_tr_b16 v[118:119], v11 offset:49152
    v_mfma_f32_16x16x32_bf16 v[152:155], v[72:75], v[36:39], 0
    ds_read_b64_tr_b16 v[120:121], v8 offset:57344
    v_mfma_f32_16x16x32_bf16 v[156:159], v[76:79], v[36:39], 0
    ds_read_b64_tr_b16 v[122:123], v9 offset:57344
    v_mfma_f32_16x16x32_bf16 v[160:163], v[64:67], v[40:43], 0
    s_add_u32 m0, s22, 0
    s_nop 0
    buffer_load_dwordx4 v2, s[8:11], s18 offen lds
    s_add_u32 s18, s18, s20
    v_mfma_f32_16x16x32_bf16 v[164:167], v[68:71], v[40:43], 0
    ds_read_b64_tr_b16 v[124:125], v10 offset:57344
    v_mfma_f32_16x16x32_bf16 v[168:171], v[72:75], v[40:43], 0
    ds_read_b64_tr_b16 v[126:127], v11 offset:57344
    v_mfma_f32_16x16x32_bf16 v[172:175], v[76:79], v[40:43], 0
    ds_read_b128 v[80:83], v5 offset:32768
    v_mfma_f32_16x16x32_bf16 v[176:179], v[64:67], v[44:47], 0
    s_add_u32 m0, s22, 8192
    s_nop 0
    buffer_load_dwordx4 v2, s[12:15], s19 offen lds
    s_add_u32 s19, s19, s20
    v_mfma_f32_16x16x32_bf16 v[180:183], v[68:71], v[44:47], 0
    ds_read_b128 v[84:87], v5 offset:33792
    v_mfma_f32_16x16x32_bf16 v[184:187], v[72:75], v[44:47], 0
    ds_read_b128 v[88:91], v5 offset:34816
    v_mfma_f32_16x16x32_bf16 v[188:191], v[76:79], v[44:47], 0
    ds_read_b128 v[92:95], v5 offset:35840
    v_mfma_f32_16x16x32_bf16 v[192:195], v[64:67], v[48:51], 0
    ds_read_b128 v[96:99], v5 offset:36864
    v_mfma_f32_16x16x32_bf16 v[196:199], v[68:71], v[48:51], 0
    ds_read_b128 v[100:103], v5 offset:37888
    v_mfma_f32_16x16x32_bf16 v[200:203], v[72:75], v[48:51], 0
    ds_read_b128 v[104:107], v5 offset:38912
    v_mfma_f32_16x16x32_bf16 v[204:207], v[76:79], v[48:51], 0
    ds_read_b128 v[108:111], v5 offset:39936
    v_mfma_f32_16x16x32_bf16 v[208:211], v[64:67], v[52:55], 0
    v_mfma_f32_16x16x32_bf16 v[212:215], v[68:71], v[52:55], 0
    v_mfma_f32_16x16x32_bf16 v[216:219], v[72:75], v[52:55], 0
    v_mfma_f32_16x16x32_bf16 v[220:223], v[76:79], v[52:55], 0
    v_mfma_f32_16x16x32_bf16 v[224:227], v[64:67], v[56:59], 0
    v_mfma_f32_16x16x32_bf16 v[228:231], v[68:71], v[56:59], 0
    v_mfma_f32_16x16x32_bf16 v[232:235], v[72:75], v[56:59], 0
    v_mfma_f32_16x16x32_bf16 v[236:239], v[76:79], v[56:59], 0
    v_mfma_f32_16x16x32_bf16 v[240:243], v[64:67], v[60:63], 0
    v_mfma_f32_16x16x32_bf16 v[244:247], v[68:71], v[60:63], 0
    v_mfma_f32_16x16x32_bf16 v[248:251], v[72:75], v[60:63], 0
    v_mfma_f32_16x16x32_bf16 v[252:255], v[76:79], v[60:63], 0
    s_waitcnt lgkmcnt(0)
w_first8_q1:
    s_waitcnt vmcnt(16)
    s_barrier
    v_mfma_f32_16x16x32_bf16 v[128:131], v[112:115], v[80:83], v[128:131]
    s_add_u32 m0, s21, 32768
    s_nop 0
    buffer_load_dwordx4 v1, s[4:7], s16 offen sc1 lds
    s_add_u32 s16, s16, s62
    v_mfma_f32_16x16x32_bf16 v[132:135], v[116:119], v[80:83], v[132:135]
    ds_read_b64_tr_b16 v[64:65], v12 offset:16384
    v_mfma_f32_16x16x32_bf16 v[136:139], v[120:123], v[80:83], v[136:139]
    ds_read_b64_tr_b16 v[66:67], v13 offset:16384
    v_mfma_f32_16x16x32_bf16 v[140:143], v[124:127], v[80:83], v[140:143]
    ds_read_b64_tr_b16 v[68:69], v14 offset:16384
    v_mfma_f32_16x16x32_bf16 v[144:147], v[112:115], v[84:87], v[144:147]
    s_add_u32 m0, s21, 33792
    s_nop 0
    buffer_load_dwordx4 v1, s[4:7], s17 offen sc1 lds
    s_add_u32 s17, s17, s62
    v_mfma_f32_16x16x32_bf16 v[148:151], v[116:119], v[84:87], v[148:151]
    ds_read_b64_tr_b16 v[70:71], v15 offset:16384
    v_mfma_f32_16x16x32_bf16 v[152:155], v[120:123], v[84:87], v[152:155]
    ds_read_b64_tr_b16 v[72:73], v12 offset:24576
    v_mfma_f32_16x16x32_bf16 v[156:159], v[124:127], v[84:87], v[156:159]
    ds_read_b64_tr_b16 v[74:75], v13 offset:24576
    v_mfma_f32_16x16x32_bf16 v[160:163], v[112:115], v[88:91], v[160:163]
    s_add_u32 m0, s22, 32768
    s_nop 0
    buffer_load_dwordx4 v2, s[8:11], s18 offen lds
    s_add_u32 s18, s18, s20
    v_mfma_f32_16x16x32_bf16 v[164:167], v[116:119], v[88:91], v[164:167]
    ds_read_b64_tr_b16 v[76:77], v14 offset:24576
    v_mfma_f32_16x16x32_bf16 v[168:171], v[120:123], v[88:91], v[168:171]
    ds_read_b64_tr_b16 v[78:79], v15 offset:24576
    v_mfma_f32_16x16x32_bf16 v[172:175], v[124:127], v[88:91], v[172:175]
    ds_read_b128 v[32:35], v6 offset:0
    v_mfma_f32_16x16x32_bf16 v[176:179], v[112:115], v[92:95], v[176:179]
    s_add_u32 m0, s22, 40960
    s_nop 0
    buffer_load_dwordx4 v2, s[12:15], s19 offen lds
    s_add_u32 s19, s19, s20
    v_mfma_f32_16x16x32_bf16 v[180:183], v[116:119], v[92:95], v[180:183]
    ds_read_b128 v[36:39], v6 offset:1024
    v_mfma_f32_16x16x32_bf16 v[184:187], v[120:123], v[92:95], v[184:187]
    ds_read_b128 v[40:43], v6 offset:2048
    v_mfma_f32_16x16x32_bf16 v[188:191], v[124:127], v[92:95], v[188:191]
    ds_read_b128 v[44:47], v6 offset:3072
    v_mfma_f32_16x16x32_bf16 v[192:195], v[112:115], v[96:99], v[192:195]
    ds_read_b128 v[48:51], v6 offset:4096
    v_mfma_f32_16x16x32_bf16 v[196:199], v[116:119], v[96:99], v[196:199]
    ds_read_b128 v[52:55], v6 offset:5120
    v_mfma_f32_16x16x32_bf16 v[200:203], v[120:123], v[96:99], v[200:203]
    ds_read_b128 v[56:59], v6 offset:6144
    v_mfma_f32_16x16x32_bf16 v[204:207], v[124:127], v[96:99], v[204:207]
    ds_read_b128 v[60:63], v6 offset:7168
    v_mfma_f32_16x16x32_bf16 v[208:211], v[112:115], v[100:103], v[208:211]
    v_mfma_f32_16x16x32_bf16 v[212:215], v[116:119], v[100:103], v[212:215]
    v_mfma_f32_16x16x32_bf16 v[216:219], v[120:123], v[100:103], v[216:219]
    v_mfma_f32_16x16x32_bf16 v[220:223], v[124:127], v[100:103], v[220:223]
    v_mfma_f32_16x16x32_bf16 v[224:227], v[112:115], v[104:107], v[224:227]
    v_mfma_f32_16x16x32_bf16 v[228:231], v[116:119], v[104:107], v[228:231]
    v_mfma_f32_16x16x32_bf16 v[232:235], v[120:123], v[104:107], v[232:235]
    v_mfma_f32_16x16x32_bf16 v[236:239], v[124:127], v[104:107], v[236:239]
    v_mfma_f32_16x16x32_bf16 v[240:243], v[112:115], v[108:111], v[240:243]
    v_mfma_f32_16x16x32_bf16 v[244:247], v[116:119], v[108:111], v[244:247]
    v_mfma_f32_16x16x32_bf16 v[248:251], v[120:123], v[108:111], v[248:251]
    v_mfma_f32_16x16x32_bf16 v[252:255], v[124:127], v[108:111], v[252:255]
    s_waitcnt lgkmcnt(0)
    s_waitcnt vmcnt(16)
    s_barrier
    v_mfma_f32_16x16x32_bf16 v[128:131], v[64:67], v[32:35], v[128:131]
    s_add_u32 m0, s21, 65536
    s_nop 0
    buffer_load_dwordx4 v1, s[4:7], s16 offen sc1 lds
    s_add_u32 s16, s16, s62
    v_mfma_f32_16x16x32_bf16 v[132:135], v[68:71], v[32:35], v[132:135]
    ds_read_b64_tr_b16 v[112:113], v12 offset:49152
    v_mfma_f32_16x16x32_bf16 v[136:139], v[72:75], v[32:35], v[136:139]
    ds_read_b64_tr_b16 v[114:115], v13 offset:49152
    v_mfma_f32_16x16x32_bf16 v[140:143], v[76:79], v[32:35], v[140:143]
    ds_read_b64_tr_b16 v[116:117], v14 offset:49152
    v_mfma_f32_16x16x32_bf16 v[144:147], v[64:67], v[36:39], v[144:147]
    s_add_u32 m0, s21, 66560
    s_nop 0
    buffer_load_dwordx4 v1, s[4:7], s17 offen sc1 lds
    s_add_u32 s17, s17, s62
    v_mfma_f32_16x16x32_bf16 v[148:151], v[68:71], v[36:39], v[148:151]
    ds_read_b64_tr_b16 v[118:119], v15 offset:49152
    v_mfma_f32_16x16x32_bf16 v[152:155], v[72:75], v[36:39], v[152:155]
    ds_read_b64_tr_b16 v[120:121], v12 offset:57344
    v_mfma_f32_16x16x32_bf16 v[156:159], v[76:79], v[36:39], v[156:159]
    ds_read_b64_tr_b16 v[122:123], v13 offset:57344
    v_mfma_f32_16x16x32_bf16 v[160:163], v[64:67], v[40:43], v[160:163]
    s_add_u32 m0, s22, 65536
    s_nop 0
    buffer_load_dwordx4 v2, s[8:11], s18 offen lds
    s_add_u32 s18, s18, s20
    v_mfma_f32_16x16x32_bf16 v[164:167], v[68:71], v[40:43], v[164:167]
    ds_read_b64_tr_b16 v[124:125], v14 offset:57344
    v_mfma_f32_16x16x32_bf16 v[168:171], v[72:75], v[40:43], v[168:171]
    ds_read_b64_tr_b16 v[126:127], v15 offset:57344
    v_mfma_f32_16x16x32_bf16 v[172:175], v[76:79], v[40:43], v[172:175]
    ds_read_b128 v[80:83], v6 offset:32768
    v_mfma_f32_16x16x32_bf16 v[176:179], v[64:67], v[44:47], v[176:179]
    s_add_u32 m0, s22, 73728
    s_nop 0
    buffer_load_dwordx4 v2, s[12:15], s19 offen lds
    s_add_u32 s19, s19, s20
    v_mfma_f32_16x16x32_bf16 v[180:183], v[68:71], v[44:47], v[180:183]
    ds_read_b128 v[84:87], v6 offset:33792
    v_mfma_f32_16x16x32_bf16 v[184:187], v[72:75], v[44:47], v[184:187]
    ds_read_b128 v[88:91], v6 offset:34816
    v_mfma_f32_16x16x32_bf16 v[188:191], v[76:79], v[44:47], v[188:191]
    ds_read_b128 v[92:95], v6 offset:35840
    v_mfma_f32_16x16x32_bf16 v[192:195], v[64:67], v[48:51], v[192:195]
    ds_read_b128 v[96:99], v6 offset:36864
    v_mfma_f32_16x16x32_bf16 v[196:199], v[68:71], v[48:51], v[196:199]
    ds_read_b128 v[100:103], v6 offset:37888
    v_mfma_f32_16x16x32_bf16 v[200:203], v[72:75], v[48:51], v[200:203]
    ds_read_b128 v[104:107], v6 offset:38912
    v_mfma_f32_16x16x32_bf16 v[204:207], v[76:79], v[48:51], v[204:207]
    ds_read_b128 v[108:111], v6 offset:39936
    v_mfma_f32_16x16x32_bf16 v[208:211], v[64:67], v[52:55], v[208:211]
    v_mfma_f32_16x16x32_bf16 v[212:215], v[68:71], v[52:55], v[212:215]
    v_mfma_f32_16x16x32_bf16 v[216:219], v[72:75], v[52:55], v[216:219]
    v_mfma_f32_16x16x32_bf16 v[220:223], v[76:79], v[52:55], v[220:223]
    v_mfma_f32_16x16x32_bf16 v[224:227], v[64:67], v[56:59], v[224:227]
    v_mfma_f32_16x16x32_bf16 v[228:231], v[68:71], v[56:59], v[228:231]
    v_mfma_f32_16x16x32_bf16 v[232:235], v[72:75], v[56:59], v[232:235]
    v_mfma_f32_16x16x32_bf16 v[236:239], v[76:79], v[56:59], v[236:239]
    v_mfma_f32_16x16x32_bf16 v[240:243], v[64:67], v[60:63], v[240:243]
    v_mfma_f32_16x16x32_bf16 v[244:247], v[68:71], v[60:63], v[244:247]
    v_mfma_f32_16x16x32_bf16 v[248:251], v[72:75], v[60:63], v[248:251]
    v_mfma_f32_16x16x32_bf16 v[252:255], v[76:79], v[60:63], v[252:255]
    s_waitcnt lgkmcnt(0)
    s_waitcnt vmcnt(8)
    s_barrier
    s_cmp_eq_u32 s28, 0
    s_cbranch_scc1 sig_4
    s_cmp_lg_u32 s3, 0
    s_cbranch_scc1 sig_4
    s_and_b32 s57, s28, 3
    v_mov_b32 v24, s57
    s_bfe_u32 s57, s28, 0x20002
    v_mov_b32 v25, s57
    s_andn2_b32 s28, s28, 15
    s_mov_b64 exec, 1
    buffer_atomic_add_x2 v[24:25], v17, s[4:7], s28 offen sc1
    s_mov_b64 exec, -1
sig_4:
    s_mov_b32 s28, 0
    v_mfma_f32_16x16x32_bf16 v[128:131], v[112:115], v[80:83], v[128:131]
    s_add_u32 m0, s21, 98304
    s_nop 0
    buffer_load_dwordx4 v1, s[4:7], s16 offen sc1 lds
    s_add_u32 s16, s16, s62
    v_mfma_f32_16x16x32_bf16 v[132:135], v[116:119], v[80:83], v[132:135]
    ds_read_b64_tr_b16 v[64:65], v8 offset:16384
    v_mfma_f32_16x16x32_bf16 v[136:139], v[120:123], v[80:83], v[136:139]
    ds_read_b64_tr_b16 v[66:67], v9 offset:16384
    v_mfma_f32_16x16x32_bf16 v[140:143], v[124:127], v[80:83], v[140:143]
    ds_read_b64_tr_b16 v[68:69], v10 offset:16384
    v_mfma_f32_16x16x32_bf16 v[144:147], v[112:115], v[84:87], v[144:147]
    s_add_u32 m0, s21, 99328
    s_nop 0
    buffer_load_dwordx4 v1, s[4:7], s17 offen sc1 lds
    s_add_u32 s17, s17, s62
    v_mfma_f32_16x16x32_bf16 v[148:151], v[116:119], v[84:87], v[148:151]
    ds_read_b64_tr_b16 v[70:71], v11 offset:16384
    v_mfma_f32_16x16x32_bf16 v[152:155], v[120:123], v[84:87], v[152:155]
    ds_read_b64_tr_b16 v[72:73], v8 offset:24576
    v_mfma_f32_16x16x32_bf16 v[156:159], v[124:127], v[84:87], v[156:159]
    ds_read_b64_tr_b16 v[74:75], v9 offset:24576
    v_mfma_f32_16x16x32_bf16 v[160:163], v[112:115], v[88:91], v[160:163]
    s_add_u32 m0, s22, 98304
    s_nop 0
    buffer_load_dwordx4 v2, s[8:11], s18 offen lds
    s_add_u32 s18, s18, s20
    v_mfma_f32_16x16x32_bf16 v[164:167], v[116:119], v[88:91], v[164:167]
    ds_read_b64_tr_b16 v[76:77], v10 offset:24576
    v_mfma_f32_16x16x32_bf16 v[168:171], v[120:123], v[88:91], v[168:171]
    ds_read_b64_tr_b16 v[78:79], v11 offset:24576
    v_mfma_f32_16x16x32_bf16 v[172:175], v[124:127], v[88:91], v[172:175]
    ds_read_b128 v[32:35], v5 offset:0
    v_mfma_f32_16x16x32_bf16 v[176:179], v[112:115], v[92:95], v[176:179]
    s_add_u32 m0, s22, 106496
    s_nop 0
    buffer_load_dwordx4 v2, s[12:15], s19 offen lds
    s_add_u32 s19, s19, s20
    v_mfma_f32_16x16x32_bf16 v[180:183], v[116:119], v[92:95], v[180:183]
    ds_read_b128 v[36:39], v5 offset:1024
    v_mfma_f32_16x16x32_bf16 v[184:187], v[120:123], v[92:95], v[184:187]
    ds_read_b128 v[40:43], v5 offset:2048
    v_mfma_f32_16x16x32_bf16 v[188:191], v[124:127], v[92:95], v[188:191]
    ds_read_b128 v[44:47], v5 offset:3072
    v_mfma_f32_16x16x32_bf16 v[192:195], v[112:115], v[96:99], v[192:195]
    ds_read_b128 v[48:51], v5 offset:4096
    v_mfma_f32_16x16x32_bf16 v[196:199], v[116:119], v[96:99], v[196:199]
    ds_read_b128 v[52:55], v5 offset:5120
    v_mfma_f32_16x16x32_bf16 v[200:203], v[120:123], v[96:99], v[200:203]
    ds_read_b128 v[56:59], v5 offset:6144
    v_mfma_f32_16x16x32_bf16 v[204:207], v[124:127], v[96:99], v[204:207]
    ds_read_b128 v[60:63], v5 offset:7168
    v_mfma_f32_16x16x32_bf16 v[208:211], v[112:115], v[100:103], v[208:211]
    v_mfma_f32_16x16x32_bf16 v[212:215], v[116:119], v[100:103], v[212:215]
    v_mfma_f32_16x16x32_bf16 v[216:219], v[120:123], v[100:103], v[216:219]
    v_mfma_f32_16x16x32_bf16 v[220:223], v[124:127], v[100:103], v[220:223]
    v_mfma_f32_16x16x32_bf16 v[224:227], v[112:115], v[104:107], v[224:227]
    v_mfma_f32_16x16x32_bf16 v[228:231], v[116:119], v[104:107], v[228:231]
    v_mfma_f32_16x16x32_bf16 v[232:235], v[120:123], v[104:107], v[232:235]
    v_mfma_f32_16x16x32_bf16 v[236:239], v[124:127], v[104:107], v[236:239]
    v_mfma_f32_16x16x32_bf16 v[240:243], v[112:115], v[108:111], v[240:243]
    v_mfma_f32_16x16x32_bf16 v[244:247], v[116:119], v[108:111], v[244:247]
    v_mfma_f32_16x16x32_bf16 v[248:251], v[120:123], v[108:111], v[248:251]
    v_mfma_f32_16x16x32_bf16 v[252:255], v[124:127], v[108:111], v[252:255]
    s_waitcnt lgkmcnt(0)
    s_branch w_loop_chk
w_first16:
    s_waitcnt vmcnt(24)
    s_barrier
    v_mfma_f32_16x16x32_bf16 v[128:131], v[64:67], v[32:35], 0
    s_add_u32 m0, s21, 0
    s_nop 0
    buffer_load_dwordx4 v1, s[4:7], s16 offen sc1 lds
    s_add_u32 s16, s16, s62
    v_mfma_f32_16x16x32_bf16 v[132:135], v[68:71], v[32:35], 0
    ds_read_b64_tr_b16 v[112:113], v8 offset:49152
    v_mfma_f32_16x16x32_bf16 v[136:139], v[72:75], v[32:35], 0
    ds_read_b64_tr_b16 v[114:115], v9 offset:49152
    v_mfma_f32_16x16x32_bf16 v[140:143], v[76:79], v[32:35], 0
    ds_read_b64_tr_b16 v[116:117], v10 offset:49152
    v_mfma_f32_16x16x32_bf16 v[144:147], v[64:67], v[36:39], 0
    s_add_u32 m0, s21, 1024
    s_nop 0
    buffer_load_dwordx4 v1, s[4:7], s17 offen sc1 lds
    s_add_u32 s17, s17, s62
    v_mfma_f32_16x16x32_bf16 v[148:151], v[68:71], v[36:39], 0
    ds_read_b64_tr_b16 v[118:119], v11 offset:49152
    v_mfma_f32_16x16x32_bf16 v[152:155], v[72:75], v[36:39], 0
    ds_read_b64_tr_b16 v[120:121], v8 offset:57344
    v_mfma_f32_16x16x32_bf16 v[156:159], v[76:79], v[36:39], 0
    ds_read_b64_tr_b16 v[122:123], v9 offset:57344
    v_mfma_f32_16x16x32_bf16 v[160:163], v[64:67], v[40:43], 0
    s_add_u32 m0, s22, 0
    s_nop 0
    buffer_load_dwordx4 v2, s[8:11], s18 offen lds
    s_add_u32 s18, s18, s20
    v_mfma_f32_16x16x32_bf16 v[164:167], v[68:71], v[40:43], 0
    ds_read_b64_tr_b16 v[124:125], v10 offset:57344
    v_mfma_f32_16x16x32_bf16 v[168:171], v[72:75], v[40:43], 0
    ds_read_b64_tr_b16 v[126:127], v11 offset:57344
    v_mfma_f32_16x16x32_bf16 v[172:175], v[76:79], v[40:43], 0
    ds_read_b128 v[80:83], v5 offset:32768
    v_mfma_f32_16x16x32_bf16 v[176:179], v[64:67], v[44:47], 0
    s_add_u32 m0, s22, 8192
    s_nop 0
    buffer_load_dwordx4 v2, s[12:15], s19 offen lds
    s_add_u32 s19, s19, s20
    v_mfma_f32_16x16x32_bf16 v[180:183], v[68:71], v[44:47], 0
    ds_read_b128 v[84:87], v5 offset:33792
    v_mfma_f32_16x16x32_bf16 v[184:187], v[72:75], v[44:47], 0
    ds_read_b128 v[88:91], v5 offset:34816
    v_mfma_f32_16x16x32_bf16 v[188:191], v[76:79], v[44:47], 0
    ds_read_b128 v[92:95], v5 offset:35840
    v_mfma_f32_16x16x32_bf16 v[192:195], v[64:67], v[48:51], 0
    ds_read_b128 v[96:99], v5 offset:36864
    v_mfma_f32_16x16x32_bf16 v[196:199], v[68:71], v[48:51], 0
    ds_read_b128 v[100:103], v5 offset:37888
    v_mfma_f32_16x16x32_bf16 v[200:203], v[72:75], v[48:51], 0
    ds_read_b128 v[104:107], v5 offset:38912
    v_mfma_f32_16x16x32_bf16 v[204:207], v[76:79], v[48:51], 0
    ds_read_b128 v[108:111], v5 offset:39936
    v_mfma_f32_16x16x32_bf16 v[208:211], v[64:67], v[52:55], 0
    v_mfma_f32_16x16x32_bf16 v[212:215], v[68:71], v[52:55], 0
    v_mfma_f32_16x16x32_bf16 v[216:219], v[72:75], v[52:55], 0
    v_mfma_f32_16x16x32_bf16 v[220:223], v[76:79], v[52:55], 0
    v_mfma_f32_16x16x32_bf16 v[224:227], v[64:67], v[56:59], 0
    v_mfma_f32_16x16x32_bf16 v[228:231], v[68:71], v[56:59], 0
    v_mfma_f32_16x16x32_bf16 v[232:235], v[72:75], v[56:59], 0
    v_mfma_f32_16x16x32_bf16 v[236:239], v[76:79], v[56:59], 0
    v_mfma_f32_16x16x32_bf16 v[240:243], v[64:67], v[60:63], 0
    v_mfma_f32_16x16x32_bf16 v[244:247], v[68:71], v[60:63], 0
    v_mfma_f32_16x16x32_bf16 v[248:251], v[72:75], v[60:63], 0
    v_mfma_f32_16x16x32_bf16 v[252:255], v[76:79], v[60:63], 0
    s_waitcnt lgkmcnt(0)
w_first16_q1:
    s_waitcnt vmcnt(24)
    s_barrier
    v_mfma_f32_16x16x32_bf16 v[128:131], v[112:115], v[80:83], v[128:131]
    s_add_u32 m0, s21, 32768
    s_nop 0
    buffer_load_dwordx4 v1, s[4:7], s16 offen sc1 lds
    s_add_u32 s16, s16, s62
    v_mfma_f32_16x16x32_bf16 v[132:135], v[116:119], v[80:83], v[132:135]
    ds_read_b64_tr_b16 v[64:65], v12 offset:16384
    v_mfma_f32_16x16x32_bf16 v[136:139], v[120:123], v[80:83], v[136:139]
    ds_read_b64_tr_b16 v[66:67], v13 offset:16384
    v_mfma_f32_16x16x32_bf16 v[140:143], v[124:127], v[80:83], v[140:143]
    ds_read_b64_tr_b16 v[68:69], v14 offset:16384
    v_mfma_f32_16x16x32_bf16 v[144:147], v[112:115], v[84:87], v[144:147]
    s_add_u32 m0, s21, 33792
    s_nop 0
    buffer_load_dwordx4 v1, s[4:7], s17 offen sc1 lds
    s_add_u32 s17, s17, s62
    v_mfma_f32_16x16x32_bf16 v[148:151], v[116:119], v[84:87], v[148:151]
    ds_read_b64_tr_b16 v[70:71], v15 offset:16384
    v_mfma_f32_16x16x32_bf16 v[152:155], v[120:123], v[84:87], v[152:155]
    ds_read_b64_tr_b16 v[72:73], v12 offset:24576
    v_mfma_f32_16x16x32_bf16 v[156:159], v[124:127], v[84:87], v[156:159]
    ds_read_b64_tr_b16 v[74:75], v13 offset:24576
    v_mfma_f32_16x16x32_bf16 v[160:163], v[112:115], v[88:91], v[160:163]
    s_add_u32 m0, s22, 32768
    s_nop 0
    buffer_load_dwordx4 v2, s[8:11], s18 offen lds
    s_add_u32 s18, s18, s20
    v_mfma_f32_16x16x32_bf16 v[164:167], v[116:119], v[88:91], v[164:167]
    ds_read_b64_tr_b16 v[76:77], v14 offset:24576
    v_mfma_f32_16x16x32_bf16 v[168:171], v[120:123], v[88:91], v[168:171]
    ds_read_b64_tr_b16 v[78:79], v15 offset:24576
    v_mfma_f32_16x16x32_bf16 v[172:175], v[124:127], v[88:91], v[172:175]
    ds_read_b128 v[32:35], v6 offset:0
    v_mfma_f32_16x16x32_bf16 v[176:179], v[112:115], v[92:95], v[176:179]
    s_add_u32 m0, s22, 40960
    s_nop 0
    buffer_load_dwordx4 v2, s[12:15], s19 offen lds
    s_add_u32 s19, s19, s20
    v_mfma_f32_16x16x32_bf16 v[180:183], v[116:119], v[92:95], v[180:183]
    ds_read_b128 v[36:39], v6 offset:1024
    v_mfma_f32_16x16x32_bf16 v[184:187], v[120:123], v[92:95], v[184:187]
    ds_read_b128 v[40:43], v6 offset:2048
    v_mfma_f32_16x16x32_bf16 v[188:191], v[124:127], v[92:95], v[188:191]
    ds_read_b128 v[44:47], v6 offset:3072
    v_mfma_f32_16x16x32_bf16 v[192:195], v[112:115], v[96:99], v[192:195]
    ds_read_b128 v[48:51], v6 offset:4096
    v_mfma_f32_16x16x32_bf16 v[196:199], v[116:119], v[96:99], v[196:199]
    ds_read_b128 v[52:55], v6 offset:5120
    v_mfma_f32_16x16x32_bf16 v[200:203], v[120:123], v[96:99], v[200:203]
    ds_read_b128 v[56:59], v6 offset:6144
    v_mfma_f32_16x16x32_bf16 v[204:207], v[124:127], v[96:99], v[204:207]
    ds_read_b128 v[60:63], v6 offset:7168
    v_mfma_f32_16x16x32_bf16 v[208:211], v[112:115], v[100:103], v[208:211]
    v_mfma_f32_16x16x32_bf16 v[212:215], v[116:119], v[100:103], v[212:215]
    v_mfma_f32_16x16x32_bf16 v[216:219], v[120:123], v[100:103], v[216:219]
    v_mfma_f32_16x16x32_bf16 v[220:223], v[124:127], v[100:103], v[220:223]
    v_mfma_f32_16x16x32_bf16 v[224:227], v[112:115], v[104:107], v[224:227]
    v_mfma_f32_16x16x32_bf16 v[228:231], v[116:119], v[104:107], v[228:231]
    v_mfma_f32_16x16x32_bf16 v[232:235], v[120:123], v[104:107], v[232:235]
    v_mfma_f32_16x16x32_bf16 v[236:239], v[124:127], v[104:107], v[236:239]
    v_mfma_f32_16x16x32_bf16 v[240:243], v[112:115], v[108:111], v[240:243]
    v_mfma_f32_16x16x32_bf16 v[244:247], v[116:119], v[108:111], v[244:247]
    v_mfma_f32_16x16x32_bf16 v[248:251], v[120:123], v[108:111], v[248:251]
    v_mfma_f32_16x16x32_bf16 v[252:255], v[124:127], v[108:111], v[252:255]
    s_waitcnt lgkmcnt(0)
    s_waitcnt vmcnt(24)
    s_barrier
    v_mfma_f32_16x16x32_bf16 v[128:131], v[64:67], v[32:35], v[128:131]
    s_add_u32 m0, s21, 65536
    s_nop 0
    buffer_load_dwordx4 v1, s[4:7], s16 offen sc1 lds
    s_add_u32 s16, s16, s62
    v_mfma_f32_16x16x32_bf16 v[132:135], v[68:71], v[32:35], v[132:135]
    ds_read_b64_tr_b16 v[112:113], v12 offset:49152
    v_mfma_f32_16x16x32_bf16 v[136:139], v[72:75], v[32:35], v[136:139]
    ds_read_b64_tr_b16 v[114:115], v13 offset:49152
    v_mfma_f32_16x16x32_bf16 v[140:143], v[76:79], v[32:35], v[140:143]
    ds_read_b64_tr_b16 v[116:117], v14 offset:49152
    v_mfma_f32_16x16x32_bf16 v[144:147], v[64:67], v[36:39], v[144:147]
    s_add_u32 m0, s21, 66560
    s_nop 0
    buffer_load_dwordx4 v1, s[4:7], s17 offen sc1 lds
    s_add_u32 s17, s17, s62
    v_mfma_f32_16x16x32_bf16 v[148:151], v[68:71], v[36:39], v[148:151]
    ds_read_b64_tr_b16 v[118:119], v15 offset:49152
    v_mfma_f32_16x16x32_bf16 v[152:155], v[72:75], v[36:39], v[152:155]
    ds_read_b64_tr_b16 v[120:121], v12 offset:57344
    v_mfma_f32_16x16x32_bf16 v[156:159], v[76:79], v[36:39], v[156:159]
    ds_read_b64_tr_b16 v[122:123], v13 offset:57344
    v_mfma_f32_16x16x32_bf16 v[160:163], v[64:67], v[40:43], v[160:163]
    s_add_u32 m0, s22, 65536
    s_nop 0
    buffer_load_dwordx4 v2, s[8:11], s18 offen lds
    s_add_u32 s18, s18, s20
    v_mfma_f32_16x16x32_bf16 v[164:167], v[68:71], v[40:43], v[164:167]
    ds_read_b64_tr_b16 v[124:125], v14 offset:57344
    v_mfma_f32_16x16x32_bf16 v[168:171], v[72:75], v[40:43], v[168:171]
    ds_read_b64_tr_b16 v[126:127], v15 offset:57344
    v_mfma_f32_16x16x32_bf16 v[172:175], v[76:79], v[40:43], v[172:175]
    ds_read_b128 v[80:83], v6 offset:32768
    v_mfma_f32_16x16x32_bf16 v[176:179], v[64:67], v[44:47], v[176:179]
    s_add_u32 m0, s22, 73728
    s_nop 0
    buffer_load_dwordx4 v2, s[12:15], s19 offen lds
    s_add_u32 s19, s19, s20
    v_mfma_f32_16x16x32_bf16 v[180:183], v[68:71], v[44:47], v[180:183]
    ds_read_b128 v[84:87], v6 offset:33792
    v_mfma_f32_16x16x32_bf16 v[184:187], v[72:75], v[44:47], v[184:187]
    ds_read_b128 v[88:91], v6 offset:34816
    v_mfma_f32_16x16x32_bf16 v[188:191], v[76:79], v[44:47], v[188:191]
    ds_read_b128 v[92:95], v6 offset:35840
    v_mfma_f32_16x16x32_bf16 v[192:195], v[64:67], v[48:51], v[192:195]
    ds_read_b128 v[96:99], v6 offset:36864
    v_mfma_f32_16x16x32_bf16 v[196:199], v[68:71], v[48:51], v[196:199]
    ds_read_b128 v[100:103], v6 offset:37888
    v_mfma_f32_16x16x32_bf16 v[200:203], v[72:75], v[48:51], v[200:203]
    ds_read_b128 v[104:107], v6 offset:38912
    v_mfma_f32_16x16x32_bf16 v[204:207], v[76:79], v[48:51], v[204:207]
    ds_read_b128 v[108:111], v6 offset:39936
    v_mfma_f32_16x16x32_bf16 v[208:211], v[64:67], v[52:55], v[208:211]
    v_mfma_f32_16x16x32_bf16 v[212:215], v[68:71], v[52:55], v[212:215]
    v_mfma_f32_16x16x32_bf16 v[216:219], v[72:75], v[52:55], v[216:219]
    v_mfma_f32_16x16x32_bf16 v[220:223], v[76:79], v[52:55], v[220:223]
    v_mfma_f32_16x16x32_bf16 v[224:227], v[64:67], v[56:59], v[224:227]
    v_mfma_f32_16x16x32_bf16 v[228:231], v[68:71], v[56:59], v[228:231]
    v_mfma_f32_16x16x32_bf16 v[232:235], v[72:75], v[56:59], v[232:235]
    v_mfma_f32_16x16x32_bf16 v[236:239], v[76:79], v[56:59], v[236:239]
    v_mfma_f32_16x16x32_bf16 v[240:243], v[64:67], v[60:63], v[240:243]
    v_mfma_f32_16x16x32_bf16 v[244:247], v[68:71], v[60:63], v[244:247]
    v_mfma_f32_16x16x32_bf16 v[248:251], v[72:75], v[60:63], v[248:251]
    v_mfma_f32_16x16x32_bf16 v[252:255], v[76:79], v[60:63], v[252:255]
    s_waitcnt lgkmcnt(0)
    s_waitcnt vmcnt(8)
    s_barrier
    s_cmp_eq_u32 s28, 0
    s_cbranch_scc1 sig_5
    s_cmp_lg_u32 s3, 0
    s_cbranch_scc1 sig_5
    s_and_b32 s57, s28, 3
    v_mov_b32 v24, s57
    s_bfe_u32 s57, s28, 0x20002
    v_mov_b32 v25, s57
    s_andn2_b32 s28, s28, 15
    s_mov_b64 exec, 1
    buffer_atomic_add_x2 v[24:25], v17, s[4:7], s28 offen sc1
    s_mov_b64 exec, -1
sig_5:
    s_mov_b32 s28, 0
    v_mfma_f32_16x16x32_bf16 v[128:131], v[112:115], v[80:83], v[128:131]
    s_add_u32 m0, s21, 98304
    s_nop 0
    buffer_load_dwordx4 v1, s[4:7], s16 offen sc1 lds
    s_add_u32 s16, s16, s62
    v_mfma_f32_16x16x32_bf16 v[132:135], v[116:119], v[80:83], v[132:135]
    ds_read_b64_tr_b16 v[64:65], v8 offset:16384
    v_mfma_f32_16x16x32_bf16 v[136:139], v[120:123], v[80:83], v[136:139]
    ds_read_b64_tr_b16 v[66:67], v9 offset:16384
    v_mfma_f32_16x16x32_bf16 v[140:143], v[124:127], v[80:83], v[140:143]
    ds_read_b64_tr_b16 v[68:69], v10 offset:16384
    v_mfma_f32_16x16x32_bf16 v[144:147], v[112:115], v[84:87], v[144:147]
    s_add_u32 m0, s21, 99328
    s_nop 0
    buffer_load_dwordx4 v1, s[4:7], s17 offen sc1 lds
    s_add_u32 s17, s17, s62
    v_mfma_f32_16x16x32_bf16 v[148:151], v[116:119], v[84:87], v[148:151]
    ds_read_b64_tr_b16 v[70:71], v11 offset:16384
    v_mfma_f32_16x16x32_bf16 v[152:155], v[120:123], v[84:87], v[152:155]
    ds_read_b64_tr_b16 v[72:73], v8 offset:24576
    v_mfma_f32_16x16x32_bf16 v[156:159], v[124:127], v[84:87], v[156:159]
    ds_read_b64_tr_b16 v[74:75], v9 offset:24576
    v_mfma_f32_16x16x32_bf16 v[160:163], v[112:115], v[88:91], v[160:163]
    s_add_u32 m0, s22, 98304
    s_nop 0
    buffer_load_dwordx4 v2, s[8:11], s18 offen lds
    s_add_u32 s18, s18, s20
    v_mfma_f32_16x16x32_bf16 v[164:167], v[116:119], v[88:91], v[164:167]
    ds_read_b64_tr_b16 v[76:77], v10 offset:24576
    v_mfma_f32_16x16x32_bf16 v[168:171], v[120:123], v[88:91], v[168:171]
    ds_read_b64_tr_b16 v[78:79], v11 offset:24576
    v_mfma_f32_16x16x32_bf16 v[172:175], v[124:127], v[88:91], v[172:175]
    ds_read_b128 v[32:35], v5 offset:0
    v_mfma_f32_16x16x32_bf16 v[176:179], v[112:115], v[92:95], v[176:179]
    s_add_u32 m0, s22, 106496
    s_nop 0
    buffer_load_dwordx4 v2, s[12:15], s19 offen lds
    s_add_u32 s19, s19, s20
    v_mfma_f32_16x16x32_bf16 v[180:183], v[116:119], v[92:95], v[180:183]
    ds_read_b128 v[36:39], v5 offset:1024
    v_mfma_f32_16x16x32_bf16 v[184:187], v[120:123], v[92:95], v[184:187]
    ds_read_b128 v[40:43], v5 offset:2048
    v_mfma_f32_16x16x32_bf16 v[188:191], v[124:127], v[92:95], v[188:191]
    ds_read_b128 v[44:47], v5 offset:3072
    v_mfma_f32_16x16x32_bf16 v[192:195], v[112:115], v[96:99], v[192:195]
    ds_read_b128 v[48:51], v5 offset:4096
    v_mfma_f32_16x16x32_bf16 v[196:199], v[116:119], v[96:99], v[196:199]
    ds_read_b128 v[52:55], v5 offset:5120
    v_mfma_f32_16x16x32_bf16 v[200:203], v[120:123], v[96:99], v[200:203]
    ds_read_b128 v[56:59], v5 offset:6144
    v_mfma_f32_16x16x32_bf16 v[204:207], v[124:127], v[96:99], v[204:207]
    ds_read_b128 v[60:63], v5 offset:7168
    v_mfma_f32_16x16x32_bf16 v[208:211], v[112:115], v[100:103], v[208:211]
    v_mfma_f32_16x16x32_bf16 v[212:215], v[116:119], v[100:103], v[212:215]
    v_mfma_f32_16x16x32_bf16 v[216:219], v[120:123], v[100:103], v[216:219]
    v_mfma_f32_16x16x32_bf16 v[220:223], v[124:127], v[100:103], v[220:223]
    v_mfma_f32_16x16x32_bf16 v[224:227], v[112:115], v[104:107], v[224:227]
    v_mfma_f32_16x16x32_bf16 v[228:231], v[116:119], v[104:107], v[228:231]
    v_mfma_f32_16x16x32_bf16 v[232:235], v[120:123], v[104:107], v[232:235]
    v_mfma_f32_16x16x32_bf16 v[236:239], v[124:127], v[104:107], v[236:239]
    v_mfma_f32_16x16x32_bf16 v[240:243], v[112:115], v[108:111], v[240:243]
    v_mfma_f32_16x16x32_bf16 v[244:247], v[116:119], v[108:111], v[244:247]
    v_mfma_f32_16x16x32_bf16 v[248:251], v[120:123], v[108:111], v[248:251]
    v_mfma_f32_16x16x32_bf16 v[252:255], v[124:127], v[108:111], v[252:255]
    s_waitcnt lgkmcnt(0)
w_loop_chk:
    s_sub_u32 s23, s23, 1
w_loop:
    s_cmp_gt_u32 s23, 3
    s_cbranch_scc1 w_body
    s_cmp_lg_u32 s23, 3
    s_cbranch_scc1 w_l2
    s_cmp_lg_u32 s3, 0
    s_cbranch_scc1 clm_6
    v_mov_b32 v26, 1
    s_mov_b64 exec, 1
    buffer_atomic_add v26, off, s[64:67], s71 sc0 sc1
    s_mov_b64 exec, -1
clm_6:
    s_branch w_body
w_l2:
    s_cmp_lg_u32 s23, 2
    s_cbranch_scc1 w_l1
    s_cmp_lg_u32 s3, 0
    s_cbranch_scc1 pub_7
    v_mov_b32 v20, 131136
    s_mov_b64 exec, 1
    ds_write_b32 v20, v26
    s_mov_b64 exec, -1
    s_waitcnt lgkmcnt(0)
pub_7:
    s_branch w_body
w_l1:
    s_waitcnt vmcnt(8)
    v_readfirstlane_b32 s30, v16
    s_cmp_ge_u32 s30, s45
    s_cselect_b32 s30, 0, 1
    s_cmp_lg_u32 s3, 0
    s_cselect_b32 s30, 0, s30
    s_or_b32 s30, s30, s70
    s_cmp_eq_u32 s32, 4
    s_cselect_b32 s30, 1, s30
    s_sub_u32 s57, s32, 1
    s_cmp_ge_u32 s57, 4
    s_cselect_b32 s30, 1, s30
    v_mov_b32 v20, s30
    ds_write_b32 v7, v20
    s_cbranch_scc1 w_body
    s_load_dwordx2 s[8:9], s[0:1], s33
    s_load_dwordx2 s[12:13], s[0:1], s34
    s_mov_b32 s10, s38
    s_mov_b32 s14, s38
    s_cmp_eq_u32 s32, 4
    s_cselect_b32 s31, 0, 1
    s_lshl_b32 s30, s3, s31
    s_mul_i32 s30, s30, s40
    s_add_u32 s16, s39, s30
    s_cmp_eq_u32 s32, 4
    s_cselect_b32 s30, 1024, s40
    s_cselect_b32 s31, 6, 5
    s_lshl_b32 s62, 32, s31
    s_add_u32 s17, s16, s30
    s_lshl_b32 s30, s3, 2
    s_mul_i32 s30, s30, s35
    s_add_u32 s18, s36, s30
    s_add_u32 s19, s37, s30
    s_lshl_b32 s20, s35, s31
    v_mul_u32_u24 v2, s35, v4
    v_add_u32 v2, v2, v3
    s_waitcnt lgkmcnt(0)
w_body:
    s_waitcnt vmcnt(8)
    s_barrier
    s_cmp_lg_u32 s23, 2
    s_cbranch_scc1 w_nf
    v_mov_b32 v20, 131136
    ds_read_b32 v20, v20
    s_waitcnt lgkmcnt(0)
    v_readfirstlane_b32 s59, v20
    s_add_u32 s59, s59, 32
    s_min_u32 s59, s59, 322
    s_lshl_b32 s57, s59, 6
    s_load_dwordx16 s[32:47], s[24:25], s57
w_nf:
    v_mfma_f32_16x16x32_bf16 v[128:131], v[64:67], v[32:35], v[128:131]
    s_add_u32 m0, s21, 0
    s_nop 0
    buffer_load_dwordx4 v1, s[4:7], s16 offen sc1 lds
    s_add_u32 s16, s16, s62
    v_mfma_f32_16x16x32_bf16 v[132:135], v[68:71], v[32:35], v[132:135]
    ds_read_b64_tr_b16 v[112:113], v8 offset:49152
    v_mfma_f32_16x16x32_bf16 v[136:139], v[72:75], v[32:35], v[136:139]
    ds_read_b64_tr_b16 v[114:115], v9 offset:49152
    v_mfma_f32_16x16x32_bf16 v[140:143], v[76:79], v[32:35], v[140:143]
    ds_read_b64_tr_b16 v[116:117], v10 offset:49152
    v_mfma_f32_16x16x32_bf16 v[144:147], v[64:67], v[36:39], v[144:147]
    s_add_u32 m0, s21, 1024
    s_nop 0
    buffer_load_dwordx4 v1, s[4:7], s17 offen sc1 lds
    s_add_u32 s17, s17, s62
    v_mfma_f32_16x16x32_bf16 v[148:151], v[68:71], v[36:39], v[148:151]
    ds_read_b64_tr_b16 v[118:119], v11 offset:49152
    v_mfma_f32_16x16x32_bf16 v[152:155], v[72:75], v[36:39], v[152:155]
    ds_read_b64_tr_b16 v[120:121], v8 offset:57344
    v_mfma_f32_16x16x32_bf16 v[156:159], v[76:79], v[36:39], v[156:159]
    ds_read_b64_tr_b16 v[122:123], v9 offset:57344
    v_mfma_f32_16x16x32_bf16 v[160:163], v[64:67], v[40:43], v[160:163]
    s_add_u32 m0, s22, 0
    s_nop 0
    buffer_load_dwordx4 v2, s[8:11], s18 offen lds
    s_add_u32 s18, s18, s20
    v_mfma_f32_16x16x32_bf16 v[164:167], v[68:71], v[40:43], v[164:167]
    ds_read_b64_tr_b16 v[124:125], v10 offset:57344
    v_mfma_f32_16x16x32_bf16 v[168:171], v[72:75], v[40:43], v[168:171]
    ds_read_b64_tr_b16 v[126:127], v11 offset:57344
    v_mfma_f32_16x16x32_bf16 v[172:175], v[76:79], v[40:43], v[172:175]
    ds_read_b128 v[80:83], v5 offset:32768
    v_mfma_f32_16x16x32_bf16 v[176:179], v[64:67], v[44:47], v[176:179]
    s_add_u32 m0, s22, 8192
    s_nop 0
    buffer_load_dwordx4 v2, s[12:15], s19 offen lds
    s_add_u32 s19, s19, s20
    v_mfma_f32_16x16x32_bf16 v[180:183], v[68:71], v[44:47], v[180:183]
    ds_read_b128 v[84:87], v5 offset:33792
    v_mfma_f32_16x16x32_bf16 v[184:187], v[72:75], v[44:47], v[184:187]
    ds_read_b128 v[88:91], v5 offset:34816
    v_mfma_f32_16x16x32_bf16 v[188:191], v[76:79], v[44:47], v[188:191]
    ds_read_b128 v[92:95], v5 offset:35840
    v_mfma_f32_16x16x32_bf16 v[192:195], v[64:67], v[48:51], v[192:195]
    ds_read_b128 v[96:99], v5 offset:36864
    v_mfma_f32_16x16x32_bf16 v[196:199], v[68:71], v[48:51], v[196:199]
    ds_read_b128 v[100:103], v5 offset:37888
    v_mfma_f32_16x16x32_bf16 v[200:203], v[72:75], v[48:51], v[200:203]
    ds_read_b128 v[104:107], v5 offset:38912
    v_mfma_f32_16x16x32_bf16 v[204:207], v[76:79], v[48:51], v[204:207]
    ds_read_b128 v[108:111], v5 offset:39936
    v_mfma_f32_16x16x32_bf16 v[208:211], v[64:67], v[52:55], v[208:211]
    v_mfma_f32_16x16x32_bf16 v[212:215], v[68:71], v[52:55], v[212:215]
    v_mfma_f32_16x16x32_bf16 v[216:219], v[72:75], v[52:55], v[216:219]
    v_mfma_f32_16x16x32_bf16 v[220:223], v[76:79], v[52:55], v[220:223]
    v_mfma_f32_16x16x32_bf16 v[224:227], v[64:67], v[56:59], v[224:227]
    v_mfma_f32_16x16x32_bf16 v[228:231], v[68:71], v[56:59], v[228:231]
    v_mfma_f32_16x16x32_bf16 v[232:235], v[72:75], v[56:59], v[232:235]
    v_mfma_f32_16x16x32_bf16 v[236:239], v[76:79], v[56:59], v[236:239]
    v_mfma_f32_16x16x32_bf16 v[240:243], v[64:67], v[60:63], v[240:243]
    v_mfma_f32_16x16x32_bf16 v[244:247], v[68:71], v[60:63], v[244:247]
    v_mfma_f32_16x16x32_bf16 v[248:251], v[72:75], v[60:63], v[248:251]
    v_mfma_f32_16x16x32_bf16 v[252:255], v[76:79], v[60:63], v[252:255]
    s_waitcnt lgkmcnt(0)
    s_waitcnt vmcnt(8)
    s_barrier
    s_lshl_b32 s57, s3, 8
    s_or_b32 s57, s57, s23
    s_cmp_lg_u32 s57, 2
    s_cbranch_scc1 np_8
    buffer_load_dword v16, v17, s[4:7], s44 offen sc1
np_8:
    v_mfma_f32_16x16x32_bf16 v[128:131], v[112:115], v[80:83], v[128:131]
    s_add_u32 m0, s21, 32768
    s_nop 0
    buffer_load_dwordx4 v1, s[4:7], s16 offen sc1 lds
    s_add_u32 s16, s16, s62
    v_mfma_f32_16x16x32_bf16 v[132:135], v[116:119], v[80:83], v[132:135]
    ds_read_b64_tr_b16 v[64:65], v12 offset:16384
    v_mfma_f32_16x16x32_bf16 v[136:139], v[120:123], v[80:83], v[136:139]
    ds_read_b64_tr_b16 v[66:67], v13 offset:16384
    v_mfma_f32_16x16x32_bf16 v[140:143], v[124:127], v[80:83], v[140:143]
    ds_read_b64_tr_b16 v[68:69], v14 offset:16384
    v_mfma_f32_16x16x32_bf16 v[144:147], v[112:115], v[84:87], v[144:147]
    s_add_u32 m0, s21, 33792
    s_nop 0
    buffer_load_dwordx4 v1, s[4:7], s17 offen sc1 lds
    s_add_u32 s17, s17, s62
    v_mfma_f32_16x16x32_bf16 v[148:151], v[116:119], v[84:87], v[148:151]
    ds_read_b64_tr_b16 v[70:71], v15 offset:16384
    v_mfma_f32_16x16x32_bf16 v[152:155], v[120:123], v[84:87], v[152:155]
    ds_read_b64_tr_b16 v[72:73], v12 offset:24576
    v_mfma_f32_16x16x32_bf16 v[156:159], v[124:127], v[84:87], v[156:159]
    ds_read_b64_tr_b16 v[74:75], v13 offset:24576
    v_mfma_f32_16x16x32_bf16 v[160:163], v[112:115], v[88:91], v[160:163]
    s_add_u32 m0, s22, 32768
    s_nop 0
    buffer_load_dwordx4 v2, s[8:11], s18 offen lds
    s_add_u32 s18, s18, s20
    v_mfma_f32_16x16x32_bf16 v[164:167], v[116:119], v[88:91], v[164:167]
    ds_read_b64_tr_b16 v[76:77], v14 offset:24576
    v_mfma_f32_16x16x32_bf16 v[168:171], v[120:123], v[88:91], v[168:171]
    ds_read_b64_tr_b16 v[78:79], v15 offset:24576
    v_mfma_f32_16x16x32_bf16 v[172:175], v[124:127], v[88:91], v[172:175]
    ds_read_b128 v[32:35], v6 offset:0
    v_mfma_f32_16x16x32_bf16 v[176:179], v[112:115], v[92:95], v[176:179]
    s_add_u32 m0, s22, 40960
    s_nop 0
    buffer_load_dwordx4 v2, s[12:15], s19 offen lds
    s_add_u32 s19, s19, s20
    v_mfma_f32_16x16x32_bf16 v[180:183], v[116:119], v[92:95], v[180:183]
    ds_read_b128 v[36:39], v6 offset:1024
    v_mfma_f32_16x16x32_bf16 v[184:187], v[120:123], v[92:95], v[184:187]
    ds_read_b128 v[40:43], v6 offset:2048
    v_mfma_f32_16x16x32_bf16 v[188:191], v[124:127], v[92:95], v[188:191]
    ds_read_b128 v[44:47], v6 offset:3072
    v_mfma_f32_16x16x32_bf16 v[192:195], v[112:115], v[96:99], v[192:195]
    ds_read_b128 v[48:51], v6 offset:4096
    v_mfma_f32_16x16x32_bf16 v[196:199], v[116:119], v[96:99], v[196:199]
    ds_read_b128 v[52:55], v6 offset:5120
    v_mfma_f32_16x16x32_bf16 v[200:203], v[120:123], v[96:99], v[200:203]
    ds_read_b128 v[56:59], v6 offset:6144
    v_mfma_f32_16x16x32_bf16 v[204:207], v[124:127], v[96:99], v[204:207]
    ds_read_b128 v[60:63], v6 offset:7168
    v_mfma_f32_16x16x32_bf16 v[208:211], v[112:115], v[100:103], v[208:211]
    v_mfma_f32_16x16x32_bf16 v[212:215], v[116:119], v[100:103], v[212:215]
    v_mfma_f32_16x16x32_bf16 v[216:219], v[120:123], v[100:103], v[216:219]
    v_mfma_f32_16x16x32_bf16 v[220:223], v[124:127], v[100:103], v[220:223]
    v_mfma_f32_16x16x32_bf16 v[224:227], v[112:115], v[104:107], v[224:227]
    v_mfma_f32_16x16x32_bf16 v[228:231], v[116:119], v[104:107], v[228:231]
    v_mfma_f32_16x16x32_bf16 v[232:235], v[120:123], v[104:107], v[232:235]
    v_mfma_f32_16x16x32_bf16 v[236:239], v[124:127], v[104:107], v[236:239]
    v_mfma_f32_16x16x32_bf16 v[240:243], v[112:115], v[108:111], v[240:243]
    v_mfma_f32_16x16x32_bf16 v[244:247], v[116:119], v[108:111], v[244:247]
    v_mfma_f32_16x16x32_bf16 v[248:251], v[120:123], v[108:111], v[248:251]
    v_mfma_f32_16x16x32_bf16 v[252:255], v[124:127], v[108:111], v[252:255]
    s_waitcnt lgkmcnt(0)
    s_waitcnt vmcnt(8)
    s_barrier
    v_mfma_f32_16x16x32_bf16 v[128:131], v[64:67], v[32:35], v[128:131]
    s_add_u32 m0, s21, 65536
    s_nop 0
    buffer_load_dwordx4 v1, s[4:7], s16 offen sc1 lds
    s_add_u32 s16, s16, s62
    v_mfma_f32_16x16x32_bf16 v[132:135], v[68:71], v[32:35], v[132:135]
    ds_read_b64_tr_b16 v[112:113], v12 offset:49152
    v_mfma_f32_16x16x32_bf16 v[136:139], v[72:75], v[32:35], v[136:139]
    ds_read_b64_tr_b16 v[114:115], v13 offset:49152
    v_mfma_f32_16x16x32_bf16 v[140:143], v[76:79], v[32:35], v[140:143]
    ds_read_b64_tr_b16 v[116:117], v14 offset:49152
    v_mfma_f32_16x16x32_bf16 v[144:147], v[64:67], v[36:39], v[144:147]
    s_add_u32 m0, s21, 66560
    s_nop 0
    buffer_load_dwordx4 v1, s[4:7], s17 offen sc1 lds
    s_add_u32 s17, s17, s62
    v_mfma_f32_16x16x32_bf16 v[148:151], v[68:71], v[36:39], v[148:151]
    ds_read_b64_tr_b16 v[118:119], v15 offset:49152
    v_mfma_f32_16x16x32_bf16 v[152:155], v[72:75], v[36:39], v[152:155]
    ds_read_b64_tr_b16 v[120:121], v12 offset:57344
    v_mfma_f32_16x16x32_bf16 v[156:159], v[76:79], v[36:39], v[156:159]
    ds_read_b64_tr_b16 v[122:123], v13 offset:57344
    v_mfma_f32_16x16x32_bf16 v[160:163], v[64:67], v[40:43], v[160:163]
    s_add_u32 m0, s22, 65536
    s_nop 0
    buffer_load_dwordx4 v2, s[8:11], s18 offen lds
    s_add_u32 s18, s18, s20
    v_mfma_f32_16x16x32_bf16 v[164:167], v[68:71], v[40:43], v[164:167]
    ds_read_b64_tr_b16 v[124:125], v14 offset:57344
    v_mfma_f32_16x16x32_bf16 v[168:171], v[72:75], v[40:43], v[168:171]
    ds_read_b64_tr_b16 v[126:127], v15 offset:57344
    v_mfma_f32_16x16x32_bf16 v[172:175], v[76:79], v[40:43], v[172:175]
    ds_read_b128 v[80:83], v6 offset:32768
    v_mfma_f32_16x16x32_bf16 v[176:179], v[64:67], v[44:47], v[176:179]
    s_add_u32 m0, s22, 73728
    s_nop 0
    buffer_load_dwordx4 v2, s[12:15], s19 offen lds
    s_add_u32 s19, s19, s20
    v_mfma_f32_16x16x32_bf16 v[180:183], v[68:71], v[44:47], v[180:183]
    ds_read_b128 v[84:87], v6 offset:33792
    v_mfma_f32_16x16x32_bf16 v[184:187], v[72:75], v[44:47], v[184:187]
    ds_read_b128 v[88:91], v6 offset:34816
    v_mfma_f32_16x16x32_bf16 v[188:191], v[76:79], v[44:47], v[188:191]
    ds_read_b128 v[92:95], v6 offset:35840
    v_mfma_f32_16x16x32_bf16 v[192:195], v[64:67], v[48:51], v[192:195]
    ds_read_b128 v[96:99], v6 offset:36864
    v_mfma_f32_16x16x32_bf16 v[196:199], v[68:71], v[48:51], v[196:199]
    ds_read_b128 v[100:103], v6 offset:37888
    v_mfma_f32_16x16x32_bf16 v[200:203], v[72:75], v[48:51], v[200:203]
    ds_read_b128 v[104:107], v6 offset:38912
    v_mfma_f32_16x16x32_bf16 v[204:207], v[76:79], v[48:51], v[204:207]
    ds_read_b128 v[108:111], v6 offset:39936
    v_mfma_f32_16x16x32_bf16 v[208:211], v[64:67], v[52:55], v[208:211]
    v_mfma_f32_16x16x32_bf16 v[212:215], v[68:71], v[52:55], v[212:215]
    v_mfma_f32_16x16x32_bf16 v[216:219], v[72:75], v[52:55], v[216:219]
    v_mfma_f32_16x16x32_bf16 v[220:223], v[76:79], v[52:55], v[220:223]
    v_mfma_f32_16x16x32_bf16 v[224:227], v[64:67], v[56:59], v[224:227]
    v_mfma_f32_16x16x32_bf16 v[228:231], v[68:71], v[56:59], v[228:231]
    v_mfma_f32_16x16x32_bf16 v[232:235], v[72:75], v[56:59], v[232:235]
    v_mfma_f32_16x16x32_bf16 v[236:239], v[76:79], v[56:59], v[236:239]
    v_mfma_f32_16x16x32_bf16 v[240:243], v[64:67], v[60:63], v[240:243]
    v_mfma_f32_16x16x32_bf16 v[244:247], v[68:71], v[60:63], v[244:247]
    v_mfma_f32_16x16x32_bf16 v[248:251], v[72:75], v[60:63], v[248:251]
    v_mfma_f32_16x16x32_bf16 v[252:255], v[76:79], v[60:63], v[252:255]
    s_waitcnt lgkmcnt(0)
    s_waitcnt vmcnt(8)
    s_barrier
    v_mfma_f32_16x16x32_bf16 v[128:131], v[112:115], v[80:83], v[128:131]
    s_add_u32 m0, s21, 98304
    s_nop 0
    buffer_load_dwordx4 v1, s[4:7], s16 offen sc1 lds
    s_add_u32 s16, s16, s62
    v_mfma_f32_16x16x32_bf16 v[132:135], v[116:119], v[80:83], v[132:135]
    ds_read_b64_tr_b16 v[64:65], v8 offset:16384
    v_mfma_f32_16x16x32_bf16 v[136:139], v[120:123], v[80:83], v[136:139]
    ds_read_b64_tr_b16 v[66:67], v9 offset:16384
    v_mfma_f32_16x16x32_bf16 v[140:143], v[124:127], v[80:83], v[140:143]
    ds_read_b64_tr_b16 v[68:69], v10 offset:16384
    v_mfma_f32_16x16x32_bf16 v[144:147], v[112:115], v[84:87], v[144:147]
    s_add_u32 m0, s21, 99328
    s_nop 0
    buffer_load_dwordx4 v1, s[4:7], s17 offen sc1 lds
    s_add_u32 s17, s17, s62
    v_mfma_f32_16x16x32_bf16 v[148:151], v[116:119], v[84:87], v[148:151]
    ds_read_b64_tr_b16 v[70:71], v11 offset:16384
    v_mfma_f32_16x16x32_bf16 v[152:155], v[120:123], v[84:87], v[152:155]
    ds_read_b64_tr_b16 v[72:73], v8 offset:24576
    v_mfma_f32_16x16x32_bf16 v[156:159], v[124:127], v[84:87], v[156:159]
    ds_read_b64_tr_b16 v[74:75], v9 offset:24576
    v_mfma_f32_16x16x32_bf16 v[160:163], v[112:115], v[88:91], v[160:163]
    s_add_u32 m0, s22, 98304
    s_nop 0
    buffer_load_dwordx4 v2, s[8:11], s18 offen lds
    s_add_u32 s18, s18, s20
    v_mfma_f32_16x16x32_bf16 v[164:167], v[116:119], v[88:91], v[164:167]
    ds_read_b64_tr_b16 v[76:77], v10 offset:24576
    v_mfma_f32_16x16x32_bf16 v[168:171], v[120:123], v[88:91], v[168:171]
    ds_read_b64_tr_b16 v[78:79], v11 offset:24576
    v_mfma_f32_16x16x32_bf16 v[172:175], v[124:127], v[88:91], v[172:175]
    ds_read_b128 v[32:35], v5 offset:0
    v_mfma_f32_16x16x32_bf16 v[176:179], v[112:115], v[92:95], v[176:179]
    s_add_u32 m0, s22, 106496
    s_nop 0
    buffer_load_dwordx4 v2, s[12:15], s19 offen lds
    s_add_u32 s19, s19, s20
    v_mfma_f32_16x16x32_bf16 v[180:183], v[116:119], v[92:95], v[180:183]
    ds_read_b128 v[36:39], v5 offset:1024
    v_mfma_f32_16x16x32_bf16 v[184:187], v[120:123], v[92:95], v[184:187]
    ds_read_b128 v[40:43], v5 offset:2048
    v_mfma_f32_16x16x32_bf16 v[188:191], v[124:127], v[92:95], v[188:191]
    ds_read_b128 v[44:47], v5 offset:3072
    v_mfma_f32_16x16x32_bf16 v[192:195], v[112:115], v[96:99], v[192:195]
    ds_read_b128 v[48:51], v5 offset:4096
    v_mfma_f32_16x16x32_bf16 v[196:199], v[116:119], v[96:99], v[196:199]
    ds_read_b128 v[52:55], v5 offset:5120
    v_mfma_f32_16x16x32_bf16 v[200:203], v[120:123], v[96:99], v[200:203]
    ds_read_b128 v[56:59], v5 offset:6144
    v_mfma_f32_16x16x32_bf16 v[204:207], v[124:127], v[96:99], v[204:207]
    ds_read_b128 v[60:63], v5 offset:7168
    v_mfma_f32_16x16x32_bf16 v[208:211], v[112:115], v[100:103], v[208:211]
    v_mfma_f32_16x16x32_bf16 v[212:215], v[116:119], v[100:103], v[212:215]
    v_mfma_f32_16x16x32_bf16 v[216:219], v[120:123], v[100:103], v[216:219]
    v_mfma_f32_16x16x32_bf16 v[220:223], v[124:127], v[100:103], v[220:223]
    v_mfma_f32_16x16x32_bf16 v[224:227], v[112:115], v[104:107], v[224:227]
    v_mfma_f32_16x16x32_bf16 v[228:231], v[116:119], v[104:107], v[228:231]
    v_mfma_f32_16x16x32_bf16 v[232:235], v[120:123], v[104:107], v[232:235]
    v_mfma_f32_16x16x32_bf16 v[236:239], v[124:127], v[104:107], v[236:239]
    v_mfma_f32_16x16x32_bf16 v[240:243], v[112:115], v[108:111], v[240:243]
    v_mfma_f32_16x16x32_bf16 v[244:247], v[116:119], v[108:111], v[244:247]
    v_mfma_f32_16x16x32_bf16 v[248:251], v[120:123], v[108:111], v[248:251]
    v_mfma_f32_16x16x32_bf16 v[252:255], v[124:127], v[108:111], v[252:255]
    s_waitcnt lgkmcnt(0)
    s_sub_u32 s23, s23, 1
    s_cmp_lg_u32 s23, 0
    s_cbranch_scc1 w_loop
    v_mov_b32 v20, 131072
    ds_read_b128 v[24:27], v20
    ds_read_b128 v[28:31], v20 offset:16
    s_cmp_eq_u32 s48, 2
    s_cbranch_scc1 w_epi_glu
    s_lshl_b32 s30, s27, 10
    s_add_u32 s30, s30, s49
    s_nop 7
    v_cvt_pk_bf16_f32 v80, v128, v129
    v_cvt_pk_bf16_f32 v81, v130, v131
    v_cvt_pk_bf16_f32 v82, v132, v133
    v_cvt_pk_bf16_f32 v83, v134, v135
    buffer_store_dwordx4 v[80:83], v1, s[4:7], s30 offen sc1
    v_cvt_pk_bf16_f32 v84, v136, v137
    v_cvt_pk_bf16_f32 v85, v138, v139
    v_cvt_pk_bf16_f32 v86, v140, v141
    v_cvt_pk_bf16_f32 v87, v142, v143
    buffer_store_dwordx4 v[84:87], v19, s[4:7], s30 offen sc1
    s_add_u32 s30, s30, s50
    v_cvt_pk_bf16_f32 v88, v144, v145
    v_cvt_pk_bf16_f32 v89, v146, v147
    v_cvt_pk_bf16_f32 v90, v148, v149
    v_cvt_pk_bf16_f32 v91, v150, v151
    buffer_store_dwordx4 v[88:91], v1, s[4:7], s30 offen sc1
    v_cvt_pk_bf16_f32 v92, v152, v153
    v_cvt_pk_bf16_f32 v93, v154, v155
    v_cvt_pk_bf16_f32 v94, v156, v157
    v_cvt_pk_bf16_f32 v95, v158, v159
    buffer_store_dwordx4 v[92:95], v19, s[4:7], s30 offen sc1
    s_add_u32 s30, s30, s50
    v_cvt_pk_bf16_f32 v80, v160, v161
    v_cvt_pk_bf16_f32 v81, v162, v163
    v_cvt_pk_bf16_f32 v82, v164, v165
    v_cvt_pk_bf16_f32 v83, v166, v167
    buffer_store_dwordx4 v[80:83], v1, s[4:7], s30 offen sc1
    v_cvt_pk_bf16_f32 v84, v168, v169
    v_cvt_pk_bf16_f32 v85, v170, v171
    v_cvt_pk_bf16_f32 v86, v172, v173
    v_cvt_pk_bf16_f32 v87, v174, v175
    buffer_store_dwordx4 v[84:87], v19, s[4:7], s30 offen sc1
    s_add_u32 s30, s30, s50
    v_cvt_pk_bf16_f32 v88, v176, v177
    v_cvt_pk_bf16_f32 v89, v178, v179
    v_cvt_pk_bf16_f32 v90, v180, v181
    v_cvt_pk_bf16_f32 v91, v182, v183
    buffer_store_dwordx4 v[88:91], v1, s[4:7], s30 offen sc1
    v_cvt_pk_bf16_f32 v92, v184, v185
    v_cvt_pk_bf16_f32 v93, v186, v187
    v_cvt_pk_bf16_f32 v94, v188, v189
    v_cvt_pk_bf16_f32 v95, v190, v191
    buffer_store_dwordx4 v[92:95], v19, s[4:7], s30 offen sc1
    s_add_u32 s30, s30, s50
    v_cvt_pk_bf16_f32 v80, v192, v193
    v_cvt_pk_bf16_f32 v81, v194, v195
    v_cvt_pk_bf16_f32 v82, v196, v197
    v_cvt_pk_bf16_f32 v83, v198, v199
    buffer_store_dwordx4 v[80:83], v1, s[4:7], s30 offen sc1
    v_cvt_pk_bf16_f32 v84, v200, v201
    v_cvt_pk_bf16_f32 v85, v202, v203
    v_cvt_pk_bf16_f32 v86, v204, v205
    v_cvt_pk_bf16_f32 v87, v206, v207
    buffer_store_dwordx4 v[84:87], v19, s[4:7], s30 offen sc1
    s_add_u32 s30, s30, s50
    v_cvt_pk_bf16_f32 v88, v208, v209
    v_cvt_pk_bf16_f32 v89, v210, v211
    v_cvt_pk_bf16_f32 v90, v212, v213
    v_cvt_pk_bf16_f32 v91, v214, v215
    buffer_store_dwordx4 v[88:91], v1, s[4:7], s30 offen sc1
    v_cvt_pk_bf16_f32 v92, v216, v217
    v_cvt_pk_bf16_f32 v93, v218, v219
    v_cvt_pk_bf16_f32 v94, v220, v221
    v_cvt_pk_bf16_f32 v95, v222, v223
    buffer_store_dwordx4 v[92:95], v19, s[4:7], s30 offen sc1
    s_add_u32 s30, s30, s50
    v_cvt_pk_bf16_f32 v80, v224, v225
    v_cvt_pk_bf16_f32 v81, v226, v227
    v_cvt_pk_bf16_f32 v82, v228, v229
    v_cvt_pk_bf16_f32 v83, v230, v231
    buffer_store_dwordx4 v[80:83], v1, s[4:7], s30 offen sc1
    v_cvt_pk_bf16_f32 v84, v232, v233
    v_cvt_pk_bf16_f32 v85, v234, v235
    v_cvt_pk_bf16_f32 v86, v236, v237
    v_cvt_pk_bf16_f32 v87, v238, v239
    buffer_store_dwordx4 v[84:87], v19, s[4:7], s30 offen sc1
    s_add_u32 s30, s30, s50
    v_cvt_pk_bf16_f32 v88, v240, v241
    v_cvt_pk_bf16_f32 v89, v242, v243
    v_cvt_pk_bf16_f32 v90, v244, v245
    v_cvt_pk_bf16_f32 v91, v246, v247
    buffer_store_dwordx4 v[88:91], v1, s[4:7], s30 offen sc1
    v_cvt_pk_bf16_f32 v92, v248, v249
    v_cvt_pk_bf16_f32 v93, v250, v251
    v_cvt_pk_bf16_f32 v94, v252, v253
    v_cvt_pk_bf16_f32 v95, v254, v255
    buffer_store_dwordx4 v[92:95], v19, s[4:7], s30 offen sc1
    s_waitcnt lgkmcnt(0)
    v_or3_b32 v24, v24, v25, v26
    v_or3_b32 v28, v28, v29, v30
    v_or3_b32 v24, v24, v27, v31
    v_or_b32 v24, v24, v28
    s_mov_b32 s28, s51
    v_readfirstlane_b32 s30, v24
    s_cmp_lg_u32 s30, 0
    s_cbranch_scc1 w_drain
    s_mov_b32 s48, s32
    s_cmp_eq_u32 s32, 4
    s_cselect_b32 s30, 2, 3
    s_lshl_b32 s30, s26, s30
    s_mul_i32 s30, s30, s43
    s_add_u32 s49, s42, s30
    s_mov_b32 s50, s43
    s_mov_b32 s51, s46
    s_mov_b32 s23, s41
    s_mov_b32 s53, s41
    s_branch w_first16
w_epi_glu:
    s_lshl_b32 s30, s27, 10
    s_add_u32 s30, s30, s49
    s_mov_b32 s54, 0xbfb8aa3b
    s_nop 7
    v_cvt_pk_bf16_f32 v80, v128, v129
    v_cvt_pk_bf16_f32 v81, v130, v131
    v_cvt_pk_bf16_f32 v82, v132, v133
    v_cvt_pk_bf16_f32 v83, v134, v135
    v_lshlrev_b32 v96, 16, v80
    v_and_b32 v97, 0xffff0000, v80
    v_lshlrev_b32 v98, 16, v81
    v_and_b32 v99, 0xffff0000, v81
    v_lshlrev_b32 v100, 16, v82
    v_and_b32 v101, 0xffff0000, v82
    v_lshlrev_b32 v102, 16, v83
    v_and_b32 v103, 0xffff0000, v83
    v_mul_f32 v96, s54, v96
    v_mul_f32 v97, s54, v97
    v_mul_f32 v98, s54, v98
    v_mul_f32 v99, s54, v99
    v_mul_f32 v100, s54, v100
    v_mul_f32 v101, s54, v101
    v_mul_f32 v102, s54, v102
    v_mul_f32 v103, s54, v103
    v_exp_f32 v96, v96
    v_exp_f32 v97, v97
    v_exp_f32 v98, v98
    v_exp_f32 v99, v99
    v_exp_f32 v100, v100
    v_exp_f32 v101, v101
    v_exp_f32 v102, v102
    v_exp_f32 v103, v103
    v_add_f32 v96, 1.0, v96
    v_add_f32 v97, 1.0, v97
    v_add_f32 v98, 1.0, v98
    v_add_f32 v99, 1.0, v99
    v_add_f32 v100, 1.0, v100
    v_add_f32 v101, 1.0, v101
    v_add_f32 v102, 1.0, v102
    v_add_f32 v103, 1.0, v103
    v_rcp_f32 v96, v96
    v_rcp_f32 v97, v97
    v_rcp_f32 v98, v98
    v_rcp_f32 v99, v99
    v_rcp_f32 v100, v100
    v_rcp_f32 v101, v101
    v_rcp_f32 v102, v102
    v_rcp_f32 v103, v103
    v_mul_f32 v96, v96, v136
    v_mul_f32 v97, v97, v137
    v_mul_f32 v98, v98, v138
    v_mul_f32 v99, v99, v139
    v_mul_f32 v100, v100, v140
    v_mul_f32 v101, v101, v141
    v_mul_f32 v102, v102, v142
    v_mul_f32 v103, v103, v143
    v_cvt_pk_bf16_f32 v80, v96, v97
    v_cvt_pk_bf16_f32 v81, v98, v99
    v_cvt_pk_bf16_f32 v82, v100, v101
    v_cvt_pk_bf16_f32 v83, v102, v103
    buffer_store_dwordx4 v[80:83], v1, s[4:7], s30 offen sc1
    s_add_u32 s30, s30, s50
    v_cvt_pk_bf16_f32 v84, v144, v145
    v_cvt_pk_bf16_f32 v85, v146, v147
    v_cvt_pk_bf16_f32 v86, v148, v149
    v_cvt_pk_bf16_f32 v87, v150, v151
    v_lshlrev_b32 v104, 16, v84
    v_and_b32 v105, 0xffff0000, v84
    v_lshlrev_b32 v106, 16, v85
    v_and_b32 v107, 0xffff0000, v85
    v_lshlrev_b32 v108, 16, v86
    v_and_b32 v109, 0xffff0000, v86
    v_lshlrev_b32 v110, 16, v87
    v_and_b32 v111, 0xffff0000, v87
    v_mul_f32 v104, s54, v104
    v_mul_f32 v105, s54, v105
    v_mul_f32 v106, s54, v106
    v_mul_f32 v107, s54, v107
    v_mul_f32 v108, s54, v108
    v_mul_f32 v109, s54, v109
    v_mul_f32 v110, s54, v110
    v_mul_f32 v111, s54, v111
    v_exp_f32 v104, v104
    v_exp_f32 v105, v105
    v_exp_f32 v106, v106
    v_exp_f32 v107, v107
    v_exp_f32 v108, v108
    v_exp_f32 v109, v109
    v_exp_f32 v110, v110
    v_exp_f32 v111, v111
    v_add_f32 v104, 1.0, v104
    v_add_f32 v105, 1.0, v105
    v_add_f32 v106, 1.0, v106
    v_add_f32 v107, 1.0, v107
    v_add_f32 v108, 1.0, v108
    v_add_f32 v109, 1.0, v109
    v_add_f32 v110, 1.0, v110
    v_add_f32 v111, 1.0, v111
    v_rcp_f32 v104, v104
    v_rcp_f32 v105, v105
    v_rcp_f32 v106, v106
    v_rcp_f32 v107, v107
    v_rcp_f32 v108, v108
    v_rcp_f32 v109, v109
    v_rcp_f32 v110, v110
    v_rcp_f32 v111, v111
    v_mul_f32 v104, v104, v152
    v_mul_f32 v105, v105, v153
    v_mul_f32 v106, v106, v154
    v_mul_f32 v107, v107, v155
    v_mul_f32 v108, v108, v156
    v_mul_f32 v109, v109, v157
    v_mul_f32 v110, v110, v158
    v_mul_f32 v111, v111, v159
    v_cvt_pk_bf16_f32 v84, v104, v105
    v_cvt_pk_bf16_f32 v85, v106, v107
    v_cvt_pk_bf16_f32 v86, v108, v109
    v_cvt_pk_bf16_f32 v87, v110, v111
    buffer_store_dwordx4 v[84:87], v1, s[4:7], s30 offen sc1
    s_add_u32 s30, s30, s50
    v_cvt_pk_bf16_f32 v88, v160, v161
    v_cvt_pk_bf16_f32 v89, v162, v163
    v_cvt_pk_bf16_f32 v90, v164, v165
    v_cvt_pk_bf16_f32 v91, v166, v167
    v_lshlrev_b32 v96, 16, v88
    v_and_b32 v97, 0xffff0000, v88
    v_lshlrev_b32 v98, 16, v89
    v_and_b32 v99, 0xffff0000, v89
    v_lshlrev_b32 v100, 16, v90
    v_and_b32 v101, 0xffff0000, v90
    v_lshlrev_b32 v102, 16, v91
    v_and_b32 v103, 0xffff0000, v91
    v_mul_f32 v96, s54, v96
    v_mul_f32 v97, s54, v97
    v_mul_f32 v98, s54, v98
    v_mul_f32 v99, s54, v99
    v_mul_f32 v100, s54, v100
    v_mul_f32 v101, s54, v101
    v_mul_f32 v102, s54, v102
    v_mul_f32 v103, s54, v103
    v_exp_f32 v96, v96
    v_exp_f32 v97, v97
    v_exp_f32 v98, v98
    v_exp_f32 v99, v99
    v_exp_f32 v100, v100
    v_exp_f32 v101, v101
    v_exp_f32 v102, v102
    v_exp_f32 v103, v103
    v_add_f32 v96, 1.0, v96
    v_add_f32 v97, 1.0, v97
    v_add_f32 v98, 1.0, v98
    v_add_f32 v99, 1.0, v99
    v_add_f32 v100, 1.0, v100
    v_add_f32 v101, 1.0, v101
    v_add_f32 v102, 1.0, v102
    v_add_f32 v103, 1.0, v103
    v_rcp_f32 v96, v96
    v_rcp_f32 v97, v97
    v_rcp_f32 v98, v98
    v_rcp_f32 v99, v99
    v_rcp_f32 v100, v100
    v_rcp_f32 v101, v101
    v_rcp_f32 v102, v102
    v_rcp_f32 v103, v103
    v_mul_f32 v96, v96, v168
    v_mul_f32 v97, v97, v169
    v_mul_f32 v98, v98, v170
    v_mul_f32 v99, v99, v171
    v_mul_f32 v100, v100, v172
    v_mul_f32 v101, v101, v173
    v_mul_f32 v102, v102, v174
    v_mul_f32 v103, v103, v175
    v_cvt_pk_bf16_f32 v88, v96, v97
    v_cvt_pk_bf16_f32 v89, v98, v99
    v_cvt_pk_bf16_f32 v90, v100, v101
    v_cvt_pk_bf16_f32 v91, v102, v103
    buffer_store_dwordx4 v[88:91], v1, s[4:7], s30 offen sc1
    s_add_u32 s30, s30, s50
    v_cvt_pk_bf16_f32 v92, v176, v177
    v_cvt_pk_bf16_f32 v93, v178, v179
    v_cvt_pk_bf16_f32 v94, v180, v181
    v_cvt_pk_bf16_f32 v95, v182, v183
    v_lshlrev_b32 v104, 16, v92
    v_and_b32 v105, 0xffff0000, v92
    v_lshlrev_b32 v106, 16, v93
    v_and_b32 v107, 0xffff0000, v93
    v_lshlrev_b32 v108, 16, v94
    v_and_b32 v109, 0xffff0000, v94
    v_lshlrev_b32 v110, 16, v95
    v_and_b32 v111, 0xffff0000, v95
    v_mul_f32 v104, s54, v104
    v_mul_f32 v105, s54, v105
    v_mul_f32 v106, s54, v106
    v_mul_f32 v107, s54, v107
    v_mul_f32 v108, s54, v108
    v_mul_f32 v109, s54, v109
    v_mul_f32 v110, s54, v110
    v_mul_f32 v111, s54, v111
    v_exp_f32 v104, v104
    v_exp_f32 v105, v105
    v_exp_f32 v106, v106
    v_exp_f32 v107, v107
    v_exp_f32 v108, v108
    v_exp_f32 v109, v109
    v_exp_f32 v110, v110
    v_exp_f32 v111, v111
    v_add_f32 v104, 1.0, v104
    v_add_f32 v105, 1.0, v105
    v_add_f32 v106, 1.0, v106
    v_add_f32 v107, 1.0, v107
    v_add_f32 v108, 1.0, v108
    v_add_f32 v109, 1.0, v109
    v_add_f32 v110, 1.0, v110
    v_add_f32 v111, 1.0, v111
    v_rcp_f32 v104, v104
    v_rcp_f32 v105, v105
    v_rcp_f32 v106, v106
    v_rcp_f32 v107, v107
    v_rcp_f32 v108, v108
    v_rcp_f32 v109, v109
    v_rcp_f32 v110, v110
    v_rcp_f32 v111, v111
    v_mul_f32 v104, v104, v184
    v_mul_f32 v105, v105, v185
    v_mul_f32 v106, v106, v186
    v_mul_f32 v107, v107, v187
    v_mul_f32 v108, v108, v188
    v_mul_f32 v109, v109, v189
    v_mul_f32 v110, v110, v190
    v_mul_f32 v111, v111, v191
    v_cvt_pk_bf16_f32 v92, v104, v105
    v_cvt_pk_bf16_f32 v93, v106, v107
    v_cvt_pk_bf16_f32 v94, v108, v109
    v_cvt_pk_bf16_f32 v95, v110, v111
    buffer_store_dwordx4 v[92:95], v1, s[4:7], s30 offen sc1
    s_add_u32 s30, s30, s50
    v_cvt_pk_bf16_f32 v80, v192, v193
    v_cvt_pk_bf16_f32 v81, v194, v195
    v_cvt_pk_bf16_f32 v82, v196, v197
    v_cvt_pk_bf16_f32 v83, v198, v199
    v_lshlrev_b32 v96, 16, v80
    v_and_b32 v97, 0xffff0000, v80
    v_lshlrev_b32 v98, 16, v81
    v_and_b32 v99, 0xffff0000, v81
    v_lshlrev_b32 v100, 16, v82
    v_and_b32 v101, 0xffff0000, v82
    v_lshlrev_b32 v102, 16, v83
    v_and_b32 v103, 0xffff0000, v83
    v_mul_f32 v96, s54, v96
    v_mul_f32 v97, s54, v97
    v_mul_f32 v98, s54, v98
    v_mul_f32 v99, s54, v99
    v_mul_f32 v100, s54, v100
    v_mul_f32 v101, s54, v101
    v_mul_f32 v102, s54, v102
    v_mul_f32 v103, s54, v103
    v_exp_f32 v96, v96
    v_exp_f32 v97, v97
    v_exp_f32 v98, v98
    v_exp_f32 v99, v99
    v_exp_f32 v100, v100
    v_exp_f32 v101, v101
    v_exp_f32 v102, v102
    v_exp_f32 v103, v103
    v_add_f32 v96, 1.0, v96
    v_add_f32 v97, 1.0, v97
    v_add_f32 v98, 1.0, v98
    v_add_f32 v99, 1.0, v99
    v_add_f32 v100, 1.0, v100
    v_add_f32 v101, 1.0, v101
    v_add_f32 v102, 1.0, v102
    v_add_f32 v103, 1.0, v103
    v_rcp_f32 v96, v96
    v_rcp_f32 v97, v97
    v_rcp_f32 v98, v98
    v_rcp_f32 v99, v99
    v_rcp_f32 v100, v100
    v_rcp_f32 v101, v101
    v_rcp_f32 v102, v102
    v_rcp_f32 v103, v103
    v_mul_f32 v96, v96, v200
    v_mul_f32 v97, v97, v201
    v_mul_f32 v98, v98, v202
    v_mul_f32 v99, v99, v203
    v_mul_f32 v100, v100, v204
    v_mul_f32 v101, v101, v205
    v_mul_f32 v102, v102, v206
    v_mul_f32 v103, v103, v207
    v_cvt_pk_bf16_f32 v80, v96, v97
    v_cvt_pk_bf16_f32 v81, v98, v99
    v_cvt_pk_bf16_f32 v82, v100, v101
    v_cvt_pk_bf16_f32 v83, v102, v103
    buffer_store_dwordx4 v[80:83], v1, s[4:7], s30 offen sc1
    s_add_u32 s30, s30, s50
    v_cvt_pk_bf16_f32 v84, v208, v209
    v_cvt_pk_bf16_f32 v85, v210, v211
    v_cvt_pk_bf16_f32 v86, v212, v213
    v_cvt_pk_bf16_f32 v87, v214, v215
    v_lshlrev_b32 v104, 16, v84
    v_and_b32 v105, 0xffff0000, v84
    v_lshlrev_b32 v106, 16, v85
    v_and_b32 v107, 0xffff0000, v85
    v_lshlrev_b32 v108, 16, v86
    v_and_b32 v109, 0xffff0000, v86
    v_lshlrev_b32 v110, 16, v87
    v_and_b32 v111, 0xffff0000, v87
    v_mul_f32 v104, s54, v104
    v_mul_f32 v105, s54, v105
    v_mul_f32 v106, s54, v106
    v_mul_f32 v107, s54, v107
    v_mul_f32 v108, s54, v108
    v_mul_f32 v109, s54, v109
    v_mul_f32 v110, s54, v110
    v_mul_f32 v111, s54, v111
    v_exp_f32 v104, v104
    v_exp_f32 v105, v105
    v_exp_f32 v106, v106
    v_exp_f32 v107, v107
    v_exp_f32 v108, v108
    v_exp_f32 v109, v109
    v_exp_f32 v110, v110
    v_exp_f32 v111, v111
    v_add_f32 v104, 1.0, v104
    v_add_f32 v105, 1.0, v105
    v_add_f32 v106, 1.0, v106
    v_add_f32 v107, 1.0, v107
    v_add_f32 v108, 1.0, v108
    v_add_f32 v109, 1.0, v109
    v_add_f32 v110, 1.0, v110
    v_add_f32 v111, 1.0, v111
    v_rcp_f32 v104, v104
    v_rcp_f32 v105, v105
    v_rcp_f32 v106, v106
    v_rcp_f32 v107, v107
    v_rcp_f32 v108, v108
    v_rcp_f32 v109, v109
    v_rcp_f32 v110, v110
    v_rcp_f32 v111, v111
    v_mul_f32 v104, v104, v216
    v_mul_f32 v105, v105, v217
    v_mul_f32 v106, v106, v218
    v_mul_f32 v107, v107, v219
    v_mul_f32 v108, v108, v220
    v_mul_f32 v109, v109, v221
    v_mul_f32 v110, v110, v222
    v_mul_f32 v111, v111, v223
    v_cvt_pk_bf16_f32 v84, v104, v105
    v_cvt_pk_bf16_f32 v85, v106, v107
    v_cvt_pk_bf16_f32 v86, v108, v109
    v_cvt_pk_bf16_f32 v87, v110, v111
    buffer_store_dwordx4 v[84:87], v1, s[4:7], s30 offen sc1
    s_add_u32 s30, s30, s50
    v_cvt_pk_bf16_f32 v88, v224, v225
    v_cvt_pk_bf16_f32 v89, v226, v227
    v_cvt_pk_bf16_f32 v90, v228, v229
    v_cvt_pk_bf16_f32 v91, v230, v231
    v_lshlrev_b32 v96, 16, v88
    v_and_b32 v97, 0xffff0000, v88
    v_lshlrev_b32 v98, 16, v89
    v_and_b32 v99, 0xffff0000, v89
    v_lshlrev_b32 v100, 16, v90
    v_and_b32 v101, 0xffff0000, v90
    v_lshlrev_b32 v102, 16, v91
    v_and_b32 v103, 0xffff0000, v91
    v_mul_f32 v96, s54, v96
    v_mul_f32 v97, s54, v97
    v_mul_f32 v98, s54, v98
    v_mul_f32 v99, s54, v99
    v_mul_f32 v100, s54, v100
    v_mul_f32 v101, s54, v101
    v_mul_f32 v102, s54, v102
    v_mul_f32 v103, s54, v103
    v_exp_f32 v96, v96
    v_exp_f32 v97, v97
    v_exp_f32 v98, v98
    v_exp_f32 v99, v99
    v_exp_f32 v100, v100
    v_exp_f32 v101, v101
    v_exp_f32 v102, v102
    v_exp_f32 v103, v103
    v_add_f32 v96, 1.0, v96
    v_add_f32 v97, 1.0, v97
    v_add_f32 v98, 1.0, v98
    v_add_f32 v99, 1.0, v99
    v_add_f32 v100, 1.0, v100
    v_add_f32 v101, 1.0, v101
    v_add_f32 v102, 1.0, v102
    v_add_f32 v103, 1.0, v103
    v_rcp_f32 v96, v96
    v_rcp_f32 v97, v97
    v_rcp_f32 v98, v98
    v_rcp_f32 v99, v99
    v_rcp_f32 v100, v100
    v_rcp_f32 v101, v101
    v_rcp_f32 v102, v102
    v_rcp_f32 v103, v103
    v_mul_f32 v96, v96, v232
    v_mul_f32 v97, v97, v233
    v_mul_f32 v98, v98, v234
    v_mul_f32 v99, v99, v235
    v_mul_f32 v100, v100, v236
    v_mul_f32 v101, v101, v237
    v_mul_f32 v102, v102, v238
    v_mul_f32 v103, v103, v239
    v_cvt_pk_bf16_f32 v88, v96, v97
    v_cvt_pk_bf16_f32 v89, v98, v99
    v_cvt_pk_bf16_f32 v90, v100, v101
    v_cvt_pk_bf16_f32 v91, v102, v103
    buffer_store_dwordx4 v[88:91], v1, s[4:7], s30 offen sc1
    s_add_u32 s30, s30, s50
    v_cvt_pk_bf16_f32 v92, v240, v241
    v_cvt_pk_bf16_f32 v93, v242, v243
    v_cvt_pk_bf16_f32 v94, v244, v245
    v_cvt_pk_bf16_f32 v95, v246, v247
    v_lshlrev_b32 v104, 16, v92
    v_and_b32 v105, 0xffff0000, v92
    v_lshlrev_b32 v106, 16, v93
    v_and_b32 v107, 0xffff0000, v93
    v_lshlrev_b32 v108, 16, v94
    v_and_b32 v109, 0xffff0000, v94
    v_lshlrev_b32 v110, 16, v95
    v_and_b32 v111, 0xffff0000, v95
    v_mul_f32 v104, s54, v104
    v_mul_f32 v105, s54, v105
    v_mul_f32 v106, s54, v106
    v_mul_f32 v107, s54, v107
    v_mul_f32 v108, s54, v108
    v_mul_f32 v109, s54, v109
    v_mul_f32 v110, s54, v110
    v_mul_f32 v111, s54, v111
    v_exp_f32 v104, v104
    v_exp_f32 v105, v105
    v_exp_f32 v106, v106
    v_exp_f32 v107, v107
    v_exp_f32 v108, v108
    v_exp_f32 v109, v109
    v_exp_f32 v110, v110
    v_exp_f32 v111, v111
    v_add_f32 v104, 1.0, v104
    v_add_f32 v105, 1.0, v105
    v_add_f32 v106, 1.0, v106
    v_add_f32 v107, 1.0, v107
    v_add_f32 v108, 1.0, v108
    v_add_f32 v109, 1.0, v109
    v_add_f32 v110, 1.0, v110
    v_add_f32 v111, 1.0, v111
    v_rcp_f32 v104, v104
    v_rcp_f32 v105, v105
    v_rcp_f32 v106, v106
    v_rcp_f32 v107, v107
    v_rcp_f32 v108, v108
    v_rcp_f32 v109, v109
    v_rcp_f32 v110, v110
    v_rcp_f32 v111, v111
    v_mul_f32 v104, v104, v248
    v_mul_f32 v105, v105, v249
    v_mul_f32 v106, v106, v250
    v_mul_f32 v107, v107, v251
    v_mul_f32 v108, v108, v252
    v_mul_f32 v109, v109, v253
    v_mul_f32 v110, v110, v254
    v_mul_f32 v111, v111, v255
    v_cvt_pk_bf16_f32 v92, v104, v105
    v_cvt_pk_bf16_f32 v93, v106, v107
    v_cvt_pk_bf16_f32 v94, v108, v109
    v_cvt_pk_bf16_f32 v95, v110, v111
    buffer_store_dwordx4 v[92:95], v1, s[4:7], s30 offen sc1
    s_waitcnt lgkmcnt(0)
    v_or3_b32 v24, v24, v25, v26
    v_or3_b32 v28, v28, v29, v30
    v_or3_b32 v24, v24, v27, v31
    v_or_b32 v24, v24, v28
    s_mov_b32 s28, s51
    v_readfirstlane_b32 s30, v24
    s_cmp_lg_u32 s30, 0
    s_cbranch_scc1 w_drain
    s_mov_b32 s48, s32
    s_cmp_eq_u32 s32, 4
    s_cselect_b32 s30, 2, 3
    s_lshl_b32 s30, s26, s30
    s_mul_i32 s30, s30, s43
    s_add_u32 s49, s42, s30
    s_mov_b32 s50, s43
    s_mov_b32 s51, s46
    s_mov_b32 s23, s41
    s_mov_b32 s53, s41
    s_branch w_first8
w_firstH:
    s_waitcnt vmcnt(8)
    s_barrier
    s_add_u32 m0, s21, 0
    s_nop 0
    buffer_load_dwordx4 v1, s[4:7], s16 offen sc1 lds
    s_add_u32 s16, s16, s62
    s_add_u32 m0, s21, 1024
    s_nop 0
    buffer_load_dwordx4 v1, s[4:7], s17 offen sc1 lds
    s_add_u32 s17, s17, s62
    s_add_u32 m0, s22, 0
    s_nop 0
    buffer_load_dwordx4 v2, s[8:11], s18 offen lds
    s_add_u32 s18, s18, s20
    s_add_u32 m0, s22, 8192
    s_nop 0
    buffer_load_dwordx4 v2, s[12:15], s19 offen lds
    s_add_u32 s19, s19, s20
    v_mfma_f32_16x16x32_bf16 v[128:131], v[64:67], v[32:35], 0
    ds_read_b64_tr_b16 v[112:113], v8 offset:49152
    v_mfma_f32_16x16x32_bf16 v[132:135], v[68:71], v[32:35], 0
    ds_read_b64_tr_b16 v[114:115], v9 offset:49152
    v_mfma_f32_16x16x32_bf16 v[144:147], v[64:67], v[40:43], 0
    ds_read_b64_tr_b16 v[116:117], v10 offset:49152
    v_mfma_f32_16x16x32_bf16 v[148:151], v[68:71], v[40:43], 0
    ds_read_b64_tr_b16 v[118:119], v11 offset:49152
    v_mfma_f32_16x16x32_bf16 v[160:163], v[64:67], v[48:51], 0
    ds_read_b64_tr_b16 v[120:121], v8 offset:57344
    v_mfma_f32_16x16x32_bf16 v[164:167], v[68:71], v[48:51], 0
    ds_read_b64_tr_b16 v[122:123], v9 offset:57344
    v_mfma_f32_16x16x32_bf16 v[176:179], v[64:67], v[56:59], 0
    ds_read_b64_tr_b16 v[124:125], v10 offset:57344
    v_mfma_f32_16x16x32_bf16 v[180:183], v[68:71], v[56:59], 0
    ds_read_b64_tr_b16 v[126:127], v11 offset:57344
    v_mfma_f32_16x16x32_bf16 v[128:131], v[72:75], v[36:39], v[128:131]
    ds_read_b128 v[80:83], v5 offset:32768
    v_mfma_f32_16x16x32_bf16 v[132:135], v[76:79], v[36:39], v[132:135]
    ds_read_b128 v[84:87], v5 offset:33792
    v_mfma_f32_16x16x32_bf16 v[144:147], v[72:75], v[44:47], v[144:147]
    ds_read_b128 v[88:91], v5 offset:34816
    v_mfma_f32_16x16x32_bf16 v[148:151], v[76:79], v[44:47], v[148:151]
    ds_read_b128 v[92:95], v5 offset:35840
    v_mfma_f32_16x16x32_bf16 v[160:163], v[72:75], v[52:55], v[160:163]
    ds_read_b128 v[96:99], v5 offset:36864
    v_mfma_f32_16x16x32_bf16 v[164:167], v[76:79], v[52:55], v[164:167]
    ds_read_b128 v[100:103], v5 offset:37888
    v_mfma_f32_16x16x32_bf16 v[176:179], v[72:75], v[60:63], v[176:179]
    ds_read_b128 v[104:107], v5 offset:38912
    v_mfma_f32_16x16x32_bf16 v[180:183], v[76:79], v[60:63], v[180:183]
    ds_read_b128 v[108:111], v5 offset:39936
    s_waitcnt lgkmcnt(0)
    s_waitcnt vmcnt(8)
    s_barrier
    s_add_u32 m0, s21, 32768
    s_nop 0
    buffer_load_dwordx4 v1, s[4:7], s16 offen sc1 lds
    s_add_u32 s16, s16, s62
    s_add_u32 m0, s21, 33792
    s_nop 0
    buffer_load_dwordx4 v1, s[4:7], s17 offen sc1 lds
    s_add_u32 s17, s17, s62
    s_add_u32 m0, s22, 32768
    s_nop 0
    buffer_load_dwordx4 v2, s[8:11], s18 offen lds
    s_add_u32 s18, s18, s20
    s_add_u32 m0, s22, 40960
    s_nop 0
    buffer_load_dwordx4 v2, s[12:15], s19 offen lds
    s_add_u32 s19, s19, s20
    v_mfma_f32_16x16x32_bf16 v[128:131], v[112:115], v[80:83], v[128:131]
    ds_read_b64_tr_b16 v[64:65], v12 offset:16384
    v_mfma_f32_16x16x32_bf16 v[132:135], v[116:119], v[80:83], v[132:135]
    ds_read_b64_tr_b16 v[66:67], v13 offset:16384
    v_mfma_f32_16x16x32_bf16 v[144:147], v[112:115], v[88:91], v[144:147]
    ds_read_b64_tr_b16 v[68:69], v14 offset:16384
    v_mfma_f32_16x16x32_bf16 v[148:151], v[116:119], v[88:91], v[148:151]
    ds_read_b64_tr_b16 v[70:71], v15 offset:16384
    v_mfma_f32_16x16x32_bf16 v[160:163], v[112:115], v[96:99], v[160:163]
    ds_read_b64_tr_b16 v[72:73], v12 offset:24576
    v_mfma_f32_16x16x32_bf16 v[164:167], v[116:119], v[96:99], v[164:167]
    ds_read_b64_tr_b16 v[74:75], v13 offset:24576
    v_mfma_f32_16x16x32_bf16 v[176:179], v[112:115], v[104:107], v[176:179]
    ds_read_b64_tr_b16 v[76:77], v14 offset:24576
    v_mfma_f32_16x16x32_bf16 v[180:183], v[116:119], v[104:107], v[180:183]
    ds_read_b64_tr_b16 v[78:79], v15 offset:24576
    v_mfma_f32_16x16x32_bf16 v[128:131], v[120:123], v[84:87], v[128:131]
    ds_read_b128 v[32:35], v6 offset:0
    v_mfma_f32_16x16x32_bf16 v[132:135], v[124:127], v[84:87], v[132:135]
    ds_read_b128 v[36:39], v6 offset:1024
    v_mfma_f32_16x16x32_bf16 v[144:147], v[120:123], v[92:95], v[144:147]
    ds_read_b128 v[40:43], v6 offset:2048
    v_mfma_f32_16x16x32_bf16 v[148:151], v[124:127], v[92:95], v[148:151]
    ds_read_b128 v[44:47], v6 offset:3072
    v_mfma_f32_16x16x32_bf16 v[160:163], v[120:123], v[100:103], v[160:163]
    ds_read_b128 v[48:51], v6 offset:4096
    v_mfma_f32_16x16x32_bf16 v[164:167], v[124:127], v[100:103], v[164:167]
    ds_read_b128 v[52:55], v6 offset:5120
    v_mfma_f32_16x16x32_bf16 v[176:179], v[120:123], v[108:111], v[176:179]
    ds_read_b128 v[56:59], v6 offset:6144
    v_mfma_f32_16x16x32_bf16 v[180:183], v[124:127], v[108:111], v[180:183]
    ds_read_b128 v[60:63], v6 offset:7168
    s_waitcnt lgkmcnt(0)
    s_waitcnt vmcnt(8)
    s_barrier
    s_add_u32 m0, s21, 65536
    s_nop 0
    buffer_load_dwordx4 v1, s[4:7], s16 offen sc1 lds
    s_add_u32 s16, s16, s62
    s_add_u32 m0, s21, 66560
    s_nop 0
    buffer_load_dwordx4 v1, s[4:7], s17 offen sc1 lds
    s_add_u32 s17, s17, s62
    s_add_u32 m0, s22, 65536
    s_nop 0
    buffer_load_dwordx4 v2, s[8:11], s18 offen lds
    s_add_u32 s18, s18, s20
    s_add_u32 m0, s22, 73728
    s_nop 0
    buffer_load_dwordx4 v2, s[12:15], s19 offen lds
    s_add_u32 s19, s19, s20
    v_mfma_f32_16x16x32_bf16 v[128:131], v[64:67], v[32:35], v[128:131]
    ds_read_b64_tr_b16 v[112:113], v12 offset:49152
    v_mfma_f32_16x16x32_bf16 v[132:135], v[68:71], v[32:35], v[132:135]
    ds_read_b64_tr_b16 v[114:115], v13 offset:49152
    v_mfma_f32_16x16x32_bf16 v[144:147], v[64:67], v[40:43], v[144:147]
    ds_read_b64_tr_b16 v[116:117], v14 offset:49152
    v_mfma_f32_16x16x32_bf16 v[148:151], v[68:71], v[40:43], v[148:151]
    ds_read_b64_tr_b16 v[118:119], v15 offset:49152
    v_mfma_f32_16x16x32_bf16 v[160:163], v[64:67], v[48:51], v[160:163]
    ds_read_b64_tr_b16 v[120:121], v12 offset:57344
    v_mfma_f32_16x16x32_bf16 v[164:167], v[68:71], v[48:51], v[164:167]
    ds_read_b64_tr_b16 v[122:123], v13 offset:57344
    v_mfma_f32_16x16x32_bf16 v[176:179], v[64:67], v[56:59], v[176:179]
    ds_read_b64_tr_b16 v[124:125], v14 offset:57344
    v_mfma_f32_16x16x32_bf16 v[180:183], v[68:71], v[56:59], v[180:183]
    ds_read_b64_tr_b16 v[126:127], v15 offset:57344
    v_mfma_f32_16x16x32_bf16 v[128:131], v[72:75], v[36:39], v[128:131]
    ds_read_b128 v[80:83], v6 offset:32768
    v_mfma_f32_16x16x32_bf16 v[132:135], v[76:79], v[36:39], v[132:135]
    ds_read_b128 v[84:87], v6 offset:33792
    v_mfma_f32_16x16x32_bf16 v[144:147], v[72:75], v[44:47], v[144:147]
    ds_read_b128 v[88:91], v6 offset:34816
    v_mfma_f32_16x16x32_bf16 v[148:151], v[76:79], v[44:47], v[148:151]
    ds_read_b128 v[92:95], v6 offset:35840
    v_mfma_f32_16x16x32_bf16 v[160:163], v[72:75], v[52:55], v[160:163]
    ds_read_b128 v[96:99], v6 offset:36864
    v_mfma_f32_16x16x32_bf16 v[164:167], v[76:79], v[52:55], v[164:167]
    ds_read_b128 v[100:103], v6 offset:37888
    v_mfma_f32_16x16x32_bf16 v[176:179], v[72:75], v[60:63], v[176:179]
    ds_read_b128 v[104:107], v6 offset:38912
    v_mfma_f32_16x16x32_bf16 v[180:183], v[76:79], v[60:63], v[180:183]
    ds_read_b128 v[108:111], v6 offset:39936
    s_waitcnt lgkmcnt(0)
    s_waitcnt vmcnt(8)
    s_barrier
    s_add_u32 m0, s21, 98304
    s_nop 0
    buffer_load_dwordx4 v1, s[4:7], s16 offen sc1 lds
    s_add_u32 s16, s16, s62
    s_add_u32 m0, s21, 99328
    s_nop 0
    buffer_load_dwordx4 v1, s[4:7], s17 offen sc1 lds
    s_add_u32 s17, s17, s62
    s_add_u32 m0, s22, 98304
    s_nop 0
    buffer_load_dwordx4 v2, s[8:11], s18 offen lds
    s_add_u32 s18, s18, s20
    s_add_u32 m0, s22, 106496
    s_nop 0
    buffer_load_dwordx4 v2, s[12:15], s19 offen lds
    s_add_u32 s19, s19, s20
    v_mfma_f32_16x16x32_bf16 v[128:131], v[112:115], v[80:83], v[128:131]
    ds_read_b64_tr_b16 v[64:65], v8 offset:16384
    v_mfma_f32_16x16x32_bf16 v[132:135], v[116:119], v[80:83], v[132:135]
    ds_read_b64_tr_b16 v[66:67], v9 offset:16384
    v_mfma_f32_16x16x32_bf16 v[144:147], v[112:115], v[88:91], v[144:147]
    ds_read_b64_tr_b16 v[68:69], v10 offset:16384
    v_mfma_f32_16x16x32_bf16 v[148:151], v[116:119], v[88:91], v[148:151]
    ds_read_b64_tr_b16 v[70:71], v11 offset:16384
    v_mfma_f32_16x16x32_bf16 v[160:163], v[112:115], v[96:99], v[160:163]
    ds_read_b64_tr_b16 v[72:73], v8 offset:24576
    v_mfma_f32_16x16x32_bf16 v[164:167], v[116:119], v[96:99], v[164:167]
    ds_read_b64_tr_b16 v[74:75], v9 offset:24576
    v_mfma_f32_16x16x32_bf16 v[176:179], v[112:115], v[104:107], v[176:179]
    ds_read_b64_tr_b16 v[76:77], v10 offset:24576
    v_mfma_f32_16x16x32_bf16 v[180:183], v[116:119], v[104:107], v[180:183]
    ds_read_b64_tr_b16 v[78:79], v11 offset:24576
    v_mfma_f32_16x16x32_bf16 v[128:131], v[120:123], v[84:87], v[128:131]
    ds_read_b128 v[32:35], v5 offset:0
    v_mfma_f32_16x16x32_bf16 v[132:135], v[124:127], v[84:87], v[132:135]
    ds_read_b128 v[36:39], v5 offset:1024
    v_mfma_f32_16x16x32_bf16 v[144:147], v[120:123], v[92:95], v[144:147]
    ds_read_b128 v[40:43], v5 offset:2048
    v_mfma_f32_16x16x32_bf16 v[148:151], v[124:127], v[92:95], v[148:151]
    ds_read_b128 v[44:47], v5 offset:3072
    v_mfma_f32_16x16x32_bf16 v[160:163], v[120:123], v[100:103], v[160:163]
    ds_read_b128 v[48:51], v5 offset:4096
    v_mfma_f32_16x16x32_bf16 v[164:167], v[124:127], v[100:103], v[164:167]
    ds_read_b128 v[52:55], v5 offset:5120
    v_mfma_f32_16x16x32_bf16 v[176:179], v[120:123], v[108:111], v[176:179]
    ds_read_b128 v[56:59], v5 offset:6144
    v_mfma_f32_16x16x32_bf16 v[180:183], v[124:127], v[108:111], v[180:183]
    ds_read_b128 v[60:63], v5 offset:7168
    s_waitcnt lgkmcnt(0)
w_loop_chkH:
    s_sub_u32 s23, s23, 1
w_loopH:
    s_cmp_gt_u32 s23, 3
    s_cbranch_scc1 w_bodyH
    s_cmp_lg_u32 s23, 3
    s_cbranch_scc1 w_l2H
    s_cmp_lg_u32 s3, 0
    s_cbranch_scc1 clm_9
    v_mov_b32 v26, 1
    s_mov_b64 exec, 1
    buffer_atomic_add v26, off, s[64:67], s71 sc0 sc1
    s_mov_b64 exec, -1
clm_9:
    s_branch w_bodyH
w_l2H:
    s_cmp_lg_u32 s23, 2
    s_cbranch_scc1 w_l1H
    s_cmp_lg_u32 s3, 0
    s_cbranch_scc1 pub_10
    v_mov_b32 v20, 131136
    s_mov_b64 exec, 1
    ds_write_b32 v20, v26
    s_mov_b64 exec, -1
    s_waitcnt lgkmcnt(0)
pub_10:
    s_branch w_bodyH
w_l1H:
    s_waitcnt vmcnt(8)
    buffer_load_dword v22, off, s[64:67], 0 sc1
    v_readfirstlane_b32 s30, v16
    s_cmp_ge_u32 s30, s45
    s_cselect_b32 s30, 0, 1
    s_cmp_lg_u32 s3, 0
    s_cselect_b32 s30, 0, s30
    s_or_b32 s30, s30, s70
    s_cmp_eq_u32 s32, 4
    s_cselect_b32 s30, 1, s30
    s_sub_u32 s57, s32, 1
    s_cmp_ge_u32 s57, 4
    s_cselect_b32 s30, 1, s30
    v_mov_b32 v20, s30
    ds_write_b32 v7, v20
    s_cbranch_scc1 w_bodyH
    s_load_dwordx2 s[8:9], s[0:1], s33
    s_load_dwordx2 s[12:13], s[0:1], s34
    s_mov_b32 s10, s38
    s_mov_b32 s14, s38
    s_cmp_eq_u32 s32, 4
    s_cselect_b32 s31, 0, 1
    s_lshl_b32 s30, s3, s31
    s_mul_i32 s30, s30, s40
    s_add_u32 s16, s39, s30
    s_cmp_eq_u32 s32, 4
    s_cselect_b32 s30, 1024, s40
    s_cselect_b32 s31, 6, 5
    s_lshl_b32 s62, 32, s31
    s_add_u32 s17, s16, s30
    s_lshl_b32 s30, s3, 2
    s_mul_i32 s30, s30, s35
    s_add_u32 s18, s36, s30
    s_add_u32 s19, s37, s30
    s_lshl_b32 s20, s35, s31
    v_mul_u32_u24 v2, s35, v4
    v_add_u32 v2, v2, v3
    s_waitcnt lgkmcnt(0)
w_bodyH:
    s_waitcnt vmcnt(8)
    s_barrier
    s_cmp_lg_u32 s23, 2
    s_cbranch_scc1 w_nfH
    v_mov_b32 v20, 131136
    ds_read_b32 v20, v20
    s_waitcnt lgkmcnt(0)
    v_readfirstlane_b32 s59, v20
    s_add_u32 s59, s59, 32
    s_min_u32 s59, s59, 322
    s_lshl_b32 s57, s59, 6
    s_load_dwordx16 s[32:47], s[24:25], s57
w_nfH:
    s_add_u32 m0, s21, 0
    s_nop 0
    buffer_load_dwordx4 v1, s[4:7], s16 offen sc1 lds
    s_add_u32 s16, s16, s62
    s_add_u32 m0, s21, 1024
    s_nop 0
    buffer_load_dwordx4 v1, s[4:7], s17 offen sc1 lds
    s_add_u32 s17, s17, s62
    s_add_u32 m0, s22, 0
    s_nop 0
    buffer_load_dwordx4 v2, s[8:11], s18 offen lds
    s_add_u32 s18, s18, s20
    s_add_u32 m0, s22, 8192
    s_nop 0
    buffer_load_dwordx4 v2, s[12:15], s19 offen lds
    s_add_u32 s19, s19, s20
    v_mfma_f32_16x16x32_bf16 v[128:131], v[64:67], v[32:35], v[128:131]
    ds_read_b64_tr_b16 v[112:113], v8 offset:49152
    v_mfma_f32_16x16x32_bf16 v[132:135], v[68:71], v[32:35], v[132:135]
    ds_read_b64_tr_b16 v[114:115], v9 offset:49152
    v_mfma_f32_16x16x32_bf16 v[144:147], v[64:67], v[40:43], v[144:147]
    ds_read_b64_tr_b16 v[116:117], v10 offset:49152
    v_mfma_f32_16x16x32_bf16 v[148:151], v[68:71], v[40:43], v[148:151]
    ds_read_b64_tr_b16 v[118:119], v11 offset:49152
    v_mfma_f32_16x16x32_bf16 v[160:163], v[64:67], v[48:51], v[160:163]
    ds_read_b64_tr_b16 v[120:121], v8 offset:57344
    v_mfma_f32_16x16x32_bf16 v[164:167], v[68:71], v[48:51], v[164:167]
    ds_read_b64_tr_b16 v[122:123], v9 offset:57344
    v_mfma_f32_16x16x32_bf16 v[176:179], v[64:67], v[56:59], v[176:179]
    ds_read_b64_tr_b16 v[124:125], v10 offset:57344
    v_mfma_f32_16x16x32_bf16 v[180:183], v[68:71], v[56:59], v[180:183]
    ds_read_b64_tr_b16 v[126:127], v11 offset:57344
    v_mfma_f32_16x16x32_bf16 v[128:131], v[72:75], v[36:39], v[128:131]
    ds_read_b128 v[80:83], v5 offset:32768
    v_mfma_f32_16x16x32_bf16 v[132:135], v[76:79], v[36:39], v[132:135]
    ds_read_b128 v[84:87], v5 offset:33792
    v_mfma_f32_16x16x32_bf16 v[144:147], v[72:75], v[44:47], v[144:147]
    ds_read_b128 v[88:91], v5 offset:34816
    v_mfma_f32_16x16x32_bf16 v[148:151], v[76:79], v[44:47], v[148:151]
    ds_read_b128 v[92:95], v5 offset:35840
    v_mfma_f32_16x16x32_bf16 v[160:163], v[72:75], v[52:55], v[160:163]
    ds_read_b128 v[96:99], v5 offset:36864
    v_mfma_f32_16x16x32_bf16 v[164:167], v[76:79], v[52:55], v[164:167]
    ds_read_b128 v[100:103], v5 offset:37888
    v_mfma_f32_16x16x32_bf16 v[176:179], v[72:75], v[60:63], v[176:179]
    ds_read_b128 v[104:107], v5 offset:38912
    v_mfma_f32_16x16x32_bf16 v[180:183], v[76:79], v[60:63], v[180:183]
    ds_read_b128 v[108:111], v5 offset:39936
    s_waitcnt lgkmcnt(0)
    s_waitcnt vmcnt(8)
    s_barrier
    s_lshl_b32 s57, s3, 8
    s_or_b32 s57, s57, s23
    s_cmp_lg_u32 s57, 2
    s_cbranch_scc1 np_11
    buffer_load_dword v16, v17, s[4:7], s44 offen sc1
np_11:
    s_add_u32 m0, s21, 32768
    s_nop 0
    buffer_load_dwordx4 v1, s[4:7], s16 offen sc1 lds
    s_add_u32 s16, s16, s62
    s_add_u32 m0, s21, 33792
    s_nop 0
    buffer_load_dwordx4 v1, s[4:7], s17 offen sc1 lds
    s_add_u32 s17, s17, s62
    s_add_u32 m0, s22, 32768
    s_nop 0
    buffer_load_dwordx4 v2, s[8:11], s18 offen lds
    s_add_u32 s18, s18, s20
    s_add_u32 m0, s22, 40960
    s_nop 0
    buffer_load_dwordx4 v2, s[12:15], s19 offen lds
    s_add_u32 s19, s19, s20
    v_mfma_f32_16x16x32_bf16 v[128:131], v[112:115], v[80:83], v[128:131]
    ds_read_b64_tr_b16 v[64:65], v12 offset:16384
    v_mfma_f32_16x16x32_bf16 v[132:135], v[116:119], v[80:83], v[132:135]
    ds_read_b64_tr_b16 v[66:67], v13 offset:16384
    v_mfma_f32_16x16x32_bf16 v[144:147], v[112:115], v[88:91], v[144:147]
    ds_read_b64_tr_b16 v[68:69], v14 offset:16384
    v_mfma_f32_16x16x32_bf16 v[148:151], v[116:119], v[88:91], v[148:151]
    ds_read_b64_tr_b16 v[70:71], v15 offset:16384
    v_mfma_f32_16x16x32_bf16 v[160:163], v[112:115], v[96:99], v[160:163]
    ds_read_b64_tr_b16 v[72:73], v12 offset:24576
    v_mfma_f32_16x16x32_bf16 v[164:167], v[116:119], v[96:99], v[164:167]
    ds_read_b64_tr_b16 v[74:75], v13 offset:24576
    v_mfma_f32_16x16x32_bf16 v[176:179], v[112:115], v[104:107], v[176:179]
    ds_read_b64_tr_b16 v[76:77], v14 offset:24576
    v_mfma_f32_16x16x32_bf16 v[180:183], v[116:119], v[104:107], v[180:183]
    ds_read_b64_tr_b16 v[78:79], v15 offset:24576
    v_mfma_f32_16x16x32_bf16 v[128:131], v[120:123], v[84:87], v[128:131]
    ds_read_b128 v[32:35], v6 offset:0
    v_mfma_f32_16x16x32_bf16 v[132:135], v[124:127], v[84:87], v[132:135]
    ds_read_b128 v[36:39], v6 offset:1024
    v_mfma_f32_16x16x32_bf16 v[144:147], v[120:123], v[92:95], v[144:147]
    ds_read_b128 v[40:43], v6 offset:2048
    v_mfma_f32_16x16x32_bf16 v[148:151], v[124:127], v[92:95], v[148:151]
    ds_read_b128 v[44:47], v6 offset:3072
    v_mfma_f32_16x16x32_bf16 v[160:163], v[120:123], v[100:103], v[160:163]
    ds_read_b128 v[48:51], v6 offset:4096
    v_mfma_f32_16x16x32_bf16 v[164:167], v[124:127], v[100:103], v[164:167]
    ds_read_b128 v[52:55], v6 offset:5120
    v_mfma_f32_16x16x32_bf16 v[176:179], v[120:123], v[108:111], v[176:179]
    ds_read_b128 v[56:59], v6 offset:6144
    v_mfma_f32_16x16x32_bf16 v[180:183], v[124:127], v[108:111], v[180:183]
    ds_read_b128 v[60:63], v6 offset:7168
    s_waitcnt lgkmcnt(0)
    s_waitcnt vmcnt(8)
    s_barrier
    s_add_u32 m0, s21, 65536
    s_nop 0
    buffer_load_dwordx4 v1, s[4:7], s16 offen sc1 lds
    s_add_u32 s16, s16, s62
    s_add_u32 m0, s21, 66560
    s_nop 0
    buffer_load_dwordx4 v1, s[4:7], s17 offen sc1 lds
    s_add_u32 s17, s17, s62
    s_add_u32 m0, s22, 65536
    s_nop 0
    buffer_load_dwordx4 v2, s[8:11], s18 offen lds
    s_add_u32 s18, s18, s20
    s_add_u32 m0, s22, 73728
    s_nop 0
    buffer_load_dwordx4 v2, s[12:15], s19 offen lds
    s_add_u32 s19, s19, s20
    v_mfma_f32_16x16x32_bf16 v[128:131], v[64:67], v[32:35], v[128:131]
    ds_read_b64_tr_b16 v[112:113], v12 offset:49152
    v_mfma_f32_16x16x32_bf16 v[132:135], v[68:71], v[32:35], v[132:135]
    ds_read_b64_tr_b16 v[114:115], v13 offset:49152
    v_mfma_f32_16x16x32_bf16 v[144:147], v[64:67], v[40:43], v[144:147]
    ds_read_b64_tr_b16 v[116:117], v14 offset:49152
    v_mfma_f32_16x16x32_bf16 v[148:151], v[68:71], v[40:43], v[148:151]
    ds_read_b64_tr_b16 v[118:119], v15 offset:49152
    v_mfma_f32_16x16x32_bf16 v[160:163], v[64:67], v[48:51], v[160:163]
    ds_read_b64_tr_b16 v[120:121], v12 offset:57344
    v_mfma_f32_16x16x32_bf16 v[164:167], v[68:71], v[48:51], v[164:167]
    ds_read_b64_tr_b16 v[122:123], v13 offset:57344
    v_mfma_f32_16x16x32_bf16 v[176:179], v[64:67], v[56:59], v[176:179]
    ds_read_b64_tr_b16 v[124:125], v14 offset:57344
    v_mfma_f32_16x16x32_bf16 v[180:183], v[68:71], v[56:59], v[180:183]
    ds_read_b64_tr_b16 v[126:127], v15 offset:57344
    v_mfma_f32_16x16x32_bf16 v[128:131], v[72:75], v[36:39], v[128:131]
    ds_read_b128 v[80:83], v6 offset:32768
    v_mfma_f32_16x16x32_bf16 v[132:135], v[76:79], v[36:39], v[132:135]
    ds_read_b128 v[84:87], v6 offset:33792
    v_mfma_f32_16x16x32_bf16 v[144:147], v[72:75], v[44:47], v[144:147]
    ds_read_b128 v[88:91], v6 offset:34816
    v_mfma_f32_16x16x32_bf16 v[148:151], v[76:79], v[44:47], v[148:151]
    ds_read_b128 v[92:95], v6 offset:35840
    v_mfma_f32_16x16x32_bf16 v[160:163], v[72:75], v[52:55], v[160:163]
    ds_read_b128 v[96:99], v6 offset:36864
    v_mfma_f32_16x16x32_bf16 v[164:167], v[76:79], v[52:55], v[164:167]
    ds_read_b128 v[100:103], v6 offset:37888
    v_mfma_f32_16x16x32_bf16 v[176:179], v[72:75], v[60:63], v[176:179]
    ds_read_b128 v[104:107], v6 offset:38912
    v_mfma_f32_16x16x32_bf16 v[180:183], v[76:79], v[60:63], v[180:183]
    ds_read_b128 v[108:111], v6 offset:39936
    s_waitcnt lgkmcnt(0)
    s_waitcnt vmcnt(8)
    s_barrier
    s_add_u32 m0, s21, 98304
    s_nop 0
    buffer_load_dwordx4 v1, s[4:7], s16 offen sc1 lds
    s_add_u32 s16, s16, s62
    s_add_u32 m0, s21, 99328
    s_nop 0
    buffer_load_dwordx4 v1, s[4:7], s17 offen sc1 lds
    s_add_u32 s17, s17, s62
    s_add_u32 m0, s22, 98304
    s_nop 0
    buffer_load_dwordx4 v2, s[8:11], s18 offen lds
    s_add_u32 s18, s18, s20
    s_add_u32 m0, s22, 106496
    s_nop 0
    buffer_load_dwordx4 v2, s[12:15], s19 offen lds
    s_add_u32 s19, s19, s20
    v_mfma_f32_16x16x32_bf16 v[128:131], v[112:115], v[80:83], v[128:131]
    ds_read_b64_tr_b16 v[64:65], v8 offset:16384
    v_mfma_f32_16x16x32_bf16 v[132:135], v[116:119], v[80:83], v[132:135]
    ds_read_b64_tr_b16 v[66:67], v9 offset:16384
    v_mfma_f32_16x16x32_bf16 v[144:147], v[112:115], v[88:91], v[144:147]
    ds_read_b64_tr_b16 v[68:69], v10 offset:16384
    v_mfma_f32_16x16x32_bf16 v[148:151], v[116:119], v[88:91], v[148:151]
    ds_read_b64_tr_b16 v[70:71], v11 offset:16384
    v_mfma_f32_16x16x32_bf16 v[160:163], v[112:115], v[96:99], v[160:163]
    ds_read_b64_tr_b16 v[72:73], v8 offset:24576
    v_mfma_f32_16x16x32_bf16 v[164:167], v[116:119], v[96:99], v[164:167]
    ds_read_b64_tr_b16 v[74:75], v9 offset:24576
    v_mfma_f32_16x16x32_bf16 v[176:179], v[112:115], v[104:107], v[176:179]
    ds_read_b64_tr_b16 v[76:77], v10 offset:24576
    v_mfma_f32_16x16x32_bf16 v[180:183], v[116:119], v[104:107], v[180:183]
    ds_read_b64_tr_b16 v[78:79], v11 offset:24576
    v_mfma_f32_16x16x32_bf16 v[128:131], v[120:123], v[84:87], v[128:131]
    ds_read_b128 v[32:35], v5 offset:0
    v_mfma_f32_16x16x32_bf16 v[132:135], v[124:127], v[84:87], v[132:135]
    ds_read_b128 v[36:39], v5 offset:1024
    v_mfma_f32_16x16x32_bf16 v[144:147], v[120:123], v[92:95], v[144:147]
    ds_read_b128 v[40:43], v5 offset:2048
    v_mfma_f32_16x16x32_bf16 v[148:151], v[124:127], v[92:95], v[148:151]
    ds_read_b128 v[44:47], v5 offset:3072
    v_mfma_f32_16x16x32_bf16 v[160:163], v[120:123], v[100:103], v[160:163]
    ds_read_b128 v[48:51], v5 offset:4096
    v_mfma_f32_16x16x32_bf16 v[164:167], v[124:127], v[100:103], v[164:167]
    ds_read_b128 v[52:55], v5 offset:5120
    v_mfma_f32_16x16x32_bf16 v[176:179], v[120:123], v[108:111], v[176:179]
    ds_read_b128 v[56:59], v5 offset:6144
    v_mfma_f32_16x16x32_bf16 v[180:183], v[124:127], v[108:111], v[180:183]
    ds_read_b128 v[60:63], v5 offset:7168
    s_waitcnt lgkmcnt(0)
    s_sub_u32 s23, s23, 1
    s_cmp_lg_u32 s23, 0
    s_cbranch_scc1 w_loopH
    v_mov_b32 v20, 131072
    ds_read_b128 v[24:27], v20
    ds_read_b128 v[28:31], v20 offset:16
    s_lshl_b32 s30, s27, 10
    s_add_u32 s30, s30, s49
    s_nop 7
    v_cvt_pk_bf16_f32 v80, v128, v129
    v_cvt_pk_bf16_f32 v81, v130, v131
    v_cvt_pk_bf16_f32 v82, v132, v133
    v_cvt_pk_bf16_f32 v83, v134, v135
    buffer_store_dwordx4 v[80:83], v1, s[4:7], s30 offen sc1
    s_add_u32 s30, s30, s50
    v_cvt_pk_bf16_f32 v84, v144, v145
    v_cvt_pk_bf16_f32 v85, v146, v147
    v_cvt_pk_bf16_f32 v86, v148, v149
    v_cvt_pk_bf16_f32 v87, v150, v151
    buffer_store_dwordx4 v[84:87], v1, s[4:7], s30 offen sc1
    s_add_u32 s30, s30, s50
    v_cvt_pk_bf16_f32 v88, v160, v161
    v_cvt_pk_bf16_f32 v89, v162, v163
    v_cvt_pk_bf16_f32 v90, v164, v165
    v_cvt_pk_bf16_f32 v91, v166, v167
    buffer_store_dwordx4 v[88:91], v1, s[4:7], s30 offen sc1
    s_add_u32 s30, s30, s50
    v_cvt_pk_bf16_f32 v92, v176, v177
    v_cvt_pk_bf16_f32 v93, v178, v179
    v_cvt_pk_bf16_f32 v94, v180, v181
    v_cvt_pk_bf16_f32 v95, v182, v183
    buffer_store_dwordx4 v[92:95], v1, s[4:7], s30 offen sc1
    s_add_u32 s30, s30, s50
    s_waitcnt lgkmcnt(0)
    v_or3_b32 v24, v24, v25, v26
    v_or3_b32 v28, v28, v29, v30
    v_or3_b32 v24, v24, v27, v31
    v_or_b32 v24, v24, v28
    s_mov_b32 s28, s51
    v_readfirstlane_b32 s30, v24
    s_cmp_lg_u32 s30, 0
    s_cbranch_scc1 w_drain
    s_mov_b32 s48, s32
    s_cmp_eq_u32 s32, 4
    s_cselect_b32 s30, 2, 3
    s_lshl_b32 s30, s26, s30
    s_mul_i32 s30, s30, s43
    s_add_u32 s49, s42, s30
    s_mov_b32 s50, s43
    s_mov_b32 s51, s46
    s_mov_b32 s23, s41
    s_mov_b32 s53, s41
    s_branch w_first4
w_drain:
    s_waitcnt vmcnt(0)
    s_barrier
    s_cmp_eq_u32 s70, 0
    s_cbranch_scc1 drw_ok
    s_mov_b32 s70, 0
    s_cmp_lg_u32 s3, 0
    s_cbranch_scc1 drw_ok
    v_readfirstlane_b32 s68, v22
    s_cmp_ge_u32 s68, 128
    s_cbranch_scc1 drw_ok
    s_mov_b32 s69, 65536
drw:
    buffer_load_dword v20, off, s[64:67], 0 offset:0 sc1
    s_waitcnt vmcnt(0)
    v_readfirstlane_b32 s68, v20
    s_cmp_ge_u32 s68, 128
    s_cbranch_scc1 drw_ok
    s_sleep 8
    s_sub_u32 s69, s69, 1
    s_cbranch_scc0 drw
drw_ok:
    s_cmp_eq_u32 s28, 0
    s_cbranch_scc1 sig_12
    s_cmp_lg_u32 s3, 0
    s_cbranch_scc1 sig_12
    s_and_b32 s57, s28, 3
    v_mov_b32 v24, s57
    s_bfe_u32 s57, s28, 0x20002
    v_mov_b32 v25, s57
    s_andn2_b32 s28, s28, 15
    s_mov_b64 exec, 1
    buffer_atomic_add_x2 v[24:25], v17, s[4:7], s28 offen sc1
    s_mov_b64 exec, -1
sig_12:
    s_mov_b32 s28, 0
    s_cmp_ge_u32 s53, 4
    s_cbranch_scc1 w_cold
    s_cmp_lg_u32 s3, 0
    s_cbranch_scc1 clm_13
    v_mov_b32 v26, 1
    s_mov_b64 exec, 1
    buffer_atomic_add v26, off, s[64:67], s71 sc0 sc1
    s_mov_b64 exec, -1
clm_13:
    s_waitcnt vmcnt(0)
    s_cmp_lg_u32 s3, 0
    s_cbranch_scc1 pub_14
    v_mov_b32 v20, 131136
    s_mov_b64 exec, 1
    ds_write_b32 v20, v26
    s_mov_b64 exec, -1
    s_waitcnt lgkmcnt(0)
pub_14:
    s_barrier
    v_mov_b32 v20, 131136
    ds_read_b32 v20, v20
    s_waitcnt lgkmcnt(0)
    v_readfirstlane_b32 s59, v20
    s_add_u32 s59, s59, 32
    s_min_u32 s59, s59, 322
    s_lshl_b32 s57, s59, 6
    s_load_dwordx16 s[32:47], s[24:25], s57
    s_waitcnt lgkmcnt(0)
    s_barrier
    s_branch w_cold
w_att:
    s_cmp_lg_u32 s3, 0
    s_cbranch_scc1 w_att_go
    s_mov_b32 s31, 0x40000
w_att_w:
    buffer_load_dwordx2 v[20:21], off, s[4:7], s33 sc1
    s_waitcnt vmcnt(0)
    v_add_u32 v20, v20, v21
    s_nop 0
    v_readfirstlane_b32 s30, v20
    s_cmp_ge_u32 s30, 8
    s_cbranch_scc1 w_att_go
    s_sleep 16
    s_sub_u32 s31, s31, 1
    s_cbranch_scc0 w_att_w
w_att_go:
    s_cmp_lg_u32 s3, 0
    s_cbranch_scc1 clm_15
    v_mov_b32 v250, 1
    s_mov_b64 exec, 1
    buffer_atomic_add v250, off, s[64:67], s71 sc0 sc1
    s_mov_b64 exec, -1
clm_15:
    s_barrier
    v_lshrrev_b32 v20, 4, v1
    v_lshrrev_b32 v21, 4, v20
    v_and_b32 v22, 15, v20
    v_lshlrev_b32 v23, 2, v21
    v_add_u32 v24, 0, v23
    v_cmp_gt_u32 s[72:73], v24, v22
    v_add_u32 v24, 1, v23
    v_cmp_gt_u32 s[74:75], v24, v22
    v_add_u32 v24, 2, v23
    v_cmp_gt_u32 s[76:77], v24, v22
    v_add_u32 v24, 3, v23
    v_cmp_gt_u32 s[78:79], v24, v22
    s_mul_i32 s83, s3, 10240
    v_and_b32 v22, 3, v20
    v_bfe_u32 v24, v20, 2, 2
    v_add_u32 v23, v23, v24
    v_lshl_add_u32 v23, v22, 4, v23
    v_lshlrev_b32 v23, 4, v23
    v_add_u32 v25, s83, v23
    v_and_b32 v24, 1, v24
    v_lshl_add_u32 v24, v21, 1, v24
    v_lshl_add_u32 v24, v22, 3, v24
    v_lshlrev_b32 v24, 4, v24
    v_add_u32 v26, s83, v24
    v_mov_b32 v22, 0xff61b1e6
    v_mov_b32 v136, 0
    v_mov_b32 v137, 0
    v_mov_b32 v220, 0
    v_mov_b32 v221, 0
    s_mov_b32 s80, 0x3e0293ee
    s_lshr_b32 s85, s3, 2
    s_add_u32 s85, s85, s39
    s_lshl_b32 s81, s85, 18
    s_and_b32 s85, s3, 3
    s_add_u32 s85, s85, s36
    s_lshl_b32 s82, s85, 13
    s_add_u32 s82, s82, s81
    s_add_u32 s82, s82, 192937984
    s_lshl_b32 s85, s85, 12
    s_add_u32 s81, s81, s85
    v_mov_b32 v28, 0x3f803f80
    v_mov_b32 v29, 0x3f803f80
    v_mov_b32 v30, 0x3f803f80
    v_mov_b32 v31, 0x3f803f80
    s_add_u32 s86, s82, 0
    buffer_load_dwordx4 v[120:123], v1, s[4:7], s86 offen offset:0 sc1
    buffer_load_dwordx4 v[124:127], v1, s[4:7], s86 offen offset:1024 sc1
    buffer_load_dwordx4 v[128:131], v1, s[4:7], s86 offen offset:2048 sc1
    buffer_load_dwordx4 v[132:135], v1, s[4:7], s86 offen offset:3072 sc1
    s_add_u32 s85, s81, 4194304
    buffer_load_dwordx4 v[56:59], v1, s[4:7], s85 offen offset:0 sc1
    buffer_load_dwordx4 v[60:63], v1, s[4:7], s85 offen offset:1024 sc1
    buffer_load_dwordx4 v[64:67], v1, s[4:7], s85 offen offset:2048 sc1
    buffer_load_dwordx4 v[68:71], v1, s[4:7], s85 offen offset:3072 sc1
    s_add_u32 s85, s81, 4325376
    buffer_load_dwordx4 v[72:75], v1, s[4:7], s85 offen offset:0 sc1
    buffer_load_dwordx4 v[76:79], v1, s[4:7], s85 offen offset:1024 sc1
    buffer_load_dwordx4 v[80:83], v1, s[4:7], s85 offen offset:2048 sc1
    buffer_load_dwordx4 v[84:87], v1, s[4:7], s85 offen offset:3072 sc1
    s_add_u32 s85, s81, 20971520
    buffer_load_dwordx4 v[88:91], v1, s[4:7], s85 offen offset:0 sc1
    buffer_load_dwordx4 v[92:95], v1, s[4:7], s85 offen offset:1024 sc1
    buffer_load_dwordx4 v[96:99], v1, s[4:7], s85 offen offset:2048 sc1
    buffer_load_dwordx4 v[100:103], v1, s[4:7], s85 offen offset:3072 sc1
    s_add_u32 s85, s81, 21102592
    buffer_load_dwordx4 v[104:107], v1, s[4:7], s85 offen offset:0 sc1
    buffer_load_dwordx4 v[108:111], v1, s[4:7], s85 offen offset:1024 sc1
    buffer_load_dwordx4 v[112:115], v1, s[4:7], s85 offen offset:2048 sc1
    buffer_load_dwordx4 v[116:119], v1, s[4:7], s85 offen offset:3072 sc1
    s_add_u32 m0, s83, 0
    s_add_u32 s85, s81, 37748736
    buffer_load_dwordx4 v1, s[4:7], s85 offen offset:0 sc1 lds
    buffer_load_dwordx4 v1, s[4:7], s85 offen offset:1024 sc1 lds
    buffer_load_dwordx4 v1, s[4:7], s85 offen offset:2048 sc1 lds
    buffer_load_dwordx4 v1, s[4:7], s85 offen offset:3072 sc1 lds
    s_add_u32 m0, s83, 4096
    s_add_u32 s85, s81, 37879808
    buffer_load_dwordx4 v1, s[4:7], s85 offen offset:0 sc1 lds
    buffer_load_dwordx4 v1, s[4:7], s85 offen offset:1024 sc1 lds
    buffer_load_dwordx4 v1, s[4:7], s85 offen offset:2048 sc1 lds
    buffer_load_dwordx4 v1, s[4:7], s85 offen offset:3072 sc1 lds
    s_add_u32 m0, s83, 8192
    s_add_u32 s85, s82, 4096
    buffer_load_dwordx4 v1, s[4:7], s85 offen offset:0 sc1 lds
    buffer_load_dwordx4 v1, s[4:7], s85 offen offset:1024 sc1 lds
    s_add_u32 s86, s82, 524288
    buffer_load_dwordx4 v[204:207], v1, s[4:7], s86 offen offset:0 sc1
    buffer_load_dwordx4 v[208:211], v1, s[4:7], s86 offen offset:1024 sc1
    buffer_load_dwordx4 v[212:215], v1, s[4:7], s86 offen offset:2048 sc1
    buffer_load_dwordx4 v[216:219], v1, s[4:7], s86 offen offset:3072 sc1
    s_add_u32 s85, s81, 4718592
    buffer_load_dwordx4 v[140:143], v1, s[4:7], s85 offen offset:0 sc1
    buffer_load_dwordx4 v[144:147], v1, s[4:7], s85 offen offset:1024 sc1
    buffer_load_dwordx4 v[148:151], v1, s[4:7], s85 offen offset:2048 sc1
    buffer_load_dwordx4 v[152:155], v1, s[4:7], s85 offen offset:3072 sc1
    s_add_u32 s85, s81, 4849664
    buffer_load_dwordx4 v[156:159], v1, s[4:7], s85 offen offset:0 sc1
    buffer_load_dwordx4 v[160:163], v1, s[4:7], s85 offen offset:1024 sc1
    buffer_load_dwordx4 v[164:167], v1, s[4:7], s85 offen offset:2048 sc1
    buffer_load_dwordx4 v[168:171], v1, s[4:7], s85 offen offset:3072 sc1
    s_add_u32 s85, s81, 21495808
    buffer_load_dwordx4 v[172:175], v1, s[4:7], s85 offen offset:0 sc1
    buffer_load_dwordx4 v[176:179], v1, s[4:7], s85 offen offset:1024 sc1
    buffer_load_dwordx4 v[180:183], v1, s[4:7], s85 offen offset:2048 sc1
    buffer_load_dwordx4 v[184:187], v1, s[4:7], s85 offen offset:3072 sc1
    s_add_u32 s85, s81, 21626880
    buffer_load_dwordx4 v[188:191], v1, s[4:7], s85 offen offset:0 sc1
    buffer_load_dwordx4 v[192:195], v1, s[4:7], s85 offen offset:1024 sc1
    buffer_load_dwordx4 v[196:199], v1, s[4:7], s85 offen offset:2048 sc1
    buffer_load_dwordx4 v[200:203], v1, s[4:7], s85 offen offset:3072 sc1
    s_add_u32 m0, s83, 81920
    s_add_u32 s85, s81, 38273024
    buffer_load_dwordx4 v1, s[4:7], s85 offen offset:0 sc1 lds
    buffer_load_dwordx4 v1, s[4:7], s85 offen offset:1024 sc1 lds
    buffer_load_dwordx4 v1, s[4:7], s85 offen offset:2048 sc1 lds
    buffer_load_dwordx4 v1, s[4:7], s85 offen offset:3072 sc1 lds
    s_add_u32 m0, s83, 86016
    s_add_u32 s85, s81, 38404096
    buffer_load_dwordx4 v1, s[4:7], s85 offen offset:0 sc1 lds
    buffer_load_dwordx4 v1, s[4:7], s85 offen offset:1024 sc1 lds
    buffer_load_dwordx4 v1, s[4:7], s85 offen offset:2048 sc1 lds
    buffer_load_dwordx4 v1, s[4:7], s85 offen offset:3072 sc1 lds
    s_add_u32 m0, s83, 90112
    s_add_u32 s85, s82, 528384
    buffer_load_dwordx4 v1, s[4:7], s85 offen offset:0 sc1 lds
    buffer_load_dwordx4 v1, s[4:7], s85 offen offset:1024 sc1 lds
    s_waitcnt vmcnt(40)
    v_mfma_f32_16x16x32_bf16 v[32:35], v[88:91], v[56:59], 0
    v_mfma_f32_16x16x32_bf16 v[40:43], v[120:123], v[56:59], 0
    v_mfma_f32_16x16x32_bf16 v[32:35], v[92:95], v[60:63], v[32:35]
    v_mfma_f32_16x16x32_bf16 v[40:43], v[124:127], v[60:63], v[40:43]
    v_mfma_f32_16x16x32_bf16 v[32:35], v[96:99], v[64:67], v[32:35]
    v_mfma_f32_16x16x32_bf16 v[40:43], v[128:131], v[64:67], v[40:43]
    v_mfma_f32_16x16x32_bf16 v[32:35], v[100:103], v[68:71], v[32:35]
    v_mfma_f32_16x16x32_bf16 v[40:43], v[132:135], v[68:71], v[40:43]
    v_mfma_f32_16x16x32_bf16 v[44:47], v[88:91], v[72:75], 0
    v_mfma_f32_16x16x32_bf16 v[48:51], v[104:107], v[72:75], 0
    v_mfma_f32_16x16x32_bf16 v[52:55], v[120:123], v[72:75], 0
    v_mfma_f32_16x16x32_bf16 v[44:47], v[92:95], v[76:79], v[44:47]
    v_mfma_f32_16x16x32_bf16 v[48:51], v[108:111], v[76:79], v[48:51]
    v_mfma_f32_16x16x32_bf16 v[52:55], v[124:127], v[76:79], v[52:55]
    v_mfma_f32_16x16x32_bf16 v[44:47], v[96:99], v[80:83], v[44:47]
    v_mfma_f32_16x16x32_bf16 v[48:51], v[112:115], v[80:83], v[48:51]
    v_mfma_f32_16x16x32_bf16 v[52:55], v[128:131], v[80:83], v[52:55]
    v_mfma_f32_16x16x32_bf16 v[44:47], v[100:103], v[84:87], v[44:47]
    v_mfma_f32_16x16x32_bf16 v[48:51], v[116:119], v[84:87], v[48:51]
    v_mfma_f32_16x16x32_bf16 v[52:55], v[132:135], v[84:87], v[52:55]
    v_cndmask_b32 v32, v32, v22, s[72:73]
    v_cndmask_b32 v33, v33, v22, s[74:75]
    v_cndmask_b32 v34, v34, v22, s[76:77]
    v_cndmask_b32 v35, v35, v22, s[78:79]
    v_max3_f32 v20, v32, v33, v34
    v_max3_f32 v21, v35, v40, v41
    v_max_f32 v20, v20, v21
    v_mov_b32 v21, v20
    s_nop 1
    v_permlane16_swap_b32 v21, v20
    v_max_f32 v20, v20, v21
    v_mov_b32 v21, v20
    s_nop 1
    v_permlane32_swap_b32 v21, v20
    v_max_f32 v20, v20, v21
    v_mul_f32 v20, s80, v20
    v_fma_f32 v32, v32, s80, -v20
    v_fma_f32 v33, v33, s80, -v20
    v_fma_f32 v34, v34, s80, -v20
    v_fma_f32 v35, v35, s80, -v20
    v_fma_f32 v40, v40, s80, -v20
    v_fma_f32 v41, v41, s80, -v20
    v_exp_f32 v32, v32
    v_exp_f32 v33, v33
    v_exp_f32 v34, v34
    v_exp_f32 v35, v35
    v_exp_f32 v40, v40
    v_exp_f32 v41, v41
    s_nop 0
    v_cvt_pk_bf16_f32 v32, v32, v33
    v_cvt_pk_bf16_f32 v33, v34, v35
    v_mov_b32 v34, 0
    v_mov_b32 v35, 0
    v_cvt_pk_bf16_f32 v40, v40, v41
    v_mov_b32 v41, 0
    v_mov_b32 v42, 0
    v_mov_b32 v43, 0
    s_nop 1
    s_waitcnt vmcnt(30)
    ds_read_b64_tr_b16 v[56:57], v25 offset:0
    ds_read_b64_tr_b16 v[58:59], v25 offset:4096
    ds_read_b64_tr_b16 v[120:121], v26 offset:8192
    ds_read_b64_tr_b16 v[60:61], v25 offset:8
    ds_read_b64_tr_b16 v[62:63], v25 offset:4104
    ds_read_b64_tr_b16 v[122:123], v26 offset:8200
    ds_read_b64_tr_b16 v[64:65], v25 offset:1024
    ds_read_b64_tr_b16 v[66:67], v25 offset:5120
    ds_read_b64_tr_b16 v[124:125], v26 offset:8704
    ds_read_b64_tr_b16 v[68:69], v25 offset:1032
    ds_read_b64_tr_b16 v[70:71], v25 offset:5128
    ds_read_b64_tr_b16 v[126:127], v26 offset:8712
    ds_read_b64_tr_b16 v[72:73], v25 offset:2048
    ds_read_b64_tr_b16 v[74:75], v25 offset:6144
    ds_read_b64_tr_b16 v[128:129], v26 offset:9216
    ds_read_b64_tr_b16 v[76:77], v25 offset:2056
    ds_read_b64_tr_b16 v[78:79], v25 offset:6152
    ds_read_b64_tr_b16 v[130:131], v26 offset:9224
    ds_read_b64_tr_b16 v[80:81], v25 offset:3072
    ds_read_b64_tr_b16 v[82:83], v25 offset:7168
    ds_read_b64_tr_b16 v[132:133], v26 offset:9728
    ds_read_b64_tr_b16 v[84:85], v25 offset:3080
    ds_read_b64_tr_b16 v[86:87], v25 offset:7176
    ds_read_b64_tr_b16 v[134:135], v26 offset:9736
    v_cndmask_b32 v48, v48, v22, s[72:73]
    v_cndmask_b32 v49, v49, v22, s[74:75]
    v_cndmask_b32 v50, v50, v22, s[76:77]
    v_cndmask_b32 v51, v51, v22, s[78:79]
    v_max3_f32 v20, v44, v45, v46
    v_max3_f32 v21, v47, v48, v49
    v_max3_f32 v20, v20, v50, v51
    v_max3_f32 v21, v21, v52, v53
    v_max_f32 v20, v20, v21
    v_mov_b32 v21, v20
    s_nop 1
    v_permlane16_swap_b32 v21, v20
    v_max_f32 v20, v20, v21
    v_mov_b32 v21, v20
    s_nop 1
    v_permlane32_swap_b32 v21, v20
    v_max_f32 v20, v20, v21
    v_mul_f32 v20, s80, v20
    v_fma_f32 v44, v44, s80, -v20
    v_fma_f32 v45, v45, s80, -v20
    v_fma_f32 v46, v46, s80, -v20
    v_fma_f32 v47, v47, s80, -v20
    v_fma_f32 v48, v48, s80, -v20
    v_fma_f32 v49, v49, s80, -v20
    v_fma_f32 v50, v50, s80, -v20
    v_fma_f32 v51, v51, s80, -v20
    v_fma_f32 v52, v52, s80, -v20
    v_fma_f32 v53, v53, s80, -v20
    v_exp_f32 v44, v44
    v_exp_f32 v45, v45
    v_exp_f32 v46, v46
    v_exp_f32 v47, v47
    v_exp_f32 v48, v48
    v_exp_f32 v49, v49
    v_exp_f32 v50, v50
    v_exp_f32 v51, v51
    v_exp_f32 v52, v52
    v_exp_f32 v53, v53
    s_nop 0
    v_cvt_pk_bf16_f32 v44, v44, v45
    v_cvt_pk_bf16_f32 v45, v46, v47
    v_cvt_pk_bf16_f32 v46, v48, v49
    v_cvt_pk_bf16_f32 v47, v50, v51
    v_cvt_pk_bf16_f32 v52, v52, v53
    v_mov_b32 v53, 0
    v_mov_b32 v54, 0
    v_mov_b32 v55, 0
    s_nop 1
    s_waitcnt lgkmcnt(0)
    v_mfma_f32_16x16x32_bf16 v[36:39], v[28:31], v[32:35], 0
    v_mfma_f32_16x16x32_bf16 v[36:39], v[28:31], v[40:43], v[36:39]
    v_mfma_f32_16x16x32_bf16 v[88:91], v[56:59], v[32:35], 0
    v_mfma_f32_16x16x32_bf16 v[88:91], v[120:123], v[40:43], v[88:91]
    v_mfma_f32_16x16x32_bf16 v[92:95], v[60:63], v[32:35], 0
    v_mfma_f32_16x16x32_bf16 v[92:95], v[122:125], v[40:43], v[92:95]
    v_mfma_f32_16x16x32_bf16 v[96:99], v[64:67], v[32:35], 0
    v_mfma_f32_16x16x32_bf16 v[96:99], v[124:127], v[40:43], v[96:99]
    v_mfma_f32_16x16x32_bf16 v[100:103], v[68:71], v[32:35], 0
    v_mfma_f32_16x16x32_bf16 v[100:103], v[126:129], v[40:43], v[100:103]
    v_mfma_f32_16x16x32_bf16 v[104:107], v[72:75], v[32:35], 0
    v_mfma_f32_16x16x32_bf16 v[104:107], v[128:131], v[40:43], v[104:107]
    v_mfma_f32_16x16x32_bf16 v[108:111], v[76:79], v[32:35], 0
    v_mfma_f32_16x16x32_bf16 v[108:111], v[130:133], v[40:43], v[108:111]
    v_mfma_f32_16x16x32_bf16 v[112:115], v[80:83], v[32:35], 0
    v_mfma_f32_16x16x32_bf16 v[112:115], v[132:135], v[40:43], v[112:115]
    v_mfma_f32_16x16x32_bf16 v[116:119], v[84:87], v[32:35], 0
    v_mfma_f32_16x16x32_bf16 v[116:119], v[134:137], v[40:43], v[116:119]
    v_rcp_f32 v23, v36
    s_add_u32 s85, s81, 176160768
    v_mul_f32 v88, v88, v23
    v_mul_f32 v89, v89, v23
    v_mul_f32 v90, v90, v23
    v_mul_f32 v91, v91, v23
    v_mul_f32 v92, v92, v23
    v_mul_f32 v93, v93, v23
    v_mul_f32 v94, v94, v23
    v_mul_f32 v95, v95, v23
    v_cvt_pk_bf16_f32 v224, v88, v89
    v_cvt_pk_bf16_f32 v225, v90, v91
    v_cvt_pk_bf16_f32 v226, v92, v93
    v_cvt_pk_bf16_f32 v227, v94, v95
    buffer_store_dwordx4 v[224:227], v1, s[4:7], s85 offen offset:0 sc1
    v_mul_f32 v96, v96, v23
    v_mul_f32 v97, v97, v23
    v_mul_f32 v98, v98, v23
    v_mul_f32 v99, v99, v23
    v_mul_f32 v100, v100, v23
    v_mul_f32 v101, v101, v23
    v_mul_f32 v102, v102, v23
    v_mul_f32 v103, v103, v23
    v_cvt_pk_bf16_f32 v228, v96, v97
    v_cvt_pk_bf16_f32 v229, v98, v99
    v_cvt_pk_bf16_f32 v230, v100, v101
    v_cvt_pk_bf16_f32 v231, v102, v103
    buffer_store_dwordx4 v[228:231], v1, s[4:7], s85 offen offset:1024 sc1
    v_mul_f32 v104, v104, v23
    v_mul_f32 v105, v105, v23
    v_mul_f32 v106, v106, v23
    v_mul_f32 v107, v107, v23
    v_mul_f32 v108, v108, v23
    v_mul_f32 v109, v109, v23
    v_mul_f32 v110, v110, v23
    v_mul_f32 v111, v111, v23
    v_cvt_pk_bf16_f32 v232, v104, v105
    v_cvt_pk_bf16_f32 v233, v106, v107
    v_cvt_pk_bf16_f32 v234, v108, v109
    v_cvt_pk_bf16_f32 v235, v110, v111
    buffer_store_dwordx4 v[232:235], v1, s[4:7], s85 offen offset:2048 sc1
    v_mul_f32 v112, v112, v23
    v_mul_f32 v113, v113, v23
    v_mul_f32 v114, v114, v23
    v_mul_f32 v115, v115, v23
    v_mul_f32 v116, v116, v23
    v_mul_f32 v117, v117, v23
    v_mul_f32 v118, v118, v23
    v_mul_f32 v119, v119, v23
    v_cvt_pk_bf16_f32 v236, v112, v113
    v_cvt_pk_bf16_f32 v237, v114, v115
    v_cvt_pk_bf16_f32 v238, v116, v117
    v_cvt_pk_bf16_f32 v239, v118, v119
    buffer_store_dwordx4 v[236:239], v1, s[4:7], s85 offen offset:3072 sc1
    v_mfma_f32_16x16x32_bf16 v[48:51], v[28:31], v[44:47], 0
    v_mfma_f32_16x16x32_bf16 v[48:51], v[28:31], v[52:55], v[48:51]
    v_mfma_f32_16x16x32_bf16 v[88:91], v[56:59], v[44:47], 0
    v_mfma_f32_16x16x32_bf16 v[88:91], v[120:123], v[52:55], v[88:91]
    v_mfma_f32_16x16x32_bf16 v[92:95], v[60:63], v[44:47], 0
    v_mfma_f32_16x16x32_bf16 v[92:95], v[122:125], v[52:55], v[92:95]
    v_mfma_f32_16x16x32_bf16 v[96:99], v[64:67], v[44:47], 0
    v_mfma_f32_16x16x32_bf16 v[96:99], v[124:127], v[52:55], v[96:99]
    v_mfma_f32_16x16x32_bf16 v[100:103], v[68:71], v[44:47], 0
    v_mfma_f32_16x16x32_bf16 v[100:103], v[126:129], v[52:55], v[100:103]
    v_mfma_f32_16x16x32_bf16 v[104:107], v[72:75], v[44:47], 0
    v_mfma_f32_16x16x32_bf16 v[104:107], v[128:131], v[52:55], v[104:107]
    v_mfma_f32_16x16x32_bf16 v[108:111], v[76:79], v[44:47], 0
    v_mfma_f32_16x16x32_bf16 v[108:111], v[130:133], v[52:55], v[108:111]
    v_mfma_f32_16x16x32_bf16 v[112:115], v[80:83], v[44:47], 0
    v_mfma_f32_16x16x32_bf16 v[112:115], v[132:135], v[52:55], v[112:115]
    v_mfma_f32_16x16x32_bf16 v[116:119], v[84:87], v[44:47], 0
    v_mfma_f32_16x16x32_bf16 v[116:119], v[134:137], v[52:55], v[116:119]
    v_rcp_f32 v23, v48
    s_add_u32 s85, s81, 176291840
    v_mul_f32 v88, v88, v23
    v_mul_f32 v89, v89, v23
    v_mul_f32 v90, v90, v23
    v_mul_f32 v91, v91, v23
    v_mul_f32 v92, v92, v23
    v_mul_f32 v93, v93, v23
    v_mul_f32 v94, v94, v23
    v_mul_f32 v95, v95, v23
    v_cvt_pk_bf16_f32 v224, v88, v89
    v_cvt_pk_bf16_f32 v225, v90, v91
    v_cvt_pk_bf16_f32 v226, v92, v93
    v_cvt_pk_bf16_f32 v227, v94, v95
    buffer_store_dwordx4 v[224:227], v1, s[4:7], s85 offen offset:0 sc1
    v_mul_f32 v96, v96, v23
    v_mul_f32 v97, v97, v23
    v_mul_f32 v98, v98, v23
    v_mul_f32 v99, v99, v23
    v_mul_f32 v100, v100, v23
    v_mul_f32 v101, v101, v23
    v_mul_f32 v102, v102, v23
    v_mul_f32 v103, v103, v23
    v_cvt_pk_bf16_f32 v228, v96, v97
    v_cvt_pk_bf16_f32 v229, v98, v99
    v_cvt_pk_bf16_f32 v230, v100, v101
    v_cvt_pk_bf16_f32 v231, v102, v103
    buffer_store_dwordx4 v[228:231], v1, s[4:7], s85 offen offset:1024 sc1
    v_mul_f32 v104, v104, v23
    v_mul_f32 v105, v105, v23
    v_mul_f32 v106, v106, v23
    v_mul_f32 v107, v107, v23
    v_mul_f32 v108, v108, v23
    v_mul_f32 v109, v109, v23
    v_mul_f32 v110, v110, v23
    v_mul_f32 v111, v111, v23
    v_cvt_pk_bf16_f32 v232, v104, v105
    v_cvt_pk_bf16_f32 v233, v106, v107
    v_cvt_pk_bf16_f32 v234, v108, v109
    v_cvt_pk_bf16_f32 v235, v110, v111
    buffer_store_dwordx4 v[232:235], v1, s[4:7], s85 offen offset:2048 sc1
    v_mul_f32 v112, v112, v23
    v_mul_f32 v113, v113, v23
    v_mul_f32 v114, v114, v23
    v_mul_f32 v115, v115, v23
    v_mul_f32 v116, v116, v23
    v_mul_f32 v117, v117, v23
    v_mul_f32 v118, v118, v23
    v_mul_f32 v119, v119, v23
    v_cvt_pk_bf16_f32 v236, v112, v113
    v_cvt_pk_bf16_f32 v237, v114, v115
    v_cvt_pk_bf16_f32 v238, v116, v117
    v_cvt_pk_bf16_f32 v239, v118, v119
    buffer_store_dwordx4 v[236:239], v1, s[4:7], s85 offen offset:3072 sc1
    s_waitcnt vmcnt(18)
    v_mfma_f32_16x16x32_bf16 v[32:35], v[172:175], v[140:143], 0
    v_mfma_f32_16x16x32_bf16 v[40:43], v[204:207], v[140:143], 0
    v_mfma_f32_16x16x32_bf16 v[32:35], v[176:179], v[144:147], v[32:35]
    v_mfma_f32_16x16x32_bf16 v[40:43], v[208:211], v[144:147], v[40:43]
    v_mfma_f32_16x16x32_bf16 v[32:35], v[180:183], v[148:151], v[32:35]
    v_mfma_f32_16x16x32_bf16 v[40:43], v[212:215], v[148:151], v[40:43]
    v_mfma_f32_16x16x32_bf16 v[32:35], v[184:187], v[152:155], v[32:35]
    v_mfma_f32_16x16x32_bf16 v[40:43], v[216:219], v[152:155], v[40:43]
    v_mfma_f32_16x16x32_bf16 v[44:47], v[172:175], v[156:159], 0
    v_mfma_f32_16x16x32_bf16 v[48:51], v[188:191], v[156:159], 0
    v_mfma_f32_16x16x32_bf16 v[52:55], v[204:207], v[156:159], 0
    v_mfma_f32_16x16x32_bf16 v[44:47], v[176:179], v[160:163], v[44:47]
    v_mfma_f32_16x16x32_bf16 v[48:51], v[192:195], v[160:163], v[48:51]
    v_mfma_f32_16x16x32_bf16 v[52:55], v[208:211], v[160:163], v[52:55]
    v_mfma_f32_16x16x32_bf16 v[44:47], v[180:183], v[164:167], v[44:47]
    v_mfma_f32_16x16x32_bf16 v[48:51], v[196:199], v[164:167], v[48:51]
    v_mfma_f32_16x16x32_bf16 v[52:55], v[212:215], v[164:167], v[52:55]
    v_mfma_f32_16x16x32_bf16 v[44:47], v[184:187], v[168:171], v[44:47]
    v_mfma_f32_16x16x32_bf16 v[48:51], v[200:203], v[168:171], v[48:51]
    v_mfma_f32_16x16x32_bf16 v[52:55], v[216:219], v[168:171], v[52:55]
    v_cndmask_b32 v32, v32, v22, s[72:73]
    v_cndmask_b32 v33, v33, v22, s[74:75]
    v_cndmask_b32 v34, v34, v22, s[76:77]
    v_cndmask_b32 v35, v35, v22, s[78:79]
    v_max3_f32 v20, v32, v33, v34
    v_max3_f32 v21, v35, v40, v41
    v_max_f32 v20, v20, v21
    v_mov_b32 v21, v20
    s_nop 1
    v_permlane16_swap_b32 v21, v20
    v_max_f32 v20, v20, v21
    v_mov_b32 v21, v20
    s_nop 1
    v_permlane32_swap_b32 v21, v20
    v_max_f32 v20, v20, v21
    v_mul_f32 v20, s80, v20
    v_fma_f32 v32, v32, s80, -v20
    v_fma_f32 v33, v33, s80, -v20
    v_fma_f32 v34, v34, s80, -v20
    v_fma_f32 v35, v35, s80, -v20
    v_fma_f32 v40, v40, s80, -v20
    v_fma_f32 v41, v41, s80, -v20
    v_exp_f32 v32, v32
    v_exp_f32 v33, v33
    v_exp_f32 v34, v34
    v_exp_f32 v35, v35
    v_exp_f32 v40, v40
    v_exp_f32 v41, v41
    s_nop 0
    v_cvt_pk_bf16_f32 v32, v32, v33
    v_cvt_pk_bf16_f32 v33, v34, v35
    v_mov_b32 v34, 0
    v_mov_b32 v35, 0
    v_cvt_pk_bf16_f32 v40, v40, v41
    v_mov_b32 v41, 0
    v_mov_b32 v42, 0
    v_mov_b32 v43, 0
    s_nop 1
    s_waitcnt vmcnt(8)
    v_add_u32 v25, 81920, v25
    v_add_u32 v26, 81920, v26
    ds_read_b64_tr_b16 v[140:141], v25 offset:0
    ds_read_b64_tr_b16 v[142:143], v25 offset:4096
    ds_read_b64_tr_b16 v[204:205], v26 offset:8192
    ds_read_b64_tr_b16 v[144:145], v25 offset:8
    ds_read_b64_tr_b16 v[146:147], v25 offset:4104
    ds_read_b64_tr_b16 v[206:207], v26 offset:8200
    ds_read_b64_tr_b16 v[148:149], v25 offset:1024
    ds_read_b64_tr_b16 v[150:151], v25 offset:5120
    ds_read_b64_tr_b16 v[208:209], v26 offset:8704
    ds_read_b64_tr_b16 v[152:153], v25 offset:1032
    ds_read_b64_tr_b16 v[154:155], v25 offset:5128
    ds_read_b64_tr_b16 v[210:211], v26 offset:8712
    ds_read_b64_tr_b16 v[156:157], v25 offset:2048
    ds_read_b64_tr_b16 v[158:159], v25 offset:6144
    ds_read_b64_tr_b16 v[212:213], v26 offset:9216
    ds_read_b64_tr_b16 v[160:161], v25 offset:2056
    ds_read_b64_tr_b16 v[162:163], v25 offset:6152
    ds_read_b64_tr_b16 v[214:215], v26 offset:9224
    ds_read_b64_tr_b16 v[164:165], v25 offset:3072
    ds_read_b64_tr_b16 v[166:167], v25 offset:7168
    ds_read_b64_tr_b16 v[216:217], v26 offset:9728
    ds_read_b64_tr_b16 v[168:169], v25 offset:3080
    ds_read_b64_tr_b16 v[170:171], v25 offset:7176
    ds_read_b64_tr_b16 v[218:219], v26 offset:9736
    v_cndmask_b32 v48, v48, v22, s[72:73]
    v_cndmask_b32 v49, v49, v22, s[74:75]
    v_cndmask_b32 v50, v50, v22, s[76:77]
    v_cndmask_b32 v51, v51, v22, s[78:79]
    v_max3_f32 v20, v44, v45, v46
    v_max3_f32 v21, v47, v48, v49
    v_max3_f32 v20, v20, v50, v51
    v_max3_f32 v21, v21, v52, v53
    v_max_f32 v20, v20, v21
    v_mov_b32 v21, v20
    s_nop 1
    v_permlane16_swap_b32 v21, v20
    v_max_f32 v20, v20, v21
    v_mov_b32 v21, v20
    s_nop 1
    v_permlane32_swap_b32 v21, v20
    v_max_f32 v20, v20, v21
    v_mul_f32 v20, s80, v20
    v_fma_f32 v44, v44, s80, -v20
    v_fma_f32 v45, v45, s80, -v20
    v_fma_f32 v46, v46, s80, -v20
    v_fma_f32 v47, v47, s80, -v20
    v_fma_f32 v48, v48, s80, -v20
    v_fma_f32 v49, v49, s80, -v20
    v_fma_f32 v50, v50, s80, -v20
    v_fma_f32 v51, v51, s80, -v20
    v_fma_f32 v52, v52, s80, -v20
    v_fma_f32 v53, v53, s80, -v20
    v_exp_f32 v44, v44
    v_exp_f32 v45, v45
    v_exp_f32 v46, v46
    v_exp_f32 v47, v47
    v_exp_f32 v48, v48
    v_exp_f32 v49, v49
    v_exp_f32 v50, v50
    v_exp_f32 v51, v51
    v_exp_f32 v52, v52
    v_exp_f32 v53, v53
    s_nop 0
    v_cvt_pk_bf16_f32 v44, v44, v45
    v_cvt_pk_bf16_f32 v45, v46, v47
    v_cvt_pk_bf16_f32 v46, v48, v49
    v_cvt_pk_bf16_f32 v47, v50, v51
    v_cvt_pk_bf16_f32 v52, v52, v53
    v_mov_b32 v53, 0
    v_mov_b32 v54, 0
    v_mov_b32 v55, 0
    s_nop 1
    s_waitcnt lgkmcnt(0)
    v_mfma_f32_16x16x32_bf16 v[36:39], v[28:31], v[32:35], 0
    v_mfma_f32_16x16x32_bf16 v[36:39], v[28:31], v[40:43], v[36:39]
    v_mfma_f32_16x16x32_bf16 v[172:175], v[140:143], v[32:35], 0
    v_mfma_f32_16x16x32_bf16 v[172:175], v[204:207], v[40:43], v[172:175]
    v_mfma_f32_16x16x32_bf16 v[176:179], v[144:147], v[32:35], 0
    v_mfma_f32_16x16x32_bf16 v[176:179], v[206:209], v[40:43], v[176:179]
    v_mfma_f32_16x16x32_bf16 v[180:183], v[148:151], v[32:35], 0
    v_mfma_f32_16x16x32_bf16 v[180:183], v[208:211], v[40:43], v[180:183]
    v_mfma_f32_16x16x32_bf16 v[184:187], v[152:155], v[32:35], 0
    v_mfma_f32_16x16x32_bf16 v[184:187], v[210:213], v[40:43], v[184:187]
    v_mfma_f32_16x16x32_bf16 v[188:191], v[156:159], v[32:35], 0
    v_mfma_f32_16x16x32_bf16 v[188:191], v[212:215], v[40:43], v[188:191]
    v_mfma_f32_16x16x32_bf16 v[192:195], v[160:163], v[32:35], 0
    v_mfma_f32_16x16x32_bf16 v[192:195], v[214:217], v[40:43], v[192:195]
    v_mfma_f32_16x16x32_bf16 v[196:199], v[164:167], v[32:35], 0
    v_mfma_f32_16x16x32_bf16 v[196:199], v[216:219], v[40:43], v[196:199]
    v_mfma_f32_16x16x32_bf16 v[200:203], v[168:171], v[32:35], 0
    v_mfma_f32_16x16x32_bf16 v[200:203], v[218:221], v[40:43], v[200:203]
    v_rcp_f32 v23, v36
    s_add_u32 s85, s81, 176685056
    v_mul_f32 v172, v172, v23
    v_mul_f32 v173, v173, v23
    v_mul_f32 v174, v174, v23
    v_mul_f32 v175, v175, v23
    v_mul_f32 v176, v176, v23
    v_mul_f32 v177, v177, v23
    v_mul_f32 v178, v178, v23
    v_mul_f32 v179, v179, v23
    v_cvt_pk_bf16_f32 v224, v172, v173
    v_cvt_pk_bf16_f32 v225, v174, v175
    v_cvt_pk_bf16_f32 v226, v176, v177
    v_cvt_pk_bf16_f32 v227, v178, v179
    buffer_store_dwordx4 v[224:227], v1, s[4:7], s85 offen offset:0 sc1
    v_mul_f32 v180, v180, v23
    v_mul_f32 v181, v181, v23
    v_mul_f32 v182, v182, v23
    v_mul_f32 v183, v183, v23
    v_mul_f32 v184, v184, v23
    v_mul_f32 v185, v185, v23
    v_mul_f32 v186, v186, v23
    v_mul_f32 v187, v187, v23
    v_cvt_pk_bf16_f32 v228, v180, v181
    v_cvt_pk_bf16_f32 v229, v182, v183
    v_cvt_pk_bf16_f32 v230, v184, v185
    v_cvt_pk_bf16_f32 v231, v186, v187
    buffer_store_dwordx4 v[228:231], v1, s[4:7], s85 offen offset:1024 sc1
    v_mul_f32 v188, v188, v23
    v_mul_f32 v189, v189, v23
    v_mul_f32 v190, v190, v23
    v_mul_f32 v191, v191, v23
    v_mul_f32 v192, v192, v23
    v_mul_f32 v193, v193, v23
    v_mul_f32 v194, v194, v23
    v_mul_f32 v195, v195, v23
    v_cvt_pk_bf16_f32 v232, v188, v189
    v_cvt_pk_bf16_f32 v233, v190, v191
    v_cvt_pk_bf16_f32 v234, v192, v193
    v_cvt_pk_bf16_f32 v235, v194, v195
    buffer_store_dwordx4 v[232:235], v1, s[4:7], s85 offen offset:2048 sc1
    v_mul_f32 v196, v196, v23
    v_mul_f32 v197, v197, v23
    v_mul_f32 v198, v198, v23
    v_mul_f32 v199, v199, v23
    v_mul_f32 v200, v200, v23
    v_mul_f32 v201, v201, v23
    v_mul_f32 v202, v202, v23
    v_mul_f32 v203, v203, v23
    v_cvt_pk_bf16_f32 v236, v196, v197
    v_cvt_pk_bf16_f32 v237, v198, v199
    v_cvt_pk_bf16_f32 v238, v200, v201
    v_cvt_pk_bf16_f32 v239, v202, v203
    buffer_store_dwordx4 v[236:239], v1, s[4:7], s85 offen offset:3072 sc1
    v_mfma_f32_16x16x32_bf16 v[48:51], v[28:31], v[44:47], 0
    v_mfma_f32_16x16x32_bf16 v[48:51], v[28:31], v[52:55], v[48:51]
    v_mfma_f32_16x16x32_bf16 v[172:175], v[140:143], v[44:47], 0
    v_mfma_f32_16x16x32_bf16 v[172:175], v[204:207], v[52:55], v[172:175]
    v_mfma_f32_16x16x32_bf16 v[176:179], v[144:147], v[44:47], 0
    v_mfma_f32_16x16x32_bf16 v[176:179], v[206:209], v[52:55], v[176:179]
    v_mfma_f32_16x16x32_bf16 v[180:183], v[148:151], v[44:47], 0
    v_mfma_f32_16x16x32_bf16 v[180:183], v[208:211], v[52:55], v[180:183]
    v_mfma_f32_16x16x32_bf16 v[184:187], v[152:155], v[44:47], 0
    v_mfma_f32_16x16x32_bf16 v[184:187], v[210:213], v[52:55], v[184:187]
    v_mfma_f32_16x16x32_bf16 v[188:191], v[156:159], v[44:47], 0
    v_mfma_f32_16x16x32_bf16 v[188:191], v[212:215], v[52:55], v[188:191]
    v_mfma_f32_16x16x32_bf16 v[192:195], v[160:163], v[44:47], 0
    v_mfma_f32_16x16x32_bf16 v[192:195], v[214:217], v[52:55], v[192:195]
    v_mfma_f32_16x16x32_bf16 v[196:199], v[164:167], v[44:47], 0
    v_mfma_f32_16x16x32_bf16 v[196:199], v[216:219], v[52:55], v[196:199]
    v_mfma_f32_16x16x32_bf16 v[200:203], v[168:171], v[44:47], 0
    v_mfma_f32_16x16x32_bf16 v[200:203], v[218:221], v[52:55], v[200:203]
    v_rcp_f32 v23, v48
    s_add_u32 s85, s81, 176816128
    v_mul_f32 v172, v172, v23
    v_mul_f32 v173, v173, v23
    v_mul_f32 v174, v174, v23
    v_mul_f32 v175, v175, v23
    v_mul_f32 v176, v176, v23
    v_mul_f32 v177, v177, v23
    v_mul_f32 v178, v178, v23
    v_mul_f32 v179, v179, v23
    v_cvt_pk_bf16_f32 v224, v172, v173
    v_cvt_pk_bf16_f32 v225, v174, v175
    v_cvt_pk_bf16_f32 v226, v176, v177
    v_cvt_pk_bf16_f32 v227, v178, v179
    buffer_store_dwordx4 v[224:227], v1, s[4:7], s85 offen offset:0 sc1
    v_mul_f32 v180, v180, v23
    v_mul_f32 v181, v181, v23
    v_mul_f32 v182, v182, v23
    v_mul_f32 v183, v183, v23
    v_mul_f32 v184, v184, v23
    v_mul_f32 v185, v185, v23
    v_mul_f32 v186, v186, v23
    v_mul_f32 v187, v187, v23
    v_cvt_pk_bf16_f32 v228, v180, v181
    v_cvt_pk_bf16_f32 v229, v182, v183
    v_cvt_pk_bf16_f32 v230, v184, v185
    v_cvt_pk_bf16_f32 v231, v186, v187
    buffer_store_dwordx4 v[228:231], v1, s[4:7], s85 offen offset:1024 sc1
    v_mul_f32 v188, v188, v23
    v_mul_f32 v189, v189, v23
    v_mul_f32 v190, v190, v23
    v_mul_f32 v191, v191, v23
    v_mul_f32 v192, v192, v23
    v_mul_f32 v193, v193, v23
    v_mul_f32 v194, v194, v23
    v_mul_f32 v195, v195, v23
    v_cvt_pk_bf16_f32 v232, v188, v189
    v_cvt_pk_bf16_f32 v233, v190, v191
    v_cvt_pk_bf16_f32 v234, v192, v193
    v_cvt_pk_bf16_f32 v235, v194, v195
    buffer_store_dwordx4 v[232:235], v1, s[4:7], s85 offen offset:2048 sc1
    v_mul_f32 v196, v196, v23
    v_mul_f32 v197, v197, v23
    v_mul_f32 v198, v198, v23
    v_mul_f32 v199, v199, v23
    v_mul_f32 v200, v200, v23
    v_mul_f32 v201, v201, v23
    v_mul_f32 v202, v202, v23
    v_mul_f32 v203, v203, v23
    v_cvt_pk_bf16_f32 v236, v196, v197
    v_cvt_pk_bf16_f32 v237, v198, v199
    v_cvt_pk_bf16_f32 v238, v200, v201
    v_cvt_pk_bf16_f32 v239, v202, v203
    buffer_store_dwordx4 v[236:239], v1, s[4:7], s85 offen offset:3072 sc1
    s_mov_b32 s28, s46
    s_waitcnt vmcnt(0)
    s_barrier
    s_cmp_eq_u32 s28, 0
    s_cbranch_scc1 sig_16
    s_cmp_lg_u32 s3, 0
    s_cbranch_scc1 sig_16
    s_and_b32 s57, s28, 3
    v_mov_b32 v24, s57
    s_bfe_u32 s57, s28, 0x20002
    v_mov_b32 v25, s57
    s_andn2_b32 s28, s28, 15
    s_mov_b64 exec, 1
    buffer_atomic_add_x2 v[24:25], v17, s[4:7], s28 offen sc1
    s_mov_b64 exec, -1
sig_16:
    s_mov_b32 s28, 0
    s_cmp_lg_u32 s3, 0
    s_cbranch_scc1 pub_17
    v_mov_b32 v20, 131136
    s_mov_b64 exec, 1
    ds_write_b32 v20, v250
    s_mov_b64 exec, -1
    s_waitcnt lgkmcnt(0)
pub_17:
    s_barrier
    v_mov_b32 v20, 131136
    ds_read_b32 v20, v20
    s_waitcnt lgkmcnt(0)
    v_readfirstlane_b32 s59, v20
    s_add_u32 s59, s59, 32
    s_min_u32 s59, s59, 322
    s_lshl_b32 s57, s59, 6
    s_load_dwordx16 s[32:47], s[24:25], s57
    s_waitcnt lgkmcnt(0)
    s_branch w_cold
w_fin:
    s_load_dwordx2 s[8:9], s[0:1], 0
    s_load_dwordx2 s[12:13], s[0:1], 88
    v_mbcnt_lo_u32_b32 v1, -1, 0
    v_mbcnt_hi_u32_b32 v1, -1, v1
    s_mov_b32 s10, 4194304
    s_mov_b32 s11, 131072
    s_mov_b32 s14, 4194304
    s_mov_b32 s15, 131072
    s_mov_b32 s89, 0xbfb8aa3b
    v_lshlrev_b32 v3, 4, v1
    v_and_b32 v4, 15, v1
    v_lshrrev_b32 v5, 4, v1
    v_lshlrev_b32 v4, 11, v4
    v_lshl_add_u32 v4, v5, 4, v4
    v_and_b32 v5, 1, v5
    v_cmp_eq_u32 s[76:77], 1, v5
    v_and_b32 v6, 3, v1
    v_lshlrev_b32 v6, 7, v6
    s_mov_b32 s80, s39
    s_lshl_b32 s81, s36, 2
    s_and_b32 s82, s3, 3
    s_add_u32 s81, s81, s82
    s_lshr_b32 s82, s3, 2
    s_mov_b32 s84, 65536
    s_mov_b32 s85, 218112000
    s_waitcnt lgkmcnt(0)
    s_cmp_eq_u32 s32, 7
    s_cbranch_scc1 fin_tail
fin_job:
    s_lshl_b32 s72, s80, 1
    s_add_u32 s72, s72, s82
    s_lshl_b32 s74, s72, 15
    s_lshl_b32 s73, s81, 11
    s_add_u32 s73, s73, s74
    s_lshl_b32 s75, s81, 7
    s_add_u32 s74, s74, s75
    s_add_u32 s78, s73, 117440512
    s_add_u32 s79, s73, 75497472
    s_lshr_b32 s83, s80, 3
    s_lshl_b32 s83, s83, 6
    s_add_u32 s83, s83, 218106368
    s_add_u32 s87, s80, 2
    buffer_load_dwordx4 v[88:91], v4, s[8:11], s74 offen offset:0
    buffer_load_dwordx4 v[92:95], v4, s[8:11], s74 offen offset:64
    s_cmp_lg_u32 s80, s39
    s_cbranch_scc1 fin_again
    s_cmp_lg_u32 s3, 0
    s_cbranch_scc1 fin_ws_ok
fin_wd:
    buffer_load_dwordx2 v[8:9], off, s[4:7], s83 sc1
    s_waitcnt vmcnt(0)
    v_readfirstlane_b32 s86, v8
    v_readfirstlane_b32 s88, v9
    s_cmp_ge_u32 s88, s37
    s_cselect_b32 s86, s86, 0
    s_cmp_ge_u32 s86, 16
    s_cbranch_scc1 fin_wd2
    s_sleep 64
    s_sub_u32 s84, s84, 1
    s_cbranch_scc0 fin_wd
    s_mov_b32 s84, 0
fin_wd2:
    s_cmp_lg_u32 s37, 0
    s_cbranch_scc1 fin_ws_ok
fin_ws:
    buffer_load_dword v7, v6, s[4:7], s85 offen sc1
    s_waitcnt vmcnt(0)
    v_cmp_gt_u32 vcc, s87, v7
    s_cbranch_vccz fin_ws_ok
    s_sleep 12
    s_sub_u32 s86, s87, 2
    v_cmp_gt_i32 vcc, s86, v7
    s_cbranch_vccz fin_ws_f
    s_sleep 64
    s_sub_u32 s86, s87, 6
    v_cmp_gt_i32 vcc, s86, v7
    s_cbranch_vccz fin_ws_f
    s_sleep 127
    s_sleep 127
fin_ws_f:
    s_sub_u32 s84, s84, 1
    s_cbranch_scc0 fin_ws
    s_mov_b32 s84, 0
fin_ws_ok:
    s_cmp_lg_u32 s3, 0
    s_cbranch_scc1 clm_18
    v_mov_b32 v250, 1
    s_mov_b64 exec, 1
    buffer_atomic_add v250, off, s[64:67], s71 sc0 sc1
    s_mov_b64 exec, -1
clm_18:
    s_barrier
fin_again:
    buffer_load_dwordx4 v[136:139], v3, s[4:7], s78 offen offset:0 sc1
    buffer_load_dwordx4 v[140:143], v3, s[4:7], s78 offen offset:1024 sc1
    s_add_u32 s78, s78, 4194304
    buffer_load_dwordx4 v[144:147], v3, s[4:7], s78 offen offset:0 sc1
    buffer_load_dwordx4 v[148:151], v3, s[4:7], s78 offen offset:1024 sc1
    s_add_u32 s78, s78, 4194304
    s_cmp_lg_u32 s33, 0
    s_cbranch_scc1 fin_g2
    buffer_load_dwordx4 v[152:155], v3, s[4:7], s78 offen offset:0 sc1
    buffer_load_dwordx4 v[156:159], v3, s[4:7], s78 offen offset:1024 sc1
    s_add_u32 s78, s78, 4194304
    buffer_load_dwordx4 v[160:163], v3, s[4:7], s78 offen offset:0 sc1
    buffer_load_dwordx4 v[164:167], v3, s[4:7], s78 offen offset:1024 sc1
    s_add_u32 s78, s78, 4194304
    s_branch fin_g4
fin_g2:
    v_mov_b32 v152, 0
    v_mov_b32 v153, 0
    v_mov_b32 v154, 0
    v_mov_b32 v155, 0
    v_mov_b32 v156, 0
    v_mov_b32 v157, 0
    v_mov_b32 v158, 0
    v_mov_b32 v159, 0
    v_mov_b32 v160, 0
    v_mov_b32 v161, 0
    v_mov_b32 v162, 0
    v_mov_b32 v163, 0
    v_mov_b32 v164, 0
    v_mov_b32 v165, 0
    v_mov_b32 v166, 0
    v_mov_b32 v167, 0
fin_g4:
    buffer_load_dwordx4 v[16:19], v3, s[4:7], s79 offen offset:0 sc1
    buffer_load_dwordx4 v[48:51], v3, s[4:7], s79 offen offset:1024 sc1
    s_add_u32 s79, s79, 4194304
    buffer_load_dwordx4 v[20:23], v3, s[4:7], s79 offen offset:0 sc1
    buffer_load_dwordx4 v[52:55], v3, s[4:7], s79 offen offset:1024 sc1
    s_add_u32 s79, s79, 4194304
    s_cmp_ge_u32 s35, 2
    s_cbranch_scc1 fin_2p
    buffer_load_dwordx4 v[24:27], v3, s[4:7], s79 offen offset:0 sc1
    buffer_load_dwordx4 v[56:59], v3, s[4:7], s79 offen offset:1024 sc1
    s_add_u32 s79, s79, 4194304
    buffer_load_dwordx4 v[28:31], v3, s[4:7], s79 offen offset:0 sc1
    buffer_load_dwordx4 v[60:63], v3, s[4:7], s79 offen offset:1024 sc1
    s_add_u32 s79, s79, 4194304
    s_cmp_ge_u32 s35, 1
    s_cbranch_scc1 fin_4p
    buffer_load_dwordx4 v[32:35], v3, s[4:7], s79 offen offset:0 sc1
    buffer_load_dwordx4 v[64:67], v3, s[4:7], s79 offen offset:1024 sc1
    s_add_u32 s79, s79, 4194304
    buffer_load_dwordx4 v[36:39], v3, s[4:7], s79 offen offset:0 sc1
    buffer_load_dwordx4 v[68:71], v3, s[4:7], s79 offen offset:1024 sc1
    s_add_u32 s79, s79, 4194304
    buffer_load_dwordx4 v[40:43], v3, s[4:7], s79 offen offset:0 sc1
    buffer_load_dwordx4 v[72:75], v3, s[4:7], s79 offen offset:1024 sc1
    s_add_u32 s79, s79, 4194304
    buffer_load_dwordx4 v[44:47], v3, s[4:7], s79 offen offset:0 sc1
    buffer_load_dwordx4 v[76:79], v3, s[4:7], s79 offen offset:1024 sc1
    s_add_u32 s79, s79, 4194304
    s_waitcnt vmcnt(16)
    s_branch fin_8p
fin_2p:
    v_mov_b32 v24, 0
    v_mov_b32 v25, 0
    v_mov_b32 v26, 0
    v_mov_b32 v27, 0
    v_mov_b32 v28, 0
    v_mov_b32 v29, 0
    v_mov_b32 v30, 0
    v_mov_b32 v31, 0
    v_mov_b32 v32, 0
    v_mov_b32 v33, 0
    v_mov_b32 v34, 0
    v_mov_b32 v35, 0
    v_mov_b32 v36, 0
    v_mov_b32 v37, 0
    v_mov_b32 v38, 0
    v_mov_b32 v39, 0
    v_mov_b32 v40, 0
    v_mov_b32 v41, 0
    v_mov_b32 v42, 0
    v_mov_b32 v43, 0
    v_mov_b32 v44, 0
    v_mov_b32 v45, 0
    v_mov_b32 v46, 0
    v_mov_b32 v47, 0
    v_mov_b32 v56, 0
    v_mov_b32 v57, 0
    v_mov_b32 v58, 0
    v_mov_b32 v59, 0
    v_mov_b32 v60, 0
    v_mov_b32 v61, 0
    v_mov_b32 v62, 0
    v_mov_b32 v63, 0
    v_mov_b32 v64, 0
    v_mov_b32 v65, 0
    v_mov_b32 v66, 0
    v_mov_b32 v67, 0
    v_mov_b32 v68, 0
    v_mov_b32 v69, 0
    v_mov_b32 v70, 0
    v_mov_b32 v71, 0
    v_mov_b32 v72, 0
    v_mov_b32 v73, 0
    v_mov_b32 v74, 0
    v_mov_b32 v75, 0
    v_mov_b32 v76, 0
    v_mov_b32 v77, 0
    v_mov_b32 v78, 0
    v_mov_b32 v79, 0
    s_waitcnt vmcnt(4)
    s_branch fin_8p
fin_4p:
    v_mov_b32 v32, 0
    v_mov_b32 v33, 0
    v_mov_b32 v34, 0
    v_mov_b32 v35, 0
    v_mov_b32 v36, 0
    v_mov_b32 v37, 0
    v_mov_b32 v38, 0
    v_mov_b32 v39, 0
    v_mov_b32 v40, 0
    v_mov_b32 v41, 0
    v_mov_b32 v42, 0
    v_mov_b32 v43, 0
    v_mov_b32 v44, 0
    v_mov_b32 v45, 0
    v_mov_b32 v46, 0
    v_mov_b32 v47, 0
    v_mov_b32 v64, 0
    v_mov_b32 v65, 0
    v_mov_b32 v66, 0
    v_mov_b32 v67, 0
    v_mov_b32 v68, 0
    v_mov_b32 v69, 0
    v_mov_b32 v70, 0
    v_mov_b32 v71, 0
    v_mov_b32 v72, 0
    v_mov_b32 v73, 0
    v_mov_b32 v74, 0
    v_mov_b32 v75, 0
    v_mov_b32 v76, 0
    v_mov_b32 v77, 0
    v_mov_b32 v78, 0
    v_mov_b32 v79, 0
    s_waitcnt vmcnt(8)
fin_8p:
    v_lshlrev_b32 v120, 16, v136
    v_and_b32 v121, 0xffff0000, v136
    v_lshlrev_b32 v136, 16, v144
    v_and_b32 v144, 0xffff0000, v144
    v_add_f32 v120, v120, v136
    v_add_f32 v121, v121, v144
    v_lshlrev_b32 v136, 16, v152
    v_and_b32 v152, 0xffff0000, v152
    v_add_f32 v120, v120, v136
    v_add_f32 v121, v121, v152
    v_lshlrev_b32 v136, 16, v160
    v_and_b32 v160, 0xffff0000, v160
    v_add_f32 v120, v120, v136
    v_add_f32 v121, v121, v160
    v_cvt_pk_bf16_f32 v136, v120, v121
    v_lshlrev_b32 v120, 16, v136
    v_and_b32 v121, 0xffff0000, v136
    v_mul_f32 v136, s89, v120
    v_mul_f32 v144, s89, v121
    v_lshlrev_b32 v122, 16, v137
    v_and_b32 v123, 0xffff0000, v137
    v_lshlrev_b32 v137, 16, v145
    v_and_b32 v145, 0xffff0000, v145
    v_add_f32 v122, v122, v137
    v_add_f32 v123, v123, v145
    v_lshlrev_b32 v137, 16, v153
    v_and_b32 v153, 0xffff0000, v153
    v_add_f32 v122, v122, v137
    v_add_f32 v123, v123, v153
    v_lshlrev_b32 v137, 16, v161
    v_and_b32 v161, 0xffff0000, v161
    v_add_f32 v122, v122, v137
    v_add_f32 v123, v123, v161
    v_cvt_pk_bf16_f32 v137, v122, v123
    v_lshlrev_b32 v122, 16, v137
    v_and_b32 v123, 0xffff0000, v137
    v_mul_f32 v137, s89, v122
    v_mul_f32 v145, s89, v123
    v_lshlrev_b32 v124, 16, v138
    v_and_b32 v125, 0xffff0000, v138
    v_lshlrev_b32 v138, 16, v146
    v_and_b32 v146, 0xffff0000, v146
    v_add_f32 v124, v124, v138
    v_add_f32 v125, v125, v146
    v_lshlrev_b32 v138, 16, v154
    v_and_b32 v154, 0xffff0000, v154
    v_add_f32 v124, v124, v138
    v_add_f32 v125, v125, v154
    v_lshlrev_b32 v138, 16, v162
    v_and_b32 v162, 0xffff0000, v162
    v_add_f32 v124, v124, v138
    v_add_f32 v125, v125, v162
    v_cvt_pk_bf16_f32 v138, v124, v125
    v_lshlrev_b32 v124, 16, v138
    v_and_b32 v125, 0xffff0000, v138
    v_mul_f32 v138, s89, v124
    v_mul_f32 v146, s89, v125
    v_lshlrev_b32 v126, 16, v139
    v_and_b32 v127, 0xffff0000, v139
    v_lshlrev_b32 v139, 16, v147
    v_and_b32 v147, 0xffff0000, v147
    v_add_f32 v126, v126, v139
    v_add_f32 v127, v127, v147
    v_lshlrev_b32 v139, 16, v155
    v_and_b32 v155, 0xffff0000, v155
    v_add_f32 v126, v126, v139
    v_add_f32 v127, v127, v155
    v_lshlrev_b32 v139, 16, v163
    v_and_b32 v163, 0xffff0000, v163
    v_add_f32 v126, v126, v139
    v_add_f32 v127, v127, v163
    v_cvt_pk_bf16_f32 v139, v126, v127
    v_lshlrev_b32 v126, 16, v139
    v_and_b32 v127, 0xffff0000, v139
    v_mul_f32 v139, s89, v126
    v_mul_f32 v147, s89, v127
    v_exp_f32 v136, v136
    v_exp_f32 v144, v144
    v_exp_f32 v137, v137
    v_exp_f32 v145, v145
    v_exp_f32 v138, v138
    v_exp_f32 v146, v146
    v_exp_f32 v139, v139
    v_exp_f32 v147, v147
    s_nop 0
    v_add_f32 v136, 1.0, v136
    v_add_f32 v144, 1.0, v144
    v_add_f32 v137, 1.0, v137
    v_add_f32 v145, 1.0, v145
    v_add_f32 v138, 1.0, v138
    v_add_f32 v146, 1.0, v146
    v_add_f32 v139, 1.0, v139
    v_add_f32 v147, 1.0, v147
    v_rcp_f32 v136, v136
    v_rcp_f32 v144, v144
    v_rcp_f32 v137, v137
    v_rcp_f32 v145, v145
    v_rcp_f32 v138, v138
    v_rcp_f32 v146, v146
    v_rcp_f32 v139, v139
    v_rcp_f32 v147, v147
    s_nop 0
    v_mul_f32 v120, v120, v136
    v_mul_f32 v121, v121, v144
    v_cvt_pk_bf16_f32 v136, v120, v121
    v_mul_f32 v122, v122, v137
    v_mul_f32 v123, v123, v145
    v_cvt_pk_bf16_f32 v137, v122, v123
    v_mul_f32 v124, v124, v138
    v_mul_f32 v125, v125, v146
    v_cvt_pk_bf16_f32 v138, v124, v125
    v_mul_f32 v126, v126, v139
    v_mul_f32 v127, v127, v147
    v_cvt_pk_bf16_f32 v139, v126, v127
    v_lshlrev_b32 v120, 16, v140
    v_and_b32 v121, 0xffff0000, v140
    v_lshlrev_b32 v140, 16, v148
    v_and_b32 v148, 0xffff0000, v148
    v_add_f32 v120, v120, v140
    v_add_f32 v121, v121, v148
    v_lshlrev_b32 v140, 16, v156
    v_and_b32 v156, 0xffff0000, v156
    v_add_f32 v120, v120, v140
    v_add_f32 v121, v121, v156
    v_lshlrev_b32 v140, 16, v164
    v_and_b32 v164, 0xffff0000, v164
    v_add_f32 v120, v120, v140
    v_add_f32 v121, v121, v164
    v_cvt_pk_bf16_f32 v140, v120, v121
    v_lshlrev_b32 v120, 16, v140
    v_and_b32 v121, 0xffff0000, v140
    v_mul_f32 v140, s89, v120
    v_mul_f32 v148, s89, v121
    v_lshlrev_b32 v122, 16, v141
    v_and_b32 v123, 0xffff0000, v141
    v_lshlrev_b32 v141, 16, v149
    v_and_b32 v149, 0xffff0000, v149
    v_add_f32 v122, v122, v141
    v_add_f32 v123, v123, v149
    v_lshlrev_b32 v141, 16, v157
    v_and_b32 v157, 0xffff0000, v157
    v_add_f32 v122, v122, v141
    v_add_f32 v123, v123, v157
    v_lshlrev_b32 v141, 16, v165
    v_and_b32 v165, 0xffff0000, v165
    v_add_f32 v122, v122, v141
    v_add_f32 v123, v123, v165
    v_cvt_pk_bf16_f32 v141, v122, v123
    v_lshlrev_b32 v122, 16, v141
    v_and_b32 v123, 0xffff0000, v141
    v_mul_f32 v141, s89, v122
    v_mul_f32 v149, s89, v123
    v_lshlrev_b32 v124, 16, v142
    v_and_b32 v125, 0xffff0000, v142
    v_lshlrev_b32 v142, 16, v150
    v_and_b32 v150, 0xffff0000, v150
    v_add_f32 v124, v124, v142
    v_add_f32 v125, v125, v150
    v_lshlrev_b32 v142, 16, v158
    v_and_b32 v158, 0xffff0000, v158
    v_add_f32 v124, v124, v142
    v_add_f32 v125, v125, v158
    v_lshlrev_b32 v142, 16, v166
    v_and_b32 v166, 0xffff0000, v166
    v_add_f32 v124, v124, v142
    v_add_f32 v125, v125, v166
    v_cvt_pk_bf16_f32 v142, v124, v125
    v_lshlrev_b32 v124, 16, v142
    v_and_b32 v125, 0xffff0000, v142
    v_mul_f32 v142, s89, v124
    v_mul_f32 v150, s89, v125
    v_lshlrev_b32 v126, 16, v143
    v_and_b32 v127, 0xffff0000, v143
    v_lshlrev_b32 v143, 16, v151
    v_and_b32 v151, 0xffff0000, v151
    v_add_f32 v126, v126, v143
    v_add_f32 v127, v127, v151
    v_lshlrev_b32 v143, 16, v159
    v_and_b32 v159, 0xffff0000, v159
    v_add_f32 v126, v126, v143
    v_add_f32 v127, v127, v159
    v_lshlrev_b32 v143, 16, v167
    v_and_b32 v167, 0xffff0000, v167
    v_add_f32 v126, v126, v143
    v_add_f32 v127, v127, v167
    v_cvt_pk_bf16_f32 v143, v126, v127
    v_lshlrev_b32 v126, 16, v143
    v_and_b32 v127, 0xffff0000, v143
    v_mul_f32 v143, s89, v126
    v_mul_f32 v151, s89, v127
    v_exp_f32 v140, v140
    v_exp_f32 v148, v148
    v_exp_f32 v141, v141
    v_exp_f32 v149, v149
    v_exp_f32 v142, v142
    v_exp_f32 v150, v150
    v_exp_f32 v143, v143
    v_exp_f32 v151, v151
    s_nop 0
    v_add_f32 v140, 1.0, v140
    v_add_f32 v148, 1.0, v148
    v_add_f32 v141, 1.0, v141
    v_add_f32 v149, 1.0, v149
    v_add_f32 v142, 1.0, v142
    v_add_f32 v150, 1.0, v150
    v_add_f32 v143, 1.0, v143
    v_add_f32 v151, 1.0, v151
    v_rcp_f32 v140, v140
    v_rcp_f32 v148, v148
    v_rcp_f32 v141, v141
    v_rcp_f32 v149, v149
    v_rcp_f32 v142, v142
    v_rcp_f32 v150, v150
    v_rcp_f32 v143, v143
    v_rcp_f32 v151, v151
    s_nop 0
    v_mul_f32 v120, v120, v140
    v_mul_f32 v121, v121, v148
    v_cvt_pk_bf16_f32 v140, v120, v121
    v_mul_f32 v122, v122, v141
    v_mul_f32 v123, v123, v149
    v_cvt_pk_bf16_f32 v141, v122, v123
    v_mul_f32 v124, v124, v142
    v_mul_f32 v125, v125, v150
    v_cvt_pk_bf16_f32 v142, v124, v125
    v_mul_f32 v126, v126, v143
    v_mul_f32 v127, v127, v151
    v_cvt_pk_bf16_f32 v143, v126, v127
    s_waitcnt vmcnt(0)
    v_lshlrev_b32 v96, 16, v16
    v_and_b32 v97, 0xffff0000, v16
    v_lshlrev_b32 v98, 16, v17
    v_and_b32 v99, 0xffff0000, v17
    v_lshlrev_b32 v100, 16, v18
    v_and_b32 v101, 0xffff0000, v18
    v_lshlrev_b32 v102, 16, v19
    v_and_b32 v103, 0xffff0000, v19
    v_lshlrev_b32 v120, 16, v20
    v_and_b32 v121, 0xffff0000, v20
    v_lshlrev_b32 v122, 16, v21
    v_and_b32 v123, 0xffff0000, v21
    v_lshlrev_b32 v124, 16, v22
    v_and_b32 v125, 0xffff0000, v22
    v_lshlrev_b32 v126, 16, v23
    v_and_b32 v127, 0xffff0000, v23
    v_add_f32 v96, v96, v120
    v_add_f32 v97, v97, v121
    v_add_f32 v98, v98, v122
    v_add_f32 v99, v99, v123
    v_add_f32 v100, v100, v124
    v_add_f32 v101, v101, v125
    v_add_f32 v102, v102, v126
    v_add_f32 v103, v103, v127
    v_lshlrev_b32 v120, 16, v24
    v_and_b32 v121, 0xffff0000, v24
    v_lshlrev_b32 v122, 16, v25
    v_and_b32 v123, 0xffff0000, v25
    v_lshlrev_b32 v124, 16, v26
    v_and_b32 v125, 0xffff0000, v26
    v_lshlrev_b32 v126, 16, v27
    v_and_b32 v127, 0xffff0000, v27
    v_add_f32 v96, v96, v120
    v_add_f32 v97, v97, v121
    v_add_f32 v98, v98, v122
    v_add_f32 v99, v99, v123
    v_add_f32 v100, v100, v124
    v_add_f32 v101, v101, v125
    v_add_f32 v102, v102, v126
    v_add_f32 v103, v103, v127
    v_lshlrev_b32 v120, 16, v28
    v_and_b32 v121, 0xffff0000, v28
    v_lshlrev_b32 v122, 16, v29
    v_and_b32 v123, 0xffff0000, v29
    v_lshlrev_b32 v124, 16, v30
    v_and_b32 v125, 0xffff0000, v30
    v_lshlrev_b32 v126, 16, v31
    v_and_b32 v127, 0xffff0000, v31
    v_add_f32 v96, v96, v120
    v_add_f32 v97, v97, v121
    v_add_f32 v98, v98, v122
    v_add_f32 v99, v99, v123
    v_add_f32 v100, v100, v124
    v_add_f32 v101, v101, v125
    v_add_f32 v102, v102, v126
    v_add_f32 v103, v103, v127
    v_lshlrev_b32 v120, 16, v32
    v_and_b32 v121, 0xffff0000, v32
    v_lshlrev_b32 v122, 16, v33
    v_and_b32 v123, 0xffff0000, v33
    v_lshlrev_b32 v124, 16, v34
    v_and_b32 v125, 0xffff0000, v34
    v_lshlrev_b32 v126, 16, v35
    v_and_b32 v127, 0xffff0000, v35
    v_add_f32 v96, v96, v120
    v_add_f32 v97, v97, v121
    v_add_f32 v98, v98, v122
    v_add_f32 v99, v99, v123
    v_add_f32 v100, v100, v124
    v_add_f32 v101, v101, v125
    v_add_f32 v102, v102, v126
    v_add_f32 v103, v103, v127
    v_lshlrev_b32 v120, 16, v36
    v_and_b32 v121, 0xffff0000, v36
    v_lshlrev_b32 v122, 16, v37
    v_and_b32 v123, 0xffff0000, v37
    v_lshlrev_b32 v124, 16, v38
    v_and_b32 v125, 0xffff0000, v38
    v_lshlrev_b32 v126, 16, v39
    v_and_b32 v127, 0xffff0000, v39
    v_add_f32 v96, v96, v120
    v_add_f32 v97, v97, v121
    v_add_f32 v98, v98, v122
    v_add_f32 v99, v99, v123
    v_add_f32 v100, v100, v124
    v_add_f32 v101, v101, v125
    v_add_f32 v102, v102, v126
    v_add_f32 v103, v103, v127
    v_lshlrev_b32 v120, 16, v40
    v_and_b32 v121, 0xffff0000, v40
    v_lshlrev_b32 v122, 16, v41
    v_and_b32 v123, 0xffff0000, v41
    v_lshlrev_b32 v124, 16, v42
    v_and_b32 v125, 0xffff0000, v42
    v_lshlrev_b32 v126, 16, v43
    v_and_b32 v127, 0xffff0000, v43
    v_add_f32 v96, v96, v120
    v_add_f32 v97, v97, v121
    v_add_f32 v98, v98, v122
    v_add_f32 v99, v99, v123
    v_add_f32 v100, v100, v124
    v_add_f32 v101, v101, v125
    v_add_f32 v102, v102, v126
    v_add_f32 v103, v103, v127
    v_lshlrev_b32 v120, 16, v44
    v_and_b32 v121, 0xffff0000, v44
    v_lshlrev_b32 v122, 16, v45
    v_and_b32 v123, 0xffff0000, v45
    v_lshlrev_b32 v124, 16, v46
    v_and_b32 v125, 0xffff0000, v46
    v_lshlrev_b32 v126, 16, v47
    v_and_b32 v127, 0xffff0000, v47
    v_add_f32 v96, v96, v120
    v_add_f32 v97, v97, v121
    v_add_f32 v98, v98, v122
    v_add_f32 v99, v99, v123
    v_add_f32 v100, v100, v124
    v_add_f32 v101, v101, v125
    v_add_f32 v102, v102, v126
    v_add_f32 v103, v103, v127
    v_cndmask_b32 v108, v88, v90, s[76:77]
    v_cndmask_b32 v109, v89, v91, s[76:77]
    v_cndmask_b32 v110, v90, v88, s[76:77]
    v_cndmask_b32 v111, v91, v89, s[76:77]
    v_cvt_pk_bf16_f32 v104, v96, v97
    v_lshlrev_b32 v96, 16, v104
    v_and_b32 v97, 0xffff0000, v104
    v_lshlrev_b32 v104, 16, v136
    v_and_b32 v105, 0xffff0000, v136
    v_mul_f32 v96, v96, v104
    v_mul_f32 v97, v97, v105
    v_cvt_pk_bf16_f32 v104, v96, v97
    v_lshlrev_b32 v96, 16, v104
    v_and_b32 v97, 0xffff0000, v104
    v_lshlrev_b32 v104, 16, v108
    v_and_b32 v105, 0xffff0000, v108
    v_add_f32 v96, v96, v104
    v_add_f32 v97, v97, v105
    v_cvt_pk_bf16_f32 v112, v96, v97
    v_cvt_pk_bf16_f32 v104, v98, v99
    v_lshlrev_b32 v98, 16, v104
    v_and_b32 v99, 0xffff0000, v104
    v_lshlrev_b32 v104, 16, v137
    v_and_b32 v105, 0xffff0000, v137
    v_mul_f32 v98, v98, v104
    v_mul_f32 v99, v99, v105
    v_cvt_pk_bf16_f32 v104, v98, v99
    v_lshlrev_b32 v98, 16, v104
    v_and_b32 v99, 0xffff0000, v104
    v_lshlrev_b32 v104, 16, v109
    v_and_b32 v105, 0xffff0000, v109
    v_add_f32 v98, v98, v104
    v_add_f32 v99, v99, v105
    v_cvt_pk_bf16_f32 v113, v98, v99
    v_cvt_pk_bf16_f32 v104, v100, v101
    v_lshlrev_b32 v100, 16, v104
    v_and_b32 v101, 0xffff0000, v104
    v_lshlrev_b32 v104, 16, v138
    v_and_b32 v105, 0xffff0000, v138
    v_mul_f32 v100, v100, v104
    v_mul_f32 v101, v101, v105
    v_cvt_pk_bf16_f32 v104, v100, v101
    v_lshlrev_b32 v100, 16, v104
    v_and_b32 v101, 0xffff0000, v104
    v_lshlrev_b32 v104, 16, v110
    v_and_b32 v105, 0xffff0000, v110
    v_add_f32 v100, v100, v104
    v_add_f32 v101, v101, v105
    v_cvt_pk_bf16_f32 v114, v100, v101
    v_cvt_pk_bf16_f32 v104, v102, v103
    v_lshlrev_b32 v102, 16, v104
    v_and_b32 v103, 0xffff0000, v104
    v_lshlrev_b32 v104, 16, v139
    v_and_b32 v105, 0xffff0000, v139
    v_mul_f32 v102, v102, v104
    v_mul_f32 v103, v103, v105
    v_cvt_pk_bf16_f32 v104, v102, v103
    v_lshlrev_b32 v102, 16, v104
    v_and_b32 v103, 0xffff0000, v104
    v_lshlrev_b32 v104, 16, v111
    v_and_b32 v105, 0xffff0000, v111
    v_add_f32 v102, v102, v104
    v_add_f32 v103, v103, v105
    v_cvt_pk_bf16_f32 v115, v102, v103
    v_cndmask_b32 v128, v112, v114, s[76:77]
    v_cndmask_b32 v129, v113, v115, s[76:77]
    v_cndmask_b32 v130, v114, v112, s[76:77]
    v_cndmask_b32 v131, v115, v113, s[76:77]
    buffer_store_dwordx4 v[128:131], v4, s[12:15], s74 offen offset:0
    v_lshlrev_b32 v96, 16, v48
    v_and_b32 v97, 0xffff0000, v48
    v_lshlrev_b32 v98, 16, v49
    v_and_b32 v99, 0xffff0000, v49
    v_lshlrev_b32 v100, 16, v50
    v_and_b32 v101, 0xffff0000, v50
    v_lshlrev_b32 v102, 16, v51
    v_and_b32 v103, 0xffff0000, v51
    v_lshlrev_b32 v120, 16, v52
    v_and_b32 v121, 0xffff0000, v52
    v_lshlrev_b32 v122, 16, v53
    v_and_b32 v123, 0xffff0000, v53
    v_lshlrev_b32 v124, 16, v54
    v_and_b32 v125, 0xffff0000, v54
    v_lshlrev_b32 v126, 16, v55
    v_and_b32 v127, 0xffff0000, v55
    v_add_f32 v96, v96, v120
    v_add_f32 v97, v97, v121
    v_add_f32 v98, v98, v122
    v_add_f32 v99, v99, v123
    v_add_f32 v100, v100, v124
    v_add_f32 v101, v101, v125
    v_add_f32 v102, v102, v126
    v_add_f32 v103, v103, v127
    v_lshlrev_b32 v120, 16, v56
    v_and_b32 v121, 0xffff0000, v56
    v_lshlrev_b32 v122, 16, v57
    v_and_b32 v123, 0xffff0000, v57
    v_lshlrev_b32 v124, 16, v58
    v_and_b32 v125, 0xffff0000, v58
    v_lshlrev_b32 v126, 16, v59
    v_and_b32 v127, 0xffff0000, v59
    v_add_f32 v96, v96, v120
    v_add_f32 v97, v97, v121
    v_add_f32 v98, v98, v122
    v_add_f32 v99, v99, v123
    v_add_f32 v100, v100, v124
    v_add_f32 v101, v101, v125
    v_add_f32 v102, v102, v126
    v_add_f32 v103, v103, v127
    v_lshlrev_b32 v120, 16, v60
    v_and_b32 v121, 0xffff0000, v60
    v_lshlrev_b32 v122, 16, v61
    v_and_b32 v123, 0xffff0000, v61
    v_lshlrev_b32 v124, 16, v62
    v_and_b32 v125, 0xffff0000, v62
    v_lshlrev_b32 v126, 16, v63
    v_and_b32 v127, 0xffff0000, v63
    v_add_f32 v96, v96, v120
    v_add_f32 v97, v97, v121
    v_add_f32 v98, v98, v122
    v_add_f32 v99, v99, v123
    v_add_f32 v100, v100, v124
    v_add_f32 v101, v101, v125
    v_add_f32 v102, v102, v126
    v_add_f32 v103, v103, v127
    v_lshlrev_b32 v120, 16, v64
    v_and_b32 v121, 0xffff0000, v64
    v_lshlrev_b32 v122, 16, v65
    v_and_b32 v123, 0xffff0000, v65
    v_lshlrev_b32 v124, 16, v66
    v_and_b32 v125, 0xffff0000, v66
    v_lshlrev_b32 v126, 16, v67
    v_and_b32 v127, 0xffff0000, v67
    v_add_f32 v96, v96, v120
    v_add_f32 v97, v97, v121
    v_add_f32 v98, v98, v122
    v_add_f32 v99, v99, v123
    v_add_f32 v100, v100, v124
    v_add_f32 v101, v101, v125
    v_add_f32 v102, v102, v126
    v_add_f32 v103, v103, v127
    v_lshlrev_b32 v120, 16, v68
    v_and_b32 v121, 0xffff0000, v68
    v_lshlrev_b32 v122, 16, v69
    v_and_b32 v123, 0xffff0000, v69
    v_lshlrev_b32 v124, 16, v70
    v_and_b32 v125, 0xffff0000, v70
    v_lshlrev_b32 v126, 16, v71
    v_and_b32 v127, 0xffff0000, v71
    v_add_f32 v96, v96, v120
    v_add_f32 v97, v97, v121
    v_add_f32 v98, v98, v122
    v_add_f32 v99, v99, v123
    v_add_f32 v100, v100, v124
    v_add_f32 v101, v101, v125
    v_add_f32 v102, v102, v126
    v_add_f32 v103, v103, v127
    v_lshlrev_b32 v120, 16, v72
    v_and_b32 v121, 0xffff0000, v72
    v_lshlrev_b32 v122, 16, v73
    v_and_b32 v123, 0xffff0000, v73
    v_lshlrev_b32 v124, 16, v74
    v_and_b32 v125, 0xffff0000, v74
    v_lshlrev_b32 v126, 16, v75
    v_and_b32 v127, 0xffff0000, v75
    v_add_f32 v96, v96, v120
    v_add_f32 v97, v97, v121
    v_add_f32 v98, v98, v122
    v_add_f32 v99, v99, v123
    v_add_f32 v100, v100, v124
    v_add_f32 v101, v101, v125
    v_add_f32 v102, v102, v126
    v_add_f32 v103, v103, v127
    v_lshlrev_b32 v120, 16, v76
    v_and_b32 v121, 0xffff0000, v76
    v_lshlrev_b32 v122, 16, v77
    v_and_b32 v123, 0xffff0000, v77
    v_lshlrev_b32 v124, 16, v78
    v_and_b32 v125, 0xffff0000, v78
    v_lshlrev_b32 v126, 16, v79
    v_and_b32 v127, 0xffff0000, v79
    v_add_f32 v96, v96, v120
    v_add_f32 v97, v97, v121
    v_add_f32 v98, v98, v122
    v_add_f32 v99, v99, v123
    v_add_f32 v100, v100, v124
    v_add_f32 v101, v101, v125
    v_add_f32 v102, v102, v126
    v_add_f32 v103, v103, v127
    v_cndmask_b32 v108, v92, v94, s[76:77]
    v_cndmask_b32 v109, v93, v95, s[76:77]
    v_cndmask_b32 v110, v94, v92, s[76:77]
    v_cndmask_b32 v111, v95, v93, s[76:77]
    v_cvt_pk_bf16_f32 v104, v96, v97
    v_lshlrev_b32 v96, 16, v104
    v_and_b32 v97, 0xffff0000, v104
    v_lshlrev_b32 v104, 16, v140
    v_and_b32 v105, 0xffff0000, v140
    v_mul_f32 v96, v96, v104
    v_mul_f32 v97, v97, v105
    v_cvt_pk_bf16_f32 v104, v96, v97
    v_lshlrev_b32 v96, 16, v104
    v_and_b32 v97, 0xffff0000, v104
    v_lshlrev_b32 v104, 16, v108
    v_and_b32 v105, 0xffff0000, v108
    v_add_f32 v96, v96, v104
    v_add_f32 v97, v97, v105
    v_cvt_pk_bf16_f32 v112, v96, v97
    v_cvt_pk_bf16_f32 v104, v98, v99
    v_lshlrev_b32 v98, 16, v104
    v_and_b32 v99, 0xffff0000, v104
    v_lshlrev_b32 v104, 16, v141
    v_and_b32 v105, 0xffff0000, v141
    v_mul_f32 v98, v98, v104
    v_mul_f32 v99, v99, v105
    v_cvt_pk_bf16_f32 v104, v98, v99
    v_lshlrev_b32 v98, 16, v104
    v_and_b32 v99, 0xffff0000, v104
    v_lshlrev_b32 v104, 16, v109
    v_and_b32 v105, 0xffff0000, v109
    v_add_f32 v98, v98, v104
    v_add_f32 v99, v99, v105
    v_cvt_pk_bf16_f32 v113, v98, v99
    v_cvt_pk_bf16_f32 v104, v100, v101
    v_lshlrev_b32 v100, 16, v104
    v_and_b32 v101, 0xffff0000, v104
    v_lshlrev_b32 v104, 16, v142
    v_and_b32 v105, 0xffff0000, v142
    v_mul_f32 v100, v100, v104
    v_mul_f32 v101, v101, v105
    v_cvt_pk_bf16_f32 v104, v100, v101
    v_lshlrev_b32 v100, 16, v104
    v_and_b32 v101, 0xffff0000, v104
    v_lshlrev_b32 v104, 16, v110
    v_and_b32 v105, 0xffff0000, v110
    v_add_f32 v100, v100, v104
    v_add_f32 v101, v101, v105
    v_cvt_pk_bf16_f32 v114, v100, v101
    v_cvt_pk_bf16_f32 v104, v102, v103
    v_lshlrev_b32 v102, 16, v104
    v_and_b32 v103, 0xffff0000, v104
    v_lshlrev_b32 v104, 16, v143
    v_and_b32 v105, 0xffff0000, v143
    v_mul_f32 v102, v102, v104
    v_mul_f32 v103, v103, v105
    v_cvt_pk_bf16_f32 v104, v102, v103
    v_lshlrev_b32 v102, 16, v104
    v_and_b32 v103, 0xffff0000, v104
    v_lshlrev_b32 v104, 16, v111
    v_and_b32 v105, 0xffff0000, v111
    v_add_f32 v102, v102, v104
    v_add_f32 v103, v103, v105
    v_cvt_pk_bf16_f32 v115, v102, v103
    v_cndmask_b32 v132, v112, v114, s[76:77]
    v_cndmask_b32 v133, v113, v115, s[76:77]
    v_cndmask_b32 v134, v114, v112, s[76:77]
    v_cndmask_b32 v135, v115, v113, s[76:77]
    buffer_store_dwordx4 v[132:135], v4, s[12:15], s74 offen offset:64
    s_add_u32 s80, s80, 1
    s_cmp_le_u32 s80, s34
    s_cbranch_scc1 fin_job
    s_branch w_fin_done
fin_tail:
    s_mov_b32 s81, s36
    s_lshl_b32 s81, s81, 2
    s_and_b32 s82, s3, 3
    s_add_u32 s81, s81, s82
    s_lshr_b32 s82, s81, 5
    s_and_b32 s81, s81, 31
    s_lshl_b32 s72, s80, 1
    s_add_u32 s72, s72, s82
    s_lshl_b32 s74, s72, 15
    s_lshl_b32 s73, s81, 10
    s_add_u32 s73, s73, s74
    s_lshl_b32 s75, s81, 6
    s_add_u32 s74, s74, s75
    s_add_u32 s78, s73, 117440512
    s_add_u32 s79, s73, 75497472
    s_mov_b32 s83, 218106816
    s_mov_b32 s84, 65536
    s_min_u32 s87, s80, 62
    v_and_b32 v8, 7, v1
    v_lshlrev_b32 v8, 22, v8
    s_cmp_lg_u32 s3, 0
    s_cbranch_scc1 ft_ok
ft_wd:
    buffer_load_dword v7, off, s[4:7], s83 sc1
    s_waitcnt vmcnt(0)
    v_readfirstlane_b32 s86, v7
    s_cmp_ge_u32 s86, 16
    s_cbranch_scc1 ft_wdok
    s_sleep 32
    s_sub_u32 s84, s84, 1
    s_cbranch_scc0 ft_wd
    s_mov_b32 s84, 0
ft_wdok:
ft_ok:
    s_barrier
    s_cmp_ge_u32 s3, 4
    s_cbranch_scc1 w_fin_done
    buffer_load_dwordx4 v[88:91], v4, s[8:11], s74 offen
    buffer_load_dwordx4 v[136:139], v3, s[4:7], s78 offen sc1
    s_add_u32 s78, s78, 4194304
    buffer_load_dwordx4 v[144:147], v3, s[4:7], s78 offen sc1
    s_add_u32 s78, s78, 4194304
    buffer_load_dwordx4 v[152:155], v3, s[4:7], s78 offen sc1
    s_add_u32 s78, s78, 4194304
    buffer_load_dwordx4 v[160:163], v3, s[4:7], s78 offen sc1
    s_add_u32 s78, s78, 4194304
    s_waitcnt vmcnt(0)
    v_lshlrev_b32 v120, 16, v136
    v_and_b32 v121, 0xffff0000, v136
    v_lshlrev_b32 v136, 16, v144
    v_and_b32 v144, 0xffff0000, v144
    v_add_f32 v120, v120, v136
    v_add_f32 v121, v121, v144
    v_lshlrev_b32 v136, 16, v152
    v_and_b32 v152, 0xffff0000, v152
    v_add_f32 v120, v120, v136
    v_add_f32 v121, v121, v152
    v_lshlrev_b32 v136, 16, v160
    v_and_b32 v160, 0xffff0000, v160
    v_add_f32 v120, v120, v136
    v_add_f32 v121, v121, v160
    v_cvt_pk_bf16_f32 v136, v120, v121
    v_lshlrev_b32 v120, 16, v136
    v_and_b32 v121, 0xffff0000, v136
    v_mul_f32 v136, s89, v120
    v_mul_f32 v144, s89, v121
    v_lshlrev_b32 v122, 16, v137
    v_and_b32 v123, 0xffff0000, v137
    v_lshlrev_b32 v137, 16, v145
    v_and_b32 v145, 0xffff0000, v145
    v_add_f32 v122, v122, v137
    v_add_f32 v123, v123, v145
    v_lshlrev_b32 v137, 16, v153
    v_and_b32 v153, 0xffff0000, v153
    v_add_f32 v122, v122, v137
    v_add_f32 v123, v123, v153
    v_lshlrev_b32 v137, 16, v161
    v_and_b32 v161, 0xffff0000, v161
    v_add_f32 v122, v122, v137
    v_add_f32 v123, v123, v161
    v_cvt_pk_bf16_f32 v137, v122, v123
    v_lshlrev_b32 v122, 16, v137
    v_and_b32 v123, 0xffff0000, v137
    v_mul_f32 v137, s89, v122
    v_mul_f32 v145, s89, v123
    v_lshlrev_b32 v124, 16, v138
    v_and_b32 v125, 0xffff0000, v138
    v_lshlrev_b32 v138, 16, v146
    v_and_b32 v146, 0xffff0000, v146
    v_add_f32 v124, v124, v138
    v_add_f32 v125, v125, v146
    v_lshlrev_b32 v138, 16, v154
    v_and_b32 v154, 0xffff0000, v154
    v_add_f32 v124, v124, v138
    v_add_f32 v125, v125, v154
    v_lshlrev_b32 v138, 16, v162
    v_and_b32 v162, 0xffff0000, v162
    v_add_f32 v124, v124, v138
    v_add_f32 v125, v125, v162
    v_cvt_pk_bf16_f32 v138, v124, v125
    v_lshlrev_b32 v124, 16, v138
    v_and_b32 v125, 0xffff0000, v138
    v_mul_f32 v138, s89, v124
    v_mul_f32 v146, s89, v125
    v_lshlrev_b32 v126, 16, v139
    v_and_b32 v127, 0xffff0000, v139
    v_lshlrev_b32 v139, 16, v147
    v_and_b32 v147, 0xffff0000, v147
    v_add_f32 v126, v126, v139
    v_add_f32 v127, v127, v147
    v_lshlrev_b32 v139, 16, v155
    v_and_b32 v155, 0xffff0000, v155
    v_add_f32 v126, v126, v139
    v_add_f32 v127, v127, v155
    v_lshlrev_b32 v139, 16, v163
    v_and_b32 v163, 0xffff0000, v163
    v_add_f32 v126, v126, v139
    v_add_f32 v127, v127, v163
    v_cvt_pk_bf16_f32 v139, v126, v127
    v_lshlrev_b32 v126, 16, v139
    v_and_b32 v127, 0xffff0000, v139
    v_mul_f32 v139, s89, v126
    v_mul_f32 v147, s89, v127
    v_exp_f32 v136, v136
    v_exp_f32 v144, v144
    v_exp_f32 v137, v137
    v_exp_f32 v145, v145
    v_exp_f32 v138, v138
    v_exp_f32 v146, v146
    v_exp_f32 v139, v139
    v_exp_f32 v147, v147
    s_nop 0
    v_add_f32 v136, 1.0, v136
    v_add_f32 v144, 1.0, v144
    v_add_f32 v137, 1.0, v137
    v_add_f32 v145, 1.0, v145
    v_add_f32 v138, 1.0, v138
    v_add_f32 v146, 1.0, v146
    v_add_f32 v139, 1.0, v139
    v_add_f32 v147, 1.0, v147
    v_rcp_f32 v136, v136
    v_rcp_f32 v144, v144
    v_rcp_f32 v137, v137
    v_rcp_f32 v145, v145
    v_rcp_f32 v138, v138
    v_rcp_f32 v146, v146
    v_rcp_f32 v139, v139
    v_rcp_f32 v147, v147
    s_nop 0
    v_mul_f32 v120, v120, v136
    v_mul_f32 v121, v121, v144
    v_cvt_pk_bf16_f32 v136, v120, v121
    v_mul_f32 v122, v122, v137
    v_mul_f32 v123, v123, v145
    v_cvt_pk_bf16_f32 v137, v122, v123
    v_mul_f32 v124, v124, v138
    v_mul_f32 v125, v125, v146
    v_cvt_pk_bf16_f32 v138, v124, v125
    v_mul_f32 v126, v126, v139
    v_mul_f32 v127, v127, v147
    v_cvt_pk_bf16_f32 v139, v126, v127
ft_ws:
    buffer_load_dword v7, v6, s[4:7], s85 offen sc1
    s_waitcnt vmcnt(0)
    v_cmp_gt_u32 vcc, s87, v7
    s_cbranch_vccz ft_p
    s_sleep 12
    v_cmp_gt_u32 vcc, 59, v7
    s_cbranch_vccz ft_wsf
    s_sleep 64
    v_cmp_gt_u32 vcc, 56, v7
    s_cbranch_vccz ft_wsf
    s_sleep 127
    s_sleep 127
ft_wsf:
    s_sub_u32 s84, s84, 1
    s_cbranch_scc0 ft_ws
    s_mov_b32 s84, 0
ft_p:
    buffer_load_dword v7, v8, s[4:7], s79 offen offset:1008 sc1
    s_waitcnt vmcnt(0)
    v_cmp_eq_u32 vcc, -1, v7
    s_cbranch_vccz ft_l0
    s_sleep 4
    s_sub_u32 s84, s84, 1
    s_cbranch_scc0 ft_p
    s_mov_b32 s84, 0
ft_l0:
    s_cmp_lg_u32 s3, 0
    s_cbranch_scc1 clm_19
    v_mov_b32 v250, 1
    s_mov_b64 exec, 1
    buffer_atomic_add v250, off, s[64:67], s71 sc0 sc1
    s_mov_b64 exec, -1
clm_19:
ft_l:
    s_mov_b32 s86, s79
    buffer_load_dwordx4 v[16:19], v3, s[4:7], s86 offen sc1
    s_add_u32 s86, s86, 4194304
    buffer_load_dwordx4 v[20:23], v3, s[4:7], s86 offen sc1
    s_add_u32 s86, s86, 4194304
    buffer_load_dwordx4 v[24:27], v3, s[4:7], s86 offen sc1
    s_add_u32 s86, s86, 4194304
    buffer_load_dwordx4 v[28:31], v3, s[4:7], s86 offen sc1
    s_add_u32 s86, s86, 4194304
    buffer_load_dwordx4 v[32:35], v3, s[4:7], s86 offen sc1
    s_add_u32 s86, s86, 4194304
    buffer_load_dwordx4 v[36:39], v3, s[4:7], s86 offen sc1
    s_add_u32 s86, s86, 4194304
    buffer_load_dwordx4 v[40:43], v3, s[4:7], s86 offen sc1
    s_add_u32 s86, s86, 4194304
    buffer_load_dwordx4 v[44:47], v3, s[4:7], s86 offen sc1
    s_waitcnt vmcnt(0)
    v_max3_u32 v7, v16, v20, v24
    v_max3_u32 v7, v7, v28, v32
    v_max3_u32 v7, v7, v36, v40
    v_max_u32 v7, v7, v44
    v_cmp_eq_u32 vcc, -1, v7
    s_cbranch_vccz ft_go
    s_sleep 0
    s_sub_u32 s84, s84, 1
    s_cbranch_scc0 ft_l
ft_go:
    v_lshlrev_b32 v96, 16, v16
    v_and_b32 v97, 0xffff0000, v16
    v_lshlrev_b32 v98, 16, v17
    v_and_b32 v99, 0xffff0000, v17
    v_lshlrev_b32 v100, 16, v18
    v_and_b32 v101, 0xffff0000, v18
    v_lshlrev_b32 v102, 16, v19
    v_and_b32 v103, 0xffff0000, v19
    v_lshlrev_b32 v120, 16, v20
    v_and_b32 v121, 0xffff0000, v20
    v_lshlrev_b32 v122, 16, v21
    v_and_b32 v123, 0xffff0000, v21
    v_lshlrev_b32 v124, 16, v22
    v_and_b32 v125, 0xffff0000, v22
    v_lshlrev_b32 v126, 16, v23
    v_and_b32 v127, 0xffff0000, v23
    v_add_f32 v96, v96, v120
    v_add_f32 v97, v97, v121
    v_add_f32 v98, v98, v122
    v_add_f32 v99, v99, v123
    v_add_f32 v100, v100, v124
    v_add_f32 v101, v101, v125
    v_add_f32 v102, v102, v126
    v_add_f32 v103, v103, v127
    v_lshlrev_b32 v120, 16, v24
    v_and_b32 v121, 0xffff0000, v24
    v_lshlrev_b32 v122, 16, v25
    v_and_b32 v123, 0xffff0000, v25
    v_lshlrev_b32 v124, 16, v26
    v_and_b32 v125, 0xffff0000, v26
    v_lshlrev_b32 v126, 16, v27
    v_and_b32 v127, 0xffff0000, v27
    v_add_f32 v96, v96, v120
    v_add_f32 v97, v97, v121
    v_add_f32 v98, v98, v122
    v_add_f32 v99, v99, v123
    v_add_f32 v100, v100, v124
    v_add_f32 v101, v101, v125
    v_add_f32 v102, v102, v126
    v_add_f32 v103, v103, v127
    v_lshlrev_b32 v120, 16, v28
    v_and_b32 v121, 0xffff0000, v28
    v_lshlrev_b32 v122, 16, v29
    v_and_b32 v123, 0xffff0000, v29
    v_lshlrev_b32 v124, 16, v30
    v_and_b32 v125, 0xffff0000, v30
    v_lshlrev_b32 v126, 16, v31
    v_and_b32 v127, 0xffff0000, v31
    v_add_f32 v96, v96, v120
    v_add_f32 v97, v97, v121
    v_add_f32 v98, v98, v122
    v_add_f32 v99, v99, v123
    v_add_f32 v100, v100, v124
    v_add_f32 v101, v101, v125
    v_add_f32 v102, v102, v126
    v_add_f32 v103, v103, v127
    v_lshlrev_b32 v120, 16, v32
    v_and_b32 v121, 0xffff0000, v32
    v_lshlrev_b32 v122, 16, v33
    v_and_b32 v123, 0xffff0000, v33
    v_lshlrev_b32 v124, 16, v34
    v_and_b32 v125, 0xffff0000, v34
    v_lshlrev_b32 v126, 16, v35
    v_and_b32 v127, 0xffff0000, v35
    v_add_f32 v96, v96, v120
    v_add_f32 v97, v97, v121
    v_add_f32 v98, v98, v122
    v_add_f32 v99, v99, v123
    v_add_f32 v100, v100, v124
    v_add_f32 v101, v101, v125
    v_add_f32 v102, v102, v126
    v_add_f32 v103, v103, v127
    v_lshlrev_b32 v120, 16, v36
    v_and_b32 v121, 0xffff0000, v36
    v_lshlrev_b32 v122, 16, v37
    v_and_b32 v123, 0xffff0000, v37
    v_lshlrev_b32 v124, 16, v38
    v_and_b32 v125, 0xffff0000, v38
    v_lshlrev_b32 v126, 16, v39
    v_and_b32 v127, 0xffff0000, v39
    v_add_f32 v96, v96, v120
    v_add_f32 v97, v97, v121
    v_add_f32 v98, v98, v122
    v_add_f32 v99, v99, v123
    v_add_f32 v100, v100, v124
    v_add_f32 v101, v101, v125
    v_add_f32 v102, v102, v126
    v_add_f32 v103, v103, v127
    v_lshlrev_b32 v120, 16, v40
    v_and_b32 v121, 0xffff0000, v40
    v_lshlrev_b32 v122, 16, v41
    v_and_b32 v123, 0xffff0000, v41
    v_lshlrev_b32 v124, 16, v42
    v_and_b32 v125, 0xffff0000, v42
    v_lshlrev_b32 v126, 16, v43
    v_and_b32 v127, 0xffff0000, v43
    v_add_f32 v96, v96, v120
    v_add_f32 v97, v97, v121
    v_add_f32 v98, v98, v122
    v_add_f32 v99, v99, v123
    v_add_f32 v100, v100, v124
    v_add_f32 v101, v101, v125
    v_add_f32 v102, v102, v126
    v_add_f32 v103, v103, v127
    v_lshlrev_b32 v120, 16, v44
    v_and_b32 v121, 0xffff0000, v44
    v_lshlrev_b32 v122, 16, v45
    v_and_b32 v123, 0xffff0000, v45
    v_lshlrev_b32 v124, 16, v46
    v_and_b32 v125, 0xffff0000, v46
    v_lshlrev_b32 v126, 16, v47
    v_and_b32 v127, 0xffff0000, v47
    v_add_f32 v96, v96, v120
    v_add_f32 v97, v97, v121
    v_add_f32 v98, v98, v122
    v_add_f32 v99, v99, v123
    v_add_f32 v100, v100, v124
    v_add_f32 v101, v101, v125
    v_add_f32 v102, v102, v126
    v_add_f32 v103, v103, v127
    v_cndmask_b32 v108, v88, v90, s[76:77]
    v_cndmask_b32 v109, v89, v91, s[76:77]
    v_cndmask_b32 v110, v90, v88, s[76:77]
    v_cndmask_b32 v111, v91, v89, s[76:77]
    v_cvt_pk_bf16_f32 v104, v96, v97
    v_lshlrev_b32 v96, 16, v104
    v_and_b32 v97, 0xffff0000, v104
    v_lshlrev_b32 v104, 16, v136
    v_and_b32 v105, 0xffff0000, v136
    v_mul_f32 v96, v96, v104
    v_mul_f32 v97, v97, v105
    v_cvt_pk_bf16_f32 v104, v96, v97
    v_lshlrev_b32 v96, 16, v104
    v_and_b32 v97, 0xffff0000, v104
    v_lshlrev_b32 v104, 16, v108
    v_and_b32 v105, 0xffff0000, v108
    v_add_f32 v96, v96, v104
    v_add_f32 v97, v97, v105
    v_cvt_pk_bf16_f32 v112, v96, v97
    v_cvt_pk_bf16_f32 v104, v98, v99
    v_lshlrev_b32 v98, 16, v104
    v_and_b32 v99, 0xffff0000, v104
    v_lshlrev_b32 v104, 16, v137
    v_and_b32 v105, 0xffff0000, v137
    v_mul_f32 v98, v98, v104
    v_mul_f32 v99, v99, v105
    v_cvt_pk_bf16_f32 v104, v98, v99
    v_lshlrev_b32 v98, 16, v104
    v_and_b32 v99, 0xffff0000, v104
    v_lshlrev_b32 v104, 16, v109
    v_and_b32 v105, 0xffff0000, v109
    v_add_f32 v98, v98, v104
    v_add_f32 v99, v99, v105
    v_cvt_pk_bf16_f32 v113, v98, v99
    v_cvt_pk_bf16_f32 v104, v100, v101
    v_lshlrev_b32 v100, 16, v104
    v_and_b32 v101, 0xffff0000, v104
    v_lshlrev_b32 v104, 16, v138
    v_and_b32 v105, 0xffff0000, v138
    v_mul_f32 v100, v100, v104
    v_mul_f32 v101, v101, v105
    v_cvt_pk_bf16_f32 v104, v100, v101
    v_lshlrev_b32 v100, 16, v104
    v_and_b32 v101, 0xffff0000, v104
    v_lshlrev_b32 v104, 16, v110
    v_and_b32 v105, 0xffff0000, v110
    v_add_f32 v100, v100, v104
    v_add_f32 v101, v101, v105
    v_cvt_pk_bf16_f32 v114, v100, v101
    v_cvt_pk_bf16_f32 v104, v102, v103
    v_lshlrev_b32 v102, 16, v104
    v_and_b32 v103, 0xffff0000, v104
    v_lshlrev_b32 v104, 16, v139
    v_and_b32 v105, 0xffff0000, v139
    v_mul_f32 v102, v102, v104
    v_mul_f32 v103, v103, v105
    v_cvt_pk_bf16_f32 v104, v102, v103
    v_lshlrev_b32 v102, 16, v104
    v_and_b32 v103, 0xffff0000, v104
    v_lshlrev_b32 v104, 16, v111
    v_and_b32 v105, 0xffff0000, v111
    v_add_f32 v102, v102, v104
    v_add_f32 v103, v103, v105
    v_cvt_pk_bf16_f32 v115, v102, v103
    v_cndmask_b32 v128, v112, v114, s[76:77]
    v_cndmask_b32 v129, v113, v115, s[76:77]
    v_cndmask_b32 v130, v114, v112, s[76:77]
    v_cndmask_b32 v131, v115, v113, s[76:77]
    buffer_store_dwordx4 v[128:131], v4, s[12:15], s74 offen offset:0
    s_branch w_fin_done
w_fin_done:
    s_cmp_lg_u32 s3, 0
    s_cbranch_scc1 pub_20
    v_mov_b32 v20, 131136
    s_mov_b64 exec, 1
    ds_write_b32 v20, v250
    s_mov_b64 exec, -1
    s_waitcnt lgkmcnt(0)
pub_20:
    s_barrier
    v_mov_b32 v20, 131136
    ds_read_b32 v20, v20
    s_waitcnt lgkmcnt(0)
    v_readfirstlane_b32 s59, v20
    s_add_u32 s59, s59, 32
    s_min_u32 s59, s59, 322
    s_lshl_b32 s57, s59, 6
    s_load_dwordx16 s[32:47], s[24:25], s57
    s_waitcnt lgkmcnt(0)
    s_barrier
    s_sub_u32 s57, s32, 1
    s_cmp_ge_u32 s57, 5
    s_cbranch_scc1 w_cold
    v_and_b32 v20, 63, v0
    v_lshlrev_b32 v1, 4, v20
    v_add_u32 v19, 0x1000, v1
    v_lshrrev_b32 v4, 4, v20
    v_mov_b32 v17, 0
    v_mov_b32 v18, 1
    s_lshr_b32 s26, s3, 2
    s_and_b32 s27, s3, 3
    s_lshl_b32 s21, s3, 11
    s_lshl_b32 s22, s3, 10
    s_add_u32 s22, s22, 16384
    s_mov_b32 s11, 131072
    s_mov_b32 s15, 131072
    s_mov_b32 s28, 0
    v_and_b32 v21, 15, v20
    v_lshlrev_b32 v22, 2, v4
    v_xor_b32 v21, v21, v22
    s_lshr_b32 s30, s3, 1
    s_and_b32 s30, s30, 1
    v_xor_b32 v21, s30, v21
    v_lshlrev_b32 v3, 4, v21
    s_lshl_b32 s30, s26, 13
    v_add_u32 v5, s30, v1
    v_add_u32 v6, 0x10000, v5
    v_bfe_u32 v21, v20, 2, 2
    v_and_b32 v22, 3, v20
    v_and_b32 v23, 1, v4
    v_xor_b32 v24, s27, v21
    v_xor_b32 v25, v22, v23
    v_lshl_add_u32 v24, v24, 2, v25
    v_lshlrev_b32 v24, 4, v24
    v_lshl_add_u32 v25, v4, 3, v21
    v_lshl_add_u32 v24, v25, 8, v24
    v_and_b32 v22, 1, v22
    v_xor_b32 v25, 0, v23
    v_lshl_add_u32 v8, v25, 10, v24
    v_xor_b32 v25, 0, v22
    v_lshl_add_u32 v8, v25, 3, v8
    v_add_u32 v12, 0x10000, v8
    v_xor_b32 v25, 1, v23
    v_lshl_add_u32 v9, v25, 10, v24
    v_xor_b32 v25, 0, v22
    v_lshl_add_u32 v9, v25, 3, v9
    v_add_u32 v13, 0x10000, v9
    v_xor_b32 v25, 0, v23
    v_lshl_add_u32 v10, v25, 10, v24
    v_xor_b32 v25, 1, v22
    v_lshl_add_u32 v10, v25, 3, v10
    v_add_u32 v14, 0x10000, v10
    v_xor_b32 v25, 1, v23
    v_lshl_add_u32 v11, v25, 10, v24
    v_xor_b32 v25, 1, v22
    v_lshl_add_u32 v11, v25, 3, v11
    v_add_u32 v15, 0x10000, v11
    s_lshl_b32 s30, s3, 2
    s_add_u32 s30, s30, 131072
    v_mov_b32 v7, s30
    s_branch w_cold
chain_map:
    s_lshl_b32 s52, s12, 5
    s_add_u32 s52, s52, s13
    s_lshr_b32 s15, s52, 2
    s_lshr_b32 s14, s52, 4
    s_and_b32 s34, s13, 15
    s_and_b32 s53, s13, 3
    s_mov_b32 s16, 0
    s_mov_b32 s22, 131072
    s_mov_b32 s100, 131072
    s_getreg_b32 s40, hwreg(HW_REG_XCC_ID)
    s_and_b32 s40, s40, 15
    s_mul_i32 s19, s40, s40
    s_lshl_b32 s19, s19, 18
    s_lshl_b32 s40, s40, 8
    s_add_u32 s40, s40, s19
    s_add_u32 s40, s40, 1
    s_lshl_b32 s35, s14, 4
    s_add_u32 s35, s35, 218104320
    s_and_b32 s21, s3, 3
    s_mul_i32 s42, s21, 24576
    s_add_u32 s42, s42, 65536
    s_lshl_b32 s41, s14, 2
    s_add_u32 s41, s41, s21
    s_lshl_b32 s41, s41, 12
    s_add_u32 s101, s42, 8192
    s_bfe_u32 s17, s34, 0x20001
    s_cmp_eq_u32 s17, s21
    s_cselect_b32 s68, 20480, s42
    s_xor_b32 s68, s68, s101
    s_lshl_b32 s43, s21, 13
    s_add_u32 s43, s43, 138412032
    s_lshl_b32 s69, s21, 24
    s_lshl_b32 s17, s52, 10
    s_add_u32 s69, s69, s17
    s_add_u32 s69, s69, 20971520
    s_cmp_ge_u32 s3, 4
    s_cbranch_scc1 ch_a_pro
    s_add_u32 s41, s41, 262144
    s_lshl_b32 s38, s15, 13
    s_add_u32 s38, s38, 214958080
    s_lshl_b32 s17, s13, 1
    s_and_b32 s18, s3, 1
    s_add_u32 s17, s17, s18
    s_lshl_b32 s17, s17, 1
    s_cmp_lt_u32 s3, 2
    s_cselect_b32 s56, 0xffff, 0
    s_mov_b32 s57, 0
    s_lshr_b32 s18, s17, 1
    s_and_b32 s19, s17, 1
    s_lshl_b32 s20, s12, 14
    s_add_u32 s20, s20, 213909504
    s_lshl_b32 s36, s3, 12
    s_add_u32 s36, s36, s20
    s_lshl_b32 s37, s18, 8
    s_add_u32 s37, s37, s20
    s_lshl_b32 s20, s19, 5
    s_add_u32 s37, s37, s20
    s_lshr_b32 s39, s17, 3
    s_lshl_b32 s39, s39, 14
    s_and_b32 s20, s17, 7
    s_lshl_b32 s20, s20, 10
    s_add_u32 s39, s39, s20
    s_add_u32 s39, s39, 209715200
    s_lshl_b32 s30, s14, 22
    s_lshl_b32 s20, s34, 11
    s_add_u32 s30, s30, s20
    s_lshl_b32 s20, s3, 9
    s_add_u32 s30, s30, s20
    s_add_u32 s30, s30, 78643200
    s_lshl_b32 s55, s15, 13
    s_add_u32 s55, s55, 192937984
    s_mov_b32 s26, s38
    s_mov_b32 s54, s30
    s_mov_b32 s29, 2
    s_mov_b32 s58, 0
    s_mov_b32 s59, 0
    s_bfe_u32 s17, s34, 0x20001
    s_lshl_b32 s60, s14, 2
    s_add_u32 s60, s60, s17
    s_lshl_b32 s60, s60, 2
    s_add_u32 s60, s60, s3
    s_lshl_b32 s60, s60, 10
    s_and_b32 s17, s34, 1
    s_lshl_b32 s17, s17, 17
    s_add_u32 s60, s60, s17
    s_add_u32 s60, s60, 175898624
    s_mov_b32 s31, 786432
    v_and_b32 v20, 63, v0
    v_lshlrev_b32 v1, 4, v20
    v_mov_b32 v10, -1
    v_mov_b32 v11, -1
    v_lshrrev_b32 v21, 2, v20
    v_and_b32 v22, 3, v20
    v_lshlrev_b32 v21, 13, v21
    v_lshl_add_u32 v21, v22, 4, v21
    s_lshl_b32 s17, s3, 21
    s_lshl_b32 s18, s52, 6
    s_add_u32 s17, s17, s18
    s_lshl_b32 s19, s3, 15
    s_mov_b32 s10, 8388608
    s_mov_b32 s11, 131072
    v_lshrrev_b32 v24, 5, v20
    v_bfe_u32 v25, v20, 3, 1
    v_lshl_add_u32 v24, v24, 1, v25
    v_bfe_u32 v26, v20, 4, 1
    v_xor_b32 v26, v26, v25
    v_lshl_add_u32 v24, v24, 1, v26
    v_bfe_u32 v25, v20, 2, 1
    v_lshl_add_u32 v24, v24, 2, v25
    v_lshlrev_b32 v24, 6, v24
    v_lshl_add_u32 v24, v22, 3, v24
    v_add_u32 v24, s19, v24
    s_and_b32 s70, s13, 0
    s_lshl_b32 s72, s70, 20
    s_lshl_b32 s73, s70, 21
    s_lshl_b32 s70, s70, 13
    s_sub_u32 s71, s19, s70
    s_add_u32 s70, s19, s70
    s_load_dwordx2 s[8:9], s[0:1], 16
    s_add_u32 s20, s17, s72
    s_waitcnt lgkmcnt(0)
    s_add_u32 m0, s70, 0
    s_nop 0
    buffer_load_dwordx4 v21, s[8:11], s20 offen lds
    s_add_u32 s20, s20, 131072
    s_add_u32 m0, s70, 1024
    s_nop 0
    buffer_load_dwordx4 v21, s[8:11], s20 offen lds
    s_add_u32 s20, s20, 131072
    s_barrier
    v_mov_b32 v27, 131136
    ds_read_b32 v27, v27
    s_mov_b32 s96, s97
    s_waitcnt lgkmcnt(0)
    v_readfirstlane_b32 s97, v27
    s_cmp_lg_u32 s96, s97
    s_cbranch_scc1 k_restart
    s_add_u32 m0, s70, 2048
    s_nop 0
    buffer_load_dwordx4 v21, s[8:11], s20 offen lds
    s_add_u32 s20, s20, 131072
    s_add_u32 m0, s70, 3072
    s_nop 0
    buffer_load_dwordx4 v21, s[8:11], s20 offen lds
    s_add_u32 s20, s20, 131072
    s_add_u32 m0, s70, 4096
    s_nop 0
    buffer_load_dwordx4 v21, s[8:11], s20 offen lds
    s_add_u32 s20, s20, 131072
    s_add_u32 m0, s70, 5120
    s_nop 0
    buffer_load_dwordx4 v21, s[8:11], s20 offen lds
    s_add_u32 s20, s20, 131072
    s_add_u32 m0, s70, 6144
    s_nop 0
    buffer_load_dwordx4 v21, s[8:11], s20 offen lds
    s_add_u32 s20, s20, 131072
    s_add_u32 m0, s70, 7168
    s_nop 0
    buffer_load_dwordx4 v21, s[8:11], s20 offen lds
    s_add_u32 s20, s20, 131072
    s_sub_u32 s20, s20, s73
    s_add_u32 m0, s71, 8192
    s_nop 0
    buffer_load_dwordx4 v21, s[8:11], s20 offen lds
    s_add_u32 s20, s20, 131072
    s_add_u32 m0, s71, 9216
    s_nop 0
    buffer_load_dwordx4 v21, s[8:11], s20 offen lds
    s_add_u32 s20, s20, 131072
    s_add_u32 m0, s71, 10240
    s_nop 0
    buffer_load_dwordx4 v21, s[8:11], s20 offen lds
    s_add_u32 s20, s20, 131072
    s_add_u32 m0, s71, 11264
    s_nop 0
    buffer_load_dwordx4 v21, s[8:11], s20 offen lds
    s_add_u32 s20, s20, 131072
    s_add_u32 m0, s71, 12288
    s_nop 0
    buffer_load_dwordx4 v21, s[8:11], s20 offen lds
    s_add_u32 s20, s20, 131072
    s_add_u32 m0, s71, 13312
    s_nop 0
    buffer_load_dwordx4 v21, s[8:11], s20 offen lds
    s_add_u32 s20, s20, 131072
    s_add_u32 m0, s71, 14336
    s_nop 0
    buffer_load_dwordx4 v21, s[8:11], s20 offen lds
    s_add_u32 s20, s20, 131072
    s_add_u32 m0, s71, 15360
    s_nop 0
    buffer_load_dwordx4 v21, s[8:11], s20 offen lds
    s_add_u32 s20, s20, 131072
    s_load_dwordx2 s[8:9], s[0:1], 24
    s_add_u32 s20, s17, s72
    s_waitcnt lgkmcnt(0)
    s_add_u32 m0, s70, 16384
    s_nop 0
    buffer_load_dwordx4 v21, s[8:11], s20 offen lds
    s_add_u32 s20, s20, 131072
    s_add_u32 m0, s70, 17408
    s_nop 0
    buffer_load_dwordx4 v21, s[8:11], s20 offen lds
    s_add_u32 s20, s20, 131072
    s_add_u32 m0, s70, 18432
    s_nop 0
    buffer_load_dwordx4 v21, s[8:11], s20 offen lds
    s_add_u32 s20, s20, 131072
    s_add_u32 m0, s70, 19456
    s_nop 0
    buffer_load_dwordx4 v21, s[8:11], s20 offen lds
    s_add_u32 s20, s20, 131072
    s_add_u32 m0, s70, 20480
    s_nop 0
    buffer_load_dwordx4 v21, s[8:11], s20 offen lds
    s_add_u32 s20, s20, 131072
    s_add_u32 m0, s70, 21504
    s_nop 0
    buffer_load_dwordx4 v21, s[8:11], s20 offen lds
    s_add_u32 s20, s20, 131072
    s_add_u32 m0, s70, 22528
    s_nop 0
    buffer_load_dwordx4 v21, s[8:11], s20 offen lds
    s_add_u32 s20, s20, 131072
    s_add_u32 m0, s70, 23552
    s_nop 0
    buffer_load_dwordx4 v21, s[8:11], s20 offen lds
    s_add_u32 s20, s20, 131072
    s_sub_u32 s20, s20, s73
    s_add_u32 m0, s71, 24576
    s_nop 0
    buffer_load_dwordx4 v21, s[8:11], s20 offen lds
    s_add_u32 s20, s20, 131072
    s_add_u32 m0, s71, 25600
    s_nop 0
    buffer_load_dwordx4 v21, s[8:11], s20 offen lds
    s_add_u32 s20, s20, 131072
    s_add_u32 m0, s71, 26624
    s_nop 0
    buffer_load_dwordx4 v21, s[8:11], s20 offen lds
    s_add_u32 s20, s20, 131072
    s_add_u32 m0, s71, 27648
    s_nop 0
    buffer_load_dwordx4 v21, s[8:11], s20 offen lds
    s_add_u32 s20, s20, 131072
    s_add_u32 m0, s71, 28672
    s_nop 0
    buffer_load_dwordx4 v21, s[8:11], s20 offen lds
    s_add_u32 s20, s20, 131072
    s_add_u32 m0, s71, 29696
    s_nop 0
    buffer_load_dwordx4 v21, s[8:11], s20 offen lds
    s_add_u32 s20, s20, 131072
    s_add_u32 m0, s71, 30720
    s_nop 0
    buffer_load_dwordx4 v21, s[8:11], s20 offen lds
    s_add_u32 s20, s20, 131072
    s_add_u32 m0, s71, 31744
    s_nop 0
    buffer_load_dwordx4 v21, s[8:11], s20 offen lds
    s_add_u32 s20, s20, 131072
    s_load_dwordx2 s[8:9], s[0:1], 32
    s_add_u32 s20, s17, s72
    s_waitcnt lgkmcnt(0)
    buffer_load_dwordx4 v[96:99], v21, s[8:11], s20 offen
    s_add_u32 s20, s20, 131072
    buffer_load_dwordx4 v[100:103], v21, s[8:11], s20 offen
    s_add_u32 s20, s20, 131072
    buffer_load_dwordx4 v[104:107], v21, s[8:11], s20 offen
    s_add_u32 s20, s20, 131072
    buffer_load_dwordx4 v[108:111], v21, s[8:11], s20 offen
    s_add_u32 s20, s20, 131072
    buffer_load_dwordx4 v[144:147], v21, s[8:11], s20 offen
    s_add_u32 s20, s20, 131072
    buffer_load_dwordx4 v[148:151], v21, s[8:11], s20 offen
    s_add_u32 s20, s20, 131072
    buffer_load_dwordx4 v[152:155], v21, s[8:11], s20 offen
    s_add_u32 s20, s20, 131072
    buffer_load_dwordx4 v[156:159], v21, s[8:11], s20 offen
    s_add_u32 s20, s20, 131072
    s_sub_u32 s20, s20, s73
    buffer_load_dwordx4 v[192:195], v21, s[8:11], s20 offen
    s_add_u32 s20, s20, 131072
    buffer_load_dwordx4 v[196:199], v21, s[8:11], s20 offen
    s_add_u32 s20, s20, 131072
    buffer_load_dwordx4 v[200:203], v21, s[8:11], s20 offen
    s_add_u32 s20, s20, 131072
    buffer_load_dwordx4 v[204:207], v21, s[8:11], s20 offen
    s_add_u32 s20, s20, 131072
    buffer_load_dwordx4 v[240:243], v21, s[8:11], s20 offen
    s_add_u32 s20, s20, 131072
    buffer_load_dwordx4 v[244:247], v21, s[8:11], s20 offen
    s_add_u32 s20, s20, 131072
    buffer_load_dwordx4 v[248:251], v21, s[8:11], s20 offen
    s_add_u32 s20, s20, 131072
    buffer_load_dwordx4 v[252:255], v21, s[8:11], s20 offen
    s_add_u32 s20, s20, 131072
    s_load_dwordx2 s[8:9], s[0:1], 8
    s_mov_b32 s10, 16384
    v_bfe_u32 v57, v20, 2, 2
    v_and_b32 v58, 1, v20
    v_lshl_add_u32 v57, v57, 1, v58
    v_lshlrev_b32 v57, 11, v57
    v_lshrrev_b32 v58, 4, v20
    v_lshl_add_u32 v57, v58, 5, v57
    v_bfe_u32 v58, v20, 1, 1
    v_lshl_add_u32 v57, v58, 4, v57
    v_lshl_add_u32 v59, v58, 3, v57
    v_xor_b32 v60, 8, v59
    s_lshl_b32 s20, s3, 9
    s_waitcnt lgkmcnt(0)
    buffer_load_dwordx2 v[32:33], v59, s[8:11], s20 offen offset:0
    buffer_load_dwordx2 v[34:35], v60, s[8:11], s20 offen offset:0
    buffer_load_dwordx2 v[36:37], v59, s[8:11], s20 offen offset:128
    buffer_load_dwordx2 v[38:39], v60, s[8:11], s20 offen offset:128
    buffer_load_dwordx2 v[40:41], v59, s[8:11], s20 offen offset:256
    buffer_load_dwordx2 v[42:43], v60, s[8:11], s20 offen offset:256
    buffer_load_dwordx2 v[44:45], v59, s[8:11], s20 offen offset:384
    buffer_load_dwordx2 v[46:47], v60, s[8:11], s20 offen offset:384
    s_barrier
    v_add_u32 v56, s70, v1
    v_add_u32 v26, s71, v1
    s_waitcnt vmcnt(40)
    ds_read_b64_tr_b16 v[64:65], v24 offset:0
    ds_read_b64_tr_b16 v[66:67], v24 offset:128
    ds_read_b64_tr_b16 v[68:69], v24 offset:2048
    ds_read_b64_tr_b16 v[70:71], v24 offset:2176
    ds_read_b64_tr_b16 v[72:73], v24 offset:32
    ds_read_b64_tr_b16 v[74:75], v24 offset:160
    ds_read_b64_tr_b16 v[76:77], v24 offset:2080
    ds_read_b64_tr_b16 v[78:79], v24 offset:2208
    s_waitcnt lgkmcnt(0)
    ds_read_b64_tr_b16 v[112:113], v24 offset:4096
    ds_read_b64_tr_b16 v[114:115], v24 offset:4224
    ds_read_b64_tr_b16 v[116:117], v24 offset:6144
    ds_read_b64_tr_b16 v[118:119], v24 offset:6272
    ds_read_b64_tr_b16 v[120:121], v24 offset:4128
    ds_read_b64_tr_b16 v[122:123], v24 offset:4256
    ds_read_b64_tr_b16 v[124:125], v24 offset:6176
    ds_read_b64_tr_b16 v[126:127], v24 offset:6304
    s_waitcnt lgkmcnt(0)
    ds_read_b64_tr_b16 v[160:161], v24 offset:8192
    ds_read_b64_tr_b16 v[162:163], v24 offset:8320
    ds_read_b64_tr_b16 v[164:165], v24 offset:10240
    ds_read_b64_tr_b16 v[166:167], v24 offset:10368
    ds_read_b64_tr_b16 v[168:169], v24 offset:8224
    ds_read_b64_tr_b16 v[170:171], v24 offset:8352
    ds_read_b64_tr_b16 v[172:173], v24 offset:10272
    ds_read_b64_tr_b16 v[174:175], v24 offset:10400
    s_waitcnt lgkmcnt(0)
    ds_read_b64_tr_b16 v[208:209], v24 offset:12288
    ds_read_b64_tr_b16 v[210:211], v24 offset:12416
    ds_read_b64_tr_b16 v[212:213], v24 offset:14336
    ds_read_b64_tr_b16 v[214:215], v24 offset:14464
    ds_read_b64_tr_b16 v[216:217], v24 offset:12320
    ds_read_b64_tr_b16 v[218:219], v24 offset:12448
    ds_read_b64_tr_b16 v[220:221], v24 offset:14368
    ds_read_b64_tr_b16 v[222:223], v24 offset:14496
    s_waitcnt lgkmcnt(0)
    s_waitcnt vmcnt(24)
    ds_read_b64_tr_b16 v[80:81], v24 offset:16384
    ds_read_b64_tr_b16 v[82:83], v24 offset:16512
    ds_read_b64_tr_b16 v[84:85], v24 offset:18432
    ds_read_b64_tr_b16 v[86:87], v24 offset:18560
    ds_read_b64_tr_b16 v[88:89], v24 offset:16416
    ds_read_b64_tr_b16 v[90:91], v24 offset:16544
    ds_read_b64_tr_b16 v[92:93], v24 offset:18464
    ds_read_b64_tr_b16 v[94:95], v24 offset:18592
    s_waitcnt lgkmcnt(0)
    ds_read_b64_tr_b16 v[128:129], v24 offset:20480
    ds_read_b64_tr_b16 v[130:131], v24 offset:20608
    ds_read_b64_tr_b16 v[132:133], v24 offset:22528
    ds_read_b64_tr_b16 v[134:135], v24 offset:22656
    ds_read_b64_tr_b16 v[136:137], v24 offset:20512
    ds_read_b64_tr_b16 v[138:139], v24 offset:20640
    ds_read_b64_tr_b16 v[140:141], v24 offset:22560
    ds_read_b64_tr_b16 v[142:143], v24 offset:22688
    s_waitcnt lgkmcnt(0)
    ds_read_b64_tr_b16 v[176:177], v24 offset:24576
    ds_read_b64_tr_b16 v[178:179], v24 offset:24704
    ds_read_b64_tr_b16 v[180:181], v24 offset:26624
    ds_read_b64_tr_b16 v[182:183], v24 offset:26752
    ds_read_b64_tr_b16 v[184:185], v24 offset:24608
    ds_read_b64_tr_b16 v[186:187], v24 offset:24736
    ds_read_b64_tr_b16 v[188:189], v24 offset:26656
    ds_read_b64_tr_b16 v[190:191], v24 offset:26784
    s_waitcnt lgkmcnt(0)
    ds_read_b64_tr_b16 v[224:225], v24 offset:28672
    ds_read_b64_tr_b16 v[226:227], v24 offset:28800
    ds_read_b64_tr_b16 v[228:229], v24 offset:30720
    ds_read_b64_tr_b16 v[230:231], v24 offset:30848
    ds_read_b64_tr_b16 v[232:233], v24 offset:28704
    ds_read_b64_tr_b16 v[234:235], v24 offset:28832
    ds_read_b64_tr_b16 v[236:237], v24 offset:30752
    ds_read_b64_tr_b16 v[238:239], v24 offset:30880
    s_waitcnt lgkmcnt(0)
    s_waitcnt vmcnt(8)
    ds_write_b128 v56, v[96:99] offset:0
    ds_write_b128 v56, v[100:103] offset:1024
    ds_write_b128 v56, v[104:107] offset:2048
    ds_write_b128 v56, v[108:111] offset:3072
    ds_write_b128 v56, v[144:147] offset:4096
    ds_write_b128 v56, v[148:151] offset:5120
    ds_write_b128 v56, v[152:155] offset:6144
    ds_write_b128 v56, v[156:159] offset:7168
    ds_write_b128 v26, v[192:195] offset:8192
    ds_write_b128 v26, v[196:199] offset:9216
    ds_write_b128 v26, v[200:203] offset:10240
    ds_write_b128 v26, v[204:207] offset:11264
    ds_write_b128 v26, v[240:243] offset:12288
    ds_write_b128 v26, v[244:247] offset:13312
    ds_write_b128 v26, v[248:251] offset:14336
    ds_write_b128 v26, v[252:255] offset:15360
    s_waitcnt lgkmcnt(0)
    ds_read_b64_tr_b16 v[96:97], v24 offset:0
    ds_read_b64_tr_b16 v[98:99], v24 offset:128
    ds_read_b64_tr_b16 v[100:101], v24 offset:2048
    ds_read_b64_tr_b16 v[102:103], v24 offset:2176
    ds_read_b64_tr_b16 v[104:105], v24 offset:32
    ds_read_b64_tr_b16 v[106:107], v24 offset:160
    ds_read_b64_tr_b16 v[108:109], v24 offset:2080
    ds_read_b64_tr_b16 v[110:111], v24 offset:2208
    s_waitcnt lgkmcnt(0)
    ds_read_b64_tr_b16 v[144:145], v24 offset:4096
    ds_read_b64_tr_b16 v[146:147], v24 offset:4224
    ds_read_b64_tr_b16 v[148:149], v24 offset:6144
    ds_read_b64_tr_b16 v[150:151], v24 offset:6272
    ds_read_b64_tr_b16 v[152:153], v24 offset:4128
    ds_read_b64_tr_b16 v[154:155], v24 offset:4256
    ds_read_b64_tr_b16 v[156:157], v24 offset:6176
    ds_read_b64_tr_b16 v[158:159], v24 offset:6304
    s_waitcnt lgkmcnt(0)
    ds_read_b64_tr_b16 v[192:193], v24 offset:8192
    ds_read_b64_tr_b16 v[194:195], v24 offset:8320
    ds_read_b64_tr_b16 v[196:197], v24 offset:10240
    ds_read_b64_tr_b16 v[198:199], v24 offset:10368
    ds_read_b64_tr_b16 v[200:201], v24 offset:8224
    ds_read_b64_tr_b16 v[202:203], v24 offset:8352
    ds_read_b64_tr_b16 v[204:205], v24 offset:10272
    ds_read_b64_tr_b16 v[206:207], v24 offset:10400
    s_waitcnt lgkmcnt(0)
    ds_read_b64_tr_b16 v[240:241], v24 offset:12288
    ds_read_b64_tr_b16 v[242:243], v24 offset:12416
    ds_read_b64_tr_b16 v[244:245], v24 offset:14336
    ds_read_b64_tr_b16 v[246:247], v24 offset:14464
    ds_read_b64_tr_b16 v[248:249], v24 offset:12320
    ds_read_b64_tr_b16 v[250:251], v24 offset:12448
    ds_read_b64_tr_b16 v[252:253], v24 offset:14368
    ds_read_b64_tr_b16 v[254:255], v24 offset:14496
    s_waitcnt lgkmcnt(0)
    v_mov_b32 v21, 0x44444444
    v_mov_b32 v22, 0xeeeeeeee
    v_and_b32 v23, 2, v20
    v_cmp_eq_u32 vcc, 0, v23
    s_nop 1
    v_cndmask_b32 v8, v22, v21, vcc
    v_bfe_u32 v21, v20, 2, 3
    v_lshrrev_b32 v22, 5, v20
    v_mul_u32_u24 v23, 160, v21
    v_mul_u32_u24 v24, 1280, v22
    v_add_u32 v23, v23, v24
    v_and_b32 v24, 3, v20
    v_lshl_add_u32 v27, v24, 4, v23
    v_lshrrev_b32 v23, 1, v21
    v_and_b32 v21, 1, v21
    v_lshl_add_u32 v21, v23, 2, v21
    v_xor_b32 v22, 1, v22
    v_lshl_add_u32 v21, v22, 1, v21
    v_bfe_u32 v22, v20, 1, 1
    v_lshl_add_u32 v21, v22, 4, v21
    v_xor_b32 v22, v20, v22
    v_and_b32 v22, 1, v22
    v_lshlrev_b32 v21, 4, v21
    v_lshl_add_u32 v25, v22, 3, v21
    v_lshrrev_b32 v21, 3, v20
    v_mul_u32_u24 v23, 160, v21
    v_and_b32 v24, 7, v20
    v_lshl_add_u32 v28, v24, 4, v23
    v_lshrrev_b32 v23, 1, v21
    v_and_b32 v21, 1, v21
    v_lshl_add_u32 v21, v23, 2, v21
    v_and_b32 v22, 1, v20
    v_lshl_add_u32 v21, v22, 1, v21
    v_bfe_u32 v22, v20, 2, 1
    v_lshl_add_u32 v21, v22, 4, v21
    v_bfe_u32 v22, v20, 1, 1
    v_lshlrev_b32 v21, 4, v21
    v_lshl_add_u32 v26, v22, 3, v21
    s_lshl_b32 s17, s53, 10
    s_lshl_b32 s18, s3, 9
    s_add_u32 s17, s17, s18
    s_lshl_b32 s18, s3, 6
    s_lshl_b32 s19, s53, 9
    s_add_u32 s19, s19, 4096
    s_cmp_ge_u32 s3, 2
    s_cselect_b32 s17, s19, s17
    s_cselect_b32 s18, 2560, s18
    s_cselect_b64 vcc, -1, 0
    v_cndmask_b32 v22, v25, v26, vcc
    v_cndmask_b32 v23, v27, v28, vcc
    v_add_u32 v2, s17, v22
    v_add_u32 v4, s18, v23
    v_lshrrev_b32 v21, 4, v20
    v_and_b32 v22, 15, v20
    v_mul_u32_u24 v23, 320, v21
    v_lshl_add_u32 v23, v22, 2, v23
    s_mul_i32 s17, s3, 3840
    v_add_u32 v3, s17, v23
    v_add_u32 v61, 1280, v3
    v_bfe_u32 v24, v20, 3, 1
    v_bfe_u32 v25, v20, 2, 1
    v_xor_b32 v25, v25, v24
    v_bfe_u32 v26, v20, 1, 1
    v_lshl_add_u32 v25, v26, 1, v25
    v_lshl_add_u32 v25, v24, 2, v25
    v_and_b32 v26, 1, v20
    v_lshl_add_u32 v25, v25, 1, v26
    v_sub_u32 v25, v25, v22
    v_lshl_add_u32 v25, v25, 2, v3
    v_add_u32 v62, 2560, v25
    v_lshlrev_b32 v23, 4, v22
    v_lshl_add_u32 v6, v21, 12, v23
    s_lshl_b32 s17, s3, 10
    s_add_u32 s17, s17, 32768
    v_add_u32 v6, s17, v6
    v_lshrrev_b32 v24, 1, v21
    v_lshl_add_u32 v23, v24, 15, v23
    v_and_b32 v24, 1, v21
    v_lshl_add_u32 v7, v24, 8, v23
    v_mov_b32 v58, 15872
    v_bfe_u32 v23, v20, 1, 2
    v_lshlrev_b32 v23, 6, v23
    v_and_b32 v25, 1, v20
    v_lshl_add_u32 v23, v25, 4, v23
    v_bfe_u32 v24, v20, 3, 1
    v_lshl_add_u32 v5, v24, 5, v23
    v_and_b32 v23, 7, v20
    v_lshlrev_b32 v23, 7, v23
    v_bfe_u32 v24, v20, 3, 1
    v_lshl_add_u32 v23, v24, 17, v23
    v_lshrrev_b32 v24, 4, v20
    v_add_u32 v24, 1, v24
    v_cmp_le_u32 vcc, 3, v24
    s_nop 1
    v_cndmask_b32 v24, v24, 0, vcc
    v_lshl_add_u32 v23, v24, 24, v23
    s_lshl_b32 s17, s14, 14
    s_lshl_b32 s18, s34, 10
    s_add_u32 s17, s17, s18
    s_add_u32 s17, s17, 4194304
    v_add_u32 v0, s17, v23
    s_lshl_b32 s17, s3, 2
    s_add_u32 s17, s17, 15872
    v_mov_b32 v63, s17
    v_and_b32 v21, 15, v20
    v_and_b32 v22, 1, v21
    v_lshlrev_b32 v22, 4, v22
    v_mov_b32 v12, 0x3f80
    v_lshlrev_b32 v22, v22, v12
    v_lshrrev_b32 v21, 1, v21
    v_cmp_eq_u32 vcc, 0, v21
    s_nop 1
    v_cndmask_b32 v12, 0, v22, vcc
    v_cmp_eq_u32 vcc, 1, v21
    s_nop 1
    v_cndmask_b32 v13, 0, v22, vcc
    v_cmp_eq_u32 vcc, 2, v21
    s_nop 1
    v_cndmask_b32 v14, 0, v22, vcc
    v_cmp_eq_u32 vcc, 3, v21
    s_nop 1
    v_cndmask_b32 v15, 0, v22, vcc
    s_waitcnt vmcnt(0)
    v_mov_b32 v16, v32
    v_mov_b32 v17, v33
    v_mov_b32 v18, v34
    v_mov_b32 v19, v35
    v_mov_b32 v20, v36
    v_mov_b32 v21, v37
    v_mov_b32 v22, v38
    v_mov_b32 v23, v39
    v_mov_b32 v24, v40
    v_mov_b32 v25, v41
    v_mov_b32 v26, v42
    v_mov_b32 v27, v43
    v_mov_b32 v28, v44
    v_mov_b32 v29, v45
    v_mov_b32 v30, v46
    v_mov_b32 v31, v47
    v_mov_b32 v52, -1
    v_mov_b32 v53, -1
    v_mov_b32 v54, -1
    v_mov_b32 v55, -1
    s_add_u32 s17, s30, 786432
    buffer_store_dwordx4 v[52:55], v7, s[4:7], s17 offen sc1
    s_add_u32 s17, s30, 851968
    buffer_store_dwordx4 v[52:55], v7, s[4:7], s17 offen sc1
    s_add_u32 s17, s30, 917504
    buffer_store_dwordx4 v[52:55], v7, s[4:7], s17 offen sc1
    s_add_u32 s17, s30, 983040
    buffer_store_dwordx4 v[52:55], v7, s[4:7], s17 offen sc1
    s_lshl_b32 s40, s40, 5
    s_barrier
    ds_write_b32 v63, v10
    ds_write_b32 v63, v10 offset:16
    ds_write_b32 v63, v10 offset:32
    ds_write_b32 v63, v10 offset:48
    v_mov_b32 v60, 12
    v_mov_b32 v56, 15968
    s_waitcnt lgkmcnt(0)
    s_barrier
    ds_read_b64 v[32:33], v56
    s_waitcnt lgkmcnt(0)
    v_cmp_ne_u32 vcc, s40, v32
    s_setprio 3
    v_readfirstlane_b32 s17, v33
    s_add_u32 s39, s39, s17
    s_cbranch_vccnz ch_p_slow
    v_mov_b32 v32, 0
    v_mov_b32 v33, 0
    v_mov_b32 v34, 0
    v_mov_b32 v35, 0
    v_mov_b32 v36, 0
    v_mov_b32 v37, 0
    v_mov_b32 v38, 0
    v_mov_b32 v39, 0
    v_mov_b32 v40, 0
    v_mov_b32 v41, 0
    v_mov_b32 v42, 0
    v_mov_b32 v43, 0
    v_mov_b32 v44, 0
    v_mov_b32 v45, 0
    v_mov_b32 v46, 0
    v_mov_b32 v47, 0
    v_mov_b32 v48, 0
    v_mov_b32 v49, 0
    v_mov_b32 v50, 0
    v_mov_b32 v51, 0
    v_mov_b32 v52, 0
    v_mov_b32 v53, 0
    v_mov_b32 v54, 0
    v_mov_b32 v55, 0
    v_mov_b32 v59, 0
    s_nop 1
    s_branch ploopL_22_nc
.p2align 6
    s_nop 0
    s_nop 0
    s_nop 0
    s_nop 0
    s_nop 0
    s_nop 0
    s_nop 0
    s_nop 0
    s_nop 0
    s_nop 0
    s_nop 0
ploopL_22:
    v_mov_b32 v32, 0
    v_mov_b32 v33, 0
    v_mov_b32 v34, 0
    v_mov_b32 v35, 0
    v_mov_b32 v36, 0
    v_mov_b32 v37, 0
    v_mov_b32 v38, 0
    v_mov_b32 v39, 0
    v_mov_b32 v40, 0
    v_mov_b32 v41, 0
    v_mov_b32 v42, 0
    v_mov_b32 v43, 0
    v_mov_b32 v44, 0
    v_mov_b32 v45, 0
    v_mov_b32 v46, 0
    v_mov_b32 v47, 0
    v_mov_b32 v48, 0
    v_mov_b32 v49, 0
    v_mov_b32 v50, 0
    v_mov_b32 v51, 0
    v_mov_b32 v52, 0
    v_mov_b32 v53, 0
    v_mov_b32 v54, 0
    v_mov_b32 v55, 0
    s_bitcmp1_b32 s29, 0
    s_cbranch_scc1 gate_23_ok
    s_add_u32 s21, s16, 1
    s_min_u32 s21, s21, 63
    s_cmp_ge_u32 s21, 16
    s_cselect_b32 s19, 12, 8
    s_and_b32 s32, s21, 4
    s_lshr_b32 s21, s21, 3
    s_lshl_b32 s21, s21, 8
    s_add_u32 s32, s32, s21
    s_add_u32 s32, s32, s35
gate_23:
    buffer_load_dword v9, off, s[4:7], s32 sc1
    s_waitcnt vmcnt(0)
    v_readfirstlane_b32 s21, v9
    s_cmp_ge_u32 s21, s19
    s_cbranch_scc1 gate_23_set
    s_sleep 8
    s_sub_u32 s22, s22, 1
    s_cbranch_scc0 gate_23
    s_mov_b32 s22, 0
gate_23_set:
    s_bitset1_b32 s29, 0
gate_23_ok:
    s_sleep 1
    buffer_load_dwordx4 v[16:19], v1, s[4:7], s23 offen offset:0 sc1
    buffer_load_dwordx4 v[20:23], v1, s[4:7], s23 offen offset:1024 sc1
    buffer_load_dwordx4 v[24:27], v1, s[4:7], s23 offen offset:2048 sc1
    buffer_load_dwordx4 v[28:31], v1, s[4:7], s23 offen offset:3072 sc1
    s_waitcnt vmcnt(3)
    v_cmp_eq_u32 vcc, -1, v16
    s_cbranch_vccnz ploopL_22_rm_0
ploopL_22_rm_0ok:
    v_smfmac_f32_16x16x64_bf16 v[32:35], v[16:19], v[64:71], v8
    v_smfmac_f32_16x16x64_bf16 v[36:39], v[16:19], v[72:79], v8
    s_waitcnt vmcnt(2)
    v_cmp_eq_u32 vcc, -1, v20
    v_smfmac_f32_16x16x64_bf16 v[40:43], v[16:19], v[80:87], v8
    v_smfmac_f32_16x16x64_bf16 v[44:47], v[16:19], v[88:95], v8
    v_smfmac_f32_16x16x64_bf16 v[48:51], v[16:19], v[96:103], v8
    v_smfmac_f32_16x16x64_bf16 v[52:55], v[16:19], v[104:111], v8
    s_cbranch_vccnz ploopL_22_rm_1
ploopL_22_rm_1ok:
    v_smfmac_f32_16x16x64_bf16 v[32:35], v[20:23], v[112:119], v8
    v_smfmac_f32_16x16x64_bf16 v[36:39], v[20:23], v[120:127], v8
    s_waitcnt vmcnt(1)
    v_cmp_eq_u32 vcc, -1, v24
    v_smfmac_f32_16x16x64_bf16 v[40:43], v[20:23], v[128:135], v8
    v_smfmac_f32_16x16x64_bf16 v[44:47], v[20:23], v[136:143], v8
    v_smfmac_f32_16x16x64_bf16 v[48:51], v[20:23], v[144:151], v8
    v_smfmac_f32_16x16x64_bf16 v[52:55], v[20:23], v[152:159], v8
    s_cbranch_vccnz ploopL_22_rm_2
ploopL_22_rm_2ok:
    v_smfmac_f32_16x16x64_bf16 v[32:35], v[24:27], v[160:167], v8
    v_smfmac_f32_16x16x64_bf16 v[36:39], v[24:27], v[168:175], v8
    s_waitcnt vmcnt(0)
    v_cmp_eq_u32 vcc, -1, v28
    v_smfmac_f32_16x16x64_bf16 v[40:43], v[24:27], v[176:183], v8
    v_smfmac_f32_16x16x64_bf16 v[44:47], v[24:27], v[184:191], v8
    v_smfmac_f32_16x16x64_bf16 v[48:51], v[24:27], v[192:199], v8
    v_smfmac_f32_16x16x64_bf16 v[52:55], v[24:27], v[200:207], v8
    s_cbranch_vccnz ploopL_22_rm_3
ploopL_22_rm_3ok:
    v_smfmac_f32_16x16x64_bf16 v[32:35], v[28:31], v[208:215], v8
    ds_write_b32 v63, v59 offset:32
    v_smfmac_f32_16x16x64_bf16 v[36:39], v[28:31], v[216:223], v8
    v_smfmac_f32_16x16x64_bf16 v[40:43], v[28:31], v[224:231], v8
    v_smfmac_f32_16x16x64_bf16 v[44:47], v[28:31], v[232:239], v8
    v_smfmac_f32_16x16x64_bf16 v[48:51], v[28:31], v[240:247], v8
    v_smfmac_f32_16x16x64_bf16 v[52:55], v[28:31], v[248:255], v8
    s_branch ploopL_22_mmd
ploopL_22_nc:
    v_smfmac_f32_16x16x64_bf16 v[32:35], v[16:19], v[64:71], v8
    v_smfmac_f32_16x16x64_bf16 v[36:39], v[16:19], v[72:79], v8
    v_smfmac_f32_16x16x64_bf16 v[40:43], v[16:19], v[80:87], v8
    v_smfmac_f32_16x16x64_bf16 v[44:47], v[16:19], v[88:95], v8
    v_smfmac_f32_16x16x64_bf16 v[48:51], v[16:19], v[96:103], v8
    v_smfmac_f32_16x16x64_bf16 v[52:55], v[16:19], v[104:111], v8
    v_smfmac_f32_16x16x64_bf16 v[32:35], v[20:23], v[112:119], v8
    v_smfmac_f32_16x16x64_bf16 v[36:39], v[20:23], v[120:127], v8
    v_smfmac_f32_16x16x64_bf16 v[40:43], v[20:23], v[128:135], v8
    v_smfmac_f32_16x16x64_bf16 v[44:47], v[20:23], v[136:143], v8
    v_smfmac_f32_16x16x64_bf16 v[48:51], v[20:23], v[144:151], v8
    v_smfmac_f32_16x16x64_bf16 v[52:55], v[20:23], v[152:159], v8
    v_smfmac_f32_16x16x64_bf16 v[32:35], v[24:27], v[160:167], v8
    v_smfmac_f32_16x16x64_bf16 v[36:39], v[24:27], v[168:175], v8
    v_smfmac_f32_16x16x64_bf16 v[40:43], v[24:27], v[176:183], v8
    v_smfmac_f32_16x16x64_bf16 v[44:47], v[24:27], v[184:191], v8
    v_smfmac_f32_16x16x64_bf16 v[48:51], v[24:27], v[192:199], v8
    v_smfmac_f32_16x16x64_bf16 v[52:55], v[24:27], v[200:207], v8
    v_smfmac_f32_16x16x64_bf16 v[32:35], v[28:31], v[208:215], v8
    ds_write_b32 v63, v59 offset:32
    v_smfmac_f32_16x16x64_bf16 v[36:39], v[28:31], v[216:223], v8
    v_smfmac_f32_16x16x64_bf16 v[40:43], v[28:31], v[224:231], v8
    v_smfmac_f32_16x16x64_bf16 v[44:47], v[28:31], v[232:239], v8
    v_smfmac_f32_16x16x64_bf16 v[48:51], v[28:31], v[240:247], v8
    v_smfmac_f32_16x16x64_bf16 v[52:55], v[28:31], v[248:255], v8
ploopL_22_mmd:
    s_cmp_eq_u32 s3, 3
    s_nop 1
    v_add_f32 v32, v32, v34
    v_add_f32 v33, v33, v35
    ds_write2_b32 v3, v32, v33 offset0:0 offset1:40
    v_add_f32 v36, v36, v38
    v_add_f32 v37, v37, v39
    ds_write2_b32 v3, v36, v37 offset0:16 offset1:56
    v_add_f32 v40, v40, v42
    v_add_f32 v41, v41, v43
    ds_write2_b32 v61, v40, v41 offset0:0 offset1:40
    v_add_f32 v44, v44, v46
    v_add_f32 v45, v45, v47
    ds_write2_b32 v61, v44, v45 offset0:16 offset1:56
    v_add_f32 v48, v48, v50
    v_add_f32 v49, v49, v51
    ds_write2_b32 v62, v48, v49 offset0:0 offset1:40
    v_add_f32 v52, v52, v54
    v_add_f32 v53, v53, v55
    ds_write2_b32 v62, v52, v53 offset0:16 offset1:56
    s_waitcnt lgkmcnt(0)
    s_barrier
    s_cbranch_scc1 ploopL_22_sk1
    ds_read_b128 v[32:35], v4 offset:0
    ds_read_b128 v[36:39], v4 offset:3840
    ds_read_b128 v[40:43], v4 offset:7680
    ds_read_b128 v[44:47], v4 offset:11520
    s_waitcnt lgkmcnt(2)
    v_add_f32 v32, v32, v36
    v_add_f32 v33, v33, v37
    v_add_f32 v34, v34, v38
    v_add_f32 v35, v35, v39
    s_waitcnt lgkmcnt(0)
    v_add_f32 v40, v40, v44
    v_add_f32 v41, v41, v45
    v_add_f32 v42, v42, v46
    v_add_f32 v43, v43, v47
    v_add_f32 v32, v32, v40
    v_add_f32 v33, v33, v41
    v_add_f32 v34, v34, v42
    v_add_f32 v35, v35, v43
    v_cvt_pk_bf16_f32 v56, v32, v33
    v_cvt_pk_bf16_f32 v57, v34, v35
    v_min_u32 v56, -2, v56
    buffer_store_dwordx2 v[56:57], v2, s[4:7], s26 offen
    s_add_u32 s27, s16, 2
    s_and_b32 s27, s27, 3
    s_lshl_b32 s27, s27, 18
    s_add_u32 s27, s27, s38
    buffer_store_dwordx2 v[10:11], v2, s[4:7], s27 offen
ploopL_22_sk1:
    s_setprio 0
    s_add_u32 s25, s16, 3
    s_and_b32 s25, s25, 3
    s_lshl_b32 s25, s25, 16
    s_add_u32 s25, s25, s37
    v_mov_b32 v44, -1
    v_mov_b32 v45, -1
    v_mov_b32 v46, -1
    v_mov_b32 v47, -1
    s_mov_b64 exec, s[56:57]
    buffer_store_dwordx4 v[44:47], v5, s[4:7], s25 offen
    s_mov_b64 exec, -1
    s_and_b32 s28, s16, 3
    s_lshl_b32 s28, s28, 18
    s_add_u32 s28, s28, s39
    s_add_u32 s24, s16, 1
    s_and_b32 s24, s24, 3
    s_lshl_b32 s24, s24, 16
    s_add_u32 s24, s24, s37
    s_add_u32 s23, s16, 1
    s_and_b32 s23, s23, 3
    s_lshl_b32 s23, s23, 16
    s_add_u32 s23, s23, s36
    s_add_u32 s26, s16, 1
    s_and_b32 s26, s26, 3
    s_lshl_b32 s26, s26, 18
    s_add_u32 s26, s26, s38
    s_cmp_eq_u32 s59, 0
    s_cbranch_scc1 ofl_24
    s_lshl_b32 s17, s3, 10
    v_add_u32 v39, s17, v1
    ds_read_b128 v[40:43], v39 offset:32768
ofl_24:
    s_cmp_ge_u32 s16, 16
    s_cbranch_scc1 ploopL_22_nx
    v_mov_b32 v40, v2
    v_mov_b32 v42, v56
    v_mov_b32 v43, v57
    s_cmp_lg_u32 s3, 2
    s_cbranch_scc1 ploopL_22_nx
    v_and_b32 v40, 0x60, v1
    v_lshlrev_b32 v40, 2, v40
    v_lshrrev_b32 v41, 3, v1
    v_and_b32 v41, 0x70, v41
    v_or_b32 v40, v40, v41
    v_bfe_u32 v41, v1, 4, 1
    v_lshl_or_b32 v40, v41, 3, v40
    s_lshl_b32 s17, s53, 9
    s_add_u32 s17, s17, 4096
    v_add_u32 v40, s17, v40
    s_mov_b32 vcc_lo, 0x55555555
    s_mov_b32 vcc_hi, 0x55555555
    v_cndmask_b32_dpp v42, v57, v56, vcc quad_perm:[1,0,3,2] row_mask:0xf bank_mask:0xf
    s_not_b64 vcc, vcc
    v_cndmask_b32_dpp v43, v56, v57, vcc quad_perm:[1,0,3,2] row_mask:0xf bank_mask:0xf
ploopL_22_nx:
    v_readfirstlane_b32 s21, v60
    s_lshr_b32 s29, s29, 1
    s_cmp_ge_u32 s21, s58
    s_cselect_b32 s21, 2, 0
    s_or_b32 s29, s29, s21
    s_cmp_eq_u32 s3, 3
    s_cselect_b32 s20, s21, 0
    s_add_u32 s21, s16, 4
    s_min_u32 s21, s21, 63
    s_cmp_ge_u32 s21, 16
    s_cselect_b32 s58, 12, 8
    s_and_b32 s33, s21, 4
    s_lshr_b32 s21, s21, 3
    s_lshl_b32 s21, s21, 8
    s_add_u32 s33, s33, s21
    s_add_u32 s33, s33, s35
    s_setprio 3
ploopL_22_fs:
    ds_read_b128 v[32:35], v58 offset:0
    s_waitcnt lgkmcnt(0)
    v_min3_i32 v32, v32, v33, v34
    v_min_i32 v32, v32, v35
    s_nop 0
    v_readfirstlane_b32 s18, v32
    s_cmp_ge_i32 s18, s16
    s_cbranch_scc1 ploopL_22_fsok
    s_sleep 1
    s_branch ploopL_22_fs
ploopL_22_fsok:
    s_setprio 1
    s_sleep 4
ploopL_22_nofd:
    s_cmp_eq_u32 s20, 0
    s_cbranch_scc1 ploopL_22_nt
    s_cmp_ge_u32 s16, 13
    s_cselect_b32 exec_hi, 0xffff, 0
    buffer_load_dword v60, v0, s[4:7], s31 offen sc1
    s_mov_b32 exec_hi, -1
ploopL_22_nt:
    s_cmp_eq_u32 s59, 0
    s_cbranch_scc1 ofl_25
    s_lshl_b32 s17, s16, 18
    s_add_u32 s17, s17, s60
    buffer_store_dwordx4 v[40:43], v1, s[4:7], s17 offen sc1
    s_mov_b32 s59, 0
ofl_25:
    s_lshr_b32 s17, s34, 3
    s_xor_b32 s17, s17, s16
    s_andn2_b32 s59, 1, s17
    s_cmp_ge_u32 s16, 16
    s_cselect_b32 s59, s59, 0
    s_cbranch_scc1 ploopL_22_nx2
    s_cmp_eq_u32 s3, 3
    s_cbranch_scc1 ploopL_22_nx2
    buffer_store_dwordx2 v[42:43], v40, s[4:7], s55 offen sc1
ploopL_22_nx2:
    s_add_u32 s55, s55, 262144
    s_or_b32 s17, s13, s3
    s_cmp_lg_u32 s17, 0
    s_cbranch_scc1 ploopL_22_npg
    s_sub_u32 s21, s16, 1
    s_cbranch_scc1 ploopL_22_npg
    s_sub_u32 s17, s21, 1
    s_and_b32 s17, s17, 3
    s_cmp_ge_u32 s16, 58
    s_cselect_b32 s17, 0, s17
    s_cmp_lg_u32 s17, 0
    s_cbranch_scc1 ploopL_22_npg
    s_lshl_b32 s17, s12, 7
    s_add_u32 s17, s17, 218112000
    v_mov_b32 v9, s21
    s_mov_b64 exec, 1
    buffer_store_dword v9, off, s[4:7], s17 sc1
    s_mov_b64 exec, -1
ploopL_22_npg:
    s_barrier
    buffer_load_dword v60, off, s[4:7], s33 sc1
    s_add_u32 s16, s16, 1
    v_mov_b32 v59, s16
    s_add_u32 s41, s41, 262144
    s_add_u32 s31, s31, 262144
    s_setprio 3
    s_sleep 13
ploopL_22_pagain:
    buffer_load_dwordx4 v[16:19], v1, s[4:7], s28 offen offset:0 sc1
    buffer_load_dwordx4 v[20:23], v1, s[4:7], s28 offen offset:1024 sc1
    s_waitcnt vmcnt(1)
    v_mfma_f32_16x16x32_bf16 v[32:35], v[12:15], v[16:19], 0
    s_waitcnt vmcnt(0)
    v_mfma_f32_16x16x32_bf16 v[32:35], v[12:15], v[20:23], v[32:35]
    v_max_u32 v9, v16, v20
    v_cmp_eq_u32 vcc, -1, v9
    s_cbranch_vccnz ploopL_22_rp
ploopL_22_pgo:
    s_cmp_lt_u32 s16, 48
    s_nop 3
    v_cvt_pk_bf16_f32 v52, v32, v33
    v_cvt_pk_bf16_f32 v53, v34, v35
    s_nop 0
    v_permlane16_swap_b32 v52, v54
    v_permlane16_swap_b32 v53, v55
    s_mov_b64 exec, s[56:57]
    v_min_u32 v52, -2, v52
    buffer_store_dwordx4 v[52:55], v5, s[4:7], s24 offen
    s_mov_b64 exec, -1
    ds_write_b32 v63, v59 offset:16
    s_cbranch_scc1 ploopL_22
    s_branch ploopH_21
ploopL_22_rm_0:
    s_sub_u32 s22, s22, 1
    s_cbranch_scc1 ploopL_22_rm_0_g
    buffer_load_dwordx4 v[16:19], v1, s[4:7], s23 offen offset:0 sc1
    buffer_load_dwordx4 v[20:23], v1, s[4:7], s23 offen offset:1024 sc1
    buffer_load_dwordx4 v[24:27], v1, s[4:7], s23 offen offset:2048 sc1
    buffer_load_dwordx4 v[28:31], v1, s[4:7], s23 offen offset:3072 sc1
    s_waitcnt vmcnt(3)
    v_cmp_eq_u32 vcc, -1, v16
    s_cbranch_vccnz ploopL_22_rm_0
    s_branch ploopL_22_rm_0ok
ploopL_22_rm_0_g:
    s_mov_b32 s22, 0
    s_waitcnt vmcnt(0)
    s_branch ploopL_22_rm_0ok
ploopL_22_rm_1:
    s_sub_u32 s22, s22, 1
    s_cbranch_scc1 ploopL_22_rm_1_g
    buffer_load_dwordx4 v[20:23], v1, s[4:7], s23 offen offset:1024 sc1
    buffer_load_dwordx4 v[24:27], v1, s[4:7], s23 offen offset:2048 sc1
    buffer_load_dwordx4 v[28:31], v1, s[4:7], s23 offen offset:3072 sc1
    s_waitcnt vmcnt(2)
    v_cmp_eq_u32 vcc, -1, v20
    s_cbranch_vccnz ploopL_22_rm_1
    s_branch ploopL_22_rm_1ok
ploopL_22_rm_1_g:
    s_mov_b32 s22, 0
    s_waitcnt vmcnt(0)
    s_branch ploopL_22_rm_1ok
ploopL_22_rm_2:
    s_sub_u32 s22, s22, 1
    s_cbranch_scc1 ploopL_22_rm_2_g
    buffer_load_dwordx4 v[24:27], v1, s[4:7], s23 offen offset:2048 sc1
    buffer_load_dwordx4 v[28:31], v1, s[4:7], s23 offen offset:3072 sc1
    s_waitcnt vmcnt(1)
    v_cmp_eq_u32 vcc, -1, v24
    s_cbranch_vccnz ploopL_22_rm_2
    s_branch ploopL_22_rm_2ok
ploopL_22_rm_2_g:
    s_mov_b32 s22, 0
    s_waitcnt vmcnt(0)
    s_branch ploopL_22_rm_2ok
ploopL_22_rm_3:
    s_sub_u32 s22, s22, 1
    s_cbranch_scc1 ploopL_22_rm_3_g
    buffer_load_dwordx4 v[28:31], v1, s[4:7], s23 offen offset:3072 sc1
    s_waitcnt vmcnt(0)
    v_cmp_eq_u32 vcc, -1, v28
    s_cbranch_vccnz ploopL_22_rm_3
    s_branch ploopL_22_rm_3ok
ploopL_22_rm_3_g:
    s_mov_b32 s22, 0
    s_waitcnt vmcnt(0)
    s_branch ploopL_22_rm_3ok
ploopL_22_rp:
    s_sub_u32 s22, s22, 1
    s_cbranch_scc0 ploopL_22_pagain
    s_mov_b32 s22, 0
    s_branch ploopL_22_pgo
.p2align 6
    s_nop 0
    s_nop 0
    s_nop 0
    s_nop 0
    s_nop 0
    s_nop 0
    s_nop 0
    s_nop 0
    s_nop 0
    s_nop 0
    s_nop 0
ploopH_21:
    v_mov_b32 v32, 0
    v_mov_b32 v33, 0
    v_mov_b32 v34, 0
    v_mov_b32 v35, 0
    v_mov_b32 v36, 0
    v_mov_b32 v37, 0
    v_mov_b32 v38, 0
    v_mov_b32 v39, 0
    v_mov_b32 v40, 0
    v_mov_b32 v41, 0
    v_mov_b32 v42, 0
    v_mov_b32 v43, 0
    v_mov_b32 v44, 0
    v_mov_b32 v45, 0
    v_mov_b32 v46, 0
    v_mov_b32 v47, 0
    v_mov_b32 v48, 0
    v_mov_b32 v49, 0
    v_mov_b32 v50, 0
    v_mov_b32 v51, 0
    v_mov_b32 v52, 0
    v_mov_b32 v53, 0
    v_mov_b32 v54, 0
    v_mov_b32 v55, 0
    s_sleep 1
    buffer_load_dwordx4 v[16:19], v1, s[4:7], s23 offen offset:0 sc1
    buffer_load_dwordx4 v[20:23], v1, s[4:7], s23 offen offset:1024 sc1
    buffer_load_dwordx4 v[24:27], v1, s[4:7], s23 offen offset:2048 sc1
    buffer_load_dwordx4 v[28:31], v1, s[4:7], s23 offen offset:3072 sc1
    s_waitcnt vmcnt(3)
    v_cmp_eq_u32 vcc, -1, v16
    s_cbranch_vccnz ploopH_21_rm_0
ploopH_21_rm_0ok:
    v_smfmac_f32_16x16x64_bf16 v[32:35], v[16:19], v[64:71], v8
    v_smfmac_f32_16x16x64_bf16 v[36:39], v[16:19], v[72:79], v8
    s_waitcnt vmcnt(2)
    v_cmp_eq_u32 vcc, -1, v20
    v_smfmac_f32_16x16x64_bf16 v[40:43], v[16:19], v[80:87], v8
    v_smfmac_f32_16x16x64_bf16 v[44:47], v[16:19], v[88:95], v8
    v_smfmac_f32_16x16x64_bf16 v[48:51], v[16:19], v[96:103], v8
    v_smfmac_f32_16x16x64_bf16 v[52:55], v[16:19], v[104:111], v8
    s_cbranch_vccnz ploopH_21_rm_1
ploopH_21_rm_1ok:
    v_smfmac_f32_16x16x64_bf16 v[32:35], v[20:23], v[112:119], v8
    v_smfmac_f32_16x16x64_bf16 v[36:39], v[20:23], v[120:127], v8
    s_waitcnt vmcnt(1)
    v_cmp_eq_u32 vcc, -1, v24
    v_smfmac_f32_16x16x64_bf16 v[40:43], v[20:23], v[128:135], v8
    v_smfmac_f32_16x16x64_bf16 v[44:47], v[20:23], v[136:143], v8
    v_smfmac_f32_16x16x64_bf16 v[48:51], v[20:23], v[144:151], v8
    v_smfmac_f32_16x16x64_bf16 v[52:55], v[20:23], v[152:159], v8
    s_cbranch_vccnz ploopH_21_rm_2
ploopH_21_rm_2ok:
    v_smfmac_f32_16x16x64_bf16 v[32:35], v[24:27], v[160:167], v8
    v_smfmac_f32_16x16x64_bf16 v[36:39], v[24:27], v[168:175], v8
    s_waitcnt vmcnt(0)
    v_cmp_eq_u32 vcc, -1, v28
    v_smfmac_f32_16x16x64_bf16 v[40:43], v[24:27], v[176:183], v8
    v_smfmac_f32_16x16x64_bf16 v[44:47], v[24:27], v[184:191], v8
    v_smfmac_f32_16x16x64_bf16 v[48:51], v[24:27], v[192:199], v8
    v_smfmac_f32_16x16x64_bf16 v[52:55], v[24:27], v[200:207], v8
    s_cbranch_vccnz ploopH_21_rm_3
ploopH_21_rm_3ok:
    v_smfmac_f32_16x16x64_bf16 v[32:35], v[28:31], v[208:215], v8
    ds_write_b32 v63, v59 offset:32
    v_smfmac_f32_16x16x64_bf16 v[36:39], v[28:31], v[216:223], v8
    v_smfmac_f32_16x16x64_bf16 v[40:43], v[28:31], v[224:231], v8
    v_smfmac_f32_16x16x64_bf16 v[44:47], v[28:31], v[232:239], v8
    v_smfmac_f32_16x16x64_bf16 v[48:51], v[28:31], v[240:247], v8
    v_smfmac_f32_16x16x64_bf16 v[52:55], v[28:31], v[248:255], v8
    s_cmp_eq_u32 s3, 3
    s_nop 1
    v_add_f32 v32, v32, v34
    v_add_f32 v33, v33, v35
    ds_write2_b32 v3, v32, v33 offset0:0 offset1:40
    v_add_f32 v36, v36, v38
    v_add_f32 v37, v37, v39
    ds_write2_b32 v3, v36, v37 offset0:16 offset1:56
    v_add_f32 v40, v40, v42
    v_add_f32 v41, v41, v43
    ds_write2_b32 v61, v40, v41 offset0:0 offset1:40
    v_add_f32 v44, v44, v46
    v_add_f32 v45, v45, v47
    ds_write2_b32 v61, v44, v45 offset0:16 offset1:56
    v_add_f32 v48, v48, v50
    v_add_f32 v49, v49, v51
    ds_write2_b32 v62, v48, v49 offset0:0 offset1:40
    v_add_f32 v52, v52, v54
    v_add_f32 v53, v53, v55
    ds_write2_b32 v62, v52, v53 offset0:16 offset1:56
    s_waitcnt lgkmcnt(0)
    s_barrier
    s_cbranch_scc1 ploopH_21_sk1
    ds_read_b128 v[32:35], v4 offset:0
    ds_read_b128 v[36:39], v4 offset:3840
    ds_read_b128 v[40:43], v4 offset:7680
    ds_read_b128 v[44:47], v4 offset:11520
    s_waitcnt lgkmcnt(2)
    v_add_f32 v32, v32, v36
    v_add_f32 v33, v33, v37
    v_add_f32 v34, v34, v38
    v_add_f32 v35, v35, v39
    s_waitcnt lgkmcnt(0)
    v_add_f32 v40, v40, v44
    v_add_f32 v41, v41, v45
    v_add_f32 v42, v42, v46
    v_add_f32 v43, v43, v47
    v_add_f32 v32, v32, v40
    v_add_f32 v33, v33, v41
    v_add_f32 v34, v34, v42
    v_add_f32 v35, v35, v43
    v_cvt_pk_bf16_f32 v56, v32, v33
    v_cvt_pk_bf16_f32 v57, v34, v35
    v_min_u32 v56, -2, v56
    buffer_store_dwordx2 v[56:57], v2, s[4:7], s26 offen
    s_add_u32 s27, s16, 2
    s_and_b32 s27, s27, 3
    s_lshl_b32 s27, s27, 18
    s_add_u32 s27, s27, s38
    buffer_store_dwordx2 v[10:11], v2, s[4:7], s27 offen
ploopH_21_sk1:
    s_setprio 0
    s_add_u32 s25, s16, 3
    s_and_b32 s25, s25, 3
    s_lshl_b32 s25, s25, 16
    s_add_u32 s25, s25, s37
    v_mov_b32 v44, -1
    v_mov_b32 v45, -1
    v_mov_b32 v46, -1
    v_mov_b32 v47, -1
    s_mov_b64 exec, s[56:57]
    buffer_store_dwordx4 v[44:47], v5, s[4:7], s25 offen
    s_mov_b64 exec, -1
    v_mov_b32_dpp v48, v12 row_ror:8 row_mask:0xf bank_mask:0xf
    v_mov_b32_dpp v49, v13 row_ror:8 row_mask:0xf bank_mask:0xf
    v_mov_b32_dpp v50, v14 row_ror:8 row_mask:0xf bank_mask:0xf
    v_mov_b32_dpp v51, v15 row_ror:8 row_mask:0xf bank_mask:0xf
    s_and_b32 s28, s16, 3
    s_lshl_b32 s28, s28, 18
    s_add_u32 s28, s28, s39
    s_add_u32 s24, s16, 1
    s_and_b32 s24, s24, 3
    s_lshl_b32 s24, s24, 16
    s_add_u32 s24, s24, s37
    s_add_u32 s23, s16, 1
    s_and_b32 s23, s23, 3
    s_lshl_b32 s23, s23, 16
    s_add_u32 s23, s23, s36
    s_add_u32 s26, s16, 1
    s_and_b32 s26, s26, 3
    s_lshl_b32 s26, s26, 18
    s_add_u32 s26, s26, s38
    s_cmp_eq_u32 s59, 0
    s_cbranch_scc1 ofl_26
    s_lshl_b32 s17, s3, 10
    v_add_u32 v39, s17, v1
    ds_read_b128 v[40:43], v39 offset:32768
ofl_26:
    s_cmp_eq_u32 s16, 63
    s_cbranch_scc1 ploopH_21_tail
    s_cmp_eq_u32 s30, s54
    s_cbranch_scc1 pnoseg_27
    ds_read_b128 v[16:19], v6 offset:0
    ds_read_b128 v[20:23], v6 offset:256
    ds_read_b128 v[24:27], v6 offset:512
    ds_read_b128 v[28:31], v6 offset:768
    v_xor_b32 v6, 0x4000, v6
    s_waitcnt lgkmcnt(2)
    v_mfma_f32_16x16x32_bf16 v[40:43], v[12:15], v[16:19], 0
    v_mfma_f32_16x16x32_bf16 v[40:43], v[48:51], v[20:23], v[40:43]
    s_waitcnt lgkmcnt(0)
    v_mfma_f32_16x16x32_bf16 v[44:47], v[12:15], v[24:27], 0
    v_mfma_f32_16x16x32_bf16 v[44:47], v[48:51], v[28:31], v[44:47]
    s_nop 7
    v_cvt_pk_bf16_f32 v40, v40, v41
    v_cvt_pk_bf16_f32 v41, v42, v43
    v_cvt_pk_bf16_f32 v42, v44, v45
    v_cvt_pk_bf16_f32 v43, v46, v47
    s_nop 1
    v_permlane16_swap_b32 v40, v42
    v_permlane16_swap_b32 v41, v43
    s_nop 1
    v_min_u32 v40, -2, v40
pnoseg_27:
    s_bitcmp1_b32 s29, 0
    s_cbranch_scc1 gate_28_ok
    s_add_u32 s21, s16, 1
    s_min_u32 s21, s21, 63
    s_cmp_ge_u32 s21, 16
    s_cselect_b32 s19, 12, 8
    s_and_b32 s32, s21, 4
    s_lshr_b32 s21, s21, 3
    s_lshl_b32 s21, s21, 8
    s_add_u32 s32, s32, s21
    s_add_u32 s32, s32, s35
gate_28:
    buffer_load_dword v9, off, s[4:7], s32 sc1
    s_waitcnt vmcnt(0)
    v_readfirstlane_b32 s21, v9
    s_cmp_ge_u32 s21, s19
    s_cbranch_scc1 gate_28_set
    s_sleep 8
    s_sub_u32 s22, s22, 1
    s_cbranch_scc0 gate_28
    s_mov_b32 s22, 0
gate_28_set:
    s_bitset1_b32 s29, 0
gate_28_ok:
    v_readfirstlane_b32 s21, v60
    s_lshr_b32 s29, s29, 1
    s_cmp_ge_u32 s21, s58
    s_cselect_b32 s21, 2, 0
    s_or_b32 s29, s29, s21
    s_cmp_eq_u32 s3, 3
    s_cselect_b32 s20, s21, 0
    s_add_u32 s21, s16, 4
    s_min_u32 s21, s21, 63
    s_cmp_ge_u32 s21, 16
    s_cselect_b32 s58, 12, 8
    s_and_b32 s33, s21, 4
    s_lshr_b32 s21, s21, 3
    s_lshl_b32 s21, s21, 8
    s_add_u32 s33, s33, s21
    s_add_u32 s33, s33, s35
    s_setprio 3
ploopH_21_fs:
    ds_read_b128 v[32:35], v58 offset:0
    s_waitcnt lgkmcnt(0)
    v_min3_i32 v32, v32, v33, v34
    v_min_i32 v32, v32, v35
    s_nop 0
    v_readfirstlane_b32 s18, v32
    s_cmp_ge_i32 s18, s16
    s_cbranch_scc1 ploopH_21_fsok
    s_sleep 1
    s_branch ploopH_21_fs
ploopH_21_fsok:
    s_setprio 1
    s_add_u32 m0, s42, 8192
    s_add_u32 s17, s41, 37748736
    buffer_load_dwordx4 v1, s[4:7], s17 offen offset:0 sc1 lds
    buffer_load_dwordx4 v1, s[4:7], s17 offen offset:1024 sc1 lds
    buffer_load_dwordx4 v1, s[4:7], s17 offen offset:2048 sc1 lds
    buffer_load_dwordx4 v1, s[4:7], s17 offen offset:3072 sc1 lds
    s_add_u32 m0, s42, 12288
    s_add_u32 s17, s41, 37879808
    buffer_load_dwordx4 v1, s[4:7], s17 offen offset:0 sc1 lds
    buffer_load_dwordx4 v1, s[4:7], s17 offen offset:1024 sc1 lds
    buffer_load_dwordx4 v1, s[4:7], s17 offen offset:2048 sc1 lds
    buffer_load_dwordx4 v1, s[4:7], s17 offen offset:3072 sc1 lds
    s_cmp_eq_u32 s20, 0
    s_cbranch_scc1 ploopH_21_nt
    s_mov_b32 exec_hi, 0xffff
    buffer_load_dword v60, v0, s[4:7], s31 offen sc1
    s_mov_b32 exec_hi, -1
ploopH_21_nt:
    s_cmp_eq_u32 s59, 0
    s_cbranch_scc1 ofl_29
    s_lshl_b32 s17, s16, 18
    s_add_u32 s17, s17, s60
    buffer_store_dwordx4 v[40:43], v1, s[4:7], s17 offen sc1
    s_mov_b32 s59, 0
ofl_29:
    s_cmp_eq_u32 s30, s54
    s_cbranch_scc1 pnoseg_30
    buffer_store_dwordx4 v[40:43], v7, s[4:7], s30 offen sc1
    s_add_u32 s30, s30, 65536
pnoseg_30:
    s_or_b32 s17, s13, s3
    s_cmp_lg_u32 s17, 0
    s_cbranch_scc1 ploopH_21_npg
    s_sub_u32 s21, s16, 1
    s_cbranch_scc1 ploopH_21_npg
    s_sub_u32 s17, s21, 1
    s_and_b32 s17, s17, 3
    s_cmp_ge_u32 s16, 58
    s_cselect_b32 s17, 0, s17
    s_cmp_lg_u32 s17, 0
    s_cbranch_scc1 ploopH_21_npg
    s_lshl_b32 s17, s12, 7
    s_add_u32 s17, s17, 218112000
    v_mov_b32 v9, s21
    s_mov_b64 exec, 1
    buffer_store_dword v9, off, s[4:7], s17 sc1
    s_mov_b64 exec, -1
ploopH_21_npg:
    s_barrier
    buffer_load_dword v60, off, s[4:7], s33 sc1
    s_add_u32 s16, s16, 1
    v_mov_b32 v59, s16
    s_add_u32 s41, s41, 262144
    s_add_u32 s31, s31, 262144
    s_mov_b32 s54, 0
    s_setprio 3
    s_sleep 13
ploopH_21_pagain:
    buffer_load_dwordx4 v[16:19], v1, s[4:7], s28 offen offset:0 sc1
    buffer_load_dwordx4 v[20:23], v1, s[4:7], s28 offen offset:1024 sc1
    s_waitcnt vmcnt(1)
    v_mfma_f32_16x16x32_bf16 v[32:35], v[12:15], v[16:19], 0
    s_waitcnt vmcnt(0)
    v_mfma_f32_16x16x32_bf16 v[32:35], v[12:15], v[20:23], v[32:35]
    v_max_u32 v9, v16, v20
    v_cmp_eq_u32 vcc, -1, v9
    s_cbranch_vccnz ploopH_21_rp
ploopH_21_pgo:
    s_nop 4
    v_cvt_pk_bf16_f32 v52, v32, v33
    v_cvt_pk_bf16_f32 v53, v34, v35
    s_nop 0
    v_permlane16_swap_b32 v52, v54
    v_permlane16_swap_b32 v53, v55
    s_mov_b64 exec, s[56:57]
    v_min_u32 v52, -2, v52
    buffer_store_dwordx4 v[52:55], v5, s[4:7], s24 offen
    s_mov_b64 exec, -1
    ds_write_b32 v63, v59 offset:16
    s_branch ploopH_21
ploopH_21_rm_0:
    s_sub_u32 s22, s22, 1
    s_cbranch_scc1 ploopH_21_rm_0_g
    buffer_load_dwordx4 v[16:19], v1, s[4:7], s23 offen offset:0 sc1
    buffer_load_dwordx4 v[20:23], v1, s[4:7], s23 offen offset:1024 sc1
    buffer_load_dwordx4 v[24:27], v1, s[4:7], s23 offen offset:2048 sc1
    buffer_load_dwordx4 v[28:31], v1, s[4:7], s23 offen offset:3072 sc1
    s_waitcnt vmcnt(3)
    v_cmp_eq_u32 vcc, -1, v16
    s_cbranch_vccnz ploopH_21_rm_0
    s_branch ploopH_21_rm_0ok
ploopH_21_rm_0_g:
    s_mov_b32 s22, 0
    s_waitcnt vmcnt(0)
    s_branch ploopH_21_rm_0ok
ploopH_21_rm_1:
    s_sub_u32 s22, s22, 1
    s_cbranch_scc1 ploopH_21_rm_1_g
    buffer_load_dwordx4 v[20:23], v1, s[4:7], s23 offen offset:1024 sc1
    buffer_load_dwordx4 v[24:27], v1, s[4:7], s23 offen offset:2048 sc1
    buffer_load_dwordx4 v[28:31], v1, s[4:7], s23 offen offset:3072 sc1
    s_waitcnt vmcnt(2)
    v_cmp_eq_u32 vcc, -1, v20
    s_cbranch_vccnz ploopH_21_rm_1
    s_branch ploopH_21_rm_1ok
ploopH_21_rm_1_g:
    s_mov_b32 s22, 0
    s_waitcnt vmcnt(0)
    s_branch ploopH_21_rm_1ok
ploopH_21_rm_2:
    s_sub_u32 s22, s22, 1
    s_cbranch_scc1 ploopH_21_rm_2_g
    buffer_load_dwordx4 v[24:27], v1, s[4:7], s23 offen offset:2048 sc1
    buffer_load_dwordx4 v[28:31], v1, s[4:7], s23 offen offset:3072 sc1
    s_waitcnt vmcnt(1)
    v_cmp_eq_u32 vcc, -1, v24
    s_cbranch_vccnz ploopH_21_rm_2
    s_branch ploopH_21_rm_2ok
ploopH_21_rm_2_g:
    s_mov_b32 s22, 0
    s_waitcnt vmcnt(0)
    s_branch ploopH_21_rm_2ok
ploopH_21_rm_3:
    s_sub_u32 s22, s22, 1
    s_cbranch_scc1 ploopH_21_rm_3_g
    buffer_load_dwordx4 v[28:31], v1, s[4:7], s23 offen offset:3072 sc1
    s_waitcnt vmcnt(0)
    v_cmp_eq_u32 vcc, -1, v28
    s_cbranch_vccnz ploopH_21_rm_3
    s_branch ploopH_21_rm_3ok
ploopH_21_rm_3_g:
    s_mov_b32 s22, 0
    s_waitcnt vmcnt(0)
    s_branch ploopH_21_rm_3ok
ploopH_21_rp:
    s_sub_u32 s22, s22, 1
    s_cbranch_scc0 ploopH_21_pagain
    s_mov_b32 s22, 0
    s_branch ploopH_21_pgo
ploopH_21_tail:
    ds_read_b128 v[16:19], v6 offset:0
    ds_read_b128 v[20:23], v6 offset:256
    ds_read_b128 v[24:27], v6 offset:512
    ds_read_b128 v[28:31], v6 offset:768
    v_xor_b32 v6, 0x4000, v6
    s_waitcnt lgkmcnt(2)
    v_mfma_f32_16x16x32_bf16 v[40:43], v[12:15], v[16:19], 0
    v_mfma_f32_16x16x32_bf16 v[40:43], v[48:51], v[20:23], v[40:43]
    s_waitcnt lgkmcnt(0)
    v_mfma_f32_16x16x32_bf16 v[44:47], v[12:15], v[24:27], 0
    v_mfma_f32_16x16x32_bf16 v[44:47], v[48:51], v[28:31], v[44:47]
    s_nop 7
    v_cvt_pk_bf16_f32 v40, v40, v41
    v_cvt_pk_bf16_f32 v41, v42, v43
    v_cvt_pk_bf16_f32 v42, v44, v45
    v_cvt_pk_bf16_f32 v43, v46, v47
    s_nop 1
    v_permlane16_swap_b32 v40, v42
    v_permlane16_swap_b32 v41, v43
    s_nop 1
    v_min_u32 v40, -2, v40
    buffer_store_dwordx4 v[40:43], v7, s[4:7], s30 offen sc1
    s_add_u32 s30, s30, 65536
    s_barrier
    ds_read_b128 v[16:19], v6 offset:0
    ds_read_b128 v[20:23], v6 offset:256
    ds_read_b128 v[24:27], v6 offset:512
    ds_read_b128 v[28:31], v6 offset:768
    v_xor_b32 v6, 0x4000, v6
    s_waitcnt lgkmcnt(2)
    v_mfma_f32_16x16x32_bf16 v[40:43], v[12:15], v[16:19], 0
    v_mfma_f32_16x16x32_bf16 v[40:43], v[48:51], v[20:23], v[40:43]
    s_waitcnt lgkmcnt(0)
    v_mfma_f32_16x16x32_bf16 v[44:47], v[12:15], v[24:27], 0
    v_mfma_f32_16x16x32_bf16 v[44:47], v[48:51], v[28:31], v[44:47]
    s_nop 7
    v_cvt_pk_bf16_f32 v40, v40, v41
    v_cvt_pk_bf16_f32 v41, v42, v43
    v_cvt_pk_bf16_f32 v42, v44, v45
    v_cvt_pk_bf16_f32 v43, v46, v47
    s_nop 1
    v_permlane16_swap_b32 v40, v42
    v_permlane16_swap_b32 v41, v43
    s_nop 1
    v_min_u32 v40, -2, v40
    buffer_store_dwordx4 v[40:43], v7, s[4:7], s30 offen sc1
    s_add_u32 s30, s30, 65536
    s_branch k_end
ch_p_slow:
    v_mov_b32 v32, 0
    v_mov_b32 v33, 0
    v_mov_b32 v34, 0
    v_mov_b32 v35, 0
    v_mov_b32 v36, 0
    v_mov_b32 v37, 0
    v_mov_b32 v38, 0
    v_mov_b32 v39, 0
    v_mov_b32 v40, 0
    v_mov_b32 v41, 0
    v_mov_b32 v42, 0
    v_mov_b32 v43, 0
    v_mov_b32 v44, 0
    v_mov_b32 v45, 0
    v_mov_b32 v46, 0
    v_mov_b32 v47, 0
    v_mov_b32 v48, 0
    v_mov_b32 v49, 0
    v_mov_b32 v50, 0
    v_mov_b32 v51, 0
    v_mov_b32 v52, 0
    v_mov_b32 v53, 0
    v_mov_b32 v54, 0
    v_mov_b32 v55, 0
    v_mov_b32 v59, 0
    s_nop 1
    s_branch ploopL_32_nc
.p2align 6
    s_nop 0
    s_nop 0
    s_nop 0
    s_nop 0
    s_nop 0
    s_nop 0
    s_nop 0
    s_nop 0
    s_nop 0
    s_nop 0
    s_nop 0
ploopL_32:
    v_mov_b32 v32, 0
    v_mov_b32 v33, 0
    v_mov_b32 v34, 0
    v_mov_b32 v35, 0
    v_mov_b32 v36, 0
    v_mov_b32 v37, 0
    v_mov_b32 v38, 0
    v_mov_b32 v39, 0
    v_mov_b32 v40, 0
    v_mov_b32 v41, 0
    v_mov_b32 v42, 0
    v_mov_b32 v43, 0
    v_mov_b32 v44, 0
    v_mov_b32 v45, 0
    v_mov_b32 v46, 0
    v_mov_b32 v47, 0
    v_mov_b32 v48, 0
    v_mov_b32 v49, 0
    v_mov_b32 v50, 0
    v_mov_b32 v51, 0
    v_mov_b32 v52, 0
    v_mov_b32 v53, 0
    v_mov_b32 v54, 0
    v_mov_b32 v55, 0
    s_bitcmp1_b32 s29, 0
    s_cbranch_scc1 gate_33_ok
    s_add_u32 s21, s16, 1
    s_min_u32 s21, s21, 63
    s_cmp_ge_u32 s21, 16
    s_cselect_b32 s19, 12, 8
    s_and_b32 s32, s21, 4
    s_lshr_b32 s21, s21, 3
    s_lshl_b32 s21, s21, 8
    s_add_u32 s32, s32, s21
    s_add_u32 s32, s32, s35
gate_33:
    buffer_load_dword v9, off, s[4:7], s32 sc1
    s_waitcnt vmcnt(0)
    v_readfirstlane_b32 s21, v9
    s_cmp_ge_u32 s21, s19
    s_cbranch_scc1 gate_33_set
    s_sleep 8
    s_sub_u32 s22, s22, 1
    s_cbranch_scc0 gate_33
    s_mov_b32 s22, 0
gate_33_set:
    s_bitset1_b32 s29, 0
gate_33_ok:
    s_sleep 1
    buffer_load_dwordx4 v[16:19], v1, s[4:7], s23 offen offset:0 sc1
    buffer_load_dwordx4 v[20:23], v1, s[4:7], s23 offen offset:1024 sc1
    buffer_load_dwordx4 v[24:27], v1, s[4:7], s23 offen offset:2048 sc1
    buffer_load_dwordx4 v[28:31], v1, s[4:7], s23 offen offset:3072 sc1
    s_waitcnt vmcnt(3)
    v_cmp_eq_u32 vcc, -1, v16
    s_cbranch_vccnz ploopL_32_rm_0
ploopL_32_rm_0ok:
    v_smfmac_f32_16x16x64_bf16 v[32:35], v[16:19], v[64:71], v8
    v_smfmac_f32_16x16x64_bf16 v[36:39], v[16:19], v[72:79], v8
    s_waitcnt vmcnt(2)
    v_cmp_eq_u32 vcc, -1, v20
    v_smfmac_f32_16x16x64_bf16 v[40:43], v[16:19], v[80:87], v8
    v_smfmac_f32_16x16x64_bf16 v[44:47], v[16:19], v[88:95], v8
    v_smfmac_f32_16x16x64_bf16 v[48:51], v[16:19], v[96:103], v8
    v_smfmac_f32_16x16x64_bf16 v[52:55], v[16:19], v[104:111], v8
    s_cbranch_vccnz ploopL_32_rm_1
ploopL_32_rm_1ok:
    v_smfmac_f32_16x16x64_bf16 v[32:35], v[20:23], v[112:119], v8
    v_smfmac_f32_16x16x64_bf16 v[36:39], v[20:23], v[120:127], v8
    s_waitcnt vmcnt(1)
    v_cmp_eq_u32 vcc, -1, v24
    v_smfmac_f32_16x16x64_bf16 v[40:43], v[20:23], v[128:135], v8
    v_smfmac_f32_16x16x64_bf16 v[44:47], v[20:23], v[136:143], v8
    v_smfmac_f32_16x16x64_bf16 v[48:51], v[20:23], v[144:151], v8
    v_smfmac_f32_16x16x64_bf16 v[52:55], v[20:23], v[152:159], v8
    s_cbranch_vccnz ploopL_32_rm_2
ploopL_32_rm_2ok:
    v_smfmac_f32_16x16x64_bf16 v[32:35], v[24:27], v[160:167], v8
    v_smfmac_f32_16x16x64_bf16 v[36:39], v[24:27], v[168:175], v8
    s_waitcnt vmcnt(0)
    v_cmp_eq_u32 vcc, -1, v28
    v_smfmac_f32_16x16x64_bf16 v[40:43], v[24:27], v[176:183], v8
    v_smfmac_f32_16x16x64_bf16 v[44:47], v[24:27], v[184:191], v8
    v_smfmac_f32_16x16x64_bf16 v[48:51], v[24:27], v[192:199], v8
    v_smfmac_f32_16x16x64_bf16 v[52:55], v[24:27], v[200:207], v8
    s_cbranch_vccnz ploopL_32_rm_3
ploopL_32_rm_3ok:
    v_smfmac_f32_16x16x64_bf16 v[32:35], v[28:31], v[208:215], v8
    ds_write_b32 v63, v59 offset:32
    v_smfmac_f32_16x16x64_bf16 v[36:39], v[28:31], v[216:223], v8
    v_smfmac_f32_16x16x64_bf16 v[40:43], v[28:31], v[224:231], v8
    v_smfmac_f32_16x16x64_bf16 v[44:47], v[28:31], v[232:239], v8
    v_smfmac_f32_16x16x64_bf16 v[48:51], v[28:31], v[240:247], v8
    v_smfmac_f32_16x16x64_bf16 v[52:55], v[28:31], v[248:255], v8
    s_branch ploopL_32_mmd
ploopL_32_nc:
    v_smfmac_f32_16x16x64_bf16 v[32:35], v[16:19], v[64:71], v8
    v_smfmac_f32_16x16x64_bf16 v[36:39], v[16:19], v[72:79], v8
    v_smfmac_f32_16x16x64_bf16 v[40:43], v[16:19], v[80:87], v8
    v_smfmac_f32_16x16x64_bf16 v[44:47], v[16:19], v[88:95], v8
    v_smfmac_f32_16x16x64_bf16 v[48:51], v[16:19], v[96:103], v8
    v_smfmac_f32_16x16x64_bf16 v[52:55], v[16:19], v[104:111], v8
    v_smfmac_f32_16x16x64_bf16 v[32:35], v[20:23], v[112:119], v8
    v_smfmac_f32_16x16x64_bf16 v[36:39], v[20:23], v[120:127], v8
    v_smfmac_f32_16x16x64_bf16 v[40:43], v[20:23], v[128:135], v8
    v_smfmac_f32_16x16x64_bf16 v[44:47], v[20:23], v[136:143], v8
    v_smfmac_f32_16x16x64_bf16 v[48:51], v[20:23], v[144:151], v8
    v_smfmac_f32_16x16x64_bf16 v[52:55], v[20:23], v[152:159], v8
    v_smfmac_f32_16x16x64_bf16 v[32:35], v[24:27], v[160:167], v8
    v_smfmac_f32_16x16x64_bf16 v[36:39], v[24:27], v[168:175], v8
    v_smfmac_f32_16x16x64_bf16 v[40:43], v[24:27], v[176:183], v8
    v_smfmac_f32_16x16x64_bf16 v[44:47], v[24:27], v[184:191], v8
    v_smfmac_f32_16x16x64_bf16 v[48:51], v[24:27], v[192:199], v8
    v_smfmac_f32_16x16x64_bf16 v[52:55], v[24:27], v[200:207], v8
    v_smfmac_f32_16x16x64_bf16 v[32:35], v[28:31], v[208:215], v8
    ds_write_b32 v63, v59 offset:32
    v_smfmac_f32_16x16x64_bf16 v[36:39], v[28:31], v[216:223], v8
    v_smfmac_f32_16x16x64_bf16 v[40:43], v[28:31], v[224:231], v8
    v_smfmac_f32_16x16x64_bf16 v[44:47], v[28:31], v[232:239], v8
    v_smfmac_f32_16x16x64_bf16 v[48:51], v[28:31], v[240:247], v8
    v_smfmac_f32_16x16x64_bf16 v[52:55], v[28:31], v[248:255], v8
ploopL_32_mmd:
    s_cmp_eq_u32 s3, 3
    s_nop 1
    v_add_f32 v32, v32, v34
    v_add_f32 v33, v33, v35
    ds_write2_b32 v3, v32, v33 offset0:0 offset1:40
    v_add_f32 v36, v36, v38
    v_add_f32 v37, v37, v39
    ds_write2_b32 v3, v36, v37 offset0:16 offset1:56
    v_add_f32 v40, v40, v42
    v_add_f32 v41, v41, v43
    ds_write2_b32 v61, v40, v41 offset0:0 offset1:40
    v_add_f32 v44, v44, v46
    v_add_f32 v45, v45, v47
    ds_write2_b32 v61, v44, v45 offset0:16 offset1:56
    v_add_f32 v48, v48, v50
    v_add_f32 v49, v49, v51
    ds_write2_b32 v62, v48, v49 offset0:0 offset1:40
    v_add_f32 v52, v52, v54
    v_add_f32 v53, v53, v55
    ds_write2_b32 v62, v52, v53 offset0:16 offset1:56
    s_waitcnt lgkmcnt(0)
    s_barrier
    s_cbranch_scc1 ploopL_32_sk1
    ds_read_b128 v[32:35], v4 offset:0
    ds_read_b128 v[36:39], v4 offset:3840
    ds_read_b128 v[40:43], v4 offset:7680
    ds_read_b128 v[44:47], v4 offset:11520
    s_waitcnt lgkmcnt(2)
    v_add_f32 v32, v32, v36
    v_add_f32 v33, v33, v37
    v_add_f32 v34, v34, v38
    v_add_f32 v35, v35, v39
    s_waitcnt lgkmcnt(0)
    v_add_f32 v40, v40, v44
    v_add_f32 v41, v41, v45
    v_add_f32 v42, v42, v46
    v_add_f32 v43, v43, v47
    v_add_f32 v32, v32, v40
    v_add_f32 v33, v33, v41
    v_add_f32 v34, v34, v42
    v_add_f32 v35, v35, v43
    v_cvt_pk_bf16_f32 v56, v32, v33
    v_cvt_pk_bf16_f32 v57, v34, v35
    v_min_u32 v56, -2, v56
    buffer_store_dwordx2 v[56:57], v2, s[4:7], s26 offen sc1
    s_add_u32 s27, s16, 2
    s_and_b32 s27, s27, 3
    s_lshl_b32 s27, s27, 18
    s_add_u32 s27, s27, s38
    buffer_store_dwordx2 v[10:11], v2, s[4:7], s27 offen sc1
ploopL_32_sk1:
    s_setprio 0
    s_add_u32 s25, s16, 3
    s_and_b32 s25, s25, 3
    s_lshl_b32 s25, s25, 16
    s_add_u32 s25, s25, s37
    v_mov_b32 v44, -1
    v_mov_b32 v45, -1
    v_mov_b32 v46, -1
    v_mov_b32 v47, -1
    s_mov_b64 exec, s[56:57]
    buffer_store_dwordx4 v[44:47], v5, s[4:7], s25 offen sc1
    s_mov_b64 exec, -1
    s_and_b32 s28, s16, 3
    s_lshl_b32 s28, s28, 18
    s_add_u32 s28, s28, s39
    s_add_u32 s24, s16, 1
    s_and_b32 s24, s24, 3
    s_lshl_b32 s24, s24, 16
    s_add_u32 s24, s24, s37
    s_add_u32 s23, s16, 1
    s_and_b32 s23, s23, 3
    s_lshl_b32 s23, s23, 16
    s_add_u32 s23, s23, s36
    s_add_u32 s26, s16, 1
    s_and_b32 s26, s26, 3
    s_lshl_b32 s26, s26, 18
    s_add_u32 s26, s26, s38
    s_cmp_eq_u32 s59, 0
    s_cbranch_scc1 ofl_34
    s_lshl_b32 s17, s3, 10
    v_add_u32 v39, s17, v1
    ds_read_b128 v[40:43], v39 offset:32768
ofl_34:
    s_cmp_ge_u32 s16, 16
    s_cbranch_scc1 ploopL_32_nx
    v_mov_b32 v40, v2
    v_mov_b32 v42, v56
    v_mov_b32 v43, v57
    s_cmp_lg_u32 s3, 2
    s_cbranch_scc1 ploopL_32_nx
    v_and_b32 v40, 0x60, v1
    v_lshlrev_b32 v40, 2, v40
    v_lshrrev_b32 v41, 3, v1
    v_and_b32 v41, 0x70, v41
    v_or_b32 v40, v40, v41
    v_bfe_u32 v41, v1, 4, 1
    v_lshl_or_b32 v40, v41, 3, v40
    s_lshl_b32 s17, s53, 9
    s_add_u32 s17, s17, 4096
    v_add_u32 v40, s17, v40
    s_mov_b32 vcc_lo, 0x55555555
    s_mov_b32 vcc_hi, 0x55555555
    v_cndmask_b32_dpp v42, v57, v56, vcc quad_perm:[1,0,3,2] row_mask:0xf bank_mask:0xf
    s_not_b64 vcc, vcc
    v_cndmask_b32_dpp v43, v56, v57, vcc quad_perm:[1,0,3,2] row_mask:0xf bank_mask:0xf
ploopL_32_nx:
    v_readfirstlane_b32 s21, v60
    s_lshr_b32 s29, s29, 1
    s_cmp_ge_u32 s21, s58
    s_cselect_b32 s21, 2, 0
    s_or_b32 s29, s29, s21
    s_cmp_eq_u32 s3, 3
    s_cselect_b32 s20, s21, 0
    s_add_u32 s21, s16, 4
    s_min_u32 s21, s21, 63
    s_cmp_ge_u32 s21, 16
    s_cselect_b32 s58, 12, 8
    s_and_b32 s33, s21, 4
    s_lshr_b32 s21, s21, 3
    s_lshl_b32 s21, s21, 8
    s_add_u32 s33, s33, s21
    s_add_u32 s33, s33, s35
    s_setprio 3
ploopL_32_fs:
    ds_read_b128 v[32:35], v58 offset:0
    s_waitcnt lgkmcnt(0)
    v_min3_i32 v32, v32, v33, v34
    v_min_i32 v32, v32, v35
    s_nop 0
    v_readfirstlane_b32 s18, v32
    s_cmp_ge_i32 s18, s16
    s_cbranch_scc1 ploopL_32_fsok
    s_sleep 1
    s_branch ploopL_32_fs
ploopL_32_fsok:
    s_setprio 1
    s_sleep 4
ploopL_32_nofd:
    s_cmp_eq_u32 s20, 0
    s_cbranch_scc1 ploopL_32_nt
    s_cmp_ge_u32 s16, 13
    s_cselect_b32 exec_hi, 0xffff, 0
    buffer_load_dword v60, v0, s[4:7], s31 offen sc1
    s_mov_b32 exec_hi, -1
ploopL_32_nt:
    s_cmp_eq_u32 s59, 0
    s_cbranch_scc1 ofl_35
    s_lshl_b32 s17, s16, 18
    s_add_u32 s17, s17, s60
    buffer_store_dwordx4 v[40:43], v1, s[4:7], s17 offen sc1
    s_mov_b32 s59, 0
ofl_35:
    s_lshr_b32 s17, s34, 3
    s_xor_b32 s17, s17, s16
    s_andn2_b32 s59, 1, s17
    s_cmp_ge_u32 s16, 16
    s_cselect_b32 s59, s59, 0
    s_cbranch_scc1 ploopL_32_nx2
    s_cmp_eq_u32 s3, 3
    s_cbranch_scc1 ploopL_32_nx2
    buffer_store_dwordx2 v[42:43], v40, s[4:7], s55 offen sc1
ploopL_32_nx2:
    s_add_u32 s55, s55, 262144
    s_or_b32 s17, s13, s3
    s_cmp_lg_u32 s17, 0
    s_cbranch_scc1 ploopL_32_npg
    s_sub_u32 s21, s16, 1
    s_cbranch_scc1 ploopL_32_npg
    s_sub_u32 s17, s21, 1
    s_and_b32 s17, s17, 3
    s_cmp_ge_u32 s16, 58
    s_cselect_b32 s17, 0, s17
    s_cmp_lg_u32 s17, 0
    s_cbranch_scc1 ploopL_32_npg
    s_lshl_b32 s17, s12, 7
    s_add_u32 s17, s17, 218112000
    v_mov_b32 v9, s21
    s_mov_b64 exec, 1
    buffer_store_dword v9, off, s[4:7], s17 sc1
    s_mov_b64 exec, -1
ploopL_32_npg:
    s_barrier
    buffer_load_dword v60, off, s[4:7], s33 sc1
    s_add_u32 s16, s16, 1
    v_mov_b32 v59, s16
    s_add_u32 s41, s41, 262144
    s_add_u32 s31, s31, 262144
    s_setprio 3
    s_sleep 13
ploopL_32_pagain:
    buffer_load_dwordx4 v[16:19], v1, s[4:7], s28 offen offset:0 sc1
    buffer_load_dwordx4 v[20:23], v1, s[4:7], s28 offen offset:1024 sc1
    s_waitcnt vmcnt(1)
    v_mfma_f32_16x16x32_bf16 v[32:35], v[12:15], v[16:19], 0
    s_waitcnt vmcnt(0)
    v_mfma_f32_16x16x32_bf16 v[32:35], v[12:15], v[20:23], v[32:35]
    v_max_u32 v9, v16, v20
    v_cmp_eq_u32 vcc, -1, v9
    s_cbranch_vccnz ploopL_32_rp
ploopL_32_pgo:
    s_cmp_lt_u32 s16, 48
    s_nop 3
    v_cvt_pk_bf16_f32 v52, v32, v33
    v_cvt_pk_bf16_f32 v53, v34, v35
    s_nop 0
    v_permlane16_swap_b32 v52, v54
    v_permlane16_swap_b32 v53, v55
    s_mov_b64 exec, s[56:57]
    v_min_u32 v52, -2, v52
    buffer_store_dwordx4 v[52:55], v5, s[4:7], s24 offen sc1
    s_mov_b64 exec, -1
    ds_write_b32 v63, v59 offset:16
    s_cbranch_scc1 ploopL_32
    s_branch ploopH_31
ploopL_32_rm_0:
    s_sub_u32 s22, s22, 1
    s_cbranch_scc1 ploopL_32_rm_0_g
    buffer_load_dwordx4 v[16:19], v1, s[4:7], s23 offen offset:0 sc1
    buffer_load_dwordx4 v[20:23], v1, s[4:7], s23 offen offset:1024 sc1
    buffer_load_dwordx4 v[24:27], v1, s[4:7], s23 offen offset:2048 sc1
    buffer_load_dwordx4 v[28:31], v1, s[4:7], s23 offen offset:3072 sc1
    s_waitcnt vmcnt(3)
    v_cmp_eq_u32 vcc, -1, v16
    s_cbranch_vccnz ploopL_32_rm_0
    s_branch ploopL_32_rm_0ok
ploopL_32_rm_0_g:
    s_mov_b32 s22, 0
    s_waitcnt vmcnt(0)
    s_branch ploopL_32_rm_0ok
ploopL_32_rm_1:
    s_sub_u32 s22, s22, 1
    s_cbranch_scc1 ploopL_32_rm_1_g
    buffer_load_dwordx4 v[20:23], v1, s[4:7], s23 offen offset:1024 sc1
    buffer_load_dwordx4 v[24:27], v1, s[4:7], s23 offen offset:2048 sc1
    buffer_load_dwordx4 v[28:31], v1, s[4:7], s23 offen offset:3072 sc1
    s_waitcnt vmcnt(2)
    v_cmp_eq_u32 vcc, -1, v20
    s_cbranch_vccnz ploopL_32_rm_1
    s_branch ploopL_32_rm_1ok
ploopL_32_rm_1_g:
    s_mov_b32 s22, 0
    s_waitcnt vmcnt(0)
    s_branch ploopL_32_rm_1ok
ploopL_32_rm_2:
    s_sub_u32 s22, s22, 1
    s_cbranch_scc1 ploopL_32_rm_2_g
    buffer_load_dwordx4 v[24:27], v1, s[4:7], s23 offen offset:2048 sc1
    buffer_load_dwordx4 v[28:31], v1, s[4:7], s23 offen offset:3072 sc1
    s_waitcnt vmcnt(1)
    v_cmp_eq_u32 vcc, -1, v24
    s_cbranch_vccnz ploopL_32_rm_2
    s_branch ploopL_32_rm_2ok
ploopL_32_rm_2_g:
    s_mov_b32 s22, 0
    s_waitcnt vmcnt(0)
    s_branch ploopL_32_rm_2ok
ploopL_32_rm_3:
    s_sub_u32 s22, s22, 1
    s_cbranch_scc1 ploopL_32_rm_3_g
    buffer_load_dwordx4 v[28:31], v1, s[4:7], s23 offen offset:3072 sc1
    s_waitcnt vmcnt(0)
    v_cmp_eq_u32 vcc, -1, v28
    s_cbranch_vccnz ploopL_32_rm_3
    s_branch ploopL_32_rm_3ok
ploopL_32_rm_3_g:
    s_mov_b32 s22, 0
    s_waitcnt vmcnt(0)
    s_branch ploopL_32_rm_3ok
ploopL_32_rp:
    s_sub_u32 s22, s22, 1
    s_cbranch_scc0 ploopL_32_pagain
    s_mov_b32 s22, 0
    s_branch ploopL_32_pgo
.p2align 6
    s_nop 0
    s_nop 0
    s_nop 0
    s_nop 0
    s_nop 0
    s_nop 0
    s_nop 0
    s_nop 0
    s_nop 0
    s_nop 0
    s_nop 0
ploopH_31:
    v_mov_b32 v32, 0
    v_mov_b32 v33, 0
    v_mov_b32 v34, 0
    v_mov_b32 v35, 0
    v_mov_b32 v36, 0
    v_mov_b32 v37, 0
    v_mov_b32 v38, 0
    v_mov_b32 v39, 0
    v_mov_b32 v40, 0
    v_mov_b32 v41, 0
    v_mov_b32 v42, 0
    v_mov_b32 v43, 0
    v_mov_b32 v44, 0
    v_mov_b32 v45, 0
    v_mov_b32 v46, 0
    v_mov_b32 v47, 0
    v_mov_b32 v48, 0
    v_mov_b32 v49, 0
    v_mov_b32 v50, 0
    v_mov_b32 v51, 0
    v_mov_b32 v52, 0
    v_mov_b32 v53, 0
    v_mov_b32 v54, 0
    v_mov_b32 v55, 0
    s_sleep 1
    buffer_load_dwordx4 v[16:19], v1, s[4:7], s23 offen offset:0 sc1
    buffer_load_dwordx4 v[20:23], v1, s[4:7], s23 offen offset:1024 sc1
    buffer_load_dwordx4 v[24:27], v1, s[4:7], s23 offen offset:2048 sc1
    buffer_load_dwordx4 v[28:31], v1, s[4:7], s23 offen offset:3072 sc1
    s_waitcnt vmcnt(3)
    v_cmp_eq_u32 vcc, -1, v16
    s_cbranch_vccnz ploopH_31_rm_0
ploopH_31_rm_0ok:
    v_smfmac_f32_16x16x64_bf16 v[32:35], v[16:19], v[64:71], v8
    v_smfmac_f32_16x16x64_bf16 v[36:39], v[16:19], v[72:79], v8
    s_waitcnt vmcnt(2)
    v_cmp_eq_u32 vcc, -1, v20
    v_smfmac_f32_16x16x64_bf16 v[40:43], v[16:19], v[80:87], v8
    v_smfmac_f32_16x16x64_bf16 v[44:47], v[16:19], v[88:95], v8
    v_smfmac_f32_16x16x64_bf16 v[48:51], v[16:19], v[96:103], v8
    v_smfmac_f32_16x16x64_bf16 v[52:55], v[16:19], v[104:111], v8
    s_cbranch_vccnz ploopH_31_rm_1
ploopH_31_rm_1ok:
    v_smfmac_f32_16x16x64_bf16 v[32:35], v[20:23], v[112:119], v8
    v_smfmac_f32_16x16x64_bf16 v[36:39], v[20:23], v[120:127], v8
    s_waitcnt vmcnt(1)
    v_cmp_eq_u32 vcc, -1, v24
    v_smfmac_f32_16x16x64_bf16 v[40:43], v[20:23], v[128:135], v8
    v_smfmac_f32_16x16x64_bf16 v[44:47], v[20:23], v[136:143], v8
    v_smfmac_f32_16x16x64_bf16 v[48:51], v[20:23], v[144:151], v8
    v_smfmac_f32_16x16x64_bf16 v[52:55], v[20:23], v[152:159], v8
    s_cbranch_vccnz ploopH_31_rm_2
ploopH_31_rm_2ok:
    v_smfmac_f32_16x16x64_bf16 v[32:35], v[24:27], v[160:167], v8
    v_smfmac_f32_16x16x64_bf16 v[36:39], v[24:27], v[168:175], v8
    s_waitcnt vmcnt(0)
    v_cmp_eq_u32 vcc, -1, v28
    v_smfmac_f32_16x16x64_bf16 v[40:43], v[24:27], v[176:183], v8
    v_smfmac_f32_16x16x64_bf16 v[44:47], v[24:27], v[184:191], v8
    v_smfmac_f32_16x16x64_bf16 v[48:51], v[24:27], v[192:199], v8
    v_smfmac_f32_16x16x64_bf16 v[52:55], v[24:27], v[200:207], v8
    s_cbranch_vccnz ploopH_31_rm_3
ploopH_31_rm_3ok:
    v_smfmac_f32_16x16x64_bf16 v[32:35], v[28:31], v[208:215], v8
    ds_write_b32 v63, v59 offset:32
    v_smfmac_f32_16x16x64_bf16 v[36:39], v[28:31], v[216:223], v8
    v_smfmac_f32_16x16x64_bf16 v[40:43], v[28:31], v[224:231], v8
    v_smfmac_f32_16x16x64_bf16 v[44:47], v[28:31], v[232:239], v8
    v_smfmac_f32_16x16x64_bf16 v[48:51], v[28:31], v[240:247], v8
    v_smfmac_f32_16x16x64_bf16 v[52:55], v[28:31], v[248:255], v8
    s_cmp_eq_u32 s3, 3
    s_nop 1
    v_add_f32 v32, v32, v34
    v_add_f32 v33, v33, v35
    ds_write2_b32 v3, v32, v33 offset0:0 offset1:40
    v_add_f32 v36, v36, v38
    v_add_f32 v37, v37, v39
    ds_write2_b32 v3, v36, v37 offset0:16 offset1:56
    v_add_f32 v40, v40, v42
    v_add_f32 v41, v41, v43
    ds_write2_b32 v61, v40, v41 offset0:0 offset1:40
    v_add_f32 v44, v44, v46
    v_add_f32 v45, v45, v47
    ds_write2_b32 v61, v44, v45 offset0:16 offset1:56
    v_add_f32 v48, v48, v50
    v_add_f32 v49, v49, v51
    ds_write2_b32 v62, v48, v49 offset0:0 offset1:40
    v_add_f32 v52, v52, v54
    v_add_f32 v53, v53, v55
    ds_write2_b32 v62, v52, v53 offset0:16 offset1:56
    s_waitcnt lgkmcnt(0)
    s_barrier
    s_cbranch_scc1 ploopH_31_sk1
    ds_read_b128 v[32:35], v4 offset:0
    ds_read_b128 v[36:39], v4 offset:3840
    ds_read_b128 v[40:43], v4 offset:7680
    ds_read_b128 v[44:47], v4 offset:11520
    s_waitcnt lgkmcnt(2)
    v_add_f32 v32, v32, v36
    v_add_f32 v33, v33, v37
    v_add_f32 v34, v34, v38
    v_add_f32 v35, v35, v39
    s_waitcnt lgkmcnt(0)
    v_add_f32 v40, v40, v44
    v_add_f32 v41, v41, v45
    v_add_f32 v42, v42, v46
    v_add_f32 v43, v43, v47
    v_add_f32 v32, v32, v40
    v_add_f32 v33, v33, v41
    v_add_f32 v34, v34, v42
    v_add_f32 v35, v35, v43
    v_cvt_pk_bf16_f32 v56, v32, v33
    v_cvt_pk_bf16_f32 v57, v34, v35
    v_min_u32 v56, -2, v56
    buffer_store_dwordx2 v[56:57], v2, s[4:7], s26 offen sc1
    s_add_u32 s27, s16, 2
    s_and_b32 s27, s27, 3
    s_lshl_b32 s27, s27, 18
    s_add_u32 s27, s27, s38
    buffer_store_dwordx2 v[10:11], v2, s[4:7], s27 offen sc1
ploopH_31_sk1:
    s_setprio 0
    s_add_u32 s25, s16, 3
    s_and_b32 s25, s25, 3
    s_lshl_b32 s25, s25, 16
    s_add_u32 s25, s25, s37
    v_mov_b32 v44, -1
    v_mov_b32 v45, -1
    v_mov_b32 v46, -1
    v_mov_b32 v47, -1
    s_mov_b64 exec, s[56:57]
    buffer_store_dwordx4 v[44:47], v5, s[4:7], s25 offen sc1
    s_mov_b64 exec, -1
    v_mov_b32_dpp v48, v12 row_ror:8 row_mask:0xf bank_mask:0xf
    v_mov_b32_dpp v49, v13 row_ror:8 row_mask:0xf bank_mask:0xf
    v_mov_b32_dpp v50, v14 row_ror:8 row_mask:0xf bank_mask:0xf
    v_mov_b32_dpp v51, v15 row_ror:8 row_mask:0xf bank_mask:0xf
    s_and_b32 s28, s16, 3
    s_lshl_b32 s28, s28, 18
    s_add_u32 s28, s28, s39
    s_add_u32 s24, s16, 1
    s_and_b32 s24, s24, 3
    s_lshl_b32 s24, s24, 16
    s_add_u32 s24, s24, s37
    s_add_u32 s23, s16, 1
    s_and_b32 s23, s23, 3
    s_lshl_b32 s23, s23, 16
    s_add_u32 s23, s23, s36
    s_add_u32 s26, s16, 1
    s_and_b32 s26, s26, 3
    s_lshl_b32 s26, s26, 18
    s_add_u32 s26, s26, s38
    s_cmp_eq_u32 s59, 0
    s_cbranch_scc1 ofl_36
    s_lshl_b32 s17, s3, 10
    v_add_u32 v39, s17, v1
    ds_read_b128 v[40:43], v39 offset:32768
ofl_36:
    s_cmp_eq_u32 s16, 63
    s_cbranch_scc1 ploopH_31_tail
    s_cmp_eq_u32 s30, s54
    s_cbranch_scc1 pnoseg_37
    ds_read_b128 v[16:19], v6 offset:0
    ds_read_b128 v[20:23], v6 offset:256
    ds_read_b128 v[24:27], v6 offset:512
    ds_read_b128 v[28:31], v6 offset:768
    v_xor_b32 v6, 0x4000, v6
    s_waitcnt lgkmcnt(2)
    v_mfma_f32_16x16x32_bf16 v[40:43], v[12:15], v[16:19], 0
    v_mfma_f32_16x16x32_bf16 v[40:43], v[48:51], v[20:23], v[40:43]
    s_waitcnt lgkmcnt(0)
    v_mfma_f32_16x16x32_bf16 v[44:47], v[12:15], v[24:27], 0
    v_mfma_f32_16x16x32_bf16 v[44:47], v[48:51], v[28:31], v[44:47]
    s_nop 7
    v_cvt_pk_bf16_f32 v40, v40, v41
    v_cvt_pk_bf16_f32 v41, v42, v43
    v_cvt_pk_bf16_f32 v42, v44, v45
    v_cvt_pk_bf16_f32 v43, v46, v47
    s_nop 1
    v_permlane16_swap_b32 v40, v42
    v_permlane16_swap_b32 v41, v43
    s_nop 1
    v_min_u32 v40, -2, v40
pnoseg_37:
    s_bitcmp1_b32 s29, 0
    s_cbranch_scc1 gate_38_ok
    s_add_u32 s21, s16, 1
    s_min_u32 s21, s21, 63
    s_cmp_ge_u32 s21, 16
    s_cselect_b32 s19, 12, 8
    s_and_b32 s32, s21, 4
    s_lshr_b32 s21, s21, 3
    s_lshl_b32 s21, s21, 8
    s_add_u32 s32, s32, s21
    s_add_u32 s32, s32, s35
gate_38:
    buffer_load_dword v9, off, s[4:7], s32 sc1
    s_waitcnt vmcnt(0)
    v_readfirstlane_b32 s21, v9
    s_cmp_ge_u32 s21, s19
    s_cbranch_scc1 gate_38_set
    s_sleep 8
    s_sub_u32 s22, s22, 1
    s_cbranch_scc0 gate_38
    s_mov_b32 s22, 0
gate_38_set:
    s_bitset1_b32 s29, 0
gate_38_ok:
    v_readfirstlane_b32 s21, v60
    s_lshr_b32 s29, s29, 1
    s_cmp_ge_u32 s21, s58
    s_cselect_b32 s21, 2, 0
    s_or_b32 s29, s29, s21
    s_cmp_eq_u32 s3, 3
    s_cselect_b32 s20, s21, 0
    s_add_u32 s21, s16, 4
    s_min_u32 s21, s21, 63
    s_cmp_ge_u32 s21, 16
    s_cselect_b32 s58, 12, 8
    s_and_b32 s33, s21, 4
    s_lshr_b32 s21, s21, 3
    s_lshl_b32 s21, s21, 8
    s_add_u32 s33, s33, s21
    s_add_u32 s33, s33, s35
    s_setprio 3
ploopH_31_fs:
    ds_read_b128 v[32:35], v58 offset:0
    s_waitcnt lgkmcnt(0)
    v_min3_i32 v32, v32, v33, v34
    v_min_i32 v32, v32, v35
    s_nop 0
    v_readfirstlane_b32 s18, v32
    s_cmp_ge_i32 s18, s16
    s_cbranch_scc1 ploopH_31_fsok
    s_sleep 1
    s_branch ploopH_31_fs
ploopH_31_fsok:
    s_setprio 1
    s_add_u32 m0, s42, 8192
    s_add_u32 s17, s41, 37748736
    buffer_load_dwordx4 v1, s[4:7], s17 offen offset:0 sc1 lds
    buffer_load_dwordx4 v1, s[4:7], s17 offen offset:1024 sc1 lds
    buffer_load_dwordx4 v1, s[4:7], s17 offen offset:2048 sc1 lds
    buffer_load_dwordx4 v1, s[4:7], s17 offen offset:3072 sc1 lds
    s_add_u32 m0, s42, 12288
    s_add_u32 s17, s41, 37879808
    buffer_load_dwordx4 v1, s[4:7], s17 offen offset:0 sc1 lds
    buffer_load_dwordx4 v1, s[4:7], s17 offen offset:1024 sc1 lds
    buffer_load_dwordx4 v1, s[4:7], s17 offen offset:2048 sc1 lds
    buffer_load_dwordx4 v1, s[4:7], s17 offen offset:3072 sc1 lds
    s_cmp_eq_u32 s20, 0
    s_cbranch_scc1 ploopH_31_nt
    s_mov_b32 exec_hi, 0xffff
    buffer_load_dword v60, v0, s[4:7], s31 offen sc1
    s_mov_b32 exec_hi, -1
ploopH_31_nt:
    s_cmp_eq_u32 s59, 0
    s_cbranch_scc1 ofl_39
    s_lshl_b32 s17, s16, 18
    s_add_u32 s17, s17, s60
    buffer_store_dwordx4 v[40:43], v1, s[4:7], s17 offen sc1
    s_mov_b32 s59, 0
ofl_39:
    s_cmp_eq_u32 s30, s54
    s_cbranch_scc1 pnoseg_40
    buffer_store_dwordx4 v[40:43], v7, s[4:7], s30 offen sc1
    s_add_u32 s30, s30, 65536
pnoseg_40:
    s_or_b32 s17, s13, s3
    s_cmp_lg_u32 s17, 0
    s_cbranch_scc1 ploopH_31_npg
    s_sub_u32 s21, s16, 1
    s_cbranch_scc1 ploopH_31_npg
    s_sub_u32 s17, s21, 1
    s_and_b32 s17, s17, 3
    s_cmp_ge_u32 s16, 58
    s_cselect_b32 s17, 0, s17
    s_cmp_lg_u32 s17, 0
    s_cbranch_scc1 ploopH_31_npg
    s_lshl_b32 s17, s12, 7
    s_add_u32 s17, s17, 218112000
    v_mov_b32 v9, s21
    s_mov_b64 exec, 1
    buffer_store_dword v9, off, s[4:7], s17 sc1
    s_mov_b64 exec, -1
ploopH_31_npg:
    s_barrier
    buffer_load_dword v60, off, s[4:7], s33 sc1
    s_add_u32 s16, s16, 1
    v_mov_b32 v59, s16
    s_add_u32 s41, s41, 262144
    s_add_u32 s31, s31, 262144
    s_mov_b32 s54, 0
    s_setprio 3
    s_sleep 13
ploopH_31_pagain:
    buffer_load_dwordx4 v[16:19], v1, s[4:7], s28 offen offset:0 sc1
    buffer_load_dwordx4 v[20:23], v1, s[4:7], s28 offen offset:1024 sc1
    s_waitcnt vmcnt(1)
    v_mfma_f32_16x16x32_bf16 v[32:35], v[12:15], v[16:19], 0
    s_waitcnt vmcnt(0)
    v_mfma_f32_16x16x32_bf16 v[32:35], v[12:15], v[20:23], v[32:35]
    v_max_u32 v9, v16, v20
    v_cmp_eq_u32 vcc, -1, v9
    s_cbranch_vccnz ploopH_31_rp
ploopH_31_pgo:
    s_nop 4
    v_cvt_pk_bf16_f32 v52, v32, v33
    v_cvt_pk_bf16_f32 v53, v34, v35
    s_nop 0
    v_permlane16_swap_b32 v52, v54
    v_permlane16_swap_b32 v53, v55
    s_mov_b64 exec, s[56:57]
    v_min_u32 v52, -2, v52
    buffer_store_dwordx4 v[52:55], v5, s[4:7], s24 offen sc1
    s_mov_b64 exec, -1
    ds_write_b32 v63, v59 offset:16
    s_branch ploopH_31
ploopH_31_rm_0:
    s_sub_u32 s22, s22, 1
    s_cbranch_scc1 ploopH_31_rm_0_g
    buffer_load_dwordx4 v[16:19], v1, s[4:7], s23 offen offset:0 sc1
    buffer_load_dwordx4 v[20:23], v1, s[4:7], s23 offen offset:1024 sc1
    buffer_load_dwordx4 v[24:27], v1, s[4:7], s23 offen offset:2048 sc1
    buffer_load_dwordx4 v[28:31], v1, s[4:7], s23 offen offset:3072 sc1
    s_waitcnt vmcnt(3)
    v_cmp_eq_u32 vcc, -1, v16
    s_cbranch_vccnz ploopH_31_rm_0
    s_branch ploopH_31_rm_0ok
ploopH_31_rm_0_g:
    s_mov_b32 s22, 0
    s_waitcnt vmcnt(0)
    s_branch ploopH_31_rm_0ok
ploopH_31_rm_1:
    s_sub_u32 s22, s22, 1
    s_cbranch_scc1 ploopH_31_rm_1_g
    buffer_load_dwordx4 v[20:23], v1, s[4:7], s23 offen offset:1024 sc1
    buffer_load_dwordx4 v[24:27], v1, s[4:7], s23 offen offset:2048 sc1
    buffer_load_dwordx4 v[28:31], v1, s[4:7], s23 offen offset:3072 sc1
    s_waitcnt vmcnt(2)
    v_cmp_eq_u32 vcc, -1, v20
    s_cbranch_vccnz ploopH_31_rm_1
    s_branch ploopH_31_rm_1ok
ploopH_31_rm_1_g:
    s_mov_b32 s22, 0
    s_waitcnt vmcnt(0)
    s_branch ploopH_31_rm_1ok
ploopH_31_rm_2:
    s_sub_u32 s22, s22, 1
    s_cbranch_scc1 ploopH_31_rm_2_g
    buffer_load_dwordx4 v[24:27], v1, s[4:7], s23 offen offset:2048 sc1
    buffer_load_dwordx4 v[28:31], v1, s[4:7], s23 offen offset:3072 sc1
    s_waitcnt vmcnt(1)
    v_cmp_eq_u32 vcc, -1, v24
    s_cbranch_vccnz ploopH_31_rm_2
    s_branch ploopH_31_rm_2ok
ploopH_31_rm_2_g:
    s_mov_b32 s22, 0
    s_waitcnt vmcnt(0)
    s_branch ploopH_31_rm_2ok
ploopH_31_rm_3:
    s_sub_u32 s22, s22, 1
    s_cbranch_scc1 ploopH_31_rm_3_g
    buffer_load_dwordx4 v[28:31], v1, s[4:7], s23 offen offset:3072 sc1
    s_waitcnt vmcnt(0)
    v_cmp_eq_u32 vcc, -1, v28
    s_cbranch_vccnz ploopH_31_rm_3
    s_branch ploopH_31_rm_3ok
ploopH_31_rm_3_g:
    s_mov_b32 s22, 0
    s_waitcnt vmcnt(0)
    s_branch ploopH_31_rm_3ok
ploopH_31_rp:
    s_sub_u32 s22, s22, 1
    s_cbranch_scc0 ploopH_31_pagain
    s_mov_b32 s22, 0
    s_branch ploopH_31_pgo
ploopH_31_tail:
    ds_read_b128 v[16:19], v6 offset:0
    ds_read_b128 v[20:23], v6 offset:256
    ds_read_b128 v[24:27], v6 offset:512
    ds_read_b128 v[28:31], v6 offset:768
    v_xor_b32 v6, 0x4000, v6
    s_waitcnt lgkmcnt(2)
    v_mfma_f32_16x16x32_bf16 v[40:43], v[12:15], v[16:19], 0
    v_mfma_f32_16x16x32_bf16 v[40:43], v[48:51], v[20:23], v[40:43]
    s_waitcnt lgkmcnt(0)
    v_mfma_f32_16x16x32_bf16 v[44:47], v[12:15], v[24:27], 0
    v_mfma_f32_16x16x32_bf16 v[44:47], v[48:51], v[28:31], v[44:47]
    s_nop 7
    v_cvt_pk_bf16_f32 v40, v40, v41
    v_cvt_pk_bf16_f32 v41, v42, v43
    v_cvt_pk_bf16_f32 v42, v44, v45
    v_cvt_pk_bf16_f32 v43, v46, v47
    s_nop 1
    v_permlane16_swap_b32 v40, v42
    v_permlane16_swap_b32 v41, v43
    s_nop 1
    v_min_u32 v40, -2, v40
    buffer_store_dwordx4 v[40:43], v7, s[4:7], s30 offen sc1
    s_add_u32 s30, s30, 65536
    s_barrier
    ds_read_b128 v[16:19], v6 offset:0
    ds_read_b128 v[20:23], v6 offset:256
    ds_read_b128 v[24:27], v6 offset:512
    ds_read_b128 v[28:31], v6 offset:768
    v_xor_b32 v6, 0x4000, v6
    s_waitcnt lgkmcnt(2)
    v_mfma_f32_16x16x32_bf16 v[40:43], v[12:15], v[16:19], 0
    v_mfma_f32_16x16x32_bf16 v[40:43], v[48:51], v[20:23], v[40:43]
    s_waitcnt lgkmcnt(0)
    v_mfma_f32_16x16x32_bf16 v[44:47], v[12:15], v[24:27], 0
    v_mfma_f32_16x16x32_bf16 v[44:47], v[48:51], v[28:31], v[44:47]
    s_nop 7
    v_cvt_pk_bf16_f32 v40, v40, v41
    v_cvt_pk_bf16_f32 v41, v42, v43
    v_cvt_pk_bf16_f32 v42, v44, v45
    v_cvt_pk_bf16_f32 v43, v46, v47
    s_nop 1
    v_permlane16_swap_b32 v40, v42
    v_permlane16_swap_b32 v41, v43
    s_nop 1
    v_min_u32 v40, -2, v40
    buffer_store_dwordx4 v[40:43], v7, s[4:7], s30 offen sc1
    s_add_u32 s30, s30, 65536
    s_branch k_end
ch_a_pro:
    s_sub_u32 s21, s3, 4
    s_lshl_b32 s15, s14, 2
    s_add_u32 s15, s15, s21
    s_lshl_b32 s38, s15, 13
    s_add_u32 s38, s38, 214958080
    s_cmp_lg_u32 s3, 7
    s_cbranch_scc1 ch_nrp
    s_mov_b32 s95, 0x10000
rp_41:
    buffer_load_dword v28, off, s[64:67], 0 offset:224 sc1
    s_waitcnt vmcnt(0)
    v_readfirstlane_b32 s96, v28
    s_cmp_lg_u32 s96, 0
    s_cbranch_scc1 rp_41_ok
    s_sleep 2
    s_sub_u32 s95, s95, 1
    s_cbranch_scc0 rp_41
    s_add_u32 s96, s97, 1
rp_41_ok:
    s_sub_u32 s96, s96, 1
    v_mov_b32 v27, 131136
    v_mov_b32 v28, s96
    ds_write_b32 v27, v28
    s_waitcnt lgkmcnt(0)
ch_nrp:
    s_barrier
    v_mov_b32 v27, 131136
    ds_read_b32 v27, v27
    s_mov_b32 s96, s97
    s_waitcnt lgkmcnt(0)
    v_readfirstlane_b32 s97, v27
    s_cmp_lg_u32 s96, s97
    s_cbranch_scc1 k_restart
    s_min_u32 s20, s21, 2
    s_lshl_b32 s18, s20, 3
    s_add_u32 s18, s18, 16
    s_load_dwordx2 s[8:9], s[0:1], s18
    s_mov_b32 s10, 8388608
    s_mov_b32 s11, 131072
    v_and_b32 v20, 63, v0
    v_lshlrev_b32 v21, 13, v20
    s_lshl_b32 s17, s34, 19
    s_lshl_b32 s18, s14, 10
    s_add_u32 s17, s17, s18
    s_waitcnt lgkmcnt(0)
    buffer_load_dword v26, v21, s[8:11], s17 offen offset:384
    v_and_b32 v20, 63, v0
    v_lshrrev_b32 v21, 4, v20
    v_bfe_u32 v22, v20, 1, 1
    v_xor_b32 v22, 1, v22
    v_lshl_add_u32 v23, v22, 2, v21
    v_bfe_u32 v22, v20, 2, 2
    v_and_b32 v24, 1, v20
    v_lshl_add_u32 v22, v22, 1, v24
    v_lshl_add_u32 v23, v23, 3, v22
    v_and_b32 v22, 7, v20
    v_lshlrev_b32 v23, 4, v23
    s_lshl_b32 s17, s21, 10
    s_add_u32 s17, s17, 16384
    v_add_u32 v160, s17, v23
    v_and_b32 v24, 15, v20
    v_lshlrev_b32 v24, 4, v24
    v_lshl_add_u32 v23, v21, 10, v24
    s_lshl_b32 s17, s21, 8
    s_add_u32 s17, s17, 16384
    v_add_u32 v161, s17, v23
    v_lshl_add_u32 v23, v21, 9, v24
    s_lshl_b32 s17, s21, 12
    s_add_u32 s17, s17, 32768
    v_add_u32 v162, s17, v23
    v_bfe_u32 v23, v20, 3, 1
    v_lshlrev_b32 v23, 10, v23
    v_lshl_add_u32 v23, v22, 4, v23
    v_lshlrev_b32 v1, 4, v20
    s_lshl_b32 s39, s34, 14
    s_lshl_b32 s17, s21, 11
    s_add_u32 s39, s39, s17
    s_lshl_b32 s17, s14, 8
    s_add_u32 s39, s39, s17
    s_add_u32 s39, s39, 209715200
    v_mov_b32 v176, -1
    v_mov_b32 v177, -1
    v_mov_b32 v178, -1
    v_mov_b32 v179, -1
    v_lshlrev_b32 v24, 4, v0
    s_lshl_b32 s17, s52, 13
    s_add_u32 s19, s17, 209711104
    s_add_u32 s17, s17, 214953984
    s_lshl_b32 s18, s52, 12
    s_add_u32 s18, s18, 213905408
    buffer_store_dwordx4 v[176:179], v24, s[4:7], s19 offen sc1
    s_add_u32 s19, s19, 4096
    buffer_store_dwordx4 v[176:179], v24, s[4:7], s19 offen sc1
    buffer_store_dwordx4 v[176:179], v24, s[4:7], s17 offen sc1
    s_add_u32 s17, s17, 4096
    buffer_store_dwordx4 v[176:179], v24, s[4:7], s17 offen sc1
    buffer_store_dwordx4 v[176:179], v24, s[4:7], s18 offen sc1
    s_and_b32 s17, s13, 7
    s_sub_u32 s18, s21, 1
    s_cmp_lt_u32 s18, 2
    s_cselect_b32 s54, s17, 1
    s_lshr_b32 s19, s52, 3
    s_lshl_b32 s19, s19, 8
    s_lshl_b32 s18, s18, 7
    s_add_u32 s19, s19, s18
    s_add_u32 s55, s19, 210763776
    s_cmp_lg_u32 s54, 0
    s_cbranch_scc1 ch_nv0
    v_lshlrev_b32 v24, 13, v20
    s_mov_b64 exec, 0xffff
    buffer_store_dword v176, v24, s[4:7], s55 offen sc1
    s_mov_b64 exec, -1
ch_nv0:
    v_mov_b32 v2, s40
    s_lshl_b32 s17, s12, 2
    s_add_u32 s17, s17, 128
    s_waitcnt vmcnt(0)
    s_barrier
    s_cmp_lg_u32 s3, 4
    s_cbranch_scc1 ch_nox
    s_mov_b64 exec, 1
    buffer_atomic_add v2, off, s[64:67], s17 sc1
    s_mov_b64 exec, -1
ch_nox:
    v_and_b32 v20, 63, v0
    v_lshlrev_b32 v0, 4, v20
    s_lshl_b32 s17, s15, 18
    s_lshl_b32 s18, s34, 7
    s_add_u32 s17, s17, s18
    s_lshl_b32 s19, s21, 13
    s_add_u32 s19, s19, 131072
    s_load_dwordx2 s[8:9], s[0:1], 40
    s_mov_b32 s10, 8388608
    s_mov_b32 s11, 131072
    v_lshrrev_b32 v21, 3, v20
    v_and_b32 v22, 7, v20
    v_lshlrev_b32 v21, 11, v21
    v_lshl_add_u32 v21, v22, 4, v21
    v_lshrrev_b32 v28, 4, v20
    v_and_b32 v29, 1, v28
    v_xor_b32 v29, 0, v29
    v_lshlrev_b32 v29, 2, v29
    v_lshl_add_u32 v29, v28, 3, v29
    v_bfe_u32 v28, v20, 2, 2
    v_add_u32 v29, v29, v28
    v_lshlrev_b32 v29, 7, v29
    v_and_b32 v28, 3, v20
    v_lshl_add_u32 v29, v28, 4, v29
    v_and_b32 v28, 1, v28
    v_xor_b32 v28, 0, v28
    v_lshl_add_u32 v24, v28, 3, v29
    v_add_u32 v24, s19, v24
    v_lshrrev_b32 v28, 4, v20
    v_and_b32 v29, 1, v28
    v_xor_b32 v29, 1, v29
    v_lshlrev_b32 v29, 2, v29
    v_lshl_add_u32 v29, v28, 3, v29
    v_bfe_u32 v28, v20, 2, 2
    v_add_u32 v29, v29, v28
    v_lshlrev_b32 v29, 7, v29
    v_and_b32 v28, 3, v20
    v_lshl_add_u32 v29, v28, 4, v29
    v_and_b32 v28, 1, v28
    v_xor_b32 v28, 0, v28
    v_lshl_add_u32 v25, v28, 3, v29
    v_add_u32 v25, s19, v25
    v_lshrrev_b32 v28, 4, v20
    v_and_b32 v29, 1, v28
    v_xor_b32 v29, 0, v29
    v_lshlrev_b32 v29, 2, v29
    v_lshl_add_u32 v29, v28, 3, v29
    v_bfe_u32 v28, v20, 2, 2
    v_add_u32 v29, v29, v28
    v_lshlrev_b32 v29, 7, v29
    v_and_b32 v28, 3, v20
    v_lshl_add_u32 v29, v28, 4, v29
    v_and_b32 v28, 1, v28
    v_xor_b32 v28, 1, v28
    v_lshl_add_u32 v26, v28, 3, v29
    v_add_u32 v26, s19, v26
    v_lshrrev_b32 v28, 4, v20
    v_and_b32 v29, 1, v28
    v_xor_b32 v29, 1, v29
    v_lshlrev_b32 v29, 2, v29
    v_lshl_add_u32 v29, v28, 3, v29
    v_bfe_u32 v28, v20, 2, 2
    v_add_u32 v29, v29, v28
    v_lshlrev_b32 v29, 7, v29
    v_and_b32 v28, 3, v20
    v_lshl_add_u32 v29, v28, 4, v29
    v_and_b32 v28, 1, v28
    v_xor_b32 v28, 1, v28
    v_lshl_add_u32 v27, v28, 3, v29
    v_add_u32 v27, s19, v27
    s_waitcnt lgkmcnt(0)
    s_add_u32 m0, s19, 0
    s_nop 0
    buffer_load_dwordx4 v21, s[8:11], s17 offen lds
    s_add_u32 s17, s17, 16384
    s_add_u32 m0, s19, 1024
    s_nop 0
    buffer_load_dwordx4 v21, s[8:11], s17 offen lds
    s_add_u32 s17, s17, 16384
    s_add_u32 m0, s19, 2048
    s_nop 0
    buffer_load_dwordx4 v21, s[8:11], s17 offen lds
    s_add_u32 s17, s17, 16384
    s_add_u32 m0, s19, 3072
    s_nop 0
    buffer_load_dwordx4 v21, s[8:11], s17 offen lds
    s_add_u32 s17, s17, 16384
    s_add_u32 m0, s19, 4096
    s_nop 0
    buffer_load_dwordx4 v21, s[8:11], s17 offen lds
    s_add_u32 s17, s17, 16384
    s_add_u32 m0, s19, 5120
    s_nop 0
    buffer_load_dwordx4 v21, s[8:11], s17 offen lds
    s_add_u32 s17, s17, 16384
    s_add_u32 m0, s19, 6144
    s_nop 0
    buffer_load_dwordx4 v21, s[8:11], s17 offen lds
    s_add_u32 s17, s17, 16384
    s_add_u32 m0, s19, 7168
    s_nop 0
    buffer_load_dwordx4 v21, s[8:11], s17 offen lds
    s_add_u32 s17, s17, 16384
    buffer_load_dwordx4 v[96:99], v21, s[8:11], s17 offen
    s_add_u32 s17, s17, 16384
    buffer_load_dwordx4 v[100:103], v21, s[8:11], s17 offen
    s_add_u32 s17, s17, 16384
    buffer_load_dwordx4 v[104:107], v21, s[8:11], s17 offen
    s_add_u32 s17, s17, 16384
    buffer_load_dwordx4 v[108:111], v21, s[8:11], s17 offen
    s_add_u32 s17, s17, 16384
    buffer_load_dwordx4 v[112:115], v21, s[8:11], s17 offen
    s_add_u32 s17, s17, 16384
    buffer_load_dwordx4 v[116:119], v21, s[8:11], s17 offen
    s_add_u32 s17, s17, 16384
    buffer_load_dwordx4 v[120:123], v21, s[8:11], s17 offen
    s_add_u32 s17, s17, 16384
    buffer_load_dwordx4 v[124:127], v21, s[8:11], s17 offen
    s_add_u32 s17, s17, 16384
    s_cmp_lg_u32 s54, 0
    s_cbranch_scc1 ch_nv1
    s_mov_b32 s58, -1
    s_mov_b32 s59, -1
    s_memtime s[60:61]
    s_add_u32 s56, s55, 0
    s_waitcnt lgkmcnt(0)
    s_load_dword s57, s[4:5], s56 glc
    s_waitcnt lgkmcnt(0)
    s_memtime s[62:63]
    s_waitcnt lgkmcnt(0)
    s_sub_u32 s57, s62, s60
    s_min_u32 s58, s58, s57
    s_memtime s[60:61]
    s_add_u32 s56, s55, 8192
    s_waitcnt lgkmcnt(0)
    s_load_dword s57, s[4:5], s56 glc
    s_waitcnt lgkmcnt(0)
    s_memtime s[62:63]
    s_waitcnt lgkmcnt(0)
    s_sub_u32 s57, s62, s60
    s_min_u32 s59, s59, s57
    s_memtime s[60:61]
    s_add_u32 s56, s55, 16384
    s_waitcnt lgkmcnt(0)
    s_load_dword s57, s[4:5], s56 glc
    s_waitcnt lgkmcnt(0)
    s_memtime s[62:63]
    s_waitcnt lgkmcnt(0)
    s_sub_u32 s57, s62, s60
    s_min_u32 s58, s58, s57
    s_memtime s[60:61]
    s_add_u32 s56, s55, 24576
    s_waitcnt lgkmcnt(0)
    s_load_dword s57, s[4:5], s56 glc
    s_waitcnt lgkmcnt(0)
    s_memtime s[62:63]
    s_waitcnt lgkmcnt(0)
    s_sub_u32 s57, s62, s60
    s_min_u32 s59, s59, s57
    s_memtime s[60:61]
    s_add_u32 s56, s55, 32768
    s_waitcnt lgkmcnt(0)
    s_load_dword s57, s[4:5], s56 glc
    s_waitcnt lgkmcnt(0)
    s_memtime s[62:63]
    s_waitcnt lgkmcnt(0)
    s_sub_u32 s57, s62, s60
    s_min_u32 s58, s58, s57
    s_memtime s[60:61]
    s_add_u32 s56, s55, 40960
    s_waitcnt lgkmcnt(0)
    s_load_dword s57, s[4:5], s56 glc
    s_waitcnt lgkmcnt(0)
    s_memtime s[62:63]
    s_waitcnt lgkmcnt(0)
    s_sub_u32 s57, s62, s60
    s_min_u32 s59, s59, s57
    s_memtime s[60:61]
    s_add_u32 s56, s55, 49152
    s_waitcnt lgkmcnt(0)
    s_load_dword s57, s[4:5], s56 glc
    s_waitcnt lgkmcnt(0)
    s_memtime s[62:63]
    s_waitcnt lgkmcnt(0)
    s_sub_u32 s57, s62, s60
    s_min_u32 s58, s58, s57
    s_memtime s[60:61]
    s_add_u32 s56, s55, 57344
    s_waitcnt lgkmcnt(0)
    s_load_dword s57, s[4:5], s56 glc
    s_waitcnt lgkmcnt(0)
    s_memtime s[62:63]
    s_waitcnt lgkmcnt(0)
    s_sub_u32 s57, s62, s60
    s_min_u32 s59, s59, s57
    s_memtime s[60:61]
    s_add_u32 s56, s55, 65536
    s_waitcnt lgkmcnt(0)
    s_load_dword s57, s[4:5], s56 glc
    s_waitcnt lgkmcnt(0)
    s_memtime s[62:63]
    s_waitcnt lgkmcnt(0)
    s_sub_u32 s57, s62, s60
    s_min_u32 s58, s58, s57
    s_memtime s[60:61]
    s_add_u32 s56, s55, 73728
    s_waitcnt lgkmcnt(0)
    s_load_dword s57, s[4:5], s56 glc
    s_waitcnt lgkmcnt(0)
    s_memtime s[62:63]
    s_waitcnt lgkmcnt(0)
    s_sub_u32 s57, s62, s60
    s_min_u32 s59, s59, s57
    s_memtime s[60:61]
    s_add_u32 s56, s55, 81920
    s_waitcnt lgkmcnt(0)
    s_load_dword s57, s[4:5], s56 glc
    s_waitcnt lgkmcnt(0)
    s_memtime s[62:63]
    s_waitcnt lgkmcnt(0)
    s_sub_u32 s57, s62, s60
    s_min_u32 s58, s58, s57
    s_memtime s[60:61]
    s_add_u32 s56, s55, 90112
    s_waitcnt lgkmcnt(0)
    s_load_dword s57, s[4:5], s56 glc
    s_waitcnt lgkmcnt(0)
    s_memtime s[62:63]
    s_waitcnt lgkmcnt(0)
    s_sub_u32 s57, s62, s60
    s_min_u32 s59, s59, s57
    s_memtime s[60:61]
    s_add_u32 s56, s55, 98304
    s_waitcnt lgkmcnt(0)
    s_load_dword s57, s[4:5], s56 glc
    s_waitcnt lgkmcnt(0)
    s_memtime s[62:63]
    s_waitcnt lgkmcnt(0)
    s_sub_u32 s57, s62, s60
    s_min_u32 s58, s58, s57
    s_memtime s[60:61]
    s_add_u32 s56, s55, 106496
    s_waitcnt lgkmcnt(0)
    s_load_dword s57, s[4:5], s56 glc
    s_waitcnt lgkmcnt(0)
    s_memtime s[62:63]
    s_waitcnt lgkmcnt(0)
    s_sub_u32 s57, s62, s60
    s_min_u32 s59, s59, s57
    s_memtime s[60:61]
    s_add_u32 s56, s55, 114688
    s_waitcnt lgkmcnt(0)
    s_load_dword s57, s[4:5], s56 glc
    s_waitcnt lgkmcnt(0)
    s_memtime s[62:63]
    s_waitcnt lgkmcnt(0)
    s_sub_u32 s57, s62, s60
    s_min_u32 s58, s58, s57
    s_memtime s[60:61]
    s_add_u32 s56, s55, 122880
    s_waitcnt lgkmcnt(0)
    s_load_dword s57, s[4:5], s56 glc
    s_waitcnt lgkmcnt(0)
    s_memtime s[62:63]
    s_waitcnt lgkmcnt(0)
    s_sub_u32 s57, s62, s60
    s_min_u32 s59, s59, s57
    s_sub_i32 s57, s58, s59
    s_min_i32 s57, s57, 400
    s_max_i32 s57, s57, -400
    s_add_u32 s57, s57, 16777616
    s_getreg_b32 s56, hwreg(HW_REG_XCC_ID)
    s_and_b32 s56, s56, 0
    v_mov_b32 v2, s57
    s_mov_b64 exec, 1
    buffer_atomic_add v2, off, s[64:67], s56 offset:160 sc1
    s_mov_b64 exec, -1
    s_waitcnt vmcnt(0)
ch_nv1:
    s_lshl_b32 s19, s21, 13
    s_add_u32 s19, s19, 131072
    v_add_u32 v30, s19, v0
    s_waitcnt vmcnt(8)
    ds_read_b64_tr_b16 v[192:193], v24 offset:0
    ds_read_b64_tr_b16 v[194:195], v25 offset:0
    ds_read_b64_tr_b16 v[208:209], v26 offset:0
    ds_read_b64_tr_b16 v[210:211], v27 offset:0
    ds_read_b64_tr_b16 v[224:225], v24 offset:64
    ds_read_b64_tr_b16 v[226:227], v25 offset:64
    ds_read_b64_tr_b16 v[240:241], v26 offset:64
    ds_read_b64_tr_b16 v[242:243], v27 offset:64
    s_waitcnt lgkmcnt(0)
    ds_read_b64_tr_b16 v[196:197], v24 offset:4096
    ds_read_b64_tr_b16 v[198:199], v25 offset:4096
    ds_read_b64_tr_b16 v[212:213], v26 offset:4096
    ds_read_b64_tr_b16 v[214:215], v27 offset:4096
    ds_read_b64_tr_b16 v[228:229], v24 offset:4160
    ds_read_b64_tr_b16 v[230:231], v25 offset:4160
    ds_read_b64_tr_b16 v[244:245], v26 offset:4160
    ds_read_b64_tr_b16 v[246:247], v27 offset:4160
    s_waitcnt lgkmcnt(0)
    s_waitcnt vmcnt(0)
    ds_write_b128 v30, v[96:99] offset:0
    ds_write_b128 v30, v[100:103] offset:1024
    ds_write_b128 v30, v[104:107] offset:2048
    ds_write_b128 v30, v[108:111] offset:3072
    ds_write_b128 v30, v[112:115] offset:4096
    ds_write_b128 v30, v[116:119] offset:5120
    ds_write_b128 v30, v[120:123] offset:6144
    ds_write_b128 v30, v[124:127] offset:7168
    s_waitcnt lgkmcnt(0)
    ds_read_b64_tr_b16 v[200:201], v24 offset:0
    ds_read_b64_tr_b16 v[202:203], v25 offset:0
    ds_read_b64_tr_b16 v[216:217], v26 offset:0
    ds_read_b64_tr_b16 v[218:219], v27 offset:0
    ds_read_b64_tr_b16 v[232:233], v24 offset:64
    ds_read_b64_tr_b16 v[234:235], v25 offset:64
    ds_read_b64_tr_b16 v[248:249], v26 offset:64
    ds_read_b64_tr_b16 v[250:251], v27 offset:64
    s_waitcnt lgkmcnt(0)
    ds_read_b64_tr_b16 v[204:205], v24 offset:4096
    ds_read_b64_tr_b16 v[206:207], v25 offset:4096
    ds_read_b64_tr_b16 v[220:221], v26 offset:4096
    ds_read_b64_tr_b16 v[222:223], v27 offset:4096
    ds_read_b64_tr_b16 v[236:237], v24 offset:4160
    ds_read_b64_tr_b16 v[238:239], v25 offset:4160
    ds_read_b64_tr_b16 v[252:253], v26 offset:4160
    ds_read_b64_tr_b16 v[254:255], v27 offset:4160
    s_waitcnt lgkmcnt(0)
    v_lshrrev_b32 v21, 4, v20
    v_and_b32 v22, 2, v20
    v_cmp_eq_u32 s[56:57], 2, v22
    v_and_b32 v23, 15, v20
    v_lshlrev_b32 v21, 2, v21
    v_mov_b32 v8, 0x44444444
    v_mov_b32 v9, 0xeeeeeeee
    v_cndmask_b32 v166, v8, v9, s[56:57]
    v_mov_b32 v8, 0x3f803f80
    v_mov_b32 v9, 0
    v_mov_b32 v10, 0
    v_mov_b32 v11, 0
    v_mov_b32 v4, 0x3f803f80
    v_mov_b32 v5, 0x3f803f80
    v_mov_b32 v6, 0x3f803f80
    v_mov_b32 v7, 0x3f803f80
    s_mov_b32 s29, 0x3e0293ee
    s_lshl_b32 s27, s13, 2
    s_add_u32 s27, s27, s21
    s_lshl_b32 s28, s12, 7
    s_add_u32 s28, s28, 218112000
    v_add_u32 v163, s42, v0
    s_lshl_b32 s17, s21, 2
    s_add_u32 s17, s17, 15872
    v_mov_b32 v164, s17
    v_mov_b32 v167, 15872
    v_and_b32 v24, 15, v20
    v_and_b32 v25, 1, v24
    v_lshlrev_b32 v25, 4, v25
    v_mov_b32 v184, 0x3f80
    v_lshlrev_b32 v25, v25, v184
    v_lshrrev_b32 v24, 1, v24
    v_cmp_eq_u32 vcc, 0, v24
    s_nop 1
    v_cndmask_b32 v184, 0, v25, vcc
    v_cmp_eq_u32 vcc, 1, v24
    s_nop 1
    v_cndmask_b32 v185, 0, v25, vcc
    v_cmp_eq_u32 vcc, 2, v24
    s_nop 1
    v_cndmask_b32 v186, 0, v25, vcc
    v_cmp_eq_u32 vcc, 3, v24
    s_nop 1
    v_cndmask_b32 v187, 0, v25, vcc
    v_lshrrev_b32 v24, 4, v20
    v_bfe_u32 v25, v20, 2, 2
    v_and_b32 v26, 1, v20
    v_lshl_add_u32 v26, v25, 1, v26
    v_lshlrev_b32 v26, 4, v26
    v_lshl_add_u32 v26, v24, 8, v26
    v_bfe_u32 v27, v20, 1, 1
    v_lshl_add_u32 v26, v27, 2, v26
    s_add_u32 s17, s42, 20480
    v_add_u32 v180, s17, v26
    v_and_b32 v26, 3, v20
    v_lshl_add_u32 v27, v24, 2, v25
    v_lshl_add_u32 v27, v26, 4, v27
    v_lshlrev_b32 v27, 4, v27
    v_add_u32 v181, s42, v27
    v_and_b32 v25, 1, v25
    v_lshl_add_u32 v25, v24, 1, v25
    v_lshl_add_u32 v25, v26, 3, v25
    v_lshlrev_b32 v25, 4, v25
    v_add_u32 v182, s17, v25
    s_bfe_u32 s17, s34, 0x20001
    s_lshr_b32 s30, s34, 3
    s_cmp_eq_u32 s17, s21
    s_cselect_b32 s30, s30, 2
    s_and_b32 s33, s34, 1
    s_lshl_b32 s33, s33, 17
    s_mov_b32 s32, 0
    v_add_u32 v24, 0, v21
    v_cmp_gt_u32 s[44:45], v24, v23
    v_add_u32 v24, 1, v21
    v_cmp_gt_u32 s[46:47], v24, v23
    v_add_u32 v24, 2, v21
    v_cmp_gt_u32 s[48:49], v24, v23
    v_add_u32 v24, 3, v21
    v_cmp_gt_u32 s[50:51], v24, v23
    s_cmp_lg_u32 s3, 4
    s_cbranch_scc1 ch_xcc_skip
    v_lshrrev_b32 v56, 2, v0
    v_add_u32 v56, 128, v56
    v_writelane_b32 v56, 0, 10
    v_mov_b32 v59, 63
    v_mov_b32 v60, 32
    v_writelane_b32 v59, 0, 8
    v_writelane_b32 v60, 0, 8
    v_writelane_b32 v59, 0, 9
    v_writelane_b32 v60, 0, 9
    v_writelane_b32 v59, -1, 10
    s_movk_i32 s17, 128
    v_writelane_b32 v60, s17, 10
    s_mov_b64 exec, 0x70f
ch_xcc:
    buffer_load_dword v57, v56, s[64:67], 0 offen sc1
    s_waitcnt vmcnt(0)
    v_and_b32 v62, v59, v57
    v_cmp_ne_u32 vcc, v62, v60
    v_readlane_b32 s18, v57, 8
    v_readlane_b32 s19, v57, 9
    s_add_u32 s17, s18, s19
    s_lshr_b32 s17, s17, 24
    s_cmp_lg_u32 s17, 32
    s_cbranch_scc1 ch_xcc_w
    s_cbranch_vccz ch_xcc_ok
ch_xcc_w:
    s_sleep 16
    s_sub_u32 s22, s22, 1
    s_cbranch_scc0 ch_xcc
    s_mov_b32 s22, 0
ch_xcc_ok:
    s_getreg_b32 s17, hwreg(HW_REG_XCC_ID)
    s_bitcmp1_b32 s17, 2
    s_cselect_b32 s18, s18, s18
    v_readlane_b32 s17, v57, s12
    s_mov_b64 exec, -1
    s_lshr_b32 s19, s18, 24
    s_mul_i32 s19, s19, 400
    s_and_b32 s18, s18, 0xffffff
    s_cmp_gt_u32 s18, s19
    s_cselect_b32 s18, 8192, 0
    v_mov_b32 v58, 15968
    v_mov_b32 v60, s17
    v_mov_b32 v61, s18
    s_barrier
    ds_write_b64 v58, v[60:61]
    s_waitcnt lgkmcnt(0)
    s_branch ch_xcc_b3
ch_xcc_skip:
    s_barrier
ch_xcc_b3:
    s_barrier
    v_mov_b32 v58, 15968
    ds_read_b64 v[60:61], v58
    v_and_b32 v23, 7, v20
    v_lshlrev_b32 v23, 7, v23
    v_bfe_u32 v24, v20, 3, 1
    v_lshl_add_u32 v23, v24, 17, v23
    v_lshrrev_b32 v24, 4, v20
    v_lshl_add_u32 v23, v24, 24, v23
    s_lshl_b32 s19, s14, 14
    s_lshl_b32 s18, s34, 10
    s_add_u32 s19, s19, s18
    s_and_b32 s18, s21, 1
    s_lshl_b32 s18, s18, 18
    s_add_u32 s19, s19, s18
    s_add_u32 s19, s19, 4456448
    s_waitcnt lgkmcnt(0)
    v_readfirstlane_b32 s17, v61
    s_add_u32 s39, s39, s17
ch_g0:
    buffer_load_dword v57, off, s[4:7], s35 sc1
    s_waitcnt vmcnt(0)
    v_readfirstlane_b32 s17, v57
    s_cmp_ge_u32 s17, 8
    s_cbranch_scc1 ch_g0b
    s_sleep 3
    s_sub_u32 s22, s22, 1
    s_cbranch_scc0 ch_g0
    s_mov_b32 s22, 0
ch_g0b:
    s_add_u32 s23, s41, 37748736
    buffer_load_dwordx4 v[128:131], v0, s[4:7], s23 offen offset:0 sc1
    buffer_load_dwordx4 v[132:135], v0, s[4:7], s23 offen offset:1024 sc1
    buffer_load_dwordx4 v[136:139], v0, s[4:7], s23 offen offset:2048 sc1
    buffer_load_dwordx4 v[140:143], v0, s[4:7], s23 offen offset:3072 sc1
    s_add_u32 s24, s41, 37879808
    buffer_load_dwordx4 v[144:147], v0, s[4:7], s24 offen offset:0 sc1
    buffer_load_dwordx4 v[148:151], v0, s[4:7], s24 offen offset:1024 sc1
    buffer_load_dwordx4 v[152:155], v0, s[4:7], s24 offen offset:2048 sc1
    buffer_load_dwordx4 v[156:159], v0, s[4:7], s24 offen offset:3072 sc1
    s_add_u32 s23, s41, 20971520
    buffer_load_dwordx4 v[96:99], v0, s[4:7], s23 offen offset:0 sc1
    buffer_load_dwordx4 v[100:103], v0, s[4:7], s23 offen offset:1024 sc1
    buffer_load_dwordx4 v[104:107], v0, s[4:7], s23 offen offset:2048 sc1
    buffer_load_dwordx4 v[108:111], v0, s[4:7], s23 offen offset:3072 sc1
    s_add_u32 s24, s41, 21102592
    buffer_load_dwordx4 v[112:115], v0, s[4:7], s24 offen offset:0 sc1
    buffer_load_dwordx4 v[116:119], v0, s[4:7], s24 offen offset:1024 sc1
    buffer_load_dwordx4 v[120:123], v0, s[4:7], s24 offen offset:2048 sc1
    buffer_load_dwordx4 v[124:127], v0, s[4:7], s24 offen offset:3072 sc1
    s_mov_b32 exec_hi, 0xffff
    buffer_load_dword v175, v23, s[4:7], s19 offen sc1
    s_mov_b32 exec_hi, -1
    v_mov_b32 v165, 0
    s_waitcnt vmcnt(1)
    ds_write_b32 v164, v165 offset:16
.p2align 6
aloopL_43:
    s_and_b32 s23, s16, 3
    s_lshl_b32 s23, s23, 18
    s_add_u32 s23, s23, s38
    s_add_u32 s24, s23, 4096
    s_and_b32 s25, s16, 3
    s_lshl_b32 s25, s25, 18
    s_add_u32 s25, s25, s39
    s_add_u32 s26, s16, 2
    s_and_b32 s26, s26, 3
    s_lshl_b32 s26, s26, 18
    s_add_u32 s26, s26, s39
    v_mov_b32 v165, s16
    s_waitcnt vmcnt(8)
    s_and_b32 s31, s16, 1
    s_cmp_lt_u32 s16, 16
    s_cselect_b32 s31, 3, s31
    s_cmp_lg_u32 s31, s30
    s_cbranch_scc1 aloopL_43_nd0
    ds_write_b128 v163, v[128:131] offset:0
    ds_write_b128 v163, v[132:135] offset:1024
    ds_write_b128 v163, v[136:139] offset:2048
    ds_write_b128 v163, v[140:143] offset:3072
    ds_write_b128 v163, v[144:147] offset:4096
    ds_write_b128 v163, v[148:151] offset:5120
    ds_write_b128 v163, v[152:155] offset:6144
    ds_write_b128 v163, v[156:159] offset:7168
aloopL_43_nd0:
    v_mfma_f32_16x16x32_bf16 v[48:51], v[128:131], v[192:195], 0
    v_mfma_f32_16x16x32_bf16 v[52:55], v[128:131], v[208:211], 0
    v_mfma_f32_16x16x32_bf16 v[56:59], v[128:131], v[224:227], 0
    v_mfma_f32_16x16x32_bf16 v[60:63], v[128:131], v[240:243], 0
    v_mfma_f32_16x16x32_bf16 v[64:67], v[144:147], v[192:195], 0
    v_mfma_f32_16x16x32_bf16 v[68:71], v[144:147], v[208:211], 0
    v_mfma_f32_16x16x32_bf16 v[72:75], v[144:147], v[224:227], 0
    v_mfma_f32_16x16x32_bf16 v[76:79], v[144:147], v[240:243], 0
    v_mfma_f32_16x16x32_bf16 v[48:51], v[132:135], v[196:199], v[48:51]
    v_mfma_f32_16x16x32_bf16 v[52:55], v[132:135], v[212:215], v[52:55]
    v_mfma_f32_16x16x32_bf16 v[56:59], v[132:135], v[228:231], v[56:59]
    v_mfma_f32_16x16x32_bf16 v[60:63], v[132:135], v[244:247], v[60:63]
    v_mfma_f32_16x16x32_bf16 v[64:67], v[148:151], v[196:199], v[64:67]
    v_mfma_f32_16x16x32_bf16 v[68:71], v[148:151], v[212:215], v[68:71]
    v_mfma_f32_16x16x32_bf16 v[72:75], v[148:151], v[228:231], v[72:75]
    v_mfma_f32_16x16x32_bf16 v[76:79], v[148:151], v[244:247], v[76:79]
    v_mfma_f32_16x16x32_bf16 v[48:51], v[136:139], v[200:203], v[48:51]
    v_mfma_f32_16x16x32_bf16 v[52:55], v[136:139], v[216:219], v[52:55]
    v_mfma_f32_16x16x32_bf16 v[56:59], v[136:139], v[232:235], v[56:59]
    v_mfma_f32_16x16x32_bf16 v[60:63], v[136:139], v[248:251], v[60:63]
    v_mfma_f32_16x16x32_bf16 v[64:67], v[152:155], v[200:203], v[64:67]
    v_mfma_f32_16x16x32_bf16 v[68:71], v[152:155], v[216:219], v[68:71]
    v_mfma_f32_16x16x32_bf16 v[72:75], v[152:155], v[232:235], v[72:75]
    v_mfma_f32_16x16x32_bf16 v[76:79], v[152:155], v[248:251], v[76:79]
    v_mfma_f32_16x16x32_bf16 v[48:51], v[140:143], v[204:207], v[48:51]
    v_mfma_f32_16x16x32_bf16 v[52:55], v[140:143], v[220:223], v[52:55]
    v_mfma_f32_16x16x32_bf16 v[56:59], v[140:143], v[236:239], v[56:59]
    v_mfma_f32_16x16x32_bf16 v[60:63], v[140:143], v[252:255], v[60:63]
    v_mfma_f32_16x16x32_bf16 v[64:67], v[156:159], v[204:207], v[64:67]
    v_mfma_f32_16x16x32_bf16 v[68:71], v[156:159], v[220:223], v[68:71]
    v_mfma_f32_16x16x32_bf16 v[72:75], v[156:159], v[236:239], v[72:75]
    v_mfma_f32_16x16x32_bf16 v[76:79], v[156:159], v[252:255], v[76:79]
    s_nop 2
    v_cvt_pk_bf16_f32 v80, v48, v49
    v_cvt_pk_bf16_f32 v81, v50, v51
    v_cvt_pk_bf16_f32 v82, v64, v65
    v_cvt_pk_bf16_f32 v83, v66, v67
    v_cvt_pk_bf16_f32 v84, v52, v53
    v_cvt_pk_bf16_f32 v85, v54, v55
    v_cvt_pk_bf16_f32 v86, v68, v69
    v_cvt_pk_bf16_f32 v87, v70, v71
    v_cvt_pk_bf16_f32 v88, v56, v57
    v_cvt_pk_bf16_f32 v89, v58, v59
    v_cvt_pk_bf16_f32 v90, v72, v73
    v_cvt_pk_bf16_f32 v91, v74, v75
    v_cvt_pk_bf16_f32 v92, v60, v61
    v_cvt_pk_bf16_f32 v93, v62, v63
    v_cvt_pk_bf16_f32 v94, v76, v77
    v_cvt_pk_bf16_f32 v95, v78, v79
    v_mov_b32 v24, 0
    v_mov_b32 v25, 0
    v_mov_b32 v26, 0
    v_mov_b32 v27, 0
    v_mov_b32 v28, 0
    v_mov_b32 v29, 0
    v_mov_b32 v30, 0
    v_mov_b32 v31, 0
    v_mov_b32 v32, 0
    v_mov_b32 v33, 0
    v_mov_b32 v34, 0
    v_mov_b32 v35, 0
    v_mov_b32 v36, 0
    v_mov_b32 v37, 0
    v_mov_b32 v38, 0
    v_mov_b32 v39, 0
    s_setprio 2
    s_add_u32 s41, s41, 262144
    s_waitcnt lgkmcnt(0)
    s_barrier
    s_cmp_lg_u32 s31, s30
    s_cbranch_scc1 aloopL_43_nd1
    s_add_u32 m0, s42, 16384
    s_add_u32 s17, s41, s33
    s_add_u32 s17, s17, 3932160
    buffer_load_dwordx4 v0, s[4:7], s17 offen offset:0 sc1 lds
    buffer_load_dwordx4 v0, s[4:7], s17 offen offset:1024 sc1 lds
    buffer_load_dwordx4 v0, s[4:7], s17 offen offset:2048 sc1 lds
    buffer_load_dwordx4 v0, s[4:7], s17 offen offset:3072 sc1 lds
aloopL_43_nd1:
    s_sleep 9
    s_waitcnt lgkmcnt(0)
    buffer_load_dwordx4 v[48:51], v0, s[4:7], s23 offen offset:0 sc1
    buffer_load_dwordx4 v[52:55], v0, s[4:7], s23 offen offset:1024 sc1
    buffer_load_dwordx4 v[56:59], v0, s[4:7], s23 offen offset:2048 sc1
    buffer_load_dwordx4 v[60:63], v0, s[4:7], s23 offen offset:3072 sc1
    s_sleep 2
    buffer_load_dwordx4 v[64:67], v0, s[4:7], s24 offen offset:0 sc1
    buffer_load_dwordx4 v[68:71], v0, s[4:7], s24 offen offset:1024 sc1
    s_waitcnt vmcnt(5)
    v_mfma_f32_16x16x32_bf16 v[12:15], v[96:99], v[48:51], 0
    v_mfma_f32_16x16x32_bf16 v[16:19], v[112:115], v[48:51], 0
    v_max_u32 v3, v48, v50
    v_cmp_eq_u32 vcc, -1, v3
    v_mfma_f32_16x16x32_bf16 v[20:23], v[48:51], v[48:51], 0
    s_cbranch_vccnz aloopL_43_rq_0
    s_waitcnt vmcnt(4)
    v_mfma_f32_16x16x32_bf16 v[12:15], v[100:103], v[52:55], v[12:15]
    v_mfma_f32_16x16x32_bf16 v[16:19], v[116:119], v[52:55], v[16:19]
    v_max_u32 v3, v52, v54
    v_cmp_eq_u32 vcc, -1, v3
    v_mfma_f32_16x16x32_bf16 v[20:23], v[52:55], v[52:55], v[20:23]
    s_cbranch_vccnz aloopL_43_rq_1
    s_waitcnt vmcnt(3)
    v_mfma_f32_16x16x32_bf16 v[12:15], v[104:107], v[56:59], v[12:15]
    v_mfma_f32_16x16x32_bf16 v[16:19], v[120:123], v[56:59], v[16:19]
    v_max_u32 v3, v56, v58
    v_cmp_eq_u32 vcc, -1, v3
    v_mfma_f32_16x16x32_bf16 v[20:23], v[56:59], v[56:59], v[20:23]
    s_cbranch_vccnz aloopL_43_rq_2
    s_waitcnt vmcnt(2)
    v_mfma_f32_16x16x32_bf16 v[12:15], v[108:111], v[60:63], v[12:15]
    v_mfma_f32_16x16x32_bf16 v[16:19], v[124:127], v[60:63], v[16:19]
    v_max_u32 v3, v60, v62
    v_cmp_eq_u32 vcc, -1, v3
    v_mfma_f32_16x16x32_bf16 v[20:23], v[60:63], v[60:63], v[20:23]
    s_cbranch_vccnz aloopL_43_rq_3
aloopL_43_sdone:
    s_nop 1
    ds_write_b32 v164, v165
    s_nop 0
    v_max3_f32 v2, v12, v13, v14
    v_max3_f32 v3, v15, v16, v17
    v_max3_f32 v2, v2, v18, v19
    v_max3_f32 v3, v3, v20, v21
    v_max_f32 v2, v2, v3
    v_mov_b32 v3, v2
    s_nop 1
    v_permlane16_swap_b32 v3, v2
    v_max_f32 v2, v2, v3
    v_mov_b32 v3, v2
    s_waitcnt vmcnt(0)
    v_max3_u32 v188, v64, v66, v68
    v_permlane32_swap_b32 v3, v2
    v_max_f32 v2, v2, v3
    v_max_u32 v188, v188, v70
    v_mul_f32 v2, s29, v2
    v_cmp_eq_u32 vcc, -1, v188
    v_fma_f32 v12, v12, s29, -v2
    v_fma_f32 v13, v13, s29, -v2
    s_cbranch_vccnz aloopL_43_rq_v
aloopL_43_vok:
    v_smfmac_f32_16x16x64_bf16 v[24:27], v[64:67], v[192:199], v166
    v_fma_f32 v14, v14, s29, -v2
    v_exp_f32 v12, v12
    v_smfmac_f32_16x16x64_bf16 v[32:35], v[64:67], v[224:231], v166
    s_add_u32 s17, s41, 37748736
    buffer_load_dwordx4 v[128:131], v0, s[4:7], s17 offen offset:0 sc1
    v_fma_f32 v15, v15, s29, -v2
    v_exp_f32 v13, v13
    v_smfmac_f32_16x16x64_bf16 v[28:31], v[64:67], v[208:215], v166
    buffer_load_dwordx4 v[132:135], v0, s[4:7], s17 offen offset:1024 sc1
    v_fma_f32 v16, v16, s29, -v2
    v_exp_f32 v14, v14
    v_smfmac_f32_16x16x64_bf16 v[36:39], v[64:67], v[240:247], v166
    buffer_load_dwordx4 v[136:139], v0, s[4:7], s17 offen offset:2048 sc1
    v_fma_f32 v17, v17, s29, -v2
    v_exp_f32 v15, v15
    v_smfmac_f32_16x16x64_bf16 v[24:27], v[68:71], v[200:207], v166
    buffer_load_dwordx4 v[140:143], v0, s[4:7], s17 offen offset:3072 sc1
    v_fma_f32 v18, v18, s29, -v2
    v_exp_f32 v16, v16
    v_smfmac_f32_16x16x64_bf16 v[32:35], v[68:71], v[232:239], v166
    s_add_u32 s18, s41, 37879808
    buffer_load_dwordx4 v[144:147], v0, s[4:7], s18 offen offset:0 sc1
    v_fma_f32 v19, v19, s29, -v2
    v_exp_f32 v17, v17
    v_smfmac_f32_16x16x64_bf16 v[28:31], v[68:71], v[216:223], v166
    buffer_load_dwordx4 v[148:151], v0, s[4:7], s18 offen offset:1024 sc1
    v_fma_f32 v20, v20, s29, -v2
    v_exp_f32 v18, v18
    v_smfmac_f32_16x16x64_bf16 v[36:39], v[68:71], v[248:255], v166
    buffer_load_dwordx4 v[152:155], v0, s[4:7], s18 offen offset:2048 sc1
    v_fma_f32 v21, v21, s29, -v2
    v_exp_f32 v19, v19
    buffer_load_dwordx4 v[156:159], v0, s[4:7], s18 offen offset:3072 sc1
    v_exp_f32 v20, v20
    v_exp_f32 v21, v21
    v_cvt_pk_bf16_f32 v12, v12, v13
    v_cvt_pk_bf16_f32 v13, v14, v15
    v_cvt_pk_bf16_f32 v14, v16, v17
    v_cvt_pk_bf16_f32 v15, v18, v19
    v_cvt_pk_bf16_f32 v20, v20, v21
    v_mov_b32 v22, 0
    v_mfma_f32_16x16x32_bf16 v[16:19], v[4:7], v[12:15], 0
    v_mov_b32 v21, v20
    v_mov_b32 v23, 0
    v_cvt_pk_bf16_f32 v40, v24, v25
    v_cvt_pk_bf16_f32 v41, v26, v27
    v_mfma_f32_16x16x32_bf16 v[16:19], v[8:11], v[20:23], v[16:19]
    v_mfma_f32_16x16x32_bf16 v[24:27], v[80:83], v[12:15], 0
    v_cvt_pk_bf16_f32 v44, v32, v33
    v_cvt_pk_bf16_f32 v45, v34, v35
    v_mfma_f32_16x16x32_bf16 v[32:35], v[88:91], v[12:15], 0
    v_cvt_pk_bf16_f32 v42, v28, v29
    v_cvt_pk_bf16_f32 v43, v30, v31
    v_mfma_f32_16x16x32_bf16 v[28:31], v[84:87], v[12:15], 0
    v_cvt_pk_bf16_f32 v46, v36, v37
    v_cvt_pk_bf16_f32 v47, v38, v39
    v_mfma_f32_16x16x32_bf16 v[36:39], v[92:95], v[12:15], 0
aloopL_43_midE:
    s_mov_b64 vcc, s[56:57]
    v_rcp_f32 v3, v16
    v_mfma_f32_16x16x32_bf16 v[24:27], v[40:43], v[20:23], v[24:27]
    v_mfma_f32_16x16x32_bf16 v[32:35], v[44:47], v[20:23], v[32:35]
    v_mfma_f32_16x16x32_bf16 v[28:31], v[42:45], v[20:23], v[28:31]
    v_mfma_f32_16x16x32_bf16 v[36:39], v[46:49], v[20:23], v[36:39]
    v_mov_b32_dpp v3, v3 quad_perm:[2,3,2,3] row_mask:0xf bank_mask:0xf
    s_nop 4
    v_cndmask_b32_dpp v24, v32, v24, vcc quad_perm:[2,3,2,3] row_mask:0xf bank_mask:0xf
    v_cndmask_b32_dpp v25, v33, v25, vcc quad_perm:[2,3,2,3] row_mask:0xf bank_mask:0xf
    v_cndmask_b32_dpp v26, v34, v26, vcc quad_perm:[2,3,2,3] row_mask:0xf bank_mask:0xf
    v_cndmask_b32_dpp v27, v35, v27, vcc quad_perm:[2,3,2,3] row_mask:0xf bank_mask:0xf
    v_cndmask_b32_dpp v28, v36, v28, vcc quad_perm:[2,3,2,3] row_mask:0xf bank_mask:0xf
    v_cndmask_b32_dpp v29, v37, v29, vcc quad_perm:[2,3,2,3] row_mask:0xf bank_mask:0xf
    v_cndmask_b32_dpp v30, v38, v30, vcc quad_perm:[2,3,2,3] row_mask:0xf bank_mask:0xf
    v_cndmask_b32_dpp v31, v39, v31, vcc quad_perm:[2,3,2,3] row_mask:0xf bank_mask:0xf
    v_mul_f32 v24, v24, v3
    v_mul_f32 v25, v25, v3
    v_mul_f32 v26, v26, v3
    v_mul_f32 v27, v27, v3
    v_mul_f32 v28, v28, v3
    v_mul_f32 v29, v29, v3
    v_mul_f32 v30, v30, v3
    v_mul_f32 v31, v31, v3
    v_cvt_pk_bf16_f32 v168, v24, v25
    v_cvt_pk_bf16_f32 v169, v26, v27
    v_cvt_pk_bf16_f32 v170, v28, v29
    v_cvt_pk_bf16_f32 v171, v30, v31
    ds_write_b128 v160, v[168:171]
    s_waitcnt lgkmcnt(0)
    s_barrier
    ds_read_b128 v[172:175], v161
    s_waitcnt lgkmcnt(0)
    v_mfma_f32_16x16x32_bf16 v[24:27], v[184:187], v[172:175], 0
    s_nop 7
    v_cvt_pk_bf16_f32 v168, v24, v25
    v_cvt_pk_bf16_f32 v169, v26, v27
    s_nop 0
    v_permlane16_swap_b32 v168, v170
    v_permlane16_swap_b32 v169, v171
    s_mov_b64 exec, 0xffff
    v_min_u32 v168, -2, v168
    buffer_store_dwordx4 v[168:171], v1, s[4:7], s25 offen sc1
    s_setprio 0
    buffer_store_dwordx4 v[176:179], v1, s[4:7], s26 offen sc1
    s_mov_b64 exec, -1
    s_branch pg_44
    s_cmp_lg_u32 s27, 0
    s_cbranch_scc1 pg_44
    s_sub_u32 s21, s16, 1
    s_cbranch_scc1 pg_44
    s_sub_u32 s17, s21, 1
    s_and_b32 s17, s17, 3
    s_cmp_ge_u32 s16, 58
    s_cselect_b32 s17, 0, s17
    s_cmp_lg_u32 s17, 0
    s_cbranch_scc1 pg_44
    v_mov_b32 v3, s21
    s_mov_b64 exec, 1
    buffer_store_dword v3, off, s[4:7], s28 sc1
    s_mov_b64 exec, -1
pg_44:
    s_cmp_lg_u32 s31, s30
    s_cbranch_scc1 aloopL_43_nd2
    ds_read_b128 v[24:27], v163 offset:16384
    ds_read_b128 v[28:31], v163 offset:17408
    ds_read_b128 v[32:35], v163 offset:18432
    ds_read_b128 v[36:39], v163 offset:19456
    ds_write_b32 v180, v64 offset:0
    ds_write_b32 v180, v65 offset:8
    ds_write_b32 v180, v66 offset:128
    ds_write_b32 v180, v67 offset:136
    ds_write_b32 v180, v68 offset:1024
    ds_write_b32 v180, v69 offset:1032
    ds_write_b32 v180, v70 offset:1152
    ds_write_b32 v180, v71 offset:1160
    s_mov_b32 s32, 1
    s_waitcnt lgkmcnt(11)
    v_mfma_f32_16x16x32_bf16 v[12:15], v[96:99], v[24:27], 0
    v_mfma_f32_16x16x32_bf16 v[16:19], v[112:115], v[24:27], 0
    v_mfma_f32_16x16x32_bf16 v[20:23], v[48:51], v[24:27], 0
    s_waitcnt lgkmcnt(10)
    v_mfma_f32_16x16x32_bf16 v[12:15], v[100:103], v[28:31], v[12:15]
    v_mfma_f32_16x16x32_bf16 v[16:19], v[116:119], v[28:31], v[16:19]
    v_mfma_f32_16x16x32_bf16 v[20:23], v[52:55], v[28:31], v[20:23]
    s_waitcnt lgkmcnt(9)
    v_mfma_f32_16x16x32_bf16 v[12:15], v[104:107], v[32:35], v[12:15]
    v_mfma_f32_16x16x32_bf16 v[16:19], v[120:123], v[32:35], v[16:19]
    v_mfma_f32_16x16x32_bf16 v[20:23], v[56:59], v[32:35], v[20:23]
    s_waitcnt lgkmcnt(8)
    v_mfma_f32_16x16x32_bf16 v[12:15], v[108:111], v[36:39], v[12:15]
    v_mfma_f32_16x16x32_bf16 v[16:19], v[124:127], v[36:39], v[16:19]
    v_mfma_f32_16x16x32_bf16 v[20:23], v[60:63], v[36:39], v[20:23]
    s_waitcnt lgkmcnt(0)
    s_nop 3
    s_nop 3
    s_cmp_eq_u32 s32, 0
    s_cbranch_scc1 aloopL_43_p2e
    s_mov_b32 s32, 0
    ds_read_b64_tr_b16 v[96:97], v181 offset:0
    ds_read_b64_tr_b16 v[98:99], v181 offset:4096
    ds_read_b64_tr_b16 v[64:65], v182 offset:0
    ds_read_b64_tr_b16 v[100:101], v181 offset:8
    ds_read_b64_tr_b16 v[102:103], v181 offset:4104
    ds_read_b64_tr_b16 v[66:67], v182 offset:8
    ds_read_b64_tr_b16 v[104:105], v181 offset:1024
    ds_read_b64_tr_b16 v[106:107], v181 offset:5120
    ds_read_b64_tr_b16 v[68:69], v182 offset:512
    ds_read_b64_tr_b16 v[108:109], v181 offset:1032
    ds_read_b64_tr_b16 v[110:111], v181 offset:5128
    ds_read_b64_tr_b16 v[70:71], v182 offset:520
    ds_read_b64_tr_b16 v[112:113], v181 offset:2048
    ds_read_b64_tr_b16 v[114:115], v181 offset:6144
    ds_read_b64_tr_b16 v[72:73], v182 offset:1024
    ds_read_b64_tr_b16 v[116:117], v181 offset:2056
    ds_read_b64_tr_b16 v[118:119], v181 offset:6152
    ds_read_b64_tr_b16 v[74:75], v182 offset:1032
    ds_read_b64_tr_b16 v[120:121], v181 offset:3072
    ds_read_b64_tr_b16 v[122:123], v181 offset:7168
    ds_read_b64_tr_b16 v[76:77], v182 offset:1536
    ds_read_b64_tr_b16 v[124:125], v181 offset:3080
    ds_read_b64_tr_b16 v[126:127], v181 offset:7176
    ds_read_b64_tr_b16 v[78:79], v182 offset:1544
    v_mov_b32 v188, 0xff61b1e6
    s_cmp_eq_u32 s33, 0
    s_cselect_b64 vcc, s[44:45], 0
    v_cndmask_b32 v12, v12, v188, vcc
    s_cselect_b64 vcc, -1, s[44:45]
    v_cndmask_b32 v16, v16, v188, vcc
    s_cselect_b64 vcc, s[46:47], 0
    v_cndmask_b32 v13, v13, v188, vcc
    s_cselect_b64 vcc, -1, s[46:47]
    v_cndmask_b32 v17, v17, v188, vcc
    s_cselect_b64 vcc, s[48:49], 0
    v_cndmask_b32 v14, v14, v188, vcc
    s_cselect_b64 vcc, -1, s[48:49]
    v_cndmask_b32 v18, v18, v188, vcc
    s_cselect_b64 vcc, s[50:51], 0
    v_cndmask_b32 v15, v15, v188, vcc
    s_cselect_b64 vcc, -1, s[50:51]
    v_cndmask_b32 v19, v19, v188, vcc
    v_max3_f32 v2, v12, v13, v14
    v_max3_f32 v3, v15, v16, v17
    v_max3_f32 v2, v2, v18, v19
    v_max3_f32 v3, v3, v20, v21
    v_max_f32 v2, v2, v3
    v_mov_b32 v3, v2
    s_nop 1
    v_permlane16_swap_b32 v3, v2
    v_max_f32 v2, v2, v3
    v_mov_b32 v3, v2
    s_nop 1
    v_permlane32_swap_b32 v3, v2
    v_max_f32 v2, v2, v3
    v_mul_f32 v2, s29, v2
    v_fma_f32 v12, v12, s29, -v2
    v_fma_f32 v13, v13, s29, -v2
    v_fma_f32 v14, v14, s29, -v2
    v_exp_f32 v12, v12
    v_fma_f32 v15, v15, s29, -v2
    v_exp_f32 v13, v13
    v_fma_f32 v16, v16, s29, -v2
    v_exp_f32 v14, v14
    v_fma_f32 v17, v17, s29, -v2
    v_exp_f32 v15, v15
    v_fma_f32 v18, v18, s29, -v2
    v_exp_f32 v16, v16
    v_fma_f32 v19, v19, s29, -v2
    v_exp_f32 v17, v17
    v_fma_f32 v20, v20, s29, -v2
    v_exp_f32 v18, v18
    v_fma_f32 v21, v21, s29, -v2
    v_exp_f32 v19, v19
    v_exp_f32 v20, v20
    v_exp_f32 v21, v21
    v_cvt_pk_bf16_f32 v12, v12, v13
    v_cvt_pk_bf16_f32 v13, v14, v15
    v_cvt_pk_bf16_f32 v14, v16, v17
    v_cvt_pk_bf16_f32 v15, v18, v19
    v_cvt_pk_bf16_f32 v20, v20, v21
    v_mov_b32 v22, 0
    v_mov_b32 v21, 0
    v_mov_b32 v23, 0
    s_waitcnt lgkmcnt(0)
    s_nop 0
    v_mfma_f32_16x16x32_bf16 v[16:19], v[4:7], v[12:15], 0
    v_mfma_f32_16x16x32_bf16 v[16:19], v[4:7], v[20:23], v[16:19]
    v_mfma_f32_16x16x32_bf16 v[24:27], v[96:99], v[12:15], 0
    v_mfma_f32_16x16x32_bf16 v[24:27], v[64:67], v[20:23], v[24:27]
    v_mfma_f32_16x16x32_bf16 v[28:31], v[100:103], v[12:15], 0
    v_mfma_f32_16x16x32_bf16 v[28:31], v[66:69], v[20:23], v[28:31]
    v_mfma_f32_16x16x32_bf16 v[32:35], v[104:107], v[12:15], 0
    v_mfma_f32_16x16x32_bf16 v[32:35], v[68:71], v[20:23], v[32:35]
    v_mfma_f32_16x16x32_bf16 v[36:39], v[108:111], v[12:15], 0
    v_mfma_f32_16x16x32_bf16 v[36:39], v[70:73], v[20:23], v[36:39]
    v_mfma_f32_16x16x32_bf16 v[48:51], v[112:115], v[12:15], 0
    v_mfma_f32_16x16x32_bf16 v[48:51], v[72:75], v[20:23], v[48:51]
    v_mfma_f32_16x16x32_bf16 v[52:55], v[116:119], v[12:15], 0
    v_mfma_f32_16x16x32_bf16 v[52:55], v[74:77], v[20:23], v[52:55]
    v_mfma_f32_16x16x32_bf16 v[56:59], v[120:123], v[12:15], 0
    v_mfma_f32_16x16x32_bf16 v[56:59], v[76:79], v[20:23], v[56:59]
    v_mfma_f32_16x16x32_bf16 v[60:63], v[124:127], v[12:15], 0
    v_mfma_f32_16x16x32_bf16 v[60:63], v[78:81], v[20:23], v[60:63]
    v_rcp_f32 v3, v16
    s_nop 0
    v_mul_f32 v24, v24, v3
    v_mul_f32 v25, v25, v3
    v_mul_f32 v26, v26, v3
    v_mul_f32 v27, v27, v3
    v_mul_f32 v28, v28, v3
    v_mul_f32 v29, v29, v3
    v_mul_f32 v30, v30, v3
    v_mul_f32 v31, v31, v3
    v_cvt_pk_bf16_f32 v24, v24, v25
    v_cvt_pk_bf16_f32 v25, v26, v27
    v_cvt_pk_bf16_f32 v26, v28, v29
    v_cvt_pk_bf16_f32 v27, v30, v31
    ds_write_b128 v0, v[24:27] offset:32768
    v_mul_f32 v32, v32, v3
    v_mul_f32 v33, v33, v3
    v_mul_f32 v34, v34, v3
    v_mul_f32 v35, v35, v3
    v_mul_f32 v36, v36, v3
    v_mul_f32 v37, v37, v3
    v_mul_f32 v38, v38, v3
    v_mul_f32 v39, v39, v3
    v_cvt_pk_bf16_f32 v32, v32, v33
    v_cvt_pk_bf16_f32 v33, v34, v35
    v_cvt_pk_bf16_f32 v34, v36, v37
    v_cvt_pk_bf16_f32 v35, v38, v39
    ds_write_b128 v0, v[32:35] offset:33792
    v_mul_f32 v48, v48, v3
    v_mul_f32 v49, v49, v3
    v_mul_f32 v50, v50, v3
    v_mul_f32 v51, v51, v3
    v_mul_f32 v52, v52, v3
    v_mul_f32 v53, v53, v3
    v_mul_f32 v54, v54, v3
    v_mul_f32 v55, v55, v3
    v_cvt_pk_bf16_f32 v48, v48, v49
    v_cvt_pk_bf16_f32 v49, v50, v51
    v_cvt_pk_bf16_f32 v50, v52, v53
    v_cvt_pk_bf16_f32 v51, v54, v55
    ds_write_b128 v0, v[48:51] offset:34816
    v_mul_f32 v56, v56, v3
    v_mul_f32 v57, v57, v3
    v_mul_f32 v58, v58, v3
    v_mul_f32 v59, v59, v3
    v_mul_f32 v60, v60, v3
    v_mul_f32 v61, v61, v3
    v_mul_f32 v62, v62, v3
    v_mul_f32 v63, v63, v3
    v_cvt_pk_bf16_f32 v56, v56, v57
    v_cvt_pk_bf16_f32 v57, v58, v59
    v_cvt_pk_bf16_f32 v58, v60, v61
    v_cvt_pk_bf16_f32 v59, v62, v63
    ds_write_b128 v0, v[56:59] offset:35840
aloopL_43_p2e:
    s_nop 3
aloopL_43_nd2:
    s_add_u32 s19, s41, 20971520
    buffer_load_dwordx4 v[96:99], v0, s[4:7], s19 offen offset:0 sc1
    buffer_load_dwordx4 v[100:103], v0, s[4:7], s19 offen offset:1024 sc1
    buffer_load_dwordx4 v[104:107], v0, s[4:7], s19 offen offset:2048 sc1
    buffer_load_dwordx4 v[108:111], v0, s[4:7], s19 offen offset:3072 sc1
    s_add_u32 s20, s41, 21102592
    buffer_load_dwordx4 v[112:115], v0, s[4:7], s20 offen offset:0 sc1
    buffer_load_dwordx4 v[116:119], v0, s[4:7], s20 offen offset:1024 sc1
    buffer_load_dwordx4 v[120:123], v0, s[4:7], s20 offen offset:2048 sc1
    buffer_load_dwordx4 v[124:127], v0, s[4:7], s20 offen offset:3072 sc1
    s_add_u32 s16, s16, 1
    s_cmp_lt_u32 s16, 48
    s_cbranch_scc1 aloopL_43
    s_waitcnt vmcnt(0)
    ds_write_b128 v163, v[128:131] offset:8192
    ds_write_b128 v163, v[132:135] offset:9216
    ds_write_b128 v163, v[136:139] offset:10240
    ds_write_b128 v163, v[140:143] offset:11264
    ds_write_b128 v163, v[144:147] offset:12288
    ds_write_b128 v163, v[148:151] offset:13312
    ds_write_b128 v163, v[152:155] offset:14336
    ds_write_b128 v163, v[156:159] offset:15360
    s_waitcnt lgkmcnt(0)
    s_branch aloopH_42
aloopL_43_rq_0:
    s_sub_u32 s22, s22, 1
    s_cbranch_scc1 aloopL_43_rq_0_g
    buffer_load_dwordx4 v[48:51], v0, s[4:7], s23 offen offset:0 sc1
    buffer_load_dwordx4 v[52:55], v0, s[4:7], s23 offen offset:1024 sc1
    buffer_load_dwordx4 v[56:59], v0, s[4:7], s23 offen offset:2048 sc1
    buffer_load_dwordx4 v[60:63], v0, s[4:7], s23 offen offset:3072 sc1
    buffer_load_dwordx4 v[64:67], v0, s[4:7], s24 offen offset:0 sc1
    buffer_load_dwordx4 v[68:71], v0, s[4:7], s24 offen offset:1024 sc1
    s_waitcnt vmcnt(5)
    v_max_u32 v3, v48, v50
    v_cmp_eq_u32 vcc, -1, v3
    s_cbranch_vccnz aloopL_43_rq_0
    s_branch aloopL_43_again
aloopL_43_rq_0_g:
    s_mov_b32 s22, 0
    s_waitcnt vmcnt(0)
    s_branch aloopL_43_nochk
aloopL_43_rq_1:
    s_sub_u32 s22, s22, 1
    s_cbranch_scc1 aloopL_43_rq_1_g
    buffer_load_dwordx4 v[52:55], v0, s[4:7], s23 offen offset:1024 sc1
    buffer_load_dwordx4 v[56:59], v0, s[4:7], s23 offen offset:2048 sc1
    buffer_load_dwordx4 v[60:63], v0, s[4:7], s23 offen offset:3072 sc1
    buffer_load_dwordx4 v[64:67], v0, s[4:7], s24 offen offset:0 sc1
    buffer_load_dwordx4 v[68:71], v0, s[4:7], s24 offen offset:1024 sc1
    s_waitcnt vmcnt(4)
    v_max_u32 v3, v52, v54
    v_cmp_eq_u32 vcc, -1, v3
    s_cbranch_vccnz aloopL_43_rq_1
    s_branch aloopL_43_again
aloopL_43_rq_1_g:
    s_mov_b32 s22, 0
    s_waitcnt vmcnt(0)
    s_branch aloopL_43_nochk
aloopL_43_rq_2:
    s_sub_u32 s22, s22, 1
    s_cbranch_scc1 aloopL_43_rq_2_g
    buffer_load_dwordx4 v[56:59], v0, s[4:7], s23 offen offset:2048 sc1
    buffer_load_dwordx4 v[60:63], v0, s[4:7], s23 offen offset:3072 sc1
    buffer_load_dwordx4 v[64:67], v0, s[4:7], s24 offen offset:0 sc1
    buffer_load_dwordx4 v[68:71], v0, s[4:7], s24 offen offset:1024 sc1
    s_waitcnt vmcnt(3)
    v_max_u32 v3, v56, v58
    v_cmp_eq_u32 vcc, -1, v3
    s_cbranch_vccnz aloopL_43_rq_2
    s_branch aloopL_43_again
aloopL_43_rq_2_g:
    s_mov_b32 s22, 0
    s_waitcnt vmcnt(0)
    s_branch aloopL_43_nochk
aloopL_43_rq_3:
    s_sub_u32 s22, s22, 1
    s_cbranch_scc1 aloopL_43_rq_3_g
    buffer_load_dwordx4 v[60:63], v0, s[4:7], s23 offen offset:3072 sc1
    buffer_load_dwordx4 v[64:67], v0, s[4:7], s24 offen offset:0 sc1
    buffer_load_dwordx4 v[68:71], v0, s[4:7], s24 offen offset:1024 sc1
    s_waitcnt vmcnt(2)
    v_max_u32 v3, v60, v62
    v_cmp_eq_u32 vcc, -1, v3
    s_cbranch_vccnz aloopL_43_rq_3
    s_branch aloopL_43_again
aloopL_43_rq_3_g:
    s_mov_b32 s22, 0
    s_waitcnt vmcnt(0)
    s_branch aloopL_43_nochk
aloopL_43_again:
    s_waitcnt vmcnt(5)
    v_mfma_f32_16x16x32_bf16 v[12:15], v[96:99], v[48:51], 0
    v_mfma_f32_16x16x32_bf16 v[16:19], v[112:115], v[48:51], 0
    v_max_u32 v3, v48, v50
    v_cmp_eq_u32 vcc, -1, v3
    v_mfma_f32_16x16x32_bf16 v[20:23], v[48:51], v[48:51], 0
    s_cbranch_vccnz aloopL_43_rq_0
    s_waitcnt vmcnt(4)
    v_mfma_f32_16x16x32_bf16 v[12:15], v[100:103], v[52:55], v[12:15]
    v_mfma_f32_16x16x32_bf16 v[16:19], v[116:119], v[52:55], v[16:19]
    v_max_u32 v3, v52, v54
    v_cmp_eq_u32 vcc, -1, v3
    v_mfma_f32_16x16x32_bf16 v[20:23], v[52:55], v[52:55], v[20:23]
    s_cbranch_vccnz aloopL_43_rq_1
    s_waitcnt vmcnt(3)
    v_mfma_f32_16x16x32_bf16 v[12:15], v[104:107], v[56:59], v[12:15]
    v_mfma_f32_16x16x32_bf16 v[16:19], v[120:123], v[56:59], v[16:19]
    v_max_u32 v3, v56, v58
    v_cmp_eq_u32 vcc, -1, v3
    v_mfma_f32_16x16x32_bf16 v[20:23], v[56:59], v[56:59], v[20:23]
    s_cbranch_vccnz aloopL_43_rq_2
    s_waitcnt vmcnt(2)
    v_mfma_f32_16x16x32_bf16 v[12:15], v[108:111], v[60:63], v[12:15]
    v_mfma_f32_16x16x32_bf16 v[16:19], v[124:127], v[60:63], v[16:19]
    v_max_u32 v3, v60, v62
    v_cmp_eq_u32 vcc, -1, v3
    v_mfma_f32_16x16x32_bf16 v[20:23], v[60:63], v[60:63], v[20:23]
    s_cbranch_vccnz aloopL_43_rq_3
    s_branch aloopL_43_sdone
aloopL_43_rq_v:
    s_sub_u32 s22, s22, 1
    s_cbranch_scc1 aloopL_43_rq_vg
    buffer_load_dwordx4 v[64:67], v0, s[4:7], s24 offen offset:0 sc1
    buffer_load_dwordx4 v[68:71], v0, s[4:7], s24 offen offset:1024 sc1
    s_waitcnt vmcnt(0)
    v_max3_u32 v188, v64, v66, v68
    v_max_u32 v188, v188, v70
    v_cmp_eq_u32 vcc, -1, v188
    s_cbranch_vccnz aloopL_43_rq_v
    s_branch aloopL_43_vok
aloopL_43_rq_vg:
    s_mov_b32 s22, 0
    s_branch aloopL_43_vok
aloopL_43_nochk:
    v_mfma_f32_16x16x32_bf16 v[12:15], v[96:99], v[48:51], 0
    v_mfma_f32_16x16x32_bf16 v[16:19], v[112:115], v[48:51], 0
    v_mfma_f32_16x16x32_bf16 v[20:23], v[48:51], v[48:51], 0
    v_mfma_f32_16x16x32_bf16 v[12:15], v[100:103], v[52:55], v[12:15]
    v_mfma_f32_16x16x32_bf16 v[16:19], v[116:119], v[52:55], v[16:19]
    v_mfma_f32_16x16x32_bf16 v[20:23], v[52:55], v[52:55], v[20:23]
    v_mfma_f32_16x16x32_bf16 v[12:15], v[104:107], v[56:59], v[12:15]
    v_mfma_f32_16x16x32_bf16 v[16:19], v[120:123], v[56:59], v[16:19]
    v_mfma_f32_16x16x32_bf16 v[20:23], v[56:59], v[56:59], v[20:23]
    v_mfma_f32_16x16x32_bf16 v[12:15], v[108:111], v[60:63], v[12:15]
    v_mfma_f32_16x16x32_bf16 v[16:19], v[124:127], v[60:63], v[16:19]
    v_mfma_f32_16x16x32_bf16 v[20:23], v[60:63], v[60:63], v[20:23]
    s_nop 1
    s_branch aloopL_43_sdone
ct_aH:
.p2align 6
aloopH_42:
    s_and_b32 s23, s16, 3
    s_lshl_b32 s23, s23, 18
    s_add_u32 s23, s23, s38
    s_add_u32 s24, s23, 4096
    s_and_b32 s25, s16, 3
    s_lshl_b32 s25, s25, 18
    s_add_u32 s25, s25, s39
    s_add_u32 s26, s16, 2
    s_and_b32 s26, s26, 3
    s_lshl_b32 s26, s26, 18
    s_add_u32 s26, s26, s39
    v_mov_b32 v165, s16
aloopH_42_wkv:
    ds_read_b32 v188, v164 offset:16
    s_waitcnt lgkmcnt(0)
    v_readfirstlane_b32 s19, v188
    s_cmp_ge_i32 s19, s16
    s_cbranch_scc1 aloopH_42_wkvok
    s_sleep 1
    s_branch aloopH_42_wkv
aloopH_42_wkvok:
    ds_read_b128 v[128:131], v163 offset:8192
    ds_read_b128 v[144:147], v163 offset:12288
    ds_read_b128 v[132:135], v163 offset:9216
    ds_read_b128 v[148:151], v163 offset:13312
    ds_read_b128 v[136:139], v163 offset:10240
    ds_read_b128 v[152:155], v163 offset:14336
    ds_read_b128 v[140:143], v163 offset:11264
    ds_read_b128 v[156:159], v163 offset:15360
    s_waitcnt lgkmcnt(6)
    v_mfma_f32_16x16x32_bf16 v[48:51], v[128:131], v[192:195], 0
    v_mfma_f32_16x16x32_bf16 v[52:55], v[128:131], v[208:211], 0
    v_mfma_f32_16x16x32_bf16 v[56:59], v[128:131], v[224:227], 0
    v_mfma_f32_16x16x32_bf16 v[60:63], v[128:131], v[240:243], 0
    v_mfma_f32_16x16x32_bf16 v[64:67], v[144:147], v[192:195], 0
    v_mfma_f32_16x16x32_bf16 v[68:71], v[144:147], v[208:211], 0
    v_mfma_f32_16x16x32_bf16 v[72:75], v[144:147], v[224:227], 0
    v_mfma_f32_16x16x32_bf16 v[76:79], v[144:147], v[240:243], 0
    s_setprio 2
aloopH_42_wm:
    ds_read_b32 v188, v164 offset:32
    s_waitcnt lgkmcnt(0)
    v_readfirstlane_b32 s19, v188
    s_cmp_ge_i32 s19, s16
    s_cbranch_scc1 aloopH_42_wmok
    s_sleep 1
    s_branch aloopH_42_wm
aloopH_42_wmok:
    s_add_u32 m0, s42, 16384
    s_add_u32 s17, s41, 4194304
    buffer_load_dwordx4 v0, s[4:7], s17 offen offset:0 sc1 lds
    buffer_load_dwordx4 v0, s[4:7], s17 offen offset:1024 sc1 lds
    buffer_load_dwordx4 v0, s[4:7], s17 offen offset:2048 sc1 lds
    buffer_load_dwordx4 v0, s[4:7], s17 offen offset:3072 sc1 lds
    s_add_u32 m0, s42, 20480
    s_add_u32 s17, s41, 4325376
    buffer_load_dwordx4 v0, s[4:7], s17 offen offset:0 sc1 lds
    buffer_load_dwordx4 v0, s[4:7], s17 offen offset:1024 sc1 lds
    buffer_load_dwordx4 v0, s[4:7], s17 offen offset:2048 sc1 lds
    buffer_load_dwordx4 v0, s[4:7], s17 offen offset:3072 sc1 lds
    s_add_u32 s41, s41, 262144
    s_barrier
    s_waitcnt lgkmcnt(4)
    v_mfma_f32_16x16x32_bf16 v[48:51], v[132:135], v[196:199], v[48:51]
    v_mfma_f32_16x16x32_bf16 v[52:55], v[132:135], v[212:215], v[52:55]
    v_mfma_f32_16x16x32_bf16 v[56:59], v[132:135], v[228:231], v[56:59]
    v_mfma_f32_16x16x32_bf16 v[60:63], v[132:135], v[244:247], v[60:63]
    v_mfma_f32_16x16x32_bf16 v[64:67], v[148:151], v[196:199], v[64:67]
    v_mfma_f32_16x16x32_bf16 v[68:71], v[148:151], v[212:215], v[68:71]
    v_mfma_f32_16x16x32_bf16 v[72:75], v[148:151], v[228:231], v[72:75]
    v_mfma_f32_16x16x32_bf16 v[76:79], v[148:151], v[244:247], v[76:79]
    s_waitcnt lgkmcnt(2)
    v_mfma_f32_16x16x32_bf16 v[48:51], v[136:139], v[200:203], v[48:51]
    v_mfma_f32_16x16x32_bf16 v[52:55], v[136:139], v[216:219], v[52:55]
    v_mfma_f32_16x16x32_bf16 v[56:59], v[136:139], v[232:235], v[56:59]
    v_mfma_f32_16x16x32_bf16 v[60:63], v[136:139], v[248:251], v[60:63]
    v_mfma_f32_16x16x32_bf16 v[64:67], v[152:155], v[200:203], v[64:67]
    v_mfma_f32_16x16x32_bf16 v[68:71], v[152:155], v[216:219], v[68:71]
    v_mfma_f32_16x16x32_bf16 v[72:75], v[152:155], v[232:235], v[72:75]
    v_mfma_f32_16x16x32_bf16 v[76:79], v[152:155], v[248:251], v[76:79]
    s_waitcnt lgkmcnt(0)
    v_mfma_f32_16x16x32_bf16 v[48:51], v[140:143], v[204:207], v[48:51]
    v_mfma_f32_16x16x32_bf16 v[52:55], v[140:143], v[220:223], v[52:55]
    v_mfma_f32_16x16x32_bf16 v[56:59], v[140:143], v[236:239], v[56:59]
    v_mfma_f32_16x16x32_bf16 v[60:63], v[140:143], v[252:255], v[60:63]
    v_mfma_f32_16x16x32_bf16 v[64:67], v[156:159], v[204:207], v[64:67]
    v_mfma_f32_16x16x32_bf16 v[68:71], v[156:159], v[220:223], v[68:71]
    v_mfma_f32_16x16x32_bf16 v[72:75], v[156:159], v[236:239], v[72:75]
    v_mfma_f32_16x16x32_bf16 v[76:79], v[156:159], v[252:255], v[76:79]
    s_nop 2
    v_cvt_pk_bf16_f32 v80, v48, v49
    v_cvt_pk_bf16_f32 v81, v50, v51
    v_cvt_pk_bf16_f32 v82, v64, v65
    v_cvt_pk_bf16_f32 v83, v66, v67
    v_cvt_pk_bf16_f32 v84, v52, v53
    v_cvt_pk_bf16_f32 v85, v54, v55
    v_cvt_pk_bf16_f32 v86, v68, v69
    v_cvt_pk_bf16_f32 v87, v70, v71
    v_cvt_pk_bf16_f32 v88, v56, v57
    v_cvt_pk_bf16_f32 v89, v58, v59
    v_cvt_pk_bf16_f32 v90, v72, v73
    v_cvt_pk_bf16_f32 v91, v74, v75
    v_cvt_pk_bf16_f32 v92, v60, v61
    v_cvt_pk_bf16_f32 v93, v62, v63
    v_cvt_pk_bf16_f32 v94, v76, v77
    v_cvt_pk_bf16_f32 v95, v78, v79
    v_mov_b32 v24, 0
    v_mov_b32 v25, 0
    v_mov_b32 v26, 0
    v_mov_b32 v27, 0
    v_mov_b32 v28, 0
    v_mov_b32 v29, 0
    v_mov_b32 v30, 0
    v_mov_b32 v31, 0
    v_mov_b32 v32, 0
    v_mov_b32 v33, 0
    v_mov_b32 v34, 0
    v_mov_b32 v35, 0
    v_mov_b32 v36, 0
    v_mov_b32 v37, 0
    v_mov_b32 v38, 0
    v_mov_b32 v39, 0
    s_waitcnt lgkmcnt(0)
    buffer_load_dwordx4 v[48:51], v0, s[4:7], s23 offen offset:0 sc1
    buffer_load_dwordx4 v[52:55], v0, s[4:7], s23 offen offset:1024 sc1
    buffer_load_dwordx4 v[56:59], v0, s[4:7], s23 offen offset:2048 sc1
    buffer_load_dwordx4 v[60:63], v0, s[4:7], s23 offen offset:3072 sc1
    s_sleep 2
    buffer_load_dwordx4 v[64:67], v0, s[4:7], s24 offen offset:0 sc1
    buffer_load_dwordx4 v[68:71], v0, s[4:7], s24 offen offset:1024 sc1
    s_waitcnt vmcnt(5)
    v_mfma_f32_16x16x32_bf16 v[12:15], v[96:99], v[48:51], 0
    v_mfma_f32_16x16x32_bf16 v[16:19], v[112:115], v[48:51], 0
    v_max_u32 v3, v48, v50
    v_cmp_eq_u32 vcc, -1, v3
    v_mfma_f32_16x16x32_bf16 v[20:23], v[48:51], v[48:51], 0
    s_cbranch_vccnz aloopH_42_rq_0
    s_waitcnt vmcnt(4)
    v_mfma_f32_16x16x32_bf16 v[12:15], v[100:103], v[52:55], v[12:15]
    v_mfma_f32_16x16x32_bf16 v[16:19], v[116:119], v[52:55], v[16:19]
    v_max_u32 v3, v52, v54
    v_cmp_eq_u32 vcc, -1, v3
    v_mfma_f32_16x16x32_bf16 v[20:23], v[52:55], v[52:55], v[20:23]
    s_cbranch_vccnz aloopH_42_rq_1
    s_waitcnt vmcnt(3)
    v_mfma_f32_16x16x32_bf16 v[12:15], v[104:107], v[56:59], v[12:15]
    v_mfma_f32_16x16x32_bf16 v[16:19], v[120:123], v[56:59], v[16:19]
    v_max_u32 v3, v56, v58
    v_cmp_eq_u32 vcc, -1, v3
    v_mfma_f32_16x16x32_bf16 v[20:23], v[56:59], v[56:59], v[20:23]
    s_cbranch_vccnz aloopH_42_rq_2
    s_waitcnt vmcnt(2)
    v_mfma_f32_16x16x32_bf16 v[12:15], v[108:111], v[60:63], v[12:15]
    v_mfma_f32_16x16x32_bf16 v[16:19], v[124:127], v[60:63], v[16:19]
    v_max_u32 v3, v60, v62
    v_cmp_eq_u32 vcc, -1, v3
    v_mfma_f32_16x16x32_bf16 v[20:23], v[60:63], v[60:63], v[20:23]
    s_cbranch_vccnz aloopH_42_rq_3
aloopH_42_sdone:
    s_cmp_eq_u32 s16, 63
    s_cbranch_scc1 aloopH_42_lsk
    ds_write_b32 v164, v165
    s_nop 0
    v_max3_f32 v2, v12, v13, v14
    v_max3_f32 v3, v15, v16, v17
    v_max3_f32 v2, v2, v18, v19
    v_max3_f32 v3, v3, v20, v21
    v_max_f32 v2, v2, v3
    v_mov_b32 v3, v2
    s_nop 1
    v_permlane16_swap_b32 v3, v2
    v_max_f32 v2, v2, v3
    v_mov_b32 v3, v2
    s_waitcnt vmcnt(0)
    v_max3_u32 v188, v64, v66, v68
    v_permlane32_swap_b32 v3, v2
    v_max_f32 v2, v2, v3
    v_max_u32 v188, v188, v70
    v_mul_f32 v2, s29, v2
    v_cmp_eq_u32 vcc, -1, v188
    v_fma_f32 v12, v12, s29, -v2
    v_fma_f32 v13, v13, s29, -v2
    s_cbranch_vccnz aloopH_42_rq_v
aloopH_42_vok:
    v_smfmac_f32_16x16x64_bf16 v[24:27], v[64:67], v[192:199], v166
    v_fma_f32 v14, v14, s29, -v2
    v_exp_f32 v12, v12
    v_smfmac_f32_16x16x64_bf16 v[32:35], v[64:67], v[224:231], v166
    v_fma_f32 v15, v15, s29, -v2
    v_exp_f32 v13, v13
    v_smfmac_f32_16x16x64_bf16 v[28:31], v[64:67], v[208:215], v166
    v_fma_f32 v16, v16, s29, -v2
    v_exp_f32 v14, v14
    v_smfmac_f32_16x16x64_bf16 v[36:39], v[64:67], v[240:247], v166
    v_fma_f32 v17, v17, s29, -v2
    v_exp_f32 v15, v15
    v_smfmac_f32_16x16x64_bf16 v[24:27], v[68:71], v[200:207], v166
    v_fma_f32 v18, v18, s29, -v2
    v_exp_f32 v16, v16
    v_smfmac_f32_16x16x64_bf16 v[32:35], v[68:71], v[232:239], v166
    v_fma_f32 v19, v19, s29, -v2
    v_exp_f32 v17, v17
    v_smfmac_f32_16x16x64_bf16 v[28:31], v[68:71], v[216:223], v166
    v_fma_f32 v20, v20, s29, -v2
    v_exp_f32 v18, v18
    v_smfmac_f32_16x16x64_bf16 v[36:39], v[68:71], v[248:255], v166
    v_fma_f32 v21, v21, s29, -v2
    v_exp_f32 v19, v19
    v_exp_f32 v20, v20
    v_exp_f32 v21, v21
    v_cvt_pk_bf16_f32 v12, v12, v13
    v_cvt_pk_bf16_f32 v13, v14, v15
    v_cvt_pk_bf16_f32 v14, v16, v17
    v_cvt_pk_bf16_f32 v15, v18, v19
    v_cvt_pk_bf16_f32 v20, v20, v21
    v_mov_b32 v22, 0
    v_mfma_f32_16x16x32_bf16 v[16:19], v[4:7], v[12:15], 0
    v_mov_b32 v21, v20
    v_mov_b32 v23, 0
    v_cvt_pk_bf16_f32 v40, v24, v25
    v_cvt_pk_bf16_f32 v41, v26, v27
    v_mfma_f32_16x16x32_bf16 v[16:19], v[8:11], v[20:23], v[16:19]
    v_mfma_f32_16x16x32_bf16 v[24:27], v[80:83], v[12:15], 0
    v_cvt_pk_bf16_f32 v44, v32, v33
    v_cvt_pk_bf16_f32 v45, v34, v35
    v_mfma_f32_16x16x32_bf16 v[32:35], v[88:91], v[12:15], 0
    v_cvt_pk_bf16_f32 v42, v28, v29
    v_cvt_pk_bf16_f32 v43, v30, v31
    v_mfma_f32_16x16x32_bf16 v[28:31], v[84:87], v[12:15], 0
    v_cvt_pk_bf16_f32 v46, v36, v37
    v_cvt_pk_bf16_f32 v47, v38, v39
    v_mfma_f32_16x16x32_bf16 v[36:39], v[92:95], v[12:15], 0
aloopH_42_midE:
    s_mov_b64 vcc, s[56:57]
    v_rcp_f32 v3, v16
    v_mfma_f32_16x16x32_bf16 v[24:27], v[40:43], v[20:23], v[24:27]
    v_mfma_f32_16x16x32_bf16 v[32:35], v[44:47], v[20:23], v[32:35]
    v_mfma_f32_16x16x32_bf16 v[28:31], v[42:45], v[20:23], v[28:31]
    v_mfma_f32_16x16x32_bf16 v[36:39], v[46:49], v[20:23], v[36:39]
    v_mov_b32_dpp v3, v3 quad_perm:[2,3,2,3] row_mask:0xf bank_mask:0xf
    s_nop 4
    v_cndmask_b32_dpp v24, v32, v24, vcc quad_perm:[2,3,2,3] row_mask:0xf bank_mask:0xf
    v_cndmask_b32_dpp v25, v33, v25, vcc quad_perm:[2,3,2,3] row_mask:0xf bank_mask:0xf
    v_cndmask_b32_dpp v26, v34, v26, vcc quad_perm:[2,3,2,3] row_mask:0xf bank_mask:0xf
    v_cndmask_b32_dpp v27, v35, v27, vcc quad_perm:[2,3,2,3] row_mask:0xf bank_mask:0xf
    v_cndmask_b32_dpp v28, v36, v28, vcc quad_perm:[2,3,2,3] row_mask:0xf bank_mask:0xf
    v_cndmask_b32_dpp v29, v37, v29, vcc quad_perm:[2,3,2,3] row_mask:0xf bank_mask:0xf
    v_cndmask_b32_dpp v30, v38, v30, vcc quad_perm:[2,3,2,3] row_mask:0xf bank_mask:0xf
    v_cndmask_b32_dpp v31, v39, v31, vcc quad_perm:[2,3,2,3] row_mask:0xf bank_mask:0xf
    v_mul_f32 v24, v24, v3
    v_mul_f32 v25, v25, v3
    v_mul_f32 v26, v26, v3
    v_mul_f32 v27, v27, v3
    v_mul_f32 v28, v28, v3
    v_mul_f32 v29, v29, v3
    v_mul_f32 v30, v30, v3
    v_mul_f32 v31, v31, v3
    v_cvt_pk_bf16_f32 v168, v24, v25
    v_cvt_pk_bf16_f32 v169, v26, v27
    v_cvt_pk_bf16_f32 v170, v28, v29
    v_cvt_pk_bf16_f32 v171, v30, v31
    ds_write_b128 v160, v[168:171]
    s_waitcnt lgkmcnt(0)
    s_barrier
    ds_read_b128 v[172:175], v161
    s_waitcnt lgkmcnt(0)
    v_mfma_f32_16x16x32_bf16 v[24:27], v[184:187], v[172:175], 0
    s_nop 7
    v_cvt_pk_bf16_f32 v168, v24, v25
    v_cvt_pk_bf16_f32 v169, v26, v27
    s_nop 0
    v_permlane16_swap_b32 v168, v170
    v_permlane16_swap_b32 v169, v171
    s_mov_b64 exec, 0xffff
    v_min_u32 v168, -2, v168
    buffer_store_dwordx4 v[168:171], v1, s[4:7], s25 offen sc1
    s_setprio 0
    buffer_store_dwordx4 v[176:179], v1, s[4:7], s26 offen sc1
    s_mov_b64 exec, -1
    s_branch pg_45
    s_cmp_lg_u32 s27, 0
    s_cbranch_scc1 pg_45
    s_sub_u32 s21, s16, 1
    s_cbranch_scc1 pg_45
    s_sub_u32 s17, s21, 1
    s_and_b32 s17, s17, 3
    s_cmp_ge_u32 s16, 58
    s_cselect_b32 s17, 0, s17
    s_cmp_lg_u32 s17, 0
    s_cbranch_scc1 pg_45
    v_mov_b32 v3, s21
    s_mov_b64 exec, 1
    buffer_store_dword v3, off, s[4:7], s28 sc1
    s_mov_b64 exec, -1
pg_45:
aloopH_42_lskb:
    v_mov_b32 v64, 0xff61b1e6
    ds_read_b128 v[128:131], v163 offset:16384
    ds_read_b128 v[132:135], v163 offset:17408
    ds_read_b128 v[136:139], v163 offset:18432
    ds_read_b128 v[140:143], v163 offset:19456
    ds_read_b128 v[144:147], v163 offset:20480
    ds_read_b128 v[148:151], v163 offset:21504
    ds_read_b128 v[152:155], v163 offset:22528
    ds_read_b128 v[156:159], v163 offset:23552
    s_waitcnt lgkmcnt(4)
    v_mfma_f32_16x16x32_bf16 v[12:15], v[96:99], v[128:131], 0
    v_mfma_f32_16x16x32_bf16 v[20:23], v[48:51], v[128:131], 0
    v_mfma_f32_16x16x32_bf16 v[12:15], v[100:103], v[132:135], v[12:15]
    v_mfma_f32_16x16x32_bf16 v[20:23], v[52:55], v[132:135], v[20:23]
    v_mfma_f32_16x16x32_bf16 v[12:15], v[104:107], v[136:139], v[12:15]
    v_mfma_f32_16x16x32_bf16 v[20:23], v[56:59], v[136:139], v[20:23]
    v_mfma_f32_16x16x32_bf16 v[12:15], v[108:111], v[140:143], v[12:15]
    v_mfma_f32_16x16x32_bf16 v[20:23], v[60:63], v[140:143], v[20:23]
    s_waitcnt lgkmcnt(0)
    v_mfma_f32_16x16x32_bf16 v[68:71], v[96:99], v[144:147], 0
    v_mfma_f32_16x16x32_bf16 v[72:75], v[112:115], v[144:147], 0
    v_mfma_f32_16x16x32_bf16 v[76:79], v[48:51], v[144:147], 0
    v_mfma_f32_16x16x32_bf16 v[68:71], v[100:103], v[148:151], v[68:71]
    v_mfma_f32_16x16x32_bf16 v[72:75], v[116:119], v[148:151], v[72:75]
    v_mfma_f32_16x16x32_bf16 v[76:79], v[52:55], v[148:151], v[76:79]
    v_mfma_f32_16x16x32_bf16 v[68:71], v[104:107], v[152:155], v[68:71]
    v_mfma_f32_16x16x32_bf16 v[72:75], v[120:123], v[152:155], v[72:75]
    v_mfma_f32_16x16x32_bf16 v[76:79], v[56:59], v[152:155], v[76:79]
    v_mfma_f32_16x16x32_bf16 v[68:71], v[108:111], v[156:159], v[68:71]
    v_mfma_f32_16x16x32_bf16 v[72:75], v[124:127], v[156:159], v[72:75]
    v_mfma_f32_16x16x32_bf16 v[76:79], v[60:63], v[156:159], v[76:79]
    v_cndmask_b32 v12, v12, v64, s[44:45]
    v_cndmask_b32 v13, v13, v64, s[46:47]
    v_cndmask_b32 v14, v14, v64, s[48:49]
    v_cndmask_b32 v15, v15, v64, s[50:51]
    s_add_u32 s17, s41, 20971520
    buffer_load_dwordx4 v[96:99], v0, s[4:7], s17 offen offset:0 sc1
    v_max3_f32 v2, v12, v13, v14
    buffer_load_dwordx4 v[100:103], v0, s[4:7], s17 offen offset:1024 sc1
    v_max3_f32 v3, v15, v20, v21
    buffer_load_dwordx4 v[104:107], v0, s[4:7], s17 offen offset:2048 sc1
    v_max_f32 v2, v2, v3
    buffer_load_dwordx4 v[108:111], v0, s[4:7], s17 offen offset:3072 sc1
    v_mov_b32 v3, v2
    s_add_u32 s18, s41, 21102592
    buffer_load_dwordx4 v[112:115], v0, s[4:7], s18 offen offset:0 sc1
    s_nop 1
    buffer_load_dwordx4 v[116:119], v0, s[4:7], s18 offen offset:1024 sc1
    v_permlane16_swap_b32 v3, v2
    buffer_load_dwordx4 v[120:123], v0, s[4:7], s18 offen offset:2048 sc1
    v_max_f32 v2, v2, v3
    buffer_load_dwordx4 v[124:127], v0, s[4:7], s18 offen offset:3072 sc1
    v_mov_b32 v3, v2
    s_nop 1
    v_permlane32_swap_b32 v3, v2
    v_max_f32 v2, v2, v3
    v_mul_f32 v2, s29, v2
    v_fma_f32 v12, v12, s29, -v2
    v_fma_f32 v13, v13, s29, -v2
    v_fma_f32 v14, v14, s29, -v2
    v_exp_f32 v12, v12
    v_fma_f32 v15, v15, s29, -v2
    v_exp_f32 v13, v13
    v_fma_f32 v20, v20, s29, -v2
    v_exp_f32 v14, v14
    v_fma_f32 v21, v21, s29, -v2
    v_exp_f32 v15, v15
    v_exp_f32 v20, v20
    v_exp_f32 v21, v21
    v_cvt_pk_bf16_f32 v12, v12, v13
    v_cvt_pk_bf16_f32 v13, v14, v15
    v_mov_b32 v14, 0
    v_mov_b32 v15, 0
    v_cvt_pk_bf16_f32 v20, v20, v21
    v_mov_b32 v22, 0
    v_mov_b32 v21, v20
    v_mov_b32 v23, 0
    s_nop 1
    v_cndmask_b32 v72, v72, v64, s[44:45]
    v_mfma_f32_16x16x32_bf16 v[16:19], v[4:7], v[12:15], 0
    v_cndmask_b32 v73, v73, v64, s[46:47]
    v_cndmask_b32 v74, v74, v64, s[48:49]
    v_mfma_f32_16x16x32_bf16 v[16:19], v[8:11], v[20:23], v[16:19]
    v_cndmask_b32 v75, v75, v64, s[50:51]
    v_max3_f32 v2, v68, v69, v70
    v_mfma_f32_16x16x32_bf16 v[24:27], v[80:83], v[12:15], 0
    v_max3_f32 v3, v71, v72, v73
    v_max3_f32 v2, v2, v74, v75
    v_mfma_f32_16x16x32_bf16 v[24:27], v[40:43], v[20:23], v[24:27]
    v_max3_f32 v3, v3, v76, v77
    v_max_f32 v2, v2, v3
    v_mfma_f32_16x16x32_bf16 v[28:31], v[84:87], v[12:15], 0
    v_mov_b32 v3, v2
    s_nop 1
    v_mfma_f32_16x16x32_bf16 v[28:31], v[42:45], v[20:23], v[28:31]
    v_permlane16_swap_b32 v3, v2
    v_max_f32 v2, v2, v3
    v_mfma_f32_16x16x32_bf16 v[32:35], v[88:91], v[12:15], 0
    v_mov_b32 v3, v2
    s_nop 1
    v_mfma_f32_16x16x32_bf16 v[32:35], v[44:47], v[20:23], v[32:35]
    v_permlane32_swap_b32 v3, v2
    v_max_f32 v2, v2, v3
    v_mfma_f32_16x16x32_bf16 v[36:39], v[92:95], v[12:15], 0
    v_mul_f32 v2, s29, v2
    v_fma_f32 v68, v68, s29, -v2
    v_mfma_f32_16x16x32_bf16 v[36:39], v[46:49], v[20:23], v[36:39]
    v_fma_f32 v69, v69, s29, -v2
    v_fma_f32 v70, v70, s29, -v2
    v_exp_f32 v68, v68
    v_fma_f32 v71, v71, s29, -v2
    v_exp_f32 v69, v69
    v_fma_f32 v72, v72, s29, -v2
    v_exp_f32 v70, v70
    v_fma_f32 v73, v73, s29, -v2
    v_exp_f32 v71, v71
    v_fma_f32 v74, v74, s29, -v2
    v_exp_f32 v72, v72
    v_fma_f32 v75, v75, s29, -v2
    v_exp_f32 v73, v73
    v_fma_f32 v76, v76, s29, -v2
    v_exp_f32 v74, v74
    v_fma_f32 v77, v77, s29, -v2
    v_exp_f32 v75, v75
    v_exp_f32 v76, v76
    v_exp_f32 v77, v77
    v_cvt_pk_bf16_f32 v68, v68, v69
    v_cvt_pk_bf16_f32 v69, v70, v71
    v_cvt_pk_bf16_f32 v70, v72, v73
    v_cvt_pk_bf16_f32 v71, v74, v75
    v_cvt_pk_bf16_f32 v76, v76, v77
    v_mov_b32 v78, 0
    v_mov_b32 v77, v76
    v_mov_b32 v79, 0
    v_rcp_f32 v66, v16
    s_nop 0
    v_mul_f32 v24, v24, v66
    v_mul_f32 v25, v25, v66
    v_mul_f32 v26, v26, v66
    v_mul_f32 v27, v27, v66
    v_cvt_pk_bf16_f32 v168, v24, v25
    v_cvt_pk_bf16_f32 v169, v26, v27
    v_mul_f32 v28, v28, v66
    v_mul_f32 v29, v29, v66
    v_mul_f32 v30, v30, v66
    v_mul_f32 v31, v31, v66
    v_cvt_pk_bf16_f32 v170, v28, v29
    v_cvt_pk_bf16_f32 v171, v30, v31
    v_mul_f32 v32, v32, v66
    v_mul_f32 v33, v33, v66
    v_mul_f32 v34, v34, v66
    v_mul_f32 v35, v35, v66
    v_cvt_pk_bf16_f32 v172, v32, v33
    v_cvt_pk_bf16_f32 v173, v34, v35
    v_mul_f32 v36, v36, v66
    v_mul_f32 v37, v37, v66
    v_mul_f32 v38, v38, v66
    v_mul_f32 v39, v39, v66
    v_cvt_pk_bf16_f32 v174, v36, v37
    v_cvt_pk_bf16_f32 v175, v38, v39
    ds_write_b128 v162, v[168:171] offset:0
    ds_write_b128 v162, v[172:175] offset:2048
    v_mfma_f32_16x16x32_bf16 v[72:75], v[4:7], v[68:71], 0
    v_mfma_f32_16x16x32_bf16 v[72:75], v[8:11], v[76:79], v[72:75]
    v_mfma_f32_16x16x32_bf16 v[24:27], v[80:83], v[68:71], 0
    v_mfma_f32_16x16x32_bf16 v[24:27], v[40:43], v[76:79], v[24:27]
    v_mfma_f32_16x16x32_bf16 v[28:31], v[84:87], v[68:71], 0
    v_mfma_f32_16x16x32_bf16 v[28:31], v[42:45], v[76:79], v[28:31]
    v_mfma_f32_16x16x32_bf16 v[32:35], v[88:91], v[68:71], 0
    v_mfma_f32_16x16x32_bf16 v[32:35], v[44:47], v[76:79], v[32:35]
    v_mfma_f32_16x16x32_bf16 v[36:39], v[92:95], v[68:71], 0
    v_mfma_f32_16x16x32_bf16 v[36:39], v[46:49], v[76:79], v[36:39]
    v_rcp_f32 v3, v72
    s_nop 0
    v_mul_f32 v24, v24, v3
    v_mul_f32 v25, v25, v3
    v_mul_f32 v26, v26, v3
    v_mul_f32 v27, v27, v3
    v_cvt_pk_bf16_f32 v168, v24, v25
    v_cvt_pk_bf16_f32 v169, v26, v27
    v_mul_f32 v28, v28, v3
    v_mul_f32 v29, v29, v3
    v_mul_f32 v30, v30, v3
    v_mul_f32 v31, v31, v3
    v_cvt_pk_bf16_f32 v170, v28, v29
    v_cvt_pk_bf16_f32 v171, v30, v31
    v_mul_f32 v32, v32, v3
    v_mul_f32 v33, v33, v3
    v_mul_f32 v34, v34, v3
    v_mul_f32 v35, v35, v3
    v_cvt_pk_bf16_f32 v172, v32, v33
    v_cvt_pk_bf16_f32 v173, v34, v35
    v_mul_f32 v36, v36, v3
    v_mul_f32 v37, v37, v3
    v_mul_f32 v38, v38, v3
    v_mul_f32 v39, v39, v3
    v_cvt_pk_bf16_f32 v174, v36, v37
    v_cvt_pk_bf16_f32 v175, v38, v39
    ds_write_b128 v162, v[168:171] offset:256
    ds_write_b128 v162, v[172:175] offset:2304
    v_xor_b32 v162, 0x4000, v162
    s_add_u32 s16, s16, 1
    s_cmp_le_u32 s16, 63
    s_cbranch_scc1 aloopH_42
    s_waitcnt lgkmcnt(0)
    s_barrier
    s_waitcnt vmcnt(0)
    s_branch k_end
aloopH_42_rq_0:
    s_sub_u32 s22, s22, 1
    s_cbranch_scc1 aloopH_42_rq_0_g
    buffer_load_dwordx4 v[48:51], v0, s[4:7], s23 offen offset:0 sc1
    buffer_load_dwordx4 v[52:55], v0, s[4:7], s23 offen offset:1024 sc1
    buffer_load_dwordx4 v[56:59], v0, s[4:7], s23 offen offset:2048 sc1
    buffer_load_dwordx4 v[60:63], v0, s[4:7], s23 offen offset:3072 sc1
    buffer_load_dwordx4 v[64:67], v0, s[4:7], s24 offen offset:0 sc1
    buffer_load_dwordx4 v[68:71], v0, s[4:7], s24 offen offset:1024 sc1
    s_waitcnt vmcnt(5)
    v_max_u32 v3, v48, v50
    v_cmp_eq_u32 vcc, -1, v3
    s_cbranch_vccnz aloopH_42_rq_0
    s_branch aloopH_42_again
aloopH_42_rq_0_g:
    s_mov_b32 s22, 0
    s_waitcnt vmcnt(0)
    s_branch aloopH_42_nochk
aloopH_42_rq_1:
    s_sub_u32 s22, s22, 1
    s_cbranch_scc1 aloopH_42_rq_1_g
    buffer_load_dwordx4 v[52:55], v0, s[4:7], s23 offen offset:1024 sc1
    buffer_load_dwordx4 v[56:59], v0, s[4:7], s23 offen offset:2048 sc1
    buffer_load_dwordx4 v[60:63], v0, s[4:7], s23 offen offset:3072 sc1
    buffer_load_dwordx4 v[64:67], v0, s[4:7], s24 offen offset:0 sc1
    buffer_load_dwordx4 v[68:71], v0, s[4:7], s24 offen offset:1024 sc1
    s_waitcnt vmcnt(4)
    v_max_u32 v3, v52, v54
    v_cmp_eq_u32 vcc, -1, v3
    s_cbranch_vccnz aloopH_42_rq_1
    s_branch aloopH_42_again
aloopH_42_rq_1_g:
    s_mov_b32 s22, 0
    s_waitcnt vmcnt(0)
    s_branch aloopH_42_nochk
aloopH_42_rq_2:
    s_sub_u32 s22, s22, 1
    s_cbranch_scc1 aloopH_42_rq_2_g
    buffer_load_dwordx4 v[56:59], v0, s[4:7], s23 offen offset:2048 sc1
    buffer_load_dwordx4 v[60:63], v0, s[4:7], s23 offen offset:3072 sc1
    buffer_load_dwordx4 v[64:67], v0, s[4:7], s24 offen offset:0 sc1
    buffer_load_dwordx4 v[68:71], v0, s[4:7], s24 offen offset:1024 sc1
    s_waitcnt vmcnt(3)
    v_max_u32 v3, v56, v58
    v_cmp_eq_u32 vcc, -1, v3
    s_cbranch_vccnz aloopH_42_rq_2
    s_branch aloopH_42_again
aloopH_42_rq_2_g:
    s_mov_b32 s22, 0
    s_waitcnt vmcnt(0)
    s_branch aloopH_42_nochk
aloopH_42_rq_3:
    s_sub_u32 s22, s22, 1
    s_cbranch_scc1 aloopH_42_rq_3_g
    buffer_load_dwordx4 v[60:63], v0, s[4:7], s23 offen offset:3072 sc1
    buffer_load_dwordx4 v[64:67], v0, s[4:7], s24 offen offset:0 sc1
    buffer_load_dwordx4 v[68:71], v0, s[4:7], s24 offen offset:1024 sc1
    s_waitcnt vmcnt(2)
    v_max_u32 v3, v60, v62
    v_cmp_eq_u32 vcc, -1, v3
    s_cbranch_vccnz aloopH_42_rq_3
    s_branch aloopH_42_again
aloopH_42_rq_3_g:
    s_mov_b32 s22, 0
    s_waitcnt vmcnt(0)
    s_branch aloopH_42_nochk
aloopH_42_again:
    s_waitcnt vmcnt(5)
    v_mfma_f32_16x16x32_bf16 v[12:15], v[96:99], v[48:51], 0
    v_mfma_f32_16x16x32_bf16 v[16:19], v[112:115], v[48:51], 0
    v_max_u32 v3, v48, v50
    v_cmp_eq_u32 vcc, -1, v3
    v_mfma_f32_16x16x32_bf16 v[20:23], v[48:51], v[48:51], 0
    s_cbranch_vccnz aloopH_42_rq_0
    s_waitcnt vmcnt(4)
    v_mfma_f32_16x16x32_bf16 v[12:15], v[100:103], v[52:55], v[12:15]
    v_mfma_f32_16x16x32_bf16 v[16:19], v[116:119], v[52:55], v[16:19]
    v_max_u32 v3, v52, v54
    v_cmp_eq_u32 vcc, -1, v3
    v_mfma_f32_16x16x32_bf16 v[20:23], v[52:55], v[52:55], v[20:23]
    s_cbranch_vccnz aloopH_42_rq_1
    s_waitcnt vmcnt(3)
    v_mfma_f32_16x16x32_bf16 v[12:15], v[104:107], v[56:59], v[12:15]
    v_mfma_f32_16x16x32_bf16 v[16:19], v[120:123], v[56:59], v[16:19]
    v_max_u32 v3, v56, v58
    v_cmp_eq_u32 vcc, -1, v3
    v_mfma_f32_16x16x32_bf16 v[20:23], v[56:59], v[56:59], v[20:23]
    s_cbranch_vccnz aloopH_42_rq_2
    s_waitcnt vmcnt(2)
    v_mfma_f32_16x16x32_bf16 v[12:15], v[108:111], v[60:63], v[12:15]
    v_mfma_f32_16x16x32_bf16 v[16:19], v[124:127], v[60:63], v[16:19]
    v_max_u32 v3, v60, v62
    v_cmp_eq_u32 vcc, -1, v3
    v_mfma_f32_16x16x32_bf16 v[20:23], v[60:63], v[60:63], v[20:23]
    s_cbranch_vccnz aloopH_42_rq_3
    s_branch aloopH_42_sdone
aloopH_42_rq_v:
    s_sub_u32 s22, s22, 1
    s_cbranch_scc1 aloopH_42_rq_vg
    buffer_load_dwordx4 v[64:67], v0, s[4:7], s24 offen offset:0 sc1
    buffer_load_dwordx4 v[68:71], v0, s[4:7], s24 offen offset:1024 sc1
    s_waitcnt vmcnt(0)
    v_max3_u32 v188, v64, v66, v68
    v_max_u32 v188, v188, v70
    v_cmp_eq_u32 vcc, -1, v188
    s_cbranch_vccnz aloopH_42_rq_v
    s_branch aloopH_42_vok
aloopH_42_rq_vg:
    s_mov_b32 s22, 0
    s_branch aloopH_42_vok
aloopH_42_nochk:
    v_mfma_f32_16x16x32_bf16 v[12:15], v[96:99], v[48:51], 0
    v_mfma_f32_16x16x32_bf16 v[16:19], v[112:115], v[48:51], 0
    v_mfma_f32_16x16x32_bf16 v[20:23], v[48:51], v[48:51], 0
    v_mfma_f32_16x16x32_bf16 v[12:15], v[100:103], v[52:55], v[12:15]
    v_mfma_f32_16x16x32_bf16 v[16:19], v[116:119], v[52:55], v[16:19]
    v_mfma_f32_16x16x32_bf16 v[20:23], v[52:55], v[52:55], v[20:23]
    v_mfma_f32_16x16x32_bf16 v[12:15], v[104:107], v[56:59], v[12:15]
    v_mfma_f32_16x16x32_bf16 v[16:19], v[120:123], v[56:59], v[16:19]
    v_mfma_f32_16x16x32_bf16 v[20:23], v[56:59], v[56:59], v[20:23]
    v_mfma_f32_16x16x32_bf16 v[12:15], v[108:111], v[60:63], v[12:15]
    v_mfma_f32_16x16x32_bf16 v[16:19], v[124:127], v[60:63], v[16:19]
    v_mfma_f32_16x16x32_bf16 v[20:23], v[60:63], v[60:63], v[20:23]
    s_nop 1
    s_branch aloopH_42_sdone
aloopH_42_rq_v2:
    s_sub_u32 s22, s22, 1
    s_cbranch_scc1 aloopH_42_rq_v2g
    buffer_load_dwordx4 v[64:67], v0, s[4:7], s24 offen offset:0 sc1
    buffer_load_dwordx4 v[68:71], v0, s[4:7], s24 offen offset:1024 sc1
    s_waitcnt vmcnt(0)
    v_max3_u32 v188, v64, v66, v68
    v_max_u32 v188, v188, v70
    v_cmp_eq_u32 vcc, -1, v188
    s_cbranch_vccnz aloopH_42_rq_v2
    s_branch aloopH_42_lsk3
aloopH_42_rq_v2g:
    s_mov_b32 s22, 0
    s_branch aloopH_42_lsk3
ct_tail:
aloopH_42_lsk:
    s_cmp_lg_u32 s27, 0
    s_cbranch_scc1 aloopH_42_lsk2
    v_mov_b32 v3, 62
    s_mov_b64 exec, 1
    buffer_store_dword v3, off, s[4:7], s28 sc1
    s_mov_b64 exec, -1
aloopH_42_lsk2:
    s_waitcnt vmcnt(0)
    v_max3_u32 v188, v64, v66, v68
    v_max_u32 v188, v188, v70
    v_cmp_eq_u32 vcc, -1, v188
    s_cbranch_vccnz aloopH_42_rq_v2
aloopH_42_lsk3:
    v_smfmac_f32_16x16x64_bf16 v[24:27], v[64:67], v[192:199], v166
    v_smfmac_f32_16x16x64_bf16 v[32:35], v[64:67], v[224:231], v166
    v_smfmac_f32_16x16x64_bf16 v[28:31], v[64:67], v[208:215], v166
    v_smfmac_f32_16x16x64_bf16 v[36:39], v[64:67], v[240:247], v166
    v_smfmac_f32_16x16x64_bf16 v[24:27], v[68:71], v[200:207], v166
    v_smfmac_f32_16x16x64_bf16 v[32:35], v[68:71], v[232:239], v166
    v_smfmac_f32_16x16x64_bf16 v[28:31], v[68:71], v[216:223], v166
    v_smfmac_f32_16x16x64_bf16 v[36:39], v[68:71], v[248:255], v166
    s_nop 7
    s_nop 1
    v_cvt_pk_bf16_f32 v40, v24, v25
    v_cvt_pk_bf16_f32 v41, v26, v27
    v_cvt_pk_bf16_f32 v42, v28, v29
    v_cvt_pk_bf16_f32 v43, v30, v31
    v_cvt_pk_bf16_f32 v44, v32, v33
    v_cvt_pk_bf16_f32 v45, v34, v35
    v_cvt_pk_bf16_f32 v46, v36, v37
    v_cvt_pk_bf16_f32 v47, v38, v39
    s_waitcnt lgkmcnt(0)
    s_branch aloopH_42_lskb
k_end:
k_exit:
    s_endpgm
.section .rodata,"a"
.p2align 6
jobtab:
    .long 4, 24, 24, 8192, 0, 262144, 8388608, 0, 32768, 4, 20971520, 131072, 0, 0, 218104321, 0
    .long 4, 24, 24, 8192, 256, 262400, 8388608, 0, 32768, 4, 20975616, 131072, 0, 0, 218104321, 0
    .long 4, 24, 24, 8192, 512, 262656, 8388608, 0, 32768, 4, 20979712, 131072, 0, 0, 218104321, 0
    .long 4, 24, 24, 8192, 768, 262912, 8388608, 0, 32768, 4, 20983808, 131072, 0, 0, 218104321, 0
    .long 4, 24, 24, 8192, 1024, 263168, 8388608, 0, 32768, 4, 20987904, 131072, 0, 0, 218104337, 0
    .long 4, 24, 24, 8192, 1280, 263424, 8388608, 0, 32768, 4, 20992000, 131072, 0, 0, 218104337, 0
    .long 4, 24, 24, 8192, 1536, 263680, 8388608, 0, 32768, 4, 20996096, 131072, 0, 0, 218104337, 0
    .long 4, 24, 24, 8192, 1792, 263936, 8388608, 0, 32768, 4, 21000192, 131072, 0, 0, 218104337, 0
    .long 4, 32, 32, 8192, 0, 262144, 8388608, 0, 32768, 4, 37748736, 131072, 0, 0, 218104321, 0
    .long 4, 32, 32, 8192, 256, 262400, 8388608, 0, 32768, 4, 37752832, 131072, 0, 0, 218104321, 0
    .long 4, 32, 32, 8192, 512, 262656, 8388608, 0, 32768, 4, 37756928, 131072, 0, 0, 218104321, 0
    .long 4, 32, 32, 8192, 768, 262912, 8388608, 0, 32768, 4, 37761024, 131072, 0, 0, 218104321, 0
    .long 4, 32, 32, 8192, 1024, 263168, 8388608, 0, 32768, 4, 37765120, 131072, 0, 0, 218104337, 0
    .long 4, 32, 32, 8192, 1280, 263424, 8388608, 0, 32768, 4, 37769216, 131072, 0, 0, 218104337, 0
    .long 4, 32, 32, 8192, 1536, 263680, 8388608, 0, 32768, 4, 37773312, 131072, 0, 0, 218104337, 0
    .long 4, 32, 32, 8192, 1792, 263936, 8388608, 0, 32768, 4, 37777408, 131072, 0, 0, 218104337, 0
    .long 4, 24, 24, 8192, 0, 262144, 8388608, 262144, 32768, 4, 22020096, 131072, 0, 0, 218104324, 0
    .long 4, 24, 24, 8192, 256, 262400, 8388608, 262144, 32768, 4, 22024192, 131072, 0, 0, 218104324, 0
    .long 4, 24, 24, 8192, 512, 262656, 8388608, 262144, 32768, 4, 22028288, 131072, 0, 0, 218104324, 0
    .long 4, 24, 24, 8192, 768, 262912, 8388608, 262144, 32768, 4, 22032384, 131072, 0, 0, 218104324, 0
    .long 4, 24, 24, 8192, 1024, 263168, 8388608, 262144, 32768, 4, 22036480, 131072, 0, 0, 218104340, 0
    .long 4, 24, 24, 8192, 1280, 263424, 8388608, 262144, 32768, 4, 22040576, 131072, 0, 0, 218104340, 0
    .long 4, 24, 24, 8192, 1536, 263680, 8388608, 262144, 32768, 4, 22044672, 131072, 0, 0, 218104340, 0
    .long 4, 24, 24, 8192, 1792, 263936, 8388608, 262144, 32768, 4, 22048768, 131072, 0, 0, 218104340, 0
    .long 4, 32, 32, 8192, 0, 262144, 8388608, 262144, 32768, 4, 38797312, 131072, 0, 0, 218104324, 0
    .long 4, 32, 32, 8192, 256, 262400, 8388608, 262144, 32768, 4, 38801408, 131072, 0, 0, 218104324, 0
    .long 4, 32, 32, 8192, 512, 262656, 8388608, 262144, 32768, 4, 38805504, 131072, 0, 0, 218104324, 0
    .long 4, 32, 32, 8192, 768, 262912, 8388608, 262144, 32768, 4, 38809600, 131072, 0, 0, 218104324, 0
    .long 4, 32, 32, 8192, 1024, 263168, 8388608, 262144, 32768, 4, 38813696, 131072, 0, 0, 218104340, 0
    .long 4, 32, 32, 8192, 1280, 263424, 8388608, 262144, 32768, 4, 38817792, 131072, 0, 0, 218104340, 0
    .long 4, 32, 32, 8192, 1536, 263680, 8388608, 262144, 32768, 4, 38821888, 131072, 0, 0, 218104340, 0
    .long 4, 32, 32, 8192, 1792, 263936, 8388608, 262144, 32768, 4, 38825984, 131072, 0, 0, 218104340, 0
    .long 4, 32, 32, 8192, 256, 262400, 8388608, 786432, 32768, 4, 40898560, 131072, 0, 0, 218104580, 0
    .long 4, 24, 24, 8192, 512, 262656, 8388608, 786432, 32768, 4, 24125440, 131072, 0, 0, 218104580, 0
    .long 4, 24, 24, 8192, 1536, 263680, 8388608, 786432, 32768, 4, 24141824, 131072, 0, 0, 218104596, 0
    .long 4, 32, 32, 8192, 768, 262912, 8388608, 524288, 32768, 4, 39858176, 131072, 0, 0, 218104577, 0
    .long 4, 32, 32, 8192, 1536, 263680, 8388608, 786432, 32768, 4, 40919040, 131072, 0, 0, 218104596, 0
    .long 4, 32, 32, 8192, 1280, 263424, 8388608, 524288, 32768, 4, 39866368, 131072, 0, 0, 218104593, 0
    .long 4, 24, 24, 8192, 1024, 263168, 8388608, 786432, 32768, 4, 24133632, 131072, 0, 0, 218104596, 0
    .long 4, 32, 32, 8192, 1792, 263936, 8388608, 524288, 32768, 4, 39874560, 131072, 0, 0, 218104593, 0
    .long 4, 32, 32, 8192, 512, 262656, 8388608, 786432, 32768, 4, 40902656, 131072, 0, 0, 218104580, 0
    .long 4, 32, 32, 8192, 512, 262656, 8388608, 524288, 32768, 4, 39854080, 131072, 0, 0, 218104577, 0
    .long 4, 32, 32, 8192, 1024, 263168, 8388608, 786432, 32768, 4, 40910848, 131072, 0, 0, 218104596, 0
    .long 4, 24, 24, 8192, 768, 262912, 8388608, 524288, 32768, 4, 23080960, 131072, 0, 0, 218104577, 0
    .long 2, 64, 72, 7168, 0, 0, 7340032, 1048576, 32768, 8, 58195968, 114688, 0, 0, 218103937, 0
    .long 4, 24, 24, 8192, 256, 262400, 8388608, 786432, 32768, 4, 24121344, 131072, 0, 0, 218104580, 0
    .long 4, 24, 24, 8192, 1280, 263424, 8388608, 524288, 32768, 4, 23089152, 131072, 0, 0, 218104593, 0
    .long 4, 32, 32, 8192, 256, 262400, 8388608, 524288, 32768, 4, 39849984, 131072, 0, 0, 218104577, 0
    .long 4, 32, 32, 8192, 1792, 263936, 8388608, 786432, 32768, 4, 40923136, 131072, 0, 0, 218104596, 0
    .long 4, 24, 24, 8192, 0, 262144, 8388608, 524288, 32768, 4, 23068672, 131072, 0, 0, 218104577, 0
    .long 4, 24, 24, 8192, 1536, 263680, 8388608, 524288, 32768, 4, 23093248, 131072, 0, 0, 218104593, 0
    .long 4, 32, 32, 8192, 0, 262144, 8388608, 524288, 32768, 4, 39845888, 131072, 0, 0, 218104577, 0
    .long 4, 24, 24, 8192, 1792, 263936, 8388608, 524288, 32768, 4, 23097344, 131072, 0, 0, 218104593, 0
    .long 4, 32, 32, 8192, 0, 262144, 8388608, 786432, 32768, 4, 40894464, 131072, 0, 0, 218104580, 0
    .long 4, 24, 24, 8192, 768, 262912, 8388608, 786432, 32768, 4, 24129536, 131072, 0, 0, 218104580, 0
    .long 4, 32, 32, 8192, 768, 262912, 8388608, 786432, 32768, 4, 40906752, 131072, 0, 0, 218104580, 0
    .long 4, 32, 32, 8192, 1536, 263680, 8388608, 524288, 32768, 4, 39870464, 131072, 0, 0, 218104593, 0
    .long 4, 24, 24, 8192, 1024, 263168, 8388608, 524288, 32768, 4, 23085056, 131072, 0, 0, 218104593, 0
    .long 4, 32, 32, 8192, 1280, 263424, 8388608, 786432, 32768, 4, 40914944, 131072, 0, 0, 218104596, 0
    .long 4, 24, 24, 8192, 256, 262400, 8388608, 524288, 32768, 4, 23072768, 131072, 0, 0, 218104577, 0
    .long 4, 32, 32, 8192, 1024, 263168, 8388608, 524288, 32768, 4, 39862272, 131072, 0, 0, 218104593, 0
    .long 4, 24, 24, 8192, 512, 262656, 8388608, 524288, 32768, 4, 23076864, 131072, 0, 0, 218104577, 0
    .long 4, 24, 24, 8192, 1280, 263424, 8388608, 786432, 32768, 4, 24137728, 131072, 0, 0, 218104596, 0
    .long 4, 24, 24, 8192, 0, 262144, 8388608, 786432, 32768, 4, 24117248, 131072, 0, 0, 218104580, 0
    .long 1, 32, 32, 8192, 1024, 1280, 8388608, 1048576, 32768, 8, 41959424, 131072, 0, 0, 218104858, 0
    .long 1, 24, 24, 8192, 512, 768, 8388608, 1048576, 32768, 8, 25174016, 131072, 0, 0, 218104842, 0
    .long 1, 16, 16, 8192, 512, 768, 8388608, 1048576, 32768, 8, 8396800, 131072, 0, 0, 218104842, 0
    .long 1, 24, 24, 8192, 1024, 1280, 8388608, 1048576, 32768, 8, 25182208, 131072, 0, 0, 218104858, 0
    .long 4, 24, 24, 8192, 1792, 263936, 8388608, 786432, 32768, 4, 24145920, 131072, 0, 0, 218104596, 0
    .long 1, 16, 16, 8192, 0, 256, 8388608, 1048576, 32768, 8, 8388608, 131072, 0, 0, 218104842, 0
    .long 1, 24, 24, 8192, 512, 768, 8388608, 1572864, 32768, 8, 27271168, 131072, 0, 0, 218105098, 0
    .long 1, 32, 32, 8192, 1024, 1280, 8388608, 1572864, 32768, 8, 44056576, 131072, 0, 0, 218105114, 0
    .long 1, 24, 24, 8192, 0, 256, 8388608, 1048576, 32768, 8, 25165824, 131072, 0, 0, 218104842, 0
    .long 1, 32, 32, 8192, 512, 768, 8388608, 1048576, 32768, 8, 41951232, 131072, 0, 0, 218104842, 0
    .long 1, 16, 16, 8192, 1536, 1792, 8388608, 1572864, 32768, 8, 10510336, 131072, 0, 0, 218105114, 0
    .long 1, 16, 16, 8192, 0, 256, 8388608, 0, 32768, 8, 4194304, 131072, 0, 0, 218107914, 0
    .long 1, 24, 24, 8192, 1024, 1280, 8388608, 1572864, 32768, 8, 27279360, 131072, 0, 0, 218105114, 0
    .long 1, 32, 32, 8192, 1536, 1792, 8388608, 1572864, 32768, 8, 44064768, 131072, 0, 0, 218105114, 0
    .long 1, 32, 32, 8192, 0, 256, 8388608, 1048576, 32768, 8, 41943040, 131072, 0, 0, 218104842, 0
    .long 1, 16, 16, 8192, 1024, 1280, 8388608, 1572864, 32768, 8, 10502144, 131072, 0, 0, 218105114, 0
    .long 1, 32, 32, 8192, 1536, 1792, 8388608, 1048576, 32768, 8, 41967616, 131072, 0, 0, 218104858, 0
    .long 1, 24, 24, 8192, 1536, 1792, 8388608, 1572864, 32768, 8, 27287552, 131072, 0, 0, 218105114, 0
    .long 1, 16, 16, 8192, 1536, 1792, 8388608, 1048576, 32768, 8, 8413184, 131072, 0, 0, 218104858, 0
    .long 1, 32, 32, 8192, 0, 256, 8388608, 1572864, 32768, 8, 44040192, 131072, 0, 0, 218105098, 0
    .long 1, 16, 16, 8192, 1536, 1792, 8388608, 0, 32768, 8, 4218880, 131072, 0, 0, 218107930, 0
    .long 1, 16, 16, 8192, 512, 768, 8388608, 2097152, 32768, 8, 12591104, 131072, 0, 0, 218105354, 0
    .long 1, 16, 16, 8192, 1024, 1280, 8388608, 1048576, 32768, 8, 8404992, 131072, 0, 0, 218104858, 0
    .long 1, 16, 16, 8192, 0, 256, 8388608, 1572864, 32768, 8, 10485760, 131072, 0, 0, 218105098, 0
    .long 1, 32, 32, 8192, 0, 256, 8388608, 2097152, 32768, 8, 46137344, 131072, 0, 0, 218105354, 0
    .long 1, 16, 16, 8192, 512, 768, 8388608, 0, 32768, 8, 4202496, 131072, 0, 0, 218107914, 0
    .long 1, 24, 24, 8192, 1536, 1792, 8388608, 1048576, 32768, 8, 25190400, 131072, 0, 0, 218104858, 0
    .long 1, 16, 16, 8192, 512, 768, 8388608, 1572864, 32768, 8, 10493952, 131072, 0, 0, 218105098, 0
    .long 1, 16, 16, 8192, 1024, 1280, 8388608, 0, 32768, 8, 4210688, 131072, 0, 0, 218107930, 0
    .long 1, 32, 32, 8192, 512, 768, 8388608, 2097152, 32768, 8, 46145536, 131072, 0, 0, 218105354, 0
    .long 1, 32, 32, 8192, 512, 768, 8388608, 1572864, 32768, 8, 44048384, 131072, 0, 0, 218105098, 0
    .long 1, 24, 24, 8192, 0, 256, 8388608, 1572864, 32768, 8, 27262976, 131072, 0, 0, 218105098, 0
    .long 1, 16, 16, 8192, 0, 256, 8388608, 524288, 32768, 8, 6291456, 131072, 0, 0, 218108170, 0
    .long 1, 32, 32, 8192, 1024, 1280, 8388608, 3670016, 32768, 8, 52445184, 131072, 0, 0, 218106138, 0
    .long 1, 16, 16, 8192, 1024, 1280, 8388608, 2621440, 32768, 8, 14696448, 131072, 0, 0, 218105626, 0
    .long 1, 24, 24, 8192, 512, 768, 8388608, 3145728, 32768, 8, 33562624, 131072, 0, 0, 218105866, 0
    .long 1, 16, 16, 8192, 0, 256, 8388608, 2621440, 32768, 8, 14680064, 131072, 0, 0, 218105610, 0
    .long 1, 32, 32, 8192, 1536, 1792, 8388608, 3670016, 32768, 8, 52453376, 131072, 0, 0, 218106138, 0
    .long 1, 16, 16, 8192, 0, 256, 8388608, 3145728, 32768, 8, 16777216, 131072, 0, 0, 218105866, 0
    .long 1, 24, 24, 8192, 1024, 1280, 8388608, 2097152, 32768, 8, 29376512, 131072, 0, 0, 218105370, 0
    .long 1, 16, 16, 8192, 1536, 1792, 8388608, 2097152, 32768, 8, 12607488, 131072, 0, 0, 218105370, 0
    .long 1, 24, 24, 8192, 512, 768, 8388608, 3670016, 32768, 8, 35659776, 131072, 0, 0, 218106122, 0
    .long 1, 24, 24, 8192, 1536, 1792, 8388608, 3145728, 32768, 8, 33579008, 131072, 0, 0, 218105882, 0
    .long 1, 32, 32, 8192, 1536, 1792, 8388608, 2621440, 32768, 8, 48259072, 131072, 0, 0, 218105626, 0
    .long 1, 32, 32, 8192, 1536, 1792, 8388608, 2097152, 32768, 8, 46161920, 131072, 0, 0, 218105370, 0
    .long 1, 24, 24, 8192, 1536, 1792, 8388608, 2097152, 32768, 8, 29384704, 131072, 0, 0, 218105370, 0
    .long 1, 24, 24, 8192, 0, 256, 8388608, 2097152, 32768, 8, 29360128, 131072, 0, 0, 218105354, 0
    .long 1, 32, 32, 8192, 1536, 1792, 8388608, 3145728, 32768, 8, 50356224, 131072, 0, 0, 218105882, 0
    .long 1, 32, 32, 8192, 0, 256, 8388608, 3145728, 32768, 8, 50331648, 131072, 0, 0, 218105866, 0
    .long 1, 16, 16, 8192, 1024, 1280, 8388608, 3145728, 32768, 8, 16793600, 131072, 0, 0, 218105882, 0
    .long 1, 16, 16, 8192, 1024, 1280, 8388608, 2097152, 32768, 8, 12599296, 131072, 0, 0, 218105370, 0
    .long 5, 218107920, 0, 0, 4, 0, 0, 0, 0, 0, 0, 0, 218112000, 4, 218106881, 0
    .long 1, 32, 32, 8192, 1024, 1280, 8388608, 3145728, 32768, 8, 50348032, 131072, 0, 0, 218105882, 0
    .long 1, 24, 24, 8192, 1536, 1792, 8388608, 3670016, 32768, 8, 35676160, 131072, 0, 0, 218106138, 0
    .long 1, 32, 32, 8192, 0, 256, 8388608, 2621440, 32768, 8, 48234496, 131072, 0, 0, 218105610, 0
    .long 1, 32, 32, 8192, 1024, 1280, 8388608, 2097152, 32768, 8, 46153728, 131072, 0, 0, 218105370, 0
    .long 1, 24, 24, 8192, 512, 768, 8388608, 2621440, 32768, 8, 31465472, 131072, 0, 0, 218105610, 0
    .long 1, 24, 24, 8192, 512, 768, 8388608, 2097152, 32768, 8, 29368320, 131072, 0, 0, 218105354, 0
    .long 1, 16, 16, 8192, 1536, 1792, 8388608, 524288, 32768, 8, 6316032, 131072, 0, 0, 218108186, 0
    .long 1, 32, 32, 8192, 1024, 1280, 8388608, 2621440, 32768, 8, 48250880, 131072, 0, 0, 218105626, 0
    .long 1, 16, 16, 8192, 1024, 1280, 8388608, 524288, 32768, 8, 6307840, 131072, 0, 0, 218108186, 0
    .long 1, 24, 24, 8192, 0, 256, 8388608, 2621440, 32768, 8, 31457280, 131072, 0, 0, 218105610, 0
    .long 1, 16, 16, 8192, 0, 256, 8388608, 2097152, 32768, 8, 12582912, 131072, 0, 0, 218105354, 0
    .long 5, 218107920, 0, 0, 4, 0, 0, 4, 0, 0, 0, 0, 218112000, 8, 218106881, 0
    .long 5, 218107904, 0, 0, 0, 0, 0, 0, 0, 0, 0, 0, 218112000, 4, 218106881, 0
    .long 1, 24, 24, 8192, 1024, 1280, 8388608, 3670016, 32768, 8, 35667968, 131072, 0, 0, 218106138, 0
    .long 2, 64, 72, 7168, 0, 0, 7340032, 2097152, 32768, 8, 61865984, 114688, 0, 0, 218104065, 0
    .long 1, 24, 24, 8192, 1536, 1792, 8388608, 2621440, 32768, 8, 31481856, 131072, 0, 0, 218105626, 0
    .long 2, 64, 72, 7168, 256, 256, 7340032, 0, 32768, 8, 54530048, 114688, 0, 0, 218103809, 0
    .long 1, 24, 24, 8192, 0, 256, 8388608, 3670016, 32768, 8, 35651584, 131072, 0, 0, 218106122, 0
    .long 1, 32, 32, 8192, 512, 768, 8388608, 3670016, 32768, 8, 52436992, 131072, 0, 0, 218106122, 0
    .long 2, 64, 72, 7168, 1024, 1024, 7340032, 2621440, 32768, 8, 63717376, 114688, 0, 0, 218104129, 0
    .long 1, 32, 32, 8192, 512, 768, 8388608, 2621440, 32768, 8, 48242688, 131072, 0, 0, 218105610, 0
    .long 1, 16, 16, 8192, 512, 768, 8388608, 2621440, 32768, 8, 14688256, 131072, 0, 0, 218105610, 0
    .long 2, 64, 72, 7168, 0, 0, 7340032, 0, 32768, 8, 54525952, 114688, 0, 0, 218103809, 0
    .long 1, 16, 16, 8192, 1536, 1792, 8388608, 3145728, 32768, 8, 16801792, 131072, 0, 0, 218105882, 0
    .long 1, 24, 24, 8192, 1024, 1280, 8388608, 2621440, 32768, 8, 31473664, 131072, 0, 0, 218105626, 0
    .long 2, 64, 72, 7168, 256, 256, 7340032, 524288, 32768, 8, 56365056, 114688, 0, 0, 218103873, 0
    .long 1, 24, 24, 8192, 0, 256, 8388608, 3145728, 32768, 8, 33554432, 131072, 0, 0, 218105866, 0
    .long 2, 64, 72, 7168, 768, 768, 7340032, 0, 32768, 8, 54538240, 114688, 0, 0, 218103809, 0
    .long 2, 64, 72, 7168, 768, 768, 7340032, 524288, 32768, 8, 56373248, 114688, 0, 0, 218103873, 0
    .long 2, 64, 72, 7168, 512, 512, 7340032, 2097152, 32768, 8, 61874176, 114688, 0, 0, 218104065, 0
    .long 2, 64, 72, 7168, 1024, 1024, 7340032, 2097152, 32768, 8, 61882368, 114688, 0, 0, 218104065, 0
    .long 1, 16, 16, 8192, 512, 768, 8388608, 524288, 32768, 8, 6299648, 131072, 0, 0, 218108170, 0
    .long 1, 16, 16, 8192, 512, 768, 8388608, 3145728, 32768, 8, 16785408, 131072, 0, 0, 218105866, 0
    .long 2, 64, 72, 7168, 1024, 1024, 7340032, 0, 32768, 8, 54542336, 114688, 0, 0, 218103809, 0
    .long 2, 64, 72, 7168, 1280, 1280, 7340032, 0, 32768, 8, 54546432, 114688, 0, 0, 218103809, 0
    .long 1, 16, 16, 8192, 1536, 1792, 8388608, 2621440, 32768, 8, 14704640, 131072, 0, 0, 218105626, 0
    .long 1, 24, 24, 8192, 1024, 1280, 8388608, 3145728, 32768, 8, 33570816, 131072, 0, 0, 218105882, 0
    .long 2, 64, 72, 7168, 1280, 1280, 7340032, 3145728, 32768, 8, 65556480, 114688, 0, 0, 218104193, 0
    .long 1, 32, 32, 8192, 512, 768, 8388608, 3145728, 32768, 8, 50339840, 131072, 0, 0, 218105866, 0
    .long 1, 16, 16, 8192, 1536, 1792, 8388608, 3670016, 32768, 8, 18898944, 131072, 0, 0, 218106138, 0
    .long 2, 64, 72, 7168, 1536, 1536, 7340032, 0, 32768, 8, 54550528, 114688, 0, 0, 218103809, 0
    .long 2, 64, 72, 7168, 512, 512, 7340032, 0, 32768, 8, 54534144, 114688, 0, 0, 218103809, 0
    .long 5, 218107904, 0, 0, 0, 0, 0, 4, 0, 0, 0, 0, 218112000, 8, 218106881, 0
    .long 2, 64, 72, 7168, 1536, 1536, 7340032, 3145728, 32768, 8, 65560576, 114688, 0, 0, 218104193, 0
    .long 2, 64, 72, 7168, 0, 0, 7340032, 524288, 32768, 8, 56360960, 114688, 0, 0, 218103873, 0
    .long 2, 64, 72, 7168, 1280, 1280, 7340032, 1572864, 32768, 8, 60051456, 114688, 0, 0, 218104001, 0
    .long 2, 64, 72, 7168, 1536, 1536, 7340032, 524288, 32768, 8, 56385536, 114688, 0, 0, 218103873, 0
    .long 1, 16, 16, 8192, 0, 256, 8388608, 3670016, 32768, 8, 18874368, 131072, 0, 0, 218106122, 0
    .long 5, 218108176, 0, 0, 4, 0, 0, 8, 0, 0, 0, 0, 218112000, 12, 218106945, 0
    .long 2, 64, 72, 7168, 0, 0, 7340032, 3145728, 32768, 8, 65536000, 114688, 0, 0, 218104193, 0
    .long 2, 64, 72, 7168, 512, 512, 7340032, 1572864, 32768, 8, 60039168, 114688, 0, 0, 218104001, 0
    .long 2, 64, 72, 7168, 768, 768, 7340032, 2097152, 32768, 8, 61878272, 114688, 0, 0, 218104065, 0
    .long 2, 64, 72, 7168, 0, 0, 7340032, 1572864, 32768, 8, 60030976, 114688, 0, 0, 218104001, 0
    .long 2, 64, 72, 7168, 768, 768, 7340032, 1572864, 32768, 8, 60043264, 114688, 0, 0, 218104001, 0
    .long 2, 64, 72, 7168, 1536, 1536, 7340032, 1572864, 32768, 8, 60055552, 114688, 0, 0, 218104001, 0
    .long 2, 64, 72, 7168, 256, 256, 7340032, 1572864, 32768, 8, 60035072, 114688, 0, 0, 218104001, 0
    .long 2, 64, 72, 7168, 256, 256, 7340032, 2097152, 32768, 8, 61870080, 114688, 0, 0, 218104065, 0
    .long 2, 64, 72, 7168, 1280, 1280, 7340032, 2097152, 32768, 8, 61886464, 114688, 0, 0, 218104065, 0
    .long 2, 64, 72, 7168, 512, 512, 7340032, 524288, 32768, 8, 56369152, 114688, 0, 0, 218103873, 0
    .long 2, 64, 72, 7168, 1536, 1536, 7340032, 2097152, 32768, 8, 61890560, 114688, 0, 0, 218104065, 0
    .long 2, 64, 72, 7168, 1024, 1024, 7340032, 1572864, 32768, 8, 60047360, 114688, 0, 0, 218104001, 0
    .long 2, 64, 72, 7168, 256, 256, 7340032, 1048576, 32768, 8, 58200064, 114688, 0, 0, 218103937, 0
    .long 2, 64, 72, 7168, 1024, 1024, 7340032, 1048576, 32768, 8, 58212352, 114688, 0, 0, 218103937, 0
    .long 2, 64, 72, 7168, 512, 512, 7340032, 3145728, 32768, 8, 65544192, 114688, 0, 0, 218104193, 0
    .long 2, 64, 72, 7168, 1280, 1280, 7340032, 1048576, 32768, 8, 58216448, 114688, 0, 0, 218103937, 0
    .long 5, 218108176, 0, 0, 4, 0, 0, 12, 0, 0, 0, 0, 218112000, 16, 218106945, 0
    .long 2, 64, 72, 7168, 1536, 1536, 7340032, 1048576, 32768, 8, 58220544, 114688, 0, 0, 218103937, 0
    .long 2, 64, 72, 7168, 1024, 1024, 7340032, 3145728, 32768, 8, 65552384, 114688, 0, 0, 218104193, 0
    .long 2, 64, 72, 7168, 1280, 1280, 7340032, 524288, 32768, 8, 56381440, 114688, 0, 0, 218103873, 0
    .long 2, 64, 72, 7168, 768, 768, 7340032, 1048576, 32768, 8, 58208256, 114688, 0, 0, 218103937, 0
    .long 2, 64, 72, 7168, 512, 512, 7340032, 1048576, 32768, 8, 58204160, 114688, 0, 0, 218103937, 0
    .long 2, 64, 72, 7168, 256, 256, 7340032, 3145728, 32768, 8, 65540096, 114688, 0, 0, 218104193, 0
    .long 5, 218108160, 0, 0, 0, 0, 0, 12, 0, 0, 0, 0, 218112000, 16, 218106945, 0
    .long 2, 64, 72, 7168, 768, 768, 7340032, 3670016, 32768, 8, 67383296, 114688, 0, 0, 218104257, 0
    .long 2, 64, 72, 7168, 1024, 1024, 7340032, 524288, 32768, 8, 56377344, 114688, 0, 0, 218103873, 0
    .long 1, 80, 80, 2048, 512, 768, 7340032, 54525952, 114688, 14, 117448704, 32768, 218103808, 14, 218106370, 0
    .long 1, 40, 40, 2048, 0, 256, 8388608, 176160768, 131072, 16, 75497472, 32768, 218106880, 8, 218106376, 0
    .long 5, 218108160, 0, 0, 0, 0, 0, 8, 0, 0, 0, 0, 218112000, 12, 218106945, 0
    .long 1, 32, 32, 8192, 0, 256, 8388608, 3670016, 32768, 8, 52428800, 131072, 0, 0, 218106122, 0
    .long 1, 16, 16, 8192, 512, 768, 8388608, 3670016, 32768, 8, 18882560, 131072, 0, 0, 218106122, 0
    .long 1, 16, 16, 8192, 1024, 1280, 8388608, 3670016, 32768, 8, 18890752, 131072, 0, 0, 218106138, 0
    .long 1, 40, 40, 2048, 512, 768, 8388608, 182452224, 131072, 16, 77078528, 32768, 218112000, 33, 218106568, 0
    .long 1, 40, 40, 2048, 512, 768, 8388608, 176160768, 131072, 16, 75505664, 32768, 218106880, 8, 218106376, 0
    .long 2, 64, 72, 7168, 768, 768, 7340032, 3145728, 32768, 8, 65548288, 114688, 0, 0, 218104193, 0
    .long 1, 40, 40, 2048, 0, 256, 8388608, 180355072, 131072, 16, 76546048, 32768, 218112000, 25, 218106504, 0
    .long 1, 40, 40, 2048, 512, 768, 8388608, 180355072, 131072, 16, 76554240, 32768, 218112000, 25, 218106504, 0
    .long 2, 64, 72, 7168, 1280, 1280, 7340032, 2621440, 32768, 8, 63721472, 114688, 0, 0, 218104129, 0
    .long 1, 40, 40, 2048, 0, 256, 8388608, 182452224, 131072, 16, 77070336, 32768, 218112000, 33, 218106568, 0
    .long 2, 64, 72, 7168, 0, 0, 7340032, 2621440, 32768, 8, 63700992, 114688, 0, 0, 218104129, 0
    .long 1, 80, 80, 2048, 0, 256, 7340032, 54525952, 114688, 14, 117440512, 32768, 218103808, 14, 218106370, 0
    .long 2, 64, 72, 7168, 1536, 1536, 7340032, 2621440, 32768, 8, 63725568, 114688, 0, 0, 218104129, 0
    .long 2, 64, 72, 7168, 256, 256, 7340032, 2621440, 32768, 8, 63705088, 114688, 0, 0, 218104129, 0
    .long 2, 64, 72, 7168, 512, 512, 7340032, 3670016, 32768, 8, 67379200, 114688, 0, 0, 218104257, 0
    .long 2, 64, 72, 7168, 1280, 1280, 7340032, 3670016, 32768, 8, 67391488, 114688, 0, 0, 218104257, 0
    .long 1, 40, 40, 2048, 0, 256, 8388608, 178257920, 131072, 16, 76021760, 32768, 218106944, 8, 218106440, 0
    .long 1, 40, 40, 2048, 512, 768, 8388608, 178257920, 131072, 16, 76029952, 32768, 218106944, 8, 218106440, 0
    .long 2, 64, 72, 7168, 768, 768, 7340032, 2621440, 32768, 8, 63713280, 114688, 0, 0, 218104129, 0
    .long 2, 64, 72, 7168, 0, 0, 7340032, 3670016, 32768, 8, 67371008, 114688, 0, 0, 218104257, 0
    .long 2, 64, 72, 7168, 512, 512, 7340032, 2621440, 32768, 8, 63709184, 114688, 0, 0, 218104129, 0
    .long 1, 80, 80, 2048, 512, 768, 7340032, 61865984, 114688, 14, 119545856, 32768, 218104064, 14, 218106626, 0
    .long 1, 80, 80, 2048, 0, 256, 7340032, 60030976, 114688, 14, 119013376, 32768, 218104000, 14, 218106562, 0
    .long 1, 80, 80, 2048, 0, 256, 7340032, 61865984, 114688, 14, 119537664, 32768, 218104064, 14, 218106626, 0
    .long 1, 80, 80, 2048, 512, 768, 7340032, 60030976, 114688, 14, 119021568, 32768, 218104000, 14, 218106562, 0
    .long 2, 64, 72, 7168, 1024, 1024, 7340032, 3670016, 32768, 8, 67387392, 114688, 0, 0, 218104257, 0
    .long 2, 64, 72, 7168, 256, 256, 7340032, 3670016, 32768, 8, 67375104, 114688, 0, 0, 218104257, 0
    .long 1, 80, 80, 2048, 0, 256, 7340032, 58195968, 114688, 14, 118489088, 32768, 218103936, 14, 218106498, 0
    .long 1, 80, 80, 2048, 512, 768, 7340032, 58195968, 114688, 14, 118497280, 32768, 218103936, 14, 218106498, 0
    .long 2, 64, 72, 7168, 1536, 1536, 7340032, 3670016, 32768, 8, 67395584, 114688, 0, 0, 218104257, 0
    .long 1, 80, 80, 2048, 512, 768, 7340032, 56360960, 114688, 14, 117972992, 32768, 218103872, 14, 218106434, 0
    .long 1, 80, 80, 2048, 0, 256, 7340032, 56360960, 114688, 14, 117964800, 32768, 218103872, 14, 218106434, 0
    .long 1, 40, 40, 2048, 512, 768, 8388608, 184549376, 131072, 8, 77602816, 32768, 218112000, 41, 218106628, 0
    .long 1, 80, 80, 2048, 0, 256, 7340032, 65536000, 114688, 7, 120586240, 32768, 218104192, 7, 218106753, 0
    .long 1, 80, 80, 2048, 512, 768, 7340032, 65536000, 114688, 7, 120594432, 32768, 218104192, 7, 218106753, 0
    .long 1, 40, 40, 2048, 0, 256, 8388608, 184549376, 131072, 8, 77594624, 32768, 218112000, 41, 218106628, 0
    .long 1, 80, 80, 2048, 1536, 1792, 7340032, 65536000, 114688, 7, 120610816, 32768, 218104192, 7, 218106753, 0
    .long 1, 40, 40, 2048, 1024, 1280, 8388608, 184549376, 131072, 8, 77611008, 32768, 218112000, 41, 218106628, 0
    .long 1, 40, 40, 2048, 1536, 1792, 8388608, 184549376, 131072, 8, 77619200, 32768, 218112000, 41, 218106628, 0
    .long 1, 40, 40, 2048, 512, 768, 8388608, 186646528, 131072, 8, 78127104, 32768, 218112000, 49, 218106692, 0
    .long 1, 80, 80, 2048, 1024, 1280, 7340032, 65536000, 114688, 7, 120602624, 32768, 218104192, 7, 218106753, 0
    .long 1, 40, 40, 2048, 1024, 1280, 8388608, 186646528, 131072, 8, 78135296, 32768, 218112000, 49, 218106692, 0
    .long 1, 40, 40, 2048, 0, 256, 8388608, 186646528, 131072, 8, 78118912, 32768, 218112000, 49, 218106692, 0
    .long 1, 40, 40, 2048, 1536, 1792, 8388608, 186646528, 131072, 8, 78143488, 32768, 218112000, 49, 218106692, 0
    .long 1, 80, 80, 2048, 1024, 1280, 7340032, 63700992, 114688, 7, 120078336, 32768, 218104128, 7, 218106689, 0
    .long 1, 80, 80, 2048, 1536, 1792, 7340032, 63700992, 114688, 7, 120086528, 32768, 218104128, 7, 218106689, 0
    .long 1, 80, 80, 2048, 0, 256, 7340032, 63700992, 114688, 7, 120061952, 32768, 218104128, 7, 218106689, 0
    .long 1, 80, 80, 2048, 512, 768, 7340032, 63700992, 114688, 7, 120070144, 32768, 218104128, 7, 218106689, 0
    .long 1, 80, 80, 2048, 512, 768, 7340032, 67371008, 114688, 7, 121118720, 32768, 218104256, 7, 218106817, 0
    .long 1, 80, 80, 2048, 1024, 1280, 7340032, 67371008, 114688, 7, 121126912, 32768, 218104256, 7, 218106817, 0
    .long 1, 80, 80, 2048, 1536, 1792, 7340032, 67371008, 114688, 7, 121135104, 32768, 218104256, 7, 218106817, 0
    .long 1, 80, 80, 2048, 0, 256, 7340032, 67371008, 114688, 7, 121110528, 32768, 218104256, 7, 218106817, 0
    .long 6, 1, 3, 2, 0, 16, 0, 3, 0, 0, 0, 0, 0, 0, 0, 0
    .long 6, 0, 51, 0, 0, 0, 0, 51, 0, 0, 0, 0, 0, 0, 0, 0
    .long 6, 1, 1, 2, 0, 16, 0, 1, 0, 0, 0, 0, 0, 0, 0, 0
    .long 6, 1, 0, 2, 0, 16, 0, 0, 0, 0, 0, 0, 0, 0, 0, 0
    .long 6, 1, 5, 2, 0, 16, 0, 5, 0, 0, 0, 0, 0, 0, 0, 0
    .long 6, 1, 4, 2, 0, 16, 0, 4, 0, 0, 0, 0, 0, 0, 0, 0
    .long 6, 1, 22, 2, 0, 16, 0, 22, 0, 0, 0, 0, 0, 0, 0, 0
    .long 6, 1, 6, 2, 0, 16, 0, 6, 0, 0, 0, 0, 0, 0, 0, 0
    .long 6, 1, 18, 2, 0, 16, 0, 18, 0, 0, 0, 0, 0, 0, 0, 0
    .long 6, 1, 19, 2, 0, 16, 0, 19, 0, 0, 0, 0, 0, 0, 0, 0
    .long 6, 1, 20, 2, 0, 16, 0, 20, 0, 0, 0, 0, 0, 0, 0, 0
    .long 6, 1, 7, 2, 0, 16, 0, 7, 0, 0, 0, 0, 0, 0, 0, 0
    .long 6, 1, 2, 2, 0, 16, 0, 2, 0, 0, 0, 0, 0, 0, 0, 0
    .long 6, 1, 17, 2, 0, 16, 0, 17, 0, 0, 0, 0, 0, 0, 0, 0
    .long 6, 1, 21, 2, 0, 16, 0, 21, 0, 0, 0, 0, 0, 0, 0, 0
    .long 6, 1, 16, 2, 0, 16, 0, 16, 0, 0, 0, 0, 0, 0, 0, 0
    .long 6, 0, 50, 0, 0, 0, 0, 50, 0, 0, 0, 0, 0, 0, 0, 0
    .long 6, 0, 52, 0, 0, 0, 0, 52, 0, 0, 0, 0, 0, 0, 0, 0
    .long 6, 0, 54, 0, 0, 0, 0, 54, 0, 0, 0, 0, 0, 0, 0, 0
    .long 6, 0, 49, 0, 0, 0, 0, 49, 0, 0, 0, 0, 0, 0, 0, 0
    .long 6, 0, 48, 0, 0, 0, 0, 48, 0, 0, 0, 0, 0, 0, 0, 0
    .long 6, 0, 53, 0, 0, 0, 0, 53, 0, 0, 0, 0, 0, 0, 0, 0
    .long 6, 0, 55, 0, 0, 0, 0, 55, 0, 0, 0, 0, 0, 0, 0, 0
    .long 6, 0, 56, 0, 0, 0, 0, 56, 0, 0, 0, 0, 0, 0, 0, 0
    .long 6, 1, 23, 2, 0, 16, 0, 23, 0, 0, 0, 0, 0, 0, 0, 0
    .long 6, 1, 24, 2, 0, 16, 0, 24, 0, 0, 0, 0, 0, 0, 0, 0
    .long 6, 1, 25, 2, 0, 16, 0, 25, 0, 0, 0, 0, 0, 0, 0, 0
    .long 6, 1, 26, 2, 0, 16, 0, 26, 0, 0, 0, 0, 0, 0, 0, 0
    .long 6, 1, 27, 2, 0, 16, 0, 27, 0, 0, 0, 0, 0, 0, 0, 0
    .long 6, 1, 28, 2, 0, 16, 0, 28, 0, 0, 0, 0, 0, 0, 0, 0
    .long 6, 1, 29, 2, 0, 16, 0, 29, 0, 0, 0, 0, 0, 0, 0, 0
    .long 6, 1, 30, 2, 0, 16, 0, 30, 0, 0, 0, 0, 0, 0, 0, 0
    .long 6, 1, 31, 2, 0, 16, 0, 31, 0, 0, 0, 0, 0, 0, 0, 0
    .long 6, 0, 40, 1, 0, 16, 0, 40, 0, 0, 0, 0, 0, 0, 0, 0
    .long 6, 0, 41, 1, 0, 16, 0, 41, 0, 0, 0, 0, 0, 0, 0, 0
    .long 6, 0, 43, 1, 0, 16, 0, 43, 0, 0, 0, 0, 0, 0, 0, 0
    .long 6, 0, 45, 1, 0, 16, 0, 45, 0, 0, 0, 0, 0, 0, 0, 0
    .long 6, 0, 46, 1, 0, 16, 0, 46, 0, 0, 0, 0, 0, 0, 0, 0
    .long 6, 0, 47, 1, 0, 16, 0, 47, 0, 0, 0, 0, 0, 0, 0, 0
    .long 6, 1, 32, 1, 0, 16, 0, 32, 0, 0, 0, 0, 0, 0, 0, 0
    .long 6, 1, 33, 1, 0, 16, 0, 33, 0, 0, 0, 0, 0, 0, 0, 0
    .long 6, 1, 35, 1, 0, 16, 0, 35, 0, 0, 0, 0, 0, 0, 0, 0
    .long 6, 1, 36, 1, 0, 16, 0, 36, 0, 0, 0, 0, 0, 0, 0, 0
    .long 6, 1, 38, 1, 0, 16, 0, 38, 0, 0, 0, 0, 0, 0, 0, 0
    .long 6, 1, 39, 1, 0, 16, 0, 39, 0, 0, 0, 0, 0, 0, 0, 0
    .long 6, 0, 57, 0, 0, 0, 0, 57, 0, 0, 0, 0, 0, 0, 0, 0
    .long 6, 0, 44, 1, 0, 16, 0, 44, 0, 0, 0, 0, 0, 0, 0, 0
    .long 6, 1, 34, 1, 0, 16, 0, 34, 0, 0, 0, 0, 0, 0, 0, 0
    .long 6, 0, 58, 0, 0, 0, 0, 58, 0, 0, 0, 0, 0, 0, 0, 0
    .long 6, 1, 37, 1, 0, 16, 0, 37, 0, 0, 0, 0, 0, 0, 0, 0
    .long 6, 0, 42, 1, 0, 16, 0, 42, 0, 0, 0, 0, 0, 0, 0, 0
    .long 6, 0, 59, 0, 0, 0, 0, 59, 0, 0, 0, 0, 0, 0, 0, 0
    .long 6, 1, 8, 2, 0, 16, 0, 8, 0, 0, 0, 0, 0, 0, 0, 0
    .long 6, 1, 9, 2, 0, 16, 0, 9, 0, 0, 0, 0, 0, 0, 0, 0
    .long 6, 1, 10, 2, 0, 16, 0, 10, 0, 0, 0, 0, 0, 0, 0, 0
    .long 6, 1, 11, 2, 0, 16, 0, 11, 0, 0, 0, 0, 0, 0, 0, 0
    .long 6, 1, 12, 2, 0, 16, 0, 12, 0, 0, 0, 0, 0, 0, 0, 0
    .long 6, 1, 13, 2, 0, 16, 0, 13, 0, 0, 0, 0, 0, 0, 0, 0
    .long 6, 1, 14, 2, 0, 16, 0, 14, 0, 0, 0, 0, 0, 0, 0, 0
    .long 6, 1, 15, 2, 0, 16, 0, 15, 0, 0, 0, 0, 0, 0, 0, 0
    .long 7, 0, 60, 0, 0, 0, 0, 60, 0, 0, 0, 0, 0, 0, 0, 0
    .long 7, 0, 60, 0, 1, 0, 0, 60, 0, 0, 0, 0, 0, 0, 0, 0
    .long 7, 0, 60, 0, 2, 0, 0, 60, 0, 0, 0, 0, 0, 0, 0, 0
    .long 7, 0, 60, 0, 3, 0, 0, 60, 0, 0, 0, 0, 0, 0, 0, 0
    .long 7, 0, 61, 0, 0, 0, 0, 61, 0, 0, 0, 0, 0, 0, 0, 0
    .long 7, 0, 61, 0, 1, 0, 0, 61, 0, 0, 0, 0, 0, 0, 0, 0
    .long 7, 0, 61, 0, 2, 0, 0, 61, 0, 0, 0, 0, 0, 0, 0, 0
    .long 7, 0, 61, 0, 3, 0, 0, 61, 0, 0, 0, 0, 0, 0, 0, 0
    .long 7, 0, 62, 0, 0, 0, 0, 62, 0, 0, 0, 0, 0, 0, 0, 0
    .long 7, 0, 62, 0, 1, 0, 0, 62, 0, 0, 0, 0, 0, 0, 0, 0
    .long 7, 0, 62, 0, 2, 0, 0, 62, 0, 0, 0, 0, 0, 0, 0, 0
    .long 7, 0, 62, 0, 3, 0, 0, 62, 0, 0, 0, 0, 0, 0, 0, 0
    .long 7, 0, 63, 0, 0, 0, 0, 63, 0, 0, 0, 0, 0, 0, 0, 0
    .long 7, 0, 63, 0, 1, 0, 0, 63, 0, 0, 0, 0, 0, 0, 0, 0
    .long 7, 0, 63, 0, 2, 0, 0, 63, 0, 0, 0, 0, 0, 0, 0, 0
    .long 7, 0, 63, 0, 3, 0, 0, 63, 0, 0, 0, 0, 0, 0, 0, 0
    .long 0, 0, 0, 0, 0, 0, 0, 0, 0, 0, 0, 0, 0, 0, 0, 0
    .long 4, 24, 24, 8192, 2048, 264192, 8388608, 0, 32768, 4, 21004288, 131072, 0, 0, 218104353, 0
    .long 4, 24, 24, 8192, 2304, 264448, 8388608, 0, 32768, 4, 21008384, 131072, 0, 0, 218104353, 0
    .long 4, 24, 24, 8192, 2560, 264704, 8388608, 0, 32768, 4, 21012480, 131072, 0, 0, 218104353, 0
    .long 4, 24, 24, 8192, 2816, 264960, 8388608, 0, 32768, 4, 21016576, 131072, 0, 0, 218104353, 0
    .long 4, 24, 24, 8192, 3072, 265216, 8388608, 0, 32768, 4, 21020672, 131072, 0, 0, 218104369, 0
    .long 4, 24, 24, 8192, 3328, 265472, 8388608, 0, 32768, 4, 21024768, 131072, 0, 0, 218104369, 0
    .long 4, 24, 24, 8192, 3584, 265728, 8388608, 0, 32768, 4, 21028864, 131072, 0, 0, 218104369, 0
    .long 4, 24, 24, 8192, 3840, 265984, 8388608, 0, 32768, 4, 21032960, 131072, 0, 0, 218104369, 0
    .long 4, 32, 32, 8192, 2048, 264192, 8388608, 0, 32768, 4, 37781504, 131072, 0, 0, 218104353, 0
    .long 4, 32, 32, 8192, 2304, 264448, 8388608, 0, 32768, 4, 37785600, 131072, 0, 0, 218104353, 0
    .long 4, 32, 32, 8192, 2560, 264704, 8388608, 0, 32768, 4, 37789696, 131072, 0, 0, 218104353, 0
    .long 4, 32, 32, 8192, 2816, 264960, 8388608, 0, 32768, 4, 37793792, 131072, 0, 0, 218104353, 0
    .long 4, 32, 32, 8192, 3072, 265216, 8388608, 0, 32768, 4, 37797888, 131072, 0, 0, 218104369, 0
    .long 4, 32, 32, 8192, 3328, 265472, 8388608, 0, 32768, 4, 37801984, 131072, 0, 0, 218104369, 0
    .long 4, 32, 32, 8192, 3584, 265728, 8388608, 0, 32768, 4, 37806080, 131072, 0, 0, 218104369, 0
    .long 4, 32, 32, 8192, 3840, 265984, 8388608, 0, 32768, 4, 37810176, 131072, 0, 0, 218104369, 0
    .long 4, 24, 24, 8192, 2048, 264192, 8388608, 262144, 32768, 4, 22052864, 131072, 0, 0, 218104356, 0
    .long 4, 24, 24, 8192, 2304, 264448, 8388608, 262144, 32768, 4, 22056960, 131072, 0, 0, 218104356, 0
    .long 4, 24, 24, 8192, 2560, 264704, 8388608, 262144, 32768, 4, 22061056, 131072, 0, 0, 218104356, 0
    .long 4, 24, 24, 8192, 2816, 264960, 8388608, 262144, 32768, 4, 22065152, 131072, 0, 0, 218104356, 0
    .long 4, 24, 24, 8192, 3072, 265216, 8388608, 262144, 32768, 4, 22069248, 131072, 0, 0, 218104372, 0
    .long 4, 24, 24, 8192, 3328, 265472, 8388608, 262144, 32768, 4, 22073344, 131072, 0, 0, 218104372, 0
    .long 4, 24, 24, 8192, 3584, 265728, 8388608, 262144, 32768, 4, 22077440, 131072, 0, 0, 218104372, 0
    .long 4, 24, 24, 8192, 3840, 265984, 8388608, 262144, 32768, 4, 22081536, 131072, 0, 0, 218104372, 0
    .long 4, 32, 32, 8192, 2048, 264192, 8388608, 262144, 32768, 4, 38830080, 131072, 0, 0, 218104356, 0
    .long 4, 32, 32, 8192, 2304, 264448, 8388608, 262144, 32768, 4, 38834176, 131072, 0, 0, 218104356, 0
    .long 4, 32, 32, 8192, 2560, 264704, 8388608, 262144, 32768, 4, 38838272, 131072, 0, 0, 218104356, 0
    .long 4, 32, 32, 8192, 2816, 264960, 8388608, 262144, 32768, 4, 38842368, 131072, 0, 0, 218104356, 0
    .long 4, 32, 32, 8192, 3072, 265216, 8388608, 262144, 32768, 4, 38846464, 131072, 0, 0, 218104372, 0
    .long 4, 32, 32, 8192, 3328, 265472, 8388608, 262144, 32768, 4, 38850560, 131072, 0, 0, 218104372, 0
    .long 4, 32, 32, 8192, 3584, 265728, 8388608, 262144, 32768, 4, 38854656, 131072, 0, 0, 218104372, 0
    .long 4, 32, 32, 8192, 3840, 265984, 8388608, 262144, 32768, 4, 38858752, 131072, 0, 0, 218104372, 0
    .long 4, 32, 32, 8192, 2304, 264448, 8388608, 786432, 32768, 4, 40931328, 131072, 0, 0, 218104612, 0
    .long 4, 24, 24, 8192, 2560, 264704, 8388608, 786432, 32768, 4, 24158208, 131072, 0, 0, 218104612, 0
    .long 4, 24, 24, 8192, 3584, 265728, 8388608, 786432, 32768, 4, 24174592, 131072, 0, 0, 218104628, 0
    .long 4, 32, 32, 8192, 2816, 264960, 8388608, 524288, 32768, 4, 39890944, 131072, 0, 0, 218104609, 0
    .long 4, 32, 32, 8192, 3584, 265728, 8388608, 786432, 32768, 4, 40951808, 131072, 0, 0, 218104628, 0
    .long 4, 32, 32, 8192, 3328, 265472, 8388608, 524288, 32768, 4, 39899136, 131072, 0, 0, 218104625, 0
    .long 4, 24, 24, 8192, 3072, 265216, 8388608, 786432, 32768, 4, 24166400, 131072, 0, 0, 218104628, 0
    .long 4, 32, 32, 8192, 3840, 265984, 8388608, 524288, 32768, 4, 39907328, 131072, 0, 0, 218104625, 0
    .long 4, 32, 32, 8192, 2560, 264704, 8388608, 786432, 32768, 4, 40935424, 131072, 0, 0, 218104612, 0
    .long 4, 32, 32, 8192, 2560, 264704, 8388608, 524288, 32768, 4, 39886848, 131072, 0, 0, 218104609, 0
    .long 4, 32, 32, 8192, 3072, 265216, 8388608, 786432, 32768, 4, 40943616, 131072, 0, 0, 218104628, 0
    .long 4, 24, 24, 8192, 2816, 264960, 8388608, 524288, 32768, 4, 23113728, 131072, 0, 0, 218104609, 0
    .long 2, 64, 72, 7168, 1792, 1792, 7340032, 1048576, 32768, 8, 58224640, 114688, 0, 0, 218103937, 0
    .long 4, 24, 24, 8192, 2304, 264448, 8388608, 786432, 32768, 4, 24154112, 131072, 0, 0, 218104612, 0
    .long 4, 24, 24, 8192, 3328, 265472, 8388608, 524288, 32768, 4, 23121920, 131072, 0, 0, 218104625, 0
    .long 4, 32, 32, 8192, 2304, 264448, 8388608, 524288, 32768, 4, 39882752, 131072, 0, 0, 218104609, 0
    .long 4, 32, 32, 8192, 3840, 265984, 8388608, 786432, 32768, 4, 40955904, 131072, 0, 0, 218104628, 0
    .long 4, 24, 24, 8192, 2048, 264192, 8388608, 524288, 32768, 4, 23101440, 131072, 0, 0, 218104609, 0
    .long 4, 24, 24, 8192, 3584, 265728, 8388608, 524288, 32768, 4, 23126016, 131072, 0, 0, 218104625, 0
    .long 4, 32, 32, 8192, 2048, 264192, 8388608, 524288, 32768, 4, 39878656, 131072, 0, 0, 218104609, 0
    .long 4, 24, 24, 8192, 3840, 265984, 8388608, 524288, 32768, 4, 23130112, 131072, 0, 0, 218104625, 0
    .long 4, 32, 32, 8192, 2048, 264192, 8388608, 786432, 32768, 4, 40927232, 131072, 0, 0, 218104612, 0
    .long 4, 24, 24, 8192, 2816, 264960, 8388608, 786432, 32768, 4, 24162304, 131072, 0, 0, 218104612, 0
    .long 4, 32, 32, 8192, 2816, 264960, 8388608, 786432, 32768, 4, 40939520, 131072, 0, 0, 218104612, 0
    .long 4, 32, 32, 8192, 3584, 265728, 8388608, 524288, 32768, 4, 39903232, 131072, 0, 0, 218104625, 0
    .long 4, 24, 24, 8192, 3072, 265216, 8388608, 524288, 32768, 4, 23117824, 131072, 0, 0, 218104625, 0
    .long 4, 32, 32, 8192, 3328, 265472, 8388608, 786432, 32768, 4, 40947712, 131072, 0, 0, 218104628, 0
    .long 4, 24, 24, 8192, 2304, 264448, 8388608, 524288, 32768, 4, 23105536, 131072, 0, 0, 218104609, 0
    .long 4, 32, 32, 8192, 3072, 265216, 8388608, 524288, 32768, 4, 39895040, 131072, 0, 0, 218104625, 0
    .long 4, 24, 24, 8192, 2560, 264704, 8388608, 524288, 32768, 4, 23109632, 131072, 0, 0, 218104609, 0
    .long 4, 24, 24, 8192, 3328, 265472, 8388608, 786432, 32768, 4, 24170496, 131072, 0, 0, 218104628, 0
    .long 4, 24, 24, 8192, 2048, 264192, 8388608, 786432, 32768, 4, 24150016, 131072, 0, 0, 218104612, 0
    .long 1, 32, 32, 8192, 3072, 3328, 8388608, 1048576, 32768, 8, 41992192, 131072, 0, 0, 218104890, 0
    .long 1, 24, 24, 8192, 2560, 2816, 8388608, 1048576, 32768, 8, 25206784, 131072, 0, 0, 218104874, 0
    .long 1, 16, 16, 8192, 2560, 2816, 8388608, 1048576, 32768, 8, 8429568, 131072, 0, 0, 218104874, 0
    .long 1, 24, 24, 8192, 3072, 3328, 8388608, 1048576, 32768, 8, 25214976, 131072, 0, 0, 218104890, 0
    .long 4, 24, 24, 8192, 3840, 265984, 8388608, 786432, 32768, 4, 24178688, 131072, 0, 0, 218104628, 0
    .long 1, 16, 16, 8192, 2048, 2304, 8388608, 1048576, 32768, 8, 8421376, 131072, 0, 0, 218104874, 0
    .long 1, 24, 24, 8192, 2560, 2816, 8388608, 1572864, 32768, 8, 27303936, 131072, 0, 0, 218105130, 0
    .long 1, 32, 32, 8192, 3072, 3328, 8388608, 1572864, 32768, 8, 44089344, 131072, 0, 0, 218105146, 0
    .long 1, 24, 24, 8192, 2048, 2304, 8388608, 1048576, 32768, 8, 25198592, 131072, 0, 0, 218104874, 0
    .long 1, 32, 32, 8192, 2560, 2816, 8388608, 1048576, 32768, 8, 41984000, 131072, 0, 0, 218104874, 0
    .long 1, 16, 16, 8192, 3584, 3840, 8388608, 1572864, 32768, 8, 10543104, 131072, 0, 0, 218105146, 0
    .long 1, 16, 16, 8192, 2048, 2304, 8388608, 0, 32768, 8, 4227072, 131072, 0, 0, 218107946, 0
    .long 1, 24, 24, 8192, 3072, 3328, 8388608, 1572864, 32768, 8, 27312128, 131072, 0, 0, 218105146, 0
    .long 1, 32, 32, 8192, 3584, 3840, 8388608, 1572864, 32768, 8, 44097536, 131072, 0, 0, 218105146, 0
    .long 1, 32, 32, 8192, 2048, 2304, 8388608, 1048576, 32768, 8, 41975808, 131072, 0, 0, 218104874, 0
    .long 1, 16, 16, 8192, 3072, 3328, 8388608, 1572864, 32768, 8, 10534912, 131072, 0, 0, 218105146, 0
    .long 1, 32, 32, 8192, 3584, 3840, 8388608, 1048576, 32768, 8, 42000384, 131072, 0, 0, 218104890, 0
    .long 1, 24, 24, 8192, 3584, 3840, 8388608, 1572864, 32768, 8, 27320320, 131072, 0, 0, 218105146, 0
    .long 1, 16, 16, 8192, 3584, 3840, 8388608, 1048576, 32768, 8, 8445952, 131072, 0, 0, 218104890, 0
    .long 1, 32, 32, 8192, 2048, 2304, 8388608, 1572864, 32768, 8, 44072960, 131072, 0, 0, 218105130, 0
    .long 1, 16, 16, 8192, 3584, 3840, 8388608, 0, 32768, 8, 4251648, 131072, 0, 0, 218107962, 0
    .long 1, 16, 16, 8192, 2560, 2816, 8388608, 2097152, 32768, 8, 12623872, 131072, 0, 0, 218105386, 0
    .long 1, 16, 16, 8192, 3072, 3328, 8388608, 1048576, 32768, 8, 8437760, 131072, 0, 0, 218104890, 0
    .long 1, 16, 16, 8192, 2048, 2304, 8388608, 1572864, 32768, 8, 10518528, 131072, 0, 0, 218105130, 0
    .long 1, 32, 32, 8192, 2048, 2304, 8388608, 2097152, 32768, 8, 46170112, 131072, 0, 0, 218105386, 0
    .long 1, 16, 16, 8192, 2560, 2816, 8388608, 0, 32768, 8, 4235264, 131072, 0, 0, 218107946, 0
    .long 1, 24, 24, 8192, 3584, 3840, 8388608, 1048576, 32768, 8, 25223168, 131072, 0, 0, 218104890, 0
    .long 1, 16, 16, 8192, 2560, 2816, 8388608, 1572864, 32768, 8, 10526720, 131072, 0, 0, 218105130, 0
    .long 1, 16, 16, 8192, 3072, 3328, 8388608, 0, 32768, 8, 4243456, 131072, 0, 0, 218107962, 0
    .long 1, 32, 32, 8192, 2560, 2816, 8388608, 2097152, 32768, 8, 46178304, 131072, 0, 0, 218105386, 0
    .long 1, 32, 32, 8192, 2560, 2816, 8388608, 1572864, 32768, 8, 44081152, 131072, 0, 0, 218105130, 0
    .long 1, 24, 24, 8192, 2048, 2304, 8388608, 1572864, 32768, 8, 27295744, 131072, 0, 0, 218105130, 0
    .long 1, 16, 16, 8192, 2048, 2304, 8388608, 524288, 32768, 8, 6324224, 131072, 0, 0, 218108202, 0
    .long 1, 32, 32, 8192, 3072, 3328, 8388608, 3670016, 32768, 8, 52477952, 131072, 0, 0, 218106170, 0
    .long 1, 16, 16, 8192, 3072, 3328, 8388608, 2621440, 32768, 8, 14729216, 131072, 0, 0, 218105658, 0
    .long 1, 24, 24, 8192, 2560, 2816, 8388608, 3145728, 32768, 8, 33595392, 131072, 0, 0, 218105898, 0
    .long 1, 16, 16, 8192, 2048, 2304, 8388608, 2621440, 32768, 8, 14712832, 131072, 0, 0, 218105642, 0
    .long 1, 32, 32, 8192, 3584, 3840, 8388608, 3670016, 32768, 8, 52486144, 131072, 0, 0, 218106170, 0
    .long 1, 16, 16, 8192, 2048, 2304, 8388608, 3145728, 32768, 8, 16809984, 131072, 0, 0, 218105898, 0
    .long 1, 24, 24, 8192, 3072, 3328, 8388608, 2097152, 32768, 8, 29409280, 131072, 0, 0, 218105402, 0
    .long 1, 16, 16, 8192, 3584, 3840, 8388608, 2097152, 32768, 8, 12640256, 131072, 0, 0, 218105402, 0
    .long 1, 24, 24, 8192, 2560, 2816, 8388608, 3670016, 32768, 8, 35692544, 131072, 0, 0, 218106154, 0
    .long 1, 24, 24, 8192, 3584, 3840, 8388608, 3145728, 32768, 8, 33611776, 131072, 0, 0, 218105914, 0
    .long 1, 32, 32, 8192, 3584, 3840, 8388608, 2621440, 32768, 8, 48291840, 131072, 0, 0, 218105658, 0
    .long 1, 32, 32, 8192, 3584, 3840, 8388608, 2097152, 32768, 8, 46194688, 131072, 0, 0, 218105402, 0
    .long 1, 24, 24, 8192, 3584, 3840, 8388608, 2097152, 32768, 8, 29417472, 131072, 0, 0, 218105402, 0
    .long 1, 24, 24, 8192, 2048, 2304, 8388608, 2097152, 32768, 8, 29392896, 131072, 0, 0, 218105386, 0
    .long 1, 32, 32, 8192, 3584, 3840, 8388608, 3145728, 32768, 8, 50388992, 131072, 0, 0, 218105914, 0
    .long 1, 32, 32, 8192, 2048, 2304, 8388608, 3145728, 32768, 8, 50364416, 131072, 0, 0, 218105898, 0
    .long 1, 16, 16, 8192, 3072, 3328, 8388608, 3145728, 32768, 8, 16826368, 131072, 0, 0, 218105914, 0
    .long 1, 16, 16, 8192, 3072, 3328, 8388608, 2097152, 32768, 8, 12632064, 131072, 0, 0, 218105402, 0
    .long 5, 218107952, 0, 0, 12, 0, 0, 0, 0, 0, 0, 0, 218112128, 4, 218106881, 0
    .long 1, 32, 32, 8192, 3072, 3328, 8388608, 3145728, 32768, 8, 50380800, 131072, 0, 0, 218105914, 0
    .long 1, 24, 24, 8192, 3584, 3840, 8388608, 3670016, 32768, 8, 35708928, 131072, 0, 0, 218106170, 0
    .long 1, 32, 32, 8192, 2048, 2304, 8388608, 2621440, 32768, 8, 48267264, 131072, 0, 0, 218105642, 0
    .long 1, 32, 32, 8192, 3072, 3328, 8388608, 2097152, 32768, 8, 46186496, 131072, 0, 0, 218105402, 0
    .long 1, 24, 24, 8192, 2560, 2816, 8388608, 2621440, 32768, 8, 31498240, 131072, 0, 0, 218105642, 0
    .long 1, 24, 24, 8192, 2560, 2816, 8388608, 2097152, 32768, 8, 29401088, 131072, 0, 0, 218105386, 0
    .long 1, 16, 16, 8192, 3584, 3840, 8388608, 524288, 32768, 8, 6348800, 131072, 0, 0, 218108218, 0
    .long 1, 32, 32, 8192, 3072, 3328, 8388608, 2621440, 32768, 8, 48283648, 131072, 0, 0, 218105658, 0
    .long 1, 16, 16, 8192, 3072, 3328, 8388608, 524288, 32768, 8, 6340608, 131072, 0, 0, 218108218, 0
    .long 1, 24, 24, 8192, 2048, 2304, 8388608, 2621440, 32768, 8, 31490048, 131072, 0, 0, 218105642, 0
    .long 1, 16, 16, 8192, 2048, 2304, 8388608, 2097152, 32768, 8, 12615680, 131072, 0, 0, 218105386, 0
    .long 5, 218107952, 0, 0, 12, 0, 0, 4, 0, 0, 0, 0, 218112128, 8, 218106881, 0
    .long 5, 218107936, 0, 0, 8, 0, 0, 0, 0, 0, 0, 0, 218112128, 4, 218106881, 0
    .long 1, 24, 24, 8192, 3072, 3328, 8388608, 3670016, 32768, 8, 35700736, 131072, 0, 0, 218106170, 0
    .long 2, 64, 72, 7168, 1792, 1792, 7340032, 2097152, 32768, 8, 61894656, 114688, 0, 0, 218104065, 0
    .long 1, 24, 24, 8192, 3584, 3840, 8388608, 2621440, 32768, 8, 31514624, 131072, 0, 0, 218105658, 0
    .long 2, 64, 72, 7168, 2048, 2048, 7340032, 0, 32768, 8, 54558720, 114688, 0, 0, 218103809, 0
    .long 1, 24, 24, 8192, 2048, 2304, 8388608, 3670016, 32768, 8, 35684352, 131072, 0, 0, 218106154, 0
    .long 1, 32, 32, 8192, 2560, 2816, 8388608, 3670016, 32768, 8, 52469760, 131072, 0, 0, 218106154, 0
    .long 2, 64, 72, 7168, 2816, 2816, 7340032, 2621440, 32768, 8, 63746048, 114688, 0, 0, 218104132, 0
    .long 1, 32, 32, 8192, 2560, 2816, 8388608, 2621440, 32768, 8, 48275456, 131072, 0, 0, 218105642, 0
    .long 1, 16, 16, 8192, 2560, 2816, 8388608, 2621440, 32768, 8, 14721024, 131072, 0, 0, 218105642, 0
    .long 2, 64, 72, 7168, 1792, 1792, 7340032, 0, 32768, 8, 54554624, 114688, 0, 0, 218103809, 0
    .long 1, 16, 16, 8192, 3584, 3840, 8388608, 3145728, 32768, 8, 16834560, 131072, 0, 0, 218105914, 0
    .long 1, 24, 24, 8192, 3072, 3328, 8388608, 2621440, 32768, 8, 31506432, 131072, 0, 0, 218105658, 0
    .long 2, 64, 72, 7168, 2048, 2048, 7340032, 524288, 32768, 8, 56393728, 114688, 0, 0, 218103873, 0
    .long 1, 24, 24, 8192, 2048, 2304, 8388608, 3145728, 32768, 8, 33587200, 131072, 0, 0, 218105898, 0
    .long 2, 64, 72, 7168, 2560, 2560, 7340032, 0, 32768, 8, 54566912, 114688, 0, 0, 218103809, 0
    .long 2, 64, 72, 7168, 2560, 2560, 7340032, 524288, 32768, 8, 56401920, 114688, 0, 0, 218103873, 0
    .long 2, 64, 72, 7168, 2304, 2304, 7340032, 2097152, 32768, 8, 61902848, 114688, 0, 0, 218104065, 0
    .long 2, 64, 72, 7168, 2816, 2816, 7340032, 2097152, 32768, 8, 61911040, 114688, 0, 0, 218104065, 0
    .long 1, 16, 16, 8192, 2560, 2816, 8388608, 524288, 32768, 8, 6332416, 131072, 0, 0, 218108202, 0
    .long 1, 16, 16, 8192, 2560, 2816, 8388608, 3145728, 32768, 8, 16818176, 131072, 0, 0, 218105898, 0
    .long 2, 64, 72, 7168, 2816, 2816, 7340032, 0, 32768, 8, 54571008, 114688, 0, 0, 218103809, 0
    .long 2, 64, 72, 7168, 3072, 3072, 7340032, 0, 32768, 8, 54575104, 114688, 0, 0, 218103809, 0
    .long 1, 16, 16, 8192, 3584, 3840, 8388608, 2621440, 32768, 8, 14737408, 131072, 0, 0, 218105658, 0
    .long 1, 24, 24, 8192, 3072, 3328, 8388608, 3145728, 32768, 8, 33603584, 131072, 0, 0, 218105914, 0
    .long 2, 64, 72, 7168, 3072, 3072, 7340032, 3145728, 32768, 8, 65585152, 114688, 0, 0, 218104196, 0
    .long 1, 32, 32, 8192, 2560, 2816, 8388608, 3145728, 32768, 8, 50372608, 131072, 0, 0, 218105898, 0
    .long 1, 16, 16, 8192, 3584, 3840, 8388608, 3670016, 32768, 8, 18931712, 131072, 0, 0, 218106170, 0
    .long 2, 64, 72, 7168, 3328, 3328, 7340032, 0, 32768, 8, 54579200, 114688, 0, 0, 218103809, 0
    .long 2, 64, 72, 7168, 2304, 2304, 7340032, 0, 32768, 8, 54562816, 114688, 0, 0, 218103809, 0
    .long 5, 218107936, 0, 0, 8, 0, 0, 4, 0, 0, 0, 0, 218112128, 8, 218106881, 0
    .long 2, 64, 72, 7168, 3328, 3328, 7340032, 3145728, 32768, 8, 65589248, 114688, 0, 0, 218104196, 0
    .long 2, 64, 72, 7168, 1792, 1792, 7340032, 524288, 32768, 8, 56389632, 114688, 0, 0, 218103873, 0
    .long 2, 64, 72, 7168, 3072, 3072, 7340032, 1572864, 32768, 8, 60080128, 114688, 0, 0, 218104001, 0
    .long 2, 64, 72, 7168, 3328, 3328, 7340032, 524288, 32768, 8, 56414208, 114688, 0, 0, 218103873, 0
    .long 1, 16, 16, 8192, 2048, 2304, 8388608, 3670016, 32768, 8, 18907136, 131072, 0, 0, 218106154, 0
    .long 5, 218108208, 0, 0, 12, 0, 0, 8, 0, 0, 0, 0, 218112128, 12, 218106945, 0
    .long 2, 64, 72, 7168, 1792, 1792, 7340032, 3145728, 32768, 8, 65564672, 114688, 0, 0, 218104196, 0
    .long 2, 64, 72, 7168, 2304, 2304, 7340032, 1572864, 32768, 8, 60067840, 114688, 0, 0, 218104001, 0
    .long 2, 64, 72, 7168, 2560, 2560, 7340032, 2097152, 32768, 8, 61906944, 114688, 0, 0, 218104065, 0
    .long 2, 64, 72, 7168, 1792, 1792, 7340032, 1572864, 32768, 8, 60059648, 114688, 0, 0, 218104001, 0
    .long 2, 64, 72, 7168, 2560, 2560, 7340032, 1572864, 32768, 8, 60071936, 114688, 0, 0, 218104001, 0
    .long 2, 64, 72, 7168, 3328, 3328, 7340032, 1572864, 32768, 8, 60084224, 114688, 0, 0, 218104001, 0
    .long 2, 64, 72, 7168, 2048, 2048, 7340032, 1572864, 32768, 8, 60063744, 114688, 0, 0, 218104001, 0
    .long 2, 64, 72, 7168, 2048, 2048, 7340032, 2097152, 32768, 8, 61898752, 114688, 0, 0, 218104065, 0
    .long 2, 64, 72, 7168, 3072, 3072, 7340032, 2097152, 32768, 8, 61915136, 114688, 0, 0, 218104065, 0
    .long 2, 64, 72, 7168, 2304, 2304, 7340032, 524288, 32768, 8, 56397824, 114688, 0, 0, 218103873, 0
    .long 2, 64, 72, 7168, 3328, 3328, 7340032, 2097152, 32768, 8, 61919232, 114688, 0, 0, 218104065, 0
    .long 2, 64, 72, 7168, 2816, 2816, 7340032, 1572864, 32768, 8, 60076032, 114688, 0, 0, 218104001, 0
    .long 2, 64, 72, 7168, 2048, 2048, 7340032, 1048576, 32768, 8, 58228736, 114688, 0, 0, 218103937, 0
    .long 2, 64, 72, 7168, 2816, 2816, 7340032, 1048576, 32768, 8, 58241024, 114688, 0, 0, 218103937, 0
    .long 2, 64, 72, 7168, 2304, 2304, 7340032, 3145728, 32768, 8, 65572864, 114688, 0, 0, 218104196, 0
    .long 2, 64, 72, 7168, 3072, 3072, 7340032, 1048576, 32768, 8, 58245120, 114688, 0, 0, 218103937, 0
    .long 5, 218108208, 0, 0, 12, 0, 0, 12, 0, 0, 0, 0, 218112128, 16, 218106945, 0
    .long 2, 64, 72, 7168, 3328, 3328, 7340032, 1048576, 32768, 8, 58249216, 114688, 0, 0, 218103937, 0
    .long 2, 64, 72, 7168, 2816, 2816, 7340032, 3145728, 32768, 8, 65581056, 114688, 0, 0, 218104196, 0
    .long 2, 64, 72, 7168, 3072, 3072, 7340032, 524288, 32768, 8, 56410112, 114688, 0, 0, 218103873, 0
    .long 2, 64, 72, 7168, 2560, 2560, 7340032, 1048576, 32768, 8, 58236928, 114688, 0, 0, 218103937, 0
    .long 2, 64, 72, 7168, 2304, 2304, 7340032, 1048576, 32768, 8, 58232832, 114688, 0, 0, 218103937, 0
    .long 2, 64, 72, 7168, 2048, 2048, 7340032, 3145728, 32768, 8, 65568768, 114688, 0, 0, 218104196, 0
    .long 5, 218108192, 0, 0, 8, 0, 0, 12, 0, 0, 0, 0, 218112128, 16, 218106945, 0
    .long 2, 64, 72, 7168, 2560, 2560, 7340032, 3670016, 32768, 8, 67411968, 114688, 0, 0, 218104260, 0
    .long 2, 64, 72, 7168, 2816, 2816, 7340032, 524288, 32768, 8, 56406016, 114688, 0, 0, 218103873, 0
    .long 1, 80, 80, 2048, 1536, 1792, 7340032, 54525952, 114688, 14, 117465088, 32768, 218103808, 14, 218106370, 0
    .long 1, 40, 40, 2048, 1024, 1280, 8388608, 176160768, 131072, 16, 75513856, 32768, 218106880, 8, 218106376, 0
    .long 5, 218108192, 0, 0, 8, 0, 0, 8, 0, 0, 0, 0, 218112128, 12, 218106945, 0
    .long 1, 32, 32, 8192, 2048, 2304, 8388608, 3670016, 32768, 8, 52461568, 131072, 0, 0, 218106154, 0
    .long 1, 16, 16, 8192, 2560, 2816, 8388608, 3670016, 32768, 8, 18915328, 131072, 0, 0, 218106154, 0
    .long 1, 16, 16, 8192, 3072, 3328, 8388608, 3670016, 32768, 8, 18923520, 131072, 0, 0, 218106170, 0
    .long 1, 40, 40, 2048, 1536, 1792, 8388608, 182452224, 131072, 16, 77094912, 32768, 218112128, 33, 218106568, 0
    .long 1, 40, 40, 2048, 1536, 1792, 8388608, 176160768, 131072, 16, 75522048, 32768, 218106880, 8, 218106376, 0
    .long 2, 64, 72, 7168, 2560, 2560, 7340032, 3145728, 32768, 8, 65576960, 114688, 0, 0, 218104196, 0
    .long 1, 40, 40, 2048, 1024, 1280, 8388608, 180355072, 131072, 16, 76562432, 32768, 218112128, 25, 218106504, 0
    .long 1, 40, 40, 2048, 1536, 1792, 8388608, 180355072, 131072, 16, 76570624, 32768, 218112128, 25, 218106504, 0
    .long 2, 64, 72, 7168, 3072, 3072, 7340032, 2621440, 32768, 8, 63750144, 114688, 0, 0, 218104132, 0
    .long 1, 40, 40, 2048, 1024, 1280, 8388608, 182452224, 131072, 16, 77086720, 32768, 218112128, 33, 218106568, 0
    .long 2, 64, 72, 7168, 1792, 1792, 7340032, 2621440, 32768, 8, 63729664, 114688, 0, 0, 218104132, 0
    .long 1, 80, 80, 2048, 1024, 1280, 7340032, 54525952, 114688, 14, 117456896, 32768, 218103808, 14, 218106370, 0
    .long 2, 64, 72, 7168, 3328, 3328, 7340032, 2621440, 32768, 8, 63754240, 114688, 0, 0, 218104132, 0
    .long 2, 64, 72, 7168, 2048, 2048, 7340032, 2621440, 32768, 8, 63733760, 114688, 0, 0, 218104132, 0
    .long 2, 64, 72, 7168, 2304, 2304, 7340032, 3670016, 32768, 8, 67407872, 114688, 0, 0, 218104260, 0
    .long 2, 64, 72, 7168, 3072, 3072, 7340032, 3670016, 32768, 8, 67420160, 114688, 0, 0, 218104260, 0
    .long 1, 40, 40, 2048, 1024, 1280, 8388608, 178257920, 131072, 16, 76038144, 32768, 218106944, 8, 218106440, 0
    .long 1, 40, 40, 2048, 1536, 1792, 8388608, 178257920, 131072, 16, 76046336, 32768, 218106944, 8, 218106440, 0
    .long 2, 64, 72, 7168, 2560, 2560, 7340032, 2621440, 32768, 8, 63741952, 114688, 0, 0, 218104132, 0
    .long 2, 64, 72, 7168, 1792, 1792, 7340032, 3670016, 32768, 8, 67399680, 114688, 0, 0, 218104260, 0
    .long 2, 64, 72, 7168, 2304, 2304, 7340032, 2621440, 32768, 8, 63737856, 114688, 0, 0, 218104132, 0
    .long 1, 80, 80, 2048, 1536, 1792, 7340032, 61865984, 114688, 14, 119562240, 32768, 218104064, 14, 218106626, 0
    .long 1, 80, 80, 2048, 1024, 1280, 7340032, 60030976, 114688, 14, 119029760, 32768, 218104000, 14, 218106562, 0
    .long 1, 80, 80, 2048, 1024, 1280, 7340032, 61865984, 114688, 14, 119554048, 32768, 218104064, 14, 218106626, 0
    .long 1, 80, 80, 2048, 1536, 1792, 7340032, 60030976, 114688, 14, 119037952, 32768, 218104000, 14, 218106562, 0
    .long 2, 64, 72, 7168, 2816, 2816, 7340032, 3670016, 32768, 8, 67416064, 114688, 0, 0, 218104260, 0
    .long 2, 64, 72, 7168, 2048, 2048, 7340032, 3670016, 32768, 8, 67403776, 114688, 0, 0, 218104260, 0
    .long 1, 80, 80, 2048, 1024, 1280, 7340032, 58195968, 114688, 14, 118505472, 32768, 218103936, 14, 218106498, 0
    .long 1, 80, 80, 2048, 1536, 1792, 7340032, 58195968, 114688, 14, 118513664, 32768, 218103936, 14, 218106498, 0
    .long 2, 64, 72, 7168, 3328, 3328, 7340032, 3670016, 32768, 8, 67424256, 114688, 0, 0, 218104260, 0
    .long 1, 80, 80, 2048, 1536, 1792, 7340032, 56360960, 114688, 14, 117989376, 32768, 218103872, 14, 218106434, 0
    .long 1, 80, 80, 2048, 1024, 1280, 7340032, 56360960, 114688, 14, 117981184, 32768, 218103872, 14, 218106434, 0
    .long 1, 40, 40, 2048, 2097664, 2097920, 8388608, 184582144, 131072, 8, 81797120, 32768, 218112128, 41, 218106628, 0
    .long 1, 80, 80, 2048, 1835008, 1835264, 7340032, 65564672, 114688, 7, 124780544, 32768, 218104196, 7, 218106753, 0
    .long 1, 80, 80, 2048, 1835520, 1835776, 7340032, 65564672, 114688, 7, 124788736, 32768, 218104196, 7, 218106753, 0
    .long 1, 40, 40, 2048, 2097152, 2097408, 8388608, 184582144, 131072, 8, 81788928, 32768, 218112128, 41, 218106628, 0
    .long 1, 80, 80, 2048, 1836544, 1836800, 7340032, 65564672, 114688, 7, 124805120, 32768, 218104196, 7, 218106753, 0
    .long 1, 40, 40, 2048, 2098176, 2098432, 8388608, 184582144, 131072, 8, 81805312, 32768, 218112128, 41, 218106628, 0
    .long 1, 40, 40, 2048, 2098688, 2098944, 8388608, 184582144, 131072, 8, 81813504, 32768, 218112128, 41, 218106628, 0
    .long 1, 40, 40, 2048, 2097664, 2097920, 8388608, 186679296, 131072, 8, 82321408, 32768, 218112128, 49, 218106692, 0
    .long 1, 80, 80, 2048, 1836032, 1836288, 7340032, 65564672, 114688, 7, 124796928, 32768, 218104196, 7, 218106753, 0
    .long 1, 40, 40, 2048, 2098176, 2098432, 8388608, 186679296, 131072, 8, 82329600, 32768, 218112128, 49, 218106692, 0
    .long 1, 40, 40, 2048, 2097152, 2097408, 8388608, 186679296, 131072, 8, 82313216, 32768, 218112128, 49, 218106692, 0
    .long 1, 40, 40, 2048, 2098688, 2098944, 8388608, 186679296, 131072, 8, 82337792, 32768, 218112128, 49, 218106692, 0
    .long 1, 80, 80, 2048, 1836032, 1836288, 7340032, 63729664, 114688, 7, 124272640, 32768, 218104132, 7, 218106689, 0
    .long 1, 80, 80, 2048, 1836544, 1836800, 7340032, 63729664, 114688, 7, 124280832, 32768, 218104132, 7, 218106689, 0
    .long 1, 80, 80, 2048, 1835008, 1835264, 7340032, 63729664, 114688, 7, 124256256, 32768, 218104132, 7, 218106689, 0
    .long 1, 80, 80, 2048, 1835520, 1835776, 7340032, 63729664, 114688, 7, 124264448, 32768, 218104132, 7, 218106689, 0
    .long 1, 80, 80, 2048, 1835520, 1835776, 7340032, 67399680, 114688, 7, 125313024, 32768, 218104260, 7, 218106817, 0
    .long 1, 80, 80, 2048, 1836032, 1836288, 7340032, 67399680, 114688, 7, 125321216, 32768, 218104260, 7, 218106817, 0
    .long 1, 80, 80, 2048, 1836544, 1836800, 7340032, 67399680, 114688, 7, 125329408, 32768, 218104260, 7, 218106817, 0
    .long 1, 80, 80, 2048, 1835008, 1835264, 7340032, 67399680, 114688, 7, 125304832, 32768, 218104260, 7, 218106817, 0
    .long 6, 1, 3, 2, 1, 16, 0, 3, 0, 0, 0, 0, 0, 0, 0, 0
    .long 6, 0, 51, 0, 1, 0, 0, 51, 0, 0, 0, 0, 0, 0, 0, 0
    .long 6, 1, 1, 2, 1, 16, 0, 1, 0, 0, 0, 0, 0, 0, 0, 0
    .long 6, 1, 0, 2, 1, 16, 0, 0, 0, 0, 0, 0, 0, 0, 0, 0
    .long 6, 1, 5, 2, 1, 16, 0, 5, 0, 0, 0, 0, 0, 0, 0, 0
    .long 6, 1, 4, 2, 1, 16, 0, 4, 0, 0, 0, 0, 0, 0, 0, 0
    .long 6, 1, 22, 2, 1, 16, 0, 22, 0, 0, 0, 0, 0, 0, 0, 0
    .long 6, 1, 6, 2, 1, 16, 0, 6, 0, 0, 0, 0, 0, 0, 0, 0
    .long 6, 1, 18, 2, 1, 16, 0, 18, 0, 0, 0, 0, 0, 0, 0, 0
    .long 6, 1, 19, 2, 1, 16, 0, 19, 0, 0, 0, 0, 0, 0, 0, 0
    .long 6, 1, 20, 2, 1, 16, 0, 20, 0, 0, 0, 0, 0, 0, 0, 0
    .long 6, 1, 7, 2, 1, 16, 0, 7, 0, 0, 0, 0, 0, 0, 0, 0
    .long 6, 1, 2, 2, 1, 16, 0, 2, 0, 0, 0, 0, 0, 0, 0, 0
    .long 6, 1, 17, 2, 1, 16, 0, 17, 0, 0, 0, 0, 0, 0, 0, 0
    .long 6, 1, 21, 2, 1, 16, 0, 21, 0, 0, 0, 0, 0, 0, 0, 0
    .long 6, 1, 16, 2, 1, 16, 0, 16, 0, 0, 0, 0, 0, 0, 0, 0
    .long 6, 0, 50, 0, 1, 0, 0, 50, 0, 0, 0, 0, 0, 0, 0, 0
    .long 6, 0, 52, 0, 1, 0, 0, 52, 0, 0, 0, 0, 0, 0, 0, 0
    .long 6, 0, 54, 0, 1, 0, 0, 54, 0, 0, 0, 0, 0, 0, 0, 0
    .long 6, 0, 49, 0, 1, 0, 0, 49, 0, 0, 0, 0, 0, 0, 0, 0
    .long 6, 0, 48, 0, 1, 0, 0, 48, 0, 0, 0, 0, 0, 0, 0, 0
    .long 6, 0, 53, 0, 1, 0, 0, 53, 0, 0, 0, 0, 0, 0, 0, 0
    .long 6, 0, 55, 0, 1, 0, 0, 55, 0, 0, 0, 0, 0, 0, 0, 0
    .long 6, 0, 56, 0, 1, 0, 0, 56, 0, 0, 0, 0, 0, 0, 0, 0
    .long 6, 1, 23, 2, 1, 16, 0, 23, 0, 0, 0, 0, 0, 0, 0, 0
    .long 6, 1, 24, 2, 1, 16, 0, 24, 0, 0, 0, 0, 0, 0, 0, 0
    .long 6, 1, 25, 2, 1, 16, 0, 25, 0, 0, 0, 0, 0, 0, 0, 0
    .long 6, 1, 26, 2, 1, 16, 0, 26, 0, 0, 0, 0, 0, 0, 0, 0
    .long 6, 1, 27, 2, 1, 16, 0, 27, 0, 0, 0, 0, 0, 0, 0, 0
    .long 6, 1, 28, 2, 1, 16, 0, 28, 0, 0, 0, 0, 0, 0, 0, 0
    .long 6, 1, 29, 2, 1, 16, 0, 29, 0, 0, 0, 0, 0, 0, 0, 0
    .long 6, 1, 30, 2, 1, 16, 0, 30, 0, 0, 0, 0, 0, 0, 0, 0
    .long 6, 1, 31, 2, 1, 16, 0, 31, 0, 0, 0, 0, 0, 0, 0, 0
    .long 6, 0, 40, 1, 1, 16, 0, 40, 0, 0, 0, 0, 0, 0, 0, 0
    .long 6, 0, 41, 1, 1, 16, 0, 41, 0, 0, 0, 0, 0, 0, 0, 0
    .long 6, 0, 43, 1, 1, 16, 0, 43, 0, 0, 0, 0, 0, 0, 0, 0
    .long 6, 0, 45, 1, 1, 16, 0, 45, 0, 0, 0, 0, 0, 0, 0, 0
    .long 6, 0, 46, 1, 1, 16, 0, 46, 0, 0, 0, 0, 0, 0, 0, 0
    .long 6, 0, 47, 1, 1, 16, 0, 47, 0, 0, 0, 0, 0, 0, 0, 0
    .long 6, 1, 32, 1, 1, 16, 0, 32, 0, 0, 0, 0, 0, 0, 0, 0
    .long 6, 1, 33, 1, 1, 16, 0, 33, 0, 0, 0, 0, 0, 0, 0, 0
    .long 6, 1, 35, 1, 1, 16, 0, 35, 0, 0, 0, 0, 0, 0, 0, 0
    .long 6, 1, 36, 1, 1, 16, 0, 36, 0, 0, 0, 0, 0, 0, 0, 0
    .long 6, 1, 38, 1, 1, 16, 0, 38, 0, 0, 0, 0, 0, 0, 0, 0
    .long 6, 1, 39, 1, 1, 16, 0, 39, 0, 0, 0, 0, 0, 0, 0, 0
    .long 6, 0, 57, 0, 1, 0, 0, 57, 0, 0, 0, 0, 0, 0, 0, 0
    .long 6, 0, 44, 1, 1, 16, 0, 44, 0, 0, 0, 0, 0, 0, 0, 0
    .long 6, 1, 34, 1, 1, 16, 0, 34, 0, 0, 0, 0, 0, 0, 0, 0
    .long 6, 0, 58, 0, 1, 0, 0, 58, 0, 0, 0, 0, 0, 0, 0, 0
    .long 6, 1, 37, 1, 1, 16, 0, 37, 0, 0, 0, 0, 0, 0, 0, 0
    .long 6, 0, 42, 1, 1, 16, 0, 42, 0, 0, 0, 0, 0, 0, 0, 0
    .long 6, 0, 59, 0, 1, 0, 0, 59, 0, 0, 0, 0, 0, 0, 0, 0
    .long 6, 1, 8, 2, 1, 16, 0, 8, 0, 0, 0, 0, 0, 0, 0, 0
    .long 6, 1, 9, 2, 1, 16, 0, 9, 0, 0, 0, 0, 0, 0, 0, 0
    .long 6, 1, 10, 2, 1, 16, 0, 10, 0, 0, 0, 0, 0, 0, 0, 0
    .long 6, 1, 11, 2, 1, 16, 0, 11, 0, 0, 0, 0, 0, 0, 0, 0
    .long 6, 1, 12, 2, 1, 16, 0, 12, 0, 0, 0, 0, 0, 0, 0, 0
    .long 6, 1, 13, 2, 1, 16, 0, 13, 0, 0, 0, 0, 0, 0, 0, 0
    .long 6, 1, 14, 2, 1, 16, 0, 14, 0, 0, 0, 0, 0, 0, 0, 0
    .long 6, 1, 15, 2, 1, 16, 0, 15, 0, 0, 0, 0, 0, 0, 0, 0
    .long 7, 0, 60, 0, 4, 0, 0, 60, 0, 0, 0, 0, 0, 0, 0, 0
    .long 7, 0, 60, 0, 5, 0, 0, 60, 0, 0, 0, 0, 0, 0, 0, 0
    .long 7, 0, 60, 0, 6, 0, 0, 60, 0, 0, 0, 0, 0, 0, 0, 0
    .long 7, 0, 60, 0, 7, 0, 0, 60, 0, 0, 0, 0, 0, 0, 0, 0
    .long 7, 0, 61, 0, 4, 0, 0, 61, 0, 0, 0, 0, 0, 0, 0, 0
    .long 7, 0, 61, 0, 5, 0, 0, 61, 0, 0, 0, 0, 0, 0, 0, 0
    .long 7, 0, 61, 0, 6, 0, 0, 61, 0, 0, 0, 0, 0, 0, 0, 0
    .long 7, 0, 61, 0, 7, 0, 0, 61, 0, 0, 0, 0, 0, 0, 0, 0
    .long 7, 0, 62, 0, 4, 0, 0, 62, 0, 0, 0, 0, 0, 0, 0, 0
    .long 7, 0, 62, 0, 5, 0, 0, 62, 0, 0, 0, 0, 0, 0, 0, 0
    .long 7, 0, 62, 0, 6, 0, 0, 62, 0, 0, 0, 0, 0, 0, 0, 0
    .long 7, 0, 62, 0, 7, 0, 0, 62, 0, 0, 0, 0, 0, 0, 0, 0
    .long 7, 0, 63, 0, 4, 0, 0, 63, 0, 0, 0, 0, 0, 0, 0, 0
    .long 7, 0, 63, 0, 5, 0, 0, 63, 0, 0, 0, 0, 0, 0, 0, 0
    .long 7, 0, 63, 0, 6, 0, 0, 63, 0, 0, 0, 0, 0, 0, 0, 0
    .long 7, 0, 63, 0, 7, 0, 0, 63, 0, 0, 0, 0, 0, 0, 0, 0
    .long 0, 0, 0, 0, 0, 0, 0, 0, 0, 0, 0, 0, 0, 0, 0, 0
    .long 4, 24, 24, 8192, 4096, 266240, 8388608, 0, 32768, 4, 21037056, 131072, 0, 0, 218104385, 0
    .long 4, 24, 24, 8192, 4352, 266496, 8388608, 0, 32768, 4, 21041152, 131072, 0, 0, 218104385, 0
    .long 4, 24, 24, 8192, 4608, 266752, 8388608, 0, 32768, 4, 21045248, 131072, 0, 0, 218104385, 0
    .long 4, 24, 24, 8192, 4864, 267008, 8388608, 0, 32768, 4, 21049344, 131072, 0, 0, 218104385, 0
    .long 4, 24, 24, 8192, 5120, 267264, 8388608, 0, 32768, 4, 21053440, 131072, 0, 0, 218104401, 0
    .long 4, 24, 24, 8192, 5376, 267520, 8388608, 0, 32768, 4, 21057536, 131072, 0, 0, 218104401, 0
    .long 4, 24, 24, 8192, 5632, 267776, 8388608, 0, 32768, 4, 21061632, 131072, 0, 0, 218104401, 0
    .long 4, 24, 24, 8192, 5888, 268032, 8388608, 0, 32768, 4, 21065728, 131072, 0, 0, 218104401, 0
    .long 4, 32, 32, 8192, 4096, 266240, 8388608, 0, 32768, 4, 37814272, 131072, 0, 0, 218104385, 0
    .long 4, 32, 32, 8192, 4352, 266496, 8388608, 0, 32768, 4, 37818368, 131072, 0, 0, 218104385, 0
    .long 4, 32, 32, 8192, 4608, 266752, 8388608, 0, 32768, 4, 37822464, 131072, 0, 0, 218104385, 0
    .long 4, 32, 32, 8192, 4864, 267008, 8388608, 0, 32768, 4, 37826560, 131072, 0, 0, 218104385, 0
    .long 4, 32, 32, 8192, 5120, 267264, 8388608, 0, 32768, 4, 37830656, 131072, 0, 0, 218104401, 0
    .long 4, 32, 32, 8192, 5376, 267520, 8388608, 0, 32768, 4, 37834752, 131072, 0, 0, 218104401, 0
    .long 4, 32, 32, 8192, 5632, 267776, 8388608, 0, 32768, 4, 37838848, 131072, 0, 0, 218104401, 0
    .long 4, 32, 32, 8192, 5888, 268032, 8388608, 0, 32768, 4, 37842944, 131072, 0, 0, 218104401, 0
    .long 4, 24, 24, 8192, 4096, 266240, 8388608, 262144, 32768, 4, 22085632, 131072, 0, 0, 218104388, 0
    .long 4, 24, 24, 8192, 4352, 266496, 8388608, 262144, 32768, 4, 22089728, 131072, 0, 0, 218104388, 0
    .long 4, 24, 24, 8192, 4608, 266752, 8388608, 262144, 32768, 4, 22093824, 131072, 0, 0, 218104388, 0
    .long 4, 24, 24, 8192, 4864, 267008, 8388608, 262144, 32768, 4, 22097920, 131072, 0, 0, 218104388, 0
    .long 4, 24, 24, 8192, 5120, 267264, 8388608, 262144, 32768, 4, 22102016, 131072, 0, 0, 218104404, 0
    .long 4, 24, 24, 8192, 5376, 267520, 8388608, 262144, 32768, 4, 22106112, 131072, 0, 0, 218104404, 0
    .long 4, 24, 24, 8192, 5632, 267776, 8388608, 262144, 32768, 4, 22110208, 131072, 0, 0, 218104404, 0
    .long 4, 24, 24, 8192, 5888, 268032, 8388608, 262144, 32768, 4, 22114304, 131072, 0, 0, 218104404, 0
    .long 4, 32, 32, 8192, 4096, 266240, 8388608, 262144, 32768, 4, 38862848, 131072, 0, 0, 218104388, 0
    .long 4, 32, 32, 8192, 4352, 266496, 8388608, 262144, 32768, 4, 38866944, 131072, 0, 0, 218104388, 0
    .long 4, 32, 32, 8192, 4608, 266752, 8388608, 262144, 32768, 4, 38871040, 131072, 0, 0, 218104388, 0
    .long 4, 32, 32, 8192, 4864, 267008, 8388608, 262144, 32768, 4, 38875136, 131072, 0, 0, 218104388, 0
    .long 4, 32, 32, 8192, 5120, 267264, 8388608, 262144, 32768, 4, 38879232, 131072, 0, 0, 218104404, 0
    .long 4, 32, 32, 8192, 5376, 267520, 8388608, 262144, 32768, 4, 38883328, 131072, 0, 0, 218104404, 0
    .long 4, 32, 32, 8192, 5632, 267776, 8388608, 262144, 32768, 4, 38887424, 131072, 0, 0, 218104404, 0
    .long 4, 32, 32, 8192, 5888, 268032, 8388608, 262144, 32768, 4, 38891520, 131072, 0, 0, 218104404, 0
    .long 4, 32, 32, 8192, 4352, 266496, 8388608, 786432, 32768, 4, 40964096, 131072, 0, 0, 218104644, 0
    .long 4, 24, 24, 8192, 4608, 266752, 8388608, 786432, 32768, 4, 24190976, 131072, 0, 0, 218104644, 0
    .long 4, 24, 24, 8192, 5632, 267776, 8388608, 786432, 32768, 4, 24207360, 131072, 0, 0, 218104660, 0
    .long 4, 32, 32, 8192, 4864, 267008, 8388608, 524288, 32768, 4, 39923712, 131072, 0, 0, 218104641, 0
    .long 4, 32, 32, 8192, 5632, 267776, 8388608, 786432, 32768, 4, 40984576, 131072, 0, 0, 218104660, 0
    .long 4, 32, 32, 8192, 5376, 267520, 8388608, 524288, 32768, 4, 39931904, 131072, 0, 0, 218104657, 0
    .long 4, 24, 24, 8192, 5120, 267264, 8388608, 786432, 32768, 4, 24199168, 131072, 0, 0, 218104660, 0
    .long 4, 32, 32, 8192, 5888, 268032, 8388608, 524288, 32768, 4, 39940096, 131072, 0, 0, 218104657, 0
    .long 4, 32, 32, 8192, 4608, 266752, 8388608, 786432, 32768, 4, 40968192, 131072, 0, 0, 218104644, 0
    .long 4, 32, 32, 8192, 4608, 266752, 8388608, 524288, 32768, 4, 39919616, 131072, 0, 0, 218104641, 0
    .long 4, 32, 32, 8192, 5120, 267264, 8388608, 786432, 32768, 4, 40976384, 131072, 0, 0, 218104660, 0
    .long 4, 24, 24, 8192, 4864, 267008, 8388608, 524288, 32768, 4, 23146496, 131072, 0, 0, 218104641, 0
    .long 2, 64, 72, 7168, 3584, 3584, 7340032, 1048576, 32768, 8, 58253312, 114688, 0, 0, 218103953, 0
    .long 4, 24, 24, 8192, 4352, 266496, 8388608, 786432, 32768, 4, 24186880, 131072, 0, 0, 218104644, 0
    .long 4, 24, 24, 8192, 5376, 267520, 8388608, 524288, 32768, 4, 23154688, 131072, 0, 0, 218104657, 0
    .long 4, 32, 32, 8192, 4352, 266496, 8388608, 524288, 32768, 4, 39915520, 131072, 0, 0, 218104641, 0
    .long 4, 32, 32, 8192, 5888, 268032, 8388608, 786432, 32768, 4, 40988672, 131072, 0, 0, 218104660, 0
    .long 4, 24, 24, 8192, 4096, 266240, 8388608, 524288, 32768, 4, 23134208, 131072, 0, 0, 218104641, 0
    .long 4, 24, 24, 8192, 5632, 267776, 8388608, 524288, 32768, 4, 23158784, 131072, 0, 0, 218104657, 0
    .long 4, 32, 32, 8192, 4096, 266240, 8388608, 524288, 32768, 4, 39911424, 131072, 0, 0, 218104641, 0
    .long 4, 24, 24, 8192, 5888, 268032, 8388608, 524288, 32768, 4, 23162880, 131072, 0, 0, 218104657, 0
    .long 4, 32, 32, 8192, 4096, 266240, 8388608, 786432, 32768, 4, 40960000, 131072, 0, 0, 218104644, 0
    .long 4, 24, 24, 8192, 4864, 267008, 8388608, 786432, 32768, 4, 24195072, 131072, 0, 0, 218104644, 0
    .long 4, 32, 32, 8192, 4864, 267008, 8388608, 786432, 32768, 4, 40972288, 131072, 0, 0, 218104644, 0
    .long 4, 32, 32, 8192, 5632, 267776, 8388608, 524288, 32768, 4, 39936000, 131072, 0, 0, 218104657, 0
    .long 4, 24, 24, 8192, 5120, 267264, 8388608, 524288, 32768, 4, 23150592, 131072, 0, 0, 218104657, 0
    .long 4, 32, 32, 8192, 5376, 267520, 8388608, 786432, 32768, 4, 40980480, 131072, 0, 0, 218104660, 0
    .long 4, 24, 24, 8192, 4352, 266496, 8388608, 524288, 32768, 4, 23138304, 131072, 0, 0, 218104641, 0
    .long 4, 32, 32, 8192, 5120, 267264, 8388608, 524288, 32768, 4, 39927808, 131072, 0, 0, 218104657, 0
    .long 4, 24, 24, 8192, 4608, 266752, 8388608, 524288, 32768, 4, 23142400, 131072, 0, 0, 218104641, 0
    .long 4, 24, 24, 8192, 5376, 267520, 8388608, 786432, 32768, 4, 24203264, 131072, 0, 0, 218104660, 0
    .long 4, 24, 24, 8192, 4096, 266240, 8388608, 786432, 32768, 4, 24182784, 131072, 0, 0, 218104644, 0
    .long 1, 32, 32, 8192, 5120, 5376, 8388608, 1048576, 32768, 8, 42024960, 131072, 0, 0, 218104922, 0
    .long 1, 24, 24, 8192, 4608, 4864, 8388608, 1048576, 32768, 8, 25239552, 131072, 0, 0, 218104906, 0
    .long 1, 16, 16, 8192, 4608, 4864, 8388608, 1048576, 32768, 8, 8462336, 131072, 0, 0, 218104906, 0
    .long 1, 24, 24, 8192, 5120, 5376, 8388608, 1048576, 32768, 8, 25247744, 131072, 0, 0, 218104922, 0
    .long 4, 24, 24, 8192, 5888, 268032, 8388608, 786432, 32768, 4, 24211456, 131072, 0, 0, 218104660, 0
    .long 1, 16, 16, 8192, 4096, 4352, 8388608, 1048576, 32768, 8, 8454144, 131072, 0, 0, 218104906, 0
    .long 1, 24, 24, 8192, 4608, 4864, 8388608, 1572864, 32768, 8, 27336704, 131072, 0, 0, 218105162, 0
    .long 1, 32, 32, 8192, 5120, 5376, 8388608, 1572864, 32768, 8, 44122112, 131072, 0, 0, 218105178, 0
    .long 1, 24, 24, 8192, 4096, 4352, 8388608, 1048576, 32768, 8, 25231360, 131072, 0, 0, 218104906, 0
    .long 1, 32, 32, 8192, 4608, 4864, 8388608, 1048576, 32768, 8, 42016768, 131072, 0, 0, 218104906, 0
    .long 1, 16, 16, 8192, 5632, 5888, 8388608, 1572864, 32768, 8, 10575872, 131072, 0, 0, 218105178, 0
    .long 1, 16, 16, 8192, 4096, 4352, 8388608, 0, 32768, 8, 4259840, 131072, 0, 0, 218107978, 0
    .long 1, 24, 24, 8192, 5120, 5376, 8388608, 1572864, 32768, 8, 27344896, 131072, 0, 0, 218105178, 0
    .long 1, 32, 32, 8192, 5632, 5888, 8388608, 1572864, 32768, 8, 44130304, 131072, 0, 0, 218105178, 0
    .long 1, 32, 32, 8192, 4096, 4352, 8388608, 1048576, 32768, 8, 42008576, 131072, 0, 0, 218104906, 0
    .long 1, 16, 16, 8192, 5120, 5376, 8388608, 1572864, 32768, 8, 10567680, 131072, 0, 0, 218105178, 0
    .long 1, 32, 32, 8192, 5632, 5888, 8388608, 1048576, 32768, 8, 42033152, 131072, 0, 0, 218104922, 0
    .long 1, 24, 24, 8192, 5632, 5888, 8388608, 1572864, 32768, 8, 27353088, 131072, 0, 0, 218105178, 0
    .long 1, 16, 16, 8192, 5632, 5888, 8388608, 1048576, 32768, 8, 8478720, 131072, 0, 0, 218104922, 0
    .long 1, 32, 32, 8192, 4096, 4352, 8388608, 1572864, 32768, 8, 44105728, 131072, 0, 0, 218105162, 0
    .long 1, 16, 16, 8192, 5632, 5888, 8388608, 0, 32768, 8, 4284416, 131072, 0, 0, 218107994, 0
    .long 1, 16, 16, 8192, 4608, 4864, 8388608, 2097152, 32768, 8, 12656640, 131072, 0, 0, 218105418, 0
    .long 1, 16, 16, 8192, 5120, 5376, 8388608, 1048576, 32768, 8, 8470528, 131072, 0, 0, 218104922, 0
    .long 1, 16, 16, 8192, 4096, 4352, 8388608, 1572864, 32768, 8, 10551296, 131072, 0, 0, 218105162, 0
    .long 1, 32, 32, 8192, 4096, 4352, 8388608, 2097152, 32768, 8, 46202880, 131072, 0, 0, 218105418, 0
    .long 1, 16, 16, 8192, 4608, 4864, 8388608, 0, 32768, 8, 4268032, 131072, 0, 0, 218107978, 0
    .long 1, 24, 24, 8192, 5632, 5888, 8388608, 1048576, 32768, 8, 25255936, 131072, 0, 0, 218104922, 0
    .long 1, 16, 16, 8192, 4608, 4864, 8388608, 1572864, 32768, 8, 10559488, 131072, 0, 0, 218105162, 0
    .long 1, 16, 16, 8192, 5120, 5376, 8388608, 0, 32768, 8, 4276224, 131072, 0, 0, 218107994, 0
    .long 1, 32, 32, 8192, 4608, 4864, 8388608, 2097152, 32768, 8, 46211072, 131072, 0, 0, 218105418, 0
    .long 1, 32, 32, 8192, 4608, 4864, 8388608, 1572864, 32768, 8, 44113920, 131072, 0, 0, 218105162, 0
    .long 1, 24, 24, 8192, 4096, 4352, 8388608, 1572864, 32768, 8, 27328512, 131072, 0, 0, 218105162, 0
    .long 1, 16, 16, 8192, 4096, 4352, 8388608, 524288, 32768, 8, 6356992, 131072, 0, 0, 218108234, 0
    .long 1, 32, 32, 8192, 5120, 5376, 8388608, 3670016, 32768, 8, 52510720, 131072, 0, 0, 218106202, 0
    .long 1, 16, 16, 8192, 5120, 5376, 8388608, 2621440, 32768, 8, 14761984, 131072, 0, 0, 218105690, 0
    .long 1, 24, 24, 8192, 4608, 4864, 8388608, 3145728, 32768, 8, 33628160, 131072, 0, 0, 218105930, 0
    .long 1, 16, 16, 8192, 4096, 4352, 8388608, 2621440, 32768, 8, 14745600, 131072, 0, 0, 218105674, 0
    .long 1, 32, 32, 8192, 5632, 5888, 8388608, 3670016, 32768, 8, 52518912, 131072, 0, 0, 218106202, 0
    .long 1, 16, 16, 8192, 4096, 4352, 8388608, 3145728, 32768, 8, 16842752, 131072, 0, 0, 218105930, 0
    .long 1, 24, 24, 8192, 5120, 5376, 8388608, 2097152, 32768, 8, 29442048, 131072, 0, 0, 218105434, 0
    .long 1, 16, 16, 8192, 5632, 5888, 8388608, 2097152, 32768, 8, 12673024, 131072, 0, 0, 218105434, 0
    .long 1, 24, 24, 8192, 4608, 4864, 8388608, 3670016, 32768, 8, 35725312, 131072, 0, 0, 218106186, 0
    .long 1, 24, 24, 8192, 5632, 5888, 8388608, 3145728, 32768, 8, 33644544, 131072, 0, 0, 218105946, 0
    .long 1, 32, 32, 8192, 5632, 5888, 8388608, 2621440, 32768, 8, 48324608, 131072, 0, 0, 218105690, 0
    .long 1, 32, 32, 8192, 5632, 5888, 8388608, 2097152, 32768, 8, 46227456, 131072, 0, 0, 218105434, 0
    .long 1, 24, 24, 8192, 5632, 5888, 8388608, 2097152, 32768, 8, 29450240, 131072, 0, 0, 218105434, 0
    .long 1, 24, 24, 8192, 4096, 4352, 8388608, 2097152, 32768, 8, 29425664, 131072, 0, 0, 218105418, 0
    .long 1, 32, 32, 8192, 5632, 5888, 8388608, 3145728, 32768, 8, 50421760, 131072, 0, 0, 218105946, 0
    .long 1, 32, 32, 8192, 4096, 4352, 8388608, 3145728, 32768, 8, 50397184, 131072, 0, 0, 218105930, 0
    .long 1, 16, 16, 8192, 5120, 5376, 8388608, 3145728, 32768, 8, 16859136, 131072, 0, 0, 218105946, 0
    .long 1, 16, 16, 8192, 5120, 5376, 8388608, 2097152, 32768, 8, 12664832, 131072, 0, 0, 218105434, 0
    .long 5, 218107984, 0, 0, 20, 0, 0, 0, 0, 0, 0, 0, 218112256, 4, 218106897, 0
    .long 1, 32, 32, 8192, 5120, 5376, 8388608, 3145728, 32768, 8, 50413568, 131072, 0, 0, 218105946, 0
    .long 1, 24, 24, 8192, 5632, 5888, 8388608, 3670016, 32768, 8, 35741696, 131072, 0, 0, 218106202, 0
    .long 1, 32, 32, 8192, 4096, 4352, 8388608, 2621440, 32768, 8, 48300032, 131072, 0, 0, 218105674, 0
    .long 1, 32, 32, 8192, 5120, 5376, 8388608, 2097152, 32768, 8, 46219264, 131072, 0, 0, 218105434, 0
    .long 1, 24, 24, 8192, 4608, 4864, 8388608, 2621440, 32768, 8, 31531008, 131072, 0, 0, 218105674, 0
    .long 1, 24, 24, 8192, 4608, 4864, 8388608, 2097152, 32768, 8, 29433856, 131072, 0, 0, 218105418, 0
    .long 1, 16, 16, 8192, 5632, 5888, 8388608, 524288, 32768, 8, 6381568, 131072, 0, 0, 218108250, 0
    .long 1, 32, 32, 8192, 5120, 5376, 8388608, 2621440, 32768, 8, 48316416, 131072, 0, 0, 218105690, 0
    .long 1, 16, 16, 8192, 5120, 5376, 8388608, 524288, 32768, 8, 6373376, 131072, 0, 0, 218108250, 0
    .long 1, 24, 24, 8192, 4096, 4352, 8388608, 2621440, 32768, 8, 31522816, 131072, 0, 0, 218105674, 0
    .long 1, 16, 16, 8192, 4096, 4352, 8388608, 2097152, 32768, 8, 12648448, 131072, 0, 0, 218105418, 0
    .long 5, 218107984, 0, 0, 20, 0, 0, 4, 0, 0, 0, 0, 218112256, 8, 218106897, 0
    .long 5, 218107968, 0, 0, 16, 0, 0, 0, 0, 0, 0, 0, 218112256, 4, 218106897, 0
    .long 1, 24, 24, 8192, 5120, 5376, 8388608, 3670016, 32768, 8, 35733504, 131072, 0, 0, 218106202, 0
    .long 2, 64, 72, 7168, 3584, 3584, 7340032, 2097152, 32768, 8, 61923328, 114688, 0, 0, 218104081, 0
    .long 1, 24, 24, 8192, 5632, 5888, 8388608, 2621440, 32768, 8, 31547392, 131072, 0, 0, 218105690, 0
    .long 2, 64, 72, 7168, 3840, 3840, 7340032, 0, 32768, 8, 54587392, 114688, 0, 0, 218103825, 0
    .long 1, 24, 24, 8192, 4096, 4352, 8388608, 3670016, 32768, 8, 35717120, 131072, 0, 0, 218106186, 0
    .long 1, 32, 32, 8192, 4608, 4864, 8388608, 3670016, 32768, 8, 52502528, 131072, 0, 0, 218106186, 0
    .long 2, 64, 72, 7168, 4608, 4608, 7340032, 2621440, 32768, 8, 63774720, 114688, 0, 0, 218104145, 0
    .long 1, 32, 32, 8192, 4608, 4864, 8388608, 2621440, 32768, 8, 48308224, 131072, 0, 0, 218105674, 0
    .long 1, 16, 16, 8192, 4608, 4864, 8388608, 2621440, 32768, 8, 14753792, 131072, 0, 0, 218105674, 0
    .long 2, 64, 72, 7168, 3584, 3584, 7340032, 0, 32768, 8, 54583296, 114688, 0, 0, 218103825, 0
    .long 1, 16, 16, 8192, 5632, 5888, 8388608, 3145728, 32768, 8, 16867328, 131072, 0, 0, 218105946, 0
    .long 1, 24, 24, 8192, 5120, 5376, 8388608, 2621440, 32768, 8, 31539200, 131072, 0, 0, 218105690, 0
    .long 2, 64, 72, 7168, 3840, 3840, 7340032, 524288, 32768, 8, 56422400, 114688, 0, 0, 218103889, 0
    .long 1, 24, 24, 8192, 4096, 4352, 8388608, 3145728, 32768, 8, 33619968, 131072, 0, 0, 218105930, 0
    .long 2, 64, 72, 7168, 4352, 4352, 7340032, 0, 32768, 8, 54595584, 114688, 0, 0, 218103825, 0
    .long 2, 64, 72, 7168, 4352, 4352, 7340032, 524288, 32768, 8, 56430592, 114688, 0, 0, 218103889, 0
    .long 2, 64, 72, 7168, 4096, 4096, 7340032, 2097152, 32768, 8, 61931520, 114688, 0, 0, 218104081, 0
    .long 2, 64, 72, 7168, 4608, 4608, 7340032, 2097152, 32768, 8, 61939712, 114688, 0, 0, 218104081, 0
    .long 1, 16, 16, 8192, 4608, 4864, 8388608, 524288, 32768, 8, 6365184, 131072, 0, 0, 218108234, 0
    .long 1, 16, 16, 8192, 4608, 4864, 8388608, 3145728, 32768, 8, 16850944, 131072, 0, 0, 218105930, 0
    .long 2, 64, 72, 7168, 4608, 4608, 7340032, 0, 32768, 8, 54599680, 114688, 0, 0, 218103825, 0
    .long 2, 64, 72, 7168, 4864, 4864, 7340032, 0, 32768, 8, 54603776, 114688, 0, 0, 218103825, 0
    .long 1, 16, 16, 8192, 5632, 5888, 8388608, 2621440, 32768, 8, 14770176, 131072, 0, 0, 218105690, 0
    .long 1, 24, 24, 8192, 5120, 5376, 8388608, 3145728, 32768, 8, 33636352, 131072, 0, 0, 218105946, 0
    .long 2, 64, 72, 7168, 4864, 4864, 7340032, 3145728, 32768, 8, 65613824, 114688, 0, 0, 218104209, 0
    .long 1, 32, 32, 8192, 4608, 4864, 8388608, 3145728, 32768, 8, 50405376, 131072, 0, 0, 218105930, 0
    .long 1, 16, 16, 8192, 5632, 5888, 8388608, 3670016, 32768, 8, 18964480, 131072, 0, 0, 218106202, 0
    .long 2, 64, 72, 7168, 5120, 5120, 7340032, 0, 32768, 8, 54607872, 114688, 0, 0, 218103825, 0
    .long 2, 64, 72, 7168, 4096, 4096, 7340032, 0, 32768, 8, 54591488, 114688, 0, 0, 218103825, 0
    .long 5, 218107968, 0, 0, 16, 0, 0, 4, 0, 0, 0, 0, 218112256, 8, 218106897, 0
    .long 2, 64, 72, 7168, 5120, 5120, 7340032, 3145728, 32768, 8, 65617920, 114688, 0, 0, 218104209, 0
    .long 2, 64, 72, 7168, 3584, 3584, 7340032, 524288, 32768, 8, 56418304, 114688, 0, 0, 218103889, 0
    .long 2, 64, 72, 7168, 4864, 4864, 7340032, 1572864, 32768, 8, 60108800, 114688, 0, 0, 218104017, 0
    .long 2, 64, 72, 7168, 5120, 5120, 7340032, 524288, 32768, 8, 56442880, 114688, 0, 0, 218103889, 0
    .long 1, 16, 16, 8192, 4096, 4352, 8388608, 3670016, 32768, 8, 18939904, 131072, 0, 0, 218106186, 0
    .long 5, 218108240, 0, 0, 20, 0, 0, 8, 0, 0, 0, 0, 218112256, 12, 218106961, 0
    .long 2, 64, 72, 7168, 3584, 3584, 7340032, 3145728, 32768, 8, 65593344, 114688, 0, 0, 218104209, 0
    .long 2, 64, 72, 7168, 4096, 4096, 7340032, 1572864, 32768, 8, 60096512, 114688, 0, 0, 218104017, 0
    .long 2, 64, 72, 7168, 4352, 4352, 7340032, 2097152, 32768, 8, 61935616, 114688, 0, 0, 218104081, 0
    .long 2, 64, 72, 7168, 3584, 3584, 7340032, 1572864, 32768, 8, 60088320, 114688, 0, 0, 218104017, 0
    .long 2, 64, 72, 7168, 4352, 4352, 7340032, 1572864, 32768, 8, 60100608, 114688, 0, 0, 218104017, 0
    .long 2, 64, 72, 7168, 5120, 5120, 7340032, 1572864, 32768, 8, 60112896, 114688, 0, 0, 218104017, 0
    .long 2, 64, 72, 7168, 3840, 3840, 7340032, 1572864, 32768, 8, 60092416, 114688, 0, 0, 218104017, 0
    .long 2, 64, 72, 7168, 3840, 3840, 7340032, 2097152, 32768, 8, 61927424, 114688, 0, 0, 218104081, 0
    .long 2, 64, 72, 7168, 4864, 4864, 7340032, 2097152, 32768, 8, 61943808, 114688, 0, 0, 218104081, 0
    .long 2, 64, 72, 7168, 4096, 4096, 7340032, 524288, 32768, 8, 56426496, 114688, 0, 0, 218103889, 0
    .long 2, 64, 72, 7168, 5120, 5120, 7340032, 2097152, 32768, 8, 61947904, 114688, 0, 0, 218104081, 0
    .long 2, 64, 72, 7168, 4608, 4608, 7340032, 1572864, 32768, 8, 60104704, 114688, 0, 0, 218104017, 0
    .long 2, 64, 72, 7168, 3840, 3840, 7340032, 1048576, 32768, 8, 58257408, 114688, 0, 0, 218103953, 0
    .long 2, 64, 72, 7168, 4608, 4608, 7340032, 1048576, 32768, 8, 58269696, 114688, 0, 0, 218103953, 0
    .long 2, 64, 72, 7168, 4096, 4096, 7340032, 3145728, 32768, 8, 65601536, 114688, 0, 0, 218104209, 0
    .long 2, 64, 72, 7168, 4864, 4864, 7340032, 1048576, 32768, 8, 58273792, 114688, 0, 0, 218103953, 0
    .long 5, 218108240, 0, 0, 20, 0, 0, 12, 0, 0, 0, 0, 218112256, 16, 218106961, 0
    .long 2, 64, 72, 7168, 5120, 5120, 7340032, 1048576, 32768, 8, 58277888, 114688, 0, 0, 218103953, 0
    .long 2, 64, 72, 7168, 4608, 4608, 7340032, 3145728, 32768, 8, 65609728, 114688, 0, 0, 218104209, 0
    .long 2, 64, 72, 7168, 4864, 4864, 7340032, 524288, 32768, 8, 56438784, 114688, 0, 0, 218103889, 0
    .long 2, 64, 72, 7168, 4352, 4352, 7340032, 1048576, 32768, 8, 58265600, 114688, 0, 0, 218103953, 0
    .long 2, 64, 72, 7168, 4096, 4096, 7340032, 1048576, 32768, 8, 58261504, 114688, 0, 0, 218103953, 0
    .long 2, 64, 72, 7168, 3840, 3840, 7340032, 3145728, 32768, 8, 65597440, 114688, 0, 0, 218104209, 0
    .long 5, 218108224, 0, 0, 16, 0, 0, 12, 0, 0, 0, 0, 218112256, 16, 218106961, 0
    .long 2, 64, 72, 7168, 4352, 4352, 7340032, 3670016, 32768, 8, 67440640, 114688, 0, 0, 218104273, 0
    .long 2, 64, 72, 7168, 4608, 4608, 7340032, 524288, 32768, 8, 56434688, 114688, 0, 0, 218103889, 0
    .long 1, 80, 80, 2048, 3670528, 3670784, 7340032, 54583296, 114688, 14, 121643008, 32768, 218103824, 14, 218106370, 0
    .long 1, 40, 40, 2048, 4194304, 4194560, 8388608, 176226304, 131072, 16, 79691776, 32768, 218106896, 8, 218106376, 0
    .long 5, 218108224, 0, 0, 16, 0, 0, 8, 0, 0, 0, 0, 218112256, 12, 218106961, 0
    .long 1, 32, 32, 8192, 4096, 4352, 8388608, 3670016, 32768, 8, 52494336, 131072, 0, 0, 218106186, 0
    .long 1, 16, 16, 8192, 4608, 4864, 8388608, 3670016, 32768, 8, 18948096, 131072, 0, 0, 218106186, 0
    .long 1, 16, 16, 8192, 5120, 5376, 8388608, 3670016, 32768, 8, 18956288, 131072, 0, 0, 218106202, 0
    .long 1, 40, 40, 2048, 4194816, 4195072, 8388608, 182517760, 131072, 16, 81272832, 32768, 218112256, 33, 218106568, 0
    .long 1, 40, 40, 2048, 4194816, 4195072, 8388608, 176226304, 131072, 16, 79699968, 32768, 218106896, 8, 218106376, 0
    .long 2, 64, 72, 7168, 4352, 4352, 7340032, 3145728, 32768, 8, 65605632, 114688, 0, 0, 218104209, 0
    .long 1, 40, 40, 2048, 4194304, 4194560, 8388608, 180420608, 131072, 16, 80740352, 32768, 218112256, 25, 218106504, 0
    .long 1, 40, 40, 2048, 4194816, 4195072, 8388608, 180420608, 131072, 16, 80748544, 32768, 218112256, 25, 218106504, 0
    .long 2, 64, 72, 7168, 4864, 4864, 7340032, 2621440, 32768, 8, 63778816, 114688, 0, 0, 218104145, 0
    .long 1, 40, 40, 2048, 4194304, 4194560, 8388608, 182517760, 131072, 16, 81264640, 32768, 218112256, 33, 218106568, 0
    .long 2, 64, 72, 7168, 3584, 3584, 7340032, 2621440, 32768, 8, 63758336, 114688, 0, 0, 218104145, 0
    .long 1, 80, 80, 2048, 3670016, 3670272, 7340032, 54583296, 114688, 14, 121634816, 32768, 218103824, 14, 218106370, 0
    .long 2, 64, 72, 7168, 5120, 5120, 7340032, 2621440, 32768, 8, 63782912, 114688, 0, 0, 218104145, 0
    .long 2, 64, 72, 7168, 3840, 3840, 7340032, 2621440, 32768, 8, 63762432, 114688, 0, 0, 218104145, 0
    .long 2, 64, 72, 7168, 4096, 4096, 7340032, 3670016, 32768, 8, 67436544, 114688, 0, 0, 218104273, 0
    .long 2, 64, 72, 7168, 4864, 4864, 7340032, 3670016, 32768, 8, 67448832, 114688, 0, 0, 218104273, 0
    .long 1, 40, 40, 2048, 4194304, 4194560, 8388608, 178323456, 131072, 16, 80216064, 32768, 218106960, 8, 218106440, 0
    .long 1, 40, 40, 2048, 4194816, 4195072, 8388608, 178323456, 131072, 16, 80224256, 32768, 218106960, 8, 218106440, 0
    .long 2, 64, 72, 7168, 4352, 4352, 7340032, 2621440, 32768, 8, 63770624, 114688, 0, 0, 218104145, 0
    .long 2, 64, 72, 7168, 3584, 3584, 7340032, 3670016, 32768, 8, 67428352, 114688, 0, 0, 218104273, 0
    .long 2, 64, 72, 7168, 4096, 4096, 7340032, 2621440, 32768, 8, 63766528, 114688, 0, 0, 218104145, 0
    .long 1, 80, 80, 2048, 3670528, 3670784, 7340032, 61923328, 114688, 14, 123740160, 32768, 218104080, 14, 218106626, 0
    .long 1, 80, 80, 2048, 3670016, 3670272, 7340032, 60088320, 114688, 14, 123207680, 32768, 218104016, 14, 218106562, 0
    .long 1, 80, 80, 2048, 3670016, 3670272, 7340032, 61923328, 114688, 14, 123731968, 32768, 218104080, 14, 218106626, 0
    .long 1, 80, 80, 2048, 3670528, 3670784, 7340032, 60088320, 114688, 14, 123215872, 32768, 218104016, 14, 218106562, 0
    .long 2, 64, 72, 7168, 4608, 4608, 7340032, 3670016, 32768, 8, 67444736, 114688, 0, 0, 218104273, 0
    .long 2, 64, 72, 7168, 3840, 3840, 7340032, 3670016, 32768, 8, 67432448, 114688, 0, 0, 218104273, 0
    .long 1, 80, 80, 2048, 3670016, 3670272, 7340032, 58253312, 114688, 14, 122683392, 32768, 218103952, 14, 218106498, 0
    .long 1, 80, 80, 2048, 3670528, 3670784, 7340032, 58253312, 114688, 14, 122691584, 32768, 218103952, 14, 218106498, 0
    .long 2, 64, 72, 7168, 5120, 5120, 7340032, 3670016, 32768, 8, 67452928, 114688, 0, 0, 218104273, 0
    .long 1, 80, 80, 2048, 3670528, 3670784, 7340032, 56418304, 114688, 14, 122167296, 32768, 218103888, 14, 218106434, 0
    .long 1, 80, 80, 2048, 3670016, 3670272, 7340032, 56418304, 114688, 14, 122159104, 32768, 218103888, 14, 218106434, 0
    .long 1, 40, 40, 2048, 4194816, 4195072, 8388608, 184614912, 131072, 8, 85991424, 32768, 218112256, 41, 218106628, 0
    .long 1, 80, 80, 2048, 3670016, 3670272, 7340032, 65593344, 114688, 7, 128974848, 32768, 218104208, 7, 218106753, 0
    .long 1, 80, 80, 2048, 3670528, 3670784, 7340032, 65593344, 114688, 7, 128983040, 32768, 218104208, 7, 218106753, 0
    .long 1, 40, 40, 2048, 4194304, 4194560, 8388608, 184614912, 131072, 8, 85983232, 32768, 218112256, 41, 218106628, 0
    .long 1, 80, 80, 2048, 3671552, 3671808, 7340032, 65593344, 114688, 7, 128999424, 32768, 218104208, 7, 218106753, 0
    .long 1, 40, 40, 2048, 4195328, 4195584, 8388608, 184614912, 131072, 8, 85999616, 32768, 218112256, 41, 218106628, 0
    .long 1, 40, 40, 2048, 4195840, 4196096, 8388608, 184614912, 131072, 8, 86007808, 32768, 218112256, 41, 218106628, 0
    .long 1, 40, 40, 2048, 4194816, 4195072, 8388608, 186712064, 131072, 8, 86515712, 32768, 218112256, 49, 218106692, 0
    .long 1, 80, 80, 2048, 3671040, 3671296, 7340032, 65593344, 114688, 7, 128991232, 32768, 218104208, 7, 218106753, 0
    .long 1, 40, 40, 2048, 4195328, 4195584, 8388608, 186712064, 131072, 8, 86523904, 32768, 218112256, 49, 218106692, 0
    .long 1, 40, 40, 2048, 4194304, 4194560, 8388608, 186712064, 131072, 8, 86507520, 32768, 218112256, 49, 218106692, 0
    .long 1, 40, 40, 2048, 4195840, 4196096, 8388608, 186712064, 131072, 8, 86532096, 32768, 218112256, 49, 218106692, 0
    .long 1, 80, 80, 2048, 3671040, 3671296, 7340032, 63758336, 114688, 7, 128466944, 32768, 218104144, 7, 218106689, 0
    .long 1, 80, 80, 2048, 3671552, 3671808, 7340032, 63758336, 114688, 7, 128475136, 32768, 218104144, 7, 218106689, 0
    .long 1, 80, 80, 2048, 3670016, 3670272, 7340032, 63758336, 114688, 7, 128450560, 32768, 218104144, 7, 218106689, 0
    .long 1, 80, 80, 2048, 3670528, 3670784, 7340032, 63758336, 114688, 7, 128458752, 32768, 218104144, 7, 218106689, 0
    .long 1, 80, 80, 2048, 3670528, 3670784, 7340032, 67428352, 114688, 7, 129507328, 32768, 218104272, 7, 218106817, 0
    .long 1, 80, 80, 2048, 3671040, 3671296, 7340032, 67428352, 114688, 7, 129515520, 32768, 218104272, 7, 218106817, 0
    .long 1, 80, 80, 2048, 3671552, 3671808, 7340032, 67428352, 114688, 7, 129523712, 32768, 218104272, 7, 218106817, 0
    .long 1, 80, 80, 2048, 3670016, 3670272, 7340032, 67428352, 114688, 7, 129499136, 32768, 218104272, 7, 218106817, 0
    .long 6, 1, 3, 2, 2, 16, 0, 3, 0, 0, 0, 0, 0, 0, 0, 0
    .long 6, 0, 51, 0, 2, 0, 0, 51, 0, 0, 0, 0, 0, 0, 0, 0
    .long 6, 1, 1, 2, 2, 16, 0, 1, 0, 0, 0, 0, 0, 0, 0, 0
    .long 6, 1, 0, 2, 2, 16, 0, 0, 0, 0, 0, 0, 0, 0, 0, 0
    .long 6, 1, 5, 2, 2, 16, 0, 5, 0, 0, 0, 0, 0, 0, 0, 0
    .long 6, 1, 4, 2, 2, 16, 0, 4, 0, 0, 0, 0, 0, 0, 0, 0
    .long 6, 1, 22, 2, 2, 16, 0, 22, 0, 0, 0, 0, 0, 0, 0, 0
    .long 6, 1, 6, 2, 2, 16, 0, 6, 0, 0, 0, 0, 0, 0, 0, 0
    .long 6, 1, 18, 2, 2, 16, 0, 18, 0, 0, 0, 0, 0, 0, 0, 0
    .long 6, 1, 19, 2, 2, 16, 0, 19, 0, 0, 0, 0, 0, 0, 0, 0
    .long 6, 1, 20, 2, 2, 16, 0, 20, 0, 0, 0, 0, 0, 0, 0, 0
    .long 6, 1, 7, 2, 2, 16, 0, 7, 0, 0, 0, 0, 0, 0, 0, 0
    .long 6, 1, 2, 2, 2, 16, 0, 2, 0, 0, 0, 0, 0, 0, 0, 0
    .long 6, 1, 17, 2, 2, 16, 0, 17, 0, 0, 0, 0, 0, 0, 0, 0
    .long 6, 1, 21, 2, 2, 16, 0, 21, 0, 0, 0, 0, 0, 0, 0, 0
    .long 6, 1, 16, 2, 2, 16, 0, 16, 0, 0, 0, 0, 0, 0, 0, 0
    .long 6, 0, 50, 0, 2, 0, 0, 50, 0, 0, 0, 0, 0, 0, 0, 0
    .long 6, 0, 52, 0, 2, 0, 0, 52, 0, 0, 0, 0, 0, 0, 0, 0
    .long 6, 0, 54, 0, 2, 0, 0, 54, 0, 0, 0, 0, 0, 0, 0, 0
    .long 6, 0, 49, 0, 2, 0, 0, 49, 0, 0, 0, 0, 0, 0, 0, 0
    .long 6, 0, 48, 0, 2, 0, 0, 48, 0, 0, 0, 0, 0, 0, 0, 0
    .long 6, 0, 53, 0, 2, 0, 0, 53, 0, 0, 0, 0, 0, 0, 0, 0
    .long 6, 0, 55, 0, 2, 0, 0, 55, 0, 0, 0, 0, 0, 0, 0, 0
    .long 6, 0, 56, 0, 2, 0, 0, 56, 0, 0, 0, 0, 0, 0, 0, 0
    .long 6, 1, 23, 2, 2, 16, 0, 23, 0, 0, 0, 0, 0, 0, 0, 0
    .long 6, 1, 24, 2, 2, 16, 0, 24, 0, 0, 0, 0, 0, 0, 0, 0
    .long 6, 1, 25, 2, 2, 16, 0, 25, 0, 0, 0, 0, 0, 0, 0, 0
    .long 6, 1, 26, 2, 2, 16, 0, 26, 0, 0, 0, 0, 0, 0, 0, 0
    .long 6, 1, 27, 2, 2, 16, 0, 27, 0, 0, 0, 0, 0, 0, 0, 0
    .long 6, 1, 28, 2, 2, 16, 0, 28, 0, 0, 0, 0, 0, 0, 0, 0
    .long 6, 1, 29, 2, 2, 16, 0, 29, 0, 0, 0, 0, 0, 0, 0, 0
    .long 6, 1, 30, 2, 2, 16, 0, 30, 0, 0, 0, 0, 0, 0, 0, 0
    .long 6, 1, 31, 2, 2, 16, 0, 31, 0, 0, 0, 0, 0, 0, 0, 0
    .long 6, 0, 40, 1, 2, 16, 0, 40, 0, 0, 0, 0, 0, 0, 0, 0
    .long 6, 0, 41, 1, 2, 16, 0, 41, 0, 0, 0, 0, 0, 0, 0, 0
    .long 6, 0, 43, 1, 2, 16, 0, 43, 0, 0, 0, 0, 0, 0, 0, 0
    .long 6, 0, 45, 1, 2, 16, 0, 45, 0, 0, 0, 0, 0, 0, 0, 0
    .long 6, 0, 46, 1, 2, 16, 0, 46, 0, 0, 0, 0, 0, 0, 0, 0
    .long 6, 0, 47, 1, 2, 16, 0, 47, 0, 0, 0, 0, 0, 0, 0, 0
    .long 6, 1, 32, 1, 2, 16, 0, 32, 0, 0, 0, 0, 0, 0, 0, 0
    .long 6, 1, 33, 1, 2, 16, 0, 33, 0, 0, 0, 0, 0, 0, 0, 0
    .long 6, 1, 35, 1, 2, 16, 0, 35, 0, 0, 0, 0, 0, 0, 0, 0
    .long 6, 1, 36, 1, 2, 16, 0, 36, 0, 0, 0, 0, 0, 0, 0, 0
    .long 6, 1, 38, 1, 2, 16, 0, 38, 0, 0, 0, 0, 0, 0, 0, 0
    .long 6, 1, 39, 1, 2, 16, 0, 39, 0, 0, 0, 0, 0, 0, 0, 0
    .long 6, 0, 57, 0, 2, 0, 0, 57, 0, 0, 0, 0, 0, 0, 0, 0
    .long 6, 0, 44, 1, 2, 16, 0, 44, 0, 0, 0, 0, 0, 0, 0, 0
    .long 6, 1, 34, 1, 2, 16, 0, 34, 0, 0, 0, 0, 0, 0, 0, 0
    .long 6, 0, 58, 0, 2, 0, 0, 58, 0, 0, 0, 0, 0, 0, 0, 0
    .long 6, 1, 37, 1, 2, 16, 0, 37, 0, 0, 0, 0, 0, 0, 0, 0
    .long 6, 0, 42, 1, 2, 16, 0, 42, 0, 0, 0, 0, 0, 0, 0, 0
    .long 6, 0, 59, 0, 2, 0, 0, 59, 0, 0, 0, 0, 0, 0, 0, 0
    .long 6, 1, 8, 2, 2, 16, 0, 8, 0, 0, 0, 0, 0, 0, 0, 0
    .long 6, 1, 9, 2, 2, 16, 0, 9, 0, 0, 0, 0, 0, 0, 0, 0
    .long 6, 1, 10, 2, 2, 16, 0, 10, 0, 0, 0, 0, 0, 0, 0, 0
    .long 6, 1, 11, 2, 2, 16, 0, 11, 0, 0, 0, 0, 0, 0, 0, 0
    .long 6, 1, 12, 2, 2, 16, 0, 12, 0, 0, 0, 0, 0, 0, 0, 0
    .long 6, 1, 13, 2, 2, 16, 0, 13, 0, 0, 0, 0, 0, 0, 0, 0
    .long 6, 1, 14, 2, 2, 16, 0, 14, 0, 0, 0, 0, 0, 0, 0, 0
    .long 6, 1, 15, 2, 2, 16, 0, 15, 0, 0, 0, 0, 0, 0, 0, 0
    .long 7, 0, 60, 0, 8, 0, 0, 60, 0, 0, 0, 0, 0, 0, 0, 0
    .long 7, 0, 60, 0, 9, 0, 0, 60, 0, 0, 0, 0, 0, 0, 0, 0
    .long 7, 0, 60, 0, 10, 0, 0, 60, 0, 0, 0, 0, 0, 0, 0, 0
    .long 7, 0, 60, 0, 11, 0, 0, 60, 0, 0, 0, 0, 0, 0, 0, 0
    .long 7, 0, 61, 0, 8, 0, 0, 61, 0, 0, 0, 0, 0, 0, 0, 0
    .long 7, 0, 61, 0, 9, 0, 0, 61, 0, 0, 0, 0, 0, 0, 0, 0
    .long 7, 0, 61, 0, 10, 0, 0, 61, 0, 0, 0, 0, 0, 0, 0, 0
    .long 7, 0, 61, 0, 11, 0, 0, 61, 0, 0, 0, 0, 0, 0, 0, 0
    .long 7, 0, 62, 0, 8, 0, 0, 62, 0, 0, 0, 0, 0, 0, 0, 0
    .long 7, 0, 62, 0, 9, 0, 0, 62, 0, 0, 0, 0, 0, 0, 0, 0
    .long 7, 0, 62, 0, 10, 0, 0, 62, 0, 0, 0, 0, 0, 0, 0, 0
    .long 7, 0, 62, 0, 11, 0, 0, 62, 0, 0, 0, 0, 0, 0, 0, 0
    .long 7, 0, 63, 0, 8, 0, 0, 63, 0, 0, 0, 0, 0, 0, 0, 0
    .long 7, 0, 63, 0, 9, 0, 0, 63, 0, 0, 0, 0, 0, 0, 0, 0
    .long 7, 0, 63, 0, 10, 0, 0, 63, 0, 0, 0, 0, 0, 0, 0, 0
    .long 7, 0, 63, 0, 11, 0, 0, 63, 0, 0, 0, 0, 0, 0, 0, 0
    .long 0, 0, 0, 0, 0, 0, 0, 0, 0, 0, 0, 0, 0, 0, 0, 0
    .long 4, 24, 24, 8192, 6144, 268288, 8388608, 0, 32768, 4, 21069824, 131072, 0, 0, 218104417, 0
    .long 4, 24, 24, 8192, 6400, 268544, 8388608, 0, 32768, 4, 21073920, 131072, 0, 0, 218104417, 0
    .long 4, 24, 24, 8192, 6656, 268800, 8388608, 0, 32768, 4, 21078016, 131072, 0, 0, 218104417, 0
    .long 4, 24, 24, 8192, 6912, 269056, 8388608, 0, 32768, 4, 21082112, 131072, 0, 0, 218104417, 0
    .long 4, 24, 24, 8192, 7168, 269312, 8388608, 0, 32768, 4, 21086208, 131072, 0, 0, 218104433, 0
    .long 4, 24, 24, 8192, 7424, 269568, 8388608, 0, 32768, 4, 21090304, 131072, 0, 0, 218104433, 0
    .long 4, 24, 24, 8192, 7680, 269824, 8388608, 0, 32768, 4, 21094400, 131072, 0, 0, 218104433, 0
    .long 4, 24, 24, 8192, 7936, 270080, 8388608, 0, 32768, 4, 21098496, 131072, 0, 0, 218104433, 0
    .long 4, 32, 32, 8192, 6144, 268288, 8388608, 0, 32768, 4, 37847040, 131072, 0, 0, 218104417, 0
    .long 4, 32, 32, 8192, 6400, 268544, 8388608, 0, 32768, 4, 37851136, 131072, 0, 0, 218104417, 0
    .long 4, 32, 32, 8192, 6656, 268800, 8388608, 0, 32768, 4, 37855232, 131072, 0, 0, 218104417, 0
    .long 4, 32, 32, 8192, 6912, 269056, 8388608, 0, 32768, 4, 37859328, 131072, 0, 0, 218104417, 0
    .long 4, 32, 32, 8192, 7168, 269312, 8388608, 0, 32768, 4, 37863424, 131072, 0, 0, 218104433, 0
    .long 4, 32, 32, 8192, 7424, 269568, 8388608, 0, 32768, 4, 37867520, 131072, 0, 0, 218104433, 0
    .long 4, 32, 32, 8192, 7680, 269824, 8388608, 0, 32768, 4, 37871616, 131072, 0, 0, 218104433, 0
    .long 4, 32, 32, 8192, 7936, 270080, 8388608, 0, 32768, 4, 37875712, 131072, 0, 0, 218104433, 0
    .long 4, 24, 24, 8192, 6144, 268288, 8388608, 262144, 32768, 4, 22118400, 131072, 0, 0, 218104420, 0
    .long 4, 24, 24, 8192, 6400, 268544, 8388608, 262144, 32768, 4, 22122496, 131072, 0, 0, 218104420, 0
    .long 4, 24, 24, 8192, 6656, 268800, 8388608, 262144, 32768, 4, 22126592, 131072, 0, 0, 218104420, 0
    .long 4, 24, 24, 8192, 6912, 269056, 8388608, 262144, 32768, 4, 22130688, 131072, 0, 0, 218104420, 0
    .long 4, 24, 24, 8192, 7168, 269312, 8388608, 262144, 32768, 4, 22134784, 131072, 0, 0, 218104436, 0
    .long 4, 24, 24, 8192, 7424, 269568, 8388608, 262144, 32768, 4, 22138880, 131072, 0, 0, 218104436, 0
    .long 4, 24, 24, 8192, 7680, 269824, 8388608, 262144, 32768, 4, 22142976, 131072, 0, 0, 218104436, 0
    .long 4, 24, 24, 8192, 7936, 270080, 8388608, 262144, 32768, 4, 22147072, 131072, 0, 0, 218104436, 0
    .long 4, 32, 32, 8192, 6144, 268288, 8388608, 262144, 32768, 4, 38895616, 131072, 0, 0, 218104420, 0
    .long 4, 32, 32, 8192, 6400, 268544, 8388608, 262144, 32768, 4, 38899712, 131072, 0, 0, 218104420, 0
    .long 4, 32, 32, 8192, 6656, 268800, 8388608, 262144, 32768, 4, 38903808, 131072, 0, 0, 218104420, 0
    .long 4, 32, 32, 8192, 6912, 269056, 8388608, 262144, 32768, 4, 38907904, 131072, 0, 0, 218104420, 0
    .long 4, 32, 32, 8192, 7168, 269312, 8388608, 262144, 32768, 4, 38912000, 131072, 0, 0, 218104436, 0
    .long 4, 32, 32, 8192, 7424, 269568, 8388608, 262144, 32768, 4, 38916096, 131072, 0, 0, 218104436, 0
    .long 4, 32, 32, 8192, 7680, 269824, 8388608, 262144, 32768, 4, 38920192, 131072, 0, 0, 218104436, 0
    .long 4, 32, 32, 8192, 7936, 270080, 8388608, 262144, 32768, 4, 38924288, 131072, 0, 0, 218104436, 0
    .long 4, 32, 32, 8192, 6400, 268544, 8388608, 786432, 32768, 4, 40996864, 131072, 0, 0, 218104676, 0
    .long 4, 24, 24, 8192, 6656, 268800, 8388608, 786432, 32768, 4, 24223744, 131072, 0, 0, 218104676, 0
    .long 4, 24, 24, 8192, 7680, 269824, 8388608, 786432, 32768, 4, 24240128, 131072, 0, 0, 218104692, 0
    .long 4, 32, 32, 8192, 6912, 269056, 8388608, 524288, 32768, 4, 39956480, 131072, 0, 0, 218104673, 0
    .long 4, 32, 32, 8192, 7680, 269824, 8388608, 786432, 32768, 4, 41017344, 131072, 0, 0, 218104692, 0
    .long 4, 32, 32, 8192, 7424, 269568, 8388608, 524288, 32768, 4, 39964672, 131072, 0, 0, 218104689, 0
    .long 4, 24, 24, 8192, 7168, 269312, 8388608, 786432, 32768, 4, 24231936, 131072, 0, 0, 218104692, 0
    .long 4, 32, 32, 8192, 7936, 270080, 8388608, 524288, 32768, 4, 39972864, 131072, 0, 0, 218104689, 0
    .long 4, 32, 32, 8192, 6656, 268800, 8388608, 786432, 32768, 4, 41000960, 131072, 0, 0, 218104676, 0
    .long 4, 32, 32, 8192, 6656, 268800, 8388608, 524288, 32768, 4, 39952384, 131072, 0, 0, 218104673, 0
    .long 4, 32, 32, 8192, 7168, 269312, 8388608, 786432, 32768, 4, 41009152, 131072, 0, 0, 218104692, 0
    .long 4, 24, 24, 8192, 6912, 269056, 8388608, 524288, 32768, 4, 23179264, 131072, 0, 0, 218104673, 0
    .long 2, 64, 72, 7168, 5376, 5376, 7340032, 1048576, 32768, 8, 58281984, 114688, 0, 0, 218103953, 0
    .long 4, 24, 24, 8192, 6400, 268544, 8388608, 786432, 32768, 4, 24219648, 131072, 0, 0, 218104676, 0
    .long 4, 24, 24, 8192, 7424, 269568, 8388608, 524288, 32768, 4, 23187456, 131072, 0, 0, 218104689, 0
    .long 4, 32, 32, 8192, 6400, 268544, 8388608, 524288, 32768, 4, 39948288, 131072, 0, 0, 218104673, 0
    .long 4, 32, 32, 8192, 7936, 270080, 8388608, 786432, 32768, 4, 41021440, 131072, 0, 0, 218104692, 0
    .long 4, 24, 24, 8192, 6144, 268288, 8388608, 524288, 32768, 4, 23166976, 131072, 0, 0, 218104673, 0
    .long 4, 24, 24, 8192, 7680, 269824, 8388608, 524288, 32768, 4, 23191552, 131072, 0, 0, 218104689, 0
    .long 4, 32, 32, 8192, 6144, 268288, 8388608, 524288, 32768, 4, 39944192, 131072, 0, 0, 218104673, 0
    .long 4, 24, 24, 8192, 7936, 270080, 8388608, 524288, 32768, 4, 23195648, 131072, 0, 0, 218104689, 0
    .long 4, 32, 32, 8192, 6144, 268288, 8388608, 786432, 32768, 4, 40992768, 131072, 0, 0, 218104676, 0
    .long 4, 24, 24, 8192, 6912, 269056, 8388608, 786432, 32768, 4, 24227840, 131072, 0, 0, 218104676, 0
    .long 4, 32, 32, 8192, 6912, 269056, 8388608, 786432, 32768, 4, 41005056, 131072, 0, 0, 218104676, 0
    .long 4, 32, 32, 8192, 7680, 269824, 8388608, 524288, 32768, 4, 39968768, 131072, 0, 0, 218104689, 0
    .long 4, 24, 24, 8192, 7168, 269312, 8388608, 524288, 32768, 4, 23183360, 131072, 0, 0, 218104689, 0
    .long 4, 32, 32, 8192, 7424, 269568, 8388608, 786432, 32768, 4, 41013248, 131072, 0, 0, 218104692, 0
    .long 4, 24, 24, 8192, 6400, 268544, 8388608, 524288, 32768, 4, 23171072, 131072, 0, 0, 218104673, 0
    .long 4, 32, 32, 8192, 7168, 269312, 8388608, 524288, 32768, 4, 39960576, 131072, 0, 0, 218104689, 0
    .long 4, 24, 24, 8192, 6656, 268800, 8388608, 524288, 32768, 4, 23175168, 131072, 0, 0, 218104673, 0
    .long 4, 24, 24, 8192, 7424, 269568, 8388608, 786432, 32768, 4, 24236032, 131072, 0, 0, 218104692, 0
    .long 4, 24, 24, 8192, 6144, 268288, 8388608, 786432, 32768, 4, 24215552, 131072, 0, 0, 218104676, 0
    .long 1, 32, 32, 8192, 7168, 7424, 8388608, 1048576, 32768, 8, 42057728, 131072, 0, 0, 218104954, 0
    .long 1, 24, 24, 8192, 6656, 6912, 8388608, 1048576, 32768, 8, 25272320, 131072, 0, 0, 218104938, 0
    .long 1, 16, 16, 8192, 6656, 6912, 8388608, 1048576, 32768, 8, 8495104, 131072, 0, 0, 218104938, 0
    .long 1, 24, 24, 8192, 7168, 7424, 8388608, 1048576, 32768, 8, 25280512, 131072, 0, 0, 218104954, 0
    .long 4, 24, 24, 8192, 7936, 270080, 8388608, 786432, 32768, 4, 24244224, 131072, 0, 0, 218104692, 0
    .long 1, 16, 16, 8192, 6144, 6400, 8388608, 1048576, 32768, 8, 8486912, 131072, 0, 0, 218104938, 0
    .long 1, 24, 24, 8192, 6656, 6912, 8388608, 1572864, 32768, 8, 27369472, 131072, 0, 0, 218105194, 0
    .long 1, 32, 32, 8192, 7168, 7424, 8388608, 1572864, 32768, 8, 44154880, 131072, 0, 0, 218105210, 0
    .long 1, 24, 24, 8192, 6144, 6400, 8388608, 1048576, 32768, 8, 25264128, 131072, 0, 0, 218104938, 0
    .long 1, 32, 32, 8192, 6656, 6912, 8388608, 1048576, 32768, 8, 42049536, 131072, 0, 0, 218104938, 0
    .long 1, 16, 16, 8192, 7680, 7936, 8388608, 1572864, 32768, 8, 10608640, 131072, 0, 0, 218105210, 0
    .long 1, 16, 16, 8192, 6144, 6400, 8388608, 0, 32768, 8, 4292608, 131072, 0, 0, 218108010, 0
    .long 1, 24, 24, 8192, 7168, 7424, 8388608, 1572864, 32768, 8, 27377664, 131072, 0, 0, 218105210, 0
    .long 1, 32, 32, 8192, 7680, 7936, 8388608, 1572864, 32768, 8, 44163072, 131072, 0, 0, 218105210, 0
    .long 1, 32, 32, 8192, 6144, 6400, 8388608, 1048576, 32768, 8, 42041344, 131072, 0, 0, 218104938, 0
    .long 1, 16, 16, 8192, 7168, 7424, 8388608, 1572864, 32768, 8, 10600448, 131072, 0, 0, 218105210, 0
    .long 1, 32, 32, 8192, 7680, 7936, 8388608, 1048576, 32768, 8, 42065920, 131072, 0, 0, 218104954, 0
    .long 1, 24, 24, 8192, 7680, 7936, 8388608, 1572864, 32768, 8, 27385856, 131072, 0, 0, 218105210, 0
    .long 1, 16, 16, 8192, 7680, 7936, 8388608, 1048576, 32768, 8, 8511488, 131072, 0, 0, 218104954, 0
    .long 1, 32, 32, 8192, 6144, 6400, 8388608, 1572864, 32768, 8, 44138496, 131072, 0, 0, 218105194, 0
    .long 1, 16, 16, 8192, 7680, 7936, 8388608, 0, 32768, 8, 4317184, 131072, 0, 0, 218108026, 0
    .long 1, 16, 16, 8192, 6656, 6912, 8388608, 2097152, 32768, 8, 12689408, 131072, 0, 0, 218105450, 0
    .long 1, 16, 16, 8192, 7168, 7424, 8388608, 1048576, 32768, 8, 8503296, 131072, 0, 0, 218104954, 0
    .long 1, 16, 16, 8192, 6144, 6400, 8388608, 1572864, 32768, 8, 10584064, 131072, 0, 0, 218105194, 0
    .long 1, 32, 32, 8192, 6144, 6400, 8388608, 2097152, 32768, 8, 46235648, 131072, 0, 0, 218105450, 0
    .long 1, 16, 16, 8192, 6656, 6912, 8388608, 0, 32768, 8, 4300800, 131072, 0, 0, 218108010, 0
    .long 1, 24, 24, 8192, 7680, 7936, 8388608, 1048576, 32768, 8, 25288704, 131072, 0, 0, 218104954, 0
    .long 1, 16, 16, 8192, 6656, 6912, 8388608, 1572864, 32768, 8, 10592256, 131072, 0, 0, 218105194, 0
    .long 1, 16, 16, 8192, 7168, 7424, 8388608, 0, 32768, 8, 4308992, 131072, 0, 0, 218108026, 0
    .long 1, 32, 32, 8192, 6656, 6912, 8388608, 2097152, 32768, 8, 46243840, 131072, 0, 0, 218105450, 0
    .long 1, 32, 32, 8192, 6656, 6912, 8388608, 1572864, 32768, 8, 44146688, 131072, 0, 0, 218105194, 0
    .long 1, 24, 24, 8192, 6144, 6400, 8388608, 1572864, 32768, 8, 27361280, 131072, 0, 0, 218105194, 0
    .long 1, 16, 16, 8192, 6144, 6400, 8388608, 524288, 32768, 8, 6389760, 131072, 0, 0, 218108266, 0
    .long 1, 32, 32, 8192, 7168, 7424, 8388608, 3670016, 32768, 8, 52543488, 131072, 0, 0, 218106234, 0
    .long 1, 16, 16, 8192, 7168, 7424, 8388608, 2621440, 32768, 8, 14794752, 131072, 0, 0, 218105722, 0
    .long 1, 24, 24, 8192, 6656, 6912, 8388608, 3145728, 32768, 8, 33660928, 131072, 0, 0, 218105962, 0
    .long 1, 16, 16, 8192, 6144, 6400, 8388608, 2621440, 32768, 8, 14778368, 131072, 0, 0, 218105706, 0
    .long 1, 32, 32, 8192, 7680, 7936, 8388608, 3670016, 32768, 8, 52551680, 131072, 0, 0, 218106234, 0
    .long 1, 16, 16, 8192, 6144, 6400, 8388608, 3145728, 32768, 8, 16875520, 131072, 0, 0, 218105962, 0
    .long 1, 24, 24, 8192, 7168, 7424, 8388608, 2097152, 32768, 8, 29474816, 131072, 0, 0, 218105466, 0
    .long 1, 16, 16, 8192, 7680, 7936, 8388608, 2097152, 32768, 8, 12705792, 131072, 0, 0, 218105466, 0
    .long 1, 24, 24, 8192, 6656, 6912, 8388608, 3670016, 32768, 8, 35758080, 131072, 0, 0, 218106218, 0
    .long 1, 24, 24, 8192, 7680, 7936, 8388608, 3145728, 32768, 8, 33677312, 131072, 0, 0, 218105978, 0
    .long 1, 32, 32, 8192, 7680, 7936, 8388608, 2621440, 32768, 8, 48357376, 131072, 0, 0, 218105722, 0
    .long 1, 32, 32, 8192, 7680, 7936, 8388608, 2097152, 32768, 8, 46260224, 131072, 0, 0, 218105466, 0
    .long 1, 24, 24, 8192, 7680, 7936, 8388608, 2097152, 32768, 8, 29483008, 131072, 0, 0, 218105466, 0
    .long 1, 24, 24, 8192, 6144, 6400, 8388608, 2097152, 32768, 8, 29458432, 131072, 0, 0, 218105450, 0
    .long 1, 32, 32, 8192, 7680, 7936, 8388608, 3145728, 32768, 8, 50454528, 131072, 0, 0, 218105978, 0
    .long 1, 32, 32, 8192, 6144, 6400, 8388608, 3145728, 32768, 8, 50429952, 131072, 0, 0, 218105962, 0
    .long 1, 16, 16, 8192, 7168, 7424, 8388608, 3145728, 32768, 8, 16891904, 131072, 0, 0, 218105978, 0
    .long 1, 16, 16, 8192, 7168, 7424, 8388608, 2097152, 32768, 8, 12697600, 131072, 0, 0, 218105466, 0
    .long 5, 218108016, 0, 0, 28, 0, 0, 0, 0, 0, 0, 0, 218112384, 4, 218106897, 0
    .long 1, 32, 32, 8192, 7168, 7424, 8388608, 3145728, 32768, 8, 50446336, 131072, 0, 0, 218105978, 0
    .long 1, 24, 24, 8192, 7680, 7936, 8388608, 3670016, 32768, 8, 35774464, 131072, 0, 0, 218106234, 0
    .long 1, 32, 32, 8192, 6144, 6400, 8388608, 2621440, 32768, 8, 48332800, 131072, 0, 0, 218105706, 0
    .long 1, 32, 32, 8192, 7168, 7424, 8388608, 2097152, 32768, 8, 46252032, 131072, 0, 0, 218105466, 0
    .long 1, 24, 24, 8192, 6656, 6912, 8388608, 2621440, 32768, 8, 31563776, 131072, 0, 0, 218105706, 0
    .long 1, 24, 24, 8192, 6656, 6912, 8388608, 2097152, 32768, 8, 29466624, 131072, 0, 0, 218105450, 0
    .long 1, 16, 16, 8192, 7680, 7936, 8388608, 524288, 32768, 8, 6414336, 131072, 0, 0, 218108282, 0
    .long 1, 32, 32, 8192, 7168, 7424, 8388608, 2621440, 32768, 8, 48349184, 131072, 0, 0, 218105722, 0
    .long 1, 16, 16, 8192, 7168, 7424, 8388608, 524288, 32768, 8, 6406144, 131072, 0, 0, 218108282, 0
    .long 1, 24, 24, 8192, 6144, 6400, 8388608, 2621440, 32768, 8, 31555584, 131072, 0, 0, 218105706, 0
    .long 1, 16, 16, 8192, 6144, 6400, 8388608, 2097152, 32768, 8, 12681216, 131072, 0, 0, 218105450, 0
    .long 5, 218108016, 0, 0, 28, 0, 0, 4, 0, 0, 0, 0, 218112384, 8, 218106897, 0
    .long 5, 218108000, 0, 0, 24, 0, 0, 0, 0, 0, 0, 0, 218112384, 4, 218106897, 0
    .long 1, 24, 24, 8192, 7168, 7424, 8388608, 3670016, 32768, 8, 35766272, 131072, 0, 0, 218106234, 0
    .long 2, 64, 72, 7168, 5376, 5376, 7340032, 2097152, 32768, 8, 61952000, 114688, 0, 0, 218104081, 0
    .long 1, 24, 24, 8192, 7680, 7936, 8388608, 2621440, 32768, 8, 31580160, 131072, 0, 0, 218105722, 0
    .long 2, 64, 72, 7168, 5632, 5632, 7340032, 0, 32768, 8, 54616064, 114688, 0, 0, 218103825, 0
    .long 1, 24, 24, 8192, 6144, 6400, 8388608, 3670016, 32768, 8, 35749888, 131072, 0, 0, 218106218, 0
    .long 1, 32, 32, 8192, 6656, 6912, 8388608, 3670016, 32768, 8, 52535296, 131072, 0, 0, 218106218, 0
    .long 2, 64, 72, 7168, 6400, 6400, 7340032, 2621440, 32768, 8, 63803392, 114688, 0, 0, 218104148, 0
    .long 1, 32, 32, 8192, 6656, 6912, 8388608, 2621440, 32768, 8, 48340992, 131072, 0, 0, 218105706, 0
    .long 1, 16, 16, 8192, 6656, 6912, 8388608, 2621440, 32768, 8, 14786560, 131072, 0, 0, 218105706, 0
    .long 2, 64, 72, 7168, 5376, 5376, 7340032, 0, 32768, 8, 54611968, 114688, 0, 0, 218103825, 0
    .long 1, 16, 16, 8192, 7680, 7936, 8388608, 3145728, 32768, 8, 16900096, 131072, 0, 0, 218105978, 0
    .long 1, 24, 24, 8192, 7168, 7424, 8388608, 2621440, 32768, 8, 31571968, 131072, 0, 0, 218105722, 0
    .long 2, 64, 72, 7168, 5632, 5632, 7340032, 524288, 32768, 8, 56451072, 114688, 0, 0, 218103889, 0
    .long 1, 24, 24, 8192, 6144, 6400, 8388608, 3145728, 32768, 8, 33652736, 131072, 0, 0, 218105962, 0
    .long 2, 64, 72, 7168, 6144, 6144, 7340032, 0, 32768, 8, 54624256, 114688, 0, 0, 218103825, 0
    .long 2, 64, 72, 7168, 6144, 6144, 7340032, 524288, 32768, 8, 56459264, 114688, 0, 0, 218103889, 0
    .long 2, 64, 72, 7168, 5888, 5888, 7340032, 2097152, 32768, 8, 61960192, 114688, 0, 0, 218104081, 0
    .long 2, 64, 72, 7168, 6400, 6400, 7340032, 2097152, 32768, 8, 61968384, 114688, 0, 0, 218104081, 0
    .long 1, 16, 16, 8192, 6656, 6912, 8388608, 524288, 32768, 8, 6397952, 131072, 0, 0, 218108266, 0
    .long 1, 16, 16, 8192, 6656, 6912, 8388608, 3145728, 32768, 8, 16883712, 131072, 0, 0, 218105962, 0
    .long 2, 64, 72, 7168, 6400, 6400, 7340032, 0, 32768, 8, 54628352, 114688, 0, 0, 218103825, 0
    .long 2, 64, 72, 7168, 6656, 6656, 7340032, 0, 32768, 8, 54632448, 114688, 0, 0, 218103825, 0
    .long 1, 16, 16, 8192, 7680, 7936, 8388608, 2621440, 32768, 8, 14802944, 131072, 0, 0, 218105722, 0
    .long 1, 24, 24, 8192, 7168, 7424, 8388608, 3145728, 32768, 8, 33669120, 131072, 0, 0, 218105978, 0
    .long 2, 64, 72, 7168, 6656, 6656, 7340032, 3145728, 32768, 8, 65642496, 114688, 0, 0, 218104212, 0
    .long 1, 32, 32, 8192, 6656, 6912, 8388608, 3145728, 32768, 8, 50438144, 131072, 0, 0, 218105962, 0
    .long 1, 16, 16, 8192, 7680, 7936, 8388608, 3670016, 32768, 8, 18997248, 131072, 0, 0, 218106234, 0
    .long 2, 64, 72, 7168, 6912, 6912, 7340032, 0, 32768, 8, 54636544, 114688, 0, 0, 218103825, 0
    .long 2, 64, 72, 7168, 5888, 5888, 7340032, 0, 32768, 8, 54620160, 114688, 0, 0, 218103825, 0
    .long 5, 218108000, 0, 0, 24, 0, 0, 4, 0, 0, 0, 0, 218112384, 8, 218106897, 0
    .long 2, 64, 72, 7168, 6912, 6912, 7340032, 3145728, 32768, 8, 65646592, 114688, 0, 0, 218104212, 0
    .long 2, 64, 72, 7168, 5376, 5376, 7340032, 524288, 32768, 8, 56446976, 114688, 0, 0, 218103889, 0
    .long 2, 64, 72, 7168, 6656, 6656, 7340032, 1572864, 32768, 8, 60137472, 114688, 0, 0, 218104017, 0
    .long 2, 64, 72, 7168, 6912, 6912, 7340032, 524288, 32768, 8, 56471552, 114688, 0, 0, 218103889, 0
    .long 1, 16, 16, 8192, 6144, 6400, 8388608, 3670016, 32768, 8, 18972672, 131072, 0, 0, 218106218, 0
    .long 5, 218108272, 0, 0, 28, 0, 0, 8, 0, 0, 0, 0, 218112384, 12, 218106961, 0
    .long 2, 64, 72, 7168, 5376, 5376, 7340032, 3145728, 32768, 8, 65622016, 114688, 0, 0, 218104212, 0
    .long 2, 64, 72, 7168, 5888, 5888, 7340032, 1572864, 32768, 8, 60125184, 114688, 0, 0, 218104017, 0
    .long 2, 64, 72, 7168, 6144, 6144, 7340032, 2097152, 32768, 8, 61964288, 114688, 0, 0, 218104081, 0
    .long 2, 64, 72, 7168, 5376, 5376, 7340032, 1572864, 32768, 8, 60116992, 114688, 0, 0, 218104017, 0
    .long 2, 64, 72, 7168, 6144, 6144, 7340032, 1572864, 32768, 8, 60129280, 114688, 0, 0, 218104017, 0
    .long 2, 64, 72, 7168, 6912, 6912, 7340032, 1572864, 32768, 8, 60141568, 114688, 0, 0, 218104017, 0
    .long 2, 64, 72, 7168, 5632, 5632, 7340032, 1572864, 32768, 8, 60121088, 114688, 0, 0, 218104017, 0
    .long 2, 64, 72, 7168, 5632, 5632, 7340032, 2097152, 32768, 8, 61956096, 114688, 0, 0, 218104081, 0
    .long 2, 64, 72, 7168, 6656, 6656, 7340032, 2097152, 32768, 8, 61972480, 114688, 0, 0, 218104081, 0
    .long 2, 64, 72, 7168, 5888, 5888, 7340032, 524288, 32768, 8, 56455168, 114688, 0, 0, 218103889, 0
    .long 2, 64, 72, 7168, 6912, 6912, 7340032, 2097152, 32768, 8, 61976576, 114688, 0, 0, 218104081, 0
    .long 2, 64, 72, 7168, 6400, 6400, 7340032, 1572864, 32768, 8, 60133376, 114688, 0, 0, 218104017, 0
    .long 2, 64, 72, 7168, 5632, 5632, 7340032, 1048576, 32768, 8, 58286080, 114688, 0, 0, 218103953, 0
    .long 2, 64, 72, 7168, 6400, 6400, 7340032, 1048576, 32768, 8, 58298368, 114688, 0, 0, 218103953, 0
    .long 2, 64, 72, 7168, 5888, 5888, 7340032, 3145728, 32768, 8, 65630208, 114688, 0, 0, 218104212, 0
    .long 2, 64, 72, 7168, 6656, 6656, 7340032, 1048576, 32768, 8, 58302464, 114688, 0, 0, 218103953, 0
    .long 5, 218108272, 0, 0, 28, 0, 0, 12, 0, 0, 0, 0, 218112384, 16, 218106961, 0
    .long 2, 64, 72, 7168, 6912, 6912, 7340032, 1048576, 32768, 8, 58306560, 114688, 0, 0, 218103953, 0
    .long 2, 64, 72, 7168, 6400, 6400, 7340032, 3145728, 32768, 8, 65638400, 114688, 0, 0, 218104212, 0
    .long 2, 64, 72, 7168, 6656, 6656, 7340032, 524288, 32768, 8, 56467456, 114688, 0, 0, 218103889, 0
    .long 2, 64, 72, 7168, 6144, 6144, 7340032, 1048576, 32768, 8, 58294272, 114688, 0, 0, 218103953, 0
    .long 2, 64, 72, 7168, 5888, 5888, 7340032, 1048576, 32768, 8, 58290176, 114688, 0, 0, 218103953, 0
    .long 2, 64, 72, 7168, 5632, 5632, 7340032, 3145728, 32768, 8, 65626112, 114688, 0, 0, 218104212, 0
    .long 5, 218108256, 0, 0, 24, 0, 0, 12, 0, 0, 0, 0, 218112384, 16, 218106961, 0
    .long 2, 64, 72, 7168, 6144, 6144, 7340032, 3670016, 32768, 8, 67469312, 114688, 0, 0, 218104276, 0
    .long 2, 64, 72, 7168, 6400, 6400, 7340032, 524288, 32768, 8, 56463360, 114688, 0, 0, 218103889, 0
    .long 1, 80, 80, 2048, 3671552, 3671808, 7340032, 54583296, 114688, 14, 121659392, 32768, 218103824, 14, 218106370, 0
    .long 1, 40, 40, 2048, 4195328, 4195584, 8388608, 176226304, 131072, 16, 79708160, 32768, 218106896, 8, 218106376, 0
    .long 5, 218108256, 0, 0, 24, 0, 0, 8, 0, 0, 0, 0, 218112384, 12, 218106961, 0
    .long 1, 32, 32, 8192, 6144, 6400, 8388608, 3670016, 32768, 8, 52527104, 131072, 0, 0, 218106218, 0
    .long 1, 16, 16, 8192, 6656, 6912, 8388608, 3670016, 32768, 8, 18980864, 131072, 0, 0, 218106218, 0
    .long 1, 16, 16, 8192, 7168, 7424, 8388608, 3670016, 32768, 8, 18989056, 131072, 0, 0, 218106234, 0
    .long 1, 40, 40, 2048, 4195840, 4196096, 8388608, 182517760, 131072, 16, 81289216, 32768, 218112384, 33, 218106568, 0
    .long 1, 40, 40, 2048, 4195840, 4196096, 8388608, 176226304, 131072, 16, 79716352, 32768, 218106896, 8, 218106376, 0
    .long 2, 64, 72, 7168, 6144, 6144, 7340032, 3145728, 32768, 8, 65634304, 114688, 0, 0, 218104212, 0
    .long 1, 40, 40, 2048, 4195328, 4195584, 8388608, 180420608, 131072, 16, 80756736, 32768, 218112384, 25, 218106504, 0
    .long 1, 40, 40, 2048, 4195840, 4196096, 8388608, 180420608, 131072, 16, 80764928, 32768, 218112384, 25, 218106504, 0
    .long 2, 64, 72, 7168, 6656, 6656, 7340032, 2621440, 32768, 8, 63807488, 114688, 0, 0, 218104148, 0
    .long 1, 40, 40, 2048, 4195328, 4195584, 8388608, 182517760, 131072, 16, 81281024, 32768, 218112384, 33, 218106568, 0
    .long 2, 64, 72, 7168, 5376, 5376, 7340032, 2621440, 32768, 8, 63787008, 114688, 0, 0, 218104148, 0
    .long 1, 80, 80, 2048, 3671040, 3671296, 7340032, 54583296, 114688, 14, 121651200, 32768, 218103824, 14, 218106370, 0
    .long 2, 64, 72, 7168, 6912, 6912, 7340032, 2621440, 32768, 8, 63811584, 114688, 0, 0, 218104148, 0
    .long 2, 64, 72, 7168, 5632, 5632, 7340032, 2621440, 32768, 8, 63791104, 114688, 0, 0, 218104148, 0
    .long 2, 64, 72, 7168, 5888, 5888, 7340032, 3670016, 32768, 8, 67465216, 114688, 0, 0, 218104276, 0
    .long 2, 64, 72, 7168, 6656, 6656, 7340032, 3670016, 32768, 8, 67477504, 114688, 0, 0, 218104276, 0
    .long 1, 40, 40, 2048, 4195328, 4195584, 8388608, 178323456, 131072, 16, 80232448, 32768, 218106960, 8, 218106440, 0
    .long 1, 40, 40, 2048, 4195840, 4196096, 8388608, 178323456, 131072, 16, 80240640, 32768, 218106960, 8, 218106440, 0
    .long 2, 64, 72, 7168, 6144, 6144, 7340032, 2621440, 32768, 8, 63799296, 114688, 0, 0, 218104148, 0
    .long 2, 64, 72, 7168, 5376, 5376, 7340032, 3670016, 32768, 8, 67457024, 114688, 0, 0, 218104276, 0
    .long 2, 64, 72, 7168, 5888, 5888, 7340032, 2621440, 32768, 8, 63795200, 114688, 0, 0, 218104148, 0
    .long 1, 80, 80, 2048, 3671552, 3671808, 7340032, 61923328, 114688, 14, 123756544, 32768, 218104080, 14, 218106626, 0
    .long 1, 80, 80, 2048, 3671040, 3671296, 7340032, 60088320, 114688, 14, 123224064, 32768, 218104016, 14, 218106562, 0
    .long 1, 80, 80, 2048, 3671040, 3671296, 7340032, 61923328, 114688, 14, 123748352, 32768, 218104080, 14, 218106626, 0
    .long 1, 80, 80, 2048, 3671552, 3671808, 7340032, 60088320, 114688, 14, 123232256, 32768, 218104016, 14, 218106562, 0
    .long 2, 64, 72, 7168, 6400, 6400, 7340032, 3670016, 32768, 8, 67473408, 114688, 0, 0, 218104276, 0
    .long 2, 64, 72, 7168, 5632, 5632, 7340032, 3670016, 32768, 8, 67461120, 114688, 0, 0, 218104276, 0
    .long 1, 80, 80, 2048, 3671040, 3671296, 7340032, 58253312, 114688, 14, 122699776, 32768, 218103952, 14, 218106498, 0
    .long 1, 80, 80, 2048, 3671552, 3671808, 7340032, 58253312, 114688, 14, 122707968, 32768, 218103952, 14, 218106498, 0
    .long 2, 64, 72, 7168, 6912, 6912, 7340032, 3670016, 32768, 8, 67481600, 114688, 0, 0, 218104276, 0
    .long 1, 80, 80, 2048, 3671552, 3671808, 7340032, 56418304, 114688, 14, 122183680, 32768, 218103888, 14, 218106434, 0
    .long 1, 80, 80, 2048, 3671040, 3671296, 7340032, 56418304, 114688, 14, 122175488, 32768, 218103888, 14, 218106434, 0
    .long 1, 40, 40, 2048, 6291968, 6292224, 8388608, 184647680, 131072, 8, 90185728, 32768, 218112384, 41, 218106628, 0
    .long 1, 80, 80, 2048, 5505024, 5505280, 7340032, 65622016, 114688, 7, 133169152, 32768, 218104212, 7, 218106753, 0
    .long 1, 80, 80, 2048, 5505536, 5505792, 7340032, 65622016, 114688, 7, 133177344, 32768, 218104212, 7, 218106753, 0
    .long 1, 40, 40, 2048, 6291456, 6291712, 8388608, 184647680, 131072, 8, 90177536, 32768, 218112384, 41, 218106628, 0
    .long 1, 80, 80, 2048, 5506560, 5506816, 7340032, 65622016, 114688, 7, 133193728, 32768, 218104212, 7, 218106753, 0
    .long 1, 40, 40, 2048, 6292480, 6292736, 8388608, 184647680, 131072, 8, 90193920, 32768, 218112384, 41, 218106628, 0
    .long 1, 40, 40, 2048, 6292992, 6293248, 8388608, 184647680, 131072, 8, 90202112, 32768, 218112384, 41, 218106628, 0
    .long 1, 40, 40, 2048, 6291968, 6292224, 8388608, 186744832, 131072, 8, 90710016, 32768, 218112384, 49, 218106692, 0
    .long 1, 80, 80, 2048, 5506048, 5506304, 7340032, 65622016, 114688, 7, 133185536, 32768, 218104212, 7, 218106753, 0
    .long 1, 40, 40, 2048, 6292480, 6292736, 8388608, 186744832, 131072, 8, 90718208, 32768, 218112384, 49, 218106692, 0
    .long 1, 40, 40, 2048, 6291456, 6291712, 8388608, 186744832, 131072, 8, 90701824, 32768, 218112384, 49, 218106692, 0
    .long 1, 40, 40, 2048, 6292992, 6293248, 8388608, 186744832, 131072, 8, 90726400, 32768, 218112384, 49, 218106692, 0
    .long 1, 80, 80, 2048, 5506048, 5506304, 7340032, 63787008, 114688, 7, 132661248, 32768, 218104148, 7, 218106689, 0
    .long 1, 80, 80, 2048, 5506560, 5506816, 7340032, 63787008, 114688, 7, 132669440, 32768, 218104148, 7, 218106689, 0
    .long 1, 80, 80, 2048, 5505024, 5505280, 7340032, 63787008, 114688, 7, 132644864, 32768, 218104148, 7, 218106689, 0
    .long 1, 80, 80, 2048, 5505536, 5505792, 7340032, 63787008, 114688, 7, 132653056, 32768, 218104148, 7, 218106689, 0
    .long 1, 80, 80, 2048, 5505536, 5505792, 7340032, 67457024, 114688, 7, 133701632, 32768, 218104276, 7, 218106817, 0
    .long 1, 80, 80, 2048, 5506048, 5506304, 7340032, 67457024, 114688, 7, 133709824, 32768, 218104276, 7, 218106817, 0
    .long 1, 80, 80, 2048, 5506560, 5506816, 7340032, 67457024, 114688, 7, 133718016, 32768, 218104276, 7, 218106817, 0
    .long 1, 80, 80, 2048, 5505024, 5505280, 7340032, 67457024, 114688, 7, 133693440, 32768, 218104276, 7, 218106817, 0
    .long 6, 1, 3, 2, 3, 16, 0, 3, 0, 0, 0, 0, 0, 0, 0, 0
    .long 6, 0, 51, 0, 3, 0, 0, 51, 0, 0, 0, 0, 0, 0, 0, 0
    .long 6, 1, 1, 2, 3, 16, 0, 1, 0, 0, 0, 0, 0, 0, 0, 0
    .long 6, 1, 0, 2, 3, 16, 0, 0, 0, 0, 0, 0, 0, 0, 0, 0
    .long 6, 1, 5, 2, 3, 16, 0, 5, 0, 0, 0, 0, 0, 0, 0, 0
    .long 6, 1, 4, 2, 3, 16, 0, 4, 0, 0, 0, 0, 0, 0, 0, 0
    .long 6, 1, 22, 2, 3, 16, 0, 22, 0, 0, 0, 0, 0, 0, 0, 0
    .long 6, 1, 6, 2, 3, 16, 0, 6, 0, 0, 0, 0, 0, 0, 0, 0
    .long 6, 1, 18, 2, 3, 16, 0, 18, 0, 0, 0, 0, 0, 0, 0, 0
    .long 6, 1, 19, 2, 3, 16, 0, 19, 0, 0, 0, 0, 0, 0, 0, 0
    .long 6, 1, 20, 2, 3, 16, 0, 20, 0, 0, 0, 0, 0, 0, 0, 0
    .long 6, 1, 7, 2, 3, 16, 0, 7, 0, 0, 0, 0, 0, 0, 0, 0
    .long 6, 1, 2, 2, 3, 16, 0, 2, 0, 0, 0, 0, 0, 0, 0, 0
    .long 6, 1, 17, 2, 3, 16, 0, 17, 0, 0, 0, 0, 0, 0, 0, 0
    .long 6, 1, 21, 2, 3, 16, 0, 21, 0, 0, 0, 0, 0, 0, 0, 0
    .long 6, 1, 16, 2, 3, 16, 0, 16, 0, 0, 0, 0, 0, 0, 0, 0
    .long 6, 0, 50, 0, 3, 0, 0, 50, 0, 0, 0, 0, 0, 0, 0, 0
    .long 6, 0, 52, 0, 3, 0, 0, 52, 0, 0, 0, 0, 0, 0, 0, 0
    .long 6, 0, 54, 0, 3, 0, 0, 54, 0, 0, 0, 0, 0, 0, 0, 0
    .long 6, 0, 49, 0, 3, 0, 0, 49, 0, 0, 0, 0, 0, 0, 0, 0
    .long 6, 0, 48, 0, 3, 0, 0, 48, 0, 0, 0, 0, 0, 0, 0, 0
    .long 6, 0, 53, 0, 3, 0, 0, 53, 0, 0, 0, 0, 0, 0, 0, 0
    .long 6, 0, 55, 0, 3, 0, 0, 55, 0, 0, 0, 0, 0, 0, 0, 0
    .long 6, 0, 56, 0, 3, 0, 0, 56, 0, 0, 0, 0, 0, 0, 0, 0
    .long 6, 1, 23, 2, 3, 16, 0, 23, 0, 0, 0, 0, 0, 0, 0, 0
    .long 6, 1, 24, 2, 3, 16, 0, 24, 0, 0, 0, 0, 0, 0, 0, 0
    .long 6, 1, 25, 2, 3, 16, 0, 25, 0, 0, 0, 0, 0, 0, 0, 0
    .long 6, 1, 26, 2, 3, 16, 0, 26, 0, 0, 0, 0, 0, 0, 0, 0
    .long 6, 1, 27, 2, 3, 16, 0, 27, 0, 0, 0, 0, 0, 0, 0, 0
    .long 6, 1, 28, 2, 3, 16, 0, 28, 0, 0, 0, 0, 0, 0, 0, 0
    .long 6, 1, 29, 2, 3, 16, 0, 29, 0, 0, 0, 0, 0, 0, 0, 0
    .long 6, 1, 30, 2, 3, 16, 0, 30, 0, 0, 0, 0, 0, 0, 0, 0
    .long 6, 1, 31, 2, 3, 16, 0, 31, 0, 0, 0, 0, 0, 0, 0, 0
    .long 6, 0, 40, 1, 3, 16, 0, 40, 0, 0, 0, 0, 0, 0, 0, 0
    .long 6, 0, 41, 1, 3, 16, 0, 41, 0, 0, 0, 0, 0, 0, 0, 0
    .long 6, 0, 43, 1, 3, 16, 0, 43, 0, 0, 0, 0, 0, 0, 0, 0
    .long 6, 0, 45, 1, 3, 16, 0, 45, 0, 0, 0, 0, 0, 0, 0, 0
    .long 6, 0, 46, 1, 3, 16, 0, 46, 0, 0, 0, 0, 0, 0, 0, 0
    .long 6, 0, 47, 1, 3, 16, 0, 47, 0, 0, 0, 0, 0, 0, 0, 0
    .long 6, 1, 32, 1, 3, 16, 0, 32, 0, 0, 0, 0, 0, 0, 0, 0
    .long 6, 1, 33, 1, 3, 16, 0, 33, 0, 0, 0, 0, 0, 0, 0, 0
    .long 6, 1, 35, 1, 3, 16, 0, 35, 0, 0, 0, 0, 0, 0, 0, 0
    .long 6, 1, 36, 1, 3, 16, 0, 36, 0, 0, 0, 0, 0, 0, 0, 0
    .long 6, 1, 38, 1, 3, 16, 0, 38, 0, 0, 0, 0, 0, 0, 0, 0
    .long 6, 1, 39, 1, 3, 16, 0, 39, 0, 0, 0, 0, 0, 0, 0, 0
    .long 6, 0, 57, 0, 3, 0, 0, 57, 0, 0, 0, 0, 0, 0, 0, 0
    .long 6, 0, 44, 1, 3, 16, 0, 44, 0, 0, 0, 0, 0, 0, 0, 0
    .long 6, 1, 34, 1, 3, 16, 0, 34, 0, 0, 0, 0, 0, 0, 0, 0
    .long 6, 0, 58, 0, 3, 0, 0, 58, 0, 0, 0, 0, 0, 0, 0, 0
    .long 6, 1, 37, 1, 3, 16, 0, 37, 0, 0, 0, 0, 0, 0, 0, 0
    .long 6, 0, 42, 1, 3, 16, 0, 42, 0, 0, 0, 0, 0, 0, 0, 0
    .long 6, 0, 59, 0, 3, 0, 0, 59, 0, 0, 0, 0, 0, 0, 0, 0
    .long 6, 1, 8, 2, 3, 16, 0, 8, 0, 0, 0, 0, 0, 0, 0, 0
    .long 6, 1, 9, 2, 3, 16, 0, 9, 0, 0, 0, 0, 0, 0, 0, 0
    .long 6, 1, 10, 2, 3, 16, 0, 10, 0, 0, 0, 0, 0, 0, 0, 0
    .long 6, 1, 11, 2, 3, 16, 0, 11, 0, 0, 0, 0, 0, 0, 0, 0
    .long 6, 1, 12, 2, 3, 16, 0, 12, 0, 0, 0, 0, 0, 0, 0, 0
    .long 6, 1, 13, 2, 3, 16, 0, 13, 0, 0, 0, 0, 0, 0, 0, 0
    .long 6, 1, 14, 2, 3, 16, 0, 14, 0, 0, 0, 0, 0, 0, 0, 0
    .long 6, 1, 15, 2, 3, 16, 0, 15, 0, 0, 0, 0, 0, 0, 0, 0
    .long 7, 0, 60, 0, 12, 0, 0, 60, 0, 0, 0, 0, 0, 0, 0, 0
    .long 7, 0, 60, 0, 13, 0, 0, 60, 0, 0, 0, 0, 0, 0, 0, 0
    .long 7, 0, 60, 0, 14, 0, 0, 60, 0, 0, 0, 0, 0, 0, 0, 0
    .long 7, 0, 60, 0, 15, 0, 0, 60, 0, 0, 0, 0, 0, 0, 0, 0
    .long 7, 0, 61, 0, 12, 0, 0, 61, 0, 0, 0, 0, 0, 0, 0, 0
    .long 7, 0, 61, 0, 13, 0, 0, 61, 0, 0, 0, 0, 0, 0, 0, 0
    .long 7, 0, 61, 0, 14, 0, 0, 61, 0, 0, 0, 0, 0, 0, 0, 0
    .long 7, 0, 61, 0, 15, 0, 0, 61, 0, 0, 0, 0, 0, 0, 0, 0
    .long 7, 0, 62, 0, 12, 0, 0, 62, 0, 0, 0, 0, 0, 0, 0, 0
    .long 7, 0, 62, 0, 13, 0, 0, 62, 0, 0, 0, 0, 0, 0, 0, 0
    .long 7, 0, 62, 0, 14, 0, 0, 62, 0, 0, 0, 0, 0, 0, 0, 0
    .long 7, 0, 62, 0, 15, 0, 0, 62, 0, 0, 0, 0, 0, 0, 0, 0
    .long 7, 0, 63, 0, 12, 0, 0, 63, 0, 0, 0, 0, 0, 0, 0, 0
    .long 7, 0, 63, 0, 13, 0, 0, 63, 0, 0, 0, 0, 0, 0, 0, 0
    .long 7, 0, 63, 0, 14, 0, 0, 63, 0, 0, 0, 0, 0, 0, 0, 0
    .long 7, 0, 63, 0, 15, 0, 0, 63, 0, 0, 0, 0, 0, 0, 0, 0
    .long 0, 0, 0, 0, 0, 0, 0, 0, 0, 0, 0, 0, 0, 0, 0, 0
.p2align 6
.amdhsa_kernel recurrent_scan__memory_aug_recurrent_mem_tr__glu_gated_glu__prompt_kernel
  .amdhsa_next_free_vgpr 256
  .amdhsa_next_free_sgpr 102
  .amdhsa_accum_offset 256
  .amdhsa_group_segment_fixed_size 0
  .amdhsa_kernarg_size 112
  .amdhsa_user_sgpr_count 2
  .amdhsa_user_sgpr_kernarg_segment_ptr 1
  .amdhsa_system_sgpr_workgroup_id_x 1
  .amdhsa_float_denorm_mode_32 3
.end_amdhsa_kernel
```

```asm
; @launch grid=(256,1,1) block=(512,1,1) lds=163840
.amdgcn_target "amdgcn-amd-amdhsa--gfx950"
.text
.globl recurrent_scan__memory_aug_recurrent_mem_tr__glu_gated_glu__prompt_kernel
.p2align 8
.type recurrent_scan__memory_aug_recurrent_mem_tr__glu_gated_glu__prompt_kernel,@function
recurrent_scan__memory_aug_recurrent_mem_tr__glu_gated_glu__prompt_kernel:
    s_cmp_ge_u32 s2, 256
    s_cbranch_scc1 k_exit
    s_mov_b32 s99, s2
    s_load_dwordx2 s[4:5], s[0:1], 104
    s_load_dwordx2 s[64:65], s[0:1], 96
    v_lshrrev_b32 v2, 6, v0
    s_mov_b32 s6, 268435456
    s_mov_b32 s7, 131072
    s_mov_b32 s66, 256
    s_mov_b32 s67, 131072
    v_readfirstlane_b32 s3, v2
    s_getreg_b32 s14, hwreg(HW_REG_XCC_ID)
    s_waitcnt lgkmcnt(0)
    s_mov_b32 s98, s2
    s_sub_u32 s97, s14, s2
    s_and_b32 s97, s97, 7
    s_or_b32 s15, s2, s3
    s_cmp_lg_u32 s15, 0
    s_cbranch_scc1 k_disp
    s_add_u32 s14, s97, 1
    v_mov_b32 v2, s14
    s_mov_b64 exec, 1
    buffer_store_dword v2, off, s[64:67], 0 offset:224 sc1
    s_mov_b64 exec, -1
    s_branch k_disp
k_restart:
    s_waitcnt vmcnt(0) lgkmcnt(0)
    s_barrier
k_disp:
    s_add_u32 s14, s97, s98
    s_and_b32 s14, s14, 7
    s_andn2_b32 s2, s98, 7
    s_or_b32 s2, s2, s14
    s_mov_b32 s99, s2
    s_lshr_b32 s13, s2, 3
    s_and_b32 s12, s2, 3
    s_waitcnt lgkmcnt(0)
    s_bitcmp0_b32 s2, 2
    s_cbranch_scc1 chain_map
    s_lshl_b32 s63, s13, 2
    s_add_u32 s63, s63, s12
    s_mov_b32 s17, s63
    s_mov_b32 s19, s3
    s_mov_b32 s18, 0
    s_cmp_ge_u32 s3, 4
    s_cbranch_scc1 ln_touch
    s_load_dwordx2 s[8:9], s[0:1], 0
    v_and_b32 v1, 63, v0
    s_mov_b32 s10, 4194304
    s_mov_b32 s11, 131072
    v_and_b32 v3, 15, v1
    v_lshrrev_b32 v4, 4, v1
    v_lshlrev_b32 v5, 11, v3
    v_lshl_add_u32 v5, v4, 4, v5
    s_lshl_b32 s12, s17, 15
    s_lshl_b32 s13, s19, 9
    s_add_u32 s12, s12, s13
    s_waitcnt lgkmcnt(0)
    buffer_load_dwordx4 v[16:19], v5, s[8:11], s12 offen offset:0
    buffer_load_dwordx4 v[20:23], v5, s[8:11], s12 offen offset:64
    buffer_load_dwordx4 v[24:27], v5, s[8:11], s12 offen offset:128
    buffer_load_dwordx4 v[28:31], v5, s[8:11], s12 offen offset:192
    buffer_load_dwordx4 v[32:35], v5, s[8:11], s12 offen offset:256
    buffer_load_dwordx4 v[36:39], v5, s[8:11], s12 offen offset:320
    buffer_load_dwordx4 v[40:43], v5, s[8:11], s12 offen offset:384
    buffer_load_dwordx4 v[44:47], v5, s[8:11], s12 offen offset:448
    v_mov_b32 v14, 0
    s_lshl_b32 s13, s63, 7
    s_add_u32 s13, s13, 218103808
    v_lshlrev_b32 v13, 2, v0
    v_lshlrev_b32 v6, 4, v3
    s_lshl_b32 s14, s18, 10
    v_add_u32 v6, s14, v6
    s_lshl_b32 s14, s19, 2
    v_add_u32 v7, s14, v6
    v_lshlrev_b32 v8, 4, v1
    s_lshl_b32 s15, s17, 15
    s_lshl_b32 s16, s19, 13
    s_add_u32 s15, s15, s16
    s_add_u32 s15, s15, 0
    s_add_u32 s16, s15, 4096
    v_and_b32 v9, 1, v4
    v_cmp_eq_u32 s[20:21], 1, v9
    s_waitcnt vmcnt(0)
    v_lshlrev_b32 v48, 16, v16
    v_and_b32 v49, 0xffff0000, v16
    v_lshlrev_b32 v50, 16, v17
    v_and_b32 v51, 0xffff0000, v17
    v_lshlrev_b32 v52, 16, v18
    v_and_b32 v53, 0xffff0000, v18
    v_lshlrev_b32 v54, 16, v19
    v_and_b32 v55, 0xffff0000, v19
    v_lshlrev_b32 v56, 16, v20
    v_and_b32 v57, 0xffff0000, v20
    v_lshlrev_b32 v58, 16, v21
    v_and_b32 v59, 0xffff0000, v21
    v_lshlrev_b32 v60, 16, v22
    v_and_b32 v61, 0xffff0000, v22
    v_lshlrev_b32 v62, 16, v23
    v_and_b32 v63, 0xffff0000, v23
    v_lshlrev_b32 v64, 16, v24
    v_and_b32 v65, 0xffff0000, v24
    v_lshlrev_b32 v66, 16, v25
    v_and_b32 v67, 0xffff0000, v25
    v_lshlrev_b32 v68, 16, v26
    v_and_b32 v69, 0xffff0000, v26
    v_lshlrev_b32 v70, 16, v27
    v_and_b32 v71, 0xffff0000, v27
    v_lshlrev_b32 v72, 16, v28
    v_and_b32 v73, 0xffff0000, v28
    v_lshlrev_b32 v74, 16, v29
    v_and_b32 v75, 0xffff0000, v29
    v_lshlrev_b32 v76, 16, v30
    v_and_b32 v77, 0xffff0000, v30
    v_lshlrev_b32 v78, 16, v31
    v_and_b32 v79, 0xffff0000, v31
    v_lshlrev_b32 v80, 16, v32
    v_and_b32 v81, 0xffff0000, v32
    v_lshlrev_b32 v82, 16, v33
    v_and_b32 v83, 0xffff0000, v33
    v_lshlrev_b32 v84, 16, v34
    v_and_b32 v85, 0xffff0000, v34
    v_lshlrev_b32 v86, 16, v35
    v_and_b32 v87, 0xffff0000, v35
    v_lshlrev_b32 v88, 16, v36
    v_and_b32 v89, 0xffff0000, v36
    v_lshlrev_b32 v90, 16, v37
    v_and_b32 v91, 0xffff0000, v37
    v_lshlrev_b32 v92, 16, v38
    v_and_b32 v93, 0xffff0000, v38
    v_lshlrev_b32 v94, 16, v39
    v_and_b32 v95, 0xffff0000, v39
    v_lshlrev_b32 v96, 16, v40
    v_and_b32 v97, 0xffff0000, v40
    v_lshlrev_b32 v98, 16, v41
    v_and_b32 v99, 0xffff0000, v41
    v_lshlrev_b32 v100, 16, v42
    v_and_b32 v101, 0xffff0000, v42
    v_lshlrev_b32 v102, 16, v43
    v_and_b32 v103, 0xffff0000, v43
    v_lshlrev_b32 v104, 16, v44
    v_and_b32 v105, 0xffff0000, v44
    v_lshlrev_b32 v106, 16, v45
    v_and_b32 v107, 0xffff0000, v45
    v_lshlrev_b32 v108, 16, v46
    v_and_b32 v109, 0xffff0000, v46
    v_lshlrev_b32 v110, 16, v47
    v_and_b32 v111, 0xffff0000, v47
    v_add_f32 v112, v48, v80
    v_add_f32 v113, v49, v81
    v_add_f32 v114, v50, v82
    v_add_f32 v115, v51, v83
    v_add_f32 v116, v52, v84
    v_add_f32 v117, v53, v85
    v_add_f32 v118, v54, v86
    v_add_f32 v119, v55, v87
    v_add_f32 v120, v56, v88
    v_add_f32 v121, v57, v89
    v_add_f32 v122, v58, v90
    v_add_f32 v123, v59, v91
    v_add_f32 v124, v60, v92
    v_add_f32 v125, v61, v93
    v_add_f32 v126, v62, v94
    v_add_f32 v127, v63, v95
    v_add_f32 v128, v64, v96
    v_add_f32 v129, v65, v97
    v_add_f32 v130, v66, v98
    v_add_f32 v131, v67, v99
    v_add_f32 v132, v68, v100
    v_add_f32 v133, v69, v101
    v_add_f32 v134, v70, v102
    v_add_f32 v135, v71, v103
    v_add_f32 v136, v72, v104
    v_add_f32 v137, v73, v105
    v_add_f32 v138, v74, v106
    v_add_f32 v139, v75, v107
    v_add_f32 v140, v76, v108
    v_add_f32 v141, v77, v109
    v_add_f32 v142, v78, v110
    v_add_f32 v143, v79, v111
    v_add_f32 v112, v112, v128
    v_add_f32 v113, v113, v129
    v_add_f32 v114, v114, v130
    v_add_f32 v115, v115, v131
    v_add_f32 v116, v116, v132
    v_add_f32 v117, v117, v133
    v_add_f32 v118, v118, v134
    v_add_f32 v119, v119, v135
    v_add_f32 v120, v120, v136
    v_add_f32 v121, v121, v137
    v_add_f32 v122, v122, v138
    v_add_f32 v123, v123, v139
    v_add_f32 v124, v124, v140
    v_add_f32 v125, v125, v141
    v_add_f32 v126, v126, v142
    v_add_f32 v127, v127, v143
    v_add_f32 v112, v112, v120
    v_add_f32 v113, v113, v121
    v_add_f32 v114, v114, v122
    v_add_f32 v115, v115, v123
    v_add_f32 v116, v116, v124
    v_add_f32 v117, v117, v125
    v_add_f32 v118, v118, v126
    v_add_f32 v119, v119, v127
    v_add_f32 v112, v112, v116
    v_add_f32 v113, v113, v117
    v_add_f32 v114, v114, v118
    v_add_f32 v115, v115, v119
    v_add_f32 v112, v112, v114
    v_add_f32 v113, v113, v115
    v_add_f32 v112, v112, v113
    v_mov_b32 v113, v112
    s_nop 1
    v_permlane16_swap_b32 v113, v112
    v_add_f32 v112, v112, v113
    v_mov_b32 v113, v112
    s_nop 1
    v_permlane32_swap_b32 v113, v112
    v_add_f32 v112, v112, v113
    ds_write_b32 v7, v112
    s_waitcnt lgkmcnt(0)
    s_barrier
    ds_read_b128 v[112:115], v6
    s_waitcnt lgkmcnt(0)
    v_add_f32 v112, v112, v114
    v_add_f32 v113, v113, v115
    v_add_f32 v112, v112, v113
    v_mul_f32 v10, 0x3a800000, v112
    v_sub_f32 v176, v48, v10
    v_sub_f32 v177, v49, v10
    v_sub_f32 v178, v50, v10
    v_sub_f32 v179, v51, v10
    v_sub_f32 v180, v52, v10
    v_sub_f32 v181, v53, v10
    v_sub_f32 v182, v54, v10
    v_sub_f32 v183, v55, v10
    v_sub_f32 v184, v56, v10
    v_sub_f32 v185, v57, v10
    v_sub_f32 v186, v58, v10
    v_sub_f32 v187, v59, v10
    v_sub_f32 v188, v60, v10
    v_sub_f32 v189, v61, v10
    v_sub_f32 v190, v62, v10
    v_sub_f32 v191, v63, v10
    v_sub_f32 v192, v64, v10
    v_sub_f32 v193, v65, v10
    v_sub_f32 v194, v66, v10
    v_sub_f32 v195, v67, v10
    v_sub_f32 v196, v68, v10
    v_sub_f32 v197, v69, v10
    v_sub_f32 v198, v70, v10
    v_sub_f32 v199, v71, v10
    v_sub_f32 v200, v72, v10
    v_sub_f32 v201, v73, v10
    v_sub_f32 v202, v74, v10
    v_sub_f32 v203, v75, v10
    v_sub_f32 v204, v76, v10
    v_sub_f32 v205, v77, v10
    v_sub_f32 v206, v78, v10
    v_sub_f32 v207, v79, v10
    v_sub_f32 v208, v80, v10
    v_sub_f32 v209, v81, v10
    v_sub_f32 v210, v82, v10
    v_sub_f32 v211, v83, v10
    v_sub_f32 v212, v84, v10
    v_sub_f32 v213, v85, v10
    v_sub_f32 v214, v86, v10
    v_sub_f32 v215, v87, v10
    v_sub_f32 v216, v88, v10
    v_sub_f32 v217, v89, v10
    v_sub_f32 v218, v90, v10
    v_sub_f32 v219, v91, v10
    v_sub_f32 v220, v92, v10
    v_sub_f32 v221, v93, v10
    v_sub_f32 v222, v94, v10
    v_sub_f32 v223, v95, v10
    v_sub_f32 v224, v96, v10
    v_sub_f32 v225, v97, v10
    v_sub_f32 v226, v98, v10
    v_sub_f32 v227, v99, v10
    v_sub_f32 v228, v100, v10
    v_sub_f32 v229, v101, v10
    v_sub_f32 v230, v102, v10
    v_sub_f32 v231, v103, v10
    v_sub_f32 v232, v104, v10
    v_sub_f32 v233, v105, v10
    v_sub_f32 v234, v106, v10
    v_sub_f32 v235, v107, v10
    v_sub_f32 v236, v108, v10
    v_sub_f32 v237, v109, v10
    v_sub_f32 v238, v110, v10
    v_sub_f32 v239, v111, v10
    v_mul_f32 v112, v176, v176
    v_fmac_f32 v112, v208, v208
    v_mul_f32 v113, v177, v177
    v_fmac_f32 v113, v209, v209
    v_mul_f32 v114, v178, v178
    v_fmac_f32 v114, v210, v210
    v_mul_f32 v115, v179, v179
    v_fmac_f32 v115, v211, v211
    v_mul_f32 v116, v180, v180
    v_fmac_f32 v116, v212, v212
    v_mul_f32 v117, v181, v181
    v_fmac_f32 v117, v213, v213
    v_mul_f32 v118, v182, v182
    v_fmac_f32 v118, v214, v214
    v_mul_f32 v119, v183, v183
    v_fmac_f32 v119, v215, v215
    v_mul_f32 v120, v184, v184
    v_fmac_f32 v120, v216, v216
    v_mul_f32 v121, v185, v185
    v_fmac_f32 v121, v217, v217
    v_mul_f32 v122, v186, v186
    v_fmac_f32 v122, v218, v218
    v_mul_f32 v123, v187, v187
    v_fmac_f32 v123, v219, v219
    v_mul_f32 v124, v188, v188
    v_fmac_f32 v124, v220, v220
    v_mul_f32 v125, v189, v189
    v_fmac_f32 v125, v221, v221
    v_mul_f32 v126, v190, v190
    v_fmac_f32 v126, v222, v222
    v_mul_f32 v127, v191, v191
    v_fmac_f32 v127, v223, v223
    v_mul_f32 v128, v192, v192
    v_fmac_f32 v128, v224, v224
    v_mul_f32 v129, v193, v193
    v_fmac_f32 v129, v225, v225
    v_mul_f32 v130, v194, v194
    v_fmac_f32 v130, v226, v226
    v_mul_f32 v131, v195, v195
    v_fmac_f32 v131, v227, v227
    v_mul_f32 v132, v196, v196
    v_fmac_f32 v132, v228, v228
    v_mul_f32 v133, v197, v197
    v_fmac_f32 v133, v229, v229
    v_mul_f32 v134, v198, v198
    v_fmac_f32 v134, v230, v230
    v_mul_f32 v135, v199, v199
    v_fmac_f32 v135, v231, v231
    v_mul_f32 v136, v200, v200
    v_fmac_f32 v136, v232, v232
    v_mul_f32 v137, v201, v201
    v_fmac_f32 v137, v233, v233
    v_mul_f32 v138, v202, v202
    v_fmac_f32 v138, v234, v234
    v_mul_f32 v139, v203, v203
    v_fmac_f32 v139, v235, v235
    v_mul_f32 v140, v204, v204
    v_fmac_f32 v140, v236, v236
    v_mul_f32 v141, v205, v205
    v_fmac_f32 v141, v237, v237
    v_mul_f32 v142, v206, v206
    v_fmac_f32 v142, v238, v238
    v_mul_f32 v143, v207, v207
    v_fmac_f32 v143, v239, v239
    v_add_f32 v112, v112, v128
    v_add_f32 v113, v113, v129
    v_add_f32 v114, v114, v130
    v_add_f32 v115, v115, v131
    v_add_f32 v116, v116, v132
    v_add_f32 v117, v117, v133
    v_add_f32 v118, v118, v134
    v_add_f32 v119, v119, v135
    v_add_f32 v120, v120, v136
    v_add_f32 v121, v121, v137
    v_add_f32 v122, v122, v138
    v_add_f32 v123, v123, v139
    v_add_f32 v124, v124, v140
    v_add_f32 v125, v125, v141
    v_add_f32 v126, v126, v142
    v_add_f32 v127, v127, v143
    v_add_f32 v112, v112, v120
    v_add_f32 v113, v113, v121
    v_add_f32 v114, v114, v122
    v_add_f32 v115, v115, v123
    v_add_f32 v116, v116, v124
    v_add_f32 v117, v117, v125
    v_add_f32 v118, v118, v126
    v_add_f32 v119, v119, v127
    v_add_f32 v112, v112, v116
    v_add_f32 v113, v113, v117
    v_add_f32 v114, v114, v118
    v_add_f32 v115, v115, v119
    v_add_f32 v112, v112, v114
    v_add_f32 v113, v113, v115
    v_add_f32 v112, v112, v113
    v_mov_b32 v113, v112
    s_nop 1
    v_permlane16_swap_b32 v113, v112
    v_add_f32 v112, v112, v113
    v_mov_b32 v113, v112
    s_nop 1
    v_permlane32_swap_b32 v113, v112
    v_add_f32 v112, v112, v113
    ds_write_b32 v7, v112 offset:512
    s_waitcnt lgkmcnt(0)
    s_barrier
    ds_read_b128 v[112:115], v6 offset:512
    v_mov_b32 v12, 2048
    ds_read_b32 v12, v12
    s_mov_b32 s96, s97
    s_waitcnt lgkmcnt(0)
    v_readfirstlane_b32 s97, v12
    s_cmp_lg_u32 s96, s97
    s_cbranch_scc1 k_restart
    s_waitcnt lgkmcnt(0)
    v_cmp_gt_u32 vcc, 32, v0
    s_and_saveexec_b64 s[22:23], vcc
    s_cbranch_execz ln_nz
    buffer_store_dword v14, v13, s[4:7], s13 offen sc1
ln_nz:
    s_mov_b64 exec, -1
    v_add_f32 v112, v112, v114
    v_add_f32 v113, v113, v115
    v_add_f32 v112, v112, v113
    v_mul_f32 v11, 0x3a800000, v112
    v_cvt_pk_bf16_f32 v10, v10, v10
    v_lshlrev_b32 v10, 16, v10
    v_cvt_pk_bf16_f32 v11, v11, v11
    v_lshlrev_b32 v11, 16, v11
    v_add_f32 v11, 0x3727c5ac, v11
    v_cvt_pk_bf16_f32 v11, v11, v11
    v_lshlrev_b32 v11, 16, v11
    v_sqrt_f32 v11, v11
    s_nop 0
    v_cvt_pk_bf16_f32 v11, v11, v11
    v_lshlrev_b32 v11, 16, v11
    v_rcp_f32 v11, v11
    s_nop 0
    v_sub_f32 v48, v48, v10
    v_sub_f32 v49, v49, v10
    v_cvt_pk_bf16_f32 v16, v48, v49
    v_lshlrev_b32 v48, 16, v16
    v_and_b32 v49, 0xffff0000, v16
    v_mul_f32 v48, v48, v11
    v_mul_f32 v49, v49, v11
    v_cvt_pk_bf16_f32 v16, v48, v49
    v_sub_f32 v50, v50, v10
    v_sub_f32 v51, v51, v10
    v_cvt_pk_bf16_f32 v17, v50, v51
    v_lshlrev_b32 v50, 16, v17
    v_and_b32 v51, 0xffff0000, v17
    v_mul_f32 v50, v50, v11
    v_mul_f32 v51, v51, v11
    v_cvt_pk_bf16_f32 v17, v50, v51
    v_sub_f32 v52, v52, v10
    v_sub_f32 v53, v53, v10
    v_cvt_pk_bf16_f32 v18, v52, v53
    v_lshlrev_b32 v52, 16, v18
    v_and_b32 v53, 0xffff0000, v18
    v_mul_f32 v52, v52, v11
    v_mul_f32 v53, v53, v11
    v_cvt_pk_bf16_f32 v18, v52, v53
    v_sub_f32 v54, v54, v10
    v_sub_f32 v55, v55, v10
    v_cvt_pk_bf16_f32 v19, v54, v55
    v_lshlrev_b32 v54, 16, v19
    v_and_b32 v55, 0xffff0000, v19
    v_mul_f32 v54, v54, v11
    v_mul_f32 v55, v55, v11
    v_cvt_pk_bf16_f32 v19, v54, v55
    v_cndmask_b32 v112, v16, v18, s[20:21]
    v_cndmask_b32 v113, v17, v19, s[20:21]
    v_cndmask_b32 v114, v18, v16, s[20:21]
    v_cndmask_b32 v115, v19, v17, s[20:21]
    buffer_store_dwordx4 v[112:115], v8, s[4:7], s15 offen offset:0 sc1
    v_sub_f32 v56, v56, v10
    v_sub_f32 v57, v57, v10
    v_cvt_pk_bf16_f32 v20, v56, v57
    v_lshlrev_b32 v56, 16, v20
    v_and_b32 v57, 0xffff0000, v20
    v_mul_f32 v56, v56, v11
    v_mul_f32 v57, v57, v11
    v_cvt_pk_bf16_f32 v20, v56, v57
    v_sub_f32 v58, v58, v10
    v_sub_f32 v59, v59, v10
    v_cvt_pk_bf16_f32 v21, v58, v59
    v_lshlrev_b32 v58, 16, v21
    v_and_b32 v59, 0xffff0000, v21
    v_mul_f32 v58, v58, v11
    v_mul_f32 v59, v59, v11
    v_cvt_pk_bf16_f32 v21, v58, v59
    v_sub_f32 v60, v60, v10
    v_sub_f32 v61, v61, v10
    v_cvt_pk_bf16_f32 v22, v60, v61
    v_lshlrev_b32 v60, 16, v22
    v_and_b32 v61, 0xffff0000, v22
    v_mul_f32 v60, v60, v11
    v_mul_f32 v61, v61, v11
    v_cvt_pk_bf16_f32 v22, v60, v61
    v_sub_f32 v62, v62, v10
    v_sub_f32 v63, v63, v10
    v_cvt_pk_bf16_f32 v23, v62, v63
    v_lshlrev_b32 v62, 16, v23
    v_and_b32 v63, 0xffff0000, v23
    v_mul_f32 v62, v62, v11
    v_mul_f32 v63, v63, v11
    v_cvt_pk_bf16_f32 v23, v62, v63
    v_cndmask_b32 v116, v20, v22, s[20:21]
    v_cndmask_b32 v117, v21, v23, s[20:21]
    v_cndmask_b32 v118, v22, v20, s[20:21]
    v_cndmask_b32 v119, v23, v21, s[20:21]
    buffer_store_dwordx4 v[116:119], v8, s[4:7], s15 offen offset:1024 sc1
    v_sub_f32 v64, v64, v10
    v_sub_f32 v65, v65, v10
    v_cvt_pk_bf16_f32 v24, v64, v65
    v_lshlrev_b32 v64, 16, v24
    v_and_b32 v65, 0xffff0000, v24
    v_mul_f32 v64, v64, v11
    v_mul_f32 v65, v65, v11
    v_cvt_pk_bf16_f32 v24, v64, v65
    v_sub_f32 v66, v66, v10
    v_sub_f32 v67, v67, v10
    v_cvt_pk_bf16_f32 v25, v66, v67
    v_lshlrev_b32 v66, 16, v25
    v_and_b32 v67, 0xffff0000, v25
    v_mul_f32 v66, v66, v11
    v_mul_f32 v67, v67, v11
    v_cvt_pk_bf16_f32 v25, v66, v67
    v_sub_f32 v68, v68, v10
    v_sub_f32 v69, v69, v10
    v_cvt_pk_bf16_f32 v26, v68, v69
    v_lshlrev_b32 v68, 16, v26
    v_and_b32 v69, 0xffff0000, v26
    v_mul_f32 v68, v68, v11
    v_mul_f32 v69, v69, v11
    v_cvt_pk_bf16_f32 v26, v68, v69
    v_sub_f32 v70, v70, v10
    v_sub_f32 v71, v71, v10
    v_cvt_pk_bf16_f32 v27, v70, v71
    v_lshlrev_b32 v70, 16, v27
    v_and_b32 v71, 0xffff0000, v27
    v_mul_f32 v70, v70, v11
    v_mul_f32 v71, v71, v11
    v_cvt_pk_bf16_f32 v27, v70, v71
    v_cndmask_b32 v120, v24, v26, s[20:21]
    v_cndmask_b32 v121, v25, v27, s[20:21]
    v_cndmask_b32 v122, v26, v24, s[20:21]
    v_cndmask_b32 v123, v27, v25, s[20:21]
    buffer_store_dwordx4 v[120:123], v8, s[4:7], s15 offen offset:2048 sc1
    v_sub_f32 v72, v72, v10
    v_sub_f32 v73, v73, v10
    v_cvt_pk_bf16_f32 v28, v72, v73
    v_lshlrev_b32 v72, 16, v28
    v_and_b32 v73, 0xffff0000, v28
    v_mul_f32 v72, v72, v11
    v_mul_f32 v73, v73, v11
    v_cvt_pk_bf16_f32 v28, v72, v73
    v_sub_f32 v74, v74, v10
    v_sub_f32 v75, v75, v10
    v_cvt_pk_bf16_f32 v29, v74, v75
    v_lshlrev_b32 v74, 16, v29
    v_and_b32 v75, 0xffff0000, v29
    v_mul_f32 v74, v74, v11
    v_mul_f32 v75, v75, v11
    v_cvt_pk_bf16_f32 v29, v74, v75
    v_sub_f32 v76, v76, v10
    v_sub_f32 v77, v77, v10
    v_cvt_pk_bf16_f32 v30, v76, v77
    v_lshlrev_b32 v76, 16, v30
    v_and_b32 v77, 0xffff0000, v30
    v_mul_f32 v76, v76, v11
    v_mul_f32 v77, v77, v11
    v_cvt_pk_bf16_f32 v30, v76, v77
    v_sub_f32 v78, v78, v10
    v_sub_f32 v79, v79, v10
    v_cvt_pk_bf16_f32 v31, v78, v79
    v_lshlrev_b32 v78, 16, v31
    v_and_b32 v79, 0xffff0000, v31
    v_mul_f32 v78, v78, v11
    v_mul_f32 v79, v79, v11
    v_cvt_pk_bf16_f32 v31, v78, v79
    v_cndmask_b32 v124, v28, v30, s[20:21]
    v_cndmask_b32 v125, v29, v31, s[20:21]
    v_cndmask_b32 v126, v30, v28, s[20:21]
    v_cndmask_b32 v127, v31, v29, s[20:21]
    buffer_store_dwordx4 v[124:127], v8, s[4:7], s15 offen offset:3072 sc1
    v_sub_f32 v80, v80, v10
    v_sub_f32 v81, v81, v10
    v_cvt_pk_bf16_f32 v32, v80, v81
    v_lshlrev_b32 v80, 16, v32
    v_and_b32 v81, 0xffff0000, v32
    v_mul_f32 v80, v80, v11
    v_mul_f32 v81, v81, v11
    v_cvt_pk_bf16_f32 v32, v80, v81
    v_sub_f32 v82, v82, v10
    v_sub_f32 v83, v83, v10
    v_cvt_pk_bf16_f32 v33, v82, v83
    v_lshlrev_b32 v82, 16, v33
    v_and_b32 v83, 0xffff0000, v33
    v_mul_f32 v82, v82, v11
    v_mul_f32 v83, v83, v11
    v_cvt_pk_bf16_f32 v33, v82, v83
    v_sub_f32 v84, v84, v10
    v_sub_f32 v85, v85, v10
    v_cvt_pk_bf16_f32 v34, v84, v85
    v_lshlrev_b32 v84, 16, v34
    v_and_b32 v85, 0xffff0000, v34
    v_mul_f32 v84, v84, v11
    v_mul_f32 v85, v85, v11
    v_cvt_pk_bf16_f32 v34, v84, v85
    v_sub_f32 v86, v86, v10
    v_sub_f32 v87, v87, v10
    v_cvt_pk_bf16_f32 v35, v86, v87
    v_lshlrev_b32 v86, 16, v35
    v_and_b32 v87, 0xffff0000, v35
    v_mul_f32 v86, v86, v11
    v_mul_f32 v87, v87, v11
    v_cvt_pk_bf16_f32 v35, v86, v87
    v_cndmask_b32 v128, v32, v34, s[20:21]
    v_cndmask_b32 v129, v33, v35, s[20:21]
    v_cndmask_b32 v130, v34, v32, s[20:21]
    v_cndmask_b32 v131, v35, v33, s[20:21]
    buffer_store_dwordx4 v[128:131], v8, s[4:7], s16 offen offset:0 sc1
    v_sub_f32 v88, v88, v10
    v_sub_f32 v89, v89, v10
    v_cvt_pk_bf16_f32 v36, v88, v89
    v_lshlrev_b32 v88, 16, v36
    v_and_b32 v89, 0xffff0000, v36
    v_mul_f32 v88, v88, v11
    v_mul_f32 v89, v89, v11
    v_cvt_pk_bf16_f32 v36, v88, v89
    v_sub_f32 v90, v90, v10
    v_sub_f32 v91, v91, v10
    v_cvt_pk_bf16_f32 v37, v90, v91
    v_lshlrev_b32 v90, 16, v37
    v_and_b32 v91, 0xffff0000, v37
    v_mul_f32 v90, v90, v11
    v_mul_f32 v91, v91, v11
    v_cvt_pk_bf16_f32 v37, v90, v91
    v_sub_f32 v92, v92, v10
    v_sub_f32 v93, v93, v10
    v_cvt_pk_bf16_f32 v38, v92, v93
    v_lshlrev_b32 v92, 16, v38
    v_and_b32 v93, 0xffff0000, v38
    v_mul_f32 v92, v92, v11
    v_mul_f32 v93, v93, v11
    v_cvt_pk_bf16_f32 v38, v92, v93
    v_sub_f32 v94, v94, v10
    v_sub_f32 v95, v95, v10
    v_cvt_pk_bf16_f32 v39, v94, v95
    v_lshlrev_b32 v94, 16, v39
    v_and_b32 v95, 0xffff0000, v39
    v_mul_f32 v94, v94, v11
    v_mul_f32 v95, v95, v11
    v_cvt_pk_bf16_f32 v39, v94, v95
    v_cndmask_b32 v132, v36, v38, s[20:21]
    v_cndmask_b32 v133, v37, v39, s[20:21]
    v_cndmask_b32 v134, v38, v36, s[20:21]
    v_cndmask_b32 v135, v39, v37, s[20:21]
    buffer_store_dwordx4 v[132:135], v8, s[4:7], s16 offen offset:1024 sc1
    v_sub_f32 v96, v96, v10
    v_sub_f32 v97, v97, v10
    v_cvt_pk_bf16_f32 v40, v96, v97
    v_lshlrev_b32 v96, 16, v40
    v_and_b32 v97, 0xffff0000, v40
    v_mul_f32 v96, v96, v11
    v_mul_f32 v97, v97, v11
    v_cvt_pk_bf16_f32 v40, v96, v97
    v_sub_f32 v98, v98, v10
    v_sub_f32 v99, v99, v10
    v_cvt_pk_bf16_f32 v41, v98, v99
    v_lshlrev_b32 v98, 16, v41
    v_and_b32 v99, 0xffff0000, v41
    v_mul_f32 v98, v98, v11
    v_mul_f32 v99, v99, v11
    v_cvt_pk_bf16_f32 v41, v98, v99
    v_sub_f32 v100, v100, v10
    v_sub_f32 v101, v101, v10
    v_cvt_pk_bf16_f32 v42, v100, v101
    v_lshlrev_b32 v100, 16, v42
    v_and_b32 v101, 0xffff0000, v42
    v_mul_f32 v100, v100, v11
    v_mul_f32 v101, v101, v11
    v_cvt_pk_bf16_f32 v42, v100, v101
    v_sub_f32 v102, v102, v10
    v_sub_f32 v103, v103, v10
    v_cvt_pk_bf16_f32 v43, v102, v103
    v_lshlrev_b32 v102, 16, v43
    v_and_b32 v103, 0xffff0000, v43
    v_mul_f32 v102, v102, v11
    v_mul_f32 v103, v103, v11
    v_cvt_pk_bf16_f32 v43, v102, v103
    v_cndmask_b32 v136, v40, v42, s[20:21]
    v_cndmask_b32 v137, v41, v43, s[20:21]
    v_cndmask_b32 v138, v42, v40, s[20:21]
    v_cndmask_b32 v139, v43, v41, s[20:21]
    buffer_store_dwordx4 v[136:139], v8, s[4:7], s16 offen offset:2048 sc1
    v_sub_f32 v104, v104, v10
    v_sub_f32 v105, v105, v10
    v_cvt_pk_bf16_f32 v44, v104, v105
    v_lshlrev_b32 v104, 16, v44
    v_and_b32 v105, 0xffff0000, v44
    v_mul_f32 v104, v104, v11
    v_mul_f32 v105, v105, v11
    v_cvt_pk_bf16_f32 v44, v104, v105
    v_sub_f32 v106, v106, v10
    v_sub_f32 v107, v107, v10
    v_cvt_pk_bf16_f32 v45, v106, v107
    v_lshlrev_b32 v106, 16, v45
    v_and_b32 v107, 0xffff0000, v45
    v_mul_f32 v106, v106, v11
    v_mul_f32 v107, v107, v11
    v_cvt_pk_bf16_f32 v45, v106, v107
    v_sub_f32 v108, v108, v10
    v_sub_f32 v109, v109, v10
    v_cvt_pk_bf16_f32 v46, v108, v109
    v_lshlrev_b32 v108, 16, v46
    v_and_b32 v109, 0xffff0000, v46
    v_mul_f32 v108, v108, v11
    v_mul_f32 v109, v109, v11
    v_cvt_pk_bf16_f32 v46, v108, v109
    v_sub_f32 v110, v110, v10
    v_sub_f32 v111, v111, v10
    v_cvt_pk_bf16_f32 v47, v110, v111
    v_lshlrev_b32 v110, 16, v47
    v_and_b32 v111, 0xffff0000, v47
    v_mul_f32 v110, v110, v11
    v_mul_f32 v111, v111, v11
    v_cvt_pk_bf16_f32 v47, v110, v111
    v_cndmask_b32 v140, v44, v46, s[20:21]
    v_cndmask_b32 v141, v45, v47, s[20:21]
    v_cndmask_b32 v142, v46, v44, s[20:21]
    v_cndmask_b32 v143, v47, v45, s[20:21]
    buffer_store_dwordx4 v[140:143], v8, s[4:7], s16 offen offset:3072 sc1
    s_waitcnt vmcnt(0)
    s_barrier
    s_cmp_lg_u32 s3, 0
    s_cbranch_scc1 ln_sig
    v_mov_b32 v2, 1
    s_mov_b64 exec, 1
    s_cmp_ge_u32 s63, 8
    s_cbranch_scc1 ln_sb
    buffer_atomic_add v2, off, s[64:67], 0 offset:192 sc1
ln_sb:
    buffer_atomic_add v2, off, s[64:67], 0 offset:0 sc1
    s_mov_b64 exec, -1
    s_branch ln_sig
ln_touch:
    s_getpc_b64 s[24:25]
    s_add_u32 s24, s24, jobtab@rel32@lo+4
    s_addc_u32 s25, s25, jobtab@rel32@hi+12
    s_and_b32 s30, s63, 3
    s_mul_i32 s30, s30, 323
    s_lshr_b32 s31, s63, 2
    s_add_u32 s30, s30, s31
    s_lshl_b32 s30, s30, 6
    s_add_u32 s24, s24, s30
    s_addc_u32 s25, s25, 0
    s_load_dwordx16 s[32:47], s[24:25], 0
    s_mov_b32 s11, 131072
    v_and_b32 v20, 63, v0
    s_waitcnt lgkmcnt(0)
    s_load_dwordx2 s[8:9], s[0:1], s33
    s_mov_b32 s10, s38
    s_lshl_b32 s30, s35, 4
    v_mul_lo_u32 v21, s30, v20
    v_and_b32 v22, 15, v20
    v_mul_lo_u32 v22, s43, v22
    s_waitcnt lgkmcnt(0)
    s_cmp_eq_u32 s3, 4
    s_cbranch_scc0 tlb_1_1
    buffer_load_dword v23, v21, s[8:11], s36 offen
    s_branch tlb_1
tlb_1_1:
    s_cmp_eq_u32 s3, 5
    s_cbranch_scc0 tlb_1
    buffer_load_dword v23, v22, s[4:7], s42 offen
    buffer_load_dword v23, off, s[4:7], s46
tlb_1:
    s_cmp_lg_u32 s3, 7
    s_cbranch_scc1 ln_nrp
    s_mov_b32 s95, 0x10000
rp_2:
    buffer_load_dword v13, off, s[64:67], 0 offset:224 sc1
    s_waitcnt vmcnt(0)
    v_readfirstlane_b32 s96, v13
    s_cmp_lg_u32 s96, 0
    s_cbranch_scc1 rp_2_ok
    s_sleep 2
    s_sub_u32 s95, s95, 1
    s_cbranch_scc0 rp_2
    s_add_u32 s96, s97, 1
rp_2_ok:
    s_sub_u32 s96, s96, 1
    v_mov_b32 v12, 2048
    v_mov_b32 v13, s96
    ds_write_b32 v12, v13
    s_waitcnt lgkmcnt(0)
ln_nrp:
    s_barrier
    s_barrier
    v_mov_b32 v12, 2048
    ds_read_b32 v12, v12
    s_mov_b32 s96, s97
    s_waitcnt lgkmcnt(0)
    v_readfirstlane_b32 s97, v12
    s_cmp_lg_u32 s96, s97
    s_cbranch_scc1 k_restart
    s_barrier
ln_sig:
    s_mov_b32 s29, s63
    v_and_b32 v20, 63, v0
    v_lshlrev_b32 v1, 4, v20
    v_add_u32 v19, 0x1000, v1
    v_lshrrev_b32 v4, 4, v20
    v_mov_b32 v17, 0
    v_mov_b32 v18, 1
    s_lshr_b32 s26, s3, 2
    s_and_b32 s27, s3, 3
    s_lshl_b32 s21, s3, 11
    s_lshl_b32 s22, s3, 10
    s_add_u32 s22, s22, 16384
    s_mov_b32 s11, 131072
    s_mov_b32 s15, 131072
    s_mov_b32 s28, 0
    v_and_b32 v21, 15, v20
    v_lshlrev_b32 v22, 2, v4
    v_xor_b32 v21, v21, v22
    s_lshr_b32 s30, s3, 1
    s_and_b32 s30, s30, 1
    v_xor_b32 v21, s30, v21
    v_lshlrev_b32 v3, 4, v21
    s_lshl_b32 s30, s26, 13
    v_add_u32 v5, s30, v1
    v_add_u32 v6, 0x10000, v5
    v_bfe_u32 v21, v20, 2, 2
    v_and_b32 v22, 3, v20
    v_and_b32 v23, 1, v4
    v_xor_b32 v24, s27, v21
    v_xor_b32 v25, v22, v23
    v_lshl_add_u32 v24, v24, 2, v25
    v_lshlrev_b32 v24, 4, v24
    v_lshl_add_u32 v25, v4, 3, v21
    v_lshl_add_u32 v24, v25, 8, v24
    v_and_b32 v22, 1, v22
    v_xor_b32 v25, 0, v23
    v_lshl_add_u32 v8, v25, 10, v24
    v_xor_b32 v25, 0, v22
    v_lshl_add_u32 v8, v25, 3, v8
    v_add_u32 v12, 0x10000, v8
    v_xor_b32 v25, 1, v23
    v_lshl_add_u32 v9, v25, 10, v24
    v_xor_b32 v25, 0, v22
    v_lshl_add_u32 v9, v25, 3, v9
    v_add_u32 v13, 0x10000, v9
    v_xor_b32 v25, 0, v23
    v_lshl_add_u32 v10, v25, 10, v24
    v_xor_b32 v25, 1, v22
    v_lshl_add_u32 v10, v25, 3, v10
    v_add_u32 v14, 0x10000, v10
    v_xor_b32 v25, 1, v23
    v_lshl_add_u32 v11, v25, 10, v24
    v_xor_b32 v25, 1, v22
    v_lshl_add_u32 v11, v25, 3, v11
    v_add_u32 v15, 0x10000, v11
    s_lshl_b32 s30, s3, 2
    s_add_u32 s30, s30, 131072
    v_mov_b32 v7, s30
    s_cmp_ge_u32 s3, 4
    s_cbranch_scc0 w_np
    s_setprio 1
w_np:
    s_getpc_b64 s[24:25]
    s_add_u32 s24, s24, jobtab@rel32@lo+4
    s_addc_u32 s25, s25, jobtab@rel32@hi+12
    s_and_b32 s31, s29, 3
    s_mul_i32 s30, s31, 20672
    s_add_u32 s24, s24, s30
    s_addc_u32 s25, s25, 0
    s_lshl_b32 s71, s31, 2
    s_add_u32 s71, s71, 64
    s_lshr_b32 s59, s29, 2
    s_lshl_b32 s30, s59, 6
    s_load_dwordx16 s[32:47], s[24:25], s30
    s_waitcnt lgkmcnt(0)
    s_sub_u32 s57, s32, 3
    s_cmp_ge_u32 s57, 2
    s_cbranch_scc1 w_nopre
    s_load_dwordx2 s[8:9], s[0:1], s33
    s_load_dwordx2 s[12:13], s[0:1], s34
    s_mov_b32 s10, s38
    s_mov_b32 s14, s38
    s_cmp_eq_u32 s32, 4
    s_cselect_b32 s31, 0, 1
    s_lshl_b32 s30, s3, s31
    s_mul_i32 s30, s30, s40
    s_add_u32 s16, s39, s30
    s_cmp_eq_u32 s32, 4
    s_cselect_b32 s30, 1024, s40
    s_cselect_b32 s31, 6, 5
    s_lshl_b32 s62, 32, s31
    s_add_u32 s17, s16, s30
    s_lshl_b32 s30, s3, 2
    s_mul_i32 s30, s30, s35
    s_add_u32 s18, s36, s30
    s_add_u32 s19, s37, s30
    s_lshl_b32 s20, s35, s31
    v_mul_u32_u24 v2, s35, v4
    v_add_u32 v2, v2, v3
    s_waitcnt lgkmcnt(0)
    s_add_u32 m0, s22, 0
    s_nop 0
    buffer_load_dwordx4 v2, s[8:11], s18 offen lds
    s_add_u32 s18, s18, s20
    s_add_u32 m0, s22, 8192
    s_nop 0
    buffer_load_dwordx4 v2, s[12:15], s19 offen lds
    s_add_u32 s19, s19, s20
    s_add_u32 m0, s22, 32768
    s_nop 0
    buffer_load_dwordx4 v2, s[8:11], s18 offen lds
    s_add_u32 s18, s18, s20
    s_add_u32 m0, s22, 40960
    s_nop 0
    buffer_load_dwordx4 v2, s[12:15], s19 offen lds
    s_add_u32 s19, s19, s20
    s_add_u32 m0, s22, 65536
    s_nop 0
    buffer_load_dwordx4 v2, s[8:11], s18 offen lds
    s_add_u32 s18, s18, s20
    s_add_u32 m0, s22, 73728
    s_nop 0
    buffer_load_dwordx4 v2, s[12:15], s19 offen lds
    s_add_u32 s19, s19, s20
    s_add_u32 m0, s22, 98304
    s_nop 0
    buffer_load_dwordx4 v2, s[8:11], s18 offen lds
    s_add_u32 s18, s18, s20
    s_add_u32 m0, s22, 106496
    s_nop 0
    buffer_load_dwordx4 v2, s[12:15], s19 offen lds
    s_add_u32 s19, s19, s20
    s_cmp_eq_u32 s32, 4
    s_cselect_b32 s70, 1, 0
    s_cmp_eq_u32 s39, 0
    s_cselect_b32 s70, s70, 0
    s_cmp_lg_u32 s3, 0
    s_cbranch_scc1 lnwp_ok
    s_cmp_eq_u32 s70, 0
    s_cbranch_scc1 lnwp_full
    s_mov_b32 s69, 65536
lnwap:
    buffer_load_dword v20, off, s[64:67], 0 offset:192 sc1
    s_waitcnt vmcnt(0)
    v_readfirstlane_b32 s68, v20
    s_cmp_ge_u32 s68, 8
    s_cbranch_scc1 lnwap_ok
    s_sleep 8
    s_sub_u32 s69, s69, 1
    s_cbranch_scc0 lnwap
lnwap_ok:
    s_branch lnwp_ok
lnwp_full:
    s_mov_b32 s69, 65536
lnwp:
    buffer_load_dword v20, off, s[64:67], 0 offset:0 sc1
    s_waitcnt vmcnt(0)
    v_readfirstlane_b32 s68, v20
    s_cmp_ge_u32 s68, 128
    s_cbranch_scc1 lnwp_ok
    s_sleep 8
    s_sub_u32 s69, s69, 1
    s_cbranch_scc0 lnwp
lnwp_ok:
    s_barrier
    s_add_u32 m0, s21, 0
    s_nop 0
    buffer_load_dwordx4 v1, s[4:7], s16 offen sc1 lds
    s_add_u32 s16, s16, s62
    s_add_u32 m0, s21, 1024
    s_nop 0
    buffer_load_dwordx4 v1, s[4:7], s17 offen sc1 lds
    s_add_u32 s17, s17, s62
    s_add_u32 m0, s21, 32768
    s_nop 0
    buffer_load_dwordx4 v1, s[4:7], s16 offen sc1 lds
    s_add_u32 s16, s16, s62
    s_add_u32 m0, s21, 33792
    s_nop 0
    buffer_load_dwordx4 v1, s[4:7], s17 offen sc1 lds
    s_add_u32 s17, s17, s62
    s_add_u32 m0, s21, 65536
    s_nop 0
    buffer_load_dwordx4 v1, s[4:7], s16 offen sc1 lds
    s_add_u32 s16, s16, s62
    s_add_u32 m0, s21, 66560
    s_nop 0
    buffer_load_dwordx4 v1, s[4:7], s17 offen sc1 lds
    s_add_u32 s17, s17, s62
    s_add_u32 m0, s21, 98304
    s_nop 0
    buffer_load_dwordx4 v1, s[4:7], s16 offen sc1 lds
    s_add_u32 s16, s16, s62
    s_add_u32 m0, s21, 99328
    s_nop 0
    buffer_load_dwordx4 v1, s[4:7], s17 offen sc1 lds
    s_add_u32 s17, s17, s62
    s_branch w_adopt
w_nopre:
    s_cmp_eq_u32 s32, 4
    s_cselect_b32 s70, 1, 0
    s_cmp_eq_u32 s39, 0
    s_cselect_b32 s70, s70, 0
    s_cmp_lg_u32 s3, 0
    s_cbranch_scc1 lnw_ok
    s_cmp_eq_u32 s70, 0
    s_cbranch_scc1 lnw_full
    s_mov_b32 s69, 65536
lnwa:
    buffer_load_dword v20, off, s[64:67], 0 offset:192 sc1
    s_waitcnt vmcnt(0)
    v_readfirstlane_b32 s68, v20
    s_cmp_ge_u32 s68, 8
    s_cbranch_scc1 lnwa_ok
    s_sleep 8
    s_sub_u32 s69, s69, 1
    s_cbranch_scc0 lnwa
lnwa_ok:
    s_branch lnw_ok
lnw_full:
    s_mov_b32 s69, 65536
lnw:
    buffer_load_dword v20, off, s[64:67], 0 offset:0 sc1
    s_waitcnt vmcnt(0)
    v_readfirstlane_b32 s68, v20
    s_cmp_ge_u32 s68, 128
    s_cbranch_scc1 lnw_ok
    s_sleep 8
    s_sub_u32 s69, s69, 1
    s_cbranch_scc0 lnw
lnw_ok:
    s_barrier
w_cold:
    s_cmp_eq_u32 s32, 0
    s_cbranch_scc1 k_end
    s_cmp_ge_u32 s32, 6
    s_cbranch_scc1 w_fin
    s_cmp_lg_u32 s3, 0
    s_cbranch_scc1 w_depok
    s_cmp_eq_u32 s45, 0
    s_cbranch_scc1 w_depok
    s_mov_b32 s31, 0x40000
w_waitdep:
    buffer_load_dword v16, v17, s[4:7], s44 offen sc1
    s_waitcnt vmcnt(0)
    v_readfirstlane_b32 s30, v16
    s_cmp_ge_u32 s30, s45
    s_cbranch_scc1 w_depok
    s_sleep 16
    s_sub_u32 s31, s31, 1
    s_cbranch_scc0 w_waitdep
w_depok:
    s_cmp_eq_u32 s32, 5
    s_cbranch_scc1 w_att
    s_load_dwordx2 s[8:9], s[0:1], s33
    s_load_dwordx2 s[12:13], s[0:1], s34
    s_mov_b32 s10, s38
    s_mov_b32 s14, s38
    s_cmp_eq_u32 s32, 4
    s_cselect_b32 s31, 0, 1
    s_lshl_b32 s30, s3, s31
    s_mul_i32 s30, s30, s40
    s_add_u32 s16, s39, s30
    s_cmp_eq_u32 s32, 4
    s_cselect_b32 s30, 1024, s40
    s_cselect_b32 s31, 6, 5
    s_lshl_b32 s62, 32, s31
    s_add_u32 s17, s16, s30
    s_lshl_b32 s30, s3, 2
    s_mul_i32 s30, s30, s35
    s_add_u32 s18, s36, s30
    s_add_u32 s19, s37, s30
    s_lshl_b32 s20, s35, s31
    v_mul_u32_u24 v2, s35, v4
    v_add_u32 v2, v2, v3
    s_waitcnt lgkmcnt(0)
    s_barrier
    s_add_u32 m0, s21, 0
    s_nop 0
    buffer_load_dwordx4 v1, s[4:7], s16 offen sc1 lds
    s_add_u32 s16, s16, s62
    s_add_u32 m0, s21, 1024
    s_nop 0
    buffer_load_dwordx4 v1, s[4:7], s17 offen sc1 lds
    s_add_u32 s17, s17, s62
    s_add_u32 m0, s22, 0
    s_nop 0
    buffer_load_dwordx4 v2, s[8:11], s18 offen lds
    s_add_u32 s18, s18, s20
    s_add_u32 m0, s22, 8192
    s_nop 0
    buffer_load_dwordx4 v2, s[12:15], s19 offen lds
    s_add_u32 s19, s19, s20
    s_add_u32 m0, s21, 32768
    s_nop 0
    buffer_load_dwordx4 v1, s[4:7], s16 offen sc1 lds
    s_add_u32 s16, s16, s62
    s_add_u32 m0, s21, 33792
    s_nop 0
    buffer_load_dwordx4 v1, s[4:7], s17 offen sc1 lds
    s_add_u32 s17, s17, s62
    s_add_u32 m0, s22, 32768
    s_nop 0
    buffer_load_dwordx4 v2, s[8:11], s18 offen lds
    s_add_u32 s18, s18, s20
    s_add_u32 m0, s22, 40960
    s_nop 0
    buffer_load_dwordx4 v2, s[12:15], s19 offen lds
    s_add_u32 s19, s19, s20
    s_add_u32 m0, s21, 65536
    s_nop 0
    buffer_load_dwordx4 v1, s[4:7], s16 offen sc1 lds
    s_add_u32 s16, s16, s62
    s_add_u32 m0, s21, 66560
    s_nop 0
    buffer_load_dwordx4 v1, s[4:7], s17 offen sc1 lds
    s_add_u32 s17, s17, s62
    s_add_u32 m0, s22, 65536
    s_nop 0
    buffer_load_dwordx4 v2, s[8:11], s18 offen lds
    s_add_u32 s18, s18, s20
    s_add_u32 m0, s22, 73728
    s_nop 0
    buffer_load_dwordx4 v2, s[12:15], s19 offen lds
    s_add_u32 s19, s19, s20
    s_add_u32 m0, s21, 98304
    s_nop 0
    buffer_load_dwordx4 v1, s[4:7], s16 offen sc1 lds
    s_add_u32 s16, s16, s62
    s_add_u32 m0, s21, 99328
    s_nop 0
    buffer_load_dwordx4 v1, s[4:7], s17 offen sc1 lds
    s_add_u32 s17, s17, s62
    s_add_u32 m0, s22, 98304
    s_nop 0
    buffer_load_dwordx4 v2, s[8:11], s18 offen lds
    s_add_u32 s18, s18, s20
    s_add_u32 m0, s22, 106496
    s_nop 0
    buffer_load_dwordx4 v2, s[12:15], s19 offen lds
    s_add_u32 s19, s19, s20
w_adopt:
    s_mov_b32 s48, s32
    s_cmp_eq_u32 s32, 4
    s_cselect_b32 s30, 2, 3
    s_lshl_b32 s30, s26, s30
    s_mul_i32 s30, s30, s43
    s_add_u32 s49, s42, s30
    s_mov_b32 s50, s43
    s_mov_b32 s51, s46
    s_mov_b32 s23, s41
    s_mov_b32 s53, s41
    s_waitcnt vmcnt(0)
    s_barrier
    ds_read_b64_tr_b16 v[64:65], v8 offset:16384
    ds_read_b64_tr_b16 v[66:67], v9 offset:16384
    ds_read_b64_tr_b16 v[68:69], v10 offset:16384
    ds_read_b64_tr_b16 v[70:71], v11 offset:16384
    ds_read_b64_tr_b16 v[72:73], v8 offset:24576
    ds_read_b64_tr_b16 v[74:75], v9 offset:24576
    ds_read_b64_tr_b16 v[76:77], v10 offset:24576
    ds_read_b64_tr_b16 v[78:79], v11 offset:24576
    ds_read_b128 v[32:35], v5 offset:0
    ds_read_b128 v[36:39], v5 offset:1024
    ds_read_b128 v[40:43], v5 offset:2048
    ds_read_b128 v[44:47], v5 offset:3072
    ds_read_b128 v[48:51], v5 offset:4096
    ds_read_b128 v[52:55], v5 offset:5120
    ds_read_b128 v[56:59], v5 offset:6144
    ds_read_b128 v[60:63], v5 offset:7168
    s_waitcnt lgkmcnt(0)
    s_cmp_eq_u32 s48, 4
    s_cbranch_scc1 w_firstH
    s_branch w_first16
w_first4:
    s_waitcnt vmcnt(12)
    s_barrier
    v_mfma_f32_16x16x32_bf16 v[128:131], v[64:67], v[32:35], 0
    s_add_u32 m0, s21, 0
    s_nop 0
    buffer_load_dwordx4 v1, s[4:7], s16 offen sc1 lds
    s_add_u32 s16, s16, s62
    v_mfma_f32_16x16x32_bf16 v[132:135], v[68:71], v[32:35], 0
    ds_read_b64_tr_b16 v[112:113], v8 offset:49152
    v_mfma_f32_16x16x32_bf16 v[136:139], v[72:75], v[32:35], 0
    ds_read_b64_tr_b16 v[114:115], v9 offset:49152
    v_mfma_f32_16x16x32_bf16 v[140:143], v[76:79], v[32:35], 0
    ds_read_b64_tr_b16 v[116:117], v10 offset:49152
    v_mfma_f32_16x16x32_bf16 v[144:147], v[64:67], v[36:39], 0
    s_add_u32 m0, s21, 1024
    s_nop 0
    buffer_load_dwordx4 v1, s[4:7], s17 offen sc1 lds
    s_add_u32 s17, s17, s62
    v_mfma_f32_16x16x32_bf16 v[148:151], v[68:71], v[36:39], 0
    ds_read_b64_tr_b16 v[118:119], v11 offset:49152
    v_mfma_f32_16x16x32_bf16 v[152:155], v[72:75], v[36:39], 0
    ds_read_b64_tr_b16 v[120:121], v8 offset:57344
    v_mfma_f32_16x16x32_bf16 v[156:159], v[76:79], v[36:39], 0
    ds_read_b64_tr_b16 v[122:123], v9 offset:57344
    v_mfma_f32_16x16x32_bf16 v[160:163], v[64:67], v[40:43], 0
    s_add_u32 m0, s22, 0
    s_nop 0
    buffer_load_dwordx4 v2, s[8:11], s18 offen lds
    s_add_u32 s18, s18, s20
    v_mfma_f32_16x16x32_bf16 v[164:167], v[68:71], v[40:43], 0
    ds_read_b64_tr_b16 v[124:125], v10 offset:57344
    v_mfma_f32_16x16x32_bf16 v[168:171], v[72:75], v[40:43], 0
    ds_read_b64_tr_b16 v[126:127], v11 offset:57344
    v_mfma_f32_16x16x32_bf16 v[172:175], v[76:79], v[40:43], 0
    ds_read_b128 v[80:83], v5 offset:32768
    v_mfma_f32_16x16x32_bf16 v[176:179], v[64:67], v[44:47], 0
    s_add_u32 m0, s22, 8192
    s_nop 0
    buffer_load_dwordx4 v2, s[12:15], s19 offen lds
    s_add_u32 s19, s19, s20
    v_mfma_f32_16x16x32_bf16 v[180:183], v[68:71], v[44:47], 0
    ds_read_b128 v[84:87], v5 offset:33792
    v_mfma_f32_16x16x32_bf16 v[184:187], v[72:75], v[44:47], 0
    ds_read_b128 v[88:91], v5 offset:34816
    v_mfma_f32_16x16x32_bf16 v[188:191], v[76:79], v[44:47], 0
    ds_read_b128 v[92:95], v5 offset:35840
    v_mfma_f32_16x16x32_bf16 v[192:195], v[64:67], v[48:51], 0
    ds_read_b128 v[96:99], v5 offset:36864
    v_mfma_f32_16x16x32_bf16 v[196:199], v[68:71], v[48:51], 0
    ds_read_b128 v[100:103], v5 offset:37888
    v_mfma_f32_16x16x32_bf16 v[200:203], v[72:75], v[48:51], 0
    ds_read_b128 v[104:107], v5 offset:38912
    v_mfma_f32_16x16x32_bf16 v[204:207], v[76:79], v[48:51], 0
    ds_read_b128 v[108:111], v5 offset:39936
    v_mfma_f32_16x16x32_bf16 v[208:211], v[64:67], v[52:55], 0
    v_mfma_f32_16x16x32_bf16 v[212:215], v[68:71], v[52:55], 0
    v_mfma_f32_16x16x32_bf16 v[216:219], v[72:75], v[52:55], 0
    v_mfma_f32_16x16x32_bf16 v[220:223], v[76:79], v[52:55], 0
    v_mfma_f32_16x16x32_bf16 v[224:227], v[64:67], v[56:59], 0
    v_mfma_f32_16x16x32_bf16 v[228:231], v[68:71], v[56:59], 0
    v_mfma_f32_16x16x32_bf16 v[232:235], v[72:75], v[56:59], 0
    v_mfma_f32_16x16x32_bf16 v[236:239], v[76:79], v[56:59], 0
    v_mfma_f32_16x16x32_bf16 v[240:243], v[64:67], v[60:63], 0
    v_mfma_f32_16x16x32_bf16 v[244:247], v[68:71], v[60:63], 0
    v_mfma_f32_16x16x32_bf16 v[248:251], v[72:75], v[60:63], 0
    v_mfma_f32_16x16x32_bf16 v[252:255], v[76:79], v[60:63], 0
    s_waitcnt lgkmcnt(0)
w_first4_q1:
    s_waitcnt vmcnt(12)
    s_barrier
    v_mfma_f32_16x16x32_bf16 v[128:131], v[112:115], v[80:83], v[128:131]
    s_add_u32 m0, s21, 32768
    s_nop 0
    buffer_load_dwordx4 v1, s[4:7], s16 offen sc1 lds
    s_add_u32 s16, s16, s62
    v_mfma_f32_16x16x32_bf16 v[132:135], v[116:119], v[80:83], v[132:135]
    ds_read_b64_tr_b16 v[64:65], v12 offset:16384
    v_mfma_f32_16x16x32_bf16 v[136:139], v[120:123], v[80:83], v[136:139]
    ds_read_b64_tr_b16 v[66:67], v13 offset:16384
    v_mfma_f32_16x16x32_bf16 v[140:143], v[124:127], v[80:83], v[140:143]
    ds_read_b64_tr_b16 v[68:69], v14 offset:16384
    v_mfma_f32_16x16x32_bf16 v[144:147], v[112:115], v[84:87], v[144:147]
    s_add_u32 m0, s21, 33792
    s_nop 0
    buffer_load_dwordx4 v1, s[4:7], s17 offen sc1 lds
    s_add_u32 s17, s17, s62
    v_mfma_f32_16x16x32_bf16 v[148:151], v[116:119], v[84:87], v[148:151]
    ds_read_b64_tr_b16 v[70:71], v15 offset:16384
    v_mfma_f32_16x16x32_bf16 v[152:155], v[120:123], v[84:87], v[152:155]
    ds_read_b64_tr_b16 v[72:73], v12 offset:24576
    v_mfma_f32_16x16x32_bf16 v[156:159], v[124:127], v[84:87], v[156:159]
    ds_read_b64_tr_b16 v[74:75], v13 offset:24576
    v_mfma_f32_16x16x32_bf16 v[160:163], v[112:115], v[88:91], v[160:163]
    s_add_u32 m0, s22, 32768
    s_nop 0
    buffer_load_dwordx4 v2, s[8:11], s18 offen lds
    s_add_u32 s18, s18, s20
    v_mfma_f32_16x16x32_bf16 v[164:167], v[116:119], v[88:91], v[164:167]
    ds_read_b64_tr_b16 v[76:77], v14 offset:24576
    v_mfma_f32_16x16x32_bf16 v[168:171], v[120:123], v[88:91], v[168:171]
    ds_read_b64_tr_b16 v[78:79], v15 offset:24576
    v_mfma_f32_16x16x32_bf16 v[172:175], v[124:127], v[88:91], v[172:175]
    ds_read_b128 v[32:35], v6 offset:0
    v_mfma_f32_16x16x32_bf16 v[176:179], v[112:115], v[92:95], v[176:179]
    s_add_u32 m0, s22, 40960
    s_nop 0
    buffer_load_dwordx4 v2, s[12:15], s19 offen lds
    s_add_u32 s19, s19, s20
    v_mfma_f32_16x16x32_bf16 v[180:183], v[116:119], v[92:95], v[180:183]
    ds_read_b128 v[36:39], v6 offset:1024
    v_mfma_f32_16x16x32_bf16 v[184:187], v[120:123], v[92:95], v[184:187]
    ds_read_b128 v[40:43], v6 offset:2048
    v_mfma_f32_16x16x32_bf16 v[188:191], v[124:127], v[92:95], v[188:191]
    ds_read_b128 v[44:47], v6 offset:3072
    v_mfma_f32_16x16x32_bf16 v[192:195], v[112:115], v[96:99], v[192:195]
    ds_read_b128 v[48:51], v6 offset:4096
    v_mfma_f32_16x16x32_bf16 v[196:199], v[116:119], v[96:99], v[196:199]
    ds_read_b128 v[52:55], v6 offset:5120
    v_mfma_f32_16x16x32_bf16 v[200:203], v[120:123], v[96:99], v[200:203]
    ds_read_b128 v[56:59], v6 offset:6144
    v_mfma_f32_16x16x32_bf16 v[204:207], v[124:127], v[96:99], v[204:207]
    ds_read_b128 v[60:63], v6 offset:7168
    v_mfma_f32_16x16x32_bf16 v[208:211], v[112:115], v[100:103], v[208:211]
    v_mfma_f32_16x16x32_bf16 v[212:215], v[116:119], v[100:103], v[212:215]
    v_mfma_f32_16x16x32_bf16 v[216:219], v[120:123], v[100:103], v[216:219]
    v_mfma_f32_16x16x32_bf16 v[220:223], v[124:127], v[100:103], v[220:223]
    v_mfma_f32_16x16x32_bf16 v[224:227], v[112:115], v[104:107], v[224:227]
    v_mfma_f32_16x16x32_bf16 v[228:231], v[116:119], v[104:107], v[228:231]
    v_mfma_f32_16x16x32_bf16 v[232:235], v[120:123], v[104:107], v[232:235]
    v_mfma_f32_16x16x32_bf16 v[236:239], v[124:127], v[104:107], v[236:239]
    v_mfma_f32_16x16x32_bf16 v[240:243], v[112:115], v[108:111], v[240:243]
    v_mfma_f32_16x16x32_bf16 v[244:247], v[116:119], v[108:111], v[244:247]
    v_mfma_f32_16x16x32_bf16 v[248:251], v[120:123], v[108:111], v[248:251]
    v_mfma_f32_16x16x32_bf16 v[252:255], v[124:127], v[108:111], v[252:255]
    s_waitcnt lgkmcnt(0)
    s_waitcnt vmcnt(12)
    s_barrier
    v_mfma_f32_16x16x32_bf16 v[128:131], v[64:67], v[32:35], v[128:131]
    s_add_u32 m0, s21, 65536
    s_nop 0
    buffer_load_dwordx4 v1, s[4:7], s16 offen sc1 lds
    s_add_u32 s16, s16, s62
    v_mfma_f32_16x16x32_bf16 v[132:135], v[68:71], v[32:35], v[132:135]
    ds_read_b64_tr_b16 v[112:113], v12 offset:49152
    v_mfma_f32_16x16x32_bf16 v[136:139], v[72:75], v[32:35], v[136:139]
    ds_read_b64_tr_b16 v[114:115], v13 offset:49152
    v_mfma_f32_16x16x32_bf16 v[140:143], v[76:79], v[32:35], v[140:143]
    ds_read_b64_tr_b16 v[116:117], v14 offset:49152
    v_mfma_f32_16x16x32_bf16 v[144:147], v[64:67], v[36:39], v[144:147]
    s_add_u32 m0, s21, 66560
    s_nop 0
    buffer_load_dwordx4 v1, s[4:7], s17 offen sc1 lds
    s_add_u32 s17, s17, s62
    v_mfma_f32_16x16x32_bf16 v[148:151], v[68:71], v[36:39], v[148:151]
    ds_read_b64_tr_b16 v[118:119], v15 offset:49152
    v_mfma_f32_16x16x32_bf16 v[152:155], v[72:75], v[36:39], v[152:155]
    ds_read_b64_tr_b16 v[120:121], v12 offset:57344
    v_mfma_f32_16x16x32_bf16 v[156:159], v[76:79], v[36:39], v[156:159]
    ds_read_b64_tr_b16 v[122:123], v13 offset:57344
    v_mfma_f32_16x16x32_bf16 v[160:163], v[64:67], v[40:43], v[160:163]
    s_add_u32 m0, s22, 65536
    s_nop 0
    buffer_load_dwordx4 v2, s[8:11], s18 offen lds
    s_add_u32 s18, s18, s20
    v_mfma_f32_16x16x32_bf16 v[164:167], v[68:71], v[40:43], v[164:167]
    ds_read_b64_tr_b16 v[124:125], v14 offset:57344
    v_mfma_f32_16x16x32_bf16 v[168:171], v[72:75], v[40:43], v[168:171]
    ds_read_b64_tr_b16 v[126:127], v15 offset:57344
    v_mfma_f32_16x16x32_bf16 v[172:175], v[76:79], v[40:43], v[172:175]
    ds_read_b128 v[80:83], v6 offset:32768
    v_mfma_f32_16x16x32_bf16 v[176:179], v[64:67], v[44:47], v[176:179]
    s_add_u32 m0, s22, 73728
    s_nop 0
    buffer_load_dwordx4 v2, s[12:15], s19 offen lds
    s_add_u32 s19, s19, s20
    v_mfma_f32_16x16x32_bf16 v[180:183], v[68:71], v[44:47], v[180:183]
    ds_read_b128 v[84:87], v6 offset:33792
    v_mfma_f32_16x16x32_bf16 v[184:187], v[72:75], v[44:47], v[184:187]
    ds_read_b128 v[88:91], v6 offset:34816
    v_mfma_f32_16x16x32_bf16 v[188:191], v[76:79], v[44:47], v[188:191]
    ds_read_b128 v[92:95], v6 offset:35840
    v_mfma_f32_16x16x32_bf16 v[192:195], v[64:67], v[48:51], v[192:195]
    ds_read_b128 v[96:99], v6 offset:36864
    v_mfma_f32_16x16x32_bf16 v[196:199], v[68:71], v[48:51], v[196:199]
    ds_read_b128 v[100:103], v6 offset:37888
    v_mfma_f32_16x16x32_bf16 v[200:203], v[72:75], v[48:51], v[200:203]
    ds_read_b128 v[104:107], v6 offset:38912
    v_mfma_f32_16x16x32_bf16 v[204:207], v[76:79], v[48:51], v[204:207]
    ds_read_b128 v[108:111], v6 offset:39936
    v_mfma_f32_16x16x32_bf16 v[208:211], v[64:67], v[52:55], v[208:211]
    v_mfma_f32_16x16x32_bf16 v[212:215], v[68:71], v[52:55], v[212:215]
    v_mfma_f32_16x16x32_bf16 v[216:219], v[72:75], v[52:55], v[216:219]
    v_mfma_f32_16x16x32_bf16 v[220:223], v[76:79], v[52:55], v[220:223]
    v_mfma_f32_16x16x32_bf16 v[224:227], v[64:67], v[56:59], v[224:227]
    v_mfma_f32_16x16x32_bf16 v[228:231], v[68:71], v[56:59], v[228:231]
    v_mfma_f32_16x16x32_bf16 v[232:235], v[72:75], v[56:59], v[232:235]
    v_mfma_f32_16x16x32_bf16 v[236:239], v[76:79], v[56:59], v[236:239]
    v_mfma_f32_16x16x32_bf16 v[240:243], v[64:67], v[60:63], v[240:243]
    v_mfma_f32_16x16x32_bf16 v[244:247], v[68:71], v[60:63], v[244:247]
    v_mfma_f32_16x16x32_bf16 v[248:251], v[72:75], v[60:63], v[248:251]
    v_mfma_f32_16x16x32_bf16 v[252:255], v[76:79], v[60:63], v[252:255]
    s_waitcnt lgkmcnt(0)
    s_waitcnt vmcnt(8)
    s_barrier
    s_cmp_eq_u32 s28, 0
    s_cbranch_scc1 sig_3
    s_cmp_lg_u32 s3, 0
    s_cbranch_scc1 sig_3
    s_and_b32 s57, s28, 3
    v_mov_b32 v24, s57
    s_bfe_u32 s57, s28, 0x20002
    v_mov_b32 v25, s57
    s_andn2_b32 s28, s28, 15
    s_mov_b64 exec, 1
    buffer_atomic_add_x2 v[24:25], v17, s[4:7], s28 offen sc1
    s_mov_b64 exec, -1
sig_3:
    s_mov_b32 s28, 0
    v_mfma_f32_16x16x32_bf16 v[128:131], v[112:115], v[80:83], v[128:131]
    s_add_u32 m0, s21, 98304
    s_nop 0
    buffer_load_dwordx4 v1, s[4:7], s16 offen sc1 lds
    s_add_u32 s16, s16, s62
    v_mfma_f32_16x16x32_bf16 v[132:135], v[116:119], v[80:83], v[132:135]
    ds_read_b64_tr_b16 v[64:65], v8 offset:16384
    v_mfma_f32_16x16x32_bf16 v[136:139], v[120:123], v[80:83], v[136:139]
    ds_read_b64_tr_b16 v[66:67], v9 offset:16384
    v_mfma_f32_16x16x32_bf16 v[140:143], v[124:127], v[80:83], v[140:143]
    ds_read_b64_tr_b16 v[68:69], v10 offset:16384
    v_mfma_f32_16x16x32_bf16 v[144:147], v[112:115], v[84:87], v[144:147]
    s_add_u32 m0, s21, 99328
    s_nop 0
    buffer_load_dwordx4 v1, s[4:7], s17 offen sc1 lds
    s_add_u32 s17, s17, s62
    v_mfma_f32_16x16x32_bf16 v[148:151], v[116:119], v[84:87], v[148:151]
    ds_read_b64_tr_b16 v[70:71], v11 offset:16384
    v_mfma_f32_16x16x32_bf16 v[152:155], v[120:123], v[84:87], v[152:155]
    ds_read_b64_tr_b16 v[72:73], v8 offset:24576
    v_mfma_f32_16x16x32_bf16 v[156:159], v[124:127], v[84:87], v[156:159]
    ds_read_b64_tr_b16 v[74:75], v9 offset:24576
    v_mfma_f32_16x16x32_bf16 v[160:163], v[112:115], v[88:91], v[160:163]
    s_add_u32 m0, s22, 98304
    s_nop 0
    buffer_load_dwordx4 v2, s[8:11], s18 offen lds
    s_add_u32 s18, s18, s20
    v_mfma_f32_16x16x32_bf16 v[164:167], v[116:119], v[88:91], v[164:167]
    ds_read_b64_tr_b16 v[76:77], v10 offset:24576
    v_mfma_f32_16x16x32_bf16 v[168:171], v[120:123], v[88:91], v[168:171]
    ds_read_b64_tr_b16 v[78:79], v11 offset:24576
    v_mfma_f32_16x16x32_bf16 v[172:175], v[124:127], v[88:91], v[172:175]
    ds_read_b128 v[32:35], v5 offset:0
    v_mfma_f32_16x16x32_bf16 v[176:179], v[112:115], v[92:95], v[176:179]
    s_add_u32 m0, s22, 106496
    s_nop 0
    buffer_load_dwordx4 v2, s[12:15], s19 offen lds
    s_add_u32 s19, s19, s20
    v_mfma_f32_16x16x32_bf16 v[180:183], v[116:119], v[92:95], v[180:183]
    ds_read_b128 v[36:39], v5 offset:1024
    v_mfma_f32_16x16x32_bf16 v[184:187], v[120:123], v[92:95], v[184:187]
    ds_read_b128 v[40:43], v5 offset:2048
    v_mfma_f32_16x16x32_bf16 v[188:191], v[124:127], v[92:95], v[188:191]
    ds_read_b128 v[44:47], v5 offset:3072
    v_mfma_f32_16x16x32_bf16 v[192:195], v[112:115], v[96:99], v[192:195]
    ds_read_b128 v[48:51], v5 offset:4096
    v_mfma_f32_16x16x32_bf16 v[196:199], v[116:119], v[96:99], v[196:199]
    ds_read_b128 v[52:55], v5 offset:5120
    v_mfma_f32_16x16x32_bf16 v[200:203], v[120:123], v[96:99], v[200:203]
    ds_read_b128 v[56:59], v5 offset:6144
    v_mfma_f32_16x16x32_bf16 v[204:207], v[124:127], v[96:99], v[204:207]
    ds_read_b128 v[60:63], v5 offset:7168
    v_mfma_f32_16x16x32_bf16 v[208:211], v[112:115], v[100:103], v[208:211]
    v_mfma_f32_16x16x32_bf16 v[212:215], v[116:119], v[100:103], v[212:215]
    v_mfma_f32_16x16x32_bf16 v[216:219], v[120:123], v[100:103], v[216:219]
    v_mfma_f32_16x16x32_bf16 v[220:223], v[124:127], v[100:103], v[220:223]
    v_mfma_f32_16x16x32_bf16 v[224:227], v[112:115], v[104:107], v[224:227]
    v_mfma_f32_16x16x32_bf16 v[228:231], v[116:119], v[104:107], v[228:231]
    v_mfma_f32_16x16x32_bf16 v[232:235], v[120:123], v[104:107], v[232:235]
    v_mfma_f32_16x16x32_bf16 v[236:239], v[124:127], v[104:107], v[236:239]
    v_mfma_f32_16x16x32_bf16 v[240:243], v[112:115], v[108:111], v[240:243]
    v_mfma_f32_16x16x32_bf16 v[244:247], v[116:119], v[108:111], v[244:247]
    v_mfma_f32_16x16x32_bf16 v[248:251], v[120:123], v[108:111], v[248:251]
    v_mfma_f32_16x16x32_bf16 v[252:255], v[124:127], v[108:111], v[252:255]
    s_waitcnt lgkmcnt(0)
    s_branch w_loop_chk
w_first8:
    s_waitcnt vmcnt(16)
    s_barrier
    v_mfma_f32_16x16x32_bf16 v[128:131], v[64:67], v[32:35], 0
    s_add_u32 m0, s21, 0
    s_nop 0
    buffer_load_dwordx4 v1, s[4:7], s16 offen sc1 lds
    s_add_u32 s16, s16, s62
    v_mfma_f32_16x16x32_bf16 v[132:135], v[68:71], v[32:35], 0
    ds_read_b64_tr_b16 v[112:113], v8 offset:49152
    v_mfma_f32_16x16x32_bf16 v[136:139], v[72:75], v[32:35], 0
    ds_read_b64_tr_b16 v[114:115], v9 offset:49152
    v_mfma_f32_16x16x32_bf16 v[140:143], v[76:79], v[32:35], 0
    ds_read_b64_tr_b16 v[116:117], v10 offset:49152
    v_mfma_f32_16x16x32_bf16 v[144:147], v[64:67], v[36:39], 0
    s_add_u32 m0, s21, 1024
    s_nop 0
    buffer_load_dwordx4 v1, s[4:7], s17 offen sc1 lds
    s_add_u32 s17, s17, s62
    v_mfma_f32_16x16x32_bf16 v[148:151], v[68:71], v[36:39], 0
    ds_read_b64_tr_b16 v[118:119], v11 offset:49152
    v_mfma_f32_16x16x32_bf16 v[152:155], v[72:75], v[36:39], 0
    ds_read_b64_tr_b16 v[120:121], v8 offset:57344
    v_mfma_f32_16x16x32_bf16 v[156:159], v[76:79], v[36:39], 0
    ds_read_b64_tr_b16 v[122:123], v9 offset:57344
    v_mfma_f32_16x16x32_bf16 v[160:163], v[64:67], v[40:43], 0
    s_add_u32 m0, s22, 0
    s_nop 0
    buffer_load_dwordx4 v2, s[8:11], s18 offen lds
    s_add_u32 s18, s18, s20
    v_mfma_f32_16x16x32_bf16 v[164:167], v[68:71], v[40:43], 0
    ds_read_b64_tr_b16 v[124:125], v10 offset:57344
    v_mfma_f32_16x16x32_bf16 v[168:171], v[72:75], v[40:43], 0
    ds_read_b64_tr_b16 v[126:127], v11 offset:57344
    v_mfma_f32_16x16x32_bf16 v[172:175], v[76:79], v[40:43], 0
    ds_read_b128 v[80:83], v5 offset:32768
    v_mfma_f32_16x16x32_bf16 v[176:179], v[64:67], v[44:47], 0
    s_add_u32 m0, s22, 8192
    s_nop 0
    buffer_load_dwordx4 v2, s[12:15], s19 offen lds
    s_add_u32 s19, s19, s20
    v_mfma_f32_16x16x32_bf16 v[180:183], v[68:71], v[44:47], 0
    ds_read_b128 v[84:87], v5 offset:33792
    v_mfma_f32_16x16x32_bf16 v[184:187], v[72:75], v[44:47], 0
    ds_read_b128 v[88:91], v5 offset:34816
    v_mfma_f32_16x16x32_bf16 v[188:191], v[76:79], v[44:47], 0
    ds_read_b128 v[92:95], v5 offset:35840
    v_mfma_f32_16x16x32_bf16 v[192:195], v[64:67], v[48:51], 0
    ds_read_b128 v[96:99], v5 offset:36864
    v_mfma_f32_16x16x32_bf16 v[196:199], v[68:71], v[48:51], 0
    ds_read_b128 v[100:103], v5 offset:37888
    v_mfma_f32_16x16x32_bf16 v[200:203], v[72:75], v[48:51], 0
    ds_read_b128 v[104:107], v5 offset:38912
    v_mfma_f32_16x16x32_bf16 v[204:207], v[76:79], v[48:51], 0
    ds_read_b128 v[108:111], v5 offset:39936
    v_mfma_f32_16x16x32_bf16 v[208:211], v[64:67], v[52:55], 0
    v_mfma_f32_16x16x32_bf16 v[212:215], v[68:71], v[52:55], 0
    v_mfma_f32_16x16x32_bf16 v[216:219], v[72:75], v[52:55], 0
    v_mfma_f32_16x16x32_bf16 v[220:223], v[76:79], v[52:55], 0
    v_mfma_f32_16x16x32_bf16 v[224:227], v[64:67], v[56:59], 0
    v_mfma_f32_16x16x32_bf16 v[228:231], v[68:71], v[56:59], 0
    v_mfma_f32_16x16x32_bf16 v[232:235], v[72:75], v[56:59], 0
    v_mfma_f32_16x16x32_bf16 v[236:239], v[76:79], v[56:59], 0
    v_mfma_f32_16x16x32_bf16 v[240:243], v[64:67], v[60:63], 0
    v_mfma_f32_16x16x32_bf16 v[244:247], v[68:71], v[60:63], 0
    v_mfma_f32_16x16x32_bf16 v[248:251], v[72:75], v[60:63], 0
    v_mfma_f32_16x16x32_bf16 v[252:255], v[76:79], v[60:63], 0
    s_waitcnt lgkmcnt(0)
w_first8_q1:
    s_waitcnt vmcnt(16)
    s_barrier
    v_mfma_f32_16x16x32_bf16 v[128:131], v[112:115], v[80:83], v[128:131]
    s_add_u32 m0, s21, 32768
    s_nop 0
    buffer_load_dwordx4 v1, s[4:7], s16 offen sc1 lds
    s_add_u32 s16, s16, s62
    v_mfma_f32_16x16x32_bf16 v[132:135], v[116:119], v[80:83], v[132:135]
    ds_read_b64_tr_b16 v[64:65], v12 offset:16384
    v_mfma_f32_16x16x32_bf16 v[136:139], v[120:123], v[80:83], v[136:139]
    ds_read_b64_tr_b16 v[66:67], v13 offset:16384
    v_mfma_f32_16x16x32_bf16 v[140:143], v[124:127], v[80:83], v[140:143]
    ds_read_b64_tr_b16 v[68:69], v14 offset:16384
    v_mfma_f32_16x16x32_bf16 v[144:147], v[112:115], v[84:87], v[144:147]
    s_add_u32 m0, s21, 33792
    s_nop 0
    buffer_load_dwordx4 v1, s[4:7], s17 offen sc1 lds
    s_add_u32 s17, s17, s62
    v_mfma_f32_16x16x32_bf16 v[148:151], v[116:119], v[84:87], v[148:151]
    ds_read_b64_tr_b16 v[70:71], v15 offset:16384
    v_mfma_f32_16x16x32_bf16 v[152:155], v[120:123], v[84:87], v[152:155]
    ds_read_b64_tr_b16 v[72:73], v12 offset:24576
    v_mfma_f32_16x16x32_bf16 v[156:159], v[124:127], v[84:87], v[156:159]
    ds_read_b64_tr_b16 v[74:75], v13 offset:24576
    v_mfma_f32_16x16x32_bf16 v[160:163], v[112:115], v[88:91], v[160:163]
    s_add_u32 m0, s22, 32768
    s_nop 0
    buffer_load_dwordx4 v2, s[8:11], s18 offen lds
    s_add_u32 s18, s18, s20
    v_mfma_f32_16x16x32_bf16 v[164:167], v[116:119], v[88:91], v[164:167]
    ds_read_b64_tr_b16 v[76:77], v14 offset:24576
    v_mfma_f32_16x16x32_bf16 v[168:171], v[120:123], v[88:91], v[168:171]
    ds_read_b64_tr_b16 v[78:79], v15 offset:24576
    v_mfma_f32_16x16x32_bf16 v[172:175], v[124:127], v[88:91], v[172:175]
    ds_read_b128 v[32:35], v6 offset:0
    v_mfma_f32_16x16x32_bf16 v[176:179], v[112:115], v[92:95], v[176:179]
    s_add_u32 m0, s22, 40960
    s_nop 0
    buffer_load_dwordx4 v2, s[12:15], s19 offen lds
    s_add_u32 s19, s19, s20
    v_mfma_f32_16x16x32_bf16 v[180:183], v[116:119], v[92:95], v[180:183]
    ds_read_b128 v[36:39], v6 offset:1024
    v_mfma_f32_16x16x32_bf16 v[184:187], v[120:123], v[92:95], v[184:187]
    ds_read_b128 v[40:43], v6 offset:2048
    v_mfma_f32_16x16x32_bf16 v[188:191], v[124:127], v[92:95], v[188:191]
    ds_read_b128 v[44:47], v6 offset:3072
    v_mfma_f32_16x16x32_bf16 v[192:195], v[112:115], v[96:99], v[192:195]
    ds_read_b128 v[48:51], v6 offset:4096
    v_mfma_f32_16x16x32_bf16 v[196:199], v[116:119], v[96:99], v[196:199]
    ds_read_b128 v[52:55], v6 offset:5120
    v_mfma_f32_16x16x32_bf16 v[200:203], v[120:123], v[96:99], v[200:203]
    ds_read_b128 v[56:59], v6 offset:6144
    v_mfma_f32_16x16x32_bf16 v[204:207], v[124:127], v[96:99], v[204:207]
    ds_read_b128 v[60:63], v6 offset:7168
    v_mfma_f32_16x16x32_bf16 v[208:211], v[112:115], v[100:103], v[208:211]
    v_mfma_f32_16x16x32_bf16 v[212:215], v[116:119], v[100:103], v[212:215]
    v_mfma_f32_16x16x32_bf16 v[216:219], v[120:123], v[100:103], v[216:219]
    v_mfma_f32_16x16x32_bf16 v[220:223], v[124:127], v[100:103], v[220:223]
    v_mfma_f32_16x16x32_bf16 v[224:227], v[112:115], v[104:107], v[224:227]
    v_mfma_f32_16x16x32_bf16 v[228:231], v[116:119], v[104:107], v[228:231]
    v_mfma_f32_16x16x32_bf16 v[232:235], v[120:123], v[104:107], v[232:235]
    v_mfma_f32_16x16x32_bf16 v[236:239], v[124:127], v[104:107], v[236:239]
    v_mfma_f32_16x16x32_bf16 v[240:243], v[112:115], v[108:111], v[240:243]
    v_mfma_f32_16x16x32_bf16 v[244:247], v[116:119], v[108:111], v[244:247]
    v_mfma_f32_16x16x32_bf16 v[248:251], v[120:123], v[108:111], v[248:251]
    v_mfma_f32_16x16x32_bf16 v[252:255], v[124:127], v[108:111], v[252:255]
    s_waitcnt lgkmcnt(0)
    s_waitcnt vmcnt(16)
    s_barrier
    v_mfma_f32_16x16x32_bf16 v[128:131], v[64:67], v[32:35], v[128:131]
    s_add_u32 m0, s21, 65536
    s_nop 0
    buffer_load_dwordx4 v1, s[4:7], s16 offen sc1 lds
    s_add_u32 s16, s16, s62
    v_mfma_f32_16x16x32_bf16 v[132:135], v[68:71], v[32:35], v[132:135]
    ds_read_b64_tr_b16 v[112:113], v12 offset:49152
    v_mfma_f32_16x16x32_bf16 v[136:139], v[72:75], v[32:35], v[136:139]
    ds_read_b64_tr_b16 v[114:115], v13 offset:49152
    v_mfma_f32_16x16x32_bf16 v[140:143], v[76:79], v[32:35], v[140:143]
    ds_read_b64_tr_b16 v[116:117], v14 offset:49152
    v_mfma_f32_16x16x32_bf16 v[144:147], v[64:67], v[36:39], v[144:147]
    s_add_u32 m0, s21, 66560
    s_nop 0
    buffer_load_dwordx4 v1, s[4:7], s17 offen sc1 lds
    s_add_u32 s17, s17, s62
    v_mfma_f32_16x16x32_bf16 v[148:151], v[68:71], v[36:39], v[148:151]
    ds_read_b64_tr_b16 v[118:119], v15 offset:49152
    v_mfma_f32_16x16x32_bf16 v[152:155], v[72:75], v[36:39], v[152:155]
    ds_read_b64_tr_b16 v[120:121], v12 offset:57344
    v_mfma_f32_16x16x32_bf16 v[156:159], v[76:79], v[36:39], v[156:159]
    ds_read_b64_tr_b16 v[122:123], v13 offset:57344
    v_mfma_f32_16x16x32_bf16 v[160:163], v[64:67], v[40:43], v[160:163]
    s_add_u32 m0, s22, 65536
    s_nop 0
    buffer_load_dwordx4 v2, s[8:11], s18 offen lds
    s_add_u32 s18, s18, s20
    v_mfma_f32_16x16x32_bf16 v[164:167], v[68:71], v[40:43], v[164:167]
    ds_read_b64_tr_b16 v[124:125], v14 offset:57344
    v_mfma_f32_16x16x32_bf16 v[168:171], v[72:75], v[40:43], v[168:171]
    ds_read_b64_tr_b16 v[126:127], v15 offset:57344
    v_mfma_f32_16x16x32_bf16 v[172:175], v[76:79], v[40:43], v[172:175]
    ds_read_b128 v[80:83], v6 offset:32768
    v_mfma_f32_16x16x32_bf16 v[176:179], v[64:67], v[44:47], v[176:179]
    s_add_u32 m0, s22, 73728
    s_nop 0
    buffer_load_dwordx4 v2, s[12:15], s19 offen lds
    s_add_u32 s19, s19, s20
    v_mfma_f32_16x16x32_bf16 v[180:183], v[68:71], v[44:47], v[180:183]
    ds_read_b128 v[84:87], v6 offset:33792
    v_mfma_f32_16x16x32_bf16 v[184:187], v[72:75], v[44:47], v[184:187]
    ds_read_b128 v[88:91], v6 offset:34816
    v_mfma_f32_16x16x32_bf16 v[188:191], v[76:79], v[44:47], v[188:191]
    ds_read_b128 v[92:95], v6 offset:35840
    v_mfma_f32_16x16x32_bf16 v[192:195], v[64:67], v[48:51], v[192:195]
    ds_read_b128 v[96:99], v6 offset:36864
    v_mfma_f32_16x16x32_bf16 v[196:199], v[68:71], v[48:51], v[196:199]
    ds_read_b128 v[100:103], v6 offset:37888
    v_mfma_f32_16x16x32_bf16 v[200:203], v[72:75], v[48:51], v[200:203]
    ds_read_b128 v[104:107], v6 offset:38912
    v_mfma_f32_16x16x32_bf16 v[204:207], v[76:79], v[48:51], v[204:207]
    ds_read_b128 v[108:111], v6 offset:39936
    v_mfma_f32_16x16x32_bf16 v[208:211], v[64:67], v[52:55], v[208:211]
    v_mfma_f32_16x16x32_bf16 v[212:215], v[68:71], v[52:55], v[212:215]
    v_mfma_f32_16x16x32_bf16 v[216:219], v[72:75], v[52:55], v[216:219]
    v_mfma_f32_16x16x32_bf16 v[220:223], v[76:79], v[52:55], v[220:223]
    v_mfma_f32_16x16x32_bf16 v[224:227], v[64:67], v[56:59], v[224:227]
    v_mfma_f32_16x16x32_bf16 v[228:231], v[68:71], v[56:59], v[228:231]
    v_mfma_f32_16x16x32_bf16 v[232:235], v[72:75], v[56:59], v[232:235]
    v_mfma_f32_16x16x32_bf16 v[236:239], v[76:79], v[56:59], v[236:239]
    v_mfma_f32_16x16x32_bf16 v[240:243], v[64:67], v[60:63], v[240:243]
    v_mfma_f32_16x16x32_bf16 v[244:247], v[68:71], v[60:63], v[244:247]
    v_mfma_f32_16x16x32_bf16 v[248:251], v[72:75], v[60:63], v[248:251]
    v_mfma_f32_16x16x32_bf16 v[252:255], v[76:79], v[60:63], v[252:255]
    s_waitcnt lgkmcnt(0)
    s_waitcnt vmcnt(8)
    s_barrier
    s_cmp_eq_u32 s28, 0
    s_cbranch_scc1 sig_4
    s_cmp_lg_u32 s3, 0
    s_cbranch_scc1 sig_4
    s_and_b32 s57, s28, 3
    v_mov_b32 v24, s57
    s_bfe_u32 s57, s28, 0x20002
    v_mov_b32 v25, s57
    s_andn2_b32 s28, s28, 15
    s_mov_b64 exec, 1
    buffer_atomic_add_x2 v[24:25], v17, s[4:7], s28 offen sc1
    s_mov_b64 exec, -1
sig_4:
    s_mov_b32 s28, 0
    v_mfma_f32_16x16x32_bf16 v[128:131], v[112:115], v[80:83], v[128:131]
    s_add_u32 m0, s21, 98304
    s_nop 0
    buffer_load_dwordx4 v1, s[4:7], s16 offen sc1 lds
    s_add_u32 s16, s16, s62
    v_mfma_f32_16x16x32_bf16 v[132:135], v[116:119], v[80:83], v[132:135]
    ds_read_b64_tr_b16 v[64:65], v8 offset:16384
    v_mfma_f32_16x16x32_bf16 v[136:139], v[120:123], v[80:83], v[136:139]
    ds_read_b64_tr_b16 v[66:67], v9 offset:16384
    v_mfma_f32_16x16x32_bf16 v[140:143], v[124:127], v[80:83], v[140:143]
    ds_read_b64_tr_b16 v[68:69], v10 offset:16384
    v_mfma_f32_16x16x32_bf16 v[144:147], v[112:115], v[84:87], v[144:147]
    s_add_u32 m0, s21, 99328
    s_nop 0
    buffer_load_dwordx4 v1, s[4:7], s17 offen sc1 lds
    s_add_u32 s17, s17, s62
    v_mfma_f32_16x16x32_bf16 v[148:151], v[116:119], v[84:87], v[148:151]
    ds_read_b64_tr_b16 v[70:71], v11 offset:16384
    v_mfma_f32_16x16x32_bf16 v[152:155], v[120:123], v[84:87], v[152:155]
    ds_read_b64_tr_b16 v[72:73], v8 offset:24576
    v_mfma_f32_16x16x32_bf16 v[156:159], v[124:127], v[84:87], v[156:159]
    ds_read_b64_tr_b16 v[74:75], v9 offset:24576
    v_mfma_f32_16x16x32_bf16 v[160:163], v[112:115], v[88:91], v[160:163]
    s_add_u32 m0, s22, 98304
    s_nop 0
    buffer_load_dwordx4 v2, s[8:11], s18 offen lds
    s_add_u32 s18, s18, s20
    v_mfma_f32_16x16x32_bf16 v[164:167], v[116:119], v[88:91], v[164:167]
    ds_read_b64_tr_b16 v[76:77], v10 offset:24576
    v_mfma_f32_16x16x32_bf16 v[168:171], v[120:123], v[88:91], v[168:171]
    ds_read_b64_tr_b16 v[78:79], v11 offset:24576
    v_mfma_f32_16x16x32_bf16 v[172:175], v[124:127], v[88:91], v[172:175]
    ds_read_b128 v[32:35], v5 offset:0
    v_mfma_f32_16x16x32_bf16 v[176:179], v[112:115], v[92:95], v[176:179]
    s_add_u32 m0, s22, 106496
    s_nop 0
    buffer_load_dwordx4 v2, s[12:15], s19 offen lds
    s_add_u32 s19, s19, s20
    v_mfma_f32_16x16x32_bf16 v[180:183], v[116:119], v[92:95], v[180:183]
    ds_read_b128 v[36:39], v5 offset:1024
    v_mfma_f32_16x16x32_bf16 v[184:187], v[120:123], v[92:95], v[184:187]
    ds_read_b128 v[40:43], v5 offset:2048
    v_mfma_f32_16x16x32_bf16 v[188:191], v[124:127], v[92:95], v[188:191]
    ds_read_b128 v[44:47], v5 offset:3072
    v_mfma_f32_16x16x32_bf16 v[192:195], v[112:115], v[96:99], v[192:195]
    ds_read_b128 v[48:51], v5 offset:4096
    v_mfma_f32_16x16x32_bf16 v[196:199], v[116:119], v[96:99], v[196:199]
    ds_read_b128 v[52:55], v5 offset:5120
    v_mfma_f32_16x16x32_bf16 v[200:203], v[120:123], v[96:99], v[200:203]
    ds_read_b128 v[56:59], v5 offset:6144
    v_mfma_f32_16x16x32_bf16 v[204:207], v[124:127], v[96:99], v[204:207]
    ds_read_b128 v[60:63], v5 offset:7168
    v_mfma_f32_16x16x32_bf16 v[208:211], v[112:115], v[100:103], v[208:211]
    v_mfma_f32_16x16x32_bf16 v[212:215], v[116:119], v[100:103], v[212:215]
    v_mfma_f32_16x16x32_bf16 v[216:219], v[120:123], v[100:103], v[216:219]
    v_mfma_f32_16x16x32_bf16 v[220:223], v[124:127], v[100:103], v[220:223]
    v_mfma_f32_16x16x32_bf16 v[224:227], v[112:115], v[104:107], v[224:227]
    v_mfma_f32_16x16x32_bf16 v[228:231], v[116:119], v[104:107], v[228:231]
    v_mfma_f32_16x16x32_bf16 v[232:235], v[120:123], v[104:107], v[232:235]
    v_mfma_f32_16x16x32_bf16 v[236:239], v[124:127], v[104:107], v[236:239]
    v_mfma_f32_16x16x32_bf16 v[240:243], v[112:115], v[108:111], v[240:243]
    v_mfma_f32_16x16x32_bf16 v[244:247], v[116:119], v[108:111], v[244:247]
    v_mfma_f32_16x16x32_bf16 v[248:251], v[120:123], v[108:111], v[248:251]
    v_mfma_f32_16x16x32_bf16 v[252:255], v[124:127], v[108:111], v[252:255]
    s_waitcnt lgkmcnt(0)
    s_branch w_loop_chk
w_first16:
    s_waitcnt vmcnt(24)
    s_barrier
    v_mfma_f32_16x16x32_bf16 v[128:131], v[64:67], v[32:35], 0
    s_add_u32 m0, s21, 0
    s_nop 0
    buffer_load_dwordx4 v1, s[4:7], s16 offen sc1 lds
    s_add_u32 s16, s16, s62
    v_mfma_f32_16x16x32_bf16 v[132:135], v[68:71], v[32:35], 0
    ds_read_b64_tr_b16 v[112:113], v8 offset:49152
    v_mfma_f32_16x16x32_bf16 v[136:139], v[72:75], v[32:35], 0
    ds_read_b64_tr_b16 v[114:115], v9 offset:49152
    v_mfma_f32_16x16x32_bf16 v[140:143], v[76:79], v[32:35], 0
    ds_read_b64_tr_b16 v[116:117], v10 offset:49152
    v_mfma_f32_16x16x32_bf16 v[144:147], v[64:67], v[36:39], 0
    s_add_u32 m0, s21, 1024
    s_nop 0
    buffer_load_dwordx4 v1, s[4:7], s17 offen sc1 lds
    s_add_u32 s17, s17, s62
    v_mfma_f32_16x16x32_bf16 v[148:151], v[68:71], v[36:39], 0
    ds_read_b64_tr_b16 v[118:119], v11 offset:49152
    v_mfma_f32_16x16x32_bf16 v[152:155], v[72:75], v[36:39], 0
    ds_read_b64_tr_b16 v[120:121], v8 offset:57344
    v_mfma_f32_16x16x32_bf16 v[156:159], v[76:79], v[36:39], 0
    ds_read_b64_tr_b16 v[122:123], v9 offset:57344
    v_mfma_f32_16x16x32_bf16 v[160:163], v[64:67], v[40:43], 0
    s_add_u32 m0, s22, 0
    s_nop 0
    buffer_load_dwordx4 v2, s[8:11], s18 offen lds
    s_add_u32 s18, s18, s20
    v_mfma_f32_16x16x32_bf16 v[164:167], v[68:71], v[40:43], 0
    ds_read_b64_tr_b16 v[124:125], v10 offset:57344
    v_mfma_f32_16x16x32_bf16 v[168:171], v[72:75], v[40:43], 0
    ds_read_b64_tr_b16 v[126:127], v11 offset:57344
    v_mfma_f32_16x16x32_bf16 v[172:175], v[76:79], v[40:43], 0
    ds_read_b128 v[80:83], v5 offset:32768
    v_mfma_f32_16x16x32_bf16 v[176:179], v[64:67], v[44:47], 0
    s_add_u32 m0, s22, 8192
    s_nop 0
    buffer_load_dwordx4 v2, s[12:15], s19 offen lds
    s_add_u32 s19, s19, s20
    v_mfma_f32_16x16x32_bf16 v[180:183], v[68:71], v[44:47], 0
    ds_read_b128 v[84:87], v5 offset:33792
    v_mfma_f32_16x16x32_bf16 v[184:187], v[72:75], v[44:47], 0
    ds_read_b128 v[88:91], v5 offset:34816
    v_mfma_f32_16x16x32_bf16 v[188:191], v[76:79], v[44:47], 0
    ds_read_b128 v[92:95], v5 offset:35840
    v_mfma_f32_16x16x32_bf16 v[192:195], v[64:67], v[48:51], 0
    ds_read_b128 v[96:99], v5 offset:36864
    v_mfma_f32_16x16x32_bf16 v[196:199], v[68:71], v[48:51], 0
    ds_read_b128 v[100:103], v5 offset:37888
    v_mfma_f32_16x16x32_bf16 v[200:203], v[72:75], v[48:51], 0
    ds_read_b128 v[104:107], v5 offset:38912
    v_mfma_f32_16x16x32_bf16 v[204:207], v[76:79], v[48:51], 0
    ds_read_b128 v[108:111], v5 offset:39936
    v_mfma_f32_16x16x32_bf16 v[208:211], v[64:67], v[52:55], 0
    v_mfma_f32_16x16x32_bf16 v[212:215], v[68:71], v[52:55], 0
    v_mfma_f32_16x16x32_bf16 v[216:219], v[72:75], v[52:55], 0
    v_mfma_f32_16x16x32_bf16 v[220:223], v[76:79], v[52:55], 0
    v_mfma_f32_16x16x32_bf16 v[224:227], v[64:67], v[56:59], 0
    v_mfma_f32_16x16x32_bf16 v[228:231], v[68:71], v[56:59], 0
    v_mfma_f32_16x16x32_bf16 v[232:235], v[72:75], v[56:59], 0
    v_mfma_f32_16x16x32_bf16 v[236:239], v[76:79], v[56:59], 0
    v_mfma_f32_16x16x32_bf16 v[240:243], v[64:67], v[60:63], 0
    v_mfma_f32_16x16x32_bf16 v[244:247], v[68:71], v[60:63], 0
    v_mfma_f32_16x16x32_bf16 v[248:251], v[72:75], v[60:63], 0
    v_mfma_f32_16x16x32_bf16 v[252:255], v[76:79], v[60:63], 0
    s_waitcnt lgkmcnt(0)
w_first16_q1:
    s_waitcnt vmcnt(24)
    s_barrier
    v_mfma_f32_16x16x32_bf16 v[128:131], v[112:115], v[80:83], v[128:131]
    s_add_u32 m0, s21, 32768
    s_nop 0
    buffer_load_dwordx4 v1, s[4:7], s16 offen sc1 lds
    s_add_u32 s16, s16, s62
    v_mfma_f32_16x16x32_bf16 v[132:135], v[116:119], v[80:83], v[132:135]
    ds_read_b64_tr_b16 v[64:65], v12 offset:16384
    v_mfma_f32_16x16x32_bf16 v[136:139], v[120:123], v[80:83], v[136:139]
    ds_read_b64_tr_b16 v[66:67], v13 offset:16384
    v_mfma_f32_16x16x32_bf16 v[140:143], v[124:127], v[80:83], v[140:143]
    ds_read_b64_tr_b16 v[68:69], v14 offset:16384
    v_mfma_f32_16x16x32_bf16 v[144:147], v[112:115], v[84:87], v[144:147]
    s_add_u32 m0, s21, 33792
    s_nop 0
    buffer_load_dwordx4 v1, s[4:7], s17 offen sc1 lds
    s_add_u32 s17, s17, s62
    v_mfma_f32_16x16x32_bf16 v[148:151], v[116:119], v[84:87], v[148:151]
    ds_read_b64_tr_b16 v[70:71], v15 offset:16384
    v_mfma_f32_16x16x32_bf16 v[152:155], v[120:123], v[84:87], v[152:155]
    ds_read_b64_tr_b16 v[72:73], v12 offset:24576
    v_mfma_f32_16x16x32_bf16 v[156:159], v[124:127], v[84:87], v[156:159]
    ds_read_b64_tr_b16 v[74:75], v13 offset:24576
    v_mfma_f32_16x16x32_bf16 v[160:163], v[112:115], v[88:91], v[160:163]
    s_add_u32 m0, s22, 32768
    s_nop 0
    buffer_load_dwordx4 v2, s[8:11], s18 offen lds
    s_add_u32 s18, s18, s20
    v_mfma_f32_16x16x32_bf16 v[164:167], v[116:119], v[88:91], v[164:167]
    ds_read_b64_tr_b16 v[76:77], v14 offset:24576
    v_mfma_f32_16x16x32_bf16 v[168:171], v[120:123], v[88:91], v[168:171]
    ds_read_b64_tr_b16 v[78:79], v15 offset:24576
    v_mfma_f32_16x16x32_bf16 v[172:175], v[124:127], v[88:91], v[172:175]
    ds_read_b128 v[32:35], v6 offset:0
    v_mfma_f32_16x16x32_bf16 v[176:179], v[112:115], v[92:95], v[176:179]
    s_add_u32 m0, s22, 40960
    s_nop 0
    buffer_load_dwordx4 v2, s[12:15], s19 offen lds
    s_add_u32 s19, s19, s20
    v_mfma_f32_16x16x32_bf16 v[180:183], v[116:119], v[92:95], v[180:183]
    ds_read_b128 v[36:39], v6 offset:1024
    v_mfma_f32_16x16x32_bf16 v[184:187], v[120:123], v[92:95], v[184:187]
    ds_read_b128 v[40:43], v6 offset:2048
    v_mfma_f32_16x16x32_bf16 v[188:191], v[124:127], v[92:95], v[188:191]
    ds_read_b128 v[44:47], v6 offset:3072
    v_mfma_f32_16x16x32_bf16 v[192:195], v[112:115], v[96:99], v[192:195]
    ds_read_b128 v[48:51], v6 offset:4096
    v_mfma_f32_16x16x32_bf16 v[196:199], v[116:119], v[96:99], v[196:199]
    ds_read_b128 v[52:55], v6 offset:5120
    v_mfma_f32_16x16x32_bf16 v[200:203], v[120:123], v[96:99], v[200:203]
    ds_read_b128 v[56:59], v6 offset:6144
    v_mfma_f32_16x16x32_bf16 v[204:207], v[124:127], v[96:99], v[204:207]
    ds_read_b128 v[60:63], v6 offset:7168
    v_mfma_f32_16x16x32_bf16 v[208:211], v[112:115], v[100:103], v[208:211]
    v_mfma_f32_16x16x32_bf16 v[212:215], v[116:119], v[100:103], v[212:215]
    v_mfma_f32_16x16x32_bf16 v[216:219], v[120:123], v[100:103], v[216:219]
    v_mfma_f32_16x16x32_bf16 v[220:223], v[124:127], v[100:103], v[220:223]
    v_mfma_f32_16x16x32_bf16 v[224:227], v[112:115], v[104:107], v[224:227]
    v_mfma_f32_16x16x32_bf16 v[228:231], v[116:119], v[104:107], v[228:231]
    v_mfma_f32_16x16x32_bf16 v[232:235], v[120:123], v[104:107], v[232:235]
    v_mfma_f32_16x16x32_bf16 v[236:239], v[124:127], v[104:107], v[236:239]
    v_mfma_f32_16x16x32_bf16 v[240:243], v[112:115], v[108:111], v[240:243]
    v_mfma_f32_16x16x32_bf16 v[244:247], v[116:119], v[108:111], v[244:247]
    v_mfma_f32_16x16x32_bf16 v[248:251], v[120:123], v[108:111], v[248:251]
    v_mfma_f32_16x16x32_bf16 v[252:255], v[124:127], v[108:111], v[252:255]
    s_waitcnt lgkmcnt(0)
    s_waitcnt vmcnt(24)
    s_barrier
    v_mfma_f32_16x16x32_bf16 v[128:131], v[64:67], v[32:35], v[128:131]
    s_add_u32 m0, s21, 65536
    s_nop 0
    buffer_load_dwordx4 v1, s[4:7], s16 offen sc1 lds
    s_add_u32 s16, s16, s62
    v_mfma_f32_16x16x32_bf16 v[132:135], v[68:71], v[32:35], v[132:135]
    ds_read_b64_tr_b16 v[112:113], v12 offset:49152
    v_mfma_f32_16x16x32_bf16 v[136:139], v[72:75], v[32:35], v[136:139]
    ds_read_b64_tr_b16 v[114:115], v13 offset:49152
    v_mfma_f32_16x16x32_bf16 v[140:143], v[76:79], v[32:35], v[140:143]
    ds_read_b64_tr_b16 v[116:117], v14 offset:49152
    v_mfma_f32_16x16x32_bf16 v[144:147], v[64:67], v[36:39], v[144:147]
    s_add_u32 m0, s21, 66560
    s_nop 0
    buffer_load_dwordx4 v1, s[4:7], s17 offen sc1 lds
    s_add_u32 s17, s17, s62
    v_mfma_f32_16x16x32_bf16 v[148:151], v[68:71], v[36:39], v[148:151]
    ds_read_b64_tr_b16 v[118:119], v15 offset:49152
    v_mfma_f32_16x16x32_bf16 v[152:155], v[72:75], v[36:39], v[152:155]
    ds_read_b64_tr_b16 v[120:121], v12 offset:57344
    v_mfma_f32_16x16x32_bf16 v[156:159], v[76:79], v[36:39], v[156:159]
    ds_read_b64_tr_b16 v[122:123], v13 offset:57344
    v_mfma_f32_16x16x32_bf16 v[160:163], v[64:67], v[40:43], v[160:163]
    s_add_u32 m0, s22, 65536
    s_nop 0
    buffer_load_dwordx4 v2, s[8:11], s18 offen lds
    s_add_u32 s18, s18, s20
    v_mfma_f32_16x16x32_bf16 v[164:167], v[68:71], v[40:43], v[164:167]
    ds_read_b64_tr_b16 v[124:125], v14 offset:57344
    v_mfma_f32_16x16x32_bf16 v[168:171], v[72:75], v[40:43], v[168:171]
    ds_read_b64_tr_b16 v[126:127], v15 offset:57344
    v_mfma_f32_16x16x32_bf16 v[172:175], v[76:79], v[40:43], v[172:175]
    ds_read_b128 v[80:83], v6 offset:32768
    v_mfma_f32_16x16x32_bf16 v[176:179], v[64:67], v[44:47], v[176:179]
    s_add_u32 m0, s22, 73728
    s_nop 0
    buffer_load_dwordx4 v2, s[12:15], s19 offen lds
    s_add_u32 s19, s19, s20
    v_mfma_f32_16x16x32_bf16 v[180:183], v[68:71], v[44:47], v[180:183]
    ds_read_b128 v[84:87], v6 offset:33792
    v_mfma_f32_16x16x32_bf16 v[184:187], v[72:75], v[44:47], v[184:187]
    ds_read_b128 v[88:91], v6 offset:34816
    v_mfma_f32_16x16x32_bf16 v[188:191], v[76:79], v[44:47], v[188:191]
    ds_read_b128 v[92:95], v6 offset:35840
    v_mfma_f32_16x16x32_bf16 v[192:195], v[64:67], v[48:51], v[192:195]
    ds_read_b128 v[96:99], v6 offset:36864
    v_mfma_f32_16x16x32_bf16 v[196:199], v[68:71], v[48:51], v[196:199]
    ds_read_b128 v[100:103], v6 offset:37888
    v_mfma_f32_16x16x32_bf16 v[200:203], v[72:75], v[48:51], v[200:203]
    ds_read_b128 v[104:107], v6 offset:38912
    v_mfma_f32_16x16x32_bf16 v[204:207], v[76:79], v[48:51], v[204:207]
    ds_read_b128 v[108:111], v6 offset:39936
    v_mfma_f32_16x16x32_bf16 v[208:211], v[64:67], v[52:55], v[208:211]
    v_mfma_f32_16x16x32_bf16 v[212:215], v[68:71], v[52:55], v[212:215]
    v_mfma_f32_16x16x32_bf16 v[216:219], v[72:75], v[52:55], v[216:219]
    v_mfma_f32_16x16x32_bf16 v[220:223], v[76:79], v[52:55], v[220:223]
    v_mfma_f32_16x16x32_bf16 v[224:227], v[64:67], v[56:59], v[224:227]
    v_mfma_f32_16x16x32_bf16 v[228:231], v[68:71], v[56:59], v[228:231]
    v_mfma_f32_16x16x32_bf16 v[232:235], v[72:75], v[56:59], v[232:235]
    v_mfma_f32_16x16x32_bf16 v[236:239], v[76:79], v[56:59], v[236:239]
    v_mfma_f32_16x16x32_bf16 v[240:243], v[64:67], v[60:63], v[240:243]
    v_mfma_f32_16x16x32_bf16 v[244:247], v[68:71], v[60:63], v[244:247]
    v_mfma_f32_16x16x32_bf16 v[248:251], v[72:75], v[60:63], v[248:251]
    v_mfma_f32_16x16x32_bf16 v[252:255], v[76:79], v[60:63], v[252:255]
    s_waitcnt lgkmcnt(0)
    s_waitcnt vmcnt(8)
    s_barrier
    s_cmp_eq_u32 s28, 0
    s_cbranch_scc1 sig_5
    s_cmp_lg_u32 s3, 0
    s_cbranch_scc1 sig_5
    s_and_b32 s57, s28, 3
    v_mov_b32 v24, s57
    s_bfe_u32 s57, s28, 0x20002
    v_mov_b32 v25, s57
    s_andn2_b32 s28, s28, 15
    s_mov_b64 exec, 1
    buffer_atomic_add_x2 v[24:25], v17, s[4:7], s28 offen sc1
    s_mov_b64 exec, -1
sig_5:
    s_mov_b32 s28, 0
    v_mfma_f32_16x16x32_bf16 v[128:131], v[112:115], v[80:83], v[128:131]
    s_add_u32 m0, s21, 98304
    s_nop 0
    buffer_load_dwordx4 v1, s[4:7], s16 offen sc1 lds
    s_add_u32 s16, s16, s62
    v_mfma_f32_16x16x32_bf16 v[132:135], v[116:119], v[80:83], v[132:135]
    ds_read_b64_tr_b16 v[64:65], v8 offset:16384
    v_mfma_f32_16x16x32_bf16 v[136:139], v[120:123], v[80:83], v[136:139]
    ds_read_b64_tr_b16 v[66:67], v9 offset:16384
    v_mfma_f32_16x16x32_bf16 v[140:143], v[124:127], v[80:83], v[140:143]
    ds_read_b64_tr_b16 v[68:69], v10 offset:16384
    v_mfma_f32_16x16x32_bf16 v[144:147], v[112:115], v[84:87], v[144:147]
    s_add_u32 m0, s21, 99328
    s_nop 0
    buffer_load_dwordx4 v1, s[4:7], s17 offen sc1 lds
    s_add_u32 s17, s17, s62
    v_mfma_f32_16x16x32_bf16 v[148:151], v[116:119], v[84:87], v[148:151]
    ds_read_b64_tr_b16 v[70:71], v11 offset:16384
    v_mfma_f32_16x16x32_bf16 v[152:155], v[120:123], v[84:87], v[152:155]
    ds_read_b64_tr_b16 v[72:73], v8 offset:24576
    v_mfma_f32_16x16x32_bf16 v[156:159], v[124:127], v[84:87], v[156:159]
    ds_read_b64_tr_b16 v[74:75], v9 offset:24576
    v_mfma_f32_16x16x32_bf16 v[160:163], v[112:115], v[88:91], v[160:163]
    s_add_u32 m0, s22, 98304
    s_nop 0
    buffer_load_dwordx4 v2, s[8:11], s18 offen lds
    s_add_u32 s18, s18, s20
    v_mfma_f32_16x16x32_bf16 v[164:167], v[116:119], v[88:91], v[164:167]
    ds_read_b64_tr_b16 v[76:77], v10 offset:24576
    v_mfma_f32_16x16x32_bf16 v[168:171], v[120:123], v[88:91], v[168:171]
    ds_read_b64_tr_b16 v[78:79], v11 offset:24576
    v_mfma_f32_16x16x32_bf16 v[172:175], v[124:127], v[88:91], v[172:175]
    ds_read_b128 v[32:35], v5 offset:0
    v_mfma_f32_16x16x32_bf16 v[176:179], v[112:115], v[92:95], v[176:179]
    s_add_u32 m0, s22, 106496
    s_nop 0
    buffer_load_dwordx4 v2, s[12:15], s19 offen lds
    s_add_u32 s19, s19, s20
    v_mfma_f32_16x16x32_bf16 v[180:183], v[116:119], v[92:95], v[180:183]
    ds_read_b128 v[36:39], v5 offset:1024
    v_mfma_f32_16x16x32_bf16 v[184:187], v[120:123], v[92:95], v[184:187]
    ds_read_b128 v[40:43], v5 offset:2048
    v_mfma_f32_16x16x32_bf16 v[188:191], v[124:127], v[92:95], v[188:191]
    ds_read_b128 v[44:47], v5 offset:3072
    v_mfma_f32_16x16x32_bf16 v[192:195], v[112:115], v[96:99], v[192:195]
    ds_read_b128 v[48:51], v5 offset:4096
    v_mfma_f32_16x16x32_bf16 v[196:199], v[116:119], v[96:99], v[196:199]
    ds_read_b128 v[52:55], v5 offset:5120
    v_mfma_f32_16x16x32_bf16 v[200:203], v[120:123], v[96:99], v[200:203]
    ds_read_b128 v[56:59], v5 offset:6144
    v_mfma_f32_16x16x32_bf16 v[204:207], v[124:127], v[96:99], v[204:207]
    ds_read_b128 v[60:63], v5 offset:7168
    v_mfma_f32_16x16x32_bf16 v[208:211], v[112:115], v[100:103], v[208:211]
    v_mfma_f32_16x16x32_bf16 v[212:215], v[116:119], v[100:103], v[212:215]
    v_mfma_f32_16x16x32_bf16 v[216:219], v[120:123], v[100:103], v[216:219]
    v_mfma_f32_16x16x32_bf16 v[220:223], v[124:127], v[100:103], v[220:223]
    v_mfma_f32_16x16x32_bf16 v[224:227], v[112:115], v[104:107], v[224:227]
    v_mfma_f32_16x16x32_bf16 v[228:231], v[116:119], v[104:107], v[228:231]
    v_mfma_f32_16x16x32_bf16 v[232:235], v[120:123], v[104:107], v[232:235]
    v_mfma_f32_16x16x32_bf16 v[236:239], v[124:127], v[104:107], v[236:239]
    v_mfma_f32_16x16x32_bf16 v[240:243], v[112:115], v[108:111], v[240:243]
    v_mfma_f32_16x16x32_bf16 v[244:247], v[116:119], v[108:111], v[244:247]
    v_mfma_f32_16x16x32_bf16 v[248:251], v[120:123], v[108:111], v[248:251]
    v_mfma_f32_16x16x32_bf16 v[252:255], v[124:127], v[108:111], v[252:255]
    s_waitcnt lgkmcnt(0)
w_loop_chk:
    s_sub_u32 s23, s23, 1
w_loop:
    s_cmp_gt_u32 s23, 3
    s_cbranch_scc1 w_body
    s_cmp_lg_u32 s23, 3
    s_cbranch_scc1 w_l2
    s_cmp_lg_u32 s3, 0
    s_cbranch_scc1 clm_6
    v_mov_b32 v26, 1
    s_mov_b64 exec, 1
    buffer_atomic_add v26, off, s[64:67], s71 sc0 sc1
    s_mov_b64 exec, -1
clm_6:
    s_branch w_body
w_l2:
    s_cmp_lg_u32 s23, 2
    s_cbranch_scc1 w_l1
    s_cmp_lg_u32 s3, 0
    s_cbranch_scc1 pub_7
    v_mov_b32 v20, 131136
    s_mov_b64 exec, 1
    ds_write_b32 v20, v26
    s_mov_b64 exec, -1
    s_waitcnt lgkmcnt(0)
pub_7:
    s_branch w_body
w_l1:
    s_waitcnt vmcnt(8)
    v_readfirstlane_b32 s30, v16
    s_cmp_ge_u32 s30, s45
    s_cselect_b32 s30, 0, 1
    s_cmp_lg_u32 s3, 0
    s_cselect_b32 s30, 0, s30
    s_or_b32 s30, s30, s70
    s_cmp_eq_u32 s32, 4
    s_cselect_b32 s30, 1, s30
    s_sub_u32 s57, s32, 1
    s_cmp_ge_u32 s57, 4
    s_cselect_b32 s30, 1, s30
    v_mov_b32 v20, s30
    ds_write_b32 v7, v20
    s_cbranch_scc1 w_body
    s_load_dwordx2 s[8:9], s[0:1], s33
    s_load_dwordx2 s[12:13], s[0:1], s34
    s_mov_b32 s10, s38
    s_mov_b32 s14, s38
    s_cmp_eq_u32 s32, 4
    s_cselect_b32 s31, 0, 1
    s_lshl_b32 s30, s3, s31
    s_mul_i32 s30, s30, s40
    s_add_u32 s16, s39, s30
    s_cmp_eq_u32 s32, 4
    s_cselect_b32 s30, 1024, s40
    s_cselect_b32 s31, 6, 5
    s_lshl_b32 s62, 32, s31
    s_add_u32 s17, s16, s30
    s_lshl_b32 s30, s3, 2
    s_mul_i32 s30, s30, s35
    s_add_u32 s18, s36, s30
    s_add_u32 s19, s37, s30
    s_lshl_b32 s20, s35, s31
    v_mul_u32_u24 v2, s35, v4
    v_add_u32 v2, v2, v3
    s_waitcnt lgkmcnt(0)
w_body:
    s_waitcnt vmcnt(8)
    s_barrier
    s_cmp_lg_u32 s23, 2
    s_cbranch_scc1 w_nf
    v_mov_b32 v20, 131136
    ds_read_b32 v20, v20
    s_waitcnt lgkmcnt(0)
    v_readfirstlane_b32 s59, v20
    s_add_u32 s59, s59, 32
    s_min_u32 s59, s59, 322
    s_lshl_b32 s57, s59, 6
    s_load_dwordx16 s[32:47], s[24:25], s57
w_nf:
    v_mfma_f32_16x16x32_bf16 v[128:131], v[64:67], v[32:35], v[128:131]
    s_add_u32 m0, s21, 0
    s_nop 0
    buffer_load_dwordx4 v1, s[4:7], s16 offen sc1 lds
    s_add_u32 s16, s16, s62
    v_mfma_f32_16x16x32_bf16 v[132:135], v[68:71], v[32:35], v[132:135]
    ds_read_b64_tr_b16 v[112:113], v8 offset:49152
    v_mfma_f32_16x16x32_bf16 v[136:139], v[72:75], v[32:35], v[136:139]
    ds_read_b64_tr_b16 v[114:115], v9 offset:49152
    v_mfma_f32_16x16x32_bf16 v[140:143], v[76:79], v[32:35], v[140:143]
    ds_read_b64_tr_b16 v[116:117], v10 offset:49152
    v_mfma_f32_16x16x32_bf16 v[144:147], v[64:67], v[36:39], v[144:147]
    s_add_u32 m0, s21, 1024
    s_nop 0
    buffer_load_dwordx4 v1, s[4:7], s17 offen sc1 lds
    s_add_u32 s17, s17, s62
    v_mfma_f32_16x16x32_bf16 v[148:151], v[68:71], v[36:39], v[148:151]
    ds_read_b64_tr_b16 v[118:119], v11 offset:49152
    v_mfma_f32_16x16x32_bf16 v[152:155], v[72:75], v[36:39], v[152:155]
    ds_read_b64_tr_b16 v[120:121], v8 offset:57344
    v_mfma_f32_16x16x32_bf16 v[156:159], v[76:79], v[36:39], v[156:159]
    ds_read_b64_tr_b16 v[122:123], v9 offset:57344
    v_mfma_f32_16x16x32_bf16 v[160:163], v[64:67], v[40:43], v[160:163]
    s_add_u32 m0, s22, 0
    s_nop 0
    buffer_load_dwordx4 v2, s[8:11], s18 offen lds
    s_add_u32 s18, s18, s20
    v_mfma_f32_16x16x32_bf16 v[164:167], v[68:71], v[40:43], v[164:167]
    ds_read_b64_tr_b16 v[124:125], v10 offset:57344
    v_mfma_f32_16x16x32_bf16 v[168:171], v[72:75], v[40:43], v[168:171]
    ds_read_b64_tr_b16 v[126:127], v11 offset:57344
    v_mfma_f32_16x16x32_bf16 v[172:175], v[76:79], v[40:43], v[172:175]
    ds_read_b128 v[80:83], v5 offset:32768
    v_mfma_f32_16x16x32_bf16 v[176:179], v[64:67], v[44:47], v[176:179]
    s_add_u32 m0, s22, 8192
    s_nop 0
    buffer_load_dwordx4 v2, s[12:15], s19 offen lds
    s_add_u32 s19, s19, s20
    v_mfma_f32_16x16x32_bf16 v[180:183], v[68:71], v[44:47], v[180:183]
    ds_read_b128 v[84:87], v5 offset:33792
    v_mfma_f32_16x16x32_bf16 v[184:187], v[72:75], v[44:47], v[184:187]
    ds_read_b128 v[88:91], v5 offset:34816
    v_mfma_f32_16x16x32_bf16 v[188:191], v[76:79], v[44:47], v[188:191]
    ds_read_b128 v[92:95], v5 offset:35840
    v_mfma_f32_16x16x32_bf16 v[192:195], v[64:67], v[48:51], v[192:195]
    ds_read_b128 v[96:99], v5 offset:36864
    v_mfma_f32_16x16x32_bf16 v[196:199], v[68:71], v[48:51], v[196:199]
    ds_read_b128 v[100:103], v5 offset:37888
    v_mfma_f32_16x16x32_bf16 v[200:203], v[72:75], v[48:51], v[200:203]
    ds_read_b128 v[104:107], v5 offset:38912
    v_mfma_f32_16x16x32_bf16 v[204:207], v[76:79], v[48:51], v[204:207]
    ds_read_b128 v[108:111], v5 offset:39936
    v_mfma_f32_16x16x32_bf16 v[208:211], v[64:67], v[52:55], v[208:211]
    v_mfma_f32_16x16x32_bf16 v[212:215], v[68:71], v[52:55], v[212:215]
    v_mfma_f32_16x16x32_bf16 v[216:219], v[72:75], v[52:55], v[216:219]
    v_mfma_f32_16x16x32_bf16 v[220:223], v[76:79], v[52:55], v[220:223]
    v_mfma_f32_16x16x32_bf16 v[224:227], v[64:67], v[56:59], v[224:227]
    v_mfma_f32_16x16x32_bf16 v[228:231], v[68:71], v[56:59], v[228:231]
    v_mfma_f32_16x16x32_bf16 v[232:235], v[72:75], v[56:59], v[232:235]
    v_mfma_f32_16x16x32_bf16 v[236:239], v[76:79], v[56:59], v[236:239]
    v_mfma_f32_16x16x32_bf16 v[240:243], v[64:67], v[60:63], v[240:243]
    v_mfma_f32_16x16x32_bf16 v[244:247], v[68:71], v[60:63], v[244:247]
    v_mfma_f32_16x16x32_bf16 v[248:251], v[72:75], v[60:63], v[248:251]
    v_mfma_f32_16x16x32_bf16 v[252:255], v[76:79], v[60:63], v[252:255]
    s_waitcnt lgkmcnt(0)
    s_waitcnt vmcnt(8)
    s_barrier
    s_lshl_b32 s57, s3, 8
    s_or_b32 s57, s57, s23
    s_cmp_lg_u32 s57, 2
    s_cbranch_scc1 np_8
    buffer_load_dword v16, v17, s[4:7], s44 offen sc1
np_8:
    v_mfma_f32_16x16x32_bf16 v[128:131], v[112:115], v[80:83], v[128:131]
    s_add_u32 m0, s21, 32768
    s_nop 0
    buffer_load_dwordx4 v1, s[4:7], s16 offen sc1 lds
    s_add_u32 s16, s16, s62
    v_mfma_f32_16x16x32_bf16 v[132:135], v[116:119], v[80:83], v[132:135]
    ds_read_b64_tr_b16 v[64:65], v12 offset:16384
    v_mfma_f32_16x16x32_bf16 v[136:139], v[120:123], v[80:83], v[136:139]
    ds_read_b64_tr_b16 v[66:67], v13 offset:16384
    v_mfma_f32_16x16x32_bf16 v[140:143], v[124:127], v[80:83], v[140:143]
    ds_read_b64_tr_b16 v[68:69], v14 offset:16384
    v_mfma_f32_16x16x32_bf16 v[144:147], v[112:115], v[84:87], v[144:147]
    s_add_u32 m0, s21, 33792
    s_nop 0
    buffer_load_dwordx4 v1, s[4:7], s17 offen sc1 lds
    s_add_u32 s17, s17, s62
    v_mfma_f32_16x16x32_bf16 v[148:151], v[116:119], v[84:87], v[148:151]
    ds_read_b64_tr_b16 v[70:71], v15 offset:16384
    v_mfma_f32_16x16x32_bf16 v[152:155], v[120:123], v[84:87], v[152:155]
    ds_read_b64_tr_b16 v[72:73], v12 offset:24576
    v_mfma_f32_16x16x32_bf16 v[156:159], v[124:127], v[84:87], v[156:159]
    ds_read_b64_tr_b16 v[74:75], v13 offset:24576
    v_mfma_f32_16x16x32_bf16 v[160:163], v[112:115], v[88:91], v[160:163]
    s_add_u32 m0, s22, 32768
    s_nop 0
    buffer_load_dwordx4 v2, s[8:11], s18 offen lds
    s_add_u32 s18, s18, s20
    v_mfma_f32_16x16x32_bf16 v[164:167], v[116:119], v[88:91], v[164:167]
    ds_read_b64_tr_b16 v[76:77], v14 offset:24576
    v_mfma_f32_16x16x32_bf16 v[168:171], v[120:123], v[88:91], v[168:171]
    ds_read_b64_tr_b16 v[78:79], v15 offset:24576
    v_mfma_f32_16x16x32_bf16 v[172:175], v[124:127], v[88:91], v[172:175]
    ds_read_b128 v[32:35], v6 offset:0
    v_mfma_f32_16x16x32_bf16 v[176:179], v[112:115], v[92:95], v[176:179]
    s_add_u32 m0, s22, 40960
    s_nop 0
    buffer_load_dwordx4 v2, s[12:15], s19 offen lds
    s_add_u32 s19, s19, s20
    v_mfma_f32_16x16x32_bf16 v[180:183], v[116:119], v[92:95], v[180:183]
    ds_read_b128 v[36:39], v6 offset:1024
    v_mfma_f32_16x16x32_bf16 v[184:187], v[120:123], v[92:95], v[184:187]
    ds_read_b128 v[40:43], v6 offset:2048
    v_mfma_f32_16x16x32_bf16 v[188:191], v[124:127], v[92:95], v[188:191]
    ds_read_b128 v[44:47], v6 offset:3072
    v_mfma_f32_16x16x32_bf16 v[192:195], v[112:115], v[96:99], v[192:195]
    ds_read_b128 v[48:51], v6 offset:4096
    v_mfma_f32_16x16x32_bf16 v[196:199], v[116:119], v[96:99], v[196:199]
    ds_read_b128 v[52:55], v6 offset:5120
    v_mfma_f32_16x16x32_bf16 v[200:203], v[120:123], v[96:99], v[200:203]
    ds_read_b128 v[56:59], v6 offset:6144
    v_mfma_f32_16x16x32_bf16 v[204:207], v[124:127], v[96:99], v[204:207]
    ds_read_b128 v[60:63], v6 offset:7168
    v_mfma_f32_16x16x32_bf16 v[208:211], v[112:115], v[100:103], v[208:211]
    v_mfma_f32_16x16x32_bf16 v[212:215], v[116:119], v[100:103], v[212:215]
    v_mfma_f32_16x16x32_bf16 v[216:219], v[120:123], v[100:103], v[216:219]
    v_mfma_f32_16x16x32_bf16 v[220:223], v[124:127], v[100:103], v[220:223]
    v_mfma_f32_16x16x32_bf16 v[224:227], v[112:115], v[104:107], v[224:227]
    v_mfma_f32_16x16x32_bf16 v[228:231], v[116:119], v[104:107], v[228:231]
    v_mfma_f32_16x16x32_bf16 v[232:235], v[120:123], v[104:107], v[232:235]
    v_mfma_f32_16x16x32_bf16 v[236:239], v[124:127], v[104:107], v[236:239]
    v_mfma_f32_16x16x32_bf16 v[240:243], v[112:115], v[108:111], v[240:243]
    v_mfma_f32_16x16x32_bf16 v[244:247], v[116:119], v[108:111], v[244:247]
    v_mfma_f32_16x16x32_bf16 v[248:251], v[120:123], v[108:111], v[248:251]
    v_mfma_f32_16x16x32_bf16 v[252:255], v[124:127], v[108:111], v[252:255]
    s_waitcnt lgkmcnt(0)
    s_waitcnt vmcnt(8)
    s_barrier
    v_mfma_f32_16x16x32_bf16 v[128:131], v[64:67], v[32:35], v[128:131]
    s_add_u32 m0, s21, 65536
    s_nop 0
    buffer_load_dwordx4 v1, s[4:7], s16 offen sc1 lds
    s_add_u32 s16, s16, s62
    v_mfma_f32_16x16x32_bf16 v[132:135], v[68:71], v[32:35], v[132:135]
    ds_read_b64_tr_b16 v[112:113], v12 offset:49152
    v_mfma_f32_16x16x32_bf16 v[136:139], v[72:75], v[32:35], v[136:139]
    ds_read_b64_tr_b16 v[114:115], v13 offset:49152
    v_mfma_f32_16x16x32_bf16 v[140:143], v[76:79], v[32:35], v[140:143]
    ds_read_b64_tr_b16 v[116:117], v14 offset:49152
    v_mfma_f32_16x16x32_bf16 v[144:147], v[64:67], v[36:39], v[144:147]
    s_add_u32 m0, s21, 66560
    s_nop 0
    buffer_load_dwordx4 v1, s[4:7], s17 offen sc1 lds
    s_add_u32 s17, s17, s62
    v_mfma_f32_16x16x32_bf16 v[148:151], v[68:71], v[36:39], v[148:151]
    ds_read_b64_tr_b16 v[118:119], v15 offset:49152
    v_mfma_f32_16x16x32_bf16 v[152:155], v[72:75], v[36:39], v[152:155]
    ds_read_b64_tr_b16 v[120:121], v12 offset:57344
    v_mfma_f32_16x16x32_bf16 v[156:159], v[76:79], v[36:39], v[156:159]
    ds_read_b64_tr_b16 v[122:123], v13 offset:57344
    v_mfma_f32_16x16x32_bf16 v[160:163], v[64:67], v[40:43], v[160:163]
    s_add_u32 m0, s22, 65536
    s_nop 0
    buffer_load_dwordx4 v2, s[8:11], s18 offen lds
    s_add_u32 s18, s18, s20
    v_mfma_f32_16x16x32_bf16 v[164:167], v[68:71], v[40:43], v[164:167]
    ds_read_b64_tr_b16 v[124:125], v14 offset:57344
    v_mfma_f32_16x16x32_bf16 v[168:171], v[72:75], v[40:43], v[168:171]
    ds_read_b64_tr_b16 v[126:127], v15 offset:57344
    v_mfma_f32_16x16x32_bf16 v[172:175], v[76:79], v[40:43], v[172:175]
    ds_read_b128 v[80:83], v6 offset:32768
    v_mfma_f32_16x16x32_bf16 v[176:179], v[64:67], v[44:47], v[176:179]
    s_add_u32 m0, s22, 73728
    s_nop 0
    buffer_load_dwordx4 v2, s[12:15], s19 offen lds
    s_add_u32 s19, s19, s20
    v_mfma_f32_16x16x32_bf16 v[180:183], v[68:71], v[44:47], v[180:183]
    ds_read_b128 v[84:87], v6 offset:33792
    v_mfma_f32_16x16x32_bf16 v[184:187], v[72:75], v[44:47], v[184:187]
    ds_read_b128 v[88:91], v6 offset:34816
    v_mfma_f32_16x16x32_bf16 v[188:191], v[76:79], v[44:47], v[188:191]
    ds_read_b128 v[92:95], v6 offset:35840
    v_mfma_f32_16x16x32_bf16 v[192:195], v[64:67], v[48:51], v[192:195]
    ds_read_b128 v[96:99], v6 offset:36864
    v_mfma_f32_16x16x32_bf16 v[196:199], v[68:71], v[48:51], v[196:199]
    ds_read_b128 v[100:103], v6 offset:37888
    v_mfma_f32_16x16x32_bf16 v[200:203], v[72:75], v[48:51], v[200:203]
    ds_read_b128 v[104:107], v6 offset:38912
    v_mfma_f32_16x16x32_bf16 v[204:207], v[76:79], v[48:51], v[204:207]
    ds_read_b128 v[108:111], v6 offset:39936
    v_mfma_f32_16x16x32_bf16 v[208:211], v[64:67], v[52:55], v[208:211]
    v_mfma_f32_16x16x32_bf16 v[212:215], v[68:71], v[52:55], v[212:215]
    v_mfma_f32_16x16x32_bf16 v[216:219], v[72:75], v[52:55], v[216:219]
    v_mfma_f32_16x16x32_bf16 v[220:223], v[76:79], v[52:55], v[220:223]
    v_mfma_f32_16x16x32_bf16 v[224:227], v[64:67], v[56:59], v[224:227]
    v_mfma_f32_16x16x32_bf16 v[228:231], v[68:71], v[56:59], v[228:231]
    v_mfma_f32_16x16x32_bf16 v[232:235], v[72:75], v[56:59], v[232:235]
    v_mfma_f32_16x16x32_bf16 v[236:239], v[76:79], v[56:59], v[236:239]
    v_mfma_f32_16x16x32_bf16 v[240:243], v[64:67], v[60:63], v[240:243]
    v_mfma_f32_16x16x32_bf16 v[244:247], v[68:71], v[60:63], v[244:247]
    v_mfma_f32_16x16x32_bf16 v[248:251], v[72:75], v[60:63], v[248:251]
    v_mfma_f32_16x16x32_bf16 v[252:255], v[76:79], v[60:63], v[252:255]
    s_waitcnt lgkmcnt(0)
    s_waitcnt vmcnt(8)
    s_barrier
    v_mfma_f32_16x16x32_bf16 v[128:131], v[112:115], v[80:83], v[128:131]
    s_add_u32 m0, s21, 98304
    s_nop 0
    buffer_load_dwordx4 v1, s[4:7], s16 offen sc1 lds
    s_add_u32 s16, s16, s62
    v_mfma_f32_16x16x32_bf16 v[132:135], v[116:119], v[80:83], v[132:135]
    ds_read_b64_tr_b16 v[64:65], v8 offset:16384
    v_mfma_f32_16x16x32_bf16 v[136:139], v[120:123], v[80:83], v[136:139]
    ds_read_b64_tr_b16 v[66:67], v9 offset:16384
    v_mfma_f32_16x16x32_bf16 v[140:143], v[124:127], v[80:83], v[140:143]
    ds_read_b64_tr_b16 v[68:69], v10 offset:16384
    v_mfma_f32_16x16x32_bf16 v[144:147], v[112:115], v[84:87], v[144:147]
    s_add_u32 m0, s21, 99328
    s_nop 0
    buffer_load_dwordx4 v1, s[4:7], s17 offen sc1 lds
    s_add_u32 s17, s17, s62
    v_mfma_f32_16x16x32_bf16 v[148:151], v[116:119], v[84:87], v[148:151]
    ds_read_b64_tr_b16 v[70:71], v11 offset:16384
    v_mfma_f32_16x16x32_bf16 v[152:155], v[120:123], v[84:87], v[152:155]
    ds_read_b64_tr_b16 v[72:73], v8 offset:24576
    v_mfma_f32_16x16x32_bf16 v[156:159], v[124:127], v[84:87], v[156:159]
    ds_read_b64_tr_b16 v[74:75], v9 offset:24576
    v_mfma_f32_16x16x32_bf16 v[160:163], v[112:115], v[88:91], v[160:163]
    s_add_u32 m0, s22, 98304
    s_nop 0
    buffer_load_dwordx4 v2, s[8:11], s18 offen lds
    s_add_u32 s18, s18, s20
    v_mfma_f32_16x16x32_bf16 v[164:167], v[116:119], v[88:91], v[164:167]
    ds_read_b64_tr_b16 v[76:77], v10 offset:24576
    v_mfma_f32_16x16x32_bf16 v[168:171], v[120:123], v[88:91], v[168:171]
    ds_read_b64_tr_b16 v[78:79], v11 offset:24576
    v_mfma_f32_16x16x32_bf16 v[172:175], v[124:127], v[88:91], v[172:175]
    ds_read_b128 v[32:35], v5 offset:0
    v_mfma_f32_16x16x32_bf16 v[176:179], v[112:115], v[92:95], v[176:179]
    s_add_u32 m0, s22, 106496
    s_nop 0
    buffer_load_dwordx4 v2, s[12:15], s19 offen lds
    s_add_u32 s19, s19, s20
    v_mfma_f32_16x16x32_bf16 v[180:183], v[116:119], v[92:95], v[180:183]
    ds_read_b128 v[36:39], v5 offset:1024
    v_mfma_f32_16x16x32_bf16 v[184:187], v[120:123], v[92:95], v[184:187]
    ds_read_b128 v[40:43], v5 offset:2048
    v_mfma_f32_16x16x32_bf16 v[188:191], v[124:127], v[92:95], v[188:191]
    ds_read_b128 v[44:47], v5 offset:3072
    v_mfma_f32_16x16x32_bf16 v[192:195], v[112:115], v[96:99], v[192:195]
    ds_read_b128 v[48:51], v5 offset:4096
    v_mfma_f32_16x16x32_bf16 v[196:199], v[116:119], v[96:99], v[196:199]
    ds_read_b128 v[52:55], v5 offset:5120
    v_mfma_f32_16x16x32_bf16 v[200:203], v[120:123], v[96:99], v[200:203]
    ds_read_b128 v[56:59], v5 offset:6144
    v_mfma_f32_16x16x32_bf16 v[204:207], v[124:127], v[96:99], v[204:207]
    ds_read_b128 v[60:63], v5 offset:7168
    v_mfma_f32_16x16x32_bf16 v[208:211], v[112:115], v[100:103], v[208:211]
    v_mfma_f32_16x16x32_bf16 v[212:215], v[116:119], v[100:103], v[212:215]
    v_mfma_f32_16x16x32_bf16 v[216:219], v[120:123], v[100:103], v[216:219]
    v_mfma_f32_16x16x32_bf16 v[220:223], v[124:127], v[100:103], v[220:223]
    v_mfma_f32_16x16x32_bf16 v[224:227], v[112:115], v[104:107], v[224:227]
    v_mfma_f32_16x16x32_bf16 v[228:231], v[116:119], v[104:107], v[228:231]
    v_mfma_f32_16x16x32_bf16 v[232:235], v[120:123], v[104:107], v[232:235]
    v_mfma_f32_16x16x32_bf16 v[236:239], v[124:127], v[104:107], v[236:239]
    v_mfma_f32_16x16x32_bf16 v[240:243], v[112:115], v[108:111], v[240:243]
    v_mfma_f32_16x16x32_bf16 v[244:247], v[116:119], v[108:111], v[244:247]
    v_mfma_f32_16x16x32_bf16 v[248:251], v[120:123], v[108:111], v[248:251]
    v_mfma_f32_16x16x32_bf16 v[252:255], v[124:127], v[108:111], v[252:255]
    s_waitcnt lgkmcnt(0)
    s_sub_u32 s23, s23, 1
    s_cmp_lg_u32 s23, 0
    s_cbranch_scc1 w_loop
    v_mov_b32 v20, 131072
    ds_read_b128 v[24:27], v20
    ds_read_b128 v[28:31], v20 offset:16
    s_cmp_eq_u32 s48, 2
    s_cbranch_scc1 w_epi_glu
    s_lshl_b32 s30, s27, 10
    s_add_u32 s30, s30, s49
    s_nop 7
    v_cvt_pk_bf16_f32 v80, v128, v129
    v_cvt_pk_bf16_f32 v81, v130, v131
    v_cvt_pk_bf16_f32 v82, v132, v133
    v_cvt_pk_bf16_f32 v83, v134, v135
    buffer_store_dwordx4 v[80:83], v1, s[4:7], s30 offen sc1
    v_cvt_pk_bf16_f32 v84, v136, v137
    v_cvt_pk_bf16_f32 v85, v138, v139
    v_cvt_pk_bf16_f32 v86, v140, v141
    v_cvt_pk_bf16_f32 v87, v142, v143
    buffer_store_dwordx4 v[84:87], v19, s[4:7], s30 offen sc1
    s_add_u32 s30, s30, s50
    v_cvt_pk_bf16_f32 v88, v144, v145
    v_cvt_pk_bf16_f32 v89, v146, v147
    v_cvt_pk_bf16_f32 v90, v148, v149
    v_cvt_pk_bf16_f32 v91, v150, v151
    buffer_store_dwordx4 v[88:91], v1, s[4:7], s30 offen sc1
    v_cvt_pk_bf16_f32 v92, v152, v153
    v_cvt_pk_bf16_f32 v93, v154, v155
    v_cvt_pk_bf16_f32 v94, v156, v157
    v_cvt_pk_bf16_f32 v95, v158, v159
    buffer_store_dwordx4 v[92:95], v19, s[4:7], s30 offen sc1
    s_add_u32 s30, s30, s50
    v_cvt_pk_bf16_f32 v80, v160, v161
    v_cvt_pk_bf16_f32 v81, v162, v163
    v_cvt_pk_bf16_f32 v82, v164, v165
    v_cvt_pk_bf16_f32 v83, v166, v167
    buffer_store_dwordx4 v[80:83], v1, s[4:7], s30 offen sc1
    v_cvt_pk_bf16_f32 v84, v168, v169
    v_cvt_pk_bf16_f32 v85, v170, v171
    v_cvt_pk_bf16_f32 v86, v172, v173
    v_cvt_pk_bf16_f32 v87, v174, v175
    buffer_store_dwordx4 v[84:87], v19, s[4:7], s30 offen sc1
    s_add_u32 s30, s30, s50
    v_cvt_pk_bf16_f32 v88, v176, v177
    v_cvt_pk_bf16_f32 v89, v178, v179
    v_cvt_pk_bf16_f32 v90, v180, v181
    v_cvt_pk_bf16_f32 v91, v182, v183
    buffer_store_dwordx4 v[88:91], v1, s[4:7], s30 offen sc1
    v_cvt_pk_bf16_f32 v92, v184, v185
    v_cvt_pk_bf16_f32 v93, v186, v187
    v_cvt_pk_bf16_f32 v94, v188, v189
    v_cvt_pk_bf16_f32 v95, v190, v191
    buffer_store_dwordx4 v[92:95], v19, s[4:7], s30 offen sc1
    s_add_u32 s30, s30, s50
    v_cvt_pk_bf16_f32 v80, v192, v193
    v_cvt_pk_bf16_f32 v81, v194, v195
    v_cvt_pk_bf16_f32 v82, v196, v197
    v_cvt_pk_bf16_f32 v83, v198, v199
    buffer_store_dwordx4 v[80:83], v1, s[4:7], s30 offen sc1
    v_cvt_pk_bf16_f32 v84, v200, v201
    v_cvt_pk_bf16_f32 v85, v202, v203
    v_cvt_pk_bf16_f32 v86, v204, v205
    v_cvt_pk_bf16_f32 v87, v206, v207
    buffer_store_dwordx4 v[84:87], v19, s[4:7], s30 offen sc1
    s_add_u32 s30, s30, s50
    v_cvt_pk_bf16_f32 v88, v208, v209
    v_cvt_pk_bf16_f32 v89, v210, v211
    v_cvt_pk_bf16_f32 v90, v212, v213
    v_cvt_pk_bf16_f32 v91, v214, v215
    buffer_store_dwordx4 v[88:91], v1, s[4:7], s30 offen sc1
    v_cvt_pk_bf16_f32 v92, v216, v217
    v_cvt_pk_bf16_f32 v93, v218, v219
    v_cvt_pk_bf16_f32 v94, v220, v221
    v_cvt_pk_bf16_f32 v95, v222, v223
    buffer_store_dwordx4 v[92:95], v19, s[4:7], s30 offen sc1
    s_add_u32 s30, s30, s50
    v_cvt_pk_bf16_f32 v80, v224, v225
    v_cvt_pk_bf16_f32 v81, v226, v227
    v_cvt_pk_bf16_f32 v82, v228, v229
    v_cvt_pk_bf16_f32 v83, v230, v231
    buffer_store_dwordx4 v[80:83], v1, s[4:7], s30 offen sc1
    v_cvt_pk_bf16_f32 v84, v232, v233
    v_cvt_pk_bf16_f32 v85, v234, v235
    v_cvt_pk_bf16_f32 v86, v236, v237
    v_cvt_pk_bf16_f32 v87, v238, v239
    buffer_store_dwordx4 v[84:87], v19, s[4:7], s30 offen sc1
    s_add_u32 s30, s30, s50
    v_cvt_pk_bf16_f32 v88, v240, v241
    v_cvt_pk_bf16_f32 v89, v242, v243
    v_cvt_pk_bf16_f32 v90, v244, v245
    v_cvt_pk_bf16_f32 v91, v246, v247
    buffer_store_dwordx4 v[88:91], v1, s[4:7], s30 offen sc1
    v_cvt_pk_bf16_f32 v92, v248, v249
    v_cvt_pk_bf16_f32 v93, v250, v251
    v_cvt_pk_bf16_f32 v94, v252, v253
    v_cvt_pk_bf16_f32 v95, v254, v255
    buffer_store_dwordx4 v[92:95], v19, s[4:7], s30 offen sc1
    s_waitcnt lgkmcnt(0)
    v_or3_b32 v24, v24, v25, v26
    v_or3_b32 v28, v28, v29, v30
    v_or3_b32 v24, v24, v27, v31
    v_or_b32 v24, v24, v28
    s_mov_b32 s28, s51
    v_readfirstlane_b32 s30, v24
    s_cmp_lg_u32 s30, 0
    s_cbranch_scc1 w_drain
    s_mov_b32 s48, s32
    s_cmp_eq_u32 s32, 4
    s_cselect_b32 s30, 2, 3
    s_lshl_b32 s30, s26, s30
    s_mul_i32 s30, s30, s43
    s_add_u32 s49, s42, s30
    s_mov_b32 s50, s43
    s_mov_b32 s51, s46
    s_mov_b32 s23, s41
    s_mov_b32 s53, s41
    s_branch w_first16
w_epi_glu:
    s_lshl_b32 s30, s27, 10
    s_add_u32 s30, s30, s49
    s_mov_b32 s54, 0xbfb8aa3b
    s_nop 7
    v_cvt_pk_bf16_f32 v80, v128, v129
    v_cvt_pk_bf16_f32 v81, v130, v131
    v_cvt_pk_bf16_f32 v82, v132, v133
    v_cvt_pk_bf16_f32 v83, v134, v135
    v_lshlrev_b32 v96, 16, v80
    v_and_b32 v97, 0xffff0000, v80
    v_lshlrev_b32 v98, 16, v81
    v_and_b32 v99, 0xffff0000, v81
    v_lshlrev_b32 v100, 16, v82
    v_and_b32 v101, 0xffff0000, v82
    v_lshlrev_b32 v102, 16, v83
    v_and_b32 v103, 0xffff0000, v83
    v_mul_f32 v96, s54, v96
    v_mul_f32 v97, s54, v97
    v_mul_f32 v98, s54, v98
    v_mul_f32 v99, s54, v99
    v_mul_f32 v100, s54, v100
    v_mul_f32 v101, s54, v101
    v_mul_f32 v102, s54, v102
    v_mul_f32 v103, s54, v103
    v_exp_f32 v96, v96
    v_exp_f32 v97, v97
    v_exp_f32 v98, v98
    v_exp_f32 v99, v99
    v_exp_f32 v100, v100
    v_exp_f32 v101, v101
    v_exp_f32 v102, v102
    v_exp_f32 v103, v103
    v_add_f32 v96, 1.0, v96
    v_add_f32 v97, 1.0, v97
    v_add_f32 v98, 1.0, v98
    v_add_f32 v99, 1.0, v99
    v_add_f32 v100, 1.0, v100
    v_add_f32 v101, 1.0, v101
    v_add_f32 v102, 1.0, v102
    v_add_f32 v103, 1.0, v103
    v_rcp_f32 v96, v96
    v_rcp_f32 v97, v97
    v_rcp_f32 v98, v98
    v_rcp_f32 v99, v99
    v_rcp_f32 v100, v100
    v_rcp_f32 v101, v101
    v_rcp_f32 v102, v102
    v_rcp_f32 v103, v103
    v_mul_f32 v96, v96, v136
    v_mul_f32 v97, v97, v137
    v_mul_f32 v98, v98, v138
    v_mul_f32 v99, v99, v139
    v_mul_f32 v100, v100, v140
    v_mul_f32 v101, v101, v141
    v_mul_f32 v102, v102, v142
    v_mul_f32 v103, v103, v143
    v_cvt_pk_bf16_f32 v80, v96, v97
    v_cvt_pk_bf16_f32 v81, v98, v99
    v_cvt_pk_bf16_f32 v82, v100, v101
    v_cvt_pk_bf16_f32 v83, v102, v103
    buffer_store_dwordx4 v[80:83], v1, s[4:7], s30 offen sc1
    s_add_u32 s30, s30, s50
    v_cvt_pk_bf16_f32 v84, v144, v145
    v_cvt_pk_bf16_f32 v85, v146, v147
    v_cvt_pk_bf16_f32 v86, v148, v149
    v_cvt_pk_bf16_f32 v87, v150, v151
    v_lshlrev_b32 v104, 16, v84
    v_and_b32 v105, 0xffff0000, v84
    v_lshlrev_b32 v106, 16, v85
    v_and_b32 v107, 0xffff0000, v85
    v_lshlrev_b32 v108, 16, v86
    v_and_b32 v109, 0xffff0000, v86
    v_lshlrev_b32 v110, 16, v87
    v_and_b32 v111, 0xffff0000, v87
    v_mul_f32 v104, s54, v104
    v_mul_f32 v105, s54, v105
    v_mul_f32 v106, s54, v106
    v_mul_f32 v107, s54, v107
    v_mul_f32 v108, s54, v108
    v_mul_f32 v109, s54, v109
    v_mul_f32 v110, s54, v110
    v_mul_f32 v111, s54, v111
    v_exp_f32 v104, v104
    v_exp_f32 v105, v105
    v_exp_f32 v106, v106
    v_exp_f32 v107, v107
    v_exp_f32 v108, v108
    v_exp_f32 v109, v109
    v_exp_f32 v110, v110
    v_exp_f32 v111, v111
    v_add_f32 v104, 1.0, v104
    v_add_f32 v105, 1.0, v105
    v_add_f32 v106, 1.0, v106
    v_add_f32 v107, 1.0, v107
    v_add_f32 v108, 1.0, v108
    v_add_f32 v109, 1.0, v109
    v_add_f32 v110, 1.0, v110
    v_add_f32 v111, 1.0, v111
    v_rcp_f32 v104, v104
    v_rcp_f32 v105, v105
    v_rcp_f32 v106, v106
    v_rcp_f32 v107, v107
    v_rcp_f32 v108, v108
    v_rcp_f32 v109, v109
    v_rcp_f32 v110, v110
    v_rcp_f32 v111, v111
    v_mul_f32 v104, v104, v152
    v_mul_f32 v105, v105, v153
    v_mul_f32 v106, v106, v154
    v_mul_f32 v107, v107, v155
    v_mul_f32 v108, v108, v156
    v_mul_f32 v109, v109, v157
    v_mul_f32 v110, v110, v158
    v_mul_f32 v111, v111, v159
    v_cvt_pk_bf16_f32 v84, v104, v105
    v_cvt_pk_bf16_f32 v85, v106, v107
    v_cvt_pk_bf16_f32 v86, v108, v109
    v_cvt_pk_bf16_f32 v87, v110, v111
    buffer_store_dwordx4 v[84:87], v1, s[4:7], s30 offen sc1
    s_add_u32 s30, s30, s50
    v_cvt_pk_bf16_f32 v88, v160, v161
    v_cvt_pk_bf16_f32 v89, v162, v163
    v_cvt_pk_bf16_f32 v90, v164, v165
    v_cvt_pk_bf16_f32 v91, v166, v167
    v_lshlrev_b32 v96, 16, v88
    v_and_b32 v97, 0xffff0000, v88
    v_lshlrev_b32 v98, 16, v89
    v_and_b32 v99, 0xffff0000, v89
    v_lshlrev_b32 v100, 16, v90
    v_and_b32 v101, 0xffff0000, v90
    v_lshlrev_b32 v102, 16, v91
    v_and_b32 v103, 0xffff0000, v91
    v_mul_f32 v96, s54, v96
    v_mul_f32 v97, s54, v97
    v_mul_f32 v98, s54, v98
    v_mul_f32 v99, s54, v99
    v_mul_f32 v100, s54, v100
    v_mul_f32 v101, s54, v101
    v_mul_f32 v102, s54, v102
    v_mul_f32 v103, s54, v103
    v_exp_f32 v96, v96
    v_exp_f32 v97, v97
    v_exp_f32 v98, v98
    v_exp_f32 v99, v99
    v_exp_f32 v100, v100
    v_exp_f32 v101, v101
    v_exp_f32 v102, v102
    v_exp_f32 v103, v103
    v_add_f32 v96, 1.0, v96
    v_add_f32 v97, 1.0, v97
    v_add_f32 v98, 1.0, v98
    v_add_f32 v99, 1.0, v99
    v_add_f32 v100, 1.0, v100
    v_add_f32 v101, 1.0, v101
    v_add_f32 v102, 1.0, v102
    v_add_f32 v103, 1.0, v103
    v_rcp_f32 v96, v96
    v_rcp_f32 v97, v97
    v_rcp_f32 v98, v98
    v_rcp_f32 v99, v99
    v_rcp_f32 v100, v100
    v_rcp_f32 v101, v101
    v_rcp_f32 v102, v102
    v_rcp_f32 v103, v103
    v_mul_f32 v96, v96, v168
    v_mul_f32 v97, v97, v169
    v_mul_f32 v98, v98, v170
    v_mul_f32 v99, v99, v171
    v_mul_f32 v100, v100, v172
    v_mul_f32 v101, v101, v173
    v_mul_f32 v102, v102, v174
    v_mul_f32 v103, v103, v175
    v_cvt_pk_bf16_f32 v88, v96, v97
    v_cvt_pk_bf16_f32 v89, v98, v99
    v_cvt_pk_bf16_f32 v90, v100, v101
    v_cvt_pk_bf16_f32 v91, v102, v103
    buffer_store_dwordx4 v[88:91], v1, s[4:7], s30 offen sc1
    s_add_u32 s30, s30, s50
    v_cvt_pk_bf16_f32 v92, v176, v177
    v_cvt_pk_bf16_f32 v93, v178, v179
    v_cvt_pk_bf16_f32 v94, v180, v181
    v_cvt_pk_bf16_f32 v95, v182, v183
    v_lshlrev_b32 v104, 16, v92
    v_and_b32 v105, 0xffff0000, v92
    v_lshlrev_b32 v106, 16, v93
    v_and_b32 v107, 0xffff0000, v93
    v_lshlrev_b32 v108, 16, v94
    v_and_b32 v109, 0xffff0000, v94
    v_lshlrev_b32 v110, 16, v95
    v_and_b32 v111, 0xffff0000, v95
    v_mul_f32 v104, s54, v104
    v_mul_f32 v105, s54, v105
    v_mul_f32 v106, s54, v106
    v_mul_f32 v107, s54, v107
    v_mul_f32 v108, s54, v108
    v_mul_f32 v109, s54, v109
    v_mul_f32 v110, s54, v110
    v_mul_f32 v111, s54, v111
    v_exp_f32 v104, v104
    v_exp_f32 v105, v105
    v_exp_f32 v106, v106
    v_exp_f32 v107, v107
    v_exp_f32 v108, v108
    v_exp_f32 v109, v109
    v_exp_f32 v110, v110
    v_exp_f32 v111, v111
    v_add_f32 v104, 1.0, v104
    v_add_f32 v105, 1.0, v105
    v_add_f32 v106, 1.0, v106
    v_add_f32 v107, 1.0, v107
    v_add_f32 v108, 1.0, v108
    v_add_f32 v109, 1.0, v109
    v_add_f32 v110, 1.0, v110
    v_add_f32 v111, 1.0, v111
    v_rcp_f32 v104, v104
    v_rcp_f32 v105, v105
    v_rcp_f32 v106, v106
    v_rcp_f32 v107, v107
    v_rcp_f32 v108, v108
    v_rcp_f32 v109, v109
    v_rcp_f32 v110, v110
    v_rcp_f32 v111, v111
    v_mul_f32 v104, v104, v184
    v_mul_f32 v105, v105, v185
    v_mul_f32 v106, v106, v186
    v_mul_f32 v107, v107, v187
    v_mul_f32 v108, v108, v188
    v_mul_f32 v109, v109, v189
    v_mul_f32 v110, v110, v190
    v_mul_f32 v111, v111, v191
    v_cvt_pk_bf16_f32 v92, v104, v105
    v_cvt_pk_bf16_f32 v93, v106, v107
    v_cvt_pk_bf16_f32 v94, v108, v109
    v_cvt_pk_bf16_f32 v95, v110, v111
    buffer_store_dwordx4 v[92:95], v1, s[4:7], s30 offen sc1
    s_add_u32 s30, s30, s50
    v_cvt_pk_bf16_f32 v80, v192, v193
    v_cvt_pk_bf16_f32 v81, v194, v195
    v_cvt_pk_bf16_f32 v82, v196, v197
    v_cvt_pk_bf16_f32 v83, v198, v199
    v_lshlrev_b32 v96, 16, v80
    v_and_b32 v97, 0xffff0000, v80
    v_lshlrev_b32 v98, 16, v81
    v_and_b32 v99, 0xffff0000, v81
    v_lshlrev_b32 v100, 16, v82
    v_and_b32 v101, 0xffff0000, v82
    v_lshlrev_b32 v102, 16, v83
    v_and_b32 v103, 0xffff0000, v83
    v_mul_f32 v96, s54, v96
    v_mul_f32 v97, s54, v97
    v_mul_f32 v98, s54, v98
    v_mul_f32 v99, s54, v99
    v_mul_f32 v100, s54, v100
    v_mul_f32 v101, s54, v101
    v_mul_f32 v102, s54, v102
    v_mul_f32 v103, s54, v103
    v_exp_f32 v96, v96
    v_exp_f32 v97, v97
    v_exp_f32 v98, v98
    v_exp_f32 v99, v99
    v_exp_f32 v100, v100
    v_exp_f32 v101, v101
    v_exp_f32 v102, v102
    v_exp_f32 v103, v103
    v_add_f32 v96, 1.0, v96
    v_add_f32 v97, 1.0, v97
    v_add_f32 v98, 1.0, v98
    v_add_f32 v99, 1.0, v99
    v_add_f32 v100, 1.0, v100
    v_add_f32 v101, 1.0, v101
    v_add_f32 v102, 1.0, v102
    v_add_f32 v103, 1.0, v103
    v_rcp_f32 v96, v96
    v_rcp_f32 v97, v97
    v_rcp_f32 v98, v98
    v_rcp_f32 v99, v99
    v_rcp_f32 v100, v100
    v_rcp_f32 v101, v101
    v_rcp_f32 v102, v102
    v_rcp_f32 v103, v103
    v_mul_f32 v96, v96, v200
    v_mul_f32 v97, v97, v201
    v_mul_f32 v98, v98, v202
    v_mul_f32 v99, v99, v203
    v_mul_f32 v100, v100, v204
    v_mul_f32 v101, v101, v205
    v_mul_f32 v102, v102, v206
    v_mul_f32 v103, v103, v207
    v_cvt_pk_bf16_f32 v80, v96, v97
    v_cvt_pk_bf16_f32 v81, v98, v99
    v_cvt_pk_bf16_f32 v82, v100, v101
    v_cvt_pk_bf16_f32 v83, v102, v103
    buffer_store_dwordx4 v[80:83], v1, s[4:7], s30 offen sc1
    s_add_u32 s30, s30, s50
    v_cvt_pk_bf16_f32 v84, v208, v209
    v_cvt_pk_bf16_f32 v85, v210, v211
    v_cvt_pk_bf16_f32 v86, v212, v213
    v_cvt_pk_bf16_f32 v87, v214, v215
    v_lshlrev_b32 v104, 16, v84
    v_and_b32 v105, 0xffff0000, v84
    v_lshlrev_b32 v106, 16, v85
    v_and_b32 v107, 0xffff0000, v85
    v_lshlrev_b32 v108, 16, v86
    v_and_b32 v109, 0xffff0000, v86
    v_lshlrev_b32 v110, 16, v87
    v_and_b32 v111, 0xffff0000, v87
    v_mul_f32 v104, s54, v104
    v_mul_f32 v105, s54, v105
    v_mul_f32 v106, s54, v106
    v_mul_f32 v107, s54, v107
    v_mul_f32 v108, s54, v108
    v_mul_f32 v109, s54, v109
    v_mul_f32 v110, s54, v110
    v_mul_f32 v111, s54, v111
    v_exp_f32 v104, v104
    v_exp_f32 v105, v105
    v_exp_f32 v106, v106
    v_exp_f32 v107, v107
    v_exp_f32 v108, v108
    v_exp_f32 v109, v109
    v_exp_f32 v110, v110
    v_exp_f32 v111, v111
    v_add_f32 v104, 1.0, v104
    v_add_f32 v105, 1.0, v105
    v_add_f32 v106, 1.0, v106
    v_add_f32 v107, 1.0, v107
    v_add_f32 v108, 1.0, v108
    v_add_f32 v109, 1.0, v109
    v_add_f32 v110, 1.0, v110
    v_add_f32 v111, 1.0, v111
    v_rcp_f32 v104, v104
    v_rcp_f32 v105, v105
    v_rcp_f32 v106, v106
    v_rcp_f32 v107, v107
    v_rcp_f32 v108, v108
    v_rcp_f32 v109, v109
    v_rcp_f32 v110, v110
    v_rcp_f32 v111, v111
    v_mul_f32 v104, v104, v216
    v_mul_f32 v105, v105, v217
    v_mul_f32 v106, v106, v218
    v_mul_f32 v107, v107, v219
    v_mul_f32 v108, v108, v220
    v_mul_f32 v109, v109, v221
    v_mul_f32 v110, v110, v222
    v_mul_f32 v111, v111, v223
    v_cvt_pk_bf16_f32 v84, v104, v105
    v_cvt_pk_bf16_f32 v85, v106, v107
    v_cvt_pk_bf16_f32 v86, v108, v109
    v_cvt_pk_bf16_f32 v87, v110, v111
    buffer_store_dwordx4 v[84:87], v1, s[4:7], s30 offen sc1
    s_add_u32 s30, s30, s50
    v_cvt_pk_bf16_f32 v88, v224, v225
    v_cvt_pk_bf16_f32 v89, v226, v227
    v_cvt_pk_bf16_f32 v90, v228, v229
    v_cvt_pk_bf16_f32 v91, v230, v231
    v_lshlrev_b32 v96, 16, v88
    v_and_b32 v97, 0xffff0000, v88
    v_lshlrev_b32 v98, 16, v89
    v_and_b32 v99, 0xffff0000, v89
    v_lshlrev_b32 v100, 16, v90
    v_and_b32 v101, 0xffff0000, v90
    v_lshlrev_b32 v102, 16, v91
    v_and_b32 v103, 0xffff0000, v91
    v_mul_f32 v96, s54, v96
    v_mul_f32 v97, s54, v97
    v_mul_f32 v98, s54, v98
    v_mul_f32 v99, s54, v99
    v_mul_f32 v100, s54, v100
    v_mul_f32 v101, s54, v101
    v_mul_f32 v102, s54, v102
    v_mul_f32 v103, s54, v103
    v_exp_f32 v96, v96
    v_exp_f32 v97, v97
    v_exp_f32 v98, v98
    v_exp_f32 v99, v99
    v_exp_f32 v100, v100
    v_exp_f32 v101, v101
    v_exp_f32 v102, v102
    v_exp_f32 v103, v103
    v_add_f32 v96, 1.0, v96
    v_add_f32 v97, 1.0, v97
    v_add_f32 v98, 1.0, v98
    v_add_f32 v99, 1.0, v99
    v_add_f32 v100, 1.0, v100
    v_add_f32 v101, 1.0, v101
    v_add_f32 v102, 1.0, v102
    v_add_f32 v103, 1.0, v103
    v_rcp_f32 v96, v96
    v_rcp_f32 v97, v97
    v_rcp_f32 v98, v98
    v_rcp_f32 v99, v99
    v_rcp_f32 v100, v100
    v_rcp_f32 v101, v101
    v_rcp_f32 v102, v102
    v_rcp_f32 v103, v103
    v_mul_f32 v96, v96, v232
    v_mul_f32 v97, v97, v233
    v_mul_f32 v98, v98, v234
    v_mul_f32 v99, v99, v235
    v_mul_f32 v100, v100, v236
    v_mul_f32 v101, v101, v237
    v_mul_f32 v102, v102, v238
    v_mul_f32 v103, v103, v239
    v_cvt_pk_bf16_f32 v88, v96, v97
    v_cvt_pk_bf16_f32 v89, v98, v99
    v_cvt_pk_bf16_f32 v90, v100, v101
    v_cvt_pk_bf16_f32 v91, v102, v103
    buffer_store_dwordx4 v[88:91], v1, s[4:7], s30 offen sc1
    s_add_u32 s30, s30, s50
    v_cvt_pk_bf16_f32 v92, v240, v241
    v_cvt_pk_bf16_f32 v93, v242, v243
    v_cvt_pk_bf16_f32 v94, v244, v245
    v_cvt_pk_bf16_f32 v95, v246, v247
    v_lshlrev_b32 v104, 16, v92
    v_and_b32 v105, 0xffff0000, v92
    v_lshlrev_b32 v106, 16, v93
    v_and_b32 v107, 0xffff0000, v93
    v_lshlrev_b32 v108, 16, v94
    v_and_b32 v109, 0xffff0000, v94
    v_lshlrev_b32 v110, 16, v95
    v_and_b32 v111, 0xffff0000, v95
    v_mul_f32 v104, s54, v104
    v_mul_f32 v105, s54, v105
    v_mul_f32 v106, s54, v106
    v_mul_f32 v107, s54, v107
    v_mul_f32 v108, s54, v108
    v_mul_f32 v109, s54, v109
    v_mul_f32 v110, s54, v110
    v_mul_f32 v111, s54, v111
    v_exp_f32 v104, v104
    v_exp_f32 v105, v105
    v_exp_f32 v106, v106
    v_exp_f32 v107, v107
    v_exp_f32 v108, v108
    v_exp_f32 v109, v109
    v_exp_f32 v110, v110
    v_exp_f32 v111, v111
    v_add_f32 v104, 1.0, v104
    v_add_f32 v105, 1.0, v105
    v_add_f32 v106, 1.0, v106
    v_add_f32 v107, 1.0, v107
    v_add_f32 v108, 1.0, v108
    v_add_f32 v109, 1.0, v109
    v_add_f32 v110, 1.0, v110
    v_add_f32 v111, 1.0, v111
    v_rcp_f32 v104, v104
    v_rcp_f32 v105, v105
    v_rcp_f32 v106, v106
    v_rcp_f32 v107, v107
    v_rcp_f32 v108, v108
    v_rcp_f32 v109, v109
    v_rcp_f32 v110, v110
    v_rcp_f32 v111, v111
    v_mul_f32 v104, v104, v248
    v_mul_f32 v105, v105, v249
    v_mul_f32 v106, v106, v250
    v_mul_f32 v107, v107, v251
    v_mul_f32 v108, v108, v252
    v_mul_f32 v109, v109, v253
    v_mul_f32 v110, v110, v254
    v_mul_f32 v111, v111, v255
    v_cvt_pk_bf16_f32 v92, v104, v105
    v_cvt_pk_bf16_f32 v93, v106, v107
    v_cvt_pk_bf16_f32 v94, v108, v109
    v_cvt_pk_bf16_f32 v95, v110, v111
    buffer_store_dwordx4 v[92:95], v1, s[4:7], s30 offen sc1
    s_waitcnt lgkmcnt(0)
    v_or3_b32 v24, v24, v25, v26
    v_or3_b32 v28, v28, v29, v30
    v_or3_b32 v24, v24, v27, v31
    v_or_b32 v24, v24, v28
    s_mov_b32 s28, s51
    v_readfirstlane_b32 s30, v24
    s_cmp_lg_u32 s30, 0
    s_cbranch_scc1 w_drain
    s_mov_b32 s48, s32
    s_cmp_eq_u32 s32, 4
    s_cselect_b32 s30, 2, 3
    s_lshl_b32 s30, s26, s30
    s_mul_i32 s30, s30, s43
    s_add_u32 s49, s42, s30
    s_mov_b32 s50, s43
    s_mov_b32 s51, s46
    s_mov_b32 s23, s41
    s_mov_b32 s53, s41
    s_branch w_first8
w_firstH:
    s_waitcnt vmcnt(8)
    s_barrier
    s_add_u32 m0, s21, 0
    s_nop 0
    buffer_load_dwordx4 v1, s[4:7], s16 offen sc1 lds
    s_add_u32 s16, s16, s62
    s_add_u32 m0, s21, 1024
    s_nop 0
    buffer_load_dwordx4 v1, s[4:7], s17 offen sc1 lds
    s_add_u32 s17, s17, s62
    s_add_u32 m0, s22, 0
    s_nop 0
    buffer_load_dwordx4 v2, s[8:11], s18 offen lds
    s_add_u32 s18, s18, s20
    s_add_u32 m0, s22, 8192
    s_nop 0
    buffer_load_dwordx4 v2, s[12:15], s19 offen lds
    s_add_u32 s19, s19, s20
    v_mfma_f32_16x16x32_bf16 v[128:131], v[64:67], v[32:35], 0
    ds_read_b64_tr_b16 v[112:113], v8 offset:49152
    v_mfma_f32_16x16x32_bf16 v[132:135], v[68:71], v[32:35], 0
    ds_read_b64_tr_b16 v[114:115], v9 offset:49152
    v_mfma_f32_16x16x32_bf16 v[144:147], v[64:67], v[40:43], 0
    ds_read_b64_tr_b16 v[116:117], v10 offset:49152
    v_mfma_f32_16x16x32_bf16 v[148:151], v[68:71], v[40:43], 0
    ds_read_b64_tr_b16 v[118:119], v11 offset:49152
    v_mfma_f32_16x16x32_bf16 v[160:163], v[64:67], v[48:51], 0
    ds_read_b64_tr_b16 v[120:121], v8 offset:57344
    v_mfma_f32_16x16x32_bf16 v[164:167], v[68:71], v[48:51], 0
    ds_read_b64_tr_b16 v[122:123], v9 offset:57344
    v_mfma_f32_16x16x32_bf16 v[176:179], v[64:67], v[56:59], 0
    ds_read_b64_tr_b16 v[124:125], v10 offset:57344
    v_mfma_f32_16x16x32_bf16 v[180:183], v[68:71], v[56:59], 0
    ds_read_b64_tr_b16 v[126:127], v11 offset:57344
    v_mfma_f32_16x16x32_bf16 v[128:131], v[72:75], v[36:39], v[128:131]
    ds_read_b128 v[80:83], v5 offset:32768
    v_mfma_f32_16x16x32_bf16 v[132:135], v[76:79], v[36:39], v[132:135]
    ds_read_b128 v[84:87], v5 offset:33792
    v_mfma_f32_16x16x32_bf16 v[144:147], v[72:75], v[44:47], v[144:147]
    ds_read_b128 v[88:91], v5 offset:34816
    v_mfma_f32_16x16x32_bf16 v[148:151], v[76:79], v[44:47], v[148:151]
    ds_read_b128 v[92:95], v5 offset:35840
    v_mfma_f32_16x16x32_bf16 v[160:163], v[72:75], v[52:55], v[160:163]
    ds_read_b128 v[96:99], v5 offset:36864
    v_mfma_f32_16x16x32_bf16 v[164:167], v[76:79], v[52:55], v[164:167]
    ds_read_b128 v[100:103], v5 offset:37888
    v_mfma_f32_16x16x32_bf16 v[176:179], v[72:75], v[60:63], v[176:179]
    ds_read_b128 v[104:107], v5 offset:38912
    v_mfma_f32_16x16x32_bf16 v[180:183], v[76:79], v[60:63], v[180:183]
    ds_read_b128 v[108:111], v5 offset:39936
    s_waitcnt lgkmcnt(0)
    s_waitcnt vmcnt(8)
    s_barrier
    s_add_u32 m0, s21, 32768
    s_nop 0
    buffer_load_dwordx4 v1, s[4:7], s16 offen sc1 lds
    s_add_u32 s16, s16, s62
    s_add_u32 m0, s21, 33792
    s_nop 0
    buffer_load_dwordx4 v1, s[4:7], s17 offen sc1 lds
    s_add_u32 s17, s17, s62
    s_add_u32 m0, s22, 32768
    s_nop 0
    buffer_load_dwordx4 v2, s[8:11], s18 offen lds
    s_add_u32 s18, s18, s20
    s_add_u32 m0, s22, 40960
    s_nop 0
    buffer_load_dwordx4 v2, s[12:15], s19 offen lds
    s_add_u32 s19, s19, s20
    v_mfma_f32_16x16x32_bf16 v[128:131], v[112:115], v[80:83], v[128:131]
    ds_read_b64_tr_b16 v[64:65], v12 offset:16384
    v_mfma_f32_16x16x32_bf16 v[132:135], v[116:119], v[80:83], v[132:135]
    ds_read_b64_tr_b16 v[66:67], v13 offset:16384
    v_mfma_f32_16x16x32_bf16 v[144:147], v[112:115], v[88:91], v[144:147]
    ds_read_b64_tr_b16 v[68:69], v14 offset:16384
    v_mfma_f32_16x16x32_bf16 v[148:151], v[116:119], v[88:91], v[148:151]
    ds_read_b64_tr_b16 v[70:71], v15 offset:16384
    v_mfma_f32_16x16x32_bf16 v[160:163], v[112:115], v[96:99], v[160:163]
    ds_read_b64_tr_b16 v[72:73], v12 offset:24576
    v_mfma_f32_16x16x32_bf16 v[164:167], v[116:119], v[96:99], v[164:167]
    ds_read_b64_tr_b16 v[74:75], v13 offset:24576
    v_mfma_f32_16x16x32_bf16 v[176:179], v[112:115], v[104:107], v[176:179]
    ds_read_b64_tr_b16 v[76:77], v14 offset:24576
    v_mfma_f32_16x16x32_bf16 v[180:183], v[116:119], v[104:107], v[180:183]
    ds_read_b64_tr_b16 v[78:79], v15 offset:24576
    v_mfma_f32_16x16x32_bf16 v[128:131], v[120:123], v[84:87], v[128:131]
    ds_read_b128 v[32:35], v6 offset:0
    v_mfma_f32_16x16x32_bf16 v[132:135], v[124:127], v[84:87], v[132:135]
    ds_read_b128 v[36:39], v6 offset:1024
    v_mfma_f32_16x16x32_bf16 v[144:147], v[120:123], v[92:95], v[144:147]
    ds_read_b128 v[40:43], v6 offset:2048
    v_mfma_f32_16x16x32_bf16 v[148:151], v[124:127], v[92:95], v[148:151]
    ds_read_b128 v[44:47], v6 offset:3072
    v_mfma_f32_16x16x32_bf16 v[160:163], v[120:123], v[100:103], v[160:163]
    ds_read_b128 v[48:51], v6 offset:4096
    v_mfma_f32_16x16x32_bf16 v[164:167], v[124:127], v[100:103], v[164:167]
    ds_read_b128 v[52:55], v6 offset:5120
    v_mfma_f32_16x16x32_bf16 v[176:179], v[120:123], v[108:111], v[176:179]
    ds_read_b128 v[56:59], v6 offset:6144
    v_mfma_f32_16x16x32_bf16 v[180:183], v[124:127], v[108:111], v[180:183]
    ds_read_b128 v[60:63], v6 offset:7168
    s_waitcnt lgkmcnt(0)
    s_waitcnt vmcnt(8)
    s_barrier
    s_add_u32 m0, s21, 65536
    s_nop 0
    buffer_load_dwordx4 v1, s[4:7], s16 offen sc1 lds
    s_add_u32 s16, s16, s62
    s_add_u32 m0, s21, 66560
    s_nop 0
    buffer_load_dwordx4 v1, s[4:7], s17 offen sc1 lds
    s_add_u32 s17, s17, s62
    s_add_u32 m0, s22, 65536
    s_nop 0
    buffer_load_dwordx4 v2, s[8:11], s18 offen lds
    s_add_u32 s18, s18, s20
    s_add_u32 m0, s22, 73728
    s_nop 0
    buffer_load_dwordx4 v2, s[12:15], s19 offen lds
    s_add_u32 s19, s19, s20
    v_mfma_f32_16x16x32_bf16 v[128:131], v[64:67], v[32:35], v[128:131]
    ds_read_b64_tr_b16 v[112:113], v12 offset:49152
    v_mfma_f32_16x16x32_bf16 v[132:135], v[68:71], v[32:35], v[132:135]
    ds_read_b64_tr_b16 v[114:115], v13 offset:49152
    v_mfma_f32_16x16x32_bf16 v[144:147], v[64:67], v[40:43], v[144:147]
    ds_read_b64_tr_b16 v[116:117], v14 offset:49152
    v_mfma_f32_16x16x32_bf16 v[148:151], v[68:71], v[40:43], v[148:151]
    ds_read_b64_tr_b16 v[118:119], v15 offset:49152
    v_mfma_f32_16x16x32_bf16 v[160:163], v[64:67], v[48:51], v[160:163]
    ds_read_b64_tr_b16 v[120:121], v12 offset:57344
    v_mfma_f32_16x16x32_bf16 v[164:167], v[68:71], v[48:51], v[164:167]
    ds_read_b64_tr_b16 v[122:123], v13 offset:57344
    v_mfma_f32_16x16x32_bf16 v[176:179], v[64:67], v[56:59], v[176:179]
    ds_read_b64_tr_b16 v[124:125], v14 offset:57344
    v_mfma_f32_16x16x32_bf16 v[180:183], v[68:71], v[56:59], v[180:183]
    ds_read_b64_tr_b16 v[126:127], v15 offset:57344
    v_mfma_f32_16x16x32_bf16 v[128:131], v[72:75], v[36:39], v[128:131]
    ds_read_b128 v[80:83], v6 offset:32768
    v_mfma_f32_16x16x32_bf16 v[132:135], v[76:79], v[36:39], v[132:135]
    ds_read_b128 v[84:87], v6 offset:33792
    v_mfma_f32_16x16x32_bf16 v[144:147], v[72:75], v[44:47], v[144:147]
    ds_read_b128 v[88:91], v6 offset:34816
    v_mfma_f32_16x16x32_bf16 v[148:151], v[76:79], v[44:47], v[148:151]
    ds_read_b128 v[92:95], v6 offset:35840
    v_mfma_f32_16x16x32_bf16 v[160:163], v[72:75], v[52:55], v[160:163]
    ds_read_b128 v[96:99], v6 offset:36864
    v_mfma_f32_16x16x32_bf16 v[164:167], v[76:79], v[52:55], v[164:167]
    ds_read_b128 v[100:103], v6 offset:37888
    v_mfma_f32_16x16x32_bf16 v[176:179], v[72:75], v[60:63], v[176:179]
    ds_read_b128 v[104:107], v6 offset:38912
    v_mfma_f32_16x16x32_bf16 v[180:183], v[76:79], v[60:63], v[180:183]
    ds_read_b128 v[108:111], v6 offset:39936
    s_waitcnt lgkmcnt(0)
    s_waitcnt vmcnt(8)
    s_barrier
    s_add_u32 m0, s21, 98304
    s_nop 0
    buffer_load_dwordx4 v1, s[4:7], s16 offen sc1 lds
    s_add_u32 s16, s16, s62
    s_add_u32 m0, s21, 99328
    s_nop 0
    buffer_load_dwordx4 v1, s[4:7], s17 offen sc1 lds
    s_add_u32 s17, s17, s62
    s_add_u32 m0, s22, 98304
    s_nop 0
    buffer_load_dwordx4 v2, s[8:11], s18 offen lds
    s_add_u32 s18, s18, s20
    s_add_u32 m0, s22, 106496
    s_nop 0
    buffer_load_dwordx4 v2, s[12:15], s19 offen lds
    s_add_u32 s19, s19, s20
    v_mfma_f32_16x16x32_bf16 v[128:131], v[112:115], v[80:83], v[128:131]
    ds_read_b64_tr_b16 v[64:65], v8 offset:16384
    v_mfma_f32_16x16x32_bf16 v[132:135], v[116:119], v[80:83], v[132:135]
    ds_read_b64_tr_b16 v[66:67], v9 offset:16384
    v_mfma_f32_16x16x32_bf16 v[144:147], v[112:115], v[88:91], v[144:147]
    ds_read_b64_tr_b16 v[68:69], v10 offset:16384
    v_mfma_f32_16x16x32_bf16 v[148:151], v[116:119], v[88:91], v[148:151]
    ds_read_b64_tr_b16 v[70:71], v11 offset:16384
    v_mfma_f32_16x16x32_bf16 v[160:163], v[112:115], v[96:99], v[160:163]
    ds_read_b64_tr_b16 v[72:73], v8 offset:24576
    v_mfma_f32_16x16x32_bf16 v[164:167], v[116:119], v[96:99], v[164:167]
    ds_read_b64_tr_b16 v[74:75], v9 offset:24576
    v_mfma_f32_16x16x32_bf16 v[176:179], v[112:115], v[104:107], v[176:179]
    ds_read_b64_tr_b16 v[76:77], v10 offset:24576
    v_mfma_f32_16x16x32_bf16 v[180:183], v[116:119], v[104:107], v[180:183]
    ds_read_b64_tr_b16 v[78:79], v11 offset:24576
    v_mfma_f32_16x16x32_bf16 v[128:131], v[120:123], v[84:87], v[128:131]
    ds_read_b128 v[32:35], v5 offset:0
    v_mfma_f32_16x16x32_bf16 v[132:135], v[124:127], v[84:87], v[132:135]
    ds_read_b128 v[36:39], v5 offset:1024
    v_mfma_f32_16x16x32_bf16 v[144:147], v[120:123], v[92:95], v[144:147]
    ds_read_b128 v[40:43], v5 offset:2048
    v_mfma_f32_16x16x32_bf16 v[148:151], v[124:127], v[92:95], v[148:151]
    ds_read_b128 v[44:47], v5 offset:3072
    v_mfma_f32_16x16x32_bf16 v[160:163], v[120:123], v[100:103], v[160:163]
    ds_read_b128 v[48:51], v5 offset:4096
    v_mfma_f32_16x16x32_bf16 v[164:167], v[124:127], v[100:103], v[164:167]
    ds_read_b128 v[52:55], v5 offset:5120
    v_mfma_f32_16x16x32_bf16 v[176:179], v[120:123], v[108:111], v[176:179]
    ds_read_b128 v[56:59], v5 offset:6144
    v_mfma_f32_16x16x32_bf16 v[180:183], v[124:127], v[108:111], v[180:183]
    ds_read_b128 v[60:63], v5 offset:7168
    s_waitcnt lgkmcnt(0)
w_loop_chkH:
    s_sub_u32 s23, s23, 1
w_loopH:
    s_cmp_gt_u32 s23, 3
    s_cbranch_scc1 w_bodyH
    s_cmp_lg_u32 s23, 3
    s_cbranch_scc1 w_l2H
    s_cmp_lg_u32 s3, 0
    s_cbranch_scc1 clm_9
    v_mov_b32 v26, 1
    s_mov_b64 exec, 1
    buffer_atomic_add v26, off, s[64:67], s71 sc0 sc1
    s_mov_b64 exec, -1
clm_9:
    s_branch w_bodyH
w_l2H:
    s_cmp_lg_u32 s23, 2
    s_cbranch_scc1 w_l1H
    s_cmp_lg_u32 s3, 0
    s_cbranch_scc1 pub_10
    v_mov_b32 v20, 131136
    s_mov_b64 exec, 1
    ds_write_b32 v20, v26
    s_mov_b64 exec, -1
    s_waitcnt lgkmcnt(0)
pub_10:
    s_branch w_bodyH
w_l1H:
    s_waitcnt vmcnt(8)
    buffer_load_dword v22, off, s[64:67], 0 sc1
    v_readfirstlane_b32 s30, v16
    s_cmp_ge_u32 s30, s45
    s_cselect_b32 s30, 0, 1
    s_cmp_lg_u32 s3, 0
    s_cselect_b32 s30, 0, s30
    s_or_b32 s30, s30, s70
    s_cmp_eq_u32 s32, 4
    s_cselect_b32 s30, 1, s30
    s_sub_u32 s57, s32, 1
    s_cmp_ge_u32 s57, 4
    s_cselect_b32 s30, 1, s30
    v_mov_b32 v20, s30
    ds_write_b32 v7, v20
    s_cbranch_scc1 w_bodyH
    s_load_dwordx2 s[8:9], s[0:1], s33
    s_load_dwordx2 s[12:13], s[0:1], s34
    s_mov_b32 s10, s38
    s_mov_b32 s14, s38
    s_cmp_eq_u32 s32, 4
    s_cselect_b32 s31, 0, 1
    s_lshl_b32 s30, s3, s31
    s_mul_i32 s30, s30, s40
    s_add_u32 s16, s39, s30
    s_cmp_eq_u32 s32, 4
    s_cselect_b32 s30, 1024, s40
    s_cselect_b32 s31, 6, 5
    s_lshl_b32 s62, 32, s31
    s_add_u32 s17, s16, s30
    s_lshl_b32 s30, s3, 2
    s_mul_i32 s30, s30, s35
    s_add_u32 s18, s36, s30
    s_add_u32 s19, s37, s30
    s_lshl_b32 s20, s35, s31
    v_mul_u32_u24 v2, s35, v4
    v_add_u32 v2, v2, v3
    s_waitcnt lgkmcnt(0)
w_bodyH:
    s_waitcnt vmcnt(8)
    s_barrier
    s_cmp_lg_u32 s23, 2
    s_cbranch_scc1 w_nfH
    v_mov_b32 v20, 131136
    ds_read_b32 v20, v20
    s_waitcnt lgkmcnt(0)
    v_readfirstlane_b32 s59, v20
    s_add_u32 s59, s59, 32
    s_min_u32 s59, s59, 322
    s_lshl_b32 s57, s59, 6
    s_load_dwordx16 s[32:47], s[24:25], s57
w_nfH:
    s_add_u32 m0, s21, 0
    s_nop 0
    buffer_load_dwordx4 v1, s[4:7], s16 offen sc1 lds
    s_add_u32 s16, s16, s62
    s_add_u32 m0, s21, 1024
    s_nop 0
    buffer_load_dwordx4 v1, s[4:7], s17 offen sc1 lds
    s_add_u32 s17, s17, s62
    s_add_u32 m0, s22, 0
    s_nop 0
    buffer_load_dwordx4 v2, s[8:11], s18 offen lds
    s_add_u32 s18, s18, s20
    s_add_u32 m0, s22, 8192
    s_nop 0
    buffer_load_dwordx4 v2, s[12:15], s19 offen lds
    s_add_u32 s19, s19, s20
    v_mfma_f32_16x16x32_bf16 v[128:131], v[64:67], v[32:35], v[128:131]
    ds_read_b64_tr_b16 v[112:113], v8 offset:49152
    v_mfma_f32_16x16x32_bf16 v[132:135], v[68:71], v[32:35], v[132:135]
    ds_read_b64_tr_b16 v[114:115], v9 offset:49152
    v_mfma_f32_16x16x32_bf16 v[144:147], v[64:67], v[40:43], v[144:147]
    ds_read_b64_tr_b16 v[116:117], v10 offset:49152
    v_mfma_f32_16x16x32_bf16 v[148:151], v[68:71], v[40:43], v[148:151]
    ds_read_b64_tr_b16 v[118:119], v11 offset:49152
    v_mfma_f32_16x16x32_bf16 v[160:163], v[64:67], v[48:51], v[160:163]
    ds_read_b64_tr_b16 v[120:121], v8 offset:57344
    v_mfma_f32_16x16x32_bf16 v[164:167], v[68:71], v[48:51], v[164:167]
    ds_read_b64_tr_b16 v[122:123], v9 offset:57344
    v_mfma_f32_16x16x32_bf16 v[176:179], v[64:67], v[56:59], v[176:179]
    ds_read_b64_tr_b16 v[124:125], v10 offset:57344
    v_mfma_f32_16x16x32_bf16 v[180:183], v[68:71], v[56:59], v[180:183]
    ds_read_b64_tr_b16 v[126:127], v11 offset:57344
    v_mfma_f32_16x16x32_bf16 v[128:131], v[72:75], v[36:39], v[128:131]
    ds_read_b128 v[80:83], v5 offset:32768
    v_mfma_f32_16x16x32_bf16 v[132:135], v[76:79], v[36:39], v[132:135]
    ds_read_b128 v[84:87], v5 offset:33792
    v_mfma_f32_16x16x32_bf16 v[144:147], v[72:75], v[44:47], v[144:147]
    ds_read_b128 v[88:91], v5 offset:34816
    v_mfma_f32_16x16x32_bf16 v[148:151], v[76:79], v[44:47], v[148:151]
    ds_read_b128 v[92:95], v5 offset:35840
    v_mfma_f32_16x16x32_bf16 v[160:163], v[72:75], v[52:55], v[160:163]
    ds_read_b128 v[96:99], v5 offset:36864
    v_mfma_f32_16x16x32_bf16 v[164:167], v[76:79], v[52:55], v[164:167]
    ds_read_b128 v[100:103], v5 offset:37888
    v_mfma_f32_16x16x32_bf16 v[176:179], v[72:75], v[60:63], v[176:179]
    ds_read_b128 v[104:107], v5 offset:38912
    v_mfma_f32_16x16x32_bf16 v[180:183], v[76:79], v[60:63], v[180:183]
    ds_read_b128 v[108:111], v5 offset:39936
    s_waitcnt lgkmcnt(0)
    s_waitcnt vmcnt(8)
    s_barrier
    s_lshl_b32 s57, s3, 8
    s_or_b32 s57, s57, s23
    s_cmp_lg_u32 s57, 2
    s_cbranch_scc1 np_11
    buffer_load_dword v16, v17, s[4:7], s44 offen sc1
np_11:
    s_add_u32 m0, s21, 32768
    s_nop 0
    buffer_load_dwordx4 v1, s[4:7], s16 offen sc1 lds
    s_add_u32 s16, s16, s62
    s_add_u32 m0, s21, 33792
    s_nop 0
    buffer_load_dwordx4 v1, s[4:7], s17 offen sc1 lds
    s_add_u32 s17, s17, s62
    s_add_u32 m0, s22, 32768
    s_nop 0
    buffer_load_dwordx4 v2, s[8:11], s18 offen lds
    s_add_u32 s18, s18, s20
    s_add_u32 m0, s22, 40960
    s_nop 0
    buffer_load_dwordx4 v2, s[12:15], s19 offen lds
    s_add_u32 s19, s19, s20
    v_mfma_f32_16x16x32_bf16 v[128:131], v[112:115], v[80:83], v[128:131]
    ds_read_b64_tr_b16 v[64:65], v12 offset:16384
    v_mfma_f32_16x16x32_bf16 v[132:135], v[116:119], v[80:83], v[132:135]
    ds_read_b64_tr_b16 v[66:67], v13 offset:16384
    v_mfma_f32_16x16x32_bf16 v[144:147], v[112:115], v[88:91], v[144:147]
    ds_read_b64_tr_b16 v[68:69], v14 offset:16384
    v_mfma_f32_16x16x32_bf16 v[148:151], v[116:119], v[88:91], v[148:151]
    ds_read_b64_tr_b16 v[70:71], v15 offset:16384
    v_mfma_f32_16x16x32_bf16 v[160:163], v[112:115], v[96:99], v[160:163]
    ds_read_b64_tr_b16 v[72:73], v12 offset:24576
    v_mfma_f32_16x16x32_bf16 v[164:167], v[116:119], v[96:99], v[164:167]
    ds_read_b64_tr_b16 v[74:75], v13 offset:24576
    v_mfma_f32_16x16x32_bf16 v[176:179], v[112:115], v[104:107], v[176:179]
    ds_read_b64_tr_b16 v[76:77], v14 offset:24576
    v_mfma_f32_16x16x32_bf16 v[180:183], v[116:119], v[104:107], v[180:183]
    ds_read_b64_tr_b16 v[78:79], v15 offset:24576
    v_mfma_f32_16x16x32_bf16 v[128:131], v[120:123], v[84:87], v[128:131]
    ds_read_b128 v[32:35], v6 offset:0
    v_mfma_f32_16x16x32_bf16 v[132:135], v[124:127], v[84:87], v[132:135]
    ds_read_b128 v[36:39], v6 offset:1024
    v_mfma_f32_16x16x32_bf16 v[144:147], v[120:123], v[92:95], v[144:147]
    ds_read_b128 v[40:43], v6 offset:2048
    v_mfma_f32_16x16x32_bf16 v[148:151], v[124:127], v[92:95], v[148:151]
    ds_read_b128 v[44:47], v6 offset:3072
    v_mfma_f32_16x16x32_bf16 v[160:163], v[120:123], v[100:103], v[160:163]
    ds_read_b128 v[48:51], v6 offset:4096
    v_mfma_f32_16x16x32_bf16 v[164:167], v[124:127], v[100:103], v[164:167]
    ds_read_b128 v[52:55], v6 offset:5120
    v_mfma_f32_16x16x32_bf16 v[176:179], v[120:123], v[108:111], v[176:179]
    ds_read_b128 v[56:59], v6 offset:6144
    v_mfma_f32_16x16x32_bf16 v[180:183], v[124:127], v[108:111], v[180:183]
    ds_read_b128 v[60:63], v6 offset:7168
    s_waitcnt lgkmcnt(0)
    s_waitcnt vmcnt(8)
    s_barrier
    s_add_u32 m0, s21, 65536
    s_nop 0
    buffer_load_dwordx4 v1, s[4:7], s16 offen sc1 lds
    s_add_u32 s16, s16, s62
    s_add_u32 m0, s21, 66560
    s_nop 0
    buffer_load_dwordx4 v1, s[4:7], s17 offen sc1 lds
    s_add_u32 s17, s17, s62
    s_add_u32 m0, s22, 65536
    s_nop 0
    buffer_load_dwordx4 v2, s[8:11], s18 offen lds
    s_add_u32 s18, s18, s20
    s_add_u32 m0, s22, 73728
    s_nop 0
    buffer_load_dwordx4 v2, s[12:15], s19 offen lds
    s_add_u32 s19, s19, s20
    v_mfma_f32_16x16x32_bf16 v[128:131], v[64:67], v[32:35], v[128:131]
    ds_read_b64_tr_b16 v[112:113], v12 offset:49152
    v_mfma_f32_16x16x32_bf16 v[132:135], v[68:71], v[32:35], v[132:135]
    ds_read_b64_tr_b16 v[114:115], v13 offset:49152
    v_mfma_f32_16x16x32_bf16 v[144:147], v[64:67], v[40:43], v[144:147]
    ds_read_b64_tr_b16 v[116:117], v14 offset:49152
    v_mfma_f32_16x16x32_bf16 v[148:151], v[68:71], v[40:43], v[148:151]
    ds_read_b64_tr_b16 v[118:119], v15 offset:49152
    v_mfma_f32_16x16x32_bf16 v[160:163], v[64:67], v[48:51], v[160:163]
    ds_read_b64_tr_b16 v[120:121], v12 offset:57344
    v_mfma_f32_16x16x32_bf16 v[164:167], v[68:71], v[48:51], v[164:167]
    ds_read_b64_tr_b16 v[122:123], v13 offset:57344
    v_mfma_f32_16x16x32_bf16 v[176:179], v[64:67], v[56:59], v[176:179]
    ds_read_b64_tr_b16 v[124:125], v14 offset:57344
    v_mfma_f32_16x16x32_bf16 v[180:183], v[68:71], v[56:59], v[180:183]
    ds_read_b64_tr_b16 v[126:127], v15 offset:57344
    v_mfma_f32_16x16x32_bf16 v[128:131], v[72:75], v[36:39], v[128:131]
    ds_read_b128 v[80:83], v6 offset:32768
    v_mfma_f32_16x16x32_bf16 v[132:135], v[76:79], v[36:39], v[132:135]
    ds_read_b128 v[84:87], v6 offset:33792
    v_mfma_f32_16x16x32_bf16 v[144:147], v[72:75], v[44:47], v[144:147]
    ds_read_b128 v[88:91], v6 offset:34816
    v_mfma_f32_16x16x32_bf16 v[148:151], v[76:79], v[44:47], v[148:151]
    ds_read_b128 v[92:95], v6 offset:35840
    v_mfma_f32_16x16x32_bf16 v[160:163], v[72:75], v[52:55], v[160:163]
    ds_read_b128 v[96:99], v6 offset:36864
    v_mfma_f32_16x16x32_bf16 v[164:167], v[76:79], v[52:55], v[164:167]
    ds_read_b128 v[100:103], v6 offset:37888
    v_mfma_f32_16x16x32_bf16 v[176:179], v[72:75], v[60:63], v[176:179]
    ds_read_b128 v[104:107], v6 offset:38912
    v_mfma_f32_16x16x32_bf16 v[180:183], v[76:79], v[60:63], v[180:183]
    ds_read_b128 v[108:111], v6 offset:39936
    s_waitcnt lgkmcnt(0)
    s_waitcnt vmcnt(8)
    s_barrier
    s_add_u32 m0, s21, 98304
    s_nop 0
    buffer_load_dwordx4 v1, s[4:7], s16 offen sc1 lds
    s_add_u32 s16, s16, s62
    s_add_u32 m0, s21, 99328
    s_nop 0
    buffer_load_dwordx4 v1, s[4:7], s17 offen sc1 lds
    s_add_u32 s17, s17, s62
    s_add_u32 m0, s22, 98304
    s_nop 0
    buffer_load_dwordx4 v2, s[8:11], s18 offen lds
    s_add_u32 s18, s18, s20
    s_add_u32 m0, s22, 106496
    s_nop 0
    buffer_load_dwordx4 v2, s[12:15], s19 offen lds
    s_add_u32 s19, s19, s20
    v_mfma_f32_16x16x32_bf16 v[128:131], v[112:115], v[80:83], v[128:131]
    ds_read_b64_tr_b16 v[64:65], v8 offset:16384
    v_mfma_f32_16x16x32_bf16 v[132:135], v[116:119], v[80:83], v[132:135]
    ds_read_b64_tr_b16 v[66:67], v9 offset:16384
    v_mfma_f32_16x16x32_bf16 v[144:147], v[112:115], v[88:91], v[144:147]
    ds_read_b64_tr_b16 v[68:69], v10 offset:16384
    v_mfma_f32_16x16x32_bf16 v[148:151], v[116:119], v[88:91], v[148:151]
    ds_read_b64_tr_b16 v[70:71], v11 offset:16384
    v_mfma_f32_16x16x32_bf16 v[160:163], v[112:115], v[96:99], v[160:163]
    ds_read_b64_tr_b16 v[72:73], v8 offset:24576
    v_mfma_f32_16x16x32_bf16 v[164:167], v[116:119], v[96:99], v[164:167]
    ds_read_b64_tr_b16 v[74:75], v9 offset:24576
    v_mfma_f32_16x16x32_bf16 v[176:179], v[112:115], v[104:107], v[176:179]
    ds_read_b64_tr_b16 v[76:77], v10 offset:24576
    v_mfma_f32_16x16x32_bf16 v[180:183], v[116:119], v[104:107], v[180:183]
    ds_read_b64_tr_b16 v[78:79], v11 offset:24576
    v_mfma_f32_16x16x32_bf16 v[128:131], v[120:123], v[84:87], v[128:131]
    ds_read_b128 v[32:35], v5 offset:0
    v_mfma_f32_16x16x32_bf16 v[132:135], v[124:127], v[84:87], v[132:135]
    ds_read_b128 v[36:39], v5 offset:1024
    v_mfma_f32_16x16x32_bf16 v[144:147], v[120:123], v[92:95], v[144:147]
    ds_read_b128 v[40:43], v5 offset:2048
    v_mfma_f32_16x16x32_bf16 v[148:151], v[124:127], v[92:95], v[148:151]
    ds_read_b128 v[44:47], v5 offset:3072
    v_mfma_f32_16x16x32_bf16 v[160:163], v[120:123], v[100:103], v[160:163]
    ds_read_b128 v[48:51], v5 offset:4096
    v_mfma_f32_16x16x32_bf16 v[164:167], v[124:127], v[100:103], v[164:167]
    ds_read_b128 v[52:55], v5 offset:5120
    v_mfma_f32_16x16x32_bf16 v[176:179], v[120:123], v[108:111], v[176:179]
    ds_read_b128 v[56:59], v5 offset:6144
    v_mfma_f32_16x16x32_bf16 v[180:183], v[124:127], v[108:111], v[180:183]
    ds_read_b128 v[60:63], v5 offset:7168
    s_waitcnt lgkmcnt(0)
    s_sub_u32 s23, s23, 1
    s_cmp_lg_u32 s23, 0
    s_cbranch_scc1 w_loopH
    v_mov_b32 v20, 131072
    ds_read_b128 v[24:27], v20
    ds_read_b128 v[28:31], v20 offset:16
    s_lshl_b32 s30, s27, 10
    s_add_u32 s30, s30, s49
    s_nop 7
    v_cvt_pk_bf16_f32 v80, v128, v129
    v_cvt_pk_bf16_f32 v81, v130, v131
    v_cvt_pk_bf16_f32 v82, v132, v133
    v_cvt_pk_bf16_f32 v83, v134, v135
    buffer_store_dwordx4 v[80:83], v1, s[4:7], s30 offen sc1
    s_add_u32 s30, s30, s50
    v_cvt_pk_bf16_f32 v84, v144, v145
    v_cvt_pk_bf16_f32 v85, v146, v147
    v_cvt_pk_bf16_f32 v86, v148, v149
    v_cvt_pk_bf16_f32 v87, v150, v151
    buffer_store_dwordx4 v[84:87], v1, s[4:7], s30 offen sc1
    s_add_u32 s30, s30, s50
    v_cvt_pk_bf16_f32 v88, v160, v161
    v_cvt_pk_bf16_f32 v89, v162, v163
    v_cvt_pk_bf16_f32 v90, v164, v165
    v_cvt_pk_bf16_f32 v91, v166, v167
    buffer_store_dwordx4 v[88:91], v1, s[4:7], s30 offen sc1
    s_add_u32 s30, s30, s50
    v_cvt_pk_bf16_f32 v92, v176, v177
    v_cvt_pk_bf16_f32 v93, v178, v179
    v_cvt_pk_bf16_f32 v94, v180, v181
    v_cvt_pk_bf16_f32 v95, v182, v183
    buffer_store_dwordx4 v[92:95], v1, s[4:7], s30 offen sc1
    s_add_u32 s30, s30, s50
    s_waitcnt lgkmcnt(0)
    v_or3_b32 v24, v24, v25, v26
    v_or3_b32 v28, v28, v29, v30
    v_or3_b32 v24, v24, v27, v31
    v_or_b32 v24, v24, v28
    s_mov_b32 s28, s51
    v_readfirstlane_b32 s30, v24
    s_cmp_lg_u32 s30, 0
    s_cbranch_scc1 w_drain
    s_mov_b32 s48, s32
    s_cmp_eq_u32 s32, 4
    s_cselect_b32 s30, 2, 3
    s_lshl_b32 s30, s26, s30
    s_mul_i32 s30, s30, s43
    s_add_u32 s49, s42, s30
    s_mov_b32 s50, s43
    s_mov_b32 s51, s46
    s_mov_b32 s23, s41
    s_mov_b32 s53, s41
    s_branch w_first4
w_drain:
    s_waitcnt vmcnt(0)
    s_barrier
    s_cmp_eq_u32 s70, 0
    s_cbranch_scc1 drw_ok
    s_mov_b32 s70, 0
    s_cmp_lg_u32 s3, 0
    s_cbranch_scc1 drw_ok
    v_readfirstlane_b32 s68, v22
    s_cmp_ge_u32 s68, 128
    s_cbranch_scc1 drw_ok
    s_mov_b32 s69, 65536
drw:
    buffer_load_dword v20, off, s[64:67], 0 offset:0 sc1
    s_waitcnt vmcnt(0)
    v_readfirstlane_b32 s68, v20
    s_cmp_ge_u32 s68, 128
    s_cbranch_scc1 drw_ok
    s_sleep 8
    s_sub_u32 s69, s69, 1
    s_cbranch_scc0 drw
drw_ok:
    s_cmp_eq_u32 s28, 0
    s_cbranch_scc1 sig_12
    s_cmp_lg_u32 s3, 0
    s_cbranch_scc1 sig_12
    s_and_b32 s57, s28, 3
    v_mov_b32 v24, s57
    s_bfe_u32 s57, s28, 0x20002
    v_mov_b32 v25, s57
    s_andn2_b32 s28, s28, 15
    s_mov_b64 exec, 1
    buffer_atomic_add_x2 v[24:25], v17, s[4:7], s28 offen sc1
    s_mov_b64 exec, -1
sig_12:
    s_mov_b32 s28, 0
    s_cmp_ge_u32 s53, 4
    s_cbranch_scc1 w_cold
    s_cmp_lg_u32 s3, 0
    s_cbranch_scc1 clm_13
    v_mov_b32 v26, 1
    s_mov_b64 exec, 1
    buffer_atomic_add v26, off, s[64:67], s71 sc0 sc1
    s_mov_b64 exec, -1
clm_13:
    s_waitcnt vmcnt(0)
    s_cmp_lg_u32 s3, 0
    s_cbranch_scc1 pub_14
    v_mov_b32 v20, 131136
    s_mov_b64 exec, 1
    ds_write_b32 v20, v26
    s_mov_b64 exec, -1
    s_waitcnt lgkmcnt(0)
pub_14:
    s_barrier
    v_mov_b32 v20, 131136
    ds_read_b32 v20, v20
    s_waitcnt lgkmcnt(0)
    v_readfirstlane_b32 s59, v20
    s_add_u32 s59, s59, 32
    s_min_u32 s59, s59, 322
    s_lshl_b32 s57, s59, 6
    s_load_dwordx16 s[32:47], s[24:25], s57
    s_waitcnt lgkmcnt(0)
    s_barrier
    s_branch w_cold
w_att:
    s_cmp_lg_u32 s3, 0
    s_cbranch_scc1 w_att_go
    s_mov_b32 s31, 0x40000
w_att_w:
    buffer_load_dwordx2 v[20:21], off, s[4:7], s33 sc1
    s_waitcnt vmcnt(0)
    v_add_u32 v20, v20, v21
    s_nop 0
    v_readfirstlane_b32 s30, v20
    s_cmp_ge_u32 s30, 8
    s_cbranch_scc1 w_att_go
    s_sleep 16
    s_sub_u32 s31, s31, 1
    s_cbranch_scc0 w_att_w
w_att_go:
    s_cmp_lg_u32 s3, 0
    s_cbranch_scc1 clm_15
    v_mov_b32 v250, 1
    s_mov_b64 exec, 1
    buffer_atomic_add v250, off, s[64:67], s71 sc0 sc1
    s_mov_b64 exec, -1
clm_15:
    s_barrier
    v_lshrrev_b32 v20, 4, v1
    v_lshrrev_b32 v21, 4, v20
    v_and_b32 v22, 15, v20
    v_lshlrev_b32 v23, 2, v21
    v_add_u32 v24, 0, v23
    v_cmp_gt_u32 s[72:73], v24, v22
    v_add_u32 v24, 1, v23
    v_cmp_gt_u32 s[74:75], v24, v22
    v_add_u32 v24, 2, v23
    v_cmp_gt_u32 s[76:77], v24, v22
    v_add_u32 v24, 3, v23
    v_cmp_gt_u32 s[78:79], v24, v22
    s_mul_i32 s83, s3, 10240
    v_and_b32 v22, 3, v20
    v_bfe_u32 v24, v20, 2, 2
    v_add_u32 v23, v23, v24
    v_lshl_add_u32 v23, v22, 4, v23
    v_lshlrev_b32 v23, 4, v23
    v_add_u32 v25, s83, v23
    v_and_b32 v24, 1, v24
    v_lshl_add_u32 v24, v21, 1, v24
    v_lshl_add_u32 v24, v22, 3, v24
    v_lshlrev_b32 v24, 4, v24
    v_add_u32 v26, s83, v24
    v_mov_b32 v22, 0xff61b1e6
    v_mov_b32 v136, 0
    v_mov_b32 v137, 0
    v_mov_b32 v220, 0
    v_mov_b32 v221, 0
    s_mov_b32 s80, 0x3e0293ee
    s_lshr_b32 s85, s3, 2
    s_add_u32 s85, s85, s39
    s_lshl_b32 s81, s85, 18
    s_and_b32 s85, s3, 3
    s_add_u32 s85, s85, s36
    s_lshl_b32 s82, s85, 13
    s_add_u32 s82, s82, s81
    s_add_u32 s82, s82, 192937984
    s_lshl_b32 s85, s85, 12
    s_add_u32 s81, s81, s85
    v_mov_b32 v28, 0x3f803f80
    v_mov_b32 v29, 0x3f803f80
    v_mov_b32 v30, 0x3f803f80
    v_mov_b32 v31, 0x3f803f80
    s_add_u32 s86, s82, 0
    buffer_load_dwordx4 v[120:123], v1, s[4:7], s86 offen offset:0 sc1
    buffer_load_dwordx4 v[124:127], v1, s[4:7], s86 offen offset:1024 sc1
    buffer_load_dwordx4 v[128:131], v1, s[4:7], s86 offen offset:2048 sc1
    buffer_load_dwordx4 v[132:135], v1, s[4:7], s86 offen offset:3072 sc1
    s_add_u32 s85, s81, 4194304
    buffer_load_dwordx4 v[56:59], v1, s[4:7], s85 offen offset:0 sc1
    buffer_load_dwordx4 v[60:63], v1, s[4:7], s85 offen offset:1024 sc1
    buffer_load_dwordx4 v[64:67], v1, s[4:7], s85 offen offset:2048 sc1
    buffer_load_dwordx4 v[68:71], v1, s[4:7], s85 offen offset:3072 sc1
    s_add_u32 s85, s81, 4325376
    buffer_load_dwordx4 v[72:75], v1, s[4:7], s85 offen offset:0 sc1
    buffer_load_dwordx4 v[76:79], v1, s[4:7], s85 offen offset:1024 sc1
    buffer_load_dwordx4 v[80:83], v1, s[4:7], s85 offen offset:2048 sc1
    buffer_load_dwordx4 v[84:87], v1, s[4:7], s85 offen offset:3072 sc1
    s_add_u32 s85, s81, 20971520
    buffer_load_dwordx4 v[88:91], v1, s[4:7], s85 offen offset:0 sc1
    buffer_load_dwordx4 v[92:95], v1, s[4:7], s85 offen offset:1024 sc1
    buffer_load_dwordx4 v[96:99], v1, s[4:7], s85 offen offset:2048 sc1
    buffer_load_dwordx4 v[100:103], v1, s[4:7], s85 offen offset:3072 sc1
    s_add_u32 s85, s81, 21102592
    buffer_load_dwordx4 v[104:107], v1, s[4:7], s85 offen offset:0 sc1
    buffer_load_dwordx4 v[108:111], v1, s[4:7], s85 offen offset:1024 sc1
    buffer_load_dwordx4 v[112:115], v1, s[4:7], s85 offen offset:2048 sc1
    buffer_load_dwordx4 v[116:119], v1, s[4:7], s85 offen offset:3072 sc1
    s_add_u32 m0, s83, 0
    s_add_u32 s85, s81, 37748736
    buffer_load_dwordx4 v1, s[4:7], s85 offen offset:0 sc1 lds
    buffer_load_dwordx4 v1, s[4:7], s85 offen offset:1024 sc1 lds
    buffer_load_dwordx4 v1, s[4:7], s85 offen offset:2048 sc1 lds
    buffer_load_dwordx4 v1, s[4:7], s85 offen offset:3072 sc1 lds
    s_add_u32 m0, s83, 4096
    s_add_u32 s85, s81, 37879808
    buffer_load_dwordx4 v1, s[4:7], s85 offen offset:0 sc1 lds
    buffer_load_dwordx4 v1, s[4:7], s85 offen offset:1024 sc1 lds
    buffer_load_dwordx4 v1, s[4:7], s85 offen offset:2048 sc1 lds
    buffer_load_dwordx4 v1, s[4:7], s85 offen offset:3072 sc1 lds
    s_add_u32 m0, s83, 8192
    s_add_u32 s85, s82, 4096
    buffer_load_dwordx4 v1, s[4:7], s85 offen offset:0 sc1 lds
    buffer_load_dwordx4 v1, s[4:7], s85 offen offset:1024 sc1 lds
    s_add_u32 s86, s82, 524288
    buffer_load_dwordx4 v[204:207], v1, s[4:7], s86 offen offset:0 sc1
    buffer_load_dwordx4 v[208:211], v1, s[4:7], s86 offen offset:1024 sc1
    buffer_load_dwordx4 v[212:215], v1, s[4:7], s86 offen offset:2048 sc1
    buffer_load_dwordx4 v[216:219], v1, s[4:7], s86 offen offset:3072 sc1
    s_add_u32 s85, s81, 4718592
    buffer_load_dwordx4 v[140:143], v1, s[4:7], s85 offen offset:0 sc1
    buffer_load_dwordx4 v[144:147], v1, s[4:7], s85 offen offset:1024 sc1
    buffer_load_dwordx4 v[148:151], v1, s[4:7], s85 offen offset:2048 sc1
    buffer_load_dwordx4 v[152:155], v1, s[4:7], s85 offen offset:3072 sc1
    s_add_u32 s85, s81, 4849664
    buffer_load_dwordx4 v[156:159], v1, s[4:7], s85 offen offset:0 sc1
    buffer_load_dwordx4 v[160:163], v1, s[4:7], s85 offen offset:1024 sc1
    buffer_load_dwordx4 v[164:167], v1, s[4:7], s85 offen offset:2048 sc1
    buffer_load_dwordx4 v[168:171], v1, s[4:7], s85 offen offset:3072 sc1
    s_add_u32 s85, s81, 21495808
    buffer_load_dwordx4 v[172:175], v1, s[4:7], s85 offen offset:0 sc1
    buffer_load_dwordx4 v[176:179], v1, s[4:7], s85 offen offset:1024 sc1
    buffer_load_dwordx4 v[180:183], v1, s[4:7], s85 offen offset:2048 sc1
    buffer_load_dwordx4 v[184:187], v1, s[4:7], s85 offen offset:3072 sc1
    s_add_u32 s85, s81, 21626880
    buffer_load_dwordx4 v[188:191], v1, s[4:7], s85 offen offset:0 sc1
    buffer_load_dwordx4 v[192:195], v1, s[4:7], s85 offen offset:1024 sc1
    buffer_load_dwordx4 v[196:199], v1, s[4:7], s85 offen offset:2048 sc1
    buffer_load_dwordx4 v[200:203], v1, s[4:7], s85 offen offset:3072 sc1
    s_add_u32 m0, s83, 81920
    s_add_u32 s85, s81, 38273024
    buffer_load_dwordx4 v1, s[4:7], s85 offen offset:0 sc1 lds
    buffer_load_dwordx4 v1, s[4:7], s85 offen offset:1024 sc1 lds
    buffer_load_dwordx4 v1, s[4:7], s85 offen offset:2048 sc1 lds
    buffer_load_dwordx4 v1, s[4:7], s85 offen offset:3072 sc1 lds
    s_add_u32 m0, s83, 86016
    s_add_u32 s85, s81, 38404096
    buffer_load_dwordx4 v1, s[4:7], s85 offen offset:0 sc1 lds
    buffer_load_dwordx4 v1, s[4:7], s85 offen offset:1024 sc1 lds
    buffer_load_dwordx4 v1, s[4:7], s85 offen offset:2048 sc1 lds
    buffer_load_dwordx4 v1, s[4:7], s85 offen offset:3072 sc1 lds
    s_add_u32 m0, s83, 90112
    s_add_u32 s85, s82, 528384
    buffer_load_dwordx4 v1, s[4:7], s85 offen offset:0 sc1 lds
    buffer_load_dwordx4 v1, s[4:7], s85 offen offset:1024 sc1 lds
    s_waitcnt vmcnt(40)
    v_mfma_f32_16x16x32_bf16 v[32:35], v[88:91], v[56:59], 0
    v_mfma_f32_16x16x32_bf16 v[40:43], v[120:123], v[56:59], 0
    v_mfma_f32_16x16x32_bf16 v[32:35], v[92:95], v[60:63], v[32:35]
    v_mfma_f32_16x16x32_bf16 v[40:43], v[124:127], v[60:63], v[40:43]
    v_mfma_f32_16x16x32_bf16 v[32:35], v[96:99], v[64:67], v[32:35]
    v_mfma_f32_16x16x32_bf16 v[40:43], v[128:131], v[64:67], v[40:43]
    v_mfma_f32_16x16x32_bf16 v[32:35], v[100:103], v[68:71], v[32:35]
    v_mfma_f32_16x16x32_bf16 v[40:43], v[132:135], v[68:71], v[40:43]
    v_mfma_f32_16x16x32_bf16 v[44:47], v[88:91], v[72:75], 0
    v_mfma_f32_16x16x32_bf16 v[48:51], v[104:107], v[72:75], 0
    v_mfma_f32_16x16x32_bf16 v[52:55], v[120:123], v[72:75], 0
    v_mfma_f32_16x16x32_bf16 v[44:47], v[92:95], v[76:79], v[44:47]
    v_mfma_f32_16x16x32_bf16 v[48:51], v[108:111], v[76:79], v[48:51]
    v_mfma_f32_16x16x32_bf16 v[52:55], v[124:127], v[76:79], v[52:55]
    v_mfma_f32_16x16x32_bf16 v[44:47], v[96:99], v[80:83], v[44:47]
    v_mfma_f32_16x16x32_bf16 v[48:51], v[112:115], v[80:83], v[48:51]
    v_mfma_f32_16x16x32_bf16 v[52:55], v[128:131], v[80:83], v[52:55]
    v_mfma_f32_16x16x32_bf16 v[44:47], v[100:103], v[84:87], v[44:47]
    v_mfma_f32_16x16x32_bf16 v[48:51], v[116:119], v[84:87], v[48:51]
    v_mfma_f32_16x16x32_bf16 v[52:55], v[132:135], v[84:87], v[52:55]
    v_cndmask_b32 v32, v32, v22, s[72:73]
    v_cndmask_b32 v33, v33, v22, s[74:75]
    v_cndmask_b32 v34, v34, v22, s[76:77]
    v_cndmask_b32 v35, v35, v22, s[78:79]
    v_max3_f32 v20, v32, v33, v34
    v_max3_f32 v21, v35, v40, v41
    v_max_f32 v20, v20, v21
    v_mov_b32 v21, v20
    s_nop 1
    v_permlane16_swap_b32 v21, v20
    v_max_f32 v20, v20, v21
    v_mov_b32 v21, v20
    s_nop 1
    v_permlane32_swap_b32 v21, v20
    v_max_f32 v20, v20, v21
    v_mul_f32 v20, s80, v20
    v_fma_f32 v32, v32, s80, -v20
    v_fma_f32 v33, v33, s80, -v20
    v_fma_f32 v34, v34, s80, -v20
    v_fma_f32 v35, v35, s80, -v20
    v_fma_f32 v40, v40, s80, -v20
    v_fma_f32 v41, v41, s80, -v20
    v_exp_f32 v32, v32
    v_exp_f32 v33, v33
    v_exp_f32 v34, v34
    v_exp_f32 v35, v35
    v_exp_f32 v40, v40
    v_exp_f32 v41, v41
    s_nop 0
    v_cvt_pk_bf16_f32 v32, v32, v33
    v_cvt_pk_bf16_f32 v33, v34, v35
    v_mov_b32 v34, 0
    v_mov_b32 v35, 0
    v_cvt_pk_bf16_f32 v40, v40, v41
    v_mov_b32 v41, 0
    v_mov_b32 v42, 0
    v_mov_b32 v43, 0
    s_nop 1
    s_waitcnt vmcnt(30)
    ds_read_b64_tr_b16 v[56:57], v25 offset:0
    ds_read_b64_tr_b16 v[58:59], v25 offset:4096
    ds_read_b64_tr_b16 v[120:121], v26 offset:8192
    ds_read_b64_tr_b16 v[60:61], v25 offset:8
    ds_read_b64_tr_b16 v[62:63], v25 offset:4104
    ds_read_b64_tr_b16 v[122:123], v26 offset:8200
    ds_read_b64_tr_b16 v[64:65], v25 offset:1024
    ds_read_b64_tr_b16 v[66:67], v25 offset:5120
    ds_read_b64_tr_b16 v[124:125], v26 offset:8704
    ds_read_b64_tr_b16 v[68:69], v25 offset:1032
    ds_read_b64_tr_b16 v[70:71], v25 offset:5128
    ds_read_b64_tr_b16 v[126:127], v26 offset:8712
    ds_read_b64_tr_b16 v[72:73], v25 offset:2048
    ds_read_b64_tr_b16 v[74:75], v25 offset:6144
    ds_read_b64_tr_b16 v[128:129], v26 offset:9216
    ds_read_b64_tr_b16 v[76:77], v25 offset:2056
    ds_read_b64_tr_b16 v[78:79], v25 offset:6152
    ds_read_b64_tr_b16 v[130:131], v26 offset:9224
    ds_read_b64_tr_b16 v[80:81], v25 offset:3072
    ds_read_b64_tr_b16 v[82:83], v25 offset:7168
    ds_read_b64_tr_b16 v[132:133], v26 offset:9728
    ds_read_b64_tr_b16 v[84:85], v25 offset:3080
    ds_read_b64_tr_b16 v[86:87], v25 offset:7176
    ds_read_b64_tr_b16 v[134:135], v26 offset:9736
    v_cndmask_b32 v48, v48, v22, s[72:73]
    v_cndmask_b32 v49, v49, v22, s[74:75]
    v_cndmask_b32 v50, v50, v22, s[76:77]
    v_cndmask_b32 v51, v51, v22, s[78:79]
    v_max3_f32 v20, v44, v45, v46
    v_max3_f32 v21, v47, v48, v49
    v_max3_f32 v20, v20, v50, v51
    v_max3_f32 v21, v21, v52, v53
    v_max_f32 v20, v20, v21
    v_mov_b32 v21, v20
    s_nop 1
    v_permlane16_swap_b32 v21, v20
    v_max_f32 v20, v20, v21
    v_mov_b32 v21, v20
    s_nop 1
    v_permlane32_swap_b32 v21, v20
    v_max_f32 v20, v20, v21
    v_mul_f32 v20, s80, v20
    v_fma_f32 v44, v44, s80, -v20
    v_fma_f32 v45, v45, s80, -v20
    v_fma_f32 v46, v46, s80, -v20
    v_fma_f32 v47, v47, s80, -v20
    v_fma_f32 v48, v48, s80, -v20
    v_fma_f32 v49, v49, s80, -v20
    v_fma_f32 v50, v50, s80, -v20
    v_fma_f32 v51, v51, s80, -v20
    v_fma_f32 v52, v52, s80, -v20
    v_fma_f32 v53, v53, s80, -v20
    v_exp_f32 v44, v44
    v_exp_f32 v45, v45
    v_exp_f32 v46, v46
    v_exp_f32 v47, v47
    v_exp_f32 v48, v48
    v_exp_f32 v49, v49
    v_exp_f32 v50, v50
    v_exp_f32 v51, v51
    v_exp_f32 v52, v52
    v_exp_f32 v53, v53
    s_nop 0
    v_cvt_pk_bf16_f32 v44, v44, v45
    v_cvt_pk_bf16_f32 v45, v46, v47
    v_cvt_pk_bf16_f32 v46, v48, v49
    v_cvt_pk_bf16_f32 v47, v50, v51
    v_cvt_pk_bf16_f32 v52, v52, v53
    v_mov_b32 v53, 0
    v_mov_b32 v54, 0
    v_mov_b32 v55, 0
    s_nop 1
    s_waitcnt lgkmcnt(0)
    v_mfma_f32_16x16x32_bf16 v[36:39], v[28:31], v[32:35], 0
    v_mfma_f32_16x16x32_bf16 v[36:39], v[28:31], v[40:43], v[36:39]
    v_mfma_f32_16x16x32_bf16 v[88:91], v[56:59], v[32:35], 0
    v_mfma_f32_16x16x32_bf16 v[88:91], v[120:123], v[40:43], v[88:91]
    v_mfma_f32_16x16x32_bf16 v[92:95], v[60:63], v[32:35], 0
    v_mfma_f32_16x16x32_bf16 v[92:95], v[122:125], v[40:43], v[92:95]
    v_mfma_f32_16x16x32_bf16 v[96:99], v[64:67], v[32:35], 0
    v_mfma_f32_16x16x32_bf16 v[96:99], v[124:127], v[40:43], v[96:99]
    v_mfma_f32_16x16x32_bf16 v[100:103], v[68:71], v[32:35], 0
    v_mfma_f32_16x16x32_bf16 v[100:103], v[126:129], v[40:43], v[100:103]
    v_mfma_f32_16x16x32_bf16 v[104:107], v[72:75], v[32:35], 0
    v_mfma_f32_16x16x32_bf16 v[104:107], v[128:131], v[40:43], v[104:107]
    v_mfma_f32_16x16x32_bf16 v[108:111], v[76:79], v[32:35], 0
    v_mfma_f32_16x16x32_bf16 v[108:111], v[130:133], v[40:43], v[108:111]
    v_mfma_f32_16x16x32_bf16 v[112:115], v[80:83], v[32:35], 0
    v_mfma_f32_16x16x32_bf16 v[112:115], v[132:135], v[40:43], v[112:115]
    v_mfma_f32_16x16x32_bf16 v[116:119], v[84:87], v[32:35], 0
    v_mfma_f32_16x16x32_bf16 v[116:119], v[134:137], v[40:43], v[116:119]
    v_rcp_f32 v23, v36
    s_add_u32 s85, s81, 176160768
    v_mul_f32 v88, v88, v23
    v_mul_f32 v89, v89, v23
    v_mul_f32 v90, v90, v23
    v_mul_f32 v91, v91, v23
    v_mul_f32 v92, v92, v23
    v_mul_f32 v93, v93, v23
    v_mul_f32 v94, v94, v23
    v_mul_f32 v95, v95, v23
    v_cvt_pk_bf16_f32 v224, v88, v89
    v_cvt_pk_bf16_f32 v225, v90, v91
    v_cvt_pk_bf16_f32 v226, v92, v93
    v_cvt_pk_bf16_f32 v227, v94, v95
    buffer_store_dwordx4 v[224:227], v1, s[4:7], s85 offen offset:0 sc1
    v_mul_f32 v96, v96, v23
    v_mul_f32 v97, v97, v23
    v_mul_f32 v98, v98, v23
    v_mul_f32 v99, v99, v23
    v_mul_f32 v100, v100, v23
    v_mul_f32 v101, v101, v23
    v_mul_f32 v102, v102, v23
    v_mul_f32 v103, v103, v23
    v_cvt_pk_bf16_f32 v228, v96, v97
    v_cvt_pk_bf16_f32 v229, v98, v99
    v_cvt_pk_bf16_f32 v230, v100, v101
    v_cvt_pk_bf16_f32 v231, v102, v103
    buffer_store_dwordx4 v[228:231], v1, s[4:7], s85 offen offset:1024 sc1
    v_mul_f32 v104, v104, v23
    v_mul_f32 v105, v105, v23
    v_mul_f32 v106, v106, v23
    v_mul_f32 v107, v107, v23
    v_mul_f32 v108, v108, v23
    v_mul_f32 v109, v109, v23
    v_mul_f32 v110, v110, v23
    v_mul_f32 v111, v111, v23
    v_cvt_pk_bf16_f32 v232, v104, v105
    v_cvt_pk_bf16_f32 v233, v106, v107
    v_cvt_pk_bf16_f32 v234, v108, v109
    v_cvt_pk_bf16_f32 v235, v110, v111
    buffer_store_dwordx4 v[232:235], v1, s[4:7], s85 offen offset:2048 sc1
    v_mul_f32 v112, v112, v23
    v_mul_f32 v113, v113, v23
    v_mul_f32 v114, v114, v23
    v_mul_f32 v115, v115, v23
    v_mul_f32 v116, v116, v23
    v_mul_f32 v117, v117, v23
    v_mul_f32 v118, v118, v23
    v_mul_f32 v119, v119, v23
    v_cvt_pk_bf16_f32 v236, v112, v113
    v_cvt_pk_bf16_f32 v237, v114, v115
    v_cvt_pk_bf16_f32 v238, v116, v117
    v_cvt_pk_bf16_f32 v239, v118, v119
    buffer_store_dwordx4 v[236:239], v1, s[4:7], s85 offen offset:3072 sc1
    v_mfma_f32_16x16x32_bf16 v[48:51], v[28:31], v[44:47], 0
    v_mfma_f32_16x16x32_bf16 v[48:51], v[28:31], v[52:55], v[48:51]
    v_mfma_f32_16x16x32_bf16 v[88:91], v[56:59], v[44:47], 0
    v_mfma_f32_16x16x32_bf16 v[88:91], v[120:123], v[52:55], v[88:91]
    v_mfma_f32_16x16x32_bf16 v[92:95], v[60:63], v[44:47], 0
    v_mfma_f32_16x16x32_bf16 v[92:95], v[122:125], v[52:55], v[92:95]
    v_mfma_f32_16x16x32_bf16 v[96:99], v[64:67], v[44:47], 0
    v_mfma_f32_16x16x32_bf16 v[96:99], v[124:127], v[52:55], v[96:99]
    v_mfma_f32_16x16x32_bf16 v[100:103], v[68:71], v[44:47], 0
    v_mfma_f32_16x16x32_bf16 v[100:103], v[126:129], v[52:55], v[100:103]
    v_mfma_f32_16x16x32_bf16 v[104:107], v[72:75], v[44:47], 0
    v_mfma_f32_16x16x32_bf16 v[104:107], v[128:131], v[52:55], v[104:107]
    v_mfma_f32_16x16x32_bf16 v[108:111], v[76:79], v[44:47], 0
    v_mfma_f32_16x16x32_bf16 v[108:111], v[130:133], v[52:55], v[108:111]
    v_mfma_f32_16x16x32_bf16 v[112:115], v[80:83], v[44:47], 0
    v_mfma_f32_16x16x32_bf16 v[112:115], v[132:135], v[52:55], v[112:115]
    v_mfma_f32_16x16x32_bf16 v[116:119], v[84:87], v[44:47], 0
    v_mfma_f32_16x16x32_bf16 v[116:119], v[134:137], v[52:55], v[116:119]
    v_rcp_f32 v23, v48
    s_add_u32 s85, s81, 176291840
    v_mul_f32 v88, v88, v23
    v_mul_f32 v89, v89, v23
    v_mul_f32 v90, v90, v23
    v_mul_f32 v91, v91, v23
    v_mul_f32 v92, v92, v23
    v_mul_f32 v93, v93, v23
    v_mul_f32 v94, v94, v23
    v_mul_f32 v95, v95, v23
    v_cvt_pk_bf16_f32 v224, v88, v89
    v_cvt_pk_bf16_f32 v225, v90, v91
    v_cvt_pk_bf16_f32 v226, v92, v93
    v_cvt_pk_bf16_f32 v227, v94, v95
    buffer_store_dwordx4 v[224:227], v1, s[4:7], s85 offen offset:0 sc1
    v_mul_f32 v96, v96, v23
    v_mul_f32 v97, v97, v23
    v_mul_f32 v98, v98, v23
    v_mul_f32 v99, v99, v23
    v_mul_f32 v100, v100, v23
    v_mul_f32 v101, v101, v23
    v_mul_f32 v102, v102, v23
    v_mul_f32 v103, v103, v23
    v_cvt_pk_bf16_f32 v228, v96, v97
    v_cvt_pk_bf16_f32 v229, v98, v99
    v_cvt_pk_bf16_f32 v230, v100, v101
    v_cvt_pk_bf16_f32 v231, v102, v103
    buffer_store_dwordx4 v[228:231], v1, s[4:7], s85 offen offset:1024 sc1
    v_mul_f32 v104, v104, v23
    v_mul_f32 v105, v105, v23
    v_mul_f32 v106, v106, v23
    v_mul_f32 v107, v107, v23
    v_mul_f32 v108, v108, v23
    v_mul_f32 v109, v109, v23
    v_mul_f32 v110, v110, v23
    v_mul_f32 v111, v111, v23
    v_cvt_pk_bf16_f32 v232, v104, v105
    v_cvt_pk_bf16_f32 v233, v106, v107
    v_cvt_pk_bf16_f32 v234, v108, v109
    v_cvt_pk_bf16_f32 v235, v110, v111
    buffer_store_dwordx4 v[232:235], v1, s[4:7], s85 offen offset:2048 sc1
    v_mul_f32 v112, v112, v23
    v_mul_f32 v113, v113, v23
    v_mul_f32 v114, v114, v23
    v_mul_f32 v115, v115, v23
    v_mul_f32 v116, v116, v23
    v_mul_f32 v117, v117, v23
    v_mul_f32 v118, v118, v23
    v_mul_f32 v119, v119, v23
    v_cvt_pk_bf16_f32 v236, v112, v113
    v_cvt_pk_bf16_f32 v237, v114, v115
    v_cvt_pk_bf16_f32 v238, v116, v117
    v_cvt_pk_bf16_f32 v239, v118, v119
    buffer_store_dwordx4 v[236:239], v1, s[4:7], s85 offen offset:3072 sc1
    s_waitcnt vmcnt(18)
    v_mfma_f32_16x16x32_bf16 v[32:35], v[172:175], v[140:143], 0
    v_mfma_f32_16x16x32_bf16 v[40:43], v[204:207], v[140:143], 0
    v_mfma_f32_16x16x32_bf16 v[32:35], v[176:179], v[144:147], v[32:35]
    v_mfma_f32_16x16x32_bf16 v[40:43], v[208:211], v[144:147], v[40:43]
    v_mfma_f32_16x16x32_bf16 v[32:35], v[180:183], v[148:151], v[32:35]
    v_mfma_f32_16x16x32_bf16 v[40:43], v[212:215], v[148:151], v[40:43]
    v_mfma_f32_16x16x32_bf16 v[32:35], v[184:187], v[152:155], v[32:35]
    v_mfma_f32_16x16x32_bf16 v[40:43], v[216:219], v[152:155], v[40:43]
    v_mfma_f32_16x16x32_bf16 v[44:47], v[172:175], v[156:159], 0
    v_mfma_f32_16x16x32_bf16 v[48:51], v[188:191], v[156:159], 0
    v_mfma_f32_16x16x32_bf16 v[52:55], v[204:207], v[156:159], 0
    v_mfma_f32_16x16x32_bf16 v[44:47], v[176:179], v[160:163], v[44:47]
    v_mfma_f32_16x16x32_bf16 v[48:51], v[192:195], v[160:163], v[48:51]
    v_mfma_f32_16x16x32_bf16 v[52:55], v[208:211], v[160:163], v[52:55]
    v_mfma_f32_16x16x32_bf16 v[44:47], v[180:183], v[164:167], v[44:47]
    v_mfma_f32_16x16x32_bf16 v[48:51], v[196:199], v[164:167], v[48:51]
    v_mfma_f32_16x16x32_bf16 v[52:55], v[212:215], v[164:167], v[52:55]
    v_mfma_f32_16x16x32_bf16 v[44:47], v[184:187], v[168:171], v[44:47]
    v_mfma_f32_16x16x32_bf16 v[48:51], v[200:203], v[168:171], v[48:51]
    v_mfma_f32_16x16x32_bf16 v[52:55], v[216:219], v[168:171], v[52:55]
    v_cndmask_b32 v32, v32, v22, s[72:73]
    v_cndmask_b32 v33, v33, v22, s[74:75]
    v_cndmask_b32 v34, v34, v22, s[76:77]
    v_cndmask_b32 v35, v35, v22, s[78:79]
    v_max3_f32 v20, v32, v33, v34
    v_max3_f32 v21, v35, v40, v41
    v_max_f32 v20, v20, v21
    v_mov_b32 v21, v20
    s_nop 1
    v_permlane16_swap_b32 v21, v20
    v_max_f32 v20, v20, v21
    v_mov_b32 v21, v20
    s_nop 1
    v_permlane32_swap_b32 v21, v20
    v_max_f32 v20, v20, v21
    v_mul_f32 v20, s80, v20
    v_fma_f32 v32, v32, s80, -v20
    v_fma_f32 v33, v33, s80, -v20
    v_fma_f32 v34, v34, s80, -v20
    v_fma_f32 v35, v35, s80, -v20
    v_fma_f32 v40, v40, s80, -v20
    v_fma_f32 v41, v41, s80, -v20
    v_exp_f32 v32, v32
    v_exp_f32 v33, v33
    v_exp_f32 v34, v34
    v_exp_f32 v35, v35
    v_exp_f32 v40, v40
    v_exp_f32 v41, v41
    s_nop 0
    v_cvt_pk_bf16_f32 v32, v32, v33
    v_cvt_pk_bf16_f32 v33, v34, v35
    v_mov_b32 v34, 0
    v_mov_b32 v35, 0
    v_cvt_pk_bf16_f32 v40, v40, v41
    v_mov_b32 v41, 0
    v_mov_b32 v42, 0
    v_mov_b32 v43, 0
    s_nop 1
    s_waitcnt vmcnt(8)
    v_add_u32 v25, 81920, v25
    v_add_u32 v26, 81920, v26
    ds_read_b64_tr_b16 v[140:141], v25 offset:0
    ds_read_b64_tr_b16 v[142:143], v25 offset:4096
    ds_read_b64_tr_b16 v[204:205], v26 offset:8192
    ds_read_b64_tr_b16 v[144:145], v25 offset:8
    ds_read_b64_tr_b16 v[146:147], v25 offset:4104
    ds_read_b64_tr_b16 v[206:207], v26 offset:8200
    ds_read_b64_tr_b16 v[148:149], v25 offset:1024
    ds_read_b64_tr_b16 v[150:151], v25 offset:5120
    ds_read_b64_tr_b16 v[208:209], v26 offset:8704
    ds_read_b64_tr_b16 v[152:153], v25 offset:1032
    ds_read_b64_tr_b16 v[154:155], v25 offset:5128
    ds_read_b64_tr_b16 v[210:211], v26 offset:8712
    ds_read_b64_tr_b16 v[156:157], v25 offset:2048
    ds_read_b64_tr_b16 v[158:159], v25 offset:6144
    ds_read_b64_tr_b16 v[212:213], v26 offset:9216
    ds_read_b64_tr_b16 v[160:161], v25 offset:2056
    ds_read_b64_tr_b16 v[162:163], v25 offset:6152
    ds_read_b64_tr_b16 v[214:215], v26 offset:9224
    ds_read_b64_tr_b16 v[164:165], v25 offset:3072
    ds_read_b64_tr_b16 v[166:167], v25 offset:7168
    ds_read_b64_tr_b16 v[216:217], v26 offset:9728
    ds_read_b64_tr_b16 v[168:169], v25 offset:3080
    ds_read_b64_tr_b16 v[170:171], v25 offset:7176
    ds_read_b64_tr_b16 v[218:219], v26 offset:9736
    v_cndmask_b32 v48, v48, v22, s[72:73]
    v_cndmask_b32 v49, v49, v22, s[74:75]
    v_cndmask_b32 v50, v50, v22, s[76:77]
    v_cndmask_b32 v51, v51, v22, s[78:79]
    v_max3_f32 v20, v44, v45, v46
    v_max3_f32 v21, v47, v48, v49
    v_max3_f32 v20, v20, v50, v51
    v_max3_f32 v21, v21, v52, v53
    v_max_f32 v20, v20, v21
    v_mov_b32 v21, v20
    s_nop 1
    v_permlane16_swap_b32 v21, v20
    v_max_f32 v20, v20, v21
    v_mov_b32 v21, v20
    s_nop 1
    v_permlane32_swap_b32 v21, v20
    v_max_f32 v20, v20, v21
    v_mul_f32 v20, s80, v20
    v_fma_f32 v44, v44, s80, -v20
    v_fma_f32 v45, v45, s80, -v20
    v_fma_f32 v46, v46, s80, -v20
    v_fma_f32 v47, v47, s80, -v20
    v_fma_f32 v48, v48, s80, -v20
    v_fma_f32 v49, v49, s80, -v20
    v_fma_f32 v50, v50, s80, -v20
    v_fma_f32 v51, v51, s80, -v20
    v_fma_f32 v52, v52, s80, -v20
    v_fma_f32 v53, v53, s80, -v20
    v_exp_f32 v44, v44
    v_exp_f32 v45, v45
    v_exp_f32 v46, v46
    v_exp_f32 v47, v47
    v_exp_f32 v48, v48
    v_exp_f32 v49, v49
    v_exp_f32 v50, v50
    v_exp_f32 v51, v51
    v_exp_f32 v52, v52
    v_exp_f32 v53, v53
    s_nop 0
    v_cvt_pk_bf16_f32 v44, v44, v45
    v_cvt_pk_bf16_f32 v45, v46, v47
    v_cvt_pk_bf16_f32 v46, v48, v49
    v_cvt_pk_bf16_f32 v47, v50, v51
    v_cvt_pk_bf16_f32 v52, v52, v53
    v_mov_b32 v53, 0
    v_mov_b32 v54, 0
    v_mov_b32 v55, 0
    s_nop 1
    s_waitcnt lgkmcnt(0)
    v_mfma_f32_16x16x32_bf16 v[36:39], v[28:31], v[32:35], 0
    v_mfma_f32_16x16x32_bf16 v[36:39], v[28:31], v[40:43], v[36:39]
    v_mfma_f32_16x16x32_bf16 v[172:175], v[140:143], v[32:35], 0
    v_mfma_f32_16x16x32_bf16 v[172:175], v[204:207], v[40:43], v[172:175]
    v_mfma_f32_16x16x32_bf16 v[176:179], v[144:147], v[32:35], 0
    v_mfma_f32_16x16x32_bf16 v[176:179], v[206:209], v[40:43], v[176:179]
    v_mfma_f32_16x16x32_bf16 v[180:183], v[148:151], v[32:35], 0
    v_mfma_f32_16x16x32_bf16 v[180:183], v[208:211], v[40:43], v[180:183]
    v_mfma_f32_16x16x32_bf16 v[184:187], v[152:155], v[32:35], 0
    v_mfma_f32_16x16x32_bf16 v[184:187], v[210:213], v[40:43], v[184:187]
    v_mfma_f32_16x16x32_bf16 v[188:191], v[156:159], v[32:35], 0
    v_mfma_f32_16x16x32_bf16 v[188:191], v[212:215], v[40:43], v[188:191]
    v_mfma_f32_16x16x32_bf16 v[192:195], v[160:163], v[32:35], 0
    v_mfma_f32_16x16x32_bf16 v[192:195], v[214:217], v[40:43], v[192:195]
    v_mfma_f32_16x16x32_bf16 v[196:199], v[164:167], v[32:35], 0
    v_mfma_f32_16x16x32_bf16 v[196:199], v[216:219], v[40:43], v[196:199]
    v_mfma_f32_16x16x32_bf16 v[200:203], v[168:171], v[32:35], 0
    v_mfma_f32_16x16x32_bf16 v[200:203], v[218:221], v[40:43], v[200:203]
    v_rcp_f32 v23, v36
    s_add_u32 s85, s81, 176685056
    v_mul_f32 v172, v172, v23
    v_mul_f32 v173, v173, v23
    v_mul_f32 v174, v174, v23
    v_mul_f32 v175, v175, v23
    v_mul_f32 v176, v176, v23
    v_mul_f32 v177, v177, v23
    v_mul_f32 v178, v178, v23
    v_mul_f32 v179, v179, v23
    v_cvt_pk_bf16_f32 v224, v172, v173
    v_cvt_pk_bf16_f32 v225, v174, v175
    v_cvt_pk_bf16_f32 v226, v176, v177
    v_cvt_pk_bf16_f32 v227, v178, v179
    buffer_store_dwordx4 v[224:227], v1, s[4:7], s85 offen offset:0 sc1
    v_mul_f32 v180, v180, v23
    v_mul_f32 v181, v181, v23
    v_mul_f32 v182, v182, v23
    v_mul_f32 v183, v183, v23
    v_mul_f32 v184, v184, v23
    v_mul_f32 v185, v185, v23
    v_mul_f32 v186, v186, v23
    v_mul_f32 v187, v187, v23
    v_cvt_pk_bf16_f32 v228, v180, v181
    v_cvt_pk_bf16_f32 v229, v182, v183
    v_cvt_pk_bf16_f32 v230, v184, v185
    v_cvt_pk_bf16_f32 v231, v186, v187
    buffer_store_dwordx4 v[228:231], v1, s[4:7], s85 offen offset:1024 sc1
    v_mul_f32 v188, v188, v23
    v_mul_f32 v189, v189, v23
    v_mul_f32 v190, v190, v23
    v_mul_f32 v191, v191, v23
    v_mul_f32 v192, v192, v23
    v_mul_f32 v193, v193, v23
    v_mul_f32 v194, v194, v23
    v_mul_f32 v195, v195, v23
    v_cvt_pk_bf16_f32 v232, v188, v189
    v_cvt_pk_bf16_f32 v233, v190, v191
    v_cvt_pk_bf16_f32 v234, v192, v193
    v_cvt_pk_bf16_f32 v235, v194, v195
    buffer_store_dwordx4 v[232:235], v1, s[4:7], s85 offen offset:2048 sc1
    v_mul_f32 v196, v196, v23
    v_mul_f32 v197, v197, v23
    v_mul_f32 v198, v198, v23
    v_mul_f32 v199, v199, v23
    v_mul_f32 v200, v200, v23
    v_mul_f32 v201, v201, v23
    v_mul_f32 v202, v202, v23
    v_mul_f32 v203, v203, v23
    v_cvt_pk_bf16_f32 v236, v196, v197
    v_cvt_pk_bf16_f32 v237, v198, v199
    v_cvt_pk_bf16_f32 v238, v200, v201
    v_cvt_pk_bf16_f32 v239, v202, v203
    buffer_store_dwordx4 v[236:239], v1, s[4:7], s85 offen offset:3072 sc1
    v_mfma_f32_16x16x32_bf16 v[48:51], v[28:31], v[44:47], 0
    v_mfma_f32_16x16x32_bf16 v[48:51], v[28:31], v[52:55], v[48:51]
    v_mfma_f32_16x16x32_bf16 v[172:175], v[140:143], v[44:47], 0
    v_mfma_f32_16x16x32_bf16 v[172:175], v[204:207], v[52:55], v[172:175]
    v_mfma_f32_16x16x32_bf16 v[176:179], v[144:147], v[44:47], 0
    v_mfma_f32_16x16x32_bf16 v[176:179], v[206:209], v[52:55], v[176:179]
    v_mfma_f32_16x16x32_bf16 v[180:183], v[148:151], v[44:47], 0
    v_mfma_f32_16x16x32_bf16 v[180:183], v[208:211], v[52:55], v[180:183]
    v_mfma_f32_16x16x32_bf16 v[184:187], v[152:155], v[44:47], 0
    v_mfma_f32_16x16x32_bf16 v[184:187], v[210:213], v[52:55], v[184:187]
    v_mfma_f32_16x16x32_bf16 v[188:191], v[156:159], v[44:47], 0
    v_mfma_f32_16x16x32_bf16 v[188:191], v[212:215], v[52:55], v[188:191]
    v_mfma_f32_16x16x32_bf16 v[192:195], v[160:163], v[44:47], 0
    v_mfma_f32_16x16x32_bf16 v[192:195], v[214:217], v[52:55], v[192:195]
    v_mfma_f32_16x16x32_bf16 v[196:199], v[164:167], v[44:47], 0
    v_mfma_f32_16x16x32_bf16 v[196:199], v[216:219], v[52:55], v[196:199]
    v_mfma_f32_16x16x32_bf16 v[200:203], v[168:171], v[44:47], 0
    v_mfma_f32_16x16x32_bf16 v[200:203], v[218:221], v[52:55], v[200:203]
    v_rcp_f32 v23, v48
    s_add_u32 s85, s81, 176816128
    v_mul_f32 v172, v172, v23
    v_mul_f32 v173, v173, v23
    v_mul_f32 v174, v174, v23
    v_mul_f32 v175, v175, v23
    v_mul_f32 v176, v176, v23
    v_mul_f32 v177, v177, v23
    v_mul_f32 v178, v178, v23
    v_mul_f32 v179, v179, v23
    v_cvt_pk_bf16_f32 v224, v172, v173
    v_cvt_pk_bf16_f32 v225, v174, v175
    v_cvt_pk_bf16_f32 v226, v176, v177
    v_cvt_pk_bf16_f32 v227, v178, v179
    buffer_store_dwordx4 v[224:227], v1, s[4:7], s85 offen offset:0 sc1
    v_mul_f32 v180, v180, v23
    v_mul_f32 v181, v181, v23
    v_mul_f32 v182, v182, v23
    v_mul_f32 v183, v183, v23
    v_mul_f32 v184, v184, v23
    v_mul_f32 v185, v185, v23
    v_mul_f32 v186, v186, v23
    v_mul_f32 v187, v187, v23
    v_cvt_pk_bf16_f32 v228, v180, v181
    v_cvt_pk_bf16_f32 v229, v182, v183
    v_cvt_pk_bf16_f32 v230, v184, v185
    v_cvt_pk_bf16_f32 v231, v186, v187
    buffer_store_dwordx4 v[228:231], v1, s[4:7], s85 offen offset:1024 sc1
    v_mul_f32 v188, v188, v23
    v_mul_f32 v189, v189, v23
    v_mul_f32 v190, v190, v23
    v_mul_f32 v191, v191, v23
    v_mul_f32 v192, v192, v23
    v_mul_f32 v193, v193, v23
    v_mul_f32 v194, v194, v23
    v_mul_f32 v195, v195, v23
    v_cvt_pk_bf16_f32 v232, v188, v189
    v_cvt_pk_bf16_f32 v233, v190, v191
    v_cvt_pk_bf16_f32 v234, v192, v193
    v_cvt_pk_bf16_f32 v235, v194, v195
    buffer_store_dwordx4 v[232:235], v1, s[4:7], s85 offen offset:2048 sc1
    v_mul_f32 v196, v196, v23
    v_mul_f32 v197, v197, v23
    v_mul_f32 v198, v198, v23
    v_mul_f32 v199, v199, v23
    v_mul_f32 v200, v200, v23
    v_mul_f32 v201, v201, v23
    v_mul_f32 v202, v202, v23
    v_mul_f32 v203, v203, v23
    v_cvt_pk_bf16_f32 v236, v196, v197
    v_cvt_pk_bf16_f32 v237, v198, v199
    v_cvt_pk_bf16_f32 v238, v200, v201
    v_cvt_pk_bf16_f32 v239, v202, v203
    buffer_store_dwordx4 v[236:239], v1, s[4:7], s85 offen offset:3072 sc1
    s_mov_b32 s28, s46
    s_waitcnt vmcnt(0)
    s_barrier
    s_cmp_eq_u32 s28, 0
    s_cbranch_scc1 sig_16
    s_cmp_lg_u32 s3, 0
    s_cbranch_scc1 sig_16
    s_and_b32 s57, s28, 3
    v_mov_b32 v24, s57
    s_bfe_u32 s57, s28, 0x20002
    v_mov_b32 v25, s57
    s_andn2_b32 s28, s28, 15
    s_mov_b64 exec, 1
    buffer_atomic_add_x2 v[24:25], v17, s[4:7], s28 offen sc1
    s_mov_b64 exec, -1
sig_16:
    s_mov_b32 s28, 0
    s_cmp_lg_u32 s3, 0
    s_cbranch_scc1 pub_17
    v_mov_b32 v20, 131136
    s_mov_b64 exec, 1
    ds_write_b32 v20, v250
    s_mov_b64 exec, -1
    s_waitcnt lgkmcnt(0)
pub_17:
    s_barrier
    v_mov_b32 v20, 131136
    ds_read_b32 v20, v20
    s_waitcnt lgkmcnt(0)
    v_readfirstlane_b32 s59, v20
    s_add_u32 s59, s59, 32
    s_min_u32 s59, s59, 322
    s_lshl_b32 s57, s59, 6
    s_load_dwordx16 s[32:47], s[24:25], s57
    s_waitcnt lgkmcnt(0)
    s_branch w_cold
w_fin:
    s_load_dwordx2 s[8:9], s[0:1], 0
    s_load_dwordx2 s[12:13], s[0:1], 88
    v_mbcnt_lo_u32_b32 v1, -1, 0
    v_mbcnt_hi_u32_b32 v1, -1, v1
    s_mov_b32 s10, 4194304
    s_mov_b32 s11, 131072
    s_mov_b32 s14, 4194304
    s_mov_b32 s15, 131072
    s_mov_b32 s89, 0xbfb8aa3b
    v_lshlrev_b32 v3, 4, v1
    v_and_b32 v4, 15, v1
    v_lshrrev_b32 v5, 4, v1
    v_lshlrev_b32 v4, 11, v4
    v_lshl_add_u32 v4, v5, 4, v4
    v_and_b32 v5, 1, v5
    v_cmp_eq_u32 s[76:77], 1, v5
    v_and_b32 v6, 3, v1
    v_lshlrev_b32 v6, 7, v6
    s_mov_b32 s80, s39
    s_lshl_b32 s81, s36, 2
    s_and_b32 s82, s3, 3
    s_add_u32 s81, s81, s82
    s_lshr_b32 s82, s3, 2
    s_mov_b32 s84, 65536
    s_mov_b32 s85, 218112000
    s_waitcnt lgkmcnt(0)
    s_cmp_eq_u32 s32, 7
    s_cbranch_scc1 fin_tail
fin_job:
    s_lshl_b32 s72, s80, 1
    s_add_u32 s72, s72, s82
    s_lshl_b32 s74, s72, 15
    s_lshl_b32 s73, s81, 11
    s_add_u32 s73, s73, s74
    s_lshl_b32 s75, s81, 7
    s_add_u32 s74, s74, s75
    s_add_u32 s78, s73, 117440512
    s_add_u32 s79, s73, 75497472
    s_lshr_b32 s83, s80, 3
    s_lshl_b32 s83, s83, 6
    s_add_u32 s83, s83, 218106368
    s_add_u32 s87, s80, 2
    buffer_load_dwordx4 v[88:91], v4, s[8:11], s74 offen offset:0
    buffer_load_dwordx4 v[92:95], v4, s[8:11], s74 offen offset:64
    s_cmp_lg_u32 s80, s39
    s_cbranch_scc1 fin_again
    s_cmp_lg_u32 s3, 0
    s_cbranch_scc1 fin_ws_ok
fin_wd:
    buffer_load_dwordx2 v[8:9], off, s[4:7], s83 sc1
    s_waitcnt vmcnt(0)
    v_readfirstlane_b32 s86, v8
    v_readfirstlane_b32 s88, v9
    s_cmp_ge_u32 s88, s37
    s_cselect_b32 s86, s86, 0
    s_cmp_ge_u32 s86, 16
    s_cbranch_scc1 fin_wd2
    s_sleep 64
    s_sub_u32 s84, s84, 1
    s_cbranch_scc0 fin_wd
    s_mov_b32 s84, 0
fin_wd2:
    s_cmp_lg_u32 s37, 0
    s_cbranch_scc1 fin_ws_ok
fin_ws:
    buffer_load_dword v7, v6, s[4:7], s85 offen sc1
    s_waitcnt vmcnt(0)
    v_cmp_gt_u32 vcc, s87, v7
    s_cbranch_vccz fin_ws_ok
    s_sleep 12
    s_sub_u32 s86, s87, 2
    v_cmp_gt_i32 vcc, s86, v7
    s_cbranch_vccz fin_ws_f
    s_sleep 64
    s_sub_u32 s86, s87, 6
    v_cmp_gt_i32 vcc, s86, v7
    s_cbranch_vccz fin_ws_f
    s_sleep 127
    s_sleep 127
fin_ws_f:
    s_sub_u32 s84, s84, 1
    s_cbranch_scc0 fin_ws
    s_mov_b32 s84, 0
fin_ws_ok:
    s_cmp_lg_u32 s3, 0
    s_cbranch_scc1 clm_18
    v_mov_b32 v250, 1
    s_mov_b64 exec, 1
    buffer_atomic_add v250, off, s[64:67], s71 sc0 sc1
    s_mov_b64 exec, -1
clm_18:
    s_barrier
fin_again:
    buffer_load_dwordx4 v[136:139], v3, s[4:7], s78 offen offset:0 sc1
    buffer_load_dwordx4 v[140:143], v3, s[4:7], s78 offen offset:1024 sc1
    s_add_u32 s78, s78, 4194304
    buffer_load_dwordx4 v[144:147], v3, s[4:7], s78 offen offset:0 sc1
    buffer_load_dwordx4 v[148:151], v3, s[4:7], s78 offen offset:1024 sc1
    s_add_u32 s78, s78, 4194304
    s_cmp_lg_u32 s33, 0
    s_cbranch_scc1 fin_g2
    buffer_load_dwordx4 v[152:155], v3, s[4:7], s78 offen offset:0 sc1
    buffer_load_dwordx4 v[156:159], v3, s[4:7], s78 offen offset:1024 sc1
    s_add_u32 s78, s78, 4194304
    buffer_load_dwordx4 v[160:163], v3, s[4:7], s78 offen offset:0 sc1
    buffer_load_dwordx4 v[164:167], v3, s[4:7], s78 offen offset:1024 sc1
    s_add_u32 s78, s78, 4194304
    s_branch fin_g4
fin_g2:
    v_mov_b32 v152, 0
    v_mov_b32 v153, 0
    v_mov_b32 v154, 0
    v_mov_b32 v155, 0
    v_mov_b32 v156, 0
    v_mov_b32 v157, 0
    v_mov_b32 v158, 0
    v_mov_b32 v159, 0
    v_mov_b32 v160, 0
    v_mov_b32 v161, 0
    v_mov_b32 v162, 0
    v_mov_b32 v163, 0
    v_mov_b32 v164, 0
    v_mov_b32 v165, 0
    v_mov_b32 v166, 0
    v_mov_b32 v167, 0
fin_g4:
    buffer_load_dwordx4 v[16:19], v3, s[4:7], s79 offen offset:0 sc1
    buffer_load_dwordx4 v[48:51], v3, s[4:7], s79 offen offset:1024 sc1
    s_add_u32 s79, s79, 4194304
    buffer_load_dwordx4 v[20:23], v3, s[4:7], s79 offen offset:0 sc1
    buffer_load_dwordx4 v[52:55], v3, s[4:7], s79 offen offset:1024 sc1
    s_add_u32 s79, s79, 4194304
    s_cmp_ge_u32 s35, 2
    s_cbranch_scc1 fin_2p
    buffer_load_dwordx4 v[24:27], v3, s[4:7], s79 offen offset:0 sc1
    buffer_load_dwordx4 v[56:59], v3, s[4:7], s79 offen offset:1024 sc1
    s_add_u32 s79, s79, 4194304
    buffer_load_dwordx4 v[28:31], v3, s[4:7], s79 offen offset:0 sc1
    buffer_load_dwordx4 v[60:63], v3, s[4:7], s79 offen offset:1024 sc1
    s_add_u32 s79, s79, 4194304
    s_cmp_ge_u32 s35, 1
    s_cbranch_scc1 fin_4p
    buffer_load_dwordx4 v[32:35], v3, s[4:7], s79 offen offset:0 sc1
    buffer_load_dwordx4 v[64:67], v3, s[4:7], s79 offen offset:1024 sc1
    s_add_u32 s79, s79, 4194304
    buffer_load_dwordx4 v[36:39], v3, s[4:7], s79 offen offset:0 sc1
    buffer_load_dwordx4 v[68:71], v3, s[4:7], s79 offen offset:1024 sc1
    s_add_u32 s79, s79, 4194304
    buffer_load_dwordx4 v[40:43], v3, s[4:7], s79 offen offset:0 sc1
    buffer_load_dwordx4 v[72:75], v3, s[4:7], s79 offen offset:1024 sc1
    s_add_u32 s79, s79, 4194304
    buffer_load_dwordx4 v[44:47], v3, s[4:7], s79 offen offset:0 sc1
    buffer_load_dwordx4 v[76:79], v3, s[4:7], s79 offen offset:1024 sc1
    s_add_u32 s79, s79, 4194304
    s_waitcnt vmcnt(16)
    s_branch fin_8p
fin_2p:
    v_mov_b32 v24, 0
    v_mov_b32 v25, 0
    v_mov_b32 v26, 0
    v_mov_b32 v27, 0
    v_mov_b32 v28, 0
    v_mov_b32 v29, 0
    v_mov_b32 v30, 0
    v_mov_b32 v31, 0
    v_mov_b32 v32, 0
    v_mov_b32 v33, 0
    v_mov_b32 v34, 0
    v_mov_b32 v35, 0
    v_mov_b32 v36, 0
    v_mov_b32 v37, 0
    v_mov_b32 v38, 0
    v_mov_b32 v39, 0
    v_mov_b32 v40, 0
    v_mov_b32 v41, 0
    v_mov_b32 v42, 0
    v_mov_b32 v43, 0
    v_mov_b32 v44, 0
    v_mov_b32 v45, 0
    v_mov_b32 v46, 0
    v_mov_b32 v47, 0
    v_mov_b32 v56, 0
    v_mov_b32 v57, 0
    v_mov_b32 v58, 0
    v_mov_b32 v59, 0
    v_mov_b32 v60, 0
    v_mov_b32 v61, 0
    v_mov_b32 v62, 0
    v_mov_b32 v63, 0
    v_mov_b32 v64, 0
    v_mov_b32 v65, 0
    v_mov_b32 v66, 0
    v_mov_b32 v67, 0
    v_mov_b32 v68, 0
    v_mov_b32 v69, 0
    v_mov_b32 v70, 0
    v_mov_b32 v71, 0
    v_mov_b32 v72, 0
    v_mov_b32 v73, 0
    v_mov_b32 v74, 0
    v_mov_b32 v75, 0
    v_mov_b32 v76, 0
    v_mov_b32 v77, 0
    v_mov_b32 v78, 0
    v_mov_b32 v79, 0
    s_waitcnt vmcnt(4)
    s_branch fin_8p
fin_4p:
    v_mov_b32 v32, 0
    v_mov_b32 v33, 0
    v_mov_b32 v34, 0
    v_mov_b32 v35, 0
    v_mov_b32 v36, 0
    v_mov_b32 v37, 0
    v_mov_b32 v38, 0
    v_mov_b32 v39, 0
    v_mov_b32 v40, 0
    v_mov_b32 v41, 0
    v_mov_b32 v42, 0
    v_mov_b32 v43, 0
    v_mov_b32 v44, 0
    v_mov_b32 v45, 0
    v_mov_b32 v46, 0
    v_mov_b32 v47, 0
    v_mov_b32 v64, 0
    v_mov_b32 v65, 0
    v_mov_b32 v66, 0
    v_mov_b32 v67, 0
    v_mov_b32 v68, 0
    v_mov_b32 v69, 0
    v_mov_b32 v70, 0
    v_mov_b32 v71, 0
    v_mov_b32 v72, 0
    v_mov_b32 v73, 0
    v_mov_b32 v74, 0
    v_mov_b32 v75, 0
    v_mov_b32 v76, 0
    v_mov_b32 v77, 0
    v_mov_b32 v78, 0
    v_mov_b32 v79, 0
    s_waitcnt vmcnt(8)
fin_8p:
    v_lshlrev_b32 v120, 16, v136
    v_and_b32 v121, 0xffff0000, v136
    v_lshlrev_b32 v136, 16, v144
    v_and_b32 v144, 0xffff0000, v144
    v_add_f32 v120, v120, v136
    v_add_f32 v121, v121, v144
    v_lshlrev_b32 v136, 16, v152
    v_and_b32 v152, 0xffff0000, v152
    v_add_f32 v120, v120, v136
    v_add_f32 v121, v121, v152
    v_lshlrev_b32 v136, 16, v160
    v_and_b32 v160, 0xffff0000, v160
    v_add_f32 v120, v120, v136
    v_add_f32 v121, v121, v160
    v_cvt_pk_bf16_f32 v136, v120, v121
    v_lshlrev_b32 v120, 16, v136
    v_and_b32 v121, 0xffff0000, v136
    v_mul_f32 v136, s89, v120
    v_mul_f32 v144, s89, v121
    v_lshlrev_b32 v122, 16, v137
    v_and_b32 v123, 0xffff0000, v137
    v_lshlrev_b32 v137, 16, v145
    v_and_b32 v145, 0xffff0000, v145
    v_add_f32 v122, v122, v137
    v_add_f32 v123, v123, v145
    v_lshlrev_b32 v137, 16, v153
    v_and_b32 v153, 0xffff0000, v153
    v_add_f32 v122, v122, v137
    v_add_f32 v123, v123, v153
    v_lshlrev_b32 v137, 16, v161
    v_and_b32 v161, 0xffff0000, v161
    v_add_f32 v122, v122, v137
    v_add_f32 v123, v123, v161
    v_cvt_pk_bf16_f32 v137, v122, v123
    v_lshlrev_b32 v122, 16, v137
    v_and_b32 v123, 0xffff0000, v137
    v_mul_f32 v137, s89, v122
    v_mul_f32 v145, s89, v123
    v_lshlrev_b32 v124, 16, v138
    v_and_b32 v125, 0xffff0000, v138
    v_lshlrev_b32 v138, 16, v146
    v_and_b32 v146, 0xffff0000, v146
    v_add_f32 v124, v124, v138
    v_add_f32 v125, v125, v146
    v_lshlrev_b32 v138, 16, v154
    v_and_b32 v154, 0xffff0000, v154
    v_add_f32 v124, v124, v138
    v_add_f32 v125, v125, v154
    v_lshlrev_b32 v138, 16, v162
    v_and_b32 v162, 0xffff0000, v162
    v_add_f32 v124, v124, v138
    v_add_f32 v125, v125, v162
    v_cvt_pk_bf16_f32 v138, v124, v125
    v_lshlrev_b32 v124, 16, v138
    v_and_b32 v125, 0xffff0000, v138
    v_mul_f32 v138, s89, v124
    v_mul_f32 v146, s89, v125
    v_lshlrev_b32 v126, 16, v139
    v_and_b32 v127, 0xffff0000, v139
    v_lshlrev_b32 v139, 16, v147
    v_and_b32 v147, 0xffff0000, v147
    v_add_f32 v126, v126, v139
    v_add_f32 v127, v127, v147
    v_lshlrev_b32 v139, 16, v155
    v_and_b32 v155, 0xffff0000, v155
    v_add_f32 v126, v126, v139
    v_add_f32 v127, v127, v155
    v_lshlrev_b32 v139, 16, v163
    v_and_b32 v163, 0xffff0000, v163
    v_add_f32 v126, v126, v139
    v_add_f32 v127, v127, v163
    v_cvt_pk_bf16_f32 v139, v126, v127
    v_lshlrev_b32 v126, 16, v139
    v_and_b32 v127, 0xffff0000, v139
    v_mul_f32 v139, s89, v126
    v_mul_f32 v147, s89, v127
    v_exp_f32 v136, v136
    v_exp_f32 v144, v144
    v_exp_f32 v137, v137
    v_exp_f32 v145, v145
    v_exp_f32 v138, v138
    v_exp_f32 v146, v146
    v_exp_f32 v139, v139
    v_exp_f32 v147, v147
    s_nop 0
    v_add_f32 v136, 1.0, v136
    v_add_f32 v144, 1.0, v144
    v_add_f32 v137, 1.0, v137
    v_add_f32 v145, 1.0, v145
    v_add_f32 v138, 1.0, v138
    v_add_f32 v146, 1.0, v146
    v_add_f32 v139, 1.0, v139
    v_add_f32 v147, 1.0, v147
    v_rcp_f32 v136, v136
    v_rcp_f32 v144, v144
    v_rcp_f32 v137, v137
    v_rcp_f32 v145, v145
    v_rcp_f32 v138, v138
    v_rcp_f32 v146, v146
    v_rcp_f32 v139, v139
    v_rcp_f32 v147, v147
    s_nop 0
    v_mul_f32 v120, v120, v136
    v_mul_f32 v121, v121, v144
    v_cvt_pk_bf16_f32 v136, v120, v121
    v_mul_f32 v122, v122, v137
    v_mul_f32 v123, v123, v145
    v_cvt_pk_bf16_f32 v137, v122, v123
    v_mul_f32 v124, v124, v138
    v_mul_f32 v125, v125, v146
    v_cvt_pk_bf16_f32 v138, v124, v125
    v_mul_f32 v126, v126, v139
    v_mul_f32 v127, v127, v147
    v_cvt_pk_bf16_f32 v139, v126, v127
    v_lshlrev_b32 v120, 16, v140
    v_and_b32 v121, 0xffff0000, v140
    v_lshlrev_b32 v140, 16, v148
    v_and_b32 v148, 0xffff0000, v148
    v_add_f32 v120, v120, v140
    v_add_f32 v121, v121, v148
    v_lshlrev_b32 v140, 16, v156
    v_and_b32 v156, 0xffff0000, v156
    v_add_f32 v120, v120, v140
    v_add_f32 v121, v121, v156
    v_lshlrev_b32 v140, 16, v164
    v_and_b32 v164, 0xffff0000, v164
    v_add_f32 v120, v120, v140
    v_add_f32 v121, v121, v164
    v_cvt_pk_bf16_f32 v140, v120, v121
    v_lshlrev_b32 v120, 16, v140
    v_and_b32 v121, 0xffff0000, v140
    v_mul_f32 v140, s89, v120
    v_mul_f32 v148, s89, v121
    v_lshlrev_b32 v122, 16, v141
    v_and_b32 v123, 0xffff0000, v141
    v_lshlrev_b32 v141, 16, v149
    v_and_b32 v149, 0xffff0000, v149
    v_add_f32 v122, v122, v141
    v_add_f32 v123, v123, v149
    v_lshlrev_b32 v141, 16, v157
    v_and_b32 v157, 0xffff0000, v157
    v_add_f32 v122, v122, v141
    v_add_f32 v123, v123, v157
    v_lshlrev_b32 v141, 16, v165
    v_and_b32 v165, 0xffff0000, v165
    v_add_f32 v122, v122, v141
    v_add_f32 v123, v123, v165
    v_cvt_pk_bf16_f32 v141, v122, v123
    v_lshlrev_b32 v122, 16, v141
    v_and_b32 v123, 0xffff0000, v141
    v_mul_f32 v141, s89, v122
    v_mul_f32 v149, s89, v123
    v_lshlrev_b32 v124, 16, v142
    v_and_b32 v125, 0xffff0000, v142
    v_lshlrev_b32 v142, 16, v150
    v_and_b32 v150, 0xffff0000, v150
    v_add_f32 v124, v124, v142
    v_add_f32 v125, v125, v150
    v_lshlrev_b32 v142, 16, v158
    v_and_b32 v158, 0xffff0000, v158
    v_add_f32 v124, v124, v142
    v_add_f32 v125, v125, v158
    v_lshlrev_b32 v142, 16, v166
    v_and_b32 v166, 0xffff0000, v166
    v_add_f32 v124, v124, v142
    v_add_f32 v125, v125, v166
    v_cvt_pk_bf16_f32 v142, v124, v125
    v_lshlrev_b32 v124, 16, v142
    v_and_b32 v125, 0xffff0000, v142
    v_mul_f32 v142, s89, v124
    v_mul_f32 v150, s89, v125
    v_lshlrev_b32 v126, 16, v143
    v_and_b32 v127, 0xffff0000, v143
    v_lshlrev_b32 v143, 16, v151
    v_and_b32 v151, 0xffff0000, v151
    v_add_f32 v126, v126, v143
    v_add_f32 v127, v127, v151
    v_lshlrev_b32 v143, 16, v159
    v_and_b32 v159, 0xffff0000, v159
    v_add_f32 v126, v126, v143
    v_add_f32 v127, v127, v159
    v_lshlrev_b32 v143, 16, v167
    v_and_b32 v167, 0xffff0000, v167
    v_add_f32 v126, v126, v143
    v_add_f32 v127, v127, v167
    v_cvt_pk_bf16_f32 v143, v126, v127
    v_lshlrev_b32 v126, 16, v143
    v_and_b32 v127, 0xffff0000, v143
    v_mul_f32 v143, s89, v126
    v_mul_f32 v151, s89, v127
    v_exp_f32 v140, v140
    v_exp_f32 v148, v148
    v_exp_f32 v141, v141
    v_exp_f32 v149, v149
    v_exp_f32 v142, v142
    v_exp_f32 v150, v150
    v_exp_f32 v143, v143
    v_exp_f32 v151, v151
    s_nop 0
    v_add_f32 v140, 1.0, v140
    v_add_f32 v148, 1.0, v148
    v_add_f32 v141, 1.0, v141
    v_add_f32 v149, 1.0, v149
    v_add_f32 v142, 1.0, v142
    v_add_f32 v150, 1.0, v150
    v_add_f32 v143, 1.0, v143
    v_add_f32 v151, 1.0, v151
    v_rcp_f32 v140, v140
    v_rcp_f32 v148, v148
    v_rcp_f32 v141, v141
    v_rcp_f32 v149, v149
    v_rcp_f32 v142, v142
    v_rcp_f32 v150, v150
    v_rcp_f32 v143, v143
    v_rcp_f32 v151, v151
    s_nop 0
    v_mul_f32 v120, v120, v140
    v_mul_f32 v121, v121, v148
    v_cvt_pk_bf16_f32 v140, v120, v121
    v_mul_f32 v122, v122, v141
    v_mul_f32 v123, v123, v149
    v_cvt_pk_bf16_f32 v141, v122, v123
    v_mul_f32 v124, v124, v142
    v_mul_f32 v125, v125, v150
    v_cvt_pk_bf16_f32 v142, v124, v125
    v_mul_f32 v126, v126, v143
    v_mul_f32 v127, v127, v151
    v_cvt_pk_bf16_f32 v143, v126, v127
    s_waitcnt vmcnt(0)
    v_lshlrev_b32 v96, 16, v16
    v_and_b32 v97, 0xffff0000, v16
    v_lshlrev_b32 v98, 16, v17
    v_and_b32 v99, 0xffff0000, v17
    v_lshlrev_b32 v100, 16, v18
    v_and_b32 v101, 0xffff0000, v18
    v_lshlrev_b32 v102, 16, v19
    v_and_b32 v103, 0xffff0000, v19
    v_lshlrev_b32 v120, 16, v20
    v_and_b32 v121, 0xffff0000, v20
    v_lshlrev_b32 v122, 16, v21
    v_and_b32 v123, 0xffff0000, v21
    v_lshlrev_b32 v124, 16, v22
    v_and_b32 v125, 0xffff0000, v22
    v_lshlrev_b32 v126, 16, v23
    v_and_b32 v127, 0xffff0000, v23
    v_add_f32 v96, v96, v120
    v_add_f32 v97, v97, v121
    v_add_f32 v98, v98, v122
    v_add_f32 v99, v99, v123
    v_add_f32 v100, v100, v124
    v_add_f32 v101, v101, v125
    v_add_f32 v102, v102, v126
    v_add_f32 v103, v103, v127
    v_lshlrev_b32 v120, 16, v24
    v_and_b32 v121, 0xffff0000, v24
    v_lshlrev_b32 v122, 16, v25
    v_and_b32 v123, 0xffff0000, v25
    v_lshlrev_b32 v124, 16, v26
    v_and_b32 v125, 0xffff0000, v26
    v_lshlrev_b32 v126, 16, v27
    v_and_b32 v127, 0xffff0000, v27
    v_add_f32 v96, v96, v120
    v_add_f32 v97, v97, v121
    v_add_f32 v98, v98, v122
    v_add_f32 v99, v99, v123
    v_add_f32 v100, v100, v124
    v_add_f32 v101, v101, v125
    v_add_f32 v102, v102, v126
    v_add_f32 v103, v103, v127
    v_lshlrev_b32 v120, 16, v28
    v_and_b32 v121, 0xffff0000, v28
    v_lshlrev_b32 v122, 16, v29
    v_and_b32 v123, 0xffff0000, v29
    v_lshlrev_b32 v124, 16, v30
    v_and_b32 v125, 0xffff0000, v30
    v_lshlrev_b32 v126, 16, v31
    v_and_b32 v127, 0xffff0000, v31
    v_add_f32 v96, v96, v120
    v_add_f32 v97, v97, v121
    v_add_f32 v98, v98, v122
    v_add_f32 v99, v99, v123
    v_add_f32 v100, v100, v124
    v_add_f32 v101, v101, v125
    v_add_f32 v102, v102, v126
    v_add_f32 v103, v103, v127
    v_lshlrev_b32 v120, 16, v32
    v_and_b32 v121, 0xffff0000, v32
    v_lshlrev_b32 v122, 16, v33
    v_and_b32 v123, 0xffff0000, v33
    v_lshlrev_b32 v124, 16, v34
    v_and_b32 v125, 0xffff0000, v34
    v_lshlrev_b32 v126, 16, v35
    v_and_b32 v127, 0xffff0000, v35
    v_add_f32 v96, v96, v120
    v_add_f32 v97, v97, v121
    v_add_f32 v98, v98, v122
    v_add_f32 v99, v99, v123
    v_add_f32 v100, v100, v124
    v_add_f32 v101, v101, v125
    v_add_f32 v102, v102, v126
    v_add_f32 v103, v103, v127
    v_lshlrev_b32 v120, 16, v36
    v_and_b32 v121, 0xffff0000, v36
    v_lshlrev_b32 v122, 16, v37
    v_and_b32 v123, 0xffff0000, v37
    v_lshlrev_b32 v124, 16, v38
    v_and_b32 v125, 0xffff0000, v38
    v_lshlrev_b32 v126, 16, v39
    v_and_b32 v127, 0xffff0000, v39
    v_add_f32 v96, v96, v120
    v_add_f32 v97, v97, v121
    v_add_f32 v98, v98, v122
    v_add_f32 v99, v99, v123
    v_add_f32 v100, v100, v124
    v_add_f32 v101, v101, v125
    v_add_f32 v102, v102, v126
    v_add_f32 v103, v103, v127
    v_lshlrev_b32 v120, 16, v40
    v_and_b32 v121, 0xffff0000, v40
    v_lshlrev_b32 v122, 16, v41
    v_and_b32 v123, 0xffff0000, v41
    v_lshlrev_b32 v124, 16, v42
    v_and_b32 v125, 0xffff0000, v42
    v_lshlrev_b32 v126, 16, v43
    v_and_b32 v127, 0xffff0000, v43
    v_add_f32 v96, v96, v120
    v_add_f32 v97, v97, v121
    v_add_f32 v98, v98, v122
    v_add_f32 v99, v99, v123
    v_add_f32 v100, v100, v124
    v_add_f32 v101, v101, v125
    v_add_f32 v102, v102, v126
    v_add_f32 v103, v103, v127
    v_lshlrev_b32 v120, 16, v44
    v_and_b32 v121, 0xffff0000, v44
    v_lshlrev_b32 v122, 16, v45
    v_and_b32 v123, 0xffff0000, v45
    v_lshlrev_b32 v124, 16, v46
    v_and_b32 v125, 0xffff0000, v46
    v_lshlrev_b32 v126, 16, v47
    v_and_b32 v127, 0xffff0000, v47
    v_add_f32 v96, v96, v120
    v_add_f32 v97, v97, v121
    v_add_f32 v98, v98, v122
    v_add_f32 v99, v99, v123
    v_add_f32 v100, v100, v124
    v_add_f32 v101, v101, v125
    v_add_f32 v102, v102, v126
    v_add_f32 v103, v103, v127
    v_cndmask_b32 v108, v88, v90, s[76:77]
    v_cndmask_b32 v109, v89, v91, s[76:77]
    v_cndmask_b32 v110, v90, v88, s[76:77]
    v_cndmask_b32 v111, v91, v89, s[76:77]
    v_cvt_pk_bf16_f32 v104, v96, v97
    v_lshlrev_b32 v96, 16, v104
    v_and_b32 v97, 0xffff0000, v104
    v_lshlrev_b32 v104, 16, v136
    v_and_b32 v105, 0xffff0000, v136
    v_mul_f32 v96, v96, v104
    v_mul_f32 v97, v97, v105
    v_cvt_pk_bf16_f32 v104, v96, v97
    v_lshlrev_b32 v96, 16, v104
    v_and_b32 v97, 0xffff0000, v104
    v_lshlrev_b32 v104, 16, v108
    v_and_b32 v105, 0xffff0000, v108
    v_add_f32 v96, v96, v104
    v_add_f32 v97, v97, v105
    v_cvt_pk_bf16_f32 v112, v96, v97
    v_cvt_pk_bf16_f32 v104, v98, v99
    v_lshlrev_b32 v98, 16, v104
    v_and_b32 v99, 0xffff0000, v104
    v_lshlrev_b32 v104, 16, v137
    v_and_b32 v105, 0xffff0000, v137
    v_mul_f32 v98, v98, v104
    v_mul_f32 v99, v99, v105
    v_cvt_pk_bf16_f32 v104, v98, v99
    v_lshlrev_b32 v98, 16, v104
    v_and_b32 v99, 0xffff0000, v104
    v_lshlrev_b32 v104, 16, v109
    v_and_b32 v105, 0xffff0000, v109
    v_add_f32 v98, v98, v104
    v_add_f32 v99, v99, v105
    v_cvt_pk_bf16_f32 v113, v98, v99
    v_cvt_pk_bf16_f32 v104, v100, v101
    v_lshlrev_b32 v100, 16, v104
    v_and_b32 v101, 0xffff0000, v104
    v_lshlrev_b32 v104, 16, v138
    v_and_b32 v105, 0xffff0000, v138
    v_mul_f32 v100, v100, v104
    v_mul_f32 v101, v101, v105
    v_cvt_pk_bf16_f32 v104, v100, v101
    v_lshlrev_b32 v100, 16, v104
    v_and_b32 v101, 0xffff0000, v104
    v_lshlrev_b32 v104, 16, v110
    v_and_b32 v105, 0xffff0000, v110
    v_add_f32 v100, v100, v104
    v_add_f32 v101, v101, v105
    v_cvt_pk_bf16_f32 v114, v100, v101
    v_cvt_pk_bf16_f32 v104, v102, v103
    v_lshlrev_b32 v102, 16, v104
    v_and_b32 v103, 0xffff0000, v104
    v_lshlrev_b32 v104, 16, v139
    v_and_b32 v105, 0xffff0000, v139
    v_mul_f32 v102, v102, v104
    v_mul_f32 v103, v103, v105
    v_cvt_pk_bf16_f32 v104, v102, v103
    v_lshlrev_b32 v102, 16, v104
    v_and_b32 v103, 0xffff0000, v104
    v_lshlrev_b32 v104, 16, v111
    v_and_b32 v105, 0xffff0000, v111
    v_add_f32 v102, v102, v104
    v_add_f32 v103, v103, v105
    v_cvt_pk_bf16_f32 v115, v102, v103
    v_cndmask_b32 v128, v112, v114, s[76:77]
    v_cndmask_b32 v129, v113, v115, s[76:77]
    v_cndmask_b32 v130, v114, v112, s[76:77]
    v_cndmask_b32 v131, v115, v113, s[76:77]
    buffer_store_dwordx4 v[128:131], v4, s[12:15], s74 offen offset:0
    v_lshlrev_b32 v96, 16, v48
    v_and_b32 v97, 0xffff0000, v48
    v_lshlrev_b32 v98, 16, v49
    v_and_b32 v99, 0xffff0000, v49
    v_lshlrev_b32 v100, 16, v50
    v_and_b32 v101, 0xffff0000, v50
    v_lshlrev_b32 v102, 16, v51
    v_and_b32 v103, 0xffff0000, v51
    v_lshlrev_b32 v120, 16, v52
    v_and_b32 v121, 0xffff0000, v52
    v_lshlrev_b32 v122, 16, v53
    v_and_b32 v123, 0xffff0000, v53
    v_lshlrev_b32 v124, 16, v54
    v_and_b32 v125, 0xffff0000, v54
    v_lshlrev_b32 v126, 16, v55
    v_and_b32 v127, 0xffff0000, v55
    v_add_f32 v96, v96, v120
    v_add_f32 v97, v97, v121
    v_add_f32 v98, v98, v122
    v_add_f32 v99, v99, v123
    v_add_f32 v100, v100, v124
    v_add_f32 v101, v101, v125
    v_add_f32 v102, v102, v126
    v_add_f32 v103, v103, v127
    v_lshlrev_b32 v120, 16, v56
    v_and_b32 v121, 0xffff0000, v56
    v_lshlrev_b32 v122, 16, v57
    v_and_b32 v123, 0xffff0000, v57
    v_lshlrev_b32 v124, 16, v58
    v_and_b32 v125, 0xffff0000, v58
    v_lshlrev_b32 v126, 16, v59
    v_and_b32 v127, 0xffff0000, v59
    v_add_f32 v96, v96, v120
    v_add_f32 v97, v97, v121
    v_add_f32 v98, v98, v122
    v_add_f32 v99, v99, v123
    v_add_f32 v100, v100, v124
    v_add_f32 v101, v101, v125
    v_add_f32 v102, v102, v126
    v_add_f32 v103, v103, v127
    v_lshlrev_b32 v120, 16, v60
    v_and_b32 v121, 0xffff0000, v60
    v_lshlrev_b32 v122, 16, v61
    v_and_b32 v123, 0xffff0000, v61
    v_lshlrev_b32 v124, 16, v62
    v_and_b32 v125, 0xffff0000, v62
    v_lshlrev_b32 v126, 16, v63
    v_and_b32 v127, 0xffff0000, v63
    v_add_f32 v96, v96, v120
    v_add_f32 v97, v97, v121
    v_add_f32 v98, v98, v122
    v_add_f32 v99, v99, v123
    v_add_f32 v100, v100, v124
    v_add_f32 v101, v101, v125
    v_add_f32 v102, v102, v126
    v_add_f32 v103, v103, v127
    v_lshlrev_b32 v120, 16, v64
    v_and_b32 v121, 0xffff0000, v64
    v_lshlrev_b32 v122, 16, v65
    v_and_b32 v123, 0xffff0000, v65
    v_lshlrev_b32 v124, 16, v66
    v_and_b32 v125, 0xffff0000, v66
    v_lshlrev_b32 v126, 16, v67
    v_and_b32 v127, 0xffff0000, v67
    v_add_f32 v96, v96, v120
    v_add_f32 v97, v97, v121
    v_add_f32 v98, v98, v122
    v_add_f32 v99, v99, v123
    v_add_f32 v100, v100, v124
    v_add_f32 v101, v101, v125
    v_add_f32 v102, v102, v126
    v_add_f32 v103, v103, v127
    v_lshlrev_b32 v120, 16, v68
    v_and_b32 v121, 0xffff0000, v68
    v_lshlrev_b32 v122, 16, v69
    v_and_b32 v123, 0xffff0000, v69
    v_lshlrev_b32 v124, 16, v70
    v_and_b32 v125, 0xffff0000, v70
    v_lshlrev_b32 v126, 16, v71
    v_and_b32 v127, 0xffff0000, v71
    v_add_f32 v96, v96, v120
    v_add_f32 v97, v97, v121
    v_add_f32 v98, v98, v122
    v_add_f32 v99, v99, v123
    v_add_f32 v100, v100, v124
    v_add_f32 v101, v101, v125
    v_add_f32 v102, v102, v126
    v_add_f32 v103, v103, v127
    v_lshlrev_b32 v120, 16, v72
    v_and_b32 v121, 0xffff0000, v72
    v_lshlrev_b32 v122, 16, v73
    v_and_b32 v123, 0xffff0000, v73
    v_lshlrev_b32 v124, 16, v74
    v_and_b32 v125, 0xffff0000, v74
    v_lshlrev_b32 v126, 16, v75
    v_and_b32 v127, 0xffff0000, v75
    v_add_f32 v96, v96, v120
    v_add_f32 v97, v97, v121
    v_add_f32 v98, v98, v122
    v_add_f32 v99, v99, v123
    v_add_f32 v100, v100, v124
    v_add_f32 v101, v101, v125
    v_add_f32 v102, v102, v126
    v_add_f32 v103, v103, v127
    v_lshlrev_b32 v120, 16, v76
    v_and_b32 v121, 0xffff0000, v76
    v_lshlrev_b32 v122, 16, v77
    v_and_b32 v123, 0xffff0000, v77
    v_lshlrev_b32 v124, 16, v78
    v_and_b32 v125, 0xffff0000, v78
    v_lshlrev_b32 v126, 16, v79
    v_and_b32 v127, 0xffff0000, v79
    v_add_f32 v96, v96, v120
    v_add_f32 v97, v97, v121
    v_add_f32 v98, v98, v122
    v_add_f32 v99, v99, v123
    v_add_f32 v100, v100, v124
    v_add_f32 v101, v101, v125
    v_add_f32 v102, v102, v126
    v_add_f32 v103, v103, v127
    v_cndmask_b32 v108, v92, v94, s[76:77]
    v_cndmask_b32 v109, v93, v95, s[76:77]
    v_cndmask_b32 v110, v94, v92, s[76:77]
    v_cndmask_b32 v111, v95, v93, s[76:77]
    v_cvt_pk_bf16_f32 v104, v96, v97
    v_lshlrev_b32 v96, 16, v104
    v_and_b32 v97, 0xffff0000, v104
    v_lshlrev_b32 v104, 16, v140
    v_and_b32 v105, 0xffff0000, v140
    v_mul_f32 v96, v96, v104
    v_mul_f32 v97, v97, v105
    v_cvt_pk_bf16_f32 v104, v96, v97
    v_lshlrev_b32 v96, 16, v104
    v_and_b32 v97, 0xffff0000, v104
    v_lshlrev_b32 v104, 16, v108
    v_and_b32 v105, 0xffff0000, v108
    v_add_f32 v96, v96, v104
    v_add_f32 v97, v97, v105
    v_cvt_pk_bf16_f32 v112, v96, v97
    v_cvt_pk_bf16_f32 v104, v98, v99
    v_lshlrev_b32 v98, 16, v104
    v_and_b32 v99, 0xffff0000, v104
    v_lshlrev_b32 v104, 16, v141
    v_and_b32 v105, 0xffff0000, v141
    v_mul_f32 v98, v98, v104
    v_mul_f32 v99, v99, v105
    v_cvt_pk_bf16_f32 v104, v98, v99
    v_lshlrev_b32 v98, 16, v104
    v_and_b32 v99, 0xffff0000, v104
    v_lshlrev_b32 v104, 16, v109
    v_and_b32 v105, 0xffff0000, v109
    v_add_f32 v98, v98, v104
    v_add_f32 v99, v99, v105
    v_cvt_pk_bf16_f32 v113, v98, v99
    v_cvt_pk_bf16_f32 v104, v100, v101
    v_lshlrev_b32 v100, 16, v104
    v_and_b32 v101, 0xffff0000, v104
    v_lshlrev_b32 v104, 16, v142
    v_and_b32 v105, 0xffff0000, v142
    v_mul_f32 v100, v100, v104
    v_mul_f32 v101, v101, v105
    v_cvt_pk_bf16_f32 v104, v100, v101
    v_lshlrev_b32 v100, 16, v104
    v_and_b32 v101, 0xffff0000, v104
    v_lshlrev_b32 v104, 16, v110
    v_and_b32 v105, 0xffff0000, v110
    v_add_f32 v100, v100, v104
    v_add_f32 v101, v101, v105
    v_cvt_pk_bf16_f32 v114, v100, v101
    v_cvt_pk_bf16_f32 v104, v102, v103
    v_lshlrev_b32 v102, 16, v104
    v_and_b32 v103, 0xffff0000, v104
    v_lshlrev_b32 v104, 16, v143
    v_and_b32 v105, 0xffff0000, v143
    v_mul_f32 v102, v102, v104
    v_mul_f32 v103, v103, v105
    v_cvt_pk_bf16_f32 v104, v102, v103
    v_lshlrev_b32 v102, 16, v104
    v_and_b32 v103, 0xffff0000, v104
    v_lshlrev_b32 v104, 16, v111
    v_and_b32 v105, 0xffff0000, v111
    v_add_f32 v102, v102, v104
    v_add_f32 v103, v103, v105
    v_cvt_pk_bf16_f32 v115, v102, v103
    v_cndmask_b32 v132, v112, v114, s[76:77]
    v_cndmask_b32 v133, v113, v115, s[76:77]
    v_cndmask_b32 v134, v114, v112, s[76:77]
    v_cndmask_b32 v135, v115, v113, s[76:77]
    buffer_store_dwordx4 v[132:135], v4, s[12:15], s74 offen offset:64
    s_add_u32 s80, s80, 1
    s_cmp_le_u32 s80, s34
    s_cbranch_scc1 fin_job
    s_branch w_fin_done
fin_tail:
    s_mov_b32 s81, s36
    s_lshl_b32 s81, s81, 2
    s_and_b32 s82, s3, 3
    s_add_u32 s81, s81, s82
    s_lshr_b32 s82, s81, 5
    s_and_b32 s81, s81, 31
    s_lshl_b32 s72, s80, 1
    s_add_u32 s72, s72, s82
    s_lshl_b32 s74, s72, 15
    s_lshl_b32 s73, s81, 10
    s_add_u32 s73, s73, s74
    s_lshl_b32 s75, s81, 6
    s_add_u32 s74, s74, s75
    s_add_u32 s78, s73, 117440512
    s_add_u32 s79, s73, 75497472
    s_mov_b32 s83, 218106816
    s_mov_b32 s84, 65536
    s_min_u32 s87, s80, 62
    v_and_b32 v8, 7, v1
    v_lshlrev_b32 v8, 22, v8
    s_cmp_lg_u32 s3, 0
    s_cbranch_scc1 ft_ok
ft_wd:
    buffer_load_dword v7, off, s[4:7], s83 sc1
    s_waitcnt vmcnt(0)
    v_readfirstlane_b32 s86, v7
    s_cmp_ge_u32 s86, 16
    s_cbranch_scc1 ft_wdok
    s_sleep 32
    s_sub_u32 s84, s84, 1
    s_cbranch_scc0 ft_wd
    s_mov_b32 s84, 0
ft_wdok:
ft_ok:
    s_barrier
    s_cmp_ge_u32 s3, 4
    s_cbranch_scc1 w_fin_done
    buffer_load_dwordx4 v[88:91], v4, s[8:11], s74 offen
    buffer_load_dwordx4 v[136:139], v3, s[4:7], s78 offen sc1
    s_add_u32 s78, s78, 4194304
    buffer_load_dwordx4 v[144:147], v3, s[4:7], s78 offen sc1
    s_add_u32 s78, s78, 4194304
    buffer_load_dwordx4 v[152:155], v3, s[4:7], s78 offen sc1
    s_add_u32 s78, s78, 4194304
    buffer_load_dwordx4 v[160:163], v3, s[4:7], s78 offen sc1
    s_add_u32 s78, s78, 4194304
    s_waitcnt vmcnt(0)
    v_lshlrev_b32 v120, 16, v136
    v_and_b32 v121, 0xffff0000, v136
    v_lshlrev_b32 v136, 16, v144
    v_and_b32 v144, 0xffff0000, v144
    v_add_f32 v120, v120, v136
    v_add_f32 v121, v121, v144
    v_lshlrev_b32 v136, 16, v152
    v_and_b32 v152, 0xffff0000, v152
    v_add_f32 v120, v120, v136
    v_add_f32 v121, v121, v152
    v_lshlrev_b32 v136, 16, v160
    v_and_b32 v160, 0xffff0000, v160
    v_add_f32 v120, v120, v136
    v_add_f32 v121, v121, v160
    v_cvt_pk_bf16_f32 v136, v120, v121
    v_lshlrev_b32 v120, 16, v136
    v_and_b32 v121, 0xffff0000, v136
    v_mul_f32 v136, s89, v120
    v_mul_f32 v144, s89, v121
    v_lshlrev_b32 v122, 16, v137
    v_and_b32 v123, 0xffff0000, v137
    v_lshlrev_b32 v137, 16, v145
    v_and_b32 v145, 0xffff0000, v145
    v_add_f32 v122, v122, v137
    v_add_f32 v123, v123, v145
    v_lshlrev_b32 v137, 16, v153
    v_and_b32 v153, 0xffff0000, v153
    v_add_f32 v122, v122, v137
    v_add_f32 v123, v123, v153
    v_lshlrev_b32 v137, 16, v161
    v_and_b32 v161, 0xffff0000, v161
    v_add_f32 v122, v122, v137
    v_add_f32 v123, v123, v161
    v_cvt_pk_bf16_f32 v137, v122, v123
    v_lshlrev_b32 v122, 16, v137
    v_and_b32 v123, 0xffff0000, v137
    v_mul_f32 v137, s89, v122
    v_mul_f32 v145, s89, v123
    v_lshlrev_b32 v124, 16, v138
    v_and_b32 v125, 0xffff0000, v138
    v_lshlrev_b32 v138, 16, v146
    v_and_b32 v146, 0xffff0000, v146
    v_add_f32 v124, v124, v138
    v_add_f32 v125, v125, v146
    v_lshlrev_b32 v138, 16, v154
    v_and_b32 v154, 0xffff0000, v154
    v_add_f32 v124, v124, v138
    v_add_f32 v125, v125, v154
    v_lshlrev_b32 v138, 16, v162
    v_and_b32 v162, 0xffff0000, v162
    v_add_f32 v124, v124, v138
    v_add_f32 v125, v125, v162
    v_cvt_pk_bf16_f32 v138, v124, v125
    v_lshlrev_b32 v124, 16, v138
    v_and_b32 v125, 0xffff0000, v138
    v_mul_f32 v138, s89, v124
    v_mul_f32 v146, s89, v125
    v_lshlrev_b32 v126, 16, v139
    v_and_b32 v127, 0xffff0000, v139
    v_lshlrev_b32 v139, 16, v147
    v_and_b32 v147, 0xffff0000, v147
    v_add_f32 v126, v126, v139
    v_add_f32 v127, v127, v147
    v_lshlrev_b32 v139, 16, v155
    v_and_b32 v155, 0xffff0000, v155
    v_add_f32 v126, v126, v139
    v_add_f32 v127, v127, v155
    v_lshlrev_b32 v139, 16, v163
    v_and_b32 v163, 0xffff0000, v163
    v_add_f32 v126, v126, v139
    v_add_f32 v127, v127, v163
    v_cvt_pk_bf16_f32 v139, v126, v127
    v_lshlrev_b32 v126, 16, v139
    v_and_b32 v127, 0xffff0000, v139
    v_mul_f32 v139, s89, v126
    v_mul_f32 v147, s89, v127
    v_exp_f32 v136, v136
    v_exp_f32 v144, v144
    v_exp_f32 v137, v137
    v_exp_f32 v145, v145
    v_exp_f32 v138, v138
    v_exp_f32 v146, v146
    v_exp_f32 v139, v139
    v_exp_f32 v147, v147
    s_nop 0
    v_add_f32 v136, 1.0, v136
    v_add_f32 v144, 1.0, v144
    v_add_f32 v137, 1.0, v137
    v_add_f32 v145, 1.0, v145
    v_add_f32 v138, 1.0, v138
    v_add_f32 v146, 1.0, v146
    v_add_f32 v139, 1.0, v139
    v_add_f32 v147, 1.0, v147
    v_rcp_f32 v136, v136
    v_rcp_f32 v144, v144
    v_rcp_f32 v137, v137
    v_rcp_f32 v145, v145
    v_rcp_f32 v138, v138
    v_rcp_f32 v146, v146
    v_rcp_f32 v139, v139
    v_rcp_f32 v147, v147
    s_nop 0
    v_mul_f32 v120, v120, v136
    v_mul_f32 v121, v121, v144
    v_cvt_pk_bf16_f32 v136, v120, v121
    v_mul_f32 v122, v122, v137
    v_mul_f32 v123, v123, v145
    v_cvt_pk_bf16_f32 v137, v122, v123
    v_mul_f32 v124, v124, v138
    v_mul_f32 v125, v125, v146
    v_cvt_pk_bf16_f32 v138, v124, v125
    v_mul_f32 v126, v126, v139
    v_mul_f32 v127, v127, v147
    v_cvt_pk_bf16_f32 v139, v126, v127
ft_ws:
    buffer_load_dword v7, v6, s[4:7], s85 offen sc1
    s_waitcnt vmcnt(0)
    v_cmp_gt_u32 vcc, s87, v7
    s_cbranch_vccz ft_p
    s_sleep 12
    v_cmp_gt_u32 vcc, 59, v7
    s_cbranch_vccz ft_wsf
    s_sleep 64
    v_cmp_gt_u32 vcc, 56, v7
    s_cbranch_vccz ft_wsf
    s_sleep 127
    s_sleep 127
ft_wsf:
    s_sub_u32 s84, s84, 1
    s_cbranch_scc0 ft_ws
    s_mov_b32 s84, 0
ft_p:
    buffer_load_dword v7, v8, s[4:7], s79 offen offset:1008 sc1
    s_waitcnt vmcnt(0)
    v_cmp_eq_u32 vcc, -1, v7
    s_cbranch_vccz ft_l0
    s_sleep 4
    s_sub_u32 s84, s84, 1
    s_cbranch_scc0 ft_p
    s_mov_b32 s84, 0
ft_l0:
    s_cmp_lg_u32 s3, 0
    s_cbranch_scc1 clm_19
    v_mov_b32 v250, 1
    s_mov_b64 exec, 1
    buffer_atomic_add v250, off, s[64:67], s71 sc0 sc1
    s_mov_b64 exec, -1
clm_19:
ft_l:
    s_mov_b32 s86, s79
    buffer_load_dwordx4 v[16:19], v3, s[4:7], s86 offen sc1
    s_add_u32 s86, s86, 4194304
    buffer_load_dwordx4 v[20:23], v3, s[4:7], s86 offen sc1
    s_add_u32 s86, s86, 4194304
    buffer_load_dwordx4 v[24:27], v3, s[4:7], s86 offen sc1
    s_add_u32 s86, s86, 4194304
    buffer_load_dwordx4 v[28:31], v3, s[4:7], s86 offen sc1
    s_add_u32 s86, s86, 4194304
    buffer_load_dwordx4 v[32:35], v3, s[4:7], s86 offen sc1
    s_add_u32 s86, s86, 4194304
    buffer_load_dwordx4 v[36:39], v3, s[4:7], s86 offen sc1
    s_add_u32 s86, s86, 4194304
    buffer_load_dwordx4 v[40:43], v3, s[4:7], s86 offen sc1
    s_add_u32 s86, s86, 4194304
    buffer_load_dwordx4 v[44:47], v3, s[4:7], s86 offen sc1
    s_waitcnt vmcnt(0)
    v_max3_u32 v7, v16, v20, v24
    v_max3_u32 v7, v7, v28, v32
    v_max3_u32 v7, v7, v36, v40
    v_max_u32 v7, v7, v44
    v_cmp_eq_u32 vcc, -1, v7
    s_cbranch_vccz ft_go
    s_sleep 0
    s_sub_u32 s84, s84, 1
    s_cbranch_scc0 ft_l
ft_go:
    v_lshlrev_b32 v96, 16, v16
    v_and_b32 v97, 0xffff0000, v16
    v_lshlrev_b32 v98, 16, v17
    v_and_b32 v99, 0xffff0000, v17
    v_lshlrev_b32 v100, 16, v18
    v_and_b32 v101, 0xffff0000, v18
    v_lshlrev_b32 v102, 16, v19
    v_and_b32 v103, 0xffff0000, v19
    v_lshlrev_b32 v120, 16, v20
    v_and_b32 v121, 0xffff0000, v20
    v_lshlrev_b32 v122, 16, v21
    v_and_b32 v123, 0xffff0000, v21
    v_lshlrev_b32 v124, 16, v22
    v_and_b32 v125, 0xffff0000, v22
    v_lshlrev_b32 v126, 16, v23
    v_and_b32 v127, 0xffff0000, v23
    v_add_f32 v96, v96, v120
    v_add_f32 v97, v97, v121
    v_add_f32 v98, v98, v122
    v_add_f32 v99, v99, v123
    v_add_f32 v100, v100, v124
    v_add_f32 v101, v101, v125
    v_add_f32 v102, v102, v126
    v_add_f32 v103, v103, v127
    v_lshlrev_b32 v120, 16, v24
    v_and_b32 v121, 0xffff0000, v24
    v_lshlrev_b32 v122, 16, v25
    v_and_b32 v123, 0xffff0000, v25
    v_lshlrev_b32 v124, 16, v26
    v_and_b32 v125, 0xffff0000, v26
    v_lshlrev_b32 v126, 16, v27
    v_and_b32 v127, 0xffff0000, v27
    v_add_f32 v96, v96, v120
    v_add_f32 v97, v97, v121
    v_add_f32 v98, v98, v122
    v_add_f32 v99, v99, v123
    v_add_f32 v100, v100, v124
    v_add_f32 v101, v101, v125
    v_add_f32 v102, v102, v126
    v_add_f32 v103, v103, v127
    v_lshlrev_b32 v120, 16, v28
    v_and_b32 v121, 0xffff0000, v28
    v_lshlrev_b32 v122, 16, v29
    v_and_b32 v123, 0xffff0000, v29
    v_lshlrev_b32 v124, 16, v30
    v_and_b32 v125, 0xffff0000, v30
    v_lshlrev_b32 v126, 16, v31
    v_and_b32 v127, 0xffff0000, v31
    v_add_f32 v96, v96, v120
    v_add_f32 v97, v97, v121
    v_add_f32 v98, v98, v122
    v_add_f32 v99, v99, v123
    v_add_f32 v100, v100, v124
    v_add_f32 v101, v101, v125
    v_add_f32 v102, v102, v126
    v_add_f32 v103, v103, v127
    v_lshlrev_b32 v120, 16, v32
    v_and_b32 v121, 0xffff0000, v32
    v_lshlrev_b32 v122, 16, v33
    v_and_b32 v123, 0xffff0000, v33
    v_lshlrev_b32 v124, 16, v34
    v_and_b32 v125, 0xffff0000, v34
    v_lshlrev_b32 v126, 16, v35
    v_and_b32 v127, 0xffff0000, v35
    v_add_f32 v96, v96, v120
    v_add_f32 v97, v97, v121
    v_add_f32 v98, v98, v122
    v_add_f32 v99, v99, v123
    v_add_f32 v100, v100, v124
    v_add_f32 v101, v101, v125
    v_add_f32 v102, v102, v126
    v_add_f32 v103, v103, v127
    v_lshlrev_b32 v120, 16, v36
    v_and_b32 v121, 0xffff0000, v36
    v_lshlrev_b32 v122, 16, v37
    v_and_b32 v123, 0xffff0000, v37
    v_lshlrev_b32 v124, 16, v38
    v_and_b32 v125, 0xffff0000, v38
    v_lshlrev_b32 v126, 16, v39
    v_and_b32 v127, 0xffff0000, v39
    v_add_f32 v96, v96, v120
    v_add_f32 v97, v97, v121
    v_add_f32 v98, v98, v122
    v_add_f32 v99, v99, v123
    v_add_f32 v100, v100, v124
    v_add_f32 v101, v101, v125
    v_add_f32 v102, v102, v126
    v_add_f32 v103, v103, v127
    v_lshlrev_b32 v120, 16, v40
    v_and_b32 v121, 0xffff0000, v40
    v_lshlrev_b32 v122, 16, v41
    v_and_b32 v123, 0xffff0000, v41
    v_lshlrev_b32 v124, 16, v42
    v_and_b32 v125, 0xffff0000, v42
    v_lshlrev_b32 v126, 16, v43
    v_and_b32 v127, 0xffff0000, v43
    v_add_f32 v96, v96, v120
    v_add_f32 v97, v97, v121
    v_add_f32 v98, v98, v122
    v_add_f32 v99, v99, v123
    v_add_f32 v100, v100, v124
    v_add_f32 v101, v101, v125
    v_add_f32 v102, v102, v126
    v_add_f32 v103, v103, v127
    v_lshlrev_b32 v120, 16, v44
    v_and_b32 v121, 0xffff0000, v44
    v_lshlrev_b32 v122, 16, v45
    v_and_b32 v123, 0xffff0000, v45
    v_lshlrev_b32 v124, 16, v46
    v_and_b32 v125, 0xffff0000, v46
    v_lshlrev_b32 v126, 16, v47
    v_and_b32 v127, 0xffff0000, v47
    v_add_f32 v96, v96, v120
    v_add_f32 v97, v97, v121
    v_add_f32 v98, v98, v122
    v_add_f32 v99, v99, v123
    v_add_f32 v100, v100, v124
    v_add_f32 v101, v101, v125
    v_add_f32 v102, v102, v126
    v_add_f32 v103, v103, v127
    v_cndmask_b32 v108, v88, v90, s[76:77]
    v_cndmask_b32 v109, v89, v91, s[76:77]
    v_cndmask_b32 v110, v90, v88, s[76:77]
    v_cndmask_b32 v111, v91, v89, s[76:77]
    v_cvt_pk_bf16_f32 v104, v96, v97
    v_lshlrev_b32 v96, 16, v104
    v_and_b32 v97, 0xffff0000, v104
    v_lshlrev_b32 v104, 16, v136
    v_and_b32 v105, 0xffff0000, v136
    v_mul_f32 v96, v96, v104
    v_mul_f32 v97, v97, v105
    v_cvt_pk_bf16_f32 v104, v96, v97
    v_lshlrev_b32 v96, 16, v104
    v_and_b32 v97, 0xffff0000, v104
    v_lshlrev_b32 v104, 16, v108
    v_and_b32 v105, 0xffff0000, v108
    v_add_f32 v96, v96, v104
    v_add_f32 v97, v97, v105
    v_cvt_pk_bf16_f32 v112, v96, v97
    v_cvt_pk_bf16_f32 v104, v98, v99
    v_lshlrev_b32 v98, 16, v104
    v_and_b32 v99, 0xffff0000, v104
    v_lshlrev_b32 v104, 16, v137
    v_and_b32 v105, 0xffff0000, v137
    v_mul_f32 v98, v98, v104
    v_mul_f32 v99, v99, v105
    v_cvt_pk_bf16_f32 v104, v98, v99
    v_lshlrev_b32 v98, 16, v104
    v_and_b32 v99, 0xffff0000, v104
    v_lshlrev_b32 v104, 16, v109
    v_and_b32 v105, 0xffff0000, v109
    v_add_f32 v98, v98, v104
    v_add_f32 v99, v99, v105
    v_cvt_pk_bf16_f32 v113, v98, v99
    v_cvt_pk_bf16_f32 v104, v100, v101
    v_lshlrev_b32 v100, 16, v104
    v_and_b32 v101, 0xffff0000, v104
    v_lshlrev_b32 v104, 16, v138
    v_and_b32 v105, 0xffff0000, v138
    v_mul_f32 v100, v100, v104
    v_mul_f32 v101, v101, v105
    v_cvt_pk_bf16_f32 v104, v100, v101
    v_lshlrev_b32 v100, 16, v104
    v_and_b32 v101, 0xffff0000, v104
    v_lshlrev_b32 v104, 16, v110
    v_and_b32 v105, 0xffff0000, v110
    v_add_f32 v100, v100, v104
    v_add_f32 v101, v101, v105
    v_cvt_pk_bf16_f32 v114, v100, v101
    v_cvt_pk_bf16_f32 v104, v102, v103
    v_lshlrev_b32 v102, 16, v104
    v_and_b32 v103, 0xffff0000, v104
    v_lshlrev_b32 v104, 16, v139
    v_and_b32 v105, 0xffff0000, v139
    v_mul_f32 v102, v102, v104
    v_mul_f32 v103, v103, v105
    v_cvt_pk_bf16_f32 v104, v102, v103
    v_lshlrev_b32 v102, 16, v104
    v_and_b32 v103, 0xffff0000, v104
    v_lshlrev_b32 v104, 16, v111
    v_and_b32 v105, 0xffff0000, v111
    v_add_f32 v102, v102, v104
    v_add_f32 v103, v103, v105
    v_cvt_pk_bf16_f32 v115, v102, v103
    v_cndmask_b32 v128, v112, v114, s[76:77]
    v_cndmask_b32 v129, v113, v115, s[76:77]
    v_cndmask_b32 v130, v114, v112, s[76:77]
    v_cndmask_b32 v131, v115, v113, s[76:77]
    buffer_store_dwordx4 v[128:131], v4, s[12:15], s74 offen offset:0
    s_branch w_fin_done
w_fin_done:
    s_cmp_lg_u32 s3, 0
    s_cbranch_scc1 pub_20
    v_mov_b32 v20, 131136
    s_mov_b64 exec, 1
    ds_write_b32 v20, v250
    s_mov_b64 exec, -1
    s_waitcnt lgkmcnt(0)
pub_20:
    s_barrier
    v_mov_b32 v20, 131136
    ds_read_b32 v20, v20
    s_waitcnt lgkmcnt(0)
    v_readfirstlane_b32 s59, v20
    s_add_u32 s59, s59, 32
    s_min_u32 s59, s59, 322
    s_lshl_b32 s57, s59, 6
    s_load_dwordx16 s[32:47], s[24:25], s57
    s_waitcnt lgkmcnt(0)
    s_barrier
    s_sub_u32 s57, s32, 1
    s_cmp_ge_u32 s57, 5
    s_cbranch_scc1 w_cold
    v_and_b32 v20, 63, v0
    v_lshlrev_b32 v1, 4, v20
    v_add_u32 v19, 0x1000, v1
    v_lshrrev_b32 v4, 4, v20
    v_mov_b32 v17, 0
    v_mov_b32 v18, 1
    s_lshr_b32 s26, s3, 2
    s_and_b32 s27, s3, 3
    s_lshl_b32 s21, s3, 11
    s_lshl_b32 s22, s3, 10
    s_add_u32 s22, s22, 16384
    s_mov_b32 s11, 131072
    s_mov_b32 s15, 131072
    s_mov_b32 s28, 0
    v_and_b32 v21, 15, v20
    v_lshlrev_b32 v22, 2, v4
    v_xor_b32 v21, v21, v22
    s_lshr_b32 s30, s3, 1
    s_and_b32 s30, s30, 1
    v_xor_b32 v21, s30, v21
    v_lshlrev_b32 v3, 4, v21
    s_lshl_b32 s30, s26, 13
    v_add_u32 v5, s30, v1
    v_add_u32 v6, 0x10000, v5
    v_bfe_u32 v21, v20, 2, 2
    v_and_b32 v22, 3, v20
    v_and_b32 v23, 1, v4
    v_xor_b32 v24, s27, v21
    v_xor_b32 v25, v22, v23
    v_lshl_add_u32 v24, v24, 2, v25
    v_lshlrev_b32 v24, 4, v24
    v_lshl_add_u32 v25, v4, 3, v21
    v_lshl_add_u32 v24, v25, 8, v24
    v_and_b32 v22, 1, v22
    v_xor_b32 v25, 0, v23
    v_lshl_add_u32 v8, v25, 10, v24
    v_xor_b32 v25, 0, v22
    v_lshl_add_u32 v8, v25, 3, v8
    v_add_u32 v12, 0x10000, v8
    v_xor_b32 v25, 1, v23
    v_lshl_add_u32 v9, v25, 10, v24
    v_xor_b32 v25, 0, v22
    v_lshl_add_u32 v9, v25, 3, v9
    v_add_u32 v13, 0x10000, v9
    v_xor_b32 v25, 0, v23
    v_lshl_add_u32 v10, v25, 10, v24
    v_xor_b32 v25, 1, v22
    v_lshl_add_u32 v10, v25, 3, v10
    v_add_u32 v14, 0x10000, v10
    v_xor_b32 v25, 1, v23
    v_lshl_add_u32 v11, v25, 10, v24
    v_xor_b32 v25, 1, v22
    v_lshl_add_u32 v11, v25, 3, v11
    v_add_u32 v15, 0x10000, v11
    s_lshl_b32 s30, s3, 2
    s_add_u32 s30, s30, 131072
    v_mov_b32 v7, s30
    s_branch w_cold
chain_map:
    s_lshl_b32 s52, s12, 5
    s_add_u32 s52, s52, s13
    s_lshr_b32 s15, s52, 2
    s_lshr_b32 s14, s52, 4
    s_and_b32 s34, s13, 15
    s_and_b32 s53, s13, 3
    s_mov_b32 s16, 0
    s_mov_b32 s22, 131072
    s_mov_b32 s100, 131072
    s_getreg_b32 s40, hwreg(HW_REG_XCC_ID)
    s_and_b32 s40, s40, 15
    s_mul_i32 s19, s40, s40
    s_lshl_b32 s19, s19, 18
    s_lshl_b32 s40, s40, 8
    s_add_u32 s40, s40, s19
    s_add_u32 s40, s40, 1
    s_lshl_b32 s35, s14, 4
    s_add_u32 s35, s35, 218104320
    s_and_b32 s21, s3, 3
    s_mul_i32 s42, s21, 24576
    s_add_u32 s42, s42, 65536
    s_lshl_b32 s41, s14, 2
    s_add_u32 s41, s41, s21
    s_lshl_b32 s41, s41, 12
    s_add_u32 s101, s42, 8192
    s_bfe_u32 s17, s34, 0x20001
    s_cmp_eq_u32 s17, s21
    s_cselect_b32 s68, 20480, s42
    s_xor_b32 s68, s68, s101
    s_lshl_b32 s43, s21, 13
    s_add_u32 s43, s43, 138412032
    s_lshl_b32 s69, s21, 24
    s_lshl_b32 s17, s52, 10
    s_add_u32 s69, s69, s17
    s_add_u32 s69, s69, 20971520
    s_cmp_ge_u32 s3, 4
    s_cbranch_scc1 ch_a_pro
    s_add_u32 s41, s41, 262144
    s_lshl_b32 s38, s15, 13
    s_add_u32 s38, s38, 214958080
    s_lshl_b32 s17, s13, 1
    s_and_b32 s18, s3, 1
    s_add_u32 s17, s17, s18
    s_lshl_b32 s17, s17, 1
    s_cmp_lt_u32 s3, 2
    s_cselect_b32 s56, 0xffff, 0
    s_mov_b32 s57, 0
    s_lshr_b32 s18, s17, 1
    s_and_b32 s19, s17, 1
    s_lshl_b32 s20, s12, 14
    s_add_u32 s20, s20, 213909504
    s_lshl_b32 s36, s3, 12
    s_add_u32 s36, s36, s20
    s_lshl_b32 s37, s18, 8
    s_add_u32 s37, s37, s20
    s_lshl_b32 s20, s19, 5
    s_add_u32 s37, s37, s20
    s_lshr_b32 s39, s17, 3
    s_lshl_b32 s39, s39, 14
    s_and_b32 s20, s17, 7
    s_lshl_b32 s20, s20, 10
    s_add_u32 s39, s39, s20
    s_add_u32 s39, s39, 209715200
    s_lshl_b32 s30, s14, 22
    s_lshl_b32 s20, s34, 11
    s_add_u32 s30, s30, s20
    s_lshl_b32 s20, s3, 9
    s_add_u32 s30, s30, s20
    s_add_u32 s30, s30, 78643200
    s_lshl_b32 s55, s15, 13
    s_add_u32 s55, s55, 192937984
    s_mov_b32 s26, s38
    s_mov_b32 s54, s30
    s_mov_b32 s29, 2
    s_mov_b32 s58, 0
    s_mov_b32 s59, 0
    s_bfe_u32 s17, s34, 0x20001
    s_lshl_b32 s60, s14, 2
    s_add_u32 s60, s60, s17
    s_lshl_b32 s60, s60, 2
    s_add_u32 s60, s60, s3
    s_lshl_b32 s60, s60, 10
    s_and_b32 s17, s34, 1
    s_lshl_b32 s17, s17, 17
    s_add_u32 s60, s60, s17
    s_add_u32 s60, s60, 175898624
    s_mov_b32 s31, 786432
    v_and_b32 v20, 63, v0
    v_lshlrev_b32 v1, 4, v20
    v_mov_b32 v10, -1
    v_mov_b32 v11, -1
    v_lshrrev_b32 v21, 2, v20
    v_and_b32 v22, 3, v20
    v_lshlrev_b32 v21, 13, v21
    v_lshl_add_u32 v21, v22, 4, v21
    s_lshl_b32 s17, s3, 21
    s_lshl_b32 s18, s52, 6
    s_add_u32 s17, s17, s18
    s_lshl_b32 s19, s3, 15
    s_mov_b32 s10, 8388608
    s_mov_b32 s11, 131072
    v_lshrrev_b32 v24, 5, v20
    v_bfe_u32 v25, v20, 3, 1
    v_lshl_add_u32 v24, v24, 1, v25
    v_bfe_u32 v26, v20, 4, 1
    v_xor_b32 v26, v26, v25
    v_lshl_add_u32 v24, v24, 1, v26
    v_bfe_u32 v25, v20, 2, 1
    v_lshl_add_u32 v24, v24, 2, v25
    v_lshlrev_b32 v24, 6, v24
    v_lshl_add_u32 v24, v22, 3, v24
    v_add_u32 v24, s19, v24
    s_and_b32 s70, s13, 0
    s_lshl_b32 s72, s70, 20
    s_lshl_b32 s73, s70, 21
    s_lshl_b32 s70, s70, 13
    s_sub_u32 s71, s19, s70
    s_add_u32 s70, s19, s70
    s_load_dwordx2 s[8:9], s[0:1], 16
    s_add_u32 s20, s17, s72
    s_waitcnt lgkmcnt(0)
    s_add_u32 m0, s70, 0
    s_nop 0
    buffer_load_dwordx4 v21, s[8:11], s20 offen lds
    s_add_u32 s20, s20, 131072
    s_add_u32 m0, s70, 1024
    s_nop 0
    buffer_load_dwordx4 v21, s[8:11], s20 offen lds
    s_add_u32 s20, s20, 131072
    s_barrier
    v_mov_b32 v27, 131136
    ds_read_b32 v27, v27
    s_mov_b32 s96, s97
    s_waitcnt lgkmcnt(0)
    v_readfirstlane_b32 s97, v27
    s_cmp_lg_u32 s96, s97
    s_cbranch_scc1 k_restart
    s_add_u32 m0, s70, 2048
    s_nop 0
    buffer_load_dwordx4 v21, s[8:11], s20 offen lds
    s_add_u32 s20, s20, 131072
    s_add_u32 m0, s70, 3072
    s_nop 0
    buffer_load_dwordx4 v21, s[8:11], s20 offen lds
    s_add_u32 s20, s20, 131072
    s_add_u32 m0, s70, 4096
    s_nop 0
    buffer_load_dwordx4 v21, s[8:11], s20 offen lds
    s_add_u32 s20, s20, 131072
    s_add_u32 m0, s70, 5120
    s_nop 0
    buffer_load_dwordx4 v21, s[8:11], s20 offen lds
    s_add_u32 s20, s20, 131072
    s_add_u32 m0, s70, 6144
    s_nop 0
    buffer_load_dwordx4 v21, s[8:11], s20 offen lds
    s_add_u32 s20, s20, 131072
    s_add_u32 m0, s70, 7168
    s_nop 0
    buffer_load_dwordx4 v21, s[8:11], s20 offen lds
    s_add_u32 s20, s20, 131072
    s_sub_u32 s20, s20, s73
    s_add_u32 m0, s71, 8192
    s_nop 0
    buffer_load_dwordx4 v21, s[8:11], s20 offen lds
    s_add_u32 s20, s20, 131072
    s_add_u32 m0, s71, 9216
    s_nop 0
    buffer_load_dwordx4 v21, s[8:11], s20 offen lds
    s_add_u32 s20, s20, 131072
    s_add_u32 m0, s71, 10240
    s_nop 0
    buffer_load_dwordx4 v21, s[8:11], s20 offen lds
    s_add_u32 s20, s20, 131072
    s_add_u32 m0, s71, 11264
    s_nop 0
    buffer_load_dwordx4 v21, s[8:11], s20 offen lds
    s_add_u32 s20, s20, 131072
    s_add_u32 m0, s71, 12288
    s_nop 0
    buffer_load_dwordx4 v21, s[8:11], s20 offen lds
    s_add_u32 s20, s20, 131072
    s_add_u32 m0, s71, 13312
    s_nop 0
    buffer_load_dwordx4 v21, s[8:11], s20 offen lds
    s_add_u32 s20, s20, 131072
    s_add_u32 m0, s71, 14336
    s_nop 0
    buffer_load_dwordx4 v21, s[8:11], s20 offen lds
    s_add_u32 s20, s20, 131072
    s_add_u32 m0, s71, 15360
    s_nop 0
    buffer_load_dwordx4 v21, s[8:11], s20 offen lds
    s_add_u32 s20, s20, 131072
    s_load_dwordx2 s[8:9], s[0:1], 24
    s_add_u32 s20, s17, s72
    s_waitcnt lgkmcnt(0)
    s_add_u32 m0, s70, 16384
    s_nop 0
    buffer_load_dwordx4 v21, s[8:11], s20 offen lds
    s_add_u32 s20, s20, 131072
    s_add_u32 m0, s70, 17408
    s_nop 0
    buffer_load_dwordx4 v21, s[8:11], s20 offen lds
    s_add_u32 s20, s20, 131072
    s_add_u32 m0, s70, 18432
    s_nop 0
    buffer_load_dwordx4 v21, s[8:11], s20 offen lds
    s_add_u32 s20, s20, 131072
    s_add_u32 m0, s70, 19456
    s_nop 0
    buffer_load_dwordx4 v21, s[8:11], s20 offen lds
    s_add_u32 s20, s20, 131072
    s_add_u32 m0, s70, 20480
    s_nop 0
    buffer_load_dwordx4 v21, s[8:11], s20 offen lds
    s_add_u32 s20, s20, 131072
    s_add_u32 m0, s70, 21504
    s_nop 0
    buffer_load_dwordx4 v21, s[8:11], s20 offen lds
    s_add_u32 s20, s20, 131072
    s_add_u32 m0, s70, 22528
    s_nop 0
    buffer_load_dwordx4 v21, s[8:11], s20 offen lds
    s_add_u32 s20, s20, 131072
    s_add_u32 m0, s70, 23552
    s_nop 0
    buffer_load_dwordx4 v21, s[8:11], s20 offen lds
    s_add_u32 s20, s20, 131072
    s_sub_u32 s20, s20, s73
    s_add_u32 m0, s71, 24576
    s_nop 0
    buffer_load_dwordx4 v21, s[8:11], s20 offen lds
    s_add_u32 s20, s20, 131072
    s_add_u32 m0, s71, 25600
    s_nop 0
    buffer_load_dwordx4 v21, s[8:11], s20 offen lds
    s_add_u32 s20, s20, 131072
    s_add_u32 m0, s71, 26624
    s_nop 0
    buffer_load_dwordx4 v21, s[8:11], s20 offen lds
    s_add_u32 s20, s20, 131072
    s_add_u32 m0, s71, 27648
    s_nop 0
    buffer_load_dwordx4 v21, s[8:11], s20 offen lds
    s_add_u32 s20, s20, 131072
    s_add_u32 m0, s71, 28672
    s_nop 0
    buffer_load_dwordx4 v21, s[8:11], s20 offen lds
    s_add_u32 s20, s20, 131072
    s_add_u32 m0, s71, 29696
    s_nop 0
    buffer_load_dwordx4 v21, s[8:11], s20 offen lds
    s_add_u32 s20, s20, 131072
    s_add_u32 m0, s71, 30720
    s_nop 0
    buffer_load_dwordx4 v21, s[8:11], s20 offen lds
    s_add_u32 s20, s20, 131072
    s_add_u32 m0, s71, 31744
    s_nop 0
    buffer_load_dwordx4 v21, s[8:11], s20 offen lds
    s_add_u32 s20, s20, 131072
    s_load_dwordx2 s[8:9], s[0:1], 32
    s_add_u32 s20, s17, s72
    s_waitcnt lgkmcnt(0)
    buffer_load_dwordx4 v[96:99], v21, s[8:11], s20 offen
    s_add_u32 s20, s20, 131072
    buffer_load_dwordx4 v[100:103], v21, s[8:11], s20 offen
    s_add_u32 s20, s20, 131072
    buffer_load_dwordx4 v[104:107], v21, s[8:11], s20 offen
    s_add_u32 s20, s20, 131072
    buffer_load_dwordx4 v[108:111], v21, s[8:11], s20 offen
    s_add_u32 s20, s20, 131072
    buffer_load_dwordx4 v[144:147], v21, s[8:11], s20 offen
    s_add_u32 s20, s20, 131072
    buffer_load_dwordx4 v[148:151], v21, s[8:11], s20 offen
    s_add_u32 s20, s20, 131072
    buffer_load_dwordx4 v[152:155], v21, s[8:11], s20 offen
    s_add_u32 s20, s20, 131072
    buffer_load_dwordx4 v[156:159], v21, s[8:11], s20 offen
    s_add_u32 s20, s20, 131072
    s_sub_u32 s20, s20, s73
    buffer_load_dwordx4 v[192:195], v21, s[8:11], s20 offen
    s_add_u32 s20, s20, 131072
    buffer_load_dwordx4 v[196:199], v21, s[8:11], s20 offen
    s_add_u32 s20, s20, 131072
    buffer_load_dwordx4 v[200:203], v21, s[8:11], s20 offen
    s_add_u32 s20, s20, 131072
    buffer_load_dwordx4 v[204:207], v21, s[8:11], s20 offen
    s_add_u32 s20, s20, 131072
    buffer_load_dwordx4 v[240:243], v21, s[8:11], s20 offen
    s_add_u32 s20, s20, 131072
    buffer_load_dwordx4 v[244:247], v21, s[8:11], s20 offen
    s_add_u32 s20, s20, 131072
    buffer_load_dwordx4 v[248:251], v21, s[8:11], s20 offen
    s_add_u32 s20, s20, 131072
    buffer_load_dwordx4 v[252:255], v21, s[8:11], s20 offen
    s_add_u32 s20, s20, 131072
    s_load_dwordx2 s[8:9], s[0:1], 8
    s_mov_b32 s10, 16384
    v_bfe_u32 v57, v20, 2, 2
    v_and_b32 v58, 1, v20
    v_lshl_add_u32 v57, v57, 1, v58
    v_lshlrev_b32 v57, 11, v57
    v_lshrrev_b32 v58, 4, v20
    v_lshl_add_u32 v57, v58, 5, v57
    v_bfe_u32 v58, v20, 1, 1
    v_lshl_add_u32 v57, v58, 4, v57
    v_lshl_add_u32 v59, v58, 3, v57
    v_xor_b32 v60, 8, v59
    s_lshl_b32 s20, s3, 9
    s_waitcnt lgkmcnt(0)
    buffer_load_dwordx2 v[32:33], v59, s[8:11], s20 offen offset:0
    buffer_load_dwordx2 v[34:35], v60, s[8:11], s20 offen offset:0
    buffer_load_dwordx2 v[36:37], v59, s[8:11], s20 offen offset:128
    buffer_load_dwordx2 v[38:39], v60, s[8:11], s20 offen offset:128
    buffer_load_dwordx2 v[40:41], v59, s[8:11], s20 offen offset:256
    buffer_load_dwordx2 v[42:43], v60, s[8:11], s20 offen offset:256
    buffer_load_dwordx2 v[44:45], v59, s[8:11], s20 offen offset:384
    buffer_load_dwordx2 v[46:47], v60, s[8:11], s20 offen offset:384
    s_barrier
    v_add_u32 v56, s70, v1
    v_add_u32 v26, s71, v1
    s_waitcnt vmcnt(40)
    ds_read_b64_tr_b16 v[64:65], v24 offset:0
    ds_read_b64_tr_b16 v[66:67], v24 offset:128
    ds_read_b64_tr_b16 v[68:69], v24 offset:2048
    ds_read_b64_tr_b16 v[70:71], v24 offset:2176
    ds_read_b64_tr_b16 v[72:73], v24 offset:32
    ds_read_b64_tr_b16 v[74:75], v24 offset:160
    ds_read_b64_tr_b16 v[76:77], v24 offset:2080
    ds_read_b64_tr_b16 v[78:79], v24 offset:2208
    s_waitcnt lgkmcnt(0)
    ds_read_b64_tr_b16 v[112:113], v24 offset:4096
    ds_read_b64_tr_b16 v[114:115], v24 offset:4224
    ds_read_b64_tr_b16 v[116:117], v24 offset:6144
    ds_read_b64_tr_b16 v[118:119], v24 offset:6272
    ds_read_b64_tr_b16 v[120:121], v24 offset:4128
    ds_read_b64_tr_b16 v[122:123], v24 offset:4256
    ds_read_b64_tr_b16 v[124:125], v24 offset:6176
    ds_read_b64_tr_b16 v[126:127], v24 offset:6304
    s_waitcnt lgkmcnt(0)
    ds_read_b64_tr_b16 v[160:161], v24 offset:8192
    ds_read_b64_tr_b16 v[162:163], v24 offset:8320
    ds_read_b64_tr_b16 v[164:165], v24 offset:10240
    ds_read_b64_tr_b16 v[166:167], v24 offset:10368
    ds_read_b64_tr_b16 v[168:169], v24 offset:8224
    ds_read_b64_tr_b16 v[170:171], v24 offset:8352
    ds_read_b64_tr_b16 v[172:173], v24 offset:10272
    ds_read_b64_tr_b16 v[174:175], v24 offset:10400
    s_waitcnt lgkmcnt(0)
    ds_read_b64_tr_b16 v[208:209], v24 offset:12288
    ds_read_b64_tr_b16 v[210:211], v24 offset:12416
    ds_read_b64_tr_b16 v[212:213], v24 offset:14336
    ds_read_b64_tr_b16 v[214:215], v24 offset:14464
    ds_read_b64_tr_b16 v[216:217], v24 offset:12320
    ds_read_b64_tr_b16 v[218:219], v24 offset:12448
    ds_read_b64_tr_b16 v[220:221], v24 offset:14368
    ds_read_b64_tr_b16 v[222:223], v24 offset:14496
    s_waitcnt lgkmcnt(0)
    s_waitcnt vmcnt(24)
    ds_read_b64_tr_b16 v[80:81], v24 offset:16384
    ds_read_b64_tr_b16 v[82:83], v24 offset:16512
    ds_read_b64_tr_b16 v[84:85], v24 offset:18432
    ds_read_b64_tr_b16 v[86:87], v24 offset:18560
    ds_read_b64_tr_b16 v[88:89], v24 offset:16416
    ds_read_b64_tr_b16 v[90:91], v24 offset:16544
    ds_read_b64_tr_b16 v[92:93], v24 offset:18464
    ds_read_b64_tr_b16 v[94:95], v24 offset:18592
    s_waitcnt lgkmcnt(0)
    ds_read_b64_tr_b16 v[128:129], v24 offset:20480
    ds_read_b64_tr_b16 v[130:131], v24 offset:20608
    ds_read_b64_tr_b16 v[132:133], v24 offset:22528
    ds_read_b64_tr_b16 v[134:135], v24 offset:22656
    ds_read_b64_tr_b16 v[136:137], v24 offset:20512
    ds_read_b64_tr_b16 v[138:139], v24 offset:20640
    ds_read_b64_tr_b16 v[140:141], v24 offset:22560
    ds_read_b64_tr_b16 v[142:143], v24 offset:22688
    s_waitcnt lgkmcnt(0)
    ds_read_b64_tr_b16 v[176:177], v24 offset:24576
    ds_read_b64_tr_b16 v[178:179], v24 offset:24704
    ds_read_b64_tr_b16 v[180:181], v24 offset:26624
    ds_read_b64_tr_b16 v[182:183], v24 offset:26752
    ds_read_b64_tr_b16 v[184:185], v24 offset:24608
    ds_read_b64_tr_b16 v[186:187], v24 offset:24736
    ds_read_b64_tr_b16 v[188:189], v24 offset:26656
    ds_read_b64_tr_b16 v[190:191], v24 offset:26784
    s_waitcnt lgkmcnt(0)
    ds_read_b64_tr_b16 v[224:225], v24 offset:28672
    ds_read_b64_tr_b16 v[226:227], v24 offset:28800
    ds_read_b64_tr_b16 v[228:229], v24 offset:30720
    ds_read_b64_tr_b16 v[230:231], v24 offset:30848
    ds_read_b64_tr_b16 v[232:233], v24 offset:28704
    ds_read_b64_tr_b16 v[234:235], v24 offset:28832
    ds_read_b64_tr_b16 v[236:237], v24 offset:30752
    ds_read_b64_tr_b16 v[238:239], v24 offset:30880
    s_waitcnt lgkmcnt(0)
    s_waitcnt vmcnt(8)
    ds_write_b128 v56, v[96:99] offset:0
    ds_write_b128 v56, v[100:103] offset:1024
    ds_write_b128 v56, v[104:107] offset:2048
    ds_write_b128 v56, v[108:111] offset:3072
    ds_write_b128 v56, v[144:147] offset:4096
    ds_write_b128 v56, v[148:151] offset:5120
    ds_write_b128 v56, v[152:155] offset:6144
    ds_write_b128 v56, v[156:159] offset:7168
    ds_write_b128 v26, v[192:195] offset:8192
    ds_write_b128 v26, v[196:199] offset:9216
    ds_write_b128 v26, v[200:203] offset:10240
    ds_write_b128 v26, v[204:207] offset:11264
    ds_write_b128 v26, v[240:243] offset:12288
    ds_write_b128 v26, v[244:247] offset:13312
    ds_write_b128 v26, v[248:251] offset:14336
    ds_write_b128 v26, v[252:255] offset:15360
    s_waitcnt lgkmcnt(0)
    ds_read_b64_tr_b16 v[96:97], v24 offset:0
    ds_read_b64_tr_b16 v[98:99], v24 offset:128
    ds_read_b64_tr_b16 v[100:101], v24 offset:2048
    ds_read_b64_tr_b16 v[102:103], v24 offset:2176
    ds_read_b64_tr_b16 v[104:105], v24 offset:32
    ds_read_b64_tr_b16 v[106:107], v24 offset:160
    ds_read_b64_tr_b16 v[108:109], v24 offset:2080
    ds_read_b64_tr_b16 v[110:111], v24 offset:2208
    s_waitcnt lgkmcnt(0)
    ds_read_b64_tr_b16 v[144:145], v24 offset:4096
    ds_read_b64_tr_b16 v[146:147], v24 offset:4224
    ds_read_b64_tr_b16 v[148:149], v24 offset:6144
    ds_read_b64_tr_b16 v[150:151], v24 offset:6272
    ds_read_b64_tr_b16 v[152:153], v24 offset:4128
    ds_read_b64_tr_b16 v[154:155], v24 offset:4256
    ds_read_b64_tr_b16 v[156:157], v24 offset:6176
    ds_read_b64_tr_b16 v[158:159], v24 offset:6304
    s_waitcnt lgkmcnt(0)
    ds_read_b64_tr_b16 v[192:193], v24 offset:8192
    ds_read_b64_tr_b16 v[194:195], v24 offset:8320
    ds_read_b64_tr_b16 v[196:197], v24 offset:10240
    ds_read_b64_tr_b16 v[198:199], v24 offset:10368
    ds_read_b64_tr_b16 v[200:201], v24 offset:8224
    ds_read_b64_tr_b16 v[202:203], v24 offset:8352
    ds_read_b64_tr_b16 v[204:205], v24 offset:10272
    ds_read_b64_tr_b16 v[206:207], v24 offset:10400
    s_waitcnt lgkmcnt(0)
    ds_read_b64_tr_b16 v[240:241], v24 offset:12288
    ds_read_b64_tr_b16 v[242:243], v24 offset:12416
    ds_read_b64_tr_b16 v[244:245], v24 offset:14336
    ds_read_b64_tr_b16 v[246:247], v24 offset:14464
    ds_read_b64_tr_b16 v[248:249], v24 offset:12320
    ds_read_b64_tr_b16 v[250:251], v24 offset:12448
    ds_read_b64_tr_b16 v[252:253], v24 offset:14368
    ds_read_b64_tr_b16 v[254:255], v24 offset:14496
    s_waitcnt lgkmcnt(0)
    v_mov_b32 v21, 0x44444444
    v_mov_b32 v22, 0xeeeeeeee
    v_and_b32 v23, 2, v20
    v_cmp_eq_u32 vcc, 0, v23
    s_nop 1
    v_cndmask_b32 v8, v22, v21, vcc
    v_bfe_u32 v21, v20, 2, 3
    v_lshrrev_b32 v22, 5, v20
    v_mul_u32_u24 v23, 160, v21
    v_mul_u32_u24 v24, 1280, v22
    v_add_u32 v23, v23, v24
    v_and_b32 v24, 3, v20
    v_lshl_add_u32 v27, v24, 4, v23
    v_lshrrev_b32 v23, 1, v21
    v_and_b32 v21, 1, v21
    v_lshl_add_u32 v21, v23, 2, v21
    v_xor_b32 v22, 1, v22
    v_lshl_add_u32 v21, v22, 1, v21
    v_bfe_u32 v22, v20, 1, 1
    v_lshl_add_u32 v21, v22, 4, v21
    v_xor_b32 v22, v20, v22
    v_and_b32 v22, 1, v22
    v_lshlrev_b32 v21, 4, v21
    v_lshl_add_u32 v25, v22, 3, v21
    v_lshrrev_b32 v21, 3, v20
    v_mul_u32_u24 v23, 160, v21
    v_and_b32 v24, 7, v20
    v_lshl_add_u32 v28, v24, 4, v23
    v_lshrrev_b32 v23, 1, v21
    v_and_b32 v21, 1, v21
    v_lshl_add_u32 v21, v23, 2, v21
    v_and_b32 v22, 1, v20
    v_lshl_add_u32 v21, v22, 1, v21
    v_bfe_u32 v22, v20, 2, 1
    v_lshl_add_u32 v21, v22, 4, v21
    v_bfe_u32 v22, v20, 1, 1
    v_lshlrev_b32 v21, 4, v21
    v_lshl_add_u32 v26, v22, 3, v21
    s_lshl_b32 s17, s53, 10
    s_lshl_b32 s18, s3, 9
    s_add_u32 s17, s17, s18
    s_lshl_b32 s18, s3, 6
    s_lshl_b32 s19, s53, 9
    s_add_u32 s19, s19, 4096
    s_cmp_ge_u32 s3, 2
    s_cselect_b32 s17, s19, s17
    s_cselect_b32 s18, 2560, s18
    s_cselect_b64 vcc, -1, 0
    v_cndmask_b32 v22, v25, v26, vcc
    v_cndmask_b32 v23, v27, v28, vcc
    v_add_u32 v2, s17, v22
    v_add_u32 v4, s18, v23
    v_lshrrev_b32 v21, 4, v20
    v_and_b32 v22, 15, v20
    v_mul_u32_u24 v23, 320, v21
    v_lshl_add_u32 v23, v22, 2, v23
    s_mul_i32 s17, s3, 3840
    v_add_u32 v3, s17, v23
    v_add_u32 v61, 1280, v3
    v_bfe_u32 v24, v20, 3, 1
    v_bfe_u32 v25, v20, 2, 1
    v_xor_b32 v25, v25, v24
    v_bfe_u32 v26, v20, 1, 1
    v_lshl_add_u32 v25, v26, 1, v25
    v_lshl_add_u32 v25, v24, 2, v25
    v_and_b32 v26, 1, v20
    v_lshl_add_u32 v25, v25, 1, v26
    v_sub_u32 v25, v25, v22
    v_lshl_add_u32 v25, v25, 2, v3
    v_add_u32 v62, 2560, v25
    v_lshlrev_b32 v23, 4, v22
    v_lshl_add_u32 v6, v21, 12, v23
    s_lshl_b32 s17, s3, 10
    s_add_u32 s17, s17, 32768
    v_add_u32 v6, s17, v6
    v_lshrrev_b32 v24, 1, v21
    v_lshl_add_u32 v23, v24, 15, v23
    v_and_b32 v24, 1, v21
    v_lshl_add_u32 v7, v24, 8, v23
    v_mov_b32 v58, 15872
    v_bfe_u32 v23, v20, 1, 2
    v_lshlrev_b32 v23, 6, v23
    v_and_b32 v25, 1, v20
    v_lshl_add_u32 v23, v25, 4, v23
    v_bfe_u32 v24, v20, 3, 1
    v_lshl_add_u32 v5, v24, 5, v23
    v_and_b32 v23, 7, v20
    v_lshlrev_b32 v23, 7, v23
    v_bfe_u32 v24, v20, 3, 1
    v_lshl_add_u32 v23, v24, 17, v23
    v_lshrrev_b32 v24, 4, v20
    v_add_u32 v24, 1, v24
    v_cmp_le_u32 vcc, 3, v24
    s_nop 1
    v_cndmask_b32 v24, v24, 0, vcc
    v_lshl_add_u32 v23, v24, 24, v23
    s_lshl_b32 s17, s14, 14
    s_lshl_b32 s18, s34, 10
    s_add_u32 s17, s17, s18
    s_add_u32 s17, s17, 4194304
    v_add_u32 v0, s17, v23
    s_lshl_b32 s17, s3, 2
    s_add_u32 s17, s17, 15872
    v_mov_b32 v63, s17
    v_and_b32 v21, 15, v20
    v_and_b32 v22, 1, v21
    v_lshlrev_b32 v22, 4, v22
    v_mov_b32 v12, 0x3f80
    v_lshlrev_b32 v22, v22, v12
    v_lshrrev_b32 v21, 1, v21
    v_cmp_eq_u32 vcc, 0, v21
    s_nop 1
    v_cndmask_b32 v12, 0, v22, vcc
    v_cmp_eq_u32 vcc, 1, v21
    s_nop 1
    v_cndmask_b32 v13, 0, v22, vcc
    v_cmp_eq_u32 vcc, 2, v21
    s_nop 1
    v_cndmask_b32 v14, 0, v22, vcc
    v_cmp_eq_u32 vcc, 3, v21
    s_nop 1
    v_cndmask_b32 v15, 0, v22, vcc
    s_waitcnt vmcnt(0)
    v_mov_b32 v16, v32
    v_mov_b32 v17, v33
    v_mov_b32 v18, v34
    v_mov_b32 v19, v35
    v_mov_b32 v20, v36
    v_mov_b32 v21, v37
    v_mov_b32 v22, v38
    v_mov_b32 v23, v39
    v_mov_b32 v24, v40
    v_mov_b32 v25, v41
    v_mov_b32 v26, v42
    v_mov_b32 v27, v43
    v_mov_b32 v28, v44
    v_mov_b32 v29, v45
    v_mov_b32 v30, v46
    v_mov_b32 v31, v47
    v_mov_b32 v52, -1
    v_mov_b32 v53, -1
    v_mov_b32 v54, -1
    v_mov_b32 v55, -1
    s_add_u32 s17, s30, 786432
    buffer_store_dwordx4 v[52:55], v7, s[4:7], s17 offen sc1
    s_add_u32 s17, s30, 851968
    buffer_store_dwordx4 v[52:55], v7, s[4:7], s17 offen sc1
    s_add_u32 s17, s30, 917504
    buffer_store_dwordx4 v[52:55], v7, s[4:7], s17 offen sc1
    s_add_u32 s17, s30, 983040
    buffer_store_dwordx4 v[52:55], v7, s[4:7], s17 offen sc1
    s_lshl_b32 s40, s40, 5
    s_barrier
    ds_write_b32 v63, v10
    ds_write_b32 v63, v10 offset:16
    ds_write_b32 v63, v10 offset:32
    ds_write_b32 v63, v10 offset:48
    v_mov_b32 v60, 12
    v_mov_b32 v56, 15968
    s_waitcnt lgkmcnt(0)
    s_barrier
    ds_read_b64 v[32:33], v56
    s_waitcnt lgkmcnt(0)
    v_cmp_ne_u32 vcc, s40, v32
    s_setprio 3
    v_readfirstlane_b32 s17, v33
    s_add_u32 s39, s39, s17
    s_cbranch_vccnz ch_p_slow
    v_mov_b32 v32, 0
    v_mov_b32 v33, 0
    v_mov_b32 v34, 0
    v_mov_b32 v35, 0
    v_mov_b32 v36, 0
    v_mov_b32 v37, 0
    v_mov_b32 v38, 0
    v_mov_b32 v39, 0
    v_mov_b32 v40, 0
    v_mov_b32 v41, 0
    v_mov_b32 v42, 0
    v_mov_b32 v43, 0
    v_mov_b32 v44, 0
    v_mov_b32 v45, 0
    v_mov_b32 v46, 0
    v_mov_b32 v47, 0
    v_mov_b32 v48, 0
    v_mov_b32 v49, 0
    v_mov_b32 v50, 0
    v_mov_b32 v51, 0
    v_mov_b32 v52, 0
    v_mov_b32 v53, 0
    v_mov_b32 v54, 0
    v_mov_b32 v55, 0
    v_mov_b32 v59, 0
    s_nop 1
    s_branch ploopL_22_nc
.p2align 6
    s_nop 0
    s_nop 0
    s_nop 0
    s_nop 0
    s_nop 0
    s_nop 0
    s_nop 0
    s_nop 0
    s_nop 0
    s_nop 0
    s_nop 0
ploopL_22:
    v_mov_b32 v32, 0
    v_mov_b32 v33, 0
    v_mov_b32 v34, 0
    v_mov_b32 v35, 0
    v_mov_b32 v36, 0
    v_mov_b32 v37, 0
    v_mov_b32 v38, 0
    v_mov_b32 v39, 0
    v_mov_b32 v40, 0
    v_mov_b32 v41, 0
    v_mov_b32 v42, 0
    v_mov_b32 v43, 0
    v_mov_b32 v44, 0
    v_mov_b32 v45, 0
    v_mov_b32 v46, 0
    v_mov_b32 v47, 0
    v_mov_b32 v48, 0
    v_mov_b32 v49, 0
    v_mov_b32 v50, 0
    v_mov_b32 v51, 0
    v_mov_b32 v52, 0
    v_mov_b32 v53, 0
    v_mov_b32 v54, 0
    v_mov_b32 v55, 0
    s_bitcmp1_b32 s29, 0
    s_cbranch_scc1 gate_23_ok
    s_add_u32 s21, s16, 1
    s_min_u32 s21, s21, 63
    s_cmp_ge_u32 s21, 16
    s_cselect_b32 s19, 12, 8
    s_and_b32 s32, s21, 4
    s_lshr_b32 s21, s21, 3
    s_lshl_b32 s21, s21, 8
    s_add_u32 s32, s32, s21
    s_add_u32 s32, s32, s35
gate_23:
    buffer_load_dword v9, off, s[4:7], s32 sc1
    s_waitcnt vmcnt(0)
    v_readfirstlane_b32 s21, v9
    s_cmp_ge_u32 s21, s19
    s_cbranch_scc1 gate_23_set
    s_sleep 8
    s_sub_u32 s22, s22, 1
    s_cbranch_scc0 gate_23
    s_mov_b32 s22, 0
gate_23_set:
    s_bitset1_b32 s29, 0
gate_23_ok:
    s_sleep 1
    buffer_load_dwordx4 v[16:19], v1, s[4:7], s23 offen offset:0 sc1
    buffer_load_dwordx4 v[20:23], v1, s[4:7], s23 offen offset:1024 sc1
    buffer_load_dwordx4 v[24:27], v1, s[4:7], s23 offen offset:2048 sc1
    buffer_load_dwordx4 v[28:31], v1, s[4:7], s23 offen offset:3072 sc1
    s_waitcnt vmcnt(3)
    v_cmp_eq_u32 vcc, -1, v16
    s_cbranch_vccnz ploopL_22_rm_0
ploopL_22_rm_0ok:
    v_smfmac_f32_16x16x64_bf16 v[32:35], v[16:19], v[64:71], v8
    v_smfmac_f32_16x16x64_bf16 v[36:39], v[16:19], v[72:79], v8
    s_waitcnt vmcnt(2)
    v_cmp_eq_u32 vcc, -1, v20
    v_smfmac_f32_16x16x64_bf16 v[40:43], v[16:19], v[80:87], v8
    v_smfmac_f32_16x16x64_bf16 v[44:47], v[16:19], v[88:95], v8
    v_smfmac_f32_16x16x64_bf16 v[48:51], v[16:19], v[96:103], v8
    v_smfmac_f32_16x16x64_bf16 v[52:55], v[16:19], v[104:111], v8
    s_cbranch_vccnz ploopL_22_rm_1
ploopL_22_rm_1ok:
    v_smfmac_f32_16x16x64_bf16 v[32:35], v[20:23], v[112:119], v8
    v_smfmac_f32_16x16x64_bf16 v[36:39], v[20:23], v[120:127], v8
    s_waitcnt vmcnt(1)
    v_cmp_eq_u32 vcc, -1, v24
    v_smfmac_f32_16x16x64_bf16 v[40:43], v[20:23], v[128:135], v8
    v_smfmac_f32_16x16x64_bf16 v[44:47], v[20:23], v[136:143], v8
    v_smfmac_f32_16x16x64_bf16 v[48:51], v[20:23], v[144:151], v8
    v_smfmac_f32_16x16x64_bf16 v[52:55], v[20:23], v[152:159], v8
    s_cbranch_vccnz ploopL_22_rm_2
ploopL_22_rm_2ok:
    v_smfmac_f32_16x16x64_bf16 v[32:35], v[24:27], v[160:167], v8
    v_smfmac_f32_16x16x64_bf16 v[36:39], v[24:27], v[168:175], v8
    s_waitcnt vmcnt(0)
    v_cmp_eq_u32 vcc, -1, v28
    v_smfmac_f32_16x16x64_bf16 v[40:43], v[24:27], v[176:183], v8
    v_smfmac_f32_16x16x64_bf16 v[44:47], v[24:27], v[184:191], v8
    v_smfmac_f32_16x16x64_bf16 v[48:51], v[24:27], v[192:199], v8
    v_smfmac_f32_16x16x64_bf16 v[52:55], v[24:27], v[200:207], v8
    s_cbranch_vccnz ploopL_22_rm_3
ploopL_22_rm_3ok:
    v_smfmac_f32_16x16x64_bf16 v[32:35], v[28:31], v[208:215], v8
    ds_write_b32 v63, v59 offset:32
    v_smfmac_f32_16x16x64_bf16 v[36:39], v[28:31], v[216:223], v8
    v_smfmac_f32_16x16x64_bf16 v[40:43], v[28:31], v[224:231], v8
    v_smfmac_f32_16x16x64_bf16 v[44:47], v[28:31], v[232:239], v8
    v_smfmac_f32_16x16x64_bf16 v[48:51], v[28:31], v[240:247], v8
    v_smfmac_f32_16x16x64_bf16 v[52:55], v[28:31], v[248:255], v8
    s_branch ploopL_22_mmd
ploopL_22_nc:
    v_smfmac_f32_16x16x64_bf16 v[32:35], v[16:19], v[64:71], v8
    v_smfmac_f32_16x16x64_bf16 v[36:39], v[16:19], v[72:79], v8
    v_smfmac_f32_16x16x64_bf16 v[40:43], v[16:19], v[80:87], v8
    v_smfmac_f32_16x16x64_bf16 v[44:47], v[16:19], v[88:95], v8
    v_smfmac_f32_16x16x64_bf16 v[48:51], v[16:19], v[96:103], v8
    v_smfmac_f32_16x16x64_bf16 v[52:55], v[16:19], v[104:111], v8
    v_smfmac_f32_16x16x64_bf16 v[32:35], v[20:23], v[112:119], v8
    v_smfmac_f32_16x16x64_bf16 v[36:39], v[20:23], v[120:127], v8
    v_smfmac_f32_16x16x64_bf16 v[40:43], v[20:23], v[128:135], v8
    v_smfmac_f32_16x16x64_bf16 v[44:47], v[20:23], v[136:143], v8
    v_smfmac_f32_16x16x64_bf16 v[48:51], v[20:23], v[144:151], v8
    v_smfmac_f32_16x16x64_bf16 v[52:55], v[20:23], v[152:159], v8
    v_smfmac_f32_16x16x64_bf16 v[32:35], v[24:27], v[160:167], v8
    v_smfmac_f32_16x16x64_bf16 v[36:39], v[24:27], v[168:175], v8
    v_smfmac_f32_16x16x64_bf16 v[40:43], v[24:27], v[176:183], v8
    v_smfmac_f32_16x16x64_bf16 v[44:47], v[24:27], v[184:191], v8
    v_smfmac_f32_16x16x64_bf16 v[48:51], v[24:27], v[192:199], v8
    v_smfmac_f32_16x16x64_bf16 v[52:55], v[24:27], v[200:207], v8
    v_smfmac_f32_16x16x64_bf16 v[32:35], v[28:31], v[208:215], v8
    ds_write_b32 v63, v59 offset:32
    v_smfmac_f32_16x16x64_bf16 v[36:39], v[28:31], v[216:223], v8
    v_smfmac_f32_16x16x64_bf16 v[40:43], v[28:31], v[224:231], v8
    v_smfmac_f32_16x16x64_bf16 v[44:47], v[28:31], v[232:239], v8
    v_smfmac_f32_16x16x64_bf16 v[48:51], v[28:31], v[240:247], v8
    v_smfmac_f32_16x16x64_bf16 v[52:55], v[28:31], v[248:255], v8
ploopL_22_mmd:
    s_cmp_eq_u32 s3, 3
    s_nop 1
    v_add_f32 v32, v32, v34
    v_add_f32 v33, v33, v35
    ds_write2_b32 v3, v32, v33 offset0:0 offset1:40
    v_add_f32 v36, v36, v38
    v_add_f32 v37, v37, v39
    ds_write2_b32 v3, v36, v37 offset0:16 offset1:56
    v_add_f32 v40, v40, v42
    v_add_f32 v41, v41, v43
    ds_write2_b32 v61, v40, v41 offset0:0 offset1:40
    v_add_f32 v44, v44, v46
    v_add_f32 v45, v45, v47
    ds_write2_b32 v61, v44, v45 offset0:16 offset1:56
    v_add_f32 v48, v48, v50
    v_add_f32 v49, v49, v51
    ds_write2_b32 v62, v48, v49 offset0:0 offset1:40
    v_add_f32 v52, v52, v54
    v_add_f32 v53, v53, v55
    ds_write2_b32 v62, v52, v53 offset0:16 offset1:56
    s_waitcnt lgkmcnt(0)
    s_barrier
    s_cbranch_scc1 ploopL_22_sk1
    ds_read_b128 v[32:35], v4 offset:0
    ds_read_b128 v[36:39], v4 offset:3840
    ds_read_b128 v[40:43], v4 offset:7680
    ds_read_b128 v[44:47], v4 offset:11520
    s_waitcnt lgkmcnt(2)
    v_add_f32 v32, v32, v36
    v_add_f32 v33, v33, v37
    v_add_f32 v34, v34, v38
    v_add_f32 v35, v35, v39
    s_waitcnt lgkmcnt(0)
    v_add_f32 v40, v40, v44
    v_add_f32 v41, v41, v45
    v_add_f32 v42, v42, v46
    v_add_f32 v43, v43, v47
    v_add_f32 v32, v32, v40
    v_add_f32 v33, v33, v41
    v_add_f32 v34, v34, v42
    v_add_f32 v35, v35, v43
    v_cvt_pk_bf16_f32 v56, v32, v33
    v_cvt_pk_bf16_f32 v57, v34, v35
    v_min_u32 v56, -2, v56
    buffer_store_dwordx2 v[56:57], v2, s[4:7], s26 offen
    s_add_u32 s27, s16, 2
    s_and_b32 s27, s27, 3
    s_lshl_b32 s27, s27, 18
    s_add_u32 s27, s27, s38
    buffer_store_dwordx2 v[10:11], v2, s[4:7], s27 offen
ploopL_22_sk1:
    s_setprio 0
    s_add_u32 s25, s16, 3
    s_and_b32 s25, s25, 3
    s_lshl_b32 s25, s25, 16
    s_add_u32 s25, s25, s37
    v_mov_b32 v44, -1
    v_mov_b32 v45, -1
    v_mov_b32 v46, -1
    v_mov_b32 v47, -1
    s_mov_b64 exec, s[56:57]
    buffer_store_dwordx4 v[44:47], v5, s[4:7], s25 offen
    s_mov_b64 exec, -1
    s_and_b32 s28, s16, 3
    s_lshl_b32 s28, s28, 18
    s_add_u32 s28, s28, s39
    s_add_u32 s24, s16, 1
    s_and_b32 s24, s24, 3
    s_lshl_b32 s24, s24, 16
    s_add_u32 s24, s24, s37
    s_add_u32 s23, s16, 1
    s_and_b32 s23, s23, 3
    s_lshl_b32 s23, s23, 16
    s_add_u32 s23, s23, s36
    s_add_u32 s26, s16, 1
    s_and_b32 s26, s26, 3
    s_lshl_b32 s26, s26, 18
    s_add_u32 s26, s26, s38
    s_cmp_eq_u32 s59, 0
    s_cbranch_scc1 ofl_24
    s_lshl_b32 s17, s3, 10
    v_add_u32 v39, s17, v1
    ds_read_b128 v[40:43], v39 offset:32768
ofl_24:
    s_cmp_ge_u32 s16, 16
    s_cbranch_scc1 ploopL_22_nx
    v_mov_b32 v40, v2
    v_mov_b32 v42, v56
    v_mov_b32 v43, v57
    s_cmp_lg_u32 s3, 2
    s_cbranch_scc1 ploopL_22_nx
    v_and_b32 v40, 0x60, v1
    v_lshlrev_b32 v40, 2, v40
    v_lshrrev_b32 v41, 3, v1
    v_and_b32 v41, 0x70, v41
    v_or_b32 v40, v40, v41
    v_bfe_u32 v41, v1, 4, 1
    v_lshl_or_b32 v40, v41, 3, v40
    s_lshl_b32 s17, s53, 9
    s_add_u32 s17, s17, 4096
    v_add_u32 v40, s17, v40
    s_mov_b32 vcc_lo, 0x55555555
    s_mov_b32 vcc_hi, 0x55555555
    v_cndmask_b32_dpp v42, v57, v56, vcc quad_perm:[1,0,3,2] row_mask:0xf bank_mask:0xf
    s_not_b64 vcc, vcc
    v_cndmask_b32_dpp v43, v56, v57, vcc quad_perm:[1,0,3,2] row_mask:0xf bank_mask:0xf
ploopL_22_nx:
    v_readfirstlane_b32 s21, v60
    s_lshr_b32 s29, s29, 1
    s_cmp_ge_u32 s21, s58
    s_cselect_b32 s21, 2, 0
    s_or_b32 s29, s29, s21
    s_cmp_eq_u32 s3, 3
    s_cselect_b32 s20, s21, 0
    s_add_u32 s21, s16, 4
    s_min_u32 s21, s21, 63
    s_cmp_ge_u32 s21, 16
    s_cselect_b32 s58, 12, 8
    s_and_b32 s33, s21, 4
    s_lshr_b32 s21, s21, 3
    s_lshl_b32 s21, s21, 8
    s_add_u32 s33, s33, s21
    s_add_u32 s33, s33, s35
    s_setprio 3
ploopL_22_fs:
    ds_read_b128 v[32:35], v58 offset:0
    s_waitcnt lgkmcnt(0)
    v_min3_i32 v32, v32, v33, v34
    v_min_i32 v32, v32, v35
    s_nop 0
    v_readfirstlane_b32 s18, v32
    s_cmp_ge_i32 s18, s16
    s_cbranch_scc1 ploopL_22_fsok
    s_sleep 1
    s_branch ploopL_22_fs
ploopL_22_fsok:
    s_setprio 1
    s_sleep 4
ploopL_22_nofd:
    s_cmp_eq_u32 s20, 0
    s_cbranch_scc1 ploopL_22_nt
    s_cmp_ge_u32 s16, 13
    s_cselect_b32 exec_hi, 0xffff, 0
    buffer_load_dword v60, v0, s[4:7], s31 offen sc1
    s_mov_b32 exec_hi, -1
ploopL_22_nt:
    s_cmp_eq_u32 s59, 0
    s_cbranch_scc1 ofl_25
    s_lshl_b32 s17, s16, 18
    s_add_u32 s17, s17, s60
    buffer_store_dwordx4 v[40:43], v1, s[4:7], s17 offen sc1
    s_mov_b32 s59, 0
ofl_25:
    s_lshr_b32 s17, s34, 3
    s_xor_b32 s17, s17, s16
    s_andn2_b32 s59, 1, s17
    s_cmp_ge_u32 s16, 16
    s_cselect_b32 s59, s59, 0
    s_cbranch_scc1 ploopL_22_nx2
    s_cmp_eq_u32 s3, 3
    s_cbranch_scc1 ploopL_22_nx2
    buffer_store_dwordx2 v[42:43], v40, s[4:7], s55 offen sc1
ploopL_22_nx2:
    s_add_u32 s55, s55, 262144
    s_or_b32 s17, s13, s3
    s_cmp_lg_u32 s17, 0
    s_cbranch_scc1 ploopL_22_npg
    s_sub_u32 s21, s16, 1
    s_cbranch_scc1 ploopL_22_npg
    s_sub_u32 s17, s21, 1
    s_and_b32 s17, s17, 3
    s_cmp_ge_u32 s16, 58
    s_cselect_b32 s17, 0, s17
    s_cmp_lg_u32 s17, 0
    s_cbranch_scc1 ploopL_22_npg
    s_lshl_b32 s17, s12, 7
    s_add_u32 s17, s17, 218112000
    v_mov_b32 v9, s21
    s_mov_b64 exec, 1
    buffer_store_dword v9, off, s[4:7], s17 sc1
    s_mov_b64 exec, -1
ploopL_22_npg:
    s_barrier
    buffer_load_dword v60, off, s[4:7], s33 sc1
    s_add_u32 s16, s16, 1
    v_mov_b32 v59, s16
    s_add_u32 s41, s41, 262144
    s_add_u32 s31, s31, 262144
    s_setprio 3
    s_sleep 13
ploopL_22_pagain:
    buffer_load_dwordx4 v[16:19], v1, s[4:7], s28 offen offset:0 sc1
    buffer_load_dwordx4 v[20:23], v1, s[4:7], s28 offen offset:1024 sc1
    s_waitcnt vmcnt(1)
    v_mfma_f32_16x16x32_bf16 v[32:35], v[12:15], v[16:19], 0
    s_waitcnt vmcnt(0)
    v_mfma_f32_16x16x32_bf16 v[32:35], v[12:15], v[20:23], v[32:35]
    v_max_u32 v9, v16, v20
    v_cmp_eq_u32 vcc, -1, v9
    s_cbranch_vccnz ploopL_22_rp
ploopL_22_pgo:
    s_cmp_lt_u32 s16, 48
    s_nop 3
    v_cvt_pk_bf16_f32 v52, v32, v33
    v_cvt_pk_bf16_f32 v53, v34, v35
    s_nop 0
    v_permlane16_swap_b32 v52, v54
    v_permlane16_swap_b32 v53, v55
    s_mov_b64 exec, s[56:57]
    v_min_u32 v52, -2, v52
    buffer_store_dwordx4 v[52:55], v5, s[4:7], s24 offen
    s_mov_b64 exec, -1
    ds_write_b32 v63, v59 offset:16
    s_cbranch_scc1 ploopL_22
    s_branch ploopH_21
ploopL_22_rm_0:
    s_sub_u32 s22, s22, 1
    s_cbranch_scc1 ploopL_22_rm_0_g
    buffer_load_dwordx4 v[16:19], v1, s[4:7], s23 offen offset:0 sc1
    buffer_load_dwordx4 v[20:23], v1, s[4:7], s23 offen offset:1024 sc1
    buffer_load_dwordx4 v[24:27], v1, s[4:7], s23 offen offset:2048 sc1
    buffer_load_dwordx4 v[28:31], v1, s[4:7], s23 offen offset:3072 sc1
    s_waitcnt vmcnt(3)
    v_cmp_eq_u32 vcc, -1, v16
    s_cbranch_vccnz ploopL_22_rm_0
    s_branch ploopL_22_rm_0ok
ploopL_22_rm_0_g:
    s_mov_b32 s22, 0
    s_waitcnt vmcnt(0)
    s_branch ploopL_22_rm_0ok
ploopL_22_rm_1:
    s_sub_u32 s22, s22, 1
    s_cbranch_scc1 ploopL_22_rm_1_g
    buffer_load_dwordx4 v[20:23], v1, s[4:7], s23 offen offset:1024 sc1
    buffer_load_dwordx4 v[24:27], v1, s[4:7], s23 offen offset:2048 sc1
    buffer_load_dwordx4 v[28:31], v1, s[4:7], s23 offen offset:3072 sc1
    s_waitcnt vmcnt(2)
    v_cmp_eq_u32 vcc, -1, v20
    s_cbranch_vccnz ploopL_22_rm_1
    s_branch ploopL_22_rm_1ok
ploopL_22_rm_1_g:
    s_mov_b32 s22, 0
    s_waitcnt vmcnt(0)
    s_branch ploopL_22_rm_1ok
ploopL_22_rm_2:
    s_sub_u32 s22, s22, 1
    s_cbranch_scc1 ploopL_22_rm_2_g
    buffer_load_dwordx4 v[24:27], v1, s[4:7], s23 offen offset:2048 sc1
    buffer_load_dwordx4 v[28:31], v1, s[4:7], s23 offen offset:3072 sc1
    s_waitcnt vmcnt(1)
    v_cmp_eq_u32 vcc, -1, v24
    s_cbranch_vccnz ploopL_22_rm_2
    s_branch ploopL_22_rm_2ok
ploopL_22_rm_2_g:
    s_mov_b32 s22, 0
    s_waitcnt vmcnt(0)
    s_branch ploopL_22_rm_2ok
ploopL_22_rm_3:
    s_sub_u32 s22, s22, 1
    s_cbranch_scc1 ploopL_22_rm_3_g
    buffer_load_dwordx4 v[28:31], v1, s[4:7], s23 offen offset:3072 sc1
    s_waitcnt vmcnt(0)
    v_cmp_eq_u32 vcc, -1, v28
    s_cbranch_vccnz ploopL_22_rm_3
    s_branch ploopL_22_rm_3ok
ploopL_22_rm_3_g:
    s_mov_b32 s22, 0
    s_waitcnt vmcnt(0)
    s_branch ploopL_22_rm_3ok
ploopL_22_rp:
    s_sub_u32 s22, s22, 1
    s_cbranch_scc0 ploopL_22_pagain
    s_mov_b32 s22, 0
    s_branch ploopL_22_pgo
.p2align 6
    s_nop 0
    s_nop 0
    s_nop 0
    s_nop 0
    s_nop 0
    s_nop 0
    s_nop 0
    s_nop 0
    s_nop 0
    s_nop 0
    s_nop 0
ploopH_21:
    v_mov_b32 v32, 0
    v_mov_b32 v33, 0
    v_mov_b32 v34, 0
    v_mov_b32 v35, 0
    v_mov_b32 v36, 0
    v_mov_b32 v37, 0
    v_mov_b32 v38, 0
    v_mov_b32 v39, 0
    v_mov_b32 v40, 0
    v_mov_b32 v41, 0
    v_mov_b32 v42, 0
    v_mov_b32 v43, 0
    v_mov_b32 v44, 0
    v_mov_b32 v45, 0
    v_mov_b32 v46, 0
    v_mov_b32 v47, 0
    v_mov_b32 v48, 0
    v_mov_b32 v49, 0
    v_mov_b32 v50, 0
    v_mov_b32 v51, 0
    v_mov_b32 v52, 0
    v_mov_b32 v53, 0
    v_mov_b32 v54, 0
    v_mov_b32 v55, 0
    s_sleep 1
    buffer_load_dwordx4 v[16:19], v1, s[4:7], s23 offen offset:0 sc1
    buffer_load_dwordx4 v[20:23], v1, s[4:7], s23 offen offset:1024 sc1
    buffer_load_dwordx4 v[24:27], v1, s[4:7], s23 offen offset:2048 sc1
    buffer_load_dwordx4 v[28:31], v1, s[4:7], s23 offen offset:3072 sc1
    s_waitcnt vmcnt(3)
    v_cmp_eq_u32 vcc, -1, v16
    s_cbranch_vccnz ploopH_21_rm_0
ploopH_21_rm_0ok:
    v_smfmac_f32_16x16x64_bf16 v[32:35], v[16:19], v[64:71], v8
    v_smfmac_f32_16x16x64_bf16 v[36:39], v[16:19], v[72:79], v8
    s_waitcnt vmcnt(2)
    v_cmp_eq_u32 vcc, -1, v20
    v_smfmac_f32_16x16x64_bf16 v[40:43], v[16:19], v[80:87], v8
    v_smfmac_f32_16x16x64_bf16 v[44:47], v[16:19], v[88:95], v8
    v_smfmac_f32_16x16x64_bf16 v[48:51], v[16:19], v[96:103], v8
    v_smfmac_f32_16x16x64_bf16 v[52:55], v[16:19], v[104:111], v8
    s_cbranch_vccnz ploopH_21_rm_1
ploopH_21_rm_1ok:
    v_smfmac_f32_16x16x64_bf16 v[32:35], v[20:23], v[112:119], v8
    v_smfmac_f32_16x16x64_bf16 v[36:39], v[20:23], v[120:127], v8
    s_waitcnt vmcnt(1)
    v_cmp_eq_u32 vcc, -1, v24
    v_smfmac_f32_16x16x64_bf16 v[40:43], v[20:23], v[128:135], v8
    v_smfmac_f32_16x16x64_bf16 v[44:47], v[20:23], v[136:143], v8
    v_smfmac_f32_16x16x64_bf16 v[48:51], v[20:23], v[144:151], v8
    v_smfmac_f32_16x16x64_bf16 v[52:55], v[20:23], v[152:159], v8
    s_cbranch_vccnz ploopH_21_rm_2
ploopH_21_rm_2ok:
    v_smfmac_f32_16x16x64_bf16 v[32:35], v[24:27], v[160:167], v8
    v_smfmac_f32_16x16x64_bf16 v[36:39], v[24:27], v[168:175], v8
    s_waitcnt vmcnt(0)
    v_cmp_eq_u32 vcc, -1, v28
    v_smfmac_f32_16x16x64_bf16 v[40:43], v[24:27], v[176:183], v8
    v_smfmac_f32_16x16x64_bf16 v[44:47], v[24:27], v[184:191], v8
    v_smfmac_f32_16x16x64_bf16 v[48:51], v[24:27], v[192:199], v8
    v_smfmac_f32_16x16x64_bf16 v[52:55], v[24:27], v[200:207], v8
    s_cbranch_vccnz ploopH_21_rm_3
ploopH_21_rm_3ok:
    v_smfmac_f32_16x16x64_bf16 v[32:35], v[28:31], v[208:215], v8
    ds_write_b32 v63, v59 offset:32
    v_smfmac_f32_16x16x64_bf16 v[36:39], v[28:31], v[216:223], v8
    v_smfmac_f32_16x16x64_bf16 v[40:43], v[28:31], v[224:231], v8
    v_smfmac_f32_16x16x64_bf16 v[44:47], v[28:31], v[232:239], v8
    v_smfmac_f32_16x16x64_bf16 v[48:51], v[28:31], v[240:247], v8
    v_smfmac_f32_16x16x64_bf16 v[52:55], v[28:31], v[248:255], v8
    s_cmp_eq_u32 s3, 3
    s_nop 1
    v_add_f32 v32, v32, v34
    v_add_f32 v33, v33, v35
    ds_write2_b32 v3, v32, v33 offset0:0 offset1:40
    v_add_f32 v36, v36, v38
    v_add_f32 v37, v37, v39
    ds_write2_b32 v3, v36, v37 offset0:16 offset1:56
    v_add_f32 v40, v40, v42
    v_add_f32 v41, v41, v43
    ds_write2_b32 v61, v40, v41 offset0:0 offset1:40
    v_add_f32 v44, v44, v46
    v_add_f32 v45, v45, v47
    ds_write2_b32 v61, v44, v45 offset0:16 offset1:56
    v_add_f32 v48, v48, v50
    v_add_f32 v49, v49, v51
    ds_write2_b32 v62, v48, v49 offset0:0 offset1:40
    v_add_f32 v52, v52, v54
    v_add_f32 v53, v53, v55
    ds_write2_b32 v62, v52, v53 offset0:16 offset1:56
    s_waitcnt lgkmcnt(0)
    s_barrier
    s_cbranch_scc1 ploopH_21_sk1
    ds_read_b128 v[32:35], v4 offset:0
    ds_read_b128 v[36:39], v4 offset:3840
    ds_read_b128 v[40:43], v4 offset:7680
    ds_read_b128 v[44:47], v4 offset:11520
    s_waitcnt lgkmcnt(2)
    v_add_f32 v32, v32, v36
    v_add_f32 v33, v33, v37
    v_add_f32 v34, v34, v38
    v_add_f32 v35, v35, v39
    s_waitcnt lgkmcnt(0)
    v_add_f32 v40, v40, v44
    v_add_f32 v41, v41, v45
    v_add_f32 v42, v42, v46
    v_add_f32 v43, v43, v47
    v_add_f32 v32, v32, v40
    v_add_f32 v33, v33, v41
    v_add_f32 v34, v34, v42
    v_add_f32 v35, v35, v43
    v_cvt_pk_bf16_f32 v56, v32, v33
    v_cvt_pk_bf16_f32 v57, v34, v35
    v_min_u32 v56, -2, v56
    buffer_store_dwordx2 v[56:57], v2, s[4:7], s26 offen
    s_add_u32 s27, s16, 2
    s_and_b32 s27, s27, 3
    s_lshl_b32 s27, s27, 18
    s_add_u32 s27, s27, s38
    buffer_store_dwordx2 v[10:11], v2, s[4:7], s27 offen
ploopH_21_sk1:
    s_setprio 0
    s_add_u32 s25, s16, 3
    s_and_b32 s25, s25, 3
    s_lshl_b32 s25, s25, 16
    s_add_u32 s25, s25, s37
    v_mov_b32 v44, -1
    v_mov_b32 v45, -1
    v_mov_b32 v46, -1
    v_mov_b32 v47, -1
    s_mov_b64 exec, s[56:57]
    buffer_store_dwordx4 v[44:47], v5, s[4:7], s25 offen
    s_mov_b64 exec, -1
    v_mov_b32_dpp v48, v12 row_ror:8 row_mask:0xf bank_mask:0xf
    v_mov_b32_dpp v49, v13 row_ror:8 row_mask:0xf bank_mask:0xf
    v_mov_b32_dpp v50, v14 row_ror:8 row_mask:0xf bank_mask:0xf
    v_mov_b32_dpp v51, v15 row_ror:8 row_mask:0xf bank_mask:0xf
    s_and_b32 s28, s16, 3
    s_lshl_b32 s28, s28, 18
    s_add_u32 s28, s28, s39
    s_add_u32 s24, s16, 1
    s_and_b32 s24, s24, 3
    s_lshl_b32 s24, s24, 16
    s_add_u32 s24, s24, s37
    s_add_u32 s23, s16, 1
    s_and_b32 s23, s23, 3
    s_lshl_b32 s23, s23, 16
    s_add_u32 s23, s23, s36
    s_add_u32 s26, s16, 1
    s_and_b32 s26, s26, 3
    s_lshl_b32 s26, s26, 18
    s_add_u32 s26, s26, s38
    s_cmp_eq_u32 s59, 0
    s_cbranch_scc1 ofl_26
    s_lshl_b32 s17, s3, 10
    v_add_u32 v39, s17, v1
    ds_read_b128 v[40:43], v39 offset:32768
ofl_26:
    s_cmp_eq_u32 s16, 63
    s_cbranch_scc1 ploopH_21_tail
    s_cmp_eq_u32 s30, s54
    s_cbranch_scc1 pnoseg_27
    ds_read_b128 v[16:19], v6 offset:0
    ds_read_b128 v[20:23], v6 offset:256
    ds_read_b128 v[24:27], v6 offset:512
    ds_read_b128 v[28:31], v6 offset:768
    v_xor_b32 v6, 0x4000, v6
    s_waitcnt lgkmcnt(2)
    v_mfma_f32_16x16x32_bf16 v[40:43], v[12:15], v[16:19], 0
    v_mfma_f32_16x16x32_bf16 v[40:43], v[48:51], v[20:23], v[40:43]
    s_waitcnt lgkmcnt(0)
    v_mfma_f32_16x16x32_bf16 v[44:47], v[12:15], v[24:27], 0
    v_mfma_f32_16x16x32_bf16 v[44:47], v[48:51], v[28:31], v[44:47]
    s_nop 7
    v_cvt_pk_bf16_f32 v40, v40, v41
    v_cvt_pk_bf16_f32 v41, v42, v43
    v_cvt_pk_bf16_f32 v42, v44, v45
    v_cvt_pk_bf16_f32 v43, v46, v47
    s_nop 1
    v_permlane16_swap_b32 v40, v42
    v_permlane16_swap_b32 v41, v43
    s_nop 1
    v_min_u32 v40, -2, v40
pnoseg_27:
    s_bitcmp1_b32 s29, 0
    s_cbranch_scc1 gate_28_ok
    s_add_u32 s21, s16, 1
    s_min_u32 s21, s21, 63
    s_cmp_ge_u32 s21, 16
    s_cselect_b32 s19, 12, 8
    s_and_b32 s32, s21, 4
    s_lshr_b32 s21, s21, 3
    s_lshl_b32 s21, s21, 8
    s_add_u32 s32, s32, s21
    s_add_u32 s32, s32, s35
gate_28:
    buffer_load_dword v9, off, s[4:7], s32 sc1
    s_waitcnt vmcnt(0)
    v_readfirstlane_b32 s21, v9
    s_cmp_ge_u32 s21, s19
    s_cbranch_scc1 gate_28_set
    s_sleep 8
    s_sub_u32 s22, s22, 1
    s_cbranch_scc0 gate_28
    s_mov_b32 s22, 0
gate_28_set:
    s_bitset1_b32 s29, 0
gate_28_ok:
    v_readfirstlane_b32 s21, v60
    s_lshr_b32 s29, s29, 1
    s_cmp_ge_u32 s21, s58
    s_cselect_b32 s21, 2, 0
    s_or_b32 s29, s29, s21
    s_cmp_eq_u32 s3, 3
    s_cselect_b32 s20, s21, 0
    s_add_u32 s21, s16, 4
    s_min_u32 s21, s21, 63
    s_cmp_ge_u32 s21, 16
    s_cselect_b32 s58, 12, 8
    s_and_b32 s33, s21, 4
    s_lshr_b32 s21, s21, 3
    s_lshl_b32 s21, s21, 8
    s_add_u32 s33, s33, s21
    s_add_u32 s33, s33, s35
    s_setprio 3
ploopH_21_fs:
    ds_read_b128 v[32:35], v58 offset:0
    s_waitcnt lgkmcnt(0)
    v_min3_i32 v32, v32, v33, v34
    v_min_i32 v32, v32, v35
    s_nop 0
    v_readfirstlane_b32 s18, v32
    s_cmp_ge_i32 s18, s16
    s_cbranch_scc1 ploopH_21_fsok
    s_sleep 1
    s_branch ploopH_21_fs
ploopH_21_fsok:
    s_setprio 1
    s_add_u32 m0, s42, 8192
    s_add_u32 s17, s41, 37748736
    buffer_load_dwordx4 v1, s[4:7], s17 offen offset:0 sc1 lds
    buffer_load_dwordx4 v1, s[4:7], s17 offen offset:1024 sc1 lds
    buffer_load_dwordx4 v1, s[4:7], s17 offen offset:2048 sc1 lds
    buffer_load_dwordx4 v1, s[4:7], s17 offen offset:3072 sc1 lds
    s_add_u32 m0, s42, 12288
    s_add_u32 s17, s41, 37879808
    buffer_load_dwordx4 v1, s[4:7], s17 offen offset:0 sc1 lds
    buffer_load_dwordx4 v1, s[4:7], s17 offen offset:1024 sc1 lds
    buffer_load_dwordx4 v1, s[4:7], s17 offen offset:2048 sc1 lds
    buffer_load_dwordx4 v1, s[4:7], s17 offen offset:3072 sc1 lds
    s_cmp_eq_u32 s20, 0
    s_cbranch_scc1 ploopH_21_nt
    s_mov_b32 exec_hi, 0xffff
    buffer_load_dword v60, v0, s[4:7], s31 offen sc1
    s_mov_b32 exec_hi, -1
ploopH_21_nt:
    s_cmp_eq_u32 s59, 0
    s_cbranch_scc1 ofl_29
    s_lshl_b32 s17, s16, 18
    s_add_u32 s17, s17, s60
    buffer_store_dwordx4 v[40:43], v1, s[4:7], s17 offen sc1
    s_mov_b32 s59, 0
ofl_29:
    s_cmp_eq_u32 s30, s54
    s_cbranch_scc1 pnoseg_30
    buffer_store_dwordx4 v[40:43], v7, s[4:7], s30 offen sc1
    s_add_u32 s30, s30, 65536
pnoseg_30:
    s_or_b32 s17, s13, s3
    s_cmp_lg_u32 s17, 0
    s_cbranch_scc1 ploopH_21_npg
    s_sub_u32 s21, s16, 1
    s_cbranch_scc1 ploopH_21_npg
    s_sub_u32 s17, s21, 1
    s_and_b32 s17, s17, 3
    s_cmp_ge_u32 s16, 58
    s_cselect_b32 s17, 0, s17
    s_cmp_lg_u32 s17, 0
    s_cbranch_scc1 ploopH_21_npg
    s_lshl_b32 s17, s12, 7
    s_add_u32 s17, s17, 218112000
    v_mov_b32 v9, s21
    s_mov_b64 exec, 1
    buffer_store_dword v9, off, s[4:7], s17 sc1
    s_mov_b64 exec, -1
ploopH_21_npg:
    s_barrier
    buffer_load_dword v60, off, s[4:7], s33 sc1
    s_add_u32 s16, s16, 1
    v_mov_b32 v59, s16
    s_add_u32 s41, s41, 262144
    s_add_u32 s31, s31, 262144
    s_mov_b32 s54, 0
    s_setprio 3
    s_sleep 13
ploopH_21_pagain:
    buffer_load_dwordx4 v[16:19], v1, s[4:7], s28 offen offset:0 sc1
    buffer_load_dwordx4 v[20:23], v1, s[4:7], s28 offen offset:1024 sc1
    s_waitcnt vmcnt(1)
    v_mfma_f32_16x16x32_bf16 v[32:35], v[12:15], v[16:19], 0
    s_waitcnt vmcnt(0)
    v_mfma_f32_16x16x32_bf16 v[32:35], v[12:15], v[20:23], v[32:35]
    v_max_u32 v9, v16, v20
    v_cmp_eq_u32 vcc, -1, v9
    s_cbranch_vccnz ploopH_21_rp
ploopH_21_pgo:
    s_nop 4
    v_cvt_pk_bf16_f32 v52, v32, v33
    v_cvt_pk_bf16_f32 v53, v34, v35
    s_nop 0
    v_permlane16_swap_b32 v52, v54
    v_permlane16_swap_b32 v53, v55
    s_mov_b64 exec, s[56:57]
    v_min_u32 v52, -2, v52
    buffer_store_dwordx4 v[52:55], v5, s[4:7], s24 offen
    s_mov_b64 exec, -1
    ds_write_b32 v63, v59 offset:16
    s_branch ploopH_21
ploopH_21_rm_0:
    s_sub_u32 s22, s22, 1
    s_cbranch_scc1 ploopH_21_rm_0_g
    buffer_load_dwordx4 v[16:19], v1, s[4:7], s23 offen offset:0 sc1
    buffer_load_dwordx4 v[20:23], v1, s[4:7], s23 offen offset:1024 sc1
    buffer_load_dwordx4 v[24:27], v1, s[4:7], s23 offen offset:2048 sc1
    buffer_load_dwordx4 v[28:31], v1, s[4:7], s23 offen offset:3072 sc1
    s_waitcnt vmcnt(3)
    v_cmp_eq_u32 vcc, -1, v16
    s_cbranch_vccnz ploopH_21_rm_0
    s_branch ploopH_21_rm_0ok
ploopH_21_rm_0_g:
    s_mov_b32 s22, 0
    s_waitcnt vmcnt(0)
    s_branch ploopH_21_rm_0ok
ploopH_21_rm_1:
    s_sub_u32 s22, s22, 1
    s_cbranch_scc1 ploopH_21_rm_1_g
    buffer_load_dwordx4 v[20:23], v1, s[4:7], s23 offen offset:1024 sc1
    buffer_load_dwordx4 v[24:27], v1, s[4:7], s23 offen offset:2048 sc1
    buffer_load_dwordx4 v[28:31], v1, s[4:7], s23 offen offset:3072 sc1
    s_waitcnt vmcnt(2)
    v_cmp_eq_u32 vcc, -1, v20
    s_cbranch_vccnz ploopH_21_rm_1
    s_branch ploopH_21_rm_1ok
ploopH_21_rm_1_g:
    s_mov_b32 s22, 0
    s_waitcnt vmcnt(0)
    s_branch ploopH_21_rm_1ok
ploopH_21_rm_2:
    s_sub_u32 s22, s22, 1
    s_cbranch_scc1 ploopH_21_rm_2_g
    buffer_load_dwordx4 v[24:27], v1, s[4:7], s23 offen offset:2048 sc1
    buffer_load_dwordx4 v[28:31], v1, s[4:7], s23 offen offset:3072 sc1
    s_waitcnt vmcnt(1)
    v_cmp_eq_u32 vcc, -1, v24
    s_cbranch_vccnz ploopH_21_rm_2
    s_branch ploopH_21_rm_2ok
ploopH_21_rm_2_g:
    s_mov_b32 s22, 0
    s_waitcnt vmcnt(0)
    s_branch ploopH_21_rm_2ok
ploopH_21_rm_3:
    s_sub_u32 s22, s22, 1
    s_cbranch_scc1 ploopH_21_rm_3_g
    buffer_load_dwordx4 v[28:31], v1, s[4:7], s23 offen offset:3072 sc1
    s_waitcnt vmcnt(0)
    v_cmp_eq_u32 vcc, -1, v28
    s_cbranch_vccnz ploopH_21_rm_3
    s_branch ploopH_21_rm_3ok
ploopH_21_rm_3_g:
    s_mov_b32 s22, 0
    s_waitcnt vmcnt(0)
    s_branch ploopH_21_rm_3ok
ploopH_21_rp:
    s_sub_u32 s22, s22, 1
    s_cbranch_scc0 ploopH_21_pagain
    s_mov_b32 s22, 0
    s_branch ploopH_21_pgo
ploopH_21_tail:
    ds_read_b128 v[16:19], v6 offset:0
    ds_read_b128 v[20:23], v6 offset:256
    ds_read_b128 v[24:27], v6 offset:512
    ds_read_b128 v[28:31], v6 offset:768
    v_xor_b32 v6, 0x4000, v6
    s_waitcnt lgkmcnt(2)
    v_mfma_f32_16x16x32_bf16 v[40:43], v[12:15], v[16:19], 0
    v_mfma_f32_16x16x32_bf16 v[40:43], v[48:51], v[20:23], v[40:43]
    s_waitcnt lgkmcnt(0)
    v_mfma_f32_16x16x32_bf16 v[44:47], v[12:15], v[24:27], 0
    v_mfma_f32_16x16x32_bf16 v[44:47], v[48:51], v[28:31], v[44:47]
    s_nop 7
    v_cvt_pk_bf16_f32 v40, v40, v41
    v_cvt_pk_bf16_f32 v41, v42, v43
    v_cvt_pk_bf16_f32 v42, v44, v45
    v_cvt_pk_bf16_f32 v43, v46, v47
    s_nop 1
    v_permlane16_swap_b32 v40, v42
    v_permlane16_swap_b32 v41, v43
    s_nop 1
    v_min_u32 v40, -2, v40
    buffer_store_dwordx4 v[40:43], v7, s[4:7], s30 offen sc1
    s_add_u32 s30, s30, 65536
    s_barrier
    ds_read_b128 v[16:19], v6 offset:0
    ds_read_b128 v[20:23], v6 offset:256
    ds_read_b128 v[24:27], v6 offset:512
    ds_read_b128 v[28:31], v6 offset:768
    v_xor_b32 v6, 0x4000, v6
    s_waitcnt lgkmcnt(2)
    v_mfma_f32_16x16x32_bf16 v[40:43], v[12:15], v[16:19], 0
    v_mfma_f32_16x16x32_bf16 v[40:43], v[48:51], v[20:23], v[40:43]
    s_waitcnt lgkmcnt(0)
    v_mfma_f32_16x16x32_bf16 v[44:47], v[12:15], v[24:27], 0
    v_mfma_f32_16x16x32_bf16 v[44:47], v[48:51], v[28:31], v[44:47]
    s_nop 7
    v_cvt_pk_bf16_f32 v40, v40, v41
    v_cvt_pk_bf16_f32 v41, v42, v43
    v_cvt_pk_bf16_f32 v42, v44, v45
    v_cvt_pk_bf16_f32 v43, v46, v47
    s_nop 1
    v_permlane16_swap_b32 v40, v42
    v_permlane16_swap_b32 v41, v43
    s_nop 1
    v_min_u32 v40, -2, v40
    buffer_store_dwordx4 v[40:43], v7, s[4:7], s30 offen sc1
    s_add_u32 s30, s30, 65536
    s_branch k_end
ch_p_slow:
    v_mov_b32 v32, 0
    v_mov_b32 v33, 0
    v_mov_b32 v34, 0
    v_mov_b32 v35, 0
    v_mov_b32 v36, 0
    v_mov_b32 v37, 0
    v_mov_b32 v38, 0
    v_mov_b32 v39, 0
    v_mov_b32 v40, 0
    v_mov_b32 v41, 0
    v_mov_b32 v42, 0
    v_mov_b32 v43, 0
    v_mov_b32 v44, 0
    v_mov_b32 v45, 0
    v_mov_b32 v46, 0
    v_mov_b32 v47, 0
    v_mov_b32 v48, 0
    v_mov_b32 v49, 0
    v_mov_b32 v50, 0
    v_mov_b32 v51, 0
    v_mov_b32 v52, 0
    v_mov_b32 v53, 0
    v_mov_b32 v54, 0
    v_mov_b32 v55, 0
    v_mov_b32 v59, 0
    s_nop 1
    s_branch ploopL_32_nc
.p2align 6
    s_nop 0
    s_nop 0
    s_nop 0
    s_nop 0
    s_nop 0
    s_nop 0
    s_nop 0
    s_nop 0
    s_nop 0
    s_nop 0
    s_nop 0
ploopL_32:
    v_mov_b32 v32, 0
    v_mov_b32 v33, 0
    v_mov_b32 v34, 0
    v_mov_b32 v35, 0
    v_mov_b32 v36, 0
    v_mov_b32 v37, 0
    v_mov_b32 v38, 0
    v_mov_b32 v39, 0
    v_mov_b32 v40, 0
    v_mov_b32 v41, 0
    v_mov_b32 v42, 0
    v_mov_b32 v43, 0
    v_mov_b32 v44, 0
    v_mov_b32 v45, 0
    v_mov_b32 v46, 0
    v_mov_b32 v47, 0
    v_mov_b32 v48, 0
    v_mov_b32 v49, 0
    v_mov_b32 v50, 0
    v_mov_b32 v51, 0
    v_mov_b32 v52, 0
    v_mov_b32 v53, 0
    v_mov_b32 v54, 0
    v_mov_b32 v55, 0
    s_bitcmp1_b32 s29, 0
    s_cbranch_scc1 gate_33_ok
    s_add_u32 s21, s16, 1
    s_min_u32 s21, s21, 63
    s_cmp_ge_u32 s21, 16
    s_cselect_b32 s19, 12, 8
    s_and_b32 s32, s21, 4
    s_lshr_b32 s21, s21, 3
    s_lshl_b32 s21, s21, 8
    s_add_u32 s32, s32, s21
    s_add_u32 s32, s32, s35
gate_33:
    buffer_load_dword v9, off, s[4:7], s32 sc1
    s_waitcnt vmcnt(0)
    v_readfirstlane_b32 s21, v9
    s_cmp_ge_u32 s21, s19
    s_cbranch_scc1 gate_33_set
    s_sleep 8
    s_sub_u32 s22, s22, 1
    s_cbranch_scc0 gate_33
    s_mov_b32 s22, 0
gate_33_set:
    s_bitset1_b32 s29, 0
gate_33_ok:
    s_sleep 1
    buffer_load_dwordx4 v[16:19], v1, s[4:7], s23 offen offset:0 sc1
    buffer_load_dwordx4 v[20:23], v1, s[4:7], s23 offen offset:1024 sc1
    buffer_load_dwordx4 v[24:27], v1, s[4:7], s23 offen offset:2048 sc1
    buffer_load_dwordx4 v[28:31], v1, s[4:7], s23 offen offset:3072 sc1
    s_waitcnt vmcnt(3)
    v_cmp_eq_u32 vcc, -1, v16
    s_cbranch_vccnz ploopL_32_rm_0
ploopL_32_rm_0ok:
    v_smfmac_f32_16x16x64_bf16 v[32:35], v[16:19], v[64:71], v8
    v_smfmac_f32_16x16x64_bf16 v[36:39], v[16:19], v[72:79], v8
    s_waitcnt vmcnt(2)
    v_cmp_eq_u32 vcc, -1, v20
    v_smfmac_f32_16x16x64_bf16 v[40:43], v[16:19], v[80:87], v8
    v_smfmac_f32_16x16x64_bf16 v[44:47], v[16:19], v[88:95], v8
    v_smfmac_f32_16x16x64_bf16 v[48:51], v[16:19], v[96:103], v8
    v_smfmac_f32_16x16x64_bf16 v[52:55], v[16:19], v[104:111], v8
    s_cbranch_vccnz ploopL_32_rm_1
ploopL_32_rm_1ok:
    v_smfmac_f32_16x16x64_bf16 v[32:35], v[20:23], v[112:119], v8
    v_smfmac_f32_16x16x64_bf16 v[36:39], v[20:23], v[120:127], v8
    s_waitcnt vmcnt(1)
    v_cmp_eq_u32 vcc, -1, v24
    v_smfmac_f32_16x16x64_bf16 v[40:43], v[20:23], v[128:135], v8
    v_smfmac_f32_16x16x64_bf16 v[44:47], v[20:23], v[136:143], v8
    v_smfmac_f32_16x16x64_bf16 v[48:51], v[20:23], v[144:151], v8
    v_smfmac_f32_16x16x64_bf16 v[52:55], v[20:23], v[152:159], v8
    s_cbranch_vccnz ploopL_32_rm_2
ploopL_32_rm_2ok:
    v_smfmac_f32_16x16x64_bf16 v[32:35], v[24:27], v[160:167], v8
    v_smfmac_f32_16x16x64_bf16 v[36:39], v[24:27], v[168:175], v8
    s_waitcnt vmcnt(0)
    v_cmp_eq_u32 vcc, -1, v28
    v_smfmac_f32_16x16x64_bf16 v[40:43], v[24:27], v[176:183], v8
    v_smfmac_f32_16x16x64_bf16 v[44:47], v[24:27], v[184:191], v8
    v_smfmac_f32_16x16x64_bf16 v[48:51], v[24:27], v[192:199], v8
    v_smfmac_f32_16x16x64_bf16 v[52:55], v[24:27], v[200:207], v8
    s_cbranch_vccnz ploopL_32_rm_3
ploopL_32_rm_3ok:
    v_smfmac_f32_16x16x64_bf16 v[32:35], v[28:31], v[208:215], v8
    ds_write_b32 v63, v59 offset:32
    v_smfmac_f32_16x16x64_bf16 v[36:39], v[28:31], v[216:223], v8
    v_smfmac_f32_16x16x64_bf16 v[40:43], v[28:31], v[224:231], v8
    v_smfmac_f32_16x16x64_bf16 v[44:47], v[28:31], v[232:239], v8
    v_smfmac_f32_16x16x64_bf16 v[48:51], v[28:31], v[240:247], v8
    v_smfmac_f32_16x16x64_bf16 v[52:55], v[28:31], v[248:255], v8
    s_branch ploopL_32_mmd
ploopL_32_nc:
    v_smfmac_f32_16x16x64_bf16 v[32:35], v[16:19], v[64:71], v8
    v_smfmac_f32_16x16x64_bf16 v[36:39], v[16:19], v[72:79], v8
    v_smfmac_f32_16x16x64_bf16 v[40:43], v[16:19], v[80:87], v8
    v_smfmac_f32_16x16x64_bf16 v[44:47], v[16:19], v[88:95], v8
    v_smfmac_f32_16x16x64_bf16 v[48:51], v[16:19], v[96:103], v8
    v_smfmac_f32_16x16x64_bf16 v[52:55], v[16:19], v[104:111], v8
    v_smfmac_f32_16x16x64_bf16 v[32:35], v[20:23], v[112:119], v8
    v_smfmac_f32_16x16x64_bf16 v[36:39], v[20:23], v[120:127], v8
    v_smfmac_f32_16x16x64_bf16 v[40:43], v[20:23], v[128:135], v8
    v_smfmac_f32_16x16x64_bf16 v[44:47], v[20:23], v[136:143], v8
    v_smfmac_f32_16x16x64_bf16 v[48:51], v[20:23], v[144:151], v8
    v_smfmac_f32_16x16x64_bf16 v[52:55], v[20:23], v[152:159], v8
    v_smfmac_f32_16x16x64_bf16 v[32:35], v[24:27], v[160:167], v8
    v_smfmac_f32_16x16x64_bf16 v[36:39], v[24:27], v[168:175], v8
    v_smfmac_f32_16x16x64_bf16 v[40:43], v[24:27], v[176:183], v8
    v_smfmac_f32_16x16x64_bf16 v[44:47], v[24:27], v[184:191], v8
    v_smfmac_f32_16x16x64_bf16 v[48:51], v[24:27], v[192:199], v8
    v_smfmac_f32_16x16x64_bf16 v[52:55], v[24:27], v[200:207], v8
    v_smfmac_f32_16x16x64_bf16 v[32:35], v[28:31], v[208:215], v8
    ds_write_b32 v63, v59 offset:32
    v_smfmac_f32_16x16x64_bf16 v[36:39], v[28:31], v[216:223], v8
    v_smfmac_f32_16x16x64_bf16 v[40:43], v[28:31], v[224:231], v8
    v_smfmac_f32_16x16x64_bf16 v[44:47], v[28:31], v[232:239], v8
    v_smfmac_f32_16x16x64_bf16 v[48:51], v[28:31], v[240:247], v8
    v_smfmac_f32_16x16x64_bf16 v[52:55], v[28:31], v[248:255], v8
ploopL_32_mmd:
    s_cmp_eq_u32 s3, 3
    s_nop 1
    v_add_f32 v32, v32, v34
    v_add_f32 v33, v33, v35
    ds_write2_b32 v3, v32, v33 offset0:0 offset1:40
    v_add_f32 v36, v36, v38
    v_add_f32 v37, v37, v39
    ds_write2_b32 v3, v36, v37 offset0:16 offset1:56
    v_add_f32 v40, v40, v42
    v_add_f32 v41, v41, v43
    ds_write2_b32 v61, v40, v41 offset0:0 offset1:40
    v_add_f32 v44, v44, v46
    v_add_f32 v45, v45, v47
    ds_write2_b32 v61, v44, v45 offset0:16 offset1:56
    v_add_f32 v48, v48, v50
    v_add_f32 v49, v49, v51
    ds_write2_b32 v62, v48, v49 offset0:0 offset1:40
    v_add_f32 v52, v52, v54
    v_add_f32 v53, v53, v55
    ds_write2_b32 v62, v52, v53 offset0:16 offset1:56
    s_waitcnt lgkmcnt(0)
    s_barrier
    s_cbranch_scc1 ploopL_32_sk1
    ds_read_b128 v[32:35], v4 offset:0
    ds_read_b128 v[36:39], v4 offset:3840
    ds_read_b128 v[40:43], v4 offset:7680
    ds_read_b128 v[44:47], v4 offset:11520
    s_waitcnt lgkmcnt(2)
    v_add_f32 v32, v32, v36
    v_add_f32 v33, v33, v37
    v_add_f32 v34, v34, v38
    v_add_f32 v35, v35, v39
    s_waitcnt lgkmcnt(0)
    v_add_f32 v40, v40, v44
    v_add_f32 v41, v41, v45
    v_add_f32 v42, v42, v46
    v_add_f32 v43, v43, v47
    v_add_f32 v32, v32, v40
    v_add_f32 v33, v33, v41
    v_add_f32 v34, v34, v42
    v_add_f32 v35, v35, v43
    v_cvt_pk_bf16_f32 v56, v32, v33
    v_cvt_pk_bf16_f32 v57, v34, v35
    v_min_u32 v56, -2, v56
    buffer_store_dwordx2 v[56:57], v2, s[4:7], s26 offen sc1
    s_add_u32 s27, s16, 2
    s_and_b32 s27, s27, 3
    s_lshl_b32 s27, s27, 18
    s_add_u32 s27, s27, s38
    buffer_store_dwordx2 v[10:11], v2, s[4:7], s27 offen sc1
ploopL_32_sk1:
    s_setprio 0
    s_add_u32 s25, s16, 3
    s_and_b32 s25, s25, 3
    s_lshl_b32 s25, s25, 16
    s_add_u32 s25, s25, s37
    v_mov_b32 v44, -1
    v_mov_b32 v45, -1
    v_mov_b32 v46, -1
    v_mov_b32 v47, -1
    s_mov_b64 exec, s[56:57]
    buffer_store_dwordx4 v[44:47], v5, s[4:7], s25 offen sc1
    s_mov_b64 exec, -1
    s_and_b32 s28, s16, 3
    s_lshl_b32 s28, s28, 18
    s_add_u32 s28, s28, s39
    s_add_u32 s24, s16, 1
    s_and_b32 s24, s24, 3
    s_lshl_b32 s24, s24, 16
    s_add_u32 s24, s24, s37
    s_add_u32 s23, s16, 1
    s_and_b32 s23, s23, 3
    s_lshl_b32 s23, s23, 16
    s_add_u32 s23, s23, s36
    s_add_u32 s26, s16, 1
    s_and_b32 s26, s26, 3
    s_lshl_b32 s26, s26, 18
    s_add_u32 s26, s26, s38
    s_cmp_eq_u32 s59, 0
    s_cbranch_scc1 ofl_34
    s_lshl_b32 s17, s3, 10
    v_add_u32 v39, s17, v1
    ds_read_b128 v[40:43], v39 offset:32768
ofl_34:
    s_cmp_ge_u32 s16, 16
    s_cbranch_scc1 ploopL_32_nx
    v_mov_b32 v40, v2
    v_mov_b32 v42, v56
    v_mov_b32 v43, v57
    s_cmp_lg_u32 s3, 2
    s_cbranch_scc1 ploopL_32_nx
    v_and_b32 v40, 0x60, v1
    v_lshlrev_b32 v40, 2, v40
    v_lshrrev_b32 v41, 3, v1
    v_and_b32 v41, 0x70, v41
    v_or_b32 v40, v40, v41
    v_bfe_u32 v41, v1, 4, 1
    v_lshl_or_b32 v40, v41, 3, v40
    s_lshl_b32 s17, s53, 9
    s_add_u32 s17, s17, 4096
    v_add_u32 v40, s17, v40
    s_mov_b32 vcc_lo, 0x55555555
    s_mov_b32 vcc_hi, 0x55555555
    v_cndmask_b32_dpp v42, v57, v56, vcc quad_perm:[1,0,3,2] row_mask:0xf bank_mask:0xf
    s_not_b64 vcc, vcc
    v_cndmask_b32_dpp v43, v56, v57, vcc quad_perm:[1,0,3,2] row_mask:0xf bank_mask:0xf
ploopL_32_nx:
    v_readfirstlane_b32 s21, v60
    s_lshr_b32 s29, s29, 1
    s_cmp_ge_u32 s21, s58
    s_cselect_b32 s21, 2, 0
    s_or_b32 s29, s29, s21
    s_cmp_eq_u32 s3, 3
    s_cselect_b32 s20, s21, 0
    s_add_u32 s21, s16, 4
    s_min_u32 s21, s21, 63
    s_cmp_ge_u32 s21, 16
    s_cselect_b32 s58, 12, 8
    s_and_b32 s33, s21, 4
    s_lshr_b32 s21, s21, 3
    s_lshl_b32 s21, s21, 8
    s_add_u32 s33, s33, s21
    s_add_u32 s33, s33, s35
    s_setprio 3
ploopL_32_fs:
    ds_read_b128 v[32:35], v58 offset:0
    s_waitcnt lgkmcnt(0)
    v_min3_i32 v32, v32, v33, v34
    v_min_i32 v32, v32, v35
    s_nop 0
    v_readfirstlane_b32 s18, v32
    s_cmp_ge_i32 s18, s16
    s_cbranch_scc1 ploopL_32_fsok
    s_sleep 1
    s_branch ploopL_32_fs
ploopL_32_fsok:
    s_setprio 1
    s_sleep 4
ploopL_32_nofd:
    s_cmp_eq_u32 s20, 0
    s_cbranch_scc1 ploopL_32_nt
    s_cmp_ge_u32 s16, 13
    s_cselect_b32 exec_hi, 0xffff, 0
    buffer_load_dword v60, v0, s[4:7], s31 offen sc1
    s_mov_b32 exec_hi, -1
ploopL_32_nt:
    s_cmp_eq_u32 s59, 0
    s_cbranch_scc1 ofl_35
    s_lshl_b32 s17, s16, 18
    s_add_u32 s17, s17, s60
    buffer_store_dwordx4 v[40:43], v1, s[4:7], s17 offen sc1
    s_mov_b32 s59, 0
ofl_35:
    s_lshr_b32 s17, s34, 3
    s_xor_b32 s17, s17, s16
    s_andn2_b32 s59, 1, s17
    s_cmp_ge_u32 s16, 16
    s_cselect_b32 s59, s59, 0
    s_cbranch_scc1 ploopL_32_nx2
    s_cmp_eq_u32 s3, 3
    s_cbranch_scc1 ploopL_32_nx2
    buffer_store_dwordx2 v[42:43], v40, s[4:7], s55 offen sc1
ploopL_32_nx2:
    s_add_u32 s55, s55, 262144
    s_or_b32 s17, s13, s3
    s_cmp_lg_u32 s17, 0
    s_cbranch_scc1 ploopL_32_npg
    s_sub_u32 s21, s16, 1
    s_cbranch_scc1 ploopL_32_npg
    s_sub_u32 s17, s21, 1
    s_and_b32 s17, s17, 3
    s_cmp_ge_u32 s16, 58
    s_cselect_b32 s17, 0, s17
    s_cmp_lg_u32 s17, 0
    s_cbranch_scc1 ploopL_32_npg
    s_lshl_b32 s17, s12, 7
    s_add_u32 s17, s17, 218112000
    v_mov_b32 v9, s21
    s_mov_b64 exec, 1
    buffer_store_dword v9, off, s[4:7], s17 sc1
    s_mov_b64 exec, -1
ploopL_32_npg:
    s_barrier
    buffer_load_dword v60, off, s[4:7], s33 sc1
    s_add_u32 s16, s16, 1
    v_mov_b32 v59, s16
    s_add_u32 s41, s41, 262144
    s_add_u32 s31, s31, 262144
    s_setprio 3
    s_sleep 13
ploopL_32_pagain:
    buffer_load_dwordx4 v[16:19], v1, s[4:7], s28 offen offset:0 sc1
    buffer_load_dwordx4 v[20:23], v1, s[4:7], s28 offen offset:1024 sc1
    s_waitcnt vmcnt(1)
    v_mfma_f32_16x16x32_bf16 v[32:35], v[12:15], v[16:19], 0
    s_waitcnt vmcnt(0)
    v_mfma_f32_16x16x32_bf16 v[32:35], v[12:15], v[20:23], v[32:35]
    v_max_u32 v9, v16, v20
    v_cmp_eq_u32 vcc, -1, v9
    s_cbranch_vccnz ploopL_32_rp
ploopL_32_pgo:
    s_cmp_lt_u32 s16, 48
    s_nop 3
    v_cvt_pk_bf16_f32 v52, v32, v33
    v_cvt_pk_bf16_f32 v53, v34, v35
    s_nop 0
    v_permlane16_swap_b32 v52, v54
    v_permlane16_swap_b32 v53, v55
    s_mov_b64 exec, s[56:57]
    v_min_u32 v52, -2, v52
    buffer_store_dwordx4 v[52:55], v5, s[4:7], s24 offen sc1
    s_mov_b64 exec, -1
    ds_write_b32 v63, v59 offset:16
    s_cbranch_scc1 ploopL_32
    s_branch ploopH_31
ploopL_32_rm_0:
    s_sub_u32 s22, s22, 1
    s_cbranch_scc1 ploopL_32_rm_0_g
    buffer_load_dwordx4 v[16:19], v1, s[4:7], s23 offen offset:0 sc1
    buffer_load_dwordx4 v[20:23], v1, s[4:7], s23 offen offset:1024 sc1
    buffer_load_dwordx4 v[24:27], v1, s[4:7], s23 offen offset:2048 sc1
    buffer_load_dwordx4 v[28:31], v1, s[4:7], s23 offen offset:3072 sc1
    s_waitcnt vmcnt(3)
    v_cmp_eq_u32 vcc, -1, v16
    s_cbranch_vccnz ploopL_32_rm_0
    s_branch ploopL_32_rm_0ok
ploopL_32_rm_0_g:
    s_mov_b32 s22, 0
    s_waitcnt vmcnt(0)
    s_branch ploopL_32_rm_0ok
ploopL_32_rm_1:
    s_sub_u32 s22, s22, 1
    s_cbranch_scc1 ploopL_32_rm_1_g
    buffer_load_dwordx4 v[20:23], v1, s[4:7], s23 offen offset:1024 sc1
    buffer_load_dwordx4 v[24:27], v1, s[4:7], s23 offen offset:2048 sc1
    buffer_load_dwordx4 v[28:31], v1, s[4:7], s23 offen offset:3072 sc1
    s_waitcnt vmcnt(2)
    v_cmp_eq_u32 vcc, -1, v20
    s_cbranch_vccnz ploopL_32_rm_1
    s_branch ploopL_32_rm_1ok
ploopL_32_rm_1_g:
    s_mov_b32 s22, 0
    s_waitcnt vmcnt(0)
    s_branch ploopL_32_rm_1ok
ploopL_32_rm_2:
    s_sub_u32 s22, s22, 1
    s_cbranch_scc1 ploopL_32_rm_2_g
    buffer_load_dwordx4 v[24:27], v1, s[4:7], s23 offen offset:2048 sc1
    buffer_load_dwordx4 v[28:31], v1, s[4:7], s23 offen offset:3072 sc1
    s_waitcnt vmcnt(1)
    v_cmp_eq_u32 vcc, -1, v24
    s_cbranch_vccnz ploopL_32_rm_2
    s_branch ploopL_32_rm_2ok
ploopL_32_rm_2_g:
    s_mov_b32 s22, 0
    s_waitcnt vmcnt(0)
    s_branch ploopL_32_rm_2ok
ploopL_32_rm_3:
    s_sub_u32 s22, s22, 1
    s_cbranch_scc1 ploopL_32_rm_3_g
    buffer_load_dwordx4 v[28:31], v1, s[4:7], s23 offen offset:3072 sc1
    s_waitcnt vmcnt(0)
    v_cmp_eq_u32 vcc, -1, v28
    s_cbranch_vccnz ploopL_32_rm_3
    s_branch ploopL_32_rm_3ok
ploopL_32_rm_3_g:
    s_mov_b32 s22, 0
    s_waitcnt vmcnt(0)
    s_branch ploopL_32_rm_3ok
ploopL_32_rp:
    s_sub_u32 s22, s22, 1
    s_cbranch_scc0 ploopL_32_pagain
    s_mov_b32 s22, 0
    s_branch ploopL_32_pgo
.p2align 6
    s_nop 0
    s_nop 0
    s_nop 0
    s_nop 0
    s_nop 0
    s_nop 0
    s_nop 0
    s_nop 0
    s_nop 0
    s_nop 0
    s_nop 0
ploopH_31:
    v_mov_b32 v32, 0
    v_mov_b32 v33, 0
    v_mov_b32 v34, 0
    v_mov_b32 v35, 0
    v_mov_b32 v36, 0
    v_mov_b32 v37, 0
    v_mov_b32 v38, 0
    v_mov_b32 v39, 0
    v_mov_b32 v40, 0
    v_mov_b32 v41, 0
    v_mov_b32 v42, 0
    v_mov_b32 v43, 0
    v_mov_b32 v44, 0
    v_mov_b32 v45, 0
    v_mov_b32 v46, 0
    v_mov_b32 v47, 0
    v_mov_b32 v48, 0
    v_mov_b32 v49, 0
    v_mov_b32 v50, 0
    v_mov_b32 v51, 0
    v_mov_b32 v52, 0
    v_mov_b32 v53, 0
    v_mov_b32 v54, 0
    v_mov_b32 v55, 0
    s_sleep 1
    buffer_load_dwordx4 v[16:19], v1, s[4:7], s23 offen offset:0 sc1
    buffer_load_dwordx4 v[20:23], v1, s[4:7], s23 offen offset:1024 sc1
    buffer_load_dwordx4 v[24:27], v1, s[4:7], s23 offen offset:2048 sc1
    buffer_load_dwordx4 v[28:31], v1, s[4:7], s23 offen offset:3072 sc1
    s_waitcnt vmcnt(3)
    v_cmp_eq_u32 vcc, -1, v16
    s_cbranch_vccnz ploopH_31_rm_0
ploopH_31_rm_0ok:
    v_smfmac_f32_16x16x64_bf16 v[32:35], v[16:19], v[64:71], v8
    v_smfmac_f32_16x16x64_bf16 v[36:39], v[16:19], v[72:79], v8
    s_waitcnt vmcnt(2)
    v_cmp_eq_u32 vcc, -1, v20
    v_smfmac_f32_16x16x64_bf16 v[40:43], v[16:19], v[80:87], v8
    v_smfmac_f32_16x16x64_bf16 v[44:47], v[16:19], v[88:95], v8
    v_smfmac_f32_16x16x64_bf16 v[48:51], v[16:19], v[96:103], v8
    v_smfmac_f32_16x16x64_bf16 v[52:55], v[16:19], v[104:111], v8
    s_cbranch_vccnz ploopH_31_rm_1
ploopH_31_rm_1ok:
    v_smfmac_f32_16x16x64_bf16 v[32:35], v[20:23], v[112:119], v8
    v_smfmac_f32_16x16x64_bf16 v[36:39], v[20:23], v[120:127], v8
    s_waitcnt vmcnt(1)
    v_cmp_eq_u32 vcc, -1, v24
    v_smfmac_f32_16x16x64_bf16 v[40:43], v[20:23], v[128:135], v8
    v_smfmac_f32_16x16x64_bf16 v[44:47], v[20:23], v[136:143], v8
    v_smfmac_f32_16x16x64_bf16 v[48:51], v[20:23], v[144:151], v8
    v_smfmac_f32_16x16x64_bf16 v[52:55], v[20:23], v[152:159], v8
    s_cbranch_vccnz ploopH_31_rm_2
ploopH_31_rm_2ok:
    v_smfmac_f32_16x16x64_bf16 v[32:35], v[24:27], v[160:167], v8
    v_smfmac_f32_16x16x64_bf16 v[36:39], v[24:27], v[168:175], v8
    s_waitcnt vmcnt(0)
    v_cmp_eq_u32 vcc, -1, v28
    v_smfmac_f32_16x16x64_bf16 v[40:43], v[24:27], v[176:183], v8
    v_smfmac_f32_16x16x64_bf16 v[44:47], v[24:27], v[184:191], v8
    v_smfmac_f32_16x16x64_bf16 v[48:51], v[24:27], v[192:199], v8
    v_smfmac_f32_16x16x64_bf16 v[52:55], v[24:27], v[200:207], v8
    s_cbranch_vccnz ploopH_31_rm_3
ploopH_31_rm_3ok:
    v_smfmac_f32_16x16x64_bf16 v[32:35], v[28:31], v[208:215], v8
    ds_write_b32 v63, v59 offset:32
    v_smfmac_f32_16x16x64_bf16 v[36:39], v[28:31], v[216:223], v8
    v_smfmac_f32_16x16x64_bf16 v[40:43], v[28:31], v[224:231], v8
    v_smfmac_f32_16x16x64_bf16 v[44:47], v[28:31], v[232:239], v8
    v_smfmac_f32_16x16x64_bf16 v[48:51], v[28:31], v[240:247], v8
    v_smfmac_f32_16x16x64_bf16 v[52:55], v[28:31], v[248:255], v8
    s_cmp_eq_u32 s3, 3
    s_nop 1
    v_add_f32 v32, v32, v34
    v_add_f32 v33, v33, v35
    ds_write2_b32 v3, v32, v33 offset0:0 offset1:40
    v_add_f32 v36, v36, v38
    v_add_f32 v37, v37, v39
    ds_write2_b32 v3, v36, v37 offset0:16 offset1:56
    v_add_f32 v40, v40, v42
    v_add_f32 v41, v41, v43
    ds_write2_b32 v61, v40, v41 offset0:0 offset1:40
    v_add_f32 v44, v44, v46
    v_add_f32 v45, v45, v47
    ds_write2_b32 v61, v44, v45 offset0:16 offset1:56
    v_add_f32 v48, v48, v50
    v_add_f32 v49, v49, v51
    ds_write2_b32 v62, v48, v49 offset0:0 offset1:40
    v_add_f32 v52, v52, v54
    v_add_f32 v53, v53, v55
    ds_write2_b32 v62, v52, v53 offset0:16 offset1:56
    s_waitcnt lgkmcnt(0)
    s_barrier
    s_cbranch_scc1 ploopH_31_sk1
    ds_read_b128 v[32:35], v4 offset:0
    ds_read_b128 v[36:39], v4 offset:3840
    ds_read_b128 v[40:43], v4 offset:7680
    ds_read_b128 v[44:47], v4 offset:11520
    s_waitcnt lgkmcnt(2)
    v_add_f32 v32, v32, v36
    v_add_f32 v33, v33, v37
    v_add_f32 v34, v34, v38
    v_add_f32 v35, v35, v39
    s_waitcnt lgkmcnt(0)
    v_add_f32 v40, v40, v44
    v_add_f32 v41, v41, v45
    v_add_f32 v42, v42, v46
    v_add_f32 v43, v43, v47
    v_add_f32 v32, v32, v40
    v_add_f32 v33, v33, v41
    v_add_f32 v34, v34, v42
    v_add_f32 v35, v35, v43
    v_cvt_pk_bf16_f32 v56, v32, v33
    v_cvt_pk_bf16_f32 v57, v34, v35
    v_min_u32 v56, -2, v56
    buffer_store_dwordx2 v[56:57], v2, s[4:7], s26 offen sc1
    s_add_u32 s27, s16, 2
    s_and_b32 s27, s27, 3
    s_lshl_b32 s27, s27, 18
    s_add_u32 s27, s27, s38
    buffer_store_dwordx2 v[10:11], v2, s[4:7], s27 offen sc1
ploopH_31_sk1:
    s_setprio 0
    s_add_u32 s25, s16, 3
    s_and_b32 s25, s25, 3
    s_lshl_b32 s25, s25, 16
    s_add_u32 s25, s25, s37
    v_mov_b32 v44, -1
    v_mov_b32 v45, -1
    v_mov_b32 v46, -1
    v_mov_b32 v47, -1
    s_mov_b64 exec, s[56:57]
    buffer_store_dwordx4 v[44:47], v5, s[4:7], s25 offen sc1
    s_mov_b64 exec, -1
    v_mov_b32_dpp v48, v12 row_ror:8 row_mask:0xf bank_mask:0xf
    v_mov_b32_dpp v49, v13 row_ror:8 row_mask:0xf bank_mask:0xf
    v_mov_b32_dpp v50, v14 row_ror:8 row_mask:0xf bank_mask:0xf
    v_mov_b32_dpp v51, v15 row_ror:8 row_mask:0xf bank_mask:0xf
    s_and_b32 s28, s16, 3
    s_lshl_b32 s28, s28, 18
    s_add_u32 s28, s28, s39
    s_add_u32 s24, s16, 1
    s_and_b32 s24, s24, 3
    s_lshl_b32 s24, s24, 16
    s_add_u32 s24, s24, s37
    s_add_u32 s23, s16, 1
    s_and_b32 s23, s23, 3
    s_lshl_b32 s23, s23, 16
    s_add_u32 s23, s23, s36
    s_add_u32 s26, s16, 1
    s_and_b32 s26, s26, 3
    s_lshl_b32 s26, s26, 18
    s_add_u32 s26, s26, s38
    s_cmp_eq_u32 s59, 0
    s_cbranch_scc1 ofl_36
    s_lshl_b32 s17, s3, 10
    v_add_u32 v39, s17, v1
    ds_read_b128 v[40:43], v39 offset:32768
ofl_36:
    s_cmp_eq_u32 s16, 63
    s_cbranch_scc1 ploopH_31_tail
    s_cmp_eq_u32 s30, s54
    s_cbranch_scc1 pnoseg_37
    ds_read_b128 v[16:19], v6 offset:0
    ds_read_b128 v[20:23], v6 offset:256
    ds_read_b128 v[24:27], v6 offset:512
    ds_read_b128 v[28:31], v6 offset:768
    v_xor_b32 v6, 0x4000, v6
    s_waitcnt lgkmcnt(2)
    v_mfma_f32_16x16x32_bf16 v[40:43], v[12:15], v[16:19], 0
    v_mfma_f32_16x16x32_bf16 v[40:43], v[48:51], v[20:23], v[40:43]
    s_waitcnt lgkmcnt(0)
    v_mfma_f32_16x16x32_bf16 v[44:47], v[12:15], v[24:27], 0
    v_mfma_f32_16x16x32_bf16 v[44:47], v[48:51], v[28:31], v[44:47]
    s_nop 7
    v_cvt_pk_bf16_f32 v40, v40, v41
    v_cvt_pk_bf16_f32 v41, v42, v43
    v_cvt_pk_bf16_f32 v42, v44, v45
    v_cvt_pk_bf16_f32 v43, v46, v47
    s_nop 1
    v_permlane16_swap_b32 v40, v42
    v_permlane16_swap_b32 v41, v43
    s_nop 1
    v_min_u32 v40, -2, v40
pnoseg_37:
    s_bitcmp1_b32 s29, 0
    s_cbranch_scc1 gate_38_ok
    s_add_u32 s21, s16, 1
    s_min_u32 s21, s21, 63
    s_cmp_ge_u32 s21, 16
    s_cselect_b32 s19, 12, 8
    s_and_b32 s32, s21, 4
    s_lshr_b32 s21, s21, 3
    s_lshl_b32 s21, s21, 8
    s_add_u32 s32, s32, s21
    s_add_u32 s32, s32, s35
gate_38:
    buffer_load_dword v9, off, s[4:7], s32 sc1
    s_waitcnt vmcnt(0)
    v_readfirstlane_b32 s21, v9
    s_cmp_ge_u32 s21, s19
    s_cbranch_scc1 gate_38_set
    s_sleep 8
    s_sub_u32 s22, s22, 1
    s_cbranch_scc0 gate_38
    s_mov_b32 s22, 0
gate_38_set:
    s_bitset1_b32 s29, 0
gate_38_ok:
    v_readfirstlane_b32 s21, v60
    s_lshr_b32 s29, s29, 1
    s_cmp_ge_u32 s21, s58
    s_cselect_b32 s21, 2, 0
    s_or_b32 s29, s29, s21
    s_cmp_eq_u32 s3, 3
    s_cselect_b32 s20, s21, 0
    s_add_u32 s21, s16, 4
    s_min_u32 s21, s21, 63
    s_cmp_ge_u32 s21, 16
    s_cselect_b32 s58, 12, 8
    s_and_b32 s33, s21, 4
    s_lshr_b32 s21, s21, 3
    s_lshl_b32 s21, s21, 8
    s_add_u32 s33, s33, s21
    s_add_u32 s33, s33, s35
    s_setprio 3
ploopH_31_fs:
    ds_read_b128 v[32:35], v58 offset:0
    s_waitcnt lgkmcnt(0)
    v_min3_i32 v32, v32, v33, v34
    v_min_i32 v32, v32, v35
    s_nop 0
    v_readfirstlane_b32 s18, v32
    s_cmp_ge_i32 s18, s16
    s_cbranch_scc1 ploopH_31_fsok
    s_sleep 1
    s_branch ploopH_31_fs
ploopH_31_fsok:
    s_setprio 1
    s_add_u32 m0, s42, 8192
    s_add_u32 s17, s41, 37748736
    buffer_load_dwordx4 v1, s[4:7], s17 offen offset:0 sc1 lds
    buffer_load_dwordx4 v1, s[4:7], s17 offen offset:1024 sc1 lds
    buffer_load_dwordx4 v1, s[4:7], s17 offen offset:2048 sc1 lds
    buffer_load_dwordx4 v1, s[4:7], s17 offen offset:3072 sc1 lds
    s_add_u32 m0, s42, 12288
    s_add_u32 s17, s41, 37879808
    buffer_load_dwordx4 v1, s[4:7], s17 offen offset:0 sc1 lds
    buffer_load_dwordx4 v1, s[4:7], s17 offen offset:1024 sc1 lds
    buffer_load_dwordx4 v1, s[4:7], s17 offen offset:2048 sc1 lds
    buffer_load_dwordx4 v1, s[4:7], s17 offen offset:3072 sc1 lds
    s_cmp_eq_u32 s20, 0
    s_cbranch_scc1 ploopH_31_nt
    s_mov_b32 exec_hi, 0xffff
    buffer_load_dword v60, v0, s[4:7], s31 offen sc1
    s_mov_b32 exec_hi, -1
ploopH_31_nt:
    s_cmp_eq_u32 s59, 0
    s_cbranch_scc1 ofl_39
    s_lshl_b32 s17, s16, 18
    s_add_u32 s17, s17, s60
    buffer_store_dwordx4 v[40:43], v1, s[4:7], s17 offen sc1
    s_mov_b32 s59, 0
ofl_39:
    s_cmp_eq_u32 s30, s54
    s_cbranch_scc1 pnoseg_40
    buffer_store_dwordx4 v[40:43], v7, s[4:7], s30 offen sc1
    s_add_u32 s30, s30, 65536
pnoseg_40:
    s_or_b32 s17, s13, s3
    s_cmp_lg_u32 s17, 0
    s_cbranch_scc1 ploopH_31_npg
    s_sub_u32 s21, s16, 1
    s_cbranch_scc1 ploopH_31_npg
    s_sub_u32 s17, s21, 1
    s_and_b32 s17, s17, 3
    s_cmp_ge_u32 s16, 58
    s_cselect_b32 s17, 0, s17
    s_cmp_lg_u32 s17, 0
    s_cbranch_scc1 ploopH_31_npg
    s_lshl_b32 s17, s12, 7
    s_add_u32 s17, s17, 218112000
    v_mov_b32 v9, s21
    s_mov_b64 exec, 1
    buffer_store_dword v9, off, s[4:7], s17 sc1
    s_mov_b64 exec, -1
ploopH_31_npg:
    s_barrier
    buffer_load_dword v60, off, s[4:7], s33 sc1
    s_add_u32 s16, s16, 1
    v_mov_b32 v59, s16
    s_add_u32 s41, s41, 262144
    s_add_u32 s31, s31, 262144
    s_mov_b32 s54, 0
    s_setprio 3
    s_sleep 13
ploopH_31_pagain:
    buffer_load_dwordx4 v[16:19], v1, s[4:7], s28 offen offset:0 sc1
    buffer_load_dwordx4 v[20:23], v1, s[4:7], s28 offen offset:1024 sc1
    s_waitcnt vmcnt(1)
    v_mfma_f32_16x16x32_bf16 v[32:35], v[12:15], v[16:19], 0
    s_waitcnt vmcnt(0)
    v_mfma_f32_16x16x32_bf16 v[32:35], v[12:15], v[20:23], v[32:35]
    v_max_u32 v9, v16, v20
    v_cmp_eq_u32 vcc, -1, v9
    s_cbranch_vccnz ploopH_31_rp
ploopH_31_pgo:
    s_nop 4
    v_cvt_pk_bf16_f32 v52, v32, v33
    v_cvt_pk_bf16_f32 v53, v34, v35
    s_nop 0
    v_permlane16_swap_b32 v52, v54
    v_permlane16_swap_b32 v53, v55
    s_mov_b64 exec, s[56:57]
    v_min_u32 v52, -2, v52
    buffer_store_dwordx4 v[52:55], v5, s[4:7], s24 offen sc1
    s_mov_b64 exec, -1
    ds_write_b32 v63, v59 offset:16
    s_branch ploopH_31
ploopH_31_rm_0:
    s_sub_u32 s22, s22, 1
    s_cbranch_scc1 ploopH_31_rm_0_g
    buffer_load_dwordx4 v[16:19], v1, s[4:7], s23 offen offset:0 sc1
    buffer_load_dwordx4 v[20:23], v1, s[4:7], s23 offen offset:1024 sc1
    buffer_load_dwordx4 v[24:27], v1, s[4:7], s23 offen offset:2048 sc1
    buffer_load_dwordx4 v[28:31], v1, s[4:7], s23 offen offset:3072 sc1
    s_waitcnt vmcnt(3)
    v_cmp_eq_u32 vcc, -1, v16
    s_cbranch_vccnz ploopH_31_rm_0
    s_branch ploopH_31_rm_0ok
ploopH_31_rm_0_g:
    s_mov_b32 s22, 0
    s_waitcnt vmcnt(0)
    s_branch ploopH_31_rm_0ok
ploopH_31_rm_1:
    s_sub_u32 s22, s22, 1
    s_cbranch_scc1 ploopH_31_rm_1_g
    buffer_load_dwordx4 v[20:23], v1, s[4:7], s23 offen offset:1024 sc1
    buffer_load_dwordx4 v[24:27], v1, s[4:7], s23 offen offset:2048 sc1
    buffer_load_dwordx4 v[28:31], v1, s[4:7], s23 offen offset:3072 sc1
    s_waitcnt vmcnt(2)
    v_cmp_eq_u32 vcc, -1, v20
    s_cbranch_vccnz ploopH_31_rm_1
    s_branch ploopH_31_rm_1ok
ploopH_31_rm_1_g:
    s_mov_b32 s22, 0
    s_waitcnt vmcnt(0)
    s_branch ploopH_31_rm_1ok
ploopH_31_rm_2:
    s_sub_u32 s22, s22, 1
    s_cbranch_scc1 ploopH_31_rm_2_g
    buffer_load_dwordx4 v[24:27], v1, s[4:7], s23 offen offset:2048 sc1
    buffer_load_dwordx4 v[28:31], v1, s[4:7], s23 offen offset:3072 sc1
    s_waitcnt vmcnt(1)
    v_cmp_eq_u32 vcc, -1, v24
    s_cbranch_vccnz ploopH_31_rm_2
    s_branch ploopH_31_rm_2ok
ploopH_31_rm_2_g:
    s_mov_b32 s22, 0
    s_waitcnt vmcnt(0)
    s_branch ploopH_31_rm_2ok
ploopH_31_rm_3:
    s_sub_u32 s22, s22, 1
    s_cbranch_scc1 ploopH_31_rm_3_g
    buffer_load_dwordx4 v[28:31], v1, s[4:7], s23 offen offset:3072 sc1
    s_waitcnt vmcnt(0)
    v_cmp_eq_u32 vcc, -1, v28
    s_cbranch_vccnz ploopH_31_rm_3
    s_branch ploopH_31_rm_3ok
ploopH_31_rm_3_g:
    s_mov_b32 s22, 0
    s_waitcnt vmcnt(0)
    s_branch ploopH_31_rm_3ok
ploopH_31_rp:
    s_sub_u32 s22, s22, 1
    s_cbranch_scc0 ploopH_31_pagain
    s_mov_b32 s22, 0
    s_branch ploopH_31_pgo
ploopH_31_tail:
    ds_read_b128 v[16:19], v6 offset:0
    ds_read_b128 v[20:23], v6 offset:256
    ds_read_b128 v[24:27], v6 offset:512
    ds_read_b128 v[28:31], v6 offset:768
    v_xor_b32 v6, 0x4000, v6
    s_waitcnt lgkmcnt(2)
    v_mfma_f32_16x16x32_bf16 v[40:43], v[12:15], v[16:19], 0
    v_mfma_f32_16x16x32_bf16 v[40:43], v[48:51], v[20:23], v[40:43]
    s_waitcnt lgkmcnt(0)
    v_mfma_f32_16x16x32_bf16 v[44:47], v[12:15], v[24:27], 0
    v_mfma_f32_16x16x32_bf16 v[44:47], v[48:51], v[28:31], v[44:47]
    s_nop 7
    v_cvt_pk_bf16_f32 v40, v40, v41
    v_cvt_pk_bf16_f32 v41, v42, v43
    v_cvt_pk_bf16_f32 v42, v44, v45
    v_cvt_pk_bf16_f32 v43, v46, v47
    s_nop 1
    v_permlane16_swap_b32 v40, v42
    v_permlane16_swap_b32 v41, v43
    s_nop 1
    v_min_u32 v40, -2, v40
    buffer_store_dwordx4 v[40:43], v7, s[4:7], s30 offen sc1
    s_add_u32 s30, s30, 65536
    s_barrier
    ds_read_b128 v[16:19], v6 offset:0
    ds_read_b128 v[20:23], v6 offset:256
    ds_read_b128 v[24:27], v6 offset:512
    ds_read_b128 v[28:31], v6 offset:768
    v_xor_b32 v6, 0x4000, v6
    s_waitcnt lgkmcnt(2)
    v_mfma_f32_16x16x32_bf16 v[40:43], v[12:15], v[16:19], 0
    v_mfma_f32_16x16x32_bf16 v[40:43], v[48:51], v[20:23], v[40:43]
    s_waitcnt lgkmcnt(0)
    v_mfma_f32_16x16x32_bf16 v[44:47], v[12:15], v[24:27], 0
    v_mfma_f32_16x16x32_bf16 v[44:47], v[48:51], v[28:31], v[44:47]
    s_nop 7
    v_cvt_pk_bf16_f32 v40, v40, v41
    v_cvt_pk_bf16_f32 v41, v42, v43
    v_cvt_pk_bf16_f32 v42, v44, v45
    v_cvt_pk_bf16_f32 v43, v46, v47
    s_nop 1
    v_permlane16_swap_b32 v40, v42
    v_permlane16_swap_b32 v41, v43
    s_nop 1
    v_min_u32 v40, -2, v40
    buffer_store_dwordx4 v[40:43], v7, s[4:7], s30 offen sc1
    s_add_u32 s30, s30, 65536
    s_branch k_end
ch_a_pro:
    s_sub_u32 s21, s3, 4
    s_lshl_b32 s15, s14, 2
    s_add_u32 s15, s15, s21
    s_lshl_b32 s38, s15, 13
    s_add_u32 s38, s38, 214958080
    s_cmp_lg_u32 s3, 7
    s_cbranch_scc1 ch_nrp
    s_mov_b32 s95, 0x10000
rp_41:
    buffer_load_dword v28, off, s[64:67], 0 offset:224 sc1
    s_waitcnt vmcnt(0)
    v_readfirstlane_b32 s96, v28
    s_cmp_lg_u32 s96, 0
    s_cbranch_scc1 rp_41_ok
    s_sleep 2
    s_sub_u32 s95, s95, 1
    s_cbranch_scc0 rp_41
    s_add_u32 s96, s97, 1
rp_41_ok:
    s_sub_u32 s96, s96, 1
    v_mov_b32 v27, 131136
    v_mov_b32 v28, s96
    ds_write_b32 v27, v28
    s_waitcnt lgkmcnt(0)
ch_nrp:
    s_barrier
    v_mov_b32 v27, 131136
    ds_read_b32 v27, v27
    s_mov_b32 s96, s97
    s_waitcnt lgkmcnt(0)
    v_readfirstlane_b32 s97, v27
    s_cmp_lg_u32 s96, s97
    s_cbranch_scc1 k_restart
    s_min_u32 s20, s21, 2
    s_lshl_b32 s18, s20, 3
    s_add_u32 s18, s18, 16
    s_load_dwordx2 s[8:9], s[0:1], s18
    s_mov_b32 s10, 8388608
    s_mov_b32 s11, 131072
    v_and_b32 v20, 63, v0
    v_lshlrev_b32 v21, 13, v20
    s_lshl_b32 s17, s34, 19
    s_lshl_b32 s18, s14, 10
    s_add_u32 s17, s17, s18
    s_waitcnt lgkmcnt(0)
    buffer_load_dword v26, v21, s[8:11], s17 offen offset:384
    v_and_b32 v20, 63, v0
    v_lshrrev_b32 v21, 4, v20
    v_bfe_u32 v22, v20, 1, 1
    v_xor_b32 v22, 1, v22
    v_lshl_add_u32 v23, v22, 2, v21
    v_bfe_u32 v22, v20, 2, 2
    v_and_b32 v24, 1, v20
    v_lshl_add_u32 v22, v22, 1, v24
    v_lshl_add_u32 v23, v23, 3, v22
    v_and_b32 v22, 7, v20
    v_lshlrev_b32 v23, 4, v23
    s_lshl_b32 s17, s21, 10
    s_add_u32 s17, s17, 16384
    v_add_u32 v160, s17, v23
    v_and_b32 v24, 15, v20
    v_lshlrev_b32 v24, 4, v24
    v_lshl_add_u32 v23, v21, 10, v24
    s_lshl_b32 s17, s21, 8
    s_add_u32 s17, s17, 16384
    v_add_u32 v161, s17, v23
    v_lshl_add_u32 v23, v21, 9, v24
    s_lshl_b32 s17, s21, 12
    s_add_u32 s17, s17, 32768
    v_add_u32 v162, s17, v23
    v_bfe_u32 v23, v20, 3, 1
    v_lshlrev_b32 v23, 10, v23
    v_lshl_add_u32 v23, v22, 4, v23
    v_lshlrev_b32 v1, 4, v20
    s_lshl_b32 s39, s34, 14
    s_lshl_b32 s17, s21, 11
    s_add_u32 s39, s39, s17
    s_lshl_b32 s17, s14, 8
    s_add_u32 s39, s39, s17
    s_add_u32 s39, s39, 209715200
    v_mov_b32 v176, -1
    v_mov_b32 v177, -1
    v_mov_b32 v178, -1
    v_mov_b32 v179, -1
    v_lshlrev_b32 v24, 4, v0
    s_lshl_b32 s17, s52, 13
    s_add_u32 s19, s17, 209711104
    s_add_u32 s17, s17, 214953984
    s_lshl_b32 s18, s52, 12
    s_add_u32 s18, s18, 213905408
    buffer_store_dwordx4 v[176:179], v24, s[4:7], s19 offen sc1
    s_add_u32 s19, s19, 4096
    buffer_store_dwordx4 v[176:179], v24, s[4:7], s19 offen sc1
    buffer_store_dwordx4 v[176:179], v24, s[4:7], s17 offen sc1
    s_add_u32 s17, s17, 4096
    buffer_store_dwordx4 v[176:179], v24, s[4:7], s17 offen sc1
    buffer_store_dwordx4 v[176:179], v24, s[4:7], s18 offen sc1
    s_add_u32 s18, s18, 2097152
    buffer_store_dwordx4 v[176:179], v24, s[4:7], s18 offen sc1
    s_and_b32 s17, s13, 7
    s_sub_u32 s18, s21, 1
    s_cmp_lt_u32 s18, 2
    s_cselect_b32 s54, s17, 1
    s_lshr_b32 s19, s52, 3
    s_lshl_b32 s19, s19, 8
    s_lshl_b32 s18, s18, 7
    s_add_u32 s19, s19, s18
    s_add_u32 s55, s19, 210763776
    s_cmp_lg_u32 s54, 0
    s_cbranch_scc1 ch_nv0
    v_lshlrev_b32 v24, 13, v20
    s_mov_b64 exec, 0xffff
    buffer_store_dword v176, v24, s[4:7], s55 offen sc1
    s_mov_b64 exec, -1
ch_nv0:
    v_mov_b32 v2, s40
    s_lshl_b32 s17, s12, 2
    s_add_u32 s17, s17, 128
    s_waitcnt vmcnt(0)
    s_barrier
    s_cmp_lg_u32 s3, 4
    s_cbranch_scc1 ch_nox
    s_mov_b64 exec, 1
    buffer_atomic_add v2, off, s[64:67], s17 sc1
    s_mov_b64 exec, -1
ch_nox:
    v_and_b32 v20, 63, v0
    v_lshlrev_b32 v0, 4, v20
    s_lshl_b32 s17, s15, 18
    s_lshl_b32 s18, s34, 7
    s_add_u32 s17, s17, s18
    s_lshl_b32 s19, s21, 13
    s_add_u32 s19, s19, 131072
    s_load_dwordx2 s[8:9], s[0:1], 40
    s_mov_b32 s10, 8388608
    s_mov_b32 s11, 131072
    v_lshrrev_b32 v21, 3, v20
    v_and_b32 v22, 7, v20
    v_lshlrev_b32 v21, 11, v21
    v_lshl_add_u32 v21, v22, 4, v21
    v_lshrrev_b32 v28, 4, v20
    v_and_b32 v29, 1, v28
    v_xor_b32 v29, 0, v29
    v_lshlrev_b32 v29, 2, v29
    v_lshl_add_u32 v29, v28, 3, v29
    v_bfe_u32 v28, v20, 2, 2
    v_add_u32 v29, v29, v28
    v_lshlrev_b32 v29, 7, v29
    v_and_b32 v28, 3, v20
    v_lshl_add_u32 v29, v28, 4, v29
    v_and_b32 v28, 1, v28
    v_xor_b32 v28, 0, v28
    v_lshl_add_u32 v24, v28, 3, v29
    v_add_u32 v24, s19, v24
    v_lshrrev_b32 v28, 4, v20
    v_and_b32 v29, 1, v28
    v_xor_b32 v29, 1, v29
    v_lshlrev_b32 v29, 2, v29
    v_lshl_add_u32 v29, v28, 3, v29
    v_bfe_u32 v28, v20, 2, 2
    v_add_u32 v29, v29, v28
    v_lshlrev_b32 v29, 7, v29
    v_and_b32 v28, 3, v20
    v_lshl_add_u32 v29, v28, 4, v29
    v_and_b32 v28, 1, v28
    v_xor_b32 v28, 0, v28
    v_lshl_add_u32 v25, v28, 3, v29
    v_add_u32 v25, s19, v25
    v_lshrrev_b32 v28, 4, v20
    v_and_b32 v29, 1, v28
    v_xor_b32 v29, 0, v29
    v_lshlrev_b32 v29, 2, v29
    v_lshl_add_u32 v29, v28, 3, v29
    v_bfe_u32 v28, v20, 2, 2
    v_add_u32 v29, v29, v28
    v_lshlrev_b32 v29, 7, v29
    v_and_b32 v28, 3, v20
    v_lshl_add_u32 v29, v28, 4, v29
    v_and_b32 v28, 1, v28
    v_xor_b32 v28, 1, v28
    v_lshl_add_u32 v26, v28, 3, v29
    v_add_u32 v26, s19, v26
    v_lshrrev_b32 v28, 4, v20
    v_and_b32 v29, 1, v28
    v_xor_b32 v29, 1, v29
    v_lshlrev_b32 v29, 2, v29
    v_lshl_add_u32 v29, v28, 3, v29
    v_bfe_u32 v28, v20, 2, 2
    v_add_u32 v29, v29, v28
    v_lshlrev_b32 v29, 7, v29
    v_and_b32 v28, 3, v20
    v_lshl_add_u32 v29, v28, 4, v29
    v_and_b32 v28, 1, v28
    v_xor_b32 v28, 1, v28
    v_lshl_add_u32 v27, v28, 3, v29
    v_add_u32 v27, s19, v27
    s_waitcnt lgkmcnt(0)
    s_add_u32 m0, s19, 0
    s_nop 0
    buffer_load_dwordx4 v21, s[8:11], s17 offen lds
    s_add_u32 s17, s17, 16384
    s_add_u32 m0, s19, 1024
    s_nop 0
    buffer_load_dwordx4 v21, s[8:11], s17 offen lds
    s_add_u32 s17, s17, 16384
    s_add_u32 m0, s19, 2048
    s_nop 0
    buffer_load_dwordx4 v21, s[8:11], s17 offen lds
    s_add_u32 s17, s17, 16384
    s_add_u32 m0, s19, 3072
    s_nop 0
    buffer_load_dwordx4 v21, s[8:11], s17 offen lds
    s_add_u32 s17, s17, 16384
    s_add_u32 m0, s19, 4096
    s_nop 0
    buffer_load_dwordx4 v21, s[8:11], s17 offen lds
    s_add_u32 s17, s17, 16384
    s_add_u32 m0, s19, 5120
    s_nop 0
    buffer_load_dwordx4 v21, s[8:11], s17 offen lds
    s_add_u32 s17, s17, 16384
    s_add_u32 m0, s19, 6144
    s_nop 0
    buffer_load_dwordx4 v21, s[8:11], s17 offen lds
    s_add_u32 s17, s17, 16384
    s_add_u32 m0, s19, 7168
    s_nop 0
    buffer_load_dwordx4 v21, s[8:11], s17 offen lds
    s_add_u32 s17, s17, 16384
    buffer_load_dwordx4 v[96:99], v21, s[8:11], s17 offen
    s_add_u32 s17, s17, 16384
    buffer_load_dwordx4 v[100:103], v21, s[8:11], s17 offen
    s_add_u32 s17, s17, 16384
    buffer_load_dwordx4 v[104:107], v21, s[8:11], s17 offen
    s_add_u32 s17, s17, 16384
    buffer_load_dwordx4 v[108:111], v21, s[8:11], s17 offen
    s_add_u32 s17, s17, 16384
    buffer_load_dwordx4 v[112:115], v21, s[8:11], s17 offen
    s_add_u32 s17, s17, 16384
    buffer_load_dwordx4 v[116:119], v21, s[8:11], s17 offen
    s_add_u32 s17, s17, 16384
    buffer_load_dwordx4 v[120:123], v21, s[8:11], s17 offen
    s_add_u32 s17, s17, 16384
    buffer_load_dwordx4 v[124:127], v21, s[8:11], s17 offen
    s_add_u32 s17, s17, 16384
    s_cmp_lg_u32 s54, 0
    s_cbranch_scc1 ch_nv1
    s_mov_b32 s58, -1
    s_mov_b32 s59, -1
    s_memtime s[60:61]
    s_add_u32 s56, s55, 0
    s_waitcnt lgkmcnt(0)
    s_load_dword s57, s[4:5], s56 glc
    s_waitcnt lgkmcnt(0)
    s_memtime s[62:63]
    s_waitcnt lgkmcnt(0)
    s_sub_u32 s57, s62, s60
    s_min_u32 s58, s58, s57
    s_memtime s[60:61]
    s_add_u32 s56, s55, 8192
    s_waitcnt lgkmcnt(0)
    s_load_dword s57, s[4:5], s56 glc
    s_waitcnt lgkmcnt(0)
    s_memtime s[62:63]
    s_waitcnt lgkmcnt(0)
    s_sub_u32 s57, s62, s60
    s_min_u32 s59, s59, s57
    s_memtime s[60:61]
    s_add_u32 s56, s55, 16384
    s_waitcnt lgkmcnt(0)
    s_load_dword s57, s[4:5], s56 glc
    s_waitcnt lgkmcnt(0)
    s_memtime s[62:63]
    s_waitcnt lgkmcnt(0)
    s_sub_u32 s57, s62, s60
    s_min_u32 s58, s58, s57
    s_memtime s[60:61]
    s_add_u32 s56, s55, 24576
    s_waitcnt lgkmcnt(0)
    s_load_dword s57, s[4:5], s56 glc
    s_waitcnt lgkmcnt(0)
    s_memtime s[62:63]
    s_waitcnt lgkmcnt(0)
    s_sub_u32 s57, s62, s60
    s_min_u32 s59, s59, s57
    s_memtime s[60:61]
    s_add_u32 s56, s55, 32768
    s_waitcnt lgkmcnt(0)
    s_load_dword s57, s[4:5], s56 glc
    s_waitcnt lgkmcnt(0)
    s_memtime s[62:63]
    s_waitcnt lgkmcnt(0)
    s_sub_u32 s57, s62, s60
    s_min_u32 s58, s58, s57
    s_memtime s[60:61]
    s_add_u32 s56, s55, 40960
    s_waitcnt lgkmcnt(0)
    s_load_dword s57, s[4:5], s56 glc
    s_waitcnt lgkmcnt(0)
    s_memtime s[62:63]
    s_waitcnt lgkmcnt(0)
    s_sub_u32 s57, s62, s60
    s_min_u32 s59, s59, s57
    s_memtime s[60:61]
    s_add_u32 s56, s55, 49152
    s_waitcnt lgkmcnt(0)
    s_load_dword s57, s[4:5], s56 glc
    s_waitcnt lgkmcnt(0)
    s_memtime s[62:63]
    s_waitcnt lgkmcnt(0)
    s_sub_u32 s57, s62, s60
    s_min_u32 s58, s58, s57
    s_memtime s[60:61]
    s_add_u32 s56, s55, 57344
    s_waitcnt lgkmcnt(0)
    s_load_dword s57, s[4:5], s56 glc
    s_waitcnt lgkmcnt(0)
    s_memtime s[62:63]
    s_waitcnt lgkmcnt(0)
    s_sub_u32 s57, s62, s60
    s_min_u32 s59, s59, s57
    s_memtime s[60:61]
    s_add_u32 s56, s55, 65536
    s_waitcnt lgkmcnt(0)
    s_load_dword s57, s[4:5], s56 glc
    s_waitcnt lgkmcnt(0)
    s_memtime s[62:63]
    s_waitcnt lgkmcnt(0)
    s_sub_u32 s57, s62, s60
    s_min_u32 s58, s58, s57
    s_memtime s[60:61]
    s_add_u32 s56, s55, 73728
    s_waitcnt lgkmcnt(0)
    s_load_dword s57, s[4:5], s56 glc
    s_waitcnt lgkmcnt(0)
    s_memtime s[62:63]
    s_waitcnt lgkmcnt(0)
    s_sub_u32 s57, s62, s60
    s_min_u32 s59, s59, s57
    s_memtime s[60:61]
    s_add_u32 s56, s55, 81920
    s_waitcnt lgkmcnt(0)
    s_load_dword s57, s[4:5], s56 glc
    s_waitcnt lgkmcnt(0)
    s_memtime s[62:63]
    s_waitcnt lgkmcnt(0)
    s_sub_u32 s57, s62, s60
    s_min_u32 s58, s58, s57
    s_memtime s[60:61]
    s_add_u32 s56, s55, 90112
    s_waitcnt lgkmcnt(0)
    s_load_dword s57, s[4:5], s56 glc
    s_waitcnt lgkmcnt(0)
    s_memtime s[62:63]
    s_waitcnt lgkmcnt(0)
    s_sub_u32 s57, s62, s60
    s_min_u32 s59, s59, s57
    s_memtime s[60:61]
    s_add_u32 s56, s55, 98304
    s_waitcnt lgkmcnt(0)
    s_load_dword s57, s[4:5], s56 glc
    s_waitcnt lgkmcnt(0)
    s_memtime s[62:63]
    s_waitcnt lgkmcnt(0)
    s_sub_u32 s57, s62, s60
    s_min_u32 s58, s58, s57
    s_memtime s[60:61]
    s_add_u32 s56, s55, 106496
    s_waitcnt lgkmcnt(0)
    s_load_dword s57, s[4:5], s56 glc
    s_waitcnt lgkmcnt(0)
    s_memtime s[62:63]
    s_waitcnt lgkmcnt(0)
    s_sub_u32 s57, s62, s60
    s_min_u32 s59, s59, s57
    s_memtime s[60:61]
    s_add_u32 s56, s55, 114688
    s_waitcnt lgkmcnt(0)
    s_load_dword s57, s[4:5], s56 glc
    s_waitcnt lgkmcnt(0)
    s_memtime s[62:63]
    s_waitcnt lgkmcnt(0)
    s_sub_u32 s57, s62, s60
    s_min_u32 s58, s58, s57
    s_memtime s[60:61]
    s_add_u32 s56, s55, 122880
    s_waitcnt lgkmcnt(0)
    s_load_dword s57, s[4:5], s56 glc
    s_waitcnt lgkmcnt(0)
    s_memtime s[62:63]
    s_waitcnt lgkmcnt(0)
    s_sub_u32 s57, s62, s60
    s_min_u32 s59, s59, s57
    s_sub_i32 s57, s58, s59
    s_min_i32 s57, s57, 400
    s_max_i32 s57, s57, -400
    s_add_u32 s57, s57, 16777616
    s_getreg_b32 s56, hwreg(HW_REG_XCC_ID)
    s_and_b32 s56, s56, 0
    v_mov_b32 v2, s57
    s_mov_b64 exec, 1
    buffer_atomic_add v2, off, s[64:67], s56 offset:160 sc1
    s_mov_b64 exec, -1
    s_waitcnt vmcnt(0)
ch_nv1:
    s_lshl_b32 s19, s21, 13
    s_add_u32 s19, s19, 131072
    v_add_u32 v30, s19, v0
    s_waitcnt vmcnt(8)
    ds_read_b64_tr_b16 v[192:193], v24 offset:0
    ds_read_b64_tr_b16 v[194:195], v25 offset:0
    ds_read_b64_tr_b16 v[208:209], v26 offset:0
    ds_read_b64_tr_b16 v[210:211], v27 offset:0
    ds_read_b64_tr_b16 v[224:225], v24 offset:64
    ds_read_b64_tr_b16 v[226:227], v25 offset:64
    ds_read_b64_tr_b16 v[240:241], v26 offset:64
    ds_read_b64_tr_b16 v[242:243], v27 offset:64
    s_waitcnt lgkmcnt(0)
    ds_read_b64_tr_b16 v[196:197], v24 offset:4096
    ds_read_b64_tr_b16 v[198:199], v25 offset:4096
    ds_read_b64_tr_b16 v[212:213], v26 offset:4096
    ds_read_b64_tr_b16 v[214:215], v27 offset:4096
    ds_read_b64_tr_b16 v[228:229], v24 offset:4160
    ds_read_b64_tr_b16 v[230:231], v25 offset:4160
    ds_read_b64_tr_b16 v[244:245], v26 offset:4160
    ds_read_b64_tr_b16 v[246:247], v27 offset:4160
    s_waitcnt lgkmcnt(0)
    s_waitcnt vmcnt(0)
    ds_write_b128 v30, v[96:99] offset:0
    ds_write_b128 v30, v[100:103] offset:1024
    ds_write_b128 v30, v[104:107] offset:2048
    ds_write_b128 v30, v[108:111] offset:3072
    ds_write_b128 v30, v[112:115] offset:4096
    ds_write_b128 v30, v[116:119] offset:5120
    ds_write_b128 v30, v[120:123] offset:6144
    ds_write_b128 v30, v[124:127] offset:7168
    s_waitcnt lgkmcnt(0)
    ds_read_b64_tr_b16 v[200:201], v24 offset:0
    ds_read_b64_tr_b16 v[202:203], v25 offset:0
    ds_read_b64_tr_b16 v[216:217], v26 offset:0
    ds_read_b64_tr_b16 v[218:219], v27 offset:0
    ds_read_b64_tr_b16 v[232:233], v24 offset:64
    ds_read_b64_tr_b16 v[234:235], v25 offset:64
    ds_read_b64_tr_b16 v[248:249], v26 offset:64
    ds_read_b64_tr_b16 v[250:251], v27 offset:64
    s_waitcnt lgkmcnt(0)
    ds_read_b64_tr_b16 v[204:205], v24 offset:4096
    ds_read_b64_tr_b16 v[206:207], v25 offset:4096
    ds_read_b64_tr_b16 v[220:221], v26 offset:4096
    ds_read_b64_tr_b16 v[222:223], v27 offset:4096
    ds_read_b64_tr_b16 v[236:237], v24 offset:4160
    ds_read_b64_tr_b16 v[238:239], v25 offset:4160
    ds_read_b64_tr_b16 v[252:253], v26 offset:4160
    ds_read_b64_tr_b16 v[254:255], v27 offset:4160
    s_waitcnt lgkmcnt(0)
    v_lshrrev_b32 v21, 4, v20
    v_and_b32 v22, 2, v20
    v_cmp_eq_u32 s[56:57], 2, v22
    v_and_b32 v23, 15, v20
    v_lshlrev_b32 v21, 2, v21
    v_mov_b32 v8, 0x44444444
    v_mov_b32 v9, 0xeeeeeeee
    v_cndmask_b32 v166, v8, v9, s[56:57]
    v_mov_b32 v8, 0x3f803f80
    v_mov_b32 v9, 0
    v_mov_b32 v10, 0
    v_mov_b32 v11, 0
    v_mov_b32 v4, 0x3f803f80
    v_mov_b32 v5, 0x3f803f80
    v_mov_b32 v6, 0x3f803f80
    v_mov_b32 v7, 0x3f803f80
    s_mov_b32 s29, 0x3e0293ee
    s_lshl_b32 s27, s13, 2
    s_add_u32 s27, s27, s21
    s_lshl_b32 s28, s12, 7
    s_add_u32 s28, s28, 218112000
    v_add_u32 v163, s42, v0
    s_lshl_b32 s17, s21, 2
    s_add_u32 s17, s17, 15872
    v_mov_b32 v164, s17
    v_mov_b32 v167, 15872
    v_and_b32 v24, 15, v20
    v_and_b32 v25, 1, v24
    v_lshlrev_b32 v25, 4, v25
    v_mov_b32 v184, 0x3f80
    v_lshlrev_b32 v25, v25, v184
    v_lshrrev_b32 v24, 1, v24
    v_cmp_eq_u32 vcc, 0, v24
    s_nop 1
    v_cndmask_b32 v184, 0, v25, vcc
    v_cmp_eq_u32 vcc, 1, v24
    s_nop 1
    v_cndmask_b32 v185, 0, v25, vcc
    v_cmp_eq_u32 vcc, 2, v24
    s_nop 1
    v_cndmask_b32 v186, 0, v25, vcc
    v_cmp_eq_u32 vcc, 3, v24
    s_nop 1
    v_cndmask_b32 v187, 0, v25, vcc
    v_lshrrev_b32 v24, 4, v20
    v_bfe_u32 v25, v20, 2, 2
    v_and_b32 v26, 1, v20
    v_lshl_add_u32 v26, v25, 1, v26
    v_lshlrev_b32 v26, 4, v26
    v_lshl_add_u32 v26, v24, 8, v26
    v_bfe_u32 v27, v20, 1, 1
    v_lshl_add_u32 v26, v27, 2, v26
    s_add_u32 s17, s42, 20480
    v_add_u32 v180, s17, v26
    v_and_b32 v26, 3, v20
    v_lshl_add_u32 v27, v24, 2, v25
    v_lshl_add_u32 v27, v26, 4, v27
    v_lshlrev_b32 v27, 4, v27
    v_add_u32 v181, s42, v27
    v_and_b32 v25, 1, v25
    v_lshl_add_u32 v25, v24, 1, v25
    v_lshl_add_u32 v25, v26, 3, v25
    v_lshlrev_b32 v25, 4, v25
    v_add_u32 v182, s17, v25
    s_bfe_u32 s17, s34, 0x20001
    s_lshr_b32 s30, s34, 3
    s_cmp_eq_u32 s17, s21
    s_cselect_b32 s30, s30, 2
    s_and_b32 s33, s34, 1
    s_lshl_b32 s33, s33, 17
    s_mov_b32 s32, 0
    v_add_u32 v24, 0, v21
    v_cmp_gt_u32 s[44:45], v24, v23
    v_add_u32 v24, 1, v21
    v_cmp_gt_u32 s[46:47], v24, v23
    v_add_u32 v24, 2, v21
    v_cmp_gt_u32 s[48:49], v24, v23
    v_add_u32 v24, 3, v21
    v_cmp_gt_u32 s[50:51], v24, v23
    s_cmp_lg_u32 s3, 4
    s_cbranch_scc1 ch_xcc_skip
    v_lshrrev_b32 v56, 2, v0
    v_add_u32 v56, 128, v56
    v_writelane_b32 v56, 0, 10
    v_mov_b32 v59, 63
    v_mov_b32 v60, 32
    v_writelane_b32 v59, 0, 8
    v_writelane_b32 v60, 0, 8
    v_writelane_b32 v59, 0, 9
    v_writelane_b32 v60, 0, 9
    v_writelane_b32 v59, -1, 10
    s_movk_i32 s17, 128
    v_writelane_b32 v60, s17, 10
    s_mov_b64 exec, 0x70f
ch_xcc:
    buffer_load_dword v57, v56, s[64:67], 0 offen sc1
    s_waitcnt vmcnt(0)
    v_and_b32 v62, v59, v57
    v_cmp_ne_u32 vcc, v62, v60
    v_readlane_b32 s18, v57, 8
    v_readlane_b32 s19, v57, 9
    s_add_u32 s17, s18, s19
    s_lshr_b32 s17, s17, 24
    s_cmp_lg_u32 s17, 32
    s_cbranch_scc1 ch_xcc_w
    s_cbranch_vccz ch_xcc_ok
ch_xcc_w:
    s_sleep 16
    s_sub_u32 s22, s22, 1
    s_cbranch_scc0 ch_xcc
    s_mov_b32 s22, 0
ch_xcc_ok:
    s_getreg_b32 s17, hwreg(HW_REG_XCC_ID)
    s_bitcmp1_b32 s17, 2
    s_cselect_b32 s18, s18, s18
    v_readlane_b32 s17, v57, s12
    s_mov_b64 exec, -1
    s_lshr_b32 s19, s18, 24
    s_mul_i32 s19, s19, 400
    s_and_b32 s18, s18, 0xffffff
    s_cmp_gt_u32 s18, s19
    s_cselect_b32 s18, 8192, 0
    v_mov_b32 v58, 15968
    v_mov_b32 v60, s17
    v_mov_b32 v61, s18
    s_barrier
    ds_write_b64 v58, v[60:61]
    s_waitcnt lgkmcnt(0)
    s_branch ch_xcc_b3
ch_xcc_skip:
    s_barrier
ch_xcc_b3:
    s_barrier
    v_mov_b32 v58, 15968
    ds_read_b64 v[60:61], v58
    v_and_b32 v23, 7, v20
    v_lshlrev_b32 v23, 7, v23
    v_bfe_u32 v24, v20, 3, 1
    v_lshl_add_u32 v23, v24, 17, v23
    v_lshrrev_b32 v24, 4, v20
    v_lshl_add_u32 v23, v24, 24, v23
    s_lshl_b32 s19, s14, 14
    s_lshl_b32 s18, s34, 10
    s_add_u32 s19, s19, s18
    s_and_b32 s18, s21, 1
    s_lshl_b32 s18, s18, 18
    s_add_u32 s19, s19, s18
    s_add_u32 s19, s19, 4456448
    s_waitcnt lgkmcnt(0)
    v_readfirstlane_b32 s17, v61
    v_readfirstlane_b32 s18, v60
    s_add_u32 s39, s39, s17
    s_lshl_b32 s40, s40, 5
    s_cmp_lg_u32 s18, s40
    s_cselect_b32 s59, 1, 0
    s_lshl_b32 s58, s15, 12
    s_add_u32 s58, s58, 216006656
ch_g0:
    buffer_load_dword v57, off, s[4:7], s35 sc1
    s_waitcnt vmcnt(0)
    v_readfirstlane_b32 s17, v57
    s_cmp_ge_u32 s17, 8
    s_cbranch_scc1 ch_g0b
    s_sleep 3
    s_sub_u32 s22, s22, 1
    s_cbranch_scc0 ch_g0
    s_mov_b32 s22, 0
ch_g0b:
    s_add_u32 s23, s41, 37748736
    buffer_load_dwordx4 v[128:131], v0, s[4:7], s23 offen offset:0 sc1
    buffer_load_dwordx4 v[132:135], v0, s[4:7], s23 offen offset:1024 sc1
    buffer_load_dwordx4 v[136:139], v0, s[4:7], s23 offen offset:2048 sc1
    buffer_load_dwordx4 v[140:143], v0, s[4:7], s23 offen offset:3072 sc1
    s_add_u32 s24, s41, 37879808
    buffer_load_dwordx4 v[144:147], v0, s[4:7], s24 offen offset:0 sc1
    buffer_load_dwordx4 v[148:151], v0, s[4:7], s24 offen offset:1024 sc1
    buffer_load_dwordx4 v[152:155], v0, s[4:7], s24 offen offset:2048 sc1
    buffer_load_dwordx4 v[156:159], v0, s[4:7], s24 offen offset:3072 sc1
    s_add_u32 s23, s41, 20971520
    buffer_load_dwordx4 v[96:99], v0, s[4:7], s23 offen offset:0 sc1
    buffer_load_dwordx4 v[100:103], v0, s[4:7], s23 offen offset:1024 sc1
    buffer_load_dwordx4 v[104:107], v0, s[4:7], s23 offen offset:2048 sc1
    buffer_load_dwordx4 v[108:111], v0, s[4:7], s23 offen offset:3072 sc1
    s_add_u32 s24, s41, 21102592
    buffer_load_dwordx4 v[112:115], v0, s[4:7], s24 offen offset:0 sc1
    buffer_load_dwordx4 v[116:119], v0, s[4:7], s24 offen offset:1024 sc1
    buffer_load_dwordx4 v[120:123], v0, s[4:7], s24 offen offset:2048 sc1
    buffer_load_dwordx4 v[124:127], v0, s[4:7], s24 offen offset:3072 sc1
    s_mov_b32 exec_hi, 0xffff
    buffer_load_dword v175, v23, s[4:7], s19 offen sc1
    s_mov_b32 exec_hi, -1
    v_mov_b32 v165, 0
    s_waitcnt vmcnt(1)
    ds_write_b32 v164, v165 offset:16
.p2align 6
aloopL_43:
    s_and_b32 s23, s16, 3
    s_lshl_b32 s23, s23, 18
    s_add_u32 s23, s23, s38
    s_add_u32 s24, s23, 4096
    s_and_b32 s25, s16, 3
    s_lshl_b32 s25, s25, 18
    s_add_u32 s25, s25, s39
    s_add_u32 s26, s16, 2
    s_and_b32 s26, s26, 3
    s_lshl_b32 s26, s26, 18
    s_add_u32 s26, s26, s39
    v_mov_b32 v165, s16
    s_waitcnt vmcnt(8)
    s_and_b32 s31, s16, 1
    s_cmp_lt_u32 s16, 16
    s_cselect_b32 s31, 3, s31
    s_cmp_lg_u32 s31, s30
    s_cbranch_scc1 aloopL_43_nd0
    ds_write_b128 v163, v[128:131] offset:0
    ds_write_b128 v163, v[132:135] offset:1024
    ds_write_b128 v163, v[136:139] offset:2048
    ds_write_b128 v163, v[140:143] offset:3072
    ds_write_b128 v163, v[144:147] offset:4096
    ds_write_b128 v163, v[148:151] offset:5120
    ds_write_b128 v163, v[152:155] offset:6144
    ds_write_b128 v163, v[156:159] offset:7168
aloopL_43_nd0:
    v_mfma_f32_16x16x32_bf16 v[48:51], v[128:131], v[192:195], 0
    v_mfma_f32_16x16x32_bf16 v[52:55], v[128:131], v[208:211], 0
    v_mfma_f32_16x16x32_bf16 v[56:59], v[128:131], v[224:227], 0
    v_mfma_f32_16x16x32_bf16 v[60:63], v[128:131], v[240:243], 0
    v_mfma_f32_16x16x32_bf16 v[64:67], v[144:147], v[192:195], 0
    v_mfma_f32_16x16x32_bf16 v[68:71], v[144:147], v[208:211], 0
    v_mfma_f32_16x16x32_bf16 v[72:75], v[144:147], v[224:227], 0
    v_mfma_f32_16x16x32_bf16 v[76:79], v[144:147], v[240:243], 0
    v_mfma_f32_16x16x32_bf16 v[48:51], v[132:135], v[196:199], v[48:51]
    v_mfma_f32_16x16x32_bf16 v[52:55], v[132:135], v[212:215], v[52:55]
    v_mfma_f32_16x16x32_bf16 v[56:59], v[132:135], v[228:231], v[56:59]
    v_mfma_f32_16x16x32_bf16 v[60:63], v[132:135], v[244:247], v[60:63]
    v_mfma_f32_16x16x32_bf16 v[64:67], v[148:151], v[196:199], v[64:67]
    v_mfma_f32_16x16x32_bf16 v[68:71], v[148:151], v[212:215], v[68:71]
    v_mfma_f32_16x16x32_bf16 v[72:75], v[148:151], v[228:231], v[72:75]
    v_mfma_f32_16x16x32_bf16 v[76:79], v[148:151], v[244:247], v[76:79]
    v_mfma_f32_16x16x32_bf16 v[48:51], v[136:139], v[200:203], v[48:51]
    v_mfma_f32_16x16x32_bf16 v[52:55], v[136:139], v[216:219], v[52:55]
    v_mfma_f32_16x16x32_bf16 v[56:59], v[136:139], v[232:235], v[56:59]
    v_mfma_f32_16x16x32_bf16 v[60:63], v[136:139], v[248:251], v[60:63]
    v_mfma_f32_16x16x32_bf16 v[64:67], v[152:155], v[200:203], v[64:67]
    v_mfma_f32_16x16x32_bf16 v[68:71], v[152:155], v[216:219], v[68:71]
    v_mfma_f32_16x16x32_bf16 v[72:75], v[152:155], v[232:235], v[72:75]
    v_mfma_f32_16x16x32_bf16 v[76:79], v[152:155], v[248:251], v[76:79]
    v_mfma_f32_16x16x32_bf16 v[48:51], v[140:143], v[204:207], v[48:51]
    v_mfma_f32_16x16x32_bf16 v[52:55], v[140:143], v[220:223], v[52:55]
    v_mfma_f32_16x16x32_bf16 v[56:59], v[140:143], v[236:239], v[56:59]
    v_mfma_f32_16x16x32_bf16 v[60:63], v[140:143], v[252:255], v[60:63]
    v_mfma_f32_16x16x32_bf16 v[64:67], v[156:159], v[204:207], v[64:67]
    v_mfma_f32_16x16x32_bf16 v[68:71], v[156:159], v[220:223], v[68:71]
    v_mfma_f32_16x16x32_bf16 v[72:75], v[156:159], v[236:239], v[72:75]
    v_mfma_f32_16x16x32_bf16 v[76:79], v[156:159], v[252:255], v[76:79]
    s_nop 2
    v_cvt_pk_bf16_f32 v80, v48, v49
    v_cvt_pk_bf16_f32 v81, v50, v51
    v_cvt_pk_bf16_f32 v82, v64, v65
    v_cvt_pk_bf16_f32 v83, v66, v67
    v_cvt_pk_bf16_f32 v84, v52, v53
    v_cvt_pk_bf16_f32 v85, v54, v55
    v_cvt_pk_bf16_f32 v86, v68, v69
    v_cvt_pk_bf16_f32 v87, v70, v71
    v_cvt_pk_bf16_f32 v88, v56, v57
    v_cvt_pk_bf16_f32 v89, v58, v59
    v_cvt_pk_bf16_f32 v90, v72, v73
    v_cvt_pk_bf16_f32 v91, v74, v75
    v_cvt_pk_bf16_f32 v92, v60, v61
    v_cvt_pk_bf16_f32 v93, v62, v63
    v_cvt_pk_bf16_f32 v94, v76, v77
    v_cvt_pk_bf16_f32 v95, v78, v79
    v_mov_b32 v24, 0
    v_mov_b32 v25, 0
    v_mov_b32 v26, 0
    v_mov_b32 v27, 0
    v_mov_b32 v28, 0
    v_mov_b32 v29, 0
    v_mov_b32 v30, 0
    v_mov_b32 v31, 0
    v_mov_b32 v32, 0
    v_mov_b32 v33, 0
    v_mov_b32 v34, 0
    v_mov_b32 v35, 0
    v_mov_b32 v36, 0
    v_mov_b32 v37, 0
    v_mov_b32 v38, 0
    v_mov_b32 v39, 0
    s_setprio 2
    s_add_u32 s41, s41, 262144
    s_waitcnt lgkmcnt(0)
    s_barrier
    s_cmp_lg_u32 s31, s30
    s_cbranch_scc1 aloopL_43_nd1
    s_add_u32 m0, s42, 16384
    s_add_u32 s17, s41, s33
    s_add_u32 s17, s17, 3932160
    buffer_load_dwordx4 v0, s[4:7], s17 offen offset:0 sc1 lds
    buffer_load_dwordx4 v0, s[4:7], s17 offen offset:1024 sc1 lds
    buffer_load_dwordx4 v0, s[4:7], s17 offen offset:2048 sc1 lds
    buffer_load_dwordx4 v0, s[4:7], s17 offen offset:3072 sc1 lds
aloopL_43_nd1:
    s_sleep 9
    s_waitcnt lgkmcnt(0)
    buffer_load_dwordx4 v[48:51], v0, s[4:7], s23 offen offset:0 sc1
    buffer_load_dwordx4 v[52:55], v0, s[4:7], s23 offen offset:1024 sc1
    buffer_load_dwordx4 v[56:59], v0, s[4:7], s23 offen offset:2048 sc1
    buffer_load_dwordx4 v[60:63], v0, s[4:7], s23 offen offset:3072 sc1
    s_sleep 2
    buffer_load_dwordx4 v[64:67], v0, s[4:7], s24 offen offset:0 sc1
    buffer_load_dwordx4 v[68:71], v0, s[4:7], s24 offen offset:1024 sc1
    s_waitcnt vmcnt(5)
    v_mfma_f32_16x16x32_bf16 v[12:15], v[96:99], v[48:51], 0
    v_mfma_f32_16x16x32_bf16 v[16:19], v[112:115], v[48:51], 0
    v_max_u32 v3, v48, v50
    v_cmp_eq_u32 vcc, -1, v3
    v_mfma_f32_16x16x32_bf16 v[20:23], v[48:51], v[48:51], 0
    s_cbranch_vccnz aloopL_43_rq_0
    s_waitcnt vmcnt(4)
    v_mfma_f32_16x16x32_bf16 v[12:15], v[100:103], v[52:55], v[12:15]
    v_mfma_f32_16x16x32_bf16 v[16:19], v[116:119], v[52:55], v[16:19]
    v_max_u32 v3, v52, v54
    v_cmp_eq_u32 vcc, -1, v3
    v_mfma_f32_16x16x32_bf16 v[20:23], v[52:55], v[52:55], v[20:23]
    s_cbranch_vccnz aloopL_43_rq_1
    s_waitcnt vmcnt(3)
    v_mfma_f32_16x16x32_bf16 v[12:15], v[104:107], v[56:59], v[12:15]
    v_mfma_f32_16x16x32_bf16 v[16:19], v[120:123], v[56:59], v[16:19]
    v_max_u32 v3, v56, v58
    v_cmp_eq_u32 vcc, -1, v3
    v_mfma_f32_16x16x32_bf16 v[20:23], v[56:59], v[56:59], v[20:23]
    s_cbranch_vccnz aloopL_43_rq_2
    s_waitcnt vmcnt(2)
    v_mfma_f32_16x16x32_bf16 v[12:15], v[108:111], v[60:63], v[12:15]
    v_mfma_f32_16x16x32_bf16 v[16:19], v[124:127], v[60:63], v[16:19]
    v_max_u32 v3, v60, v62
    v_cmp_eq_u32 vcc, -1, v3
    v_mfma_f32_16x16x32_bf16 v[20:23], v[60:63], v[60:63], v[20:23]
    s_cbranch_vccnz aloopL_43_rq_3
aloopL_43_sdone:
    s_nop 1
    ds_write_b32 v164, v165
    s_nop 0
    v_max3_f32 v2, v12, v13, v14
    v_max3_f32 v3, v15, v16, v17
    v_max3_f32 v2, v2, v18, v19
    v_max3_f32 v3, v3, v20, v21
    v_max_f32 v2, v2, v3
    v_mov_b32 v3, v2
    s_nop 1
    v_permlane16_swap_b32 v3, v2
    v_max_f32 v2, v2, v3
    v_mov_b32 v3, v2
    s_waitcnt vmcnt(0)
    v_max3_u32 v188, v64, v66, v68
    v_permlane32_swap_b32 v3, v2
    v_max_f32 v2, v2, v3
    v_max_u32 v188, v188, v70
    v_mul_f32 v2, s29, v2
    v_cmp_eq_u32 vcc, -1, v188
    v_fma_f32 v12, v12, s29, -v2
    v_fma_f32 v13, v13, s29, -v2
    s_cbranch_vccnz aloopL_43_rq_v
aloopL_43_vok:
    v_smfmac_f32_16x16x64_bf16 v[24:27], v[64:67], v[192:199], v166
    v_fma_f32 v14, v14, s29, -v2
    v_exp_f32 v12, v12
    v_smfmac_f32_16x16x64_bf16 v[32:35], v[64:67], v[224:231], v166
    s_add_u32 s17, s41, 37748736
    buffer_load_dwordx4 v[128:131], v0, s[4:7], s17 offen offset:0 sc1
    v_fma_f32 v15, v15, s29, -v2
    v_exp_f32 v13, v13
    v_smfmac_f32_16x16x64_bf16 v[28:31], v[64:67], v[208:215], v166
    buffer_load_dwordx4 v[132:135], v0, s[4:7], s17 offen offset:1024 sc1
    v_fma_f32 v16, v16, s29, -v2
    v_exp_f32 v14, v14
    v_smfmac_f32_16x16x64_bf16 v[36:39], v[64:67], v[240:247], v166
    buffer_load_dwordx4 v[136:139], v0, s[4:7], s17 offen offset:2048 sc1
    v_fma_f32 v17, v17, s29, -v2
    v_exp_f32 v15, v15
    v_smfmac_f32_16x16x64_bf16 v[24:27], v[68:71], v[200:207], v166
    buffer_load_dwordx4 v[140:143], v0, s[4:7], s17 offen offset:3072 sc1
    v_fma_f32 v18, v18, s29, -v2
    v_exp_f32 v16, v16
    v_smfmac_f32_16x16x64_bf16 v[32:35], v[68:71], v[232:239], v166
    s_add_u32 s18, s41, 37879808
    buffer_load_dwordx4 v[144:147], v0, s[4:7], s18 offen offset:0 sc1
    v_fma_f32 v19, v19, s29, -v2
    v_exp_f32 v17, v17
    v_smfmac_f32_16x16x64_bf16 v[28:31], v[68:71], v[216:223], v166
    buffer_load_dwordx4 v[148:151], v0, s[4:7], s18 offen offset:1024 sc1
    v_fma_f32 v20, v20, s29, -v2
    v_exp_f32 v18, v18
    v_smfmac_f32_16x16x64_bf16 v[36:39], v[68:71], v[248:255], v166
    buffer_load_dwordx4 v[152:155], v0, s[4:7], s18 offen offset:2048 sc1
    v_fma_f32 v21, v21, s29, -v2
    v_exp_f32 v19, v19
    buffer_load_dwordx4 v[156:159], v0, s[4:7], s18 offen offset:3072 sc1
    v_exp_f32 v20, v20
    v_exp_f32 v21, v21
    v_cvt_pk_bf16_f32 v12, v12, v13
    v_cvt_pk_bf16_f32 v13, v14, v15
    v_cvt_pk_bf16_f32 v14, v16, v17
    v_cvt_pk_bf16_f32 v15, v18, v19
    v_cvt_pk_bf16_f32 v20, v20, v21
    v_mov_b32 v22, 0
    v_mfma_f32_16x16x32_bf16 v[16:19], v[4:7], v[12:15], 0
    v_mov_b32 v21, v20
    v_mov_b32 v23, 0
    v_cvt_pk_bf16_f32 v40, v24, v25
    v_cvt_pk_bf16_f32 v41, v26, v27
    v_mfma_f32_16x16x32_bf16 v[16:19], v[8:11], v[20:23], v[16:19]
    v_mfma_f32_16x16x32_bf16 v[24:27], v[80:83], v[12:15], 0
    v_cvt_pk_bf16_f32 v44, v32, v33
    v_cvt_pk_bf16_f32 v45, v34, v35
    v_mfma_f32_16x16x32_bf16 v[32:35], v[88:91], v[12:15], 0
    v_cvt_pk_bf16_f32 v42, v28, v29
    v_cvt_pk_bf16_f32 v43, v30, v31
    v_mfma_f32_16x16x32_bf16 v[28:31], v[84:87], v[12:15], 0
    v_cvt_pk_bf16_f32 v46, v36, v37
    v_cvt_pk_bf16_f32 v47, v38, v39
    v_mfma_f32_16x16x32_bf16 v[36:39], v[92:95], v[12:15], 0
aloopL_43_midE:
    s_mov_b64 vcc, s[56:57]
    v_rcp_f32 v3, v16
    v_mfma_f32_16x16x32_bf16 v[24:27], v[40:43], v[20:23], v[24:27]
    v_mfma_f32_16x16x32_bf16 v[32:35], v[44:47], v[20:23], v[32:35]
    v_mfma_f32_16x16x32_bf16 v[28:31], v[42:45], v[20:23], v[28:31]
    v_mfma_f32_16x16x32_bf16 v[36:39], v[46:49], v[20:23], v[36:39]
    v_mov_b32_dpp v3, v3 quad_perm:[2,3,2,3] row_mask:0xf bank_mask:0xf
    s_nop 4
    v_cndmask_b32_dpp v24, v32, v24, vcc quad_perm:[2,3,2,3] row_mask:0xf bank_mask:0xf
    v_cndmask_b32_dpp v25, v33, v25, vcc quad_perm:[2,3,2,3] row_mask:0xf bank_mask:0xf
    v_cndmask_b32_dpp v26, v34, v26, vcc quad_perm:[2,3,2,3] row_mask:0xf bank_mask:0xf
    v_cndmask_b32_dpp v27, v35, v27, vcc quad_perm:[2,3,2,3] row_mask:0xf bank_mask:0xf
    v_cndmask_b32_dpp v28, v36, v28, vcc quad_perm:[2,3,2,3] row_mask:0xf bank_mask:0xf
    v_cndmask_b32_dpp v29, v37, v29, vcc quad_perm:[2,3,2,3] row_mask:0xf bank_mask:0xf
    v_cndmask_b32_dpp v30, v38, v30, vcc quad_perm:[2,3,2,3] row_mask:0xf bank_mask:0xf
    v_cndmask_b32_dpp v31, v39, v31, vcc quad_perm:[2,3,2,3] row_mask:0xf bank_mask:0xf
    v_mul_f32 v24, v24, v3
    v_mul_f32 v25, v25, v3
    v_mul_f32 v26, v26, v3
    v_mul_f32 v27, v27, v3
    v_mul_f32 v28, v28, v3
    v_mul_f32 v29, v29, v3
    v_mul_f32 v30, v30, v3
    v_mul_f32 v31, v31, v3
    v_cvt_pk_bf16_f32 v168, v24, v25
    v_cvt_pk_bf16_f32 v169, v26, v27
    v_cvt_pk_bf16_f32 v170, v28, v29
    v_cvt_pk_bf16_f32 v171, v30, v31
    ds_write_b128 v160, v[168:171]
    s_waitcnt lgkmcnt(0)
    s_barrier
    ds_read_b128 v[172:175], v161
    s_waitcnt lgkmcnt(0)
    v_mfma_f32_16x16x32_bf16 v[24:27], v[184:187], v[172:175], 0
    s_nop 7
    v_cvt_pk_bf16_f32 v168, v24, v25
    v_cvt_pk_bf16_f32 v169, v26, v27
    s_nop 0
    v_permlane16_swap_b32 v168, v170
    v_permlane16_swap_b32 v169, v171
    s_mov_b64 exec, 0xffff
    v_min_u32 v168, -2, v168
    buffer_store_dwordx4 v[168:171], v1, s[4:7], s25 offen sc1
    s_setprio 0
    buffer_store_dwordx4 v[176:179], v1, s[4:7], s26 offen sc1
    s_mov_b64 exec, -1
    s_branch pg_44
    s_cmp_lg_u32 s27, 0
    s_cbranch_scc1 pg_44
    s_sub_u32 s21, s16, 1
    s_cbranch_scc1 pg_44
    s_sub_u32 s17, s21, 1
    s_and_b32 s17, s17, 3
    s_cmp_ge_u32 s16, 58
    s_cselect_b32 s17, 0, s17
    s_cmp_lg_u32 s17, 0
    s_cbranch_scc1 pg_44
    v_mov_b32 v3, s21
    s_mov_b64 exec, 1
    buffer_store_dword v3, off, s[4:7], s28 sc1
    s_mov_b64 exec, -1
pg_44:
    s_cmp_lg_u32 s31, s30
    s_cbranch_scc1 aloopL_43_nd2
    ds_read_b128 v[24:27], v163 offset:16384
    ds_read_b128 v[28:31], v163 offset:17408
    ds_read_b128 v[32:35], v163 offset:18432
    ds_read_b128 v[36:39], v163 offset:19456
    ds_write_b32 v180, v64 offset:0
    ds_write_b32 v180, v65 offset:8
    ds_write_b32 v180, v66 offset:128
    ds_write_b32 v180, v67 offset:136
    ds_write_b32 v180, v68 offset:1024
    ds_write_b32 v180, v69 offset:1032
    ds_write_b32 v180, v70 offset:1152
    ds_write_b32 v180, v71 offset:1160
    s_mov_b32 s32, 1
    s_waitcnt lgkmcnt(11)
    v_mfma_f32_16x16x32_bf16 v[12:15], v[96:99], v[24:27], 0
    v_mfma_f32_16x16x32_bf16 v[16:19], v[112:115], v[24:27], 0
    v_mfma_f32_16x16x32_bf16 v[20:23], v[48:51], v[24:27], 0
    s_waitcnt lgkmcnt(10)
    v_mfma_f32_16x16x32_bf16 v[12:15], v[100:103], v[28:31], v[12:15]
    v_mfma_f32_16x16x32_bf16 v[16:19], v[116:119], v[28:31], v[16:19]
    v_mfma_f32_16x16x32_bf16 v[20:23], v[52:55], v[28:31], v[20:23]
    s_waitcnt lgkmcnt(9)
    v_mfma_f32_16x16x32_bf16 v[12:15], v[104:107], v[32:35], v[12:15]
    v_mfma_f32_16x16x32_bf16 v[16:19], v[120:123], v[32:35], v[16:19]
    v_mfma_f32_16x16x32_bf16 v[20:23], v[56:59], v[32:35], v[20:23]
    s_waitcnt lgkmcnt(8)
    v_mfma_f32_16x16x32_bf16 v[12:15], v[108:111], v[36:39], v[12:15]
    v_mfma_f32_16x16x32_bf16 v[16:19], v[124:127], v[36:39], v[16:19]
    v_mfma_f32_16x16x32_bf16 v[20:23], v[60:63], v[36:39], v[20:23]
    s_waitcnt lgkmcnt(0)
    s_nop 3
    s_nop 3
    s_cmp_eq_u32 s32, 0
    s_cbranch_scc1 aloopL_43_p2e
    s_mov_b32 s32, 0
    ds_read_b64_tr_b16 v[96:97], v181 offset:0
    ds_read_b64_tr_b16 v[98:99], v181 offset:4096
    ds_read_b64_tr_b16 v[64:65], v182 offset:0
    ds_read_b64_tr_b16 v[100:101], v181 offset:8
    ds_read_b64_tr_b16 v[102:103], v181 offset:4104
    ds_read_b64_tr_b16 v[66:67], v182 offset:8
    ds_read_b64_tr_b16 v[104:105], v181 offset:1024
    ds_read_b64_tr_b16 v[106:107], v181 offset:5120
    ds_read_b64_tr_b16 v[68:69], v182 offset:512
    ds_read_b64_tr_b16 v[108:109], v181 offset:1032
    ds_read_b64_tr_b16 v[110:111], v181 offset:5128
    ds_read_b64_tr_b16 v[70:71], v182 offset:520
    ds_read_b64_tr_b16 v[112:113], v181 offset:2048
    ds_read_b64_tr_b16 v[114:115], v181 offset:6144
    ds_read_b64_tr_b16 v[72:73], v182 offset:1024
    ds_read_b64_tr_b16 v[116:117], v181 offset:2056
    ds_read_b64_tr_b16 v[118:119], v181 offset:6152
    ds_read_b64_tr_b16 v[74:75], v182 offset:1032
    ds_read_b64_tr_b16 v[120:121], v181 offset:3072
    ds_read_b64_tr_b16 v[122:123], v181 offset:7168
    ds_read_b64_tr_b16 v[76:77], v182 offset:1536
    ds_read_b64_tr_b16 v[124:125], v181 offset:3080
    ds_read_b64_tr_b16 v[126:127], v181 offset:7176
    ds_read_b64_tr_b16 v[78:79], v182 offset:1544
    v_mov_b32 v188, 0xff61b1e6
    s_cmp_eq_u32 s33, 0
    s_cselect_b64 vcc, s[44:45], 0
    v_cndmask_b32 v12, v12, v188, vcc
    s_cselect_b64 vcc, -1, s[44:45]
    v_cndmask_b32 v16, v16, v188, vcc
    s_cselect_b64 vcc, s[46:47], 0
    v_cndmask_b32 v13, v13, v188, vcc
    s_cselect_b64 vcc, -1, s[46:47]
    v_cndmask_b32 v17, v17, v188, vcc
    s_cselect_b64 vcc, s[48:49], 0
    v_cndmask_b32 v14, v14, v188, vcc
    s_cselect_b64 vcc, -1, s[48:49]
    v_cndmask_b32 v18, v18, v188, vcc
    s_cselect_b64 vcc, s[50:51], 0
    v_cndmask_b32 v15, v15, v188, vcc
    s_cselect_b64 vcc, -1, s[50:51]
    v_cndmask_b32 v19, v19, v188, vcc
    v_max3_f32 v2, v12, v13, v14
    v_max3_f32 v3, v15, v16, v17
    v_max3_f32 v2, v2, v18, v19
    v_max3_f32 v3, v3, v20, v21
    v_max_f32 v2, v2, v3
    v_mov_b32 v3, v2
    s_nop 1
    v_permlane16_swap_b32 v3, v2
    v_max_f32 v2, v2, v3
    v_mov_b32 v3, v2
    s_nop 1
    v_permlane32_swap_b32 v3, v2
    v_max_f32 v2, v2, v3
    v_mul_f32 v2, s29, v2
    v_fma_f32 v12, v12, s29, -v2
    v_fma_f32 v13, v13, s29, -v2
    v_fma_f32 v14, v14, s29, -v2
    v_exp_f32 v12, v12
    v_fma_f32 v15, v15, s29, -v2
    v_exp_f32 v13, v13
    v_fma_f32 v16, v16, s29, -v2
    v_exp_f32 v14, v14
    v_fma_f32 v17, v17, s29, -v2
    v_exp_f32 v15, v15
    v_fma_f32 v18, v18, s29, -v2
    v_exp_f32 v16, v16
    v_fma_f32 v19, v19, s29, -v2
    v_exp_f32 v17, v17
    v_fma_f32 v20, v20, s29, -v2
    v_exp_f32 v18, v18
    v_fma_f32 v21, v21, s29, -v2
    v_exp_f32 v19, v19
    v_exp_f32 v20, v20
    v_exp_f32 v21, v21
    v_cvt_pk_bf16_f32 v12, v12, v13
    v_cvt_pk_bf16_f32 v13, v14, v15
    v_cvt_pk_bf16_f32 v14, v16, v17
    v_cvt_pk_bf16_f32 v15, v18, v19
    v_cvt_pk_bf16_f32 v20, v20, v21
    v_mov_b32 v22, 0
    v_mov_b32 v21, 0
    v_mov_b32 v23, 0
    s_waitcnt lgkmcnt(0)
    s_nop 0
    v_mfma_f32_16x16x32_bf16 v[16:19], v[4:7], v[12:15], 0
    v_mfma_f32_16x16x32_bf16 v[16:19], v[4:7], v[20:23], v[16:19]
    v_mfma_f32_16x16x32_bf16 v[24:27], v[96:99], v[12:15], 0
    v_mfma_f32_16x16x32_bf16 v[24:27], v[64:67], v[20:23], v[24:27]
    v_mfma_f32_16x16x32_bf16 v[28:31], v[100:103], v[12:15], 0
    v_mfma_f32_16x16x32_bf16 v[28:31], v[66:69], v[20:23], v[28:31]
    v_mfma_f32_16x16x32_bf16 v[32:35], v[104:107], v[12:15], 0
    v_mfma_f32_16x16x32_bf16 v[32:35], v[68:71], v[20:23], v[32:35]
    v_mfma_f32_16x16x32_bf16 v[36:39], v[108:111], v[12:15], 0
    v_mfma_f32_16x16x32_bf16 v[36:39], v[70:73], v[20:23], v[36:39]
    v_mfma_f32_16x16x32_bf16 v[48:51], v[112:115], v[12:15], 0
    v_mfma_f32_16x16x32_bf16 v[48:51], v[72:75], v[20:23], v[48:51]
    v_mfma_f32_16x16x32_bf16 v[52:55], v[116:119], v[12:15], 0
    v_mfma_f32_16x16x32_bf16 v[52:55], v[74:77], v[20:23], v[52:55]
    v_mfma_f32_16x16x32_bf16 v[56:59], v[120:123], v[12:15], 0
    v_mfma_f32_16x16x32_bf16 v[56:59], v[76:79], v[20:23], v[56:59]
    v_mfma_f32_16x16x32_bf16 v[60:63], v[124:127], v[12:15], 0
    v_mfma_f32_16x16x32_bf16 v[60:63], v[78:81], v[20:23], v[60:63]
    v_rcp_f32 v3, v16
    s_nop 0
    v_mul_f32 v24, v24, v3
    v_mul_f32 v25, v25, v3
    v_mul_f32 v26, v26, v3
    v_mul_f32 v27, v27, v3
    v_mul_f32 v28, v28, v3
    v_mul_f32 v29, v29, v3
    v_mul_f32 v30, v30, v3
    v_mul_f32 v31, v31, v3
    v_cvt_pk_bf16_f32 v24, v24, v25
    v_cvt_pk_bf16_f32 v25, v26, v27
    v_cvt_pk_bf16_f32 v26, v28, v29
    v_cvt_pk_bf16_f32 v27, v30, v31
    ds_write_b128 v0, v[24:27] offset:32768
    v_mul_f32 v32, v32, v3
    v_mul_f32 v33, v33, v3
    v_mul_f32 v34, v34, v3
    v_mul_f32 v35, v35, v3
    v_mul_f32 v36, v36, v3
    v_mul_f32 v37, v37, v3
    v_mul_f32 v38, v38, v3
    v_mul_f32 v39, v39, v3
    v_cvt_pk_bf16_f32 v32, v32, v33
    v_cvt_pk_bf16_f32 v33, v34, v35
    v_cvt_pk_bf16_f32 v34, v36, v37
    v_cvt_pk_bf16_f32 v35, v38, v39
    ds_write_b128 v0, v[32:35] offset:33792
    v_mul_f32 v48, v48, v3
    v_mul_f32 v49, v49, v3
    v_mul_f32 v50, v50, v3
    v_mul_f32 v51, v51, v3
    v_mul_f32 v52, v52, v3
    v_mul_f32 v53, v53, v3
    v_mul_f32 v54, v54, v3
    v_mul_f32 v55, v55, v3
    v_cvt_pk_bf16_f32 v48, v48, v49
    v_cvt_pk_bf16_f32 v49, v50, v51
    v_cvt_pk_bf16_f32 v50, v52, v53
    v_cvt_pk_bf16_f32 v51, v54, v55
    ds_write_b128 v0, v[48:51] offset:34816
    v_mul_f32 v56, v56, v3
    v_mul_f32 v57, v57, v3
    v_mul_f32 v58, v58, v3
    v_mul_f32 v59, v59, v3
    v_mul_f32 v60, v60, v3
    v_mul_f32 v61, v61, v3
    v_mul_f32 v62, v62, v3
    v_mul_f32 v63, v63, v3
    v_cvt_pk_bf16_f32 v56, v56, v57
    v_cvt_pk_bf16_f32 v57, v58, v59
    v_cvt_pk_bf16_f32 v58, v60, v61
    v_cvt_pk_bf16_f32 v59, v62, v63
    ds_write_b128 v0, v[56:59] offset:35840
aloopL_43_p2e:
    s_nop 3
aloopL_43_nd2:
    s_add_u32 s19, s41, 20971520
    buffer_load_dwordx4 v[96:99], v0, s[4:7], s19 offen offset:0 sc1
    buffer_load_dwordx4 v[100:103], v0, s[4:7], s19 offen offset:1024 sc1
    buffer_load_dwordx4 v[104:107], v0, s[4:7], s19 offen offset:2048 sc1
    buffer_load_dwordx4 v[108:111], v0, s[4:7], s19 offen offset:3072 sc1
    s_add_u32 s20, s41, 21102592
    buffer_load_dwordx4 v[112:115], v0, s[4:7], s20 offen offset:0 sc1
    buffer_load_dwordx4 v[116:119], v0, s[4:7], s20 offen offset:1024 sc1
    buffer_load_dwordx4 v[120:123], v0, s[4:7], s20 offen offset:2048 sc1
    buffer_load_dwordx4 v[124:127], v0, s[4:7], s20 offen offset:3072 sc1
    s_add_u32 s16, s16, 1
    s_cmp_lt_u32 s16, 48
    s_cbranch_scc1 aloopL_43
    s_waitcnt vmcnt(0)
    ds_write_b128 v163, v[128:131] offset:8192
    ds_write_b128 v163, v[132:135] offset:9216
    ds_write_b128 v163, v[136:139] offset:10240
    ds_write_b128 v163, v[140:143] offset:11264
    ds_write_b128 v163, v[144:147] offset:12288
    ds_write_b128 v163, v[148:151] offset:13312
    ds_write_b128 v163, v[152:155] offset:14336
    ds_write_b128 v163, v[156:159] offset:15360
    s_waitcnt lgkmcnt(0)
    s_branch aloopH_42
aloopL_43_rq_0:
    s_sub_u32 s22, s22, 1
    s_cbranch_scc1 aloopL_43_rq_0_g
    buffer_load_dwordx4 v[48:51], v0, s[4:7], s23 offen offset:0 sc1
    buffer_load_dwordx4 v[52:55], v0, s[4:7], s23 offen offset:1024 sc1
    buffer_load_dwordx4 v[56:59], v0, s[4:7], s23 offen offset:2048 sc1
    buffer_load_dwordx4 v[60:63], v0, s[4:7], s23 offen offset:3072 sc1
    buffer_load_dwordx4 v[64:67], v0, s[4:7], s24 offen offset:0 sc1
    buffer_load_dwordx4 v[68:71], v0, s[4:7], s24 offen offset:1024 sc1
    s_waitcnt vmcnt(5)
    v_max_u32 v3, v48, v50
    v_cmp_eq_u32 vcc, -1, v3
    s_cbranch_vccnz aloopL_43_rq_0
    s_branch aloopL_43_again
aloopL_43_rq_0_g:
    s_mov_b32 s22, 0
    s_waitcnt vmcnt(0)
    s_branch aloopL_43_nochk
aloopL_43_rq_1:
    s_sub_u32 s22, s22, 1
    s_cbranch_scc1 aloopL_43_rq_1_g
    buffer_load_dwordx4 v[52:55], v0, s[4:7], s23 offen offset:1024 sc1
    buffer_load_dwordx4 v[56:59], v0, s[4:7], s23 offen offset:2048 sc1
    buffer_load_dwordx4 v[60:63], v0, s[4:7], s23 offen offset:3072 sc1
    buffer_load_dwordx4 v[64:67], v0, s[4:7], s24 offen offset:0 sc1
    buffer_load_dwordx4 v[68:71], v0, s[4:7], s24 offen offset:1024 sc1
    s_waitcnt vmcnt(4)
    v_max_u32 v3, v52, v54
    v_cmp_eq_u32 vcc, -1, v3
    s_cbranch_vccnz aloopL_43_rq_1
    s_branch aloopL_43_again
aloopL_43_rq_1_g:
    s_mov_b32 s22, 0
    s_waitcnt vmcnt(0)
    s_branch aloopL_43_nochk
aloopL_43_rq_2:
    s_sub_u32 s22, s22, 1
    s_cbranch_scc1 aloopL_43_rq_2_g
    buffer_load_dwordx4 v[56:59], v0, s[4:7], s23 offen offset:2048 sc1
    buffer_load_dwordx4 v[60:63], v0, s[4:7], s23 offen offset:3072 sc1
    buffer_load_dwordx4 v[64:67], v0, s[4:7], s24 offen offset:0 sc1
    buffer_load_dwordx4 v[68:71], v0, s[4:7], s24 offen offset:1024 sc1
    s_waitcnt vmcnt(3)
    v_max_u32 v3, v56, v58
    v_cmp_eq_u32 vcc, -1, v3
    s_cbranch_vccnz aloopL_43_rq_2
    s_branch aloopL_43_again
aloopL_43_rq_2_g:
    s_mov_b32 s22, 0
    s_waitcnt vmcnt(0)
    s_branch aloopL_43_nochk
aloopL_43_rq_3:
    s_sub_u32 s22, s22, 1
    s_cbranch_scc1 aloopL_43_rq_3_g
    buffer_load_dwordx4 v[60:63], v0, s[4:7], s23 offen offset:3072 sc1
    buffer_load_dwordx4 v[64:67], v0, s[4:7], s24 offen offset:0 sc1
    buffer_load_dwordx4 v[68:71], v0, s[4:7], s24 offen offset:1024 sc1
    s_waitcnt vmcnt(2)
    v_max_u32 v3, v60, v62
    v_cmp_eq_u32 vcc, -1, v3
    s_cbranch_vccnz aloopL_43_rq_3
    s_branch aloopL_43_again
aloopL_43_rq_3_g:
    s_mov_b32 s22, 0
    s_waitcnt vmcnt(0)
    s_branch aloopL_43_nochk
aloopL_43_again:
    s_waitcnt vmcnt(5)
    v_mfma_f32_16x16x32_bf16 v[12:15], v[96:99], v[48:51], 0
    v_mfma_f32_16x16x32_bf16 v[16:19], v[112:115], v[48:51], 0
    v_max_u32 v3, v48, v50
    v_cmp_eq_u32 vcc, -1, v3
    v_mfma_f32_16x16x32_bf16 v[20:23], v[48:51], v[48:51], 0
    s_cbranch_vccnz aloopL_43_rq_0
    s_waitcnt vmcnt(4)
    v_mfma_f32_16x16x32_bf16 v[12:15], v[100:103], v[52:55], v[12:15]
    v_mfma_f32_16x16x32_bf16 v[16:19], v[116:119], v[52:55], v[16:19]
    v_max_u32 v3, v52, v54
    v_cmp_eq_u32 vcc, -1, v3
    v_mfma_f32_16x16x32_bf16 v[20:23], v[52:55], v[52:55], v[20:23]
    s_cbranch_vccnz aloopL_43_rq_1
    s_waitcnt vmcnt(3)
    v_mfma_f32_16x16x32_bf16 v[12:15], v[104:107], v[56:59], v[12:15]
    v_mfma_f32_16x16x32_bf16 v[16:19], v[120:123], v[56:59], v[16:19]
    v_max_u32 v3, v56, v58
    v_cmp_eq_u32 vcc, -1, v3
    v_mfma_f32_16x16x32_bf16 v[20:23], v[56:59], v[56:59], v[20:23]
    s_cbranch_vccnz aloopL_43_rq_2
    s_waitcnt vmcnt(2)
    v_mfma_f32_16x16x32_bf16 v[12:15], v[108:111], v[60:63], v[12:15]
    v_mfma_f32_16x16x32_bf16 v[16:19], v[124:127], v[60:63], v[16:19]
    v_max_u32 v3, v60, v62
    v_cmp_eq_u32 vcc, -1, v3
    v_mfma_f32_16x16x32_bf16 v[20:23], v[60:63], v[60:63], v[20:23]
    s_cbranch_vccnz aloopL_43_rq_3
    s_branch aloopL_43_sdone
aloopL_43_rq_v:
    s_sub_u32 s22, s22, 1
    s_cbranch_scc1 aloopL_43_rq_vg
    buffer_load_dwordx4 v[64:67], v0, s[4:7], s24 offen offset:0 sc1
    buffer_load_dwordx4 v[68:71], v0, s[4:7], s24 offen offset:1024 sc1
    s_waitcnt vmcnt(0)
    v_max3_u32 v188, v64, v66, v68
    v_max_u32 v188, v188, v70
    v_cmp_eq_u32 vcc, -1, v188
    s_cbranch_vccnz aloopL_43_rq_v
    s_branch aloopL_43_vok
aloopL_43_rq_vg:
    s_mov_b32 s22, 0
    s_branch aloopL_43_vok
aloopL_43_nochk:
    v_mfma_f32_16x16x32_bf16 v[12:15], v[96:99], v[48:51], 0
    v_mfma_f32_16x16x32_bf16 v[16:19], v[112:115], v[48:51], 0
    v_mfma_f32_16x16x32_bf16 v[20:23], v[48:51], v[48:51], 0
    v_mfma_f32_16x16x32_bf16 v[12:15], v[100:103], v[52:55], v[12:15]
    v_mfma_f32_16x16x32_bf16 v[16:19], v[116:119], v[52:55], v[16:19]
    v_mfma_f32_16x16x32_bf16 v[20:23], v[52:55], v[52:55], v[20:23]
    v_mfma_f32_16x16x32_bf16 v[12:15], v[104:107], v[56:59], v[12:15]
    v_mfma_f32_16x16x32_bf16 v[16:19], v[120:123], v[56:59], v[16:19]
    v_mfma_f32_16x16x32_bf16 v[20:23], v[56:59], v[56:59], v[20:23]
    v_mfma_f32_16x16x32_bf16 v[12:15], v[108:111], v[60:63], v[12:15]
    v_mfma_f32_16x16x32_bf16 v[16:19], v[124:127], v[60:63], v[16:19]
    v_mfma_f32_16x16x32_bf16 v[20:23], v[60:63], v[60:63], v[20:23]
    s_nop 1
    s_branch aloopL_43_sdone
ct_aH:
.p2align 6
aloopH_42:
    s_and_b32 s23, s16, 3
    s_lshl_b32 s23, s23, 18
    s_add_u32 s23, s23, s38
    s_add_u32 s24, s23, 4096
    s_and_b32 s25, s16, 3
    s_lshl_b32 s25, s25, 18
    s_add_u32 s25, s25, s39
    s_add_u32 s26, s16, 2
    s_and_b32 s26, s26, 3
    s_lshl_b32 s26, s26, 18
    s_add_u32 s26, s26, s39
    v_mov_b32 v165, s16
aloopH_42_wkv:
    ds_read_b32 v188, v164 offset:16
    s_waitcnt lgkmcnt(0)
    v_readfirstlane_b32 s19, v188
    s_cmp_ge_i32 s19, s16
    s_cbranch_scc1 aloopH_42_wkvok
    s_sleep 1
    s_branch aloopH_42_wkv
aloopH_42_wkvok:
    ds_read_b128 v[128:131], v163 offset:8192
    ds_read_b128 v[144:147], v163 offset:12288
    ds_read_b128 v[132:135], v163 offset:9216
    ds_read_b128 v[148:151], v163 offset:13312
    ds_read_b128 v[136:139], v163 offset:10240
    ds_read_b128 v[152:155], v163 offset:14336
    ds_read_b128 v[140:143], v163 offset:11264
    ds_read_b128 v[156:159], v163 offset:15360
    s_waitcnt lgkmcnt(6)
    v_mfma_f32_16x16x32_bf16 v[48:51], v[128:131], v[192:195], 0
    v_mfma_f32_16x16x32_bf16 v[52:55], v[128:131], v[208:211], 0
    v_mfma_f32_16x16x32_bf16 v[56:59], v[128:131], v[224:227], 0
    v_mfma_f32_16x16x32_bf16 v[60:63], v[128:131], v[240:243], 0
    v_mfma_f32_16x16x32_bf16 v[64:67], v[144:147], v[192:195], 0
    v_mfma_f32_16x16x32_bf16 v[68:71], v[144:147], v[208:211], 0
    v_mfma_f32_16x16x32_bf16 v[72:75], v[144:147], v[224:227], 0
    v_mfma_f32_16x16x32_bf16 v[76:79], v[144:147], v[240:243], 0
    s_setprio 2
aloopH_42_wm:
    ds_read_b32 v188, v164 offset:32
    s_waitcnt lgkmcnt(0)
    v_readfirstlane_b32 s19, v188
    s_cmp_ge_i32 s19, s16
    s_cbranch_scc1 aloopH_42_wmok
    s_sleep 1
    s_branch aloopH_42_wm
aloopH_42_wmok:
    s_add_u32 m0, s42, 16384
    s_add_u32 s17, s41, 4194304
    buffer_load_dwordx4 v0, s[4:7], s17 offen offset:0 sc1 lds
    buffer_load_dwordx4 v0, s[4:7], s17 offen offset:1024 sc1 lds
    buffer_load_dwordx4 v0, s[4:7], s17 offen offset:2048 sc1 lds
    buffer_load_dwordx4 v0, s[4:7], s17 offen offset:3072 sc1 lds
    s_add_u32 m0, s42, 20480
    s_add_u32 s17, s41, 4325376
    buffer_load_dwordx4 v0, s[4:7], s17 offen offset:0 sc1 lds
    buffer_load_dwordx4 v0, s[4:7], s17 offen offset:1024 sc1 lds
    buffer_load_dwordx4 v0, s[4:7], s17 offen offset:2048 sc1 lds
    buffer_load_dwordx4 v0, s[4:7], s17 offen offset:3072 sc1 lds
    s_add_u32 s41, s41, 262144
    s_barrier
    s_waitcnt lgkmcnt(4)
    v_mfma_f32_16x16x32_bf16 v[48:51], v[132:135], v[196:199], v[48:51]
    v_mfma_f32_16x16x32_bf16 v[52:55], v[132:135], v[212:215], v[52:55]
    v_mfma_f32_16x16x32_bf16 v[56:59], v[132:135], v[228:231], v[56:59]
    v_mfma_f32_16x16x32_bf16 v[60:63], v[132:135], v[244:247], v[60:63]
    v_mfma_f32_16x16x32_bf16 v[64:67], v[148:151], v[196:199], v[64:67]
    v_mfma_f32_16x16x32_bf16 v[68:71], v[148:151], v[212:215], v[68:71]
    v_mfma_f32_16x16x32_bf16 v[72:75], v[148:151], v[228:231], v[72:75]
    v_mfma_f32_16x16x32_bf16 v[76:79], v[148:151], v[244:247], v[76:79]
    s_waitcnt lgkmcnt(2)
    v_mfma_f32_16x16x32_bf16 v[48:51], v[136:139], v[200:203], v[48:51]
    v_mfma_f32_16x16x32_bf16 v[52:55], v[136:139], v[216:219], v[52:55]
    v_mfma_f32_16x16x32_bf16 v[56:59], v[136:139], v[232:235], v[56:59]
    v_mfma_f32_16x16x32_bf16 v[60:63], v[136:139], v[248:251], v[60:63]
    v_mfma_f32_16x16x32_bf16 v[64:67], v[152:155], v[200:203], v[64:67]
    v_mfma_f32_16x16x32_bf16 v[68:71], v[152:155], v[216:219], v[68:71]
    v_mfma_f32_16x16x32_bf16 v[72:75], v[152:155], v[232:235], v[72:75]
    v_mfma_f32_16x16x32_bf16 v[76:79], v[152:155], v[248:251], v[76:79]
    s_waitcnt lgkmcnt(0)
    v_mfma_f32_16x16x32_bf16 v[48:51], v[140:143], v[204:207], v[48:51]
    v_mfma_f32_16x16x32_bf16 v[52:55], v[140:143], v[220:223], v[52:55]
    v_mfma_f32_16x16x32_bf16 v[56:59], v[140:143], v[236:239], v[56:59]
    v_mfma_f32_16x16x32_bf16 v[60:63], v[140:143], v[252:255], v[60:63]
    v_mfma_f32_16x16x32_bf16 v[64:67], v[156:159], v[204:207], v[64:67]
    v_mfma_f32_16x16x32_bf16 v[68:71], v[156:159], v[220:223], v[68:71]
    v_mfma_f32_16x16x32_bf16 v[72:75], v[156:159], v[236:239], v[72:75]
    v_mfma_f32_16x16x32_bf16 v[76:79], v[156:159], v[252:255], v[76:79]
    s_nop 2
    v_cvt_pk_bf16_f32 v80, v48, v49
    v_cvt_pk_bf16_f32 v81, v50, v51
    v_cvt_pk_bf16_f32 v82, v64, v65
    v_cvt_pk_bf16_f32 v83, v66, v67
    v_cvt_pk_bf16_f32 v84, v52, v53
    v_cvt_pk_bf16_f32 v85, v54, v55
    v_cvt_pk_bf16_f32 v86, v68, v69
    v_cvt_pk_bf16_f32 v87, v70, v71
    v_cvt_pk_bf16_f32 v88, v56, v57
    v_cvt_pk_bf16_f32 v89, v58, v59
    v_cvt_pk_bf16_f32 v90, v72, v73
    v_cvt_pk_bf16_f32 v91, v74, v75
    v_cvt_pk_bf16_f32 v92, v60, v61
    v_cvt_pk_bf16_f32 v93, v62, v63
    v_cvt_pk_bf16_f32 v94, v76, v77
    v_cvt_pk_bf16_f32 v95, v78, v79
    v_mov_b32 v24, 0
    v_mov_b32 v25, 0
    v_mov_b32 v26, 0
    v_mov_b32 v27, 0
    v_mov_b32 v28, 0
    v_mov_b32 v29, 0
    v_mov_b32 v30, 0
    v_mov_b32 v31, 0
    v_mov_b32 v32, 0
    v_mov_b32 v33, 0
    v_mov_b32 v34, 0
    v_mov_b32 v35, 0
    v_mov_b32 v36, 0
    v_mov_b32 v37, 0
    v_mov_b32 v38, 0
    v_mov_b32 v39, 0
    s_waitcnt lgkmcnt(0)
    buffer_load_dwordx4 v[48:51], v0, s[4:7], s23 offen offset:0 sc1
    buffer_load_dwordx4 v[52:55], v0, s[4:7], s23 offen offset:1024 sc1
    buffer_load_dwordx4 v[56:59], v0, s[4:7], s23 offen offset:2048 sc1
    buffer_load_dwordx4 v[60:63], v0, s[4:7], s23 offen offset:3072 sc1
    s_sleep 2
    buffer_load_dwordx4 v[64:67], v0, s[4:7], s24 offen offset:0 sc1
    buffer_load_dwordx4 v[68:71], v0, s[4:7], s24 offen offset:1024 sc1
    s_waitcnt vmcnt(5)
    v_mfma_f32_16x16x32_bf16 v[12:15], v[96:99], v[48:51], 0
    v_mfma_f32_16x16x32_bf16 v[16:19], v[112:115], v[48:51], 0
    v_max_u32 v3, v48, v50
    v_cmp_eq_u32 vcc, -1, v3
    v_mfma_f32_16x16x32_bf16 v[20:23], v[48:51], v[48:51], 0
    s_cbranch_vccnz aloopH_42_rq_0
    s_waitcnt vmcnt(4)
    v_mfma_f32_16x16x32_bf16 v[12:15], v[100:103], v[52:55], v[12:15]
    v_mfma_f32_16x16x32_bf16 v[16:19], v[116:119], v[52:55], v[16:19]
    v_max_u32 v3, v52, v54
    v_cmp_eq_u32 vcc, -1, v3
    v_mfma_f32_16x16x32_bf16 v[20:23], v[52:55], v[52:55], v[20:23]
    s_cbranch_vccnz aloopH_42_rq_1
    s_waitcnt vmcnt(3)
    v_mfma_f32_16x16x32_bf16 v[12:15], v[104:107], v[56:59], v[12:15]
    v_mfma_f32_16x16x32_bf16 v[16:19], v[120:123], v[56:59], v[16:19]
    v_max_u32 v3, v56, v58
    v_cmp_eq_u32 vcc, -1, v3
    v_mfma_f32_16x16x32_bf16 v[20:23], v[56:59], v[56:59], v[20:23]
    s_cbranch_vccnz aloopH_42_rq_2
    s_waitcnt vmcnt(2)
    v_mfma_f32_16x16x32_bf16 v[12:15], v[108:111], v[60:63], v[12:15]
    v_mfma_f32_16x16x32_bf16 v[16:19], v[124:127], v[60:63], v[16:19]
    v_max_u32 v3, v60, v62
    v_cmp_eq_u32 vcc, -1, v3
    v_mfma_f32_16x16x32_bf16 v[20:23], v[60:63], v[60:63], v[20:23]
    s_cbranch_vccnz aloopH_42_rq_3
aloopH_42_sdone:
    s_cmp_eq_u32 s16, 63
    s_cbranch_scc1 aloopH_42_lsk
    ds_write_b32 v164, v165
    s_nop 0
    v_max3_f32 v2, v12, v13, v14
    v_max3_f32 v3, v15, v16, v17
    v_max3_f32 v2, v2, v18, v19
    v_max3_f32 v3, v3, v20, v21
    v_max_f32 v2, v2, v3
    v_mov_b32 v3, v2
    s_nop 1
    v_permlane16_swap_b32 v3, v2
    v_max_f32 v2, v2, v3
    v_mov_b32 v3, v2
    s_waitcnt vmcnt(0)
    v_max3_u32 v188, v64, v66, v68
    v_permlane32_swap_b32 v3, v2
    v_max_f32 v2, v2, v3
    v_max_u32 v188, v188, v70
    v_mul_f32 v2, s29, v2
    v_cmp_eq_u32 vcc, -1, v188
    v_fma_f32 v12, v12, s29, -v2
    v_fma_f32 v13, v13, s29, -v2
    s_cbranch_vccnz aloopH_42_rq_v
aloopH_42_vok:
    v_smfmac_f32_16x16x64_bf16 v[24:27], v[64:67], v[192:199], v166
    v_fma_f32 v14, v14, s29, -v2
    v_exp_f32 v12, v12
    v_smfmac_f32_16x16x64_bf16 v[32:35], v[64:67], v[224:231], v166
    v_fma_f32 v15, v15, s29, -v2
    v_exp_f32 v13, v13
    v_smfmac_f32_16x16x64_bf16 v[28:31], v[64:67], v[208:215], v166
    v_fma_f32 v16, v16, s29, -v2
    v_exp_f32 v14, v14
    v_smfmac_f32_16x16x64_bf16 v[36:39], v[64:67], v[240:247], v166
    v_fma_f32 v17, v17, s29, -v2
    v_exp_f32 v15, v15
    v_smfmac_f32_16x16x64_bf16 v[24:27], v[68:71], v[200:207], v166
    v_fma_f32 v18, v18, s29, -v2
    v_exp_f32 v16, v16
    v_smfmac_f32_16x16x64_bf16 v[32:35], v[68:71], v[232:239], v166
    v_fma_f32 v19, v19, s29, -v2
    v_exp_f32 v17, v17
    v_smfmac_f32_16x16x64_bf16 v[28:31], v[68:71], v[216:223], v166
    v_fma_f32 v20, v20, s29, -v2
    v_exp_f32 v18, v18
    v_smfmac_f32_16x16x64_bf16 v[36:39], v[68:71], v[248:255], v166
    v_fma_f32 v21, v21, s29, -v2
    v_exp_f32 v19, v19
    v_exp_f32 v20, v20
    v_exp_f32 v21, v21
    v_cvt_pk_bf16_f32 v12, v12, v13
    v_cvt_pk_bf16_f32 v13, v14, v15
    v_cvt_pk_bf16_f32 v14, v16, v17
    v_cvt_pk_bf16_f32 v15, v18, v19
    v_cvt_pk_bf16_f32 v20, v20, v21
    v_mov_b32 v22, 0
    v_mfma_f32_16x16x32_bf16 v[16:19], v[4:7], v[12:15], 0
    v_mov_b32 v21, v20
    v_mov_b32 v23, 0
    v_cvt_pk_bf16_f32 v40, v24, v25
    v_cvt_pk_bf16_f32 v41, v26, v27
    v_mfma_f32_16x16x32_bf16 v[16:19], v[8:11], v[20:23], v[16:19]
    v_mfma_f32_16x16x32_bf16 v[24:27], v[80:83], v[12:15], 0
    v_cvt_pk_bf16_f32 v44, v32, v33
    v_cvt_pk_bf16_f32 v45, v34, v35
    v_mfma_f32_16x16x32_bf16 v[32:35], v[88:91], v[12:15], 0
    v_cvt_pk_bf16_f32 v42, v28, v29
    v_cvt_pk_bf16_f32 v43, v30, v31
    v_mfma_f32_16x16x32_bf16 v[28:31], v[84:87], v[12:15], 0
    v_cvt_pk_bf16_f32 v46, v36, v37
    v_cvt_pk_bf16_f32 v47, v38, v39
    v_mfma_f32_16x16x32_bf16 v[36:39], v[92:95], v[12:15], 0
aloopH_42_midE:
    s_mov_b64 vcc, s[56:57]
    v_rcp_f32 v3, v16
    v_mfma_f32_16x16x32_bf16 v[24:27], v[40:43], v[20:23], v[24:27]
    v_mfma_f32_16x16x32_bf16 v[32:35], v[44:47], v[20:23], v[32:35]
    v_mfma_f32_16x16x32_bf16 v[28:31], v[42:45], v[20:23], v[28:31]
    v_mfma_f32_16x16x32_bf16 v[36:39], v[46:49], v[20:23], v[36:39]
    v_mov_b32_dpp v3, v3 quad_perm:[2,3,2,3] row_mask:0xf bank_mask:0xf
    s_nop 4
    v_cndmask_b32_dpp v24, v32, v24, vcc quad_perm:[2,3,2,3] row_mask:0xf bank_mask:0xf
    v_cndmask_b32_dpp v25, v33, v25, vcc quad_perm:[2,3,2,3] row_mask:0xf bank_mask:0xf
    v_cndmask_b32_dpp v26, v34, v26, vcc quad_perm:[2,3,2,3] row_mask:0xf bank_mask:0xf
    v_cndmask_b32_dpp v27, v35, v27, vcc quad_perm:[2,3,2,3] row_mask:0xf bank_mask:0xf
    v_cndmask_b32_dpp v28, v36, v28, vcc quad_perm:[2,3,2,3] row_mask:0xf bank_mask:0xf
    v_cndmask_b32_dpp v29, v37, v29, vcc quad_perm:[2,3,2,3] row_mask:0xf bank_mask:0xf
    v_cndmask_b32_dpp v30, v38, v30, vcc quad_perm:[2,3,2,3] row_mask:0xf bank_mask:0xf
    v_cndmask_b32_dpp v31, v39, v31, vcc quad_perm:[2,3,2,3] row_mask:0xf bank_mask:0xf
    v_mul_f32 v24, v24, v3
    v_mul_f32 v25, v25, v3
    v_mul_f32 v26, v26, v3
    v_mul_f32 v27, v27, v3
    v_mul_f32 v28, v28, v3
    v_mul_f32 v29, v29, v3
    v_mul_f32 v30, v30, v3
    v_mul_f32 v31, v31, v3
    v_cvt_pk_bf16_f32 v168, v24, v25
    v_cvt_pk_bf16_f32 v169, v26, v27
    v_cvt_pk_bf16_f32 v170, v28, v29
    v_cvt_pk_bf16_f32 v171, v30, v31
    ds_write_b128 v160, v[168:171]
    s_waitcnt lgkmcnt(0)
    s_barrier
    ds_read_b128 v[172:175], v161
    s_waitcnt lgkmcnt(0)
    v_mfma_f32_16x16x32_bf16 v[24:27], v[184:187], v[172:175], 0
    s_nop 7
    v_cvt_pk_bf16_f32 v168, v24, v25
    v_cvt_pk_bf16_f32 v169, v26, v27
    s_nop 0
    v_permlane16_swap_b32 v168, v170
    v_permlane16_swap_b32 v169, v171
    s_mov_b64 exec, 0xffff
    v_min_u32 v168, -2, v168
    buffer_store_dwordx4 v[168:171], v1, s[4:7], s25 offen sc1
    s_setprio 0
    buffer_store_dwordx4 v[176:179], v1, s[4:7], s26 offen sc1
    s_mov_b64 exec, -1
    s_branch pg_45
    s_cmp_lg_u32 s27, 0
    s_cbranch_scc1 pg_45
    s_sub_u32 s21, s16, 1
    s_cbranch_scc1 pg_45
    s_sub_u32 s17, s21, 1
    s_and_b32 s17, s17, 3
    s_cmp_ge_u32 s16, 58
    s_cselect_b32 s17, 0, s17
    s_cmp_lg_u32 s17, 0
    s_cbranch_scc1 pg_45
    v_mov_b32 v3, s21
    s_mov_b64 exec, 1
    buffer_store_dword v3, off, s[4:7], s28 sc1
    s_mov_b64 exec, -1
pg_45:
aloopH_42_lskb:
    v_mov_b32 v64, 0xff61b1e6
    ds_read_b128 v[128:131], v163 offset:16384
    ds_read_b128 v[132:135], v163 offset:17408
    ds_read_b128 v[136:139], v163 offset:18432
    ds_read_b128 v[140:143], v163 offset:19456
    ds_read_b128 v[144:147], v163 offset:20480
    ds_read_b128 v[148:151], v163 offset:21504
    ds_read_b128 v[152:155], v163 offset:22528
    ds_read_b128 v[156:159], v163 offset:23552
    s_waitcnt lgkmcnt(4)
    v_mfma_f32_16x16x32_bf16 v[12:15], v[96:99], v[128:131], 0
    v_mfma_f32_16x16x32_bf16 v[20:23], v[48:51], v[128:131], 0
    v_mfma_f32_16x16x32_bf16 v[12:15], v[100:103], v[132:135], v[12:15]
    v_mfma_f32_16x16x32_bf16 v[20:23], v[52:55], v[132:135], v[20:23]
    v_mfma_f32_16x16x32_bf16 v[12:15], v[104:107], v[136:139], v[12:15]
    v_mfma_f32_16x16x32_bf16 v[20:23], v[56:59], v[136:139], v[20:23]
    v_mfma_f32_16x16x32_bf16 v[12:15], v[108:111], v[140:143], v[12:15]
    v_mfma_f32_16x16x32_bf16 v[20:23], v[60:63], v[140:143], v[20:23]
    s_waitcnt lgkmcnt(0)
    v_mfma_f32_16x16x32_bf16 v[68:71], v[96:99], v[144:147], 0
    v_mfma_f32_16x16x32_bf16 v[72:75], v[112:115], v[144:147], 0
    v_mfma_f32_16x16x32_bf16 v[76:79], v[48:51], v[144:147], 0
    v_mfma_f32_16x16x32_bf16 v[68:71], v[100:103], v[148:151], v[68:71]
    v_mfma_f32_16x16x32_bf16 v[72:75], v[116:119], v[148:151], v[72:75]
    v_mfma_f32_16x16x32_bf16 v[76:79], v[52:55], v[148:151], v[76:79]
    v_mfma_f32_16x16x32_bf16 v[68:71], v[104:107], v[152:155], v[68:71]
    v_mfma_f32_16x16x32_bf16 v[72:75], v[120:123], v[152:155], v[72:75]
    v_mfma_f32_16x16x32_bf16 v[76:79], v[56:59], v[152:155], v[76:79]
    v_mfma_f32_16x16x32_bf16 v[68:71], v[108:111], v[156:159], v[68:71]
    v_mfma_f32_16x16x32_bf16 v[72:75], v[124:127], v[156:159], v[72:75]
    v_mfma_f32_16x16x32_bf16 v[76:79], v[60:63], v[156:159], v[76:79]
    v_cndmask_b32 v12, v12, v64, s[44:45]
    v_cndmask_b32 v13, v13, v64, s[46:47]
    v_cndmask_b32 v14, v14, v64, s[48:49]
    v_cndmask_b32 v15, v15, v64, s[50:51]
    s_add_u32 s17, s41, 20971520
    buffer_load_dwordx4 v[96:99], v0, s[4:7], s17 offen offset:0 sc1
    v_max3_f32 v2, v12, v13, v14
    buffer_load_dwordx4 v[100:103], v0, s[4:7], s17 offen offset:1024 sc1
    v_max3_f32 v3, v15, v20, v21
    buffer_load_dwordx4 v[104:107], v0, s[4:7], s17 offen offset:2048 sc1
    v_max_f32 v2, v2, v3
    buffer_load_dwordx4 v[108:111], v0, s[4:7], s17 offen offset:3072 sc1
    v_mov_b32 v3, v2
    s_add_u32 s18, s41, 21102592
    buffer_load_dwordx4 v[112:115], v0, s[4:7], s18 offen offset:0 sc1
    s_nop 1
    buffer_load_dwordx4 v[116:119], v0, s[4:7], s18 offen offset:1024 sc1
    v_permlane16_swap_b32 v3, v2
    buffer_load_dwordx4 v[120:123], v0, s[4:7], s18 offen offset:2048 sc1
    v_max_f32 v2, v2, v3
    buffer_load_dwordx4 v[124:127], v0, s[4:7], s18 offen offset:3072 sc1
    v_mov_b32 v3, v2
    s_nop 1
    v_permlane32_swap_b32 v3, v2
    v_max_f32 v2, v2, v3
    v_mul_f32 v2, s29, v2
    v_fma_f32 v12, v12, s29, -v2
    v_fma_f32 v13, v13, s29, -v2
    v_fma_f32 v14, v14, s29, -v2
    v_exp_f32 v12, v12
    v_fma_f32 v15, v15, s29, -v2
    v_exp_f32 v13, v13
    v_fma_f32 v20, v20, s29, -v2
    v_exp_f32 v14, v14
    v_fma_f32 v21, v21, s29, -v2
    v_exp_f32 v15, v15
    v_exp_f32 v20, v20
    v_exp_f32 v21, v21
    v_cvt_pk_bf16_f32 v12, v12, v13
    v_cvt_pk_bf16_f32 v13, v14, v15
    v_mov_b32 v14, 0
    v_mov_b32 v15, 0
    v_cvt_pk_bf16_f32 v20, v20, v21
    v_mov_b32 v22, 0
    v_mov_b32 v21, v20
    v_mov_b32 v23, 0
    s_nop 1
    v_cndmask_b32 v72, v72, v64, s[44:45]
    v_mfma_f32_16x16x32_bf16 v[16:19], v[4:7], v[12:15], 0
    v_cndmask_b32 v73, v73, v64, s[46:47]
    v_cndmask_b32 v74, v74, v64, s[48:49]
    v_mfma_f32_16x16x32_bf16 v[16:19], v[8:11], v[20:23], v[16:19]
    v_cndmask_b32 v75, v75, v64, s[50:51]
    v_max3_f32 v2, v68, v69, v70
    v_mfma_f32_16x16x32_bf16 v[24:27], v[80:83], v[12:15], 0
    v_max3_f32 v3, v71, v72, v73
    v_max3_f32 v2, v2, v74, v75
    v_mfma_f32_16x16x32_bf16 v[24:27], v[40:43], v[20:23], v[24:27]
    v_max3_f32 v3, v3, v76, v77
    v_max_f32 v2, v2, v3
    v_mfma_f32_16x16x32_bf16 v[28:31], v[84:87], v[12:15], 0
    v_mov_b32 v3, v2
    s_nop 1
    v_mfma_f32_16x16x32_bf16 v[28:31], v[42:45], v[20:23], v[28:31]
    v_permlane16_swap_b32 v3, v2
    v_max_f32 v2, v2, v3
    v_mfma_f32_16x16x32_bf16 v[32:35], v[88:91], v[12:15], 0
    v_mov_b32 v3, v2
    s_nop 1
    v_mfma_f32_16x16x32_bf16 v[32:35], v[44:47], v[20:23], v[32:35]
    v_permlane32_swap_b32 v3, v2
    v_max_f32 v2, v2, v3
    v_mfma_f32_16x16x32_bf16 v[36:39], v[92:95], v[12:15], 0
    v_mul_f32 v2, s29, v2
    v_fma_f32 v68, v68, s29, -v2
    v_mfma_f32_16x16x32_bf16 v[36:39], v[46:49], v[20:23], v[36:39]
    v_fma_f32 v69, v69, s29, -v2
    v_fma_f32 v70, v70, s29, -v2
    v_exp_f32 v68, v68
    v_fma_f32 v71, v71, s29, -v2
    v_exp_f32 v69, v69
    v_fma_f32 v72, v72, s29, -v2
    v_exp_f32 v70, v70
    v_fma_f32 v73, v73, s29, -v2
    v_exp_f32 v71, v71
    v_fma_f32 v74, v74, s29, -v2
    v_exp_f32 v72, v72
    v_fma_f32 v75, v75, s29, -v2
    v_exp_f32 v73, v73
    v_fma_f32 v76, v76, s29, -v2
    v_exp_f32 v74, v74
    v_fma_f32 v77, v77, s29, -v2
    v_exp_f32 v75, v75
    v_exp_f32 v76, v76
    v_exp_f32 v77, v77
    v_cvt_pk_bf16_f32 v68, v68, v69
    v_cvt_pk_bf16_f32 v69, v70, v71
    v_cvt_pk_bf16_f32 v70, v72, v73
    v_cvt_pk_bf16_f32 v71, v74, v75
    v_cvt_pk_bf16_f32 v76, v76, v77
    v_mov_b32 v78, 0
    v_mov_b32 v77, v76
    v_mov_b32 v79, 0
    v_rcp_f32 v66, v16
    s_nop 0
    v_mul_f32 v24, v24, v66
    v_mul_f32 v25, v25, v66
    v_mul_f32 v26, v26, v66
    v_mul_f32 v27, v27, v66
    v_cvt_pk_bf16_f32 v168, v24, v25
    v_cvt_pk_bf16_f32 v169, v26, v27
    v_mul_f32 v28, v28, v66
    v_mul_f32 v29, v29, v66
    v_mul_f32 v30, v30, v66
    v_mul_f32 v31, v31, v66
    v_cvt_pk_bf16_f32 v170, v28, v29
    v_cvt_pk_bf16_f32 v171, v30, v31
    v_mul_f32 v32, v32, v66
    v_mul_f32 v33, v33, v66
    v_mul_f32 v34, v34, v66
    v_mul_f32 v35, v35, v66
    v_cvt_pk_bf16_f32 v172, v32, v33
    v_cvt_pk_bf16_f32 v173, v34, v35
    v_mul_f32 v36, v36, v66
    v_mul_f32 v37, v37, v66
    v_mul_f32 v38, v38, v66
    v_mul_f32 v39, v39, v66
    v_cvt_pk_bf16_f32 v174, v36, v37
    v_cvt_pk_bf16_f32 v175, v38, v39
    ds_write_b128 v162, v[168:171] offset:0
    ds_write_b128 v162, v[172:175] offset:2048
    v_mfma_f32_16x16x32_bf16 v[72:75], v[4:7], v[68:71], 0
    v_mfma_f32_16x16x32_bf16 v[72:75], v[8:11], v[76:79], v[72:75]
    v_mfma_f32_16x16x32_bf16 v[24:27], v[80:83], v[68:71], 0
    v_mfma_f32_16x16x32_bf16 v[24:27], v[40:43], v[76:79], v[24:27]
    v_mfma_f32_16x16x32_bf16 v[28:31], v[84:87], v[68:71], 0
    v_mfma_f32_16x16x32_bf16 v[28:31], v[42:45], v[76:79], v[28:31]
    v_mfma_f32_16x16x32_bf16 v[32:35], v[88:91], v[68:71], 0
    v_mfma_f32_16x16x32_bf16 v[32:35], v[44:47], v[76:79], v[32:35]
    v_mfma_f32_16x16x32_bf16 v[36:39], v[92:95], v[68:71], 0
    v_mfma_f32_16x16x32_bf16 v[36:39], v[46:49], v[76:79], v[36:39]
    v_rcp_f32 v3, v72
    s_nop 0
    v_mul_f32 v24, v24, v3
    v_mul_f32 v25, v25, v3
    v_mul_f32 v26, v26, v3
    v_mul_f32 v27, v27, v3
    v_cvt_pk_bf16_f32 v168, v24, v25
    v_cvt_pk_bf16_f32 v169, v26, v27
    v_mul_f32 v28, v28, v3
    v_mul_f32 v29, v29, v3
    v_mul_f32 v30, v30, v3
    v_mul_f32 v31, v31, v3
    v_cvt_pk_bf16_f32 v170, v28, v29
    v_cvt_pk_bf16_f32 v171, v30, v31
    v_mul_f32 v32, v32, v3
    v_mul_f32 v33, v33, v3
    v_mul_f32 v34, v34, v3
    v_mul_f32 v35, v35, v3
    v_cvt_pk_bf16_f32 v172, v32, v33
    v_cvt_pk_bf16_f32 v173, v34, v35
    v_mul_f32 v36, v36, v3
    v_mul_f32 v37, v37, v3
    v_mul_f32 v38, v38, v3
    v_mul_f32 v39, v39, v3
    v_cvt_pk_bf16_f32 v174, v36, v37
    v_cvt_pk_bf16_f32 v175, v38, v39
    ds_write_b128 v162, v[168:171] offset:256
    ds_write_b128 v162, v[172:175] offset:2304
    v_xor_b32 v162, 0x4000, v162
    s_add_u32 s16, s16, 1
    s_cmp_le_u32 s16, 63
    s_cbranch_scc1 aloopH_42
    s_waitcnt lgkmcnt(0)
    s_barrier
    s_waitcnt vmcnt(0)
    s_branch k_end
aloopH_42_rq_0:
    s_sub_u32 s22, s22, 1
    s_cbranch_scc1 aloopH_42_rq_0_g
    buffer_load_dwordx4 v[48:51], v0, s[4:7], s23 offen offset:0 sc1
    buffer_load_dwordx4 v[52:55], v0, s[4:7], s23 offen offset:1024 sc1
    buffer_load_dwordx4 v[56:59], v0, s[4:7], s23 offen offset:2048 sc1
    buffer_load_dwordx4 v[60:63], v0, s[4:7], s23 offen offset:3072 sc1
    buffer_load_dwordx4 v[64:67], v0, s[4:7], s24 offen offset:0 sc1
    buffer_load_dwordx4 v[68:71], v0, s[4:7], s24 offen offset:1024 sc1
    s_waitcnt vmcnt(5)
    v_max_u32 v3, v48, v50
    v_cmp_eq_u32 vcc, -1, v3
    s_cbranch_vccnz aloopH_42_rq_0
    s_branch aloopH_42_again
aloopH_42_rq_0_g:
    s_mov_b32 s22, 0
    s_waitcnt vmcnt(0)
    s_branch aloopH_42_nochk
aloopH_42_rq_1:
    s_sub_u32 s22, s22, 1
    s_cbranch_scc1 aloopH_42_rq_1_g
    buffer_load_dwordx4 v[52:55], v0, s[4:7], s23 offen offset:1024 sc1
    buffer_load_dwordx4 v[56:59], v0, s[4:7], s23 offen offset:2048 sc1
    buffer_load_dwordx4 v[60:63], v0, s[4:7], s23 offen offset:3072 sc1
    buffer_load_dwordx4 v[64:67], v0, s[4:7], s24 offen offset:0 sc1
    buffer_load_dwordx4 v[68:71], v0, s[4:7], s24 offen offset:1024 sc1
    s_waitcnt vmcnt(4)
    v_max_u32 v3, v52, v54
    v_cmp_eq_u32 vcc, -1, v3
    s_cbranch_vccnz aloopH_42_rq_1
    s_branch aloopH_42_again
aloopH_42_rq_1_g:
    s_mov_b32 s22, 0
    s_waitcnt vmcnt(0)
    s_branch aloopH_42_nochk
aloopH_42_rq_2:
    s_sub_u32 s22, s22, 1
    s_cbranch_scc1 aloopH_42_rq_2_g
    buffer_load_dwordx4 v[56:59], v0, s[4:7], s23 offen offset:2048 sc1
    buffer_load_dwordx4 v[60:63], v0, s[4:7], s23 offen offset:3072 sc1
    buffer_load_dwordx4 v[64:67], v0, s[4:7], s24 offen offset:0 sc1
    buffer_load_dwordx4 v[68:71], v0, s[4:7], s24 offen offset:1024 sc1
    s_waitcnt vmcnt(3)
    v_max_u32 v3, v56, v58
    v_cmp_eq_u32 vcc, -1, v3
    s_cbranch_vccnz aloopH_42_rq_2
    s_branch aloopH_42_again
aloopH_42_rq_2_g:
    s_mov_b32 s22, 0
    s_waitcnt vmcnt(0)
    s_branch aloopH_42_nochk
aloopH_42_rq_3:
    s_sub_u32 s22, s22, 1
    s_cbranch_scc1 aloopH_42_rq_3_g
    buffer_load_dwordx4 v[60:63], v0, s[4:7], s23 offen offset:3072 sc1
    buffer_load_dwordx4 v[64:67], v0, s[4:7], s24 offen offset:0 sc1
    buffer_load_dwordx4 v[68:71], v0, s[4:7], s24 offen offset:1024 sc1
    s_waitcnt vmcnt(2)
    v_max_u32 v3, v60, v62
    v_cmp_eq_u32 vcc, -1, v3
    s_cbranch_vccnz aloopH_42_rq_3
    s_branch aloopH_42_again
aloopH_42_rq_3_g:
    s_mov_b32 s22, 0
    s_waitcnt vmcnt(0)
    s_branch aloopH_42_nochk
aloopH_42_again:
    s_waitcnt vmcnt(5)
    v_mfma_f32_16x16x32_bf16 v[12:15], v[96:99], v[48:51], 0
    v_mfma_f32_16x16x32_bf16 v[16:19], v[112:115], v[48:51], 0
    v_max_u32 v3, v48, v50
    v_cmp_eq_u32 vcc, -1, v3
    v_mfma_f32_16x16x32_bf16 v[20:23], v[48:51], v[48:51], 0
    s_cbranch_vccnz aloopH_42_rq_0
    s_waitcnt vmcnt(4)
    v_mfma_f32_16x16x32_bf16 v[12:15], v[100:103], v[52:55], v[12:15]
    v_mfma_f32_16x16x32_bf16 v[16:19], v[116:119], v[52:55], v[16:19]
    v_max_u32 v3, v52, v54
    v_cmp_eq_u32 vcc, -1, v3
    v_mfma_f32_16x16x32_bf16 v[20:23], v[52:55], v[52:55], v[20:23]
    s_cbranch_vccnz aloopH_42_rq_1
    s_waitcnt vmcnt(3)
    v_mfma_f32_16x16x32_bf16 v[12:15], v[104:107], v[56:59], v[12:15]
    v_mfma_f32_16x16x32_bf16 v[16:19], v[120:123], v[56:59], v[16:19]
    v_max_u32 v3, v56, v58
    v_cmp_eq_u32 vcc, -1, v3
    v_mfma_f32_16x16x32_bf16 v[20:23], v[56:59], v[56:59], v[20:23]
    s_cbranch_vccnz aloopH_42_rq_2
    s_waitcnt vmcnt(2)
    v_mfma_f32_16x16x32_bf16 v[12:15], v[108:111], v[60:63], v[12:15]
    v_mfma_f32_16x16x32_bf16 v[16:19], v[124:127], v[60:63], v[16:19]
    v_max_u32 v3, v60, v62
    v_cmp_eq_u32 vcc, -1, v3
    v_mfma_f32_16x16x32_bf16 v[20:23], v[60:63], v[60:63], v[20:23]
    s_cbranch_vccnz aloopH_42_rq_3
    s_branch aloopH_42_sdone
aloopH_42_rq_v:
    s_sub_u32 s22, s22, 1
    s_cbranch_scc1 aloopH_42_rq_vg
    buffer_load_dwordx4 v[64:67], v0, s[4:7], s24 offen offset:0 sc1
    buffer_load_dwordx4 v[68:71], v0, s[4:7], s24 offen offset:1024 sc1
    s_waitcnt vmcnt(0)
    v_max3_u32 v188, v64, v66, v68
    v_max_u32 v188, v188, v70
    v_cmp_eq_u32 vcc, -1, v188
    s_cbranch_vccnz aloopH_42_rq_v
    s_branch aloopH_42_vok
aloopH_42_rq_vg:
    s_mov_b32 s22, 0
    s_branch aloopH_42_vok
aloopH_42_nochk:
    v_mfma_f32_16x16x32_bf16 v[12:15], v[96:99], v[48:51], 0
    v_mfma_f32_16x16x32_bf16 v[16:19], v[112:115], v[48:51], 0
    v_mfma_f32_16x16x32_bf16 v[20:23], v[48:51], v[48:51], 0
    v_mfma_f32_16x16x32_bf16 v[12:15], v[100:103], v[52:55], v[12:15]
    v_mfma_f32_16x16x32_bf16 v[16:19], v[116:119], v[52:55], v[16:19]
    v_mfma_f32_16x16x32_bf16 v[20:23], v[52:55], v[52:55], v[20:23]
    v_mfma_f32_16x16x32_bf16 v[12:15], v[104:107], v[56:59], v[12:15]
    v_mfma_f32_16x16x32_bf16 v[16:19], v[120:123], v[56:59], v[16:19]
    v_mfma_f32_16x16x32_bf16 v[20:23], v[56:59], v[56:59], v[20:23]
    v_mfma_f32_16x16x32_bf16 v[12:15], v[108:111], v[60:63], v[12:15]
    v_mfma_f32_16x16x32_bf16 v[16:19], v[124:127], v[60:63], v[16:19]
    v_mfma_f32_16x16x32_bf16 v[20:23], v[60:63], v[60:63], v[20:23]
    s_nop 1
    s_branch aloopH_42_sdone
aloopH_42_rq_v2:
    s_sub_u32 s22, s22, 1
    s_cbranch_scc1 aloopH_42_rq_v2g
    buffer_load_dwordx4 v[64:67], v0, s[4:7], s24 offen offset:0 sc1
    buffer_load_dwordx4 v[68:71], v0, s[4:7], s24 offen offset:1024 sc1
    s_waitcnt vmcnt(0)
    v_max3_u32 v188, v64, v66, v68
    v_max_u32 v188, v188, v70
    v_cmp_eq_u32 vcc, -1, v188
    s_cbranch_vccnz aloopH_42_rq_v2
    s_branch aloopH_42_lsk3
aloopH_42_rq_v2g:
    s_mov_b32 s22, 0
    s_branch aloopH_42_lsk3
ct_tail:
aloopH_42_lsk:
    s_cmp_lg_u32 s27, 0
    s_cbranch_scc1 aloopH_42_lsk2
    v_mov_b32 v3, 62
    s_mov_b64 exec, 1
    buffer_store_dword v3, off, s[4:7], s28 sc1
    s_mov_b64 exec, -1
aloopH_42_lsk2:
    s_waitcnt vmcnt(0)
    v_max3_u32 v188, v64, v66, v68
    v_max_u32 v188, v188, v70
    v_cmp_eq_u32 vcc, -1, v188
    s_cbranch_vccnz aloopH_42_rq_v2
aloopH_42_lsk3:
    v_smfmac_f32_16x16x64_bf16 v[24:27], v[64:67], v[192:199], v166
    v_smfmac_f32_16x16x64_bf16 v[32:35], v[64:67], v[224:231], v166
    v_smfmac_f32_16x16x64_bf16 v[28:31], v[64:67], v[208:215], v166
    v_smfmac_f32_16x16x64_bf16 v[36:39], v[64:67], v[240:247], v166
    v_smfmac_f32_16x16x64_bf16 v[24:27], v[68:71], v[200:207], v166
    v_smfmac_f32_16x16x64_bf16 v[32:35], v[68:71], v[232:239], v166
    v_smfmac_f32_16x16x64_bf16 v[28:31], v[68:71], v[216:223], v166
    v_smfmac_f32_16x16x64_bf16 v[36:39], v[68:71], v[248:255], v166
    s_nop 7
    s_nop 1
    v_cvt_pk_bf16_f32 v40, v24, v25
    v_cvt_pk_bf16_f32 v41, v26, v27
    v_cvt_pk_bf16_f32 v42, v28, v29
    v_cvt_pk_bf16_f32 v43, v30, v31
    v_cvt_pk_bf16_f32 v44, v32, v33
    v_cvt_pk_bf16_f32 v45, v34, v35
    v_cvt_pk_bf16_f32 v46, v36, v37
    v_cvt_pk_bf16_f32 v47, v38, v39
    s_waitcnt lgkmcnt(0)
    s_branch aloopH_42_lskb
k_end:
k_exit:
    s_endpgm
.section .rodata,"a"
.p2align 6
jobtab:
    .long 4, 24, 24, 8192, 0, 262144, 8388608, 0, 32768, 4, 20971520, 131072, 0, 0, 218104321, 0
    .long 4, 24, 24, 8192, 256, 262400, 8388608, 0, 32768, 4, 20975616, 131072, 0, 0, 218104321, 0
    .long 4, 24, 24, 8192, 512, 262656, 8388608, 0, 32768, 4, 20979712, 131072, 0, 0, 218104321, 0
    .long 4, 24, 24, 8192, 768, 262912, 8388608, 0, 32768, 4, 20983808, 131072, 0, 0, 218104321, 0
    .long 4, 24, 24, 8192, 1024, 263168, 8388608, 0, 32768, 4, 20987904, 131072, 0, 0, 218104337, 0
    .long 4, 24, 24, 8192, 1280, 263424, 8388608, 0, 32768, 4, 20992000, 131072, 0, 0, 218104337, 0
    .long 4, 24, 24, 8192, 1536, 263680, 8388608, 0, 32768, 4, 20996096, 131072, 0, 0, 218104337, 0
    .long 4, 24, 24, 8192, 1792, 263936, 8388608, 0, 32768, 4, 21000192, 131072, 0, 0, 218104337, 0
    .long 4, 32, 32, 8192, 0, 262144, 8388608, 0, 32768, 4, 37748736, 131072, 0, 0, 218104321, 0
    .long 4, 32, 32, 8192, 256, 262400, 8388608, 0, 32768, 4, 37752832, 131072, 0, 0, 218104321, 0
    .long 4, 32, 32, 8192, 512, 262656, 8388608, 0, 32768, 4, 37756928, 131072, 0, 0, 218104321, 0
    .long 4, 32, 32, 8192, 768, 262912, 8388608, 0, 32768, 4, 37761024, 131072, 0, 0, 218104321, 0
    .long 4, 32, 32, 8192, 1024, 263168, 8388608, 0, 32768, 4, 37765120, 131072, 0, 0, 218104337, 0
    .long 4, 32, 32, 8192, 1280, 263424, 8388608, 0, 32768, 4, 37769216, 131072, 0, 0, 218104337, 0
    .long 4, 32, 32, 8192, 1536, 263680, 8388608, 0, 32768, 4, 37773312, 131072, 0, 0, 218104337, 0
    .long 4, 32, 32, 8192, 1792, 263936, 8388608, 0, 32768, 4, 37777408, 131072, 0, 0, 218104337, 0
    .long 4, 24, 24, 8192, 0, 262144, 8388608, 262144, 32768, 4, 22020096, 131072, 0, 0, 218104324, 0
    .long 4, 24, 24, 8192, 256, 262400, 8388608, 262144, 32768, 4, 22024192, 131072, 0, 0, 218104324, 0
    .long 4, 24, 24, 8192, 512, 262656, 8388608, 262144, 32768, 4, 22028288, 131072, 0, 0, 218104324, 0
    .long 4, 24, 24, 8192, 768, 262912, 8388608, 262144, 32768, 4, 22032384, 131072, 0, 0, 218104324, 0
    .long 4, 24, 24, 8192, 1024, 263168, 8388608, 262144, 32768, 4, 22036480, 131072, 0, 0, 218104340, 0
    .long 4, 24, 24, 8192, 1280, 263424, 8388608, 262144, 32768, 4, 22040576, 131072, 0, 0, 218104340, 0
    .long 4, 24, 24, 8192, 1536, 263680, 8388608, 262144, 32768, 4, 22044672, 131072, 0, 0, 218104340, 0
    .long 4, 24, 24, 8192, 1792, 263936, 8388608, 262144, 32768, 4, 22048768, 131072, 0, 0, 218104340, 0
    .long 4, 32, 32, 8192, 0, 262144, 8388608, 262144, 32768, 4, 38797312, 131072, 0, 0, 218104324, 0
    .long 4, 32, 32, 8192, 256, 262400, 8388608, 262144, 32768, 4, 38801408, 131072, 0, 0, 218104324, 0
    .long 4, 32, 32, 8192, 512, 262656, 8388608, 262144, 32768, 4, 38805504, 131072, 0, 0, 218104324, 0
    .long 4, 32, 32, 8192, 768, 262912, 8388608, 262144, 32768, 4, 38809600, 131072, 0, 0, 218104324, 0
    .long 4, 32, 32, 8192, 1024, 263168, 8388608, 262144, 32768, 4, 38813696, 131072, 0, 0, 218104340, 0
    .long 4, 32, 32, 8192, 1280, 263424, 8388608, 262144, 32768, 4, 38817792, 131072, 0, 0, 218104340, 0
    .long 4, 32, 32, 8192, 1536, 263680, 8388608, 262144, 32768, 4, 38821888, 131072, 0, 0, 218104340, 0
    .long 4, 32, 32, 8192, 1792, 263936, 8388608, 262144, 32768, 4, 38825984, 131072, 0, 0, 218104340, 0
    .long 4, 32, 32, 8192, 256, 262400, 8388608, 786432, 32768, 4, 40898560, 131072, 0, 0, 218104580, 0
    .long 4, 24, 24, 8192, 512, 262656, 8388608, 786432, 32768, 4, 24125440, 131072, 0, 0, 218104580, 0
    .long 4, 24, 24, 8192, 1536, 263680, 8388608, 786432, 32768, 4, 24141824, 131072, 0, 0, 218104596, 0
    .long 4, 32, 32, 8192, 768, 262912, 8388608, 524288, 32768, 4, 39858176, 131072, 0, 0, 218104577, 0
    .long 4, 32, 32, 8192, 1536, 263680, 8388608, 786432, 32768, 4, 40919040, 131072, 0, 0, 218104596, 0
    .long 4, 32, 32, 8192, 1280, 263424, 8388608, 524288, 32768, 4, 39866368, 131072, 0, 0, 218104593, 0
    .long 4, 24, 24, 8192, 1024, 263168, 8388608, 786432, 32768, 4, 24133632, 131072, 0, 0, 218104596, 0
    .long 4, 32, 32, 8192, 1792, 263936, 8388608, 524288, 32768, 4, 39874560, 131072, 0, 0, 218104593, 0
    .long 4, 32, 32, 8192, 512, 262656, 8388608, 786432, 32768, 4, 40902656, 131072, 0, 0, 218104580, 0
    .long 4, 32, 32, 8192, 512, 262656, 8388608, 524288, 32768, 4, 39854080, 131072, 0, 0, 218104577, 0
    .long 4, 32, 32, 8192, 1024, 263168, 8388608, 786432, 32768, 4, 40910848, 131072, 0, 0, 218104596, 0
    .long 4, 24, 24, 8192, 768, 262912, 8388608, 524288, 32768, 4, 23080960, 131072, 0, 0, 218104577, 0
    .long 2, 64, 72, 7168, 0, 0, 7340032, 1048576, 32768, 8, 58195968, 114688, 0, 0, 218103937, 0
    .long 4, 24, 24, 8192, 256, 262400, 8388608, 786432, 32768, 4, 24121344, 131072, 0, 0, 218104580, 0
    .long 4, 24, 24, 8192, 1280, 263424, 8388608, 524288, 32768, 4, 23089152, 131072, 0, 0, 218104593, 0
    .long 4, 32, 32, 8192, 256, 262400, 8388608, 524288, 32768, 4, 39849984, 131072, 0, 0, 218104577, 0
    .long 4, 32, 32, 8192, 1792, 263936, 8388608, 786432, 32768, 4, 40923136, 131072, 0, 0, 218104596, 0
    .long 4, 24, 24, 8192, 0, 262144, 8388608, 524288, 32768, 4, 23068672, 131072, 0, 0, 218104577, 0
    .long 4, 24, 24, 8192, 1536, 263680, 8388608, 524288, 32768, 4, 23093248, 131072, 0, 0, 218104593, 0
    .long 4, 32, 32, 8192, 0, 262144, 8388608, 524288, 32768, 4, 39845888, 131072, 0, 0, 218104577, 0
    .long 4, 24, 24, 8192, 1792, 263936, 8388608, 524288, 32768, 4, 23097344, 131072, 0, 0, 218104593, 0
    .long 4, 32, 32, 8192, 0, 262144, 8388608, 786432, 32768, 4, 40894464, 131072, 0, 0, 218104580, 0
    .long 4, 24, 24, 8192, 768, 262912, 8388608, 786432, 32768, 4, 24129536, 131072, 0, 0, 218104580, 0
    .long 4, 32, 32, 8192, 768, 262912, 8388608, 786432, 32768, 4, 40906752, 131072, 0, 0, 218104580, 0
    .long 4, 32, 32, 8192, 1536, 263680, 8388608, 524288, 32768, 4, 39870464, 131072, 0, 0, 218104593, 0
    .long 4, 24, 24, 8192, 1024, 263168, 8388608, 524288, 32768, 4, 23085056, 131072, 0, 0, 218104593, 0
    .long 4, 32, 32, 8192, 1280, 263424, 8388608, 786432, 32768, 4, 40914944, 131072, 0, 0, 218104596, 0
    .long 4, 24, 24, 8192, 256, 262400, 8388608, 524288, 32768, 4, 23072768, 131072, 0, 0, 218104577, 0
    .long 4, 32, 32, 8192, 1024, 263168, 8388608, 524288, 32768, 4, 39862272, 131072, 0, 0, 218104593, 0
    .long 4, 24, 24, 8192, 512, 262656, 8388608, 524288, 32768, 4, 23076864, 131072, 0, 0, 218104577, 0
    .long 4, 24, 24, 8192, 1280, 263424, 8388608, 786432, 32768, 4, 24137728, 131072, 0, 0, 218104596, 0
    .long 4, 24, 24, 8192, 0, 262144, 8388608, 786432, 32768, 4, 24117248, 131072, 0, 0, 218104580, 0
    .long 1, 32, 32, 8192, 1024, 1280, 8388608, 1048576, 32768, 8, 41959424, 131072, 0, 0, 218104858, 0
    .long 1, 24, 24, 8192, 512, 768, 8388608, 1048576, 32768, 8, 25174016, 131072, 0, 0, 218104842, 0
    .long 1, 16, 16, 8192, 512, 768, 8388608, 1048576, 32768, 8, 8396800, 131072, 0, 0, 218104842, 0
    .long 1, 24, 24, 8192, 1024, 1280, 8388608, 1048576, 32768, 8, 25182208, 131072, 0, 0, 218104858, 0
    .long 4, 24, 24, 8192, 1792, 263936, 8388608, 786432, 32768, 4, 24145920, 131072, 0, 0, 218104596, 0
    .long 1, 16, 16, 8192, 0, 256, 8388608, 1048576, 32768, 8, 8388608, 131072, 0, 0, 218104842, 0
    .long 1, 24, 24, 8192, 512, 768, 8388608, 1572864, 32768, 8, 27271168, 131072, 0, 0, 218105098, 0
    .long 1, 32, 32, 8192, 1024, 1280, 8388608, 1572864, 32768, 8, 44056576, 131072, 0, 0, 218105114, 0
    .long 1, 24, 24, 8192, 0, 256, 8388608, 1048576, 32768, 8, 25165824, 131072, 0, 0, 218104842, 0
    .long 1, 32, 32, 8192, 512, 768, 8388608, 1048576, 32768, 8, 41951232, 131072, 0, 0, 218104842, 0
    .long 1, 16, 16, 8192, 1536, 1792, 8388608, 1572864, 32768, 8, 10510336, 131072, 0, 0, 218105114, 0
    .long 1, 16, 16, 8192, 0, 256, 8388608, 0, 32768, 8, 4194304, 131072, 0, 0, 218107914, 0
    .long 1, 24, 24, 8192, 1024, 1280, 8388608, 1572864, 32768, 8, 27279360, 131072, 0, 0, 218105114, 0
    .long 1, 32, 32, 8192, 1536, 1792, 8388608, 1572864, 32768, 8, 44064768, 131072, 0, 0, 218105114, 0
    .long 1, 32, 32, 8192, 0, 256, 8388608, 1048576, 32768, 8, 41943040, 131072, 0, 0, 218104842, 0
    .long 1, 16, 16, 8192, 1024, 1280, 8388608, 1572864, 32768, 8, 10502144, 131072, 0, 0, 218105114, 0
    .long 1, 32, 32, 8192, 1536, 1792, 8388608, 1048576, 32768, 8, 41967616, 131072, 0, 0, 218104858, 0
    .long 1, 24, 24, 8192, 1536, 1792, 8388608, 1572864, 32768, 8, 27287552, 131072, 0, 0, 218105114, 0
    .long 1, 16, 16, 8192, 1536, 1792, 8388608, 1048576, 32768, 8, 8413184, 131072, 0, 0, 218104858, 0
    .long 1, 32, 32, 8192, 0, 256, 8388608, 1572864, 32768, 8, 44040192, 131072, 0, 0, 218105098, 0
    .long 1, 16, 16, 8192, 1536, 1792, 8388608, 0, 32768, 8, 4218880, 131072, 0, 0, 218107930, 0
    .long 1, 16, 16, 8192, 512, 768, 8388608, 2097152, 32768, 8, 12591104, 131072, 0, 0, 218105354, 0
    .long 1, 16, 16, 8192, 1024, 1280, 8388608, 1048576, 32768, 8, 8404992, 131072, 0, 0, 218104858, 0
    .long 1, 16, 16, 8192, 0, 256, 8388608, 1572864, 32768, 8, 10485760, 131072, 0, 0, 218105098, 0
    .long 1, 32, 32, 8192, 0, 256, 8388608, 2097152, 32768, 8, 46137344, 131072, 0, 0, 218105354, 0
    .long 1, 16, 16, 8192, 512, 768, 8388608, 0, 32768, 8, 4202496, 131072, 0, 0, 218107914, 0
    .long 1, 24, 24, 8192, 1536, 1792, 8388608, 1048576, 32768, 8, 25190400, 131072, 0, 0, 218104858, 0
    .long 1, 16, 16, 8192, 512, 768, 8388608, 1572864, 32768, 8, 10493952, 131072, 0, 0, 218105098, 0
    .long 1, 16, 16, 8192, 1024, 1280, 8388608, 0, 32768, 8, 4210688, 131072, 0, 0, 218107930, 0
    .long 1, 32, 32, 8192, 512, 768, 8388608, 2097152, 32768, 8, 46145536, 131072, 0, 0, 218105354, 0
    .long 1, 32, 32, 8192, 512, 768, 8388608, 1572864, 32768, 8, 44048384, 131072, 0, 0, 218105098, 0
    .long 1, 24, 24, 8192, 0, 256, 8388608, 1572864, 32768, 8, 27262976, 131072, 0, 0, 218105098, 0
    .long 1, 16, 16, 8192, 0, 256, 8388608, 524288, 32768, 8, 6291456, 131072, 0, 0, 218108170, 0
    .long 1, 32, 32, 8192, 1024, 1280, 8388608, 3670016, 32768, 8, 52445184, 131072, 0, 0, 218106138, 0
    .long 1, 16, 16, 8192, 1024, 1280, 8388608, 2621440, 32768, 8, 14696448, 131072, 0, 0, 218105626, 0
    .long 1, 24, 24, 8192, 512, 768, 8388608, 3145728, 32768, 8, 33562624, 131072, 0, 0, 218105866, 0
    .long 1, 16, 16, 8192, 0, 256, 8388608, 2621440, 32768, 8, 14680064, 131072, 0, 0, 218105610, 0
    .long 1, 32, 32, 8192, 1536, 1792, 8388608, 3670016, 32768, 8, 52453376, 131072, 0, 0, 218106138, 0
    .long 1, 16, 16, 8192, 0, 256, 8388608, 3145728, 32768, 8, 16777216, 131072, 0, 0, 218105866, 0
    .long 1, 24, 24, 8192, 1024, 1280, 8388608, 2097152, 32768, 8, 29376512, 131072, 0, 0, 218105370, 0
    .long 1, 16, 16, 8192, 1536, 1792, 8388608, 2097152, 32768, 8, 12607488, 131072, 0, 0, 218105370, 0
    .long 1, 24, 24, 8192, 512, 768, 8388608, 3670016, 32768, 8, 35659776, 131072, 0, 0, 218106122, 0
    .long 1, 24, 24, 8192, 1536, 1792, 8388608, 3145728, 32768, 8, 33579008, 131072, 0, 0, 218105882, 0
    .long 1, 32, 32, 8192, 1536, 1792, 8388608, 2621440, 32768, 8, 48259072, 131072, 0, 0, 218105626, 0
    .long 1, 32, 32, 8192, 1536, 1792, 8388608, 2097152, 32768, 8, 46161920, 131072, 0, 0, 218105370, 0
    .long 1, 24, 24, 8192, 1536, 1792, 8388608, 2097152, 32768, 8, 29384704, 131072, 0, 0, 218105370, 0
    .long 1, 24, 24, 8192, 0, 256, 8388608, 2097152, 32768, 8, 29360128, 131072, 0, 0, 218105354, 0
    .long 1, 32, 32, 8192, 1536, 1792, 8388608, 3145728, 32768, 8, 50356224, 131072, 0, 0, 218105882, 0
    .long 1, 32, 32, 8192, 0, 256, 8388608, 3145728, 32768, 8, 50331648, 131072, 0, 0, 218105866, 0
    .long 1, 16, 16, 8192, 1024, 1280, 8388608, 3145728, 32768, 8, 16793600, 131072, 0, 0, 218105882, 0
    .long 1, 16, 16, 8192, 1024, 1280, 8388608, 2097152, 32768, 8, 12599296, 131072, 0, 0, 218105370, 0
    .long 5, 218107920, 0, 0, 4, 0, 0, 0, 0, 0, 0, 0, 218112000, 4, 218106881, 0
    .long 1, 32, 32, 8192, 1024, 1280, 8388608, 3145728, 32768, 8, 50348032, 131072, 0, 0, 218105882, 0
    .long 1, 24, 24, 8192, 1536, 1792, 8388608, 3670016, 32768, 8, 35676160, 131072, 0, 0, 218106138, 0
    .long 1, 32, 32, 8192, 0, 256, 8388608, 2621440, 32768, 8, 48234496, 131072, 0, 0, 218105610, 0
    .long 1, 32, 32, 8192, 1024, 1280, 8388608, 2097152, 32768, 8, 46153728, 131072, 0, 0, 218105370, 0
    .long 1, 24, 24, 8192, 512, 768, 8388608, 2621440, 32768, 8, 31465472, 131072, 0, 0, 218105610, 0
    .long 1, 24, 24, 8192, 512, 768, 8388608, 2097152, 32768, 8, 29368320, 131072, 0, 0, 218105354, 0
    .long 1, 16, 16, 8192, 1536, 1792, 8388608, 524288, 32768, 8, 6316032, 131072, 0, 0, 218108186, 0
    .long 1, 32, 32, 8192, 1024, 1280, 8388608, 2621440, 32768, 8, 48250880, 131072, 0, 0, 218105626, 0
    .long 1, 16, 16, 8192, 1024, 1280, 8388608, 524288, 32768, 8, 6307840, 131072, 0, 0, 218108186, 0
    .long 1, 24, 24, 8192, 0, 256, 8388608, 2621440, 32768, 8, 31457280, 131072, 0, 0, 218105610, 0
    .long 1, 16, 16, 8192, 0, 256, 8388608, 2097152, 32768, 8, 12582912, 131072, 0, 0, 218105354, 0
    .long 5, 218107920, 0, 0, 4, 0, 0, 4, 0, 0, 0, 0, 218112000, 8, 218106881, 0
    .long 5, 218107904, 0, 0, 0, 0, 0, 0, 0, 0, 0, 0, 218112000, 4, 218106881, 0
    .long 1, 24, 24, 8192, 1024, 1280, 8388608, 3670016, 32768, 8, 35667968, 131072, 0, 0, 218106138, 0
    .long 2, 64, 72, 7168, 0, 0, 7340032, 2097152, 32768, 8, 61865984, 114688, 0, 0, 218104065, 0
    .long 1, 24, 24, 8192, 1536, 1792, 8388608, 2621440, 32768, 8, 31481856, 131072, 0, 0, 218105626, 0
    .long 2, 64, 72, 7168, 256, 256, 7340032, 0, 32768, 8, 54530048, 114688, 0, 0, 218103809, 0
    .long 1, 24, 24, 8192, 0, 256, 8388608, 3670016, 32768, 8, 35651584, 131072, 0, 0, 218106122, 0
    .long 1, 32, 32, 8192, 512, 768, 8388608, 3670016, 32768, 8, 52436992, 131072, 0, 0, 218106122, 0
    .long 2, 64, 72, 7168, 1024, 1024, 7340032, 2621440, 32768, 8, 63717376, 114688, 0, 0, 218104129, 0
    .long 1, 32, 32, 8192, 512, 768, 8388608, 2621440, 32768, 8, 48242688, 131072, 0, 0, 218105610, 0
    .long 1, 16, 16, 8192, 512, 768, 8388608, 2621440, 32768, 8, 14688256, 131072, 0, 0, 218105610, 0
    .long 2, 64, 72, 7168, 0, 0, 7340032, 0, 32768, 8, 54525952, 114688, 0, 0, 218103809, 0
    .long 1, 16, 16, 8192, 1536, 1792, 8388608, 3145728, 32768, 8, 16801792, 131072, 0, 0, 218105882, 0
    .long 1, 24, 24, 8192, 1024, 1280, 8388608, 2621440, 32768, 8, 31473664, 131072, 0, 0, 218105626, 0
    .long 2, 64, 72, 7168, 256, 256, 7340032, 524288, 32768, 8, 56365056, 114688, 0, 0, 218103873, 0
    .long 1, 24, 24, 8192, 0, 256, 8388608, 3145728, 32768, 8, 33554432, 131072, 0, 0, 218105866, 0
    .long 2, 64, 72, 7168, 768, 768, 7340032, 0, 32768, 8, 54538240, 114688, 0, 0, 218103809, 0
    .long 2, 64, 72, 7168, 768, 768, 7340032, 524288, 32768, 8, 56373248, 114688, 0, 0, 218103873, 0
    .long 2, 64, 72, 7168, 512, 512, 7340032, 2097152, 32768, 8, 61874176, 114688, 0, 0, 218104065, 0
    .long 2, 64, 72, 7168, 1024, 1024, 7340032, 2097152, 32768, 8, 61882368, 114688, 0, 0, 218104065, 0
    .long 1, 16, 16, 8192, 512, 768, 8388608, 524288, 32768, 8, 6299648, 131072, 0, 0, 218108170, 0
    .long 1, 16, 16, 8192, 512, 768, 8388608, 3145728, 32768, 8, 16785408, 131072, 0, 0, 218105866, 0
    .long 2, 64, 72, 7168, 1024, 1024, 7340032, 0, 32768, 8, 54542336, 114688, 0, 0, 218103809, 0
    .long 2, 64, 72, 7168, 1280, 1280, 7340032, 0, 32768, 8, 54546432, 114688, 0, 0, 218103809, 0
    .long 1, 16, 16, 8192, 1536, 1792, 8388608, 2621440, 32768, 8, 14704640, 131072, 0, 0, 218105626, 0
    .long 1, 24, 24, 8192, 1024, 1280, 8388608, 3145728, 32768, 8, 33570816, 131072, 0, 0, 218105882, 0
    .long 2, 64, 72, 7168, 1280, 1280, 7340032, 3145728, 32768, 8, 65556480, 114688, 0, 0, 218104193, 0
    .long 1, 32, 32, 8192, 512, 768, 8388608, 3145728, 32768, 8, 50339840, 131072, 0, 0, 218105866, 0
    .long 1, 16, 16, 8192, 1536, 1792, 8388608, 3670016, 32768, 8, 18898944, 131072, 0, 0, 218106138, 0
    .long 2, 64, 72, 7168, 1536, 1536, 7340032, 0, 32768, 8, 54550528, 114688, 0, 0, 218103809, 0
    .long 2, 64, 72, 7168, 512, 512, 7340032, 0, 32768, 8, 54534144, 114688, 0, 0, 218103809, 0
    .long 5, 218107904, 0, 0, 0, 0, 0, 4, 0, 0, 0, 0, 218112000, 8, 218106881, 0
    .long 2, 64, 72, 7168, 1536, 1536, 7340032, 3145728, 32768, 8, 65560576, 114688, 0, 0, 218104193, 0
    .long 2, 64, 72, 7168, 0, 0, 7340032, 524288, 32768, 8, 56360960, 114688, 0, 0, 218103873, 0
    .long 2, 64, 72, 7168, 1280, 1280, 7340032, 1572864, 32768, 8, 60051456, 114688, 0, 0, 218104001, 0
    .long 2, 64, 72, 7168, 1536, 1536, 7340032, 524288, 32768, 8, 56385536, 114688, 0, 0, 218103873, 0
    .long 1, 16, 16, 8192, 0, 256, 8388608, 3670016, 32768, 8, 18874368, 131072, 0, 0, 218106122, 0
    .long 5, 218108176, 0, 0, 4, 0, 0, 8, 0, 0, 0, 0, 218112000, 12, 218106945, 0
    .long 2, 64, 72, 7168, 0, 0, 7340032, 3145728, 32768, 8, 65536000, 114688, 0, 0, 218104193, 0
    .long 2, 64, 72, 7168, 512, 512, 7340032, 1572864, 32768, 8, 60039168, 114688, 0, 0, 218104001, 0
    .long 2, 64, 72, 7168, 768, 768, 7340032, 2097152, 32768, 8, 61878272, 114688, 0, 0, 218104065, 0
    .long 2, 64, 72, 7168, 0, 0, 7340032, 1572864, 32768, 8, 60030976, 114688, 0, 0, 218104001, 0
    .long 2, 64, 72, 7168, 768, 768, 7340032, 1572864, 32768, 8, 60043264, 114688, 0, 0, 218104001, 0
    .long 2, 64, 72, 7168, 1536, 1536, 7340032, 1572864, 32768, 8, 60055552, 114688, 0, 0, 218104001, 0
    .long 2, 64, 72, 7168, 256, 256, 7340032, 1572864, 32768, 8, 60035072, 114688, 0, 0, 218104001, 0
    .long 2, 64, 72, 7168, 256, 256, 7340032, 2097152, 32768, 8, 61870080, 114688, 0, 0, 218104065, 0
    .long 2, 64, 72, 7168, 1280, 1280, 7340032, 2097152, 32768, 8, 61886464, 114688, 0, 0, 218104065, 0
    .long 2, 64, 72, 7168, 512, 512, 7340032, 524288, 32768, 8, 56369152, 114688, 0, 0, 218103873, 0
    .long 2, 64, 72, 7168, 1536, 1536, 7340032, 2097152, 32768, 8, 61890560, 114688, 0, 0, 218104065, 0
    .long 2, 64, 72, 7168, 1024, 1024, 7340032, 1572864, 32768, 8, 60047360, 114688, 0, 0, 218104001, 0
    .long 2, 64, 72, 7168, 256, 256, 7340032, 1048576, 32768, 8, 58200064, 114688, 0, 0, 218103937, 0
    .long 2, 64, 72, 7168, 1024, 1024, 7340032, 1048576, 32768, 8, 58212352, 114688, 0, 0, 218103937, 0
    .long 2, 64, 72, 7168, 512, 512, 7340032, 3145728, 32768, 8, 65544192, 114688, 0, 0, 218104193, 0
    .long 2, 64, 72, 7168, 1280, 1280, 7340032, 1048576, 32768, 8, 58216448, 114688, 0, 0, 218103937, 0
    .long 5, 218108176, 0, 0, 4, 0, 0, 12, 0, 0, 0, 0, 218112000, 16, 218106945, 0
    .long 2, 64, 72, 7168, 1536, 1536, 7340032, 1048576, 32768, 8, 58220544, 114688, 0, 0, 218103937, 0
    .long 2, 64, 72, 7168, 1024, 1024, 7340032, 3145728, 32768, 8, 65552384, 114688, 0, 0, 218104193, 0
    .long 2, 64, 72, 7168, 1280, 1280, 7340032, 524288, 32768, 8, 56381440, 114688, 0, 0, 218103873, 0
    .long 2, 64, 72, 7168, 768, 768, 7340032, 1048576, 32768, 8, 58208256, 114688, 0, 0, 218103937, 0
    .long 2, 64, 72, 7168, 512, 512, 7340032, 1048576, 32768, 8, 58204160, 114688, 0, 0, 218103937, 0
    .long 2, 64, 72, 7168, 256, 256, 7340032, 3145728, 32768, 8, 65540096, 114688, 0, 0, 218104193, 0
    .long 5, 218108160, 0, 0, 0, 0, 0, 12, 0, 0, 0, 0, 218112000, 16, 218106945, 0
    .long 2, 64, 72, 7168, 768, 768, 7340032, 3670016, 32768, 8, 67383296, 114688, 0, 0, 218104257, 0
    .long 2, 64, 72, 7168, 1024, 1024, 7340032, 524288, 32768, 8, 56377344, 114688, 0, 0, 218103873, 0
    .long 1, 80, 80, 2048, 512, 768, 7340032, 54525952, 114688, 14, 117448704, 32768, 218103808, 14, 218106370, 0
    .long 1, 40, 40, 2048, 0, 256, 8388608, 176160768, 131072, 16, 75497472, 32768, 218106880, 8, 218106376, 0
    .long 5, 218108160, 0, 0, 0, 0, 0, 8, 0, 0, 0, 0, 218112000, 12, 218106945, 0
    .long 1, 32, 32, 8192, 0, 256, 8388608, 3670016, 32768, 8, 52428800, 131072, 0, 0, 218106122, 0
    .long 1, 16, 16, 8192, 512, 768, 8388608, 3670016, 32768, 8, 18882560, 131072, 0, 0, 218106122, 0
    .long 1, 16, 16, 8192, 1024, 1280, 8388608, 3670016, 32768, 8, 18890752, 131072, 0, 0, 218106138, 0
    .long 1, 40, 40, 2048, 512, 768, 8388608, 182452224, 131072, 16, 77078528, 32768, 218112000, 33, 218106568, 0
    .long 1, 40, 40, 2048, 512, 768, 8388608, 176160768, 131072, 16, 75505664, 32768, 218106880, 8, 218106376, 0
    .long 2, 64, 72, 7168, 768, 768, 7340032, 3145728, 32768, 8, 65548288, 114688, 0, 0, 218104193, 0
    .long 1, 40, 40, 2048, 0, 256, 8388608, 180355072, 131072, 16, 76546048, 32768, 218112000, 25, 218106504, 0
    .long 1, 40, 40, 2048, 512, 768, 8388608, 180355072, 131072, 16, 76554240, 32768, 218112000, 25, 218106504, 0
    .long 2, 64, 72, 7168, 1280, 1280, 7340032, 2621440, 32768, 8, 63721472, 114688, 0, 0, 218104129, 0
    .long 1, 40, 40, 2048, 0, 256, 8388608, 182452224, 131072, 16, 77070336, 32768, 218112000, 33, 218106568, 0
    .long 2, 64, 72, 7168, 0, 0, 7340032, 2621440, 32768, 8, 63700992, 114688, 0, 0, 218104129, 0
    .long 1, 80, 80, 2048, 0, 256, 7340032, 54525952, 114688, 14, 117440512, 32768, 218103808, 14, 218106370, 0
    .long 2, 64, 72, 7168, 1536, 1536, 7340032, 2621440, 32768, 8, 63725568, 114688, 0, 0, 218104129, 0
    .long 2, 64, 72, 7168, 256, 256, 7340032, 2621440, 32768, 8, 63705088, 114688, 0, 0, 218104129, 0
    .long 2, 64, 72, 7168, 512, 512, 7340032, 3670016, 32768, 8, 67379200, 114688, 0, 0, 218104257, 0
    .long 2, 64, 72, 7168, 1280, 1280, 7340032, 3670016, 32768, 8, 67391488, 114688, 0, 0, 218104257, 0
    .long 1, 40, 40, 2048, 0, 256, 8388608, 178257920, 131072, 16, 76021760, 32768, 218106944, 8, 218106440, 0
    .long 1, 40, 40, 2048, 512, 768, 8388608, 178257920, 131072, 16, 76029952, 32768, 218106944, 8, 218106440, 0
    .long 2, 64, 72, 7168, 768, 768, 7340032, 2621440, 32768, 8, 63713280, 114688, 0, 0, 218104129, 0
    .long 2, 64, 72, 7168, 0, 0, 7340032, 3670016, 32768, 8, 67371008, 114688, 0, 0, 218104257, 0
    .long 2, 64, 72, 7168, 512, 512, 7340032, 2621440, 32768, 8, 63709184, 114688, 0, 0, 218104129, 0
    .long 1, 80, 80, 2048, 512, 768, 7340032, 61865984, 114688, 14, 119545856, 32768, 218104064, 14, 218106626, 0
    .long 1, 80, 80, 2048, 0, 256, 7340032, 60030976, 114688, 14, 119013376, 32768, 218104000, 14, 218106562, 0
    .long 1, 80, 80, 2048, 0, 256, 7340032, 61865984, 114688, 14, 119537664, 32768, 218104064, 14, 218106626, 0
    .long 1, 80, 80, 2048, 512, 768, 7340032, 60030976, 114688, 14, 119021568, 32768, 218104000, 14, 218106562, 0
    .long 2, 64, 72, 7168, 1024, 1024, 7340032, 3670016, 32768, 8, 67387392, 114688, 0, 0, 218104257, 0
    .long 2, 64, 72, 7168, 256, 256, 7340032, 3670016, 32768, 8, 67375104, 114688, 0, 0, 218104257, 0
    .long 1, 80, 80, 2048, 0, 256, 7340032, 58195968, 114688, 14, 118489088, 32768, 218103936, 14, 218106498, 0
    .long 1, 80, 80, 2048, 512, 768, 7340032, 58195968, 114688, 14, 118497280, 32768, 218103936, 14, 218106498, 0
    .long 2, 64, 72, 7168, 1536, 1536, 7340032, 3670016, 32768, 8, 67395584, 114688, 0, 0, 218104257, 0
    .long 1, 80, 80, 2048, 512, 768, 7340032, 56360960, 114688, 14, 117972992, 32768, 218103872, 14, 218106434, 0
    .long 1, 80, 80, 2048, 0, 256, 7340032, 56360960, 114688, 14, 117964800, 32768, 218103872, 14, 218106434, 0
    .long 1, 40, 40, 2048, 512, 768, 8388608, 184549376, 131072, 8, 77602816, 32768, 218112000, 41, 218106628, 0
    .long 1, 80, 80, 2048, 0, 256, 7340032, 65536000, 114688, 7, 120586240, 32768, 218104192, 7, 218106753, 0
    .long 1, 80, 80, 2048, 512, 768, 7340032, 65536000, 114688, 7, 120594432, 32768, 218104192, 7, 218106753, 0
    .long 1, 40, 40, 2048, 0, 256, 8388608, 184549376, 131072, 8, 77594624, 32768, 218112000, 41, 218106628, 0
    .long 1, 80, 80, 2048, 1536, 1792, 7340032, 65536000, 114688, 7, 120610816, 32768, 218104192, 7, 218106753, 0
    .long 1, 40, 40, 2048, 1024, 1280, 8388608, 184549376, 131072, 8, 77611008, 32768, 218112000, 41, 218106628, 0
    .long 1, 40, 40, 2048, 1536, 1792, 8388608, 184549376, 131072, 8, 77619200, 32768, 218112000, 41, 218106628, 0
    .long 1, 40, 40, 2048, 512, 768, 8388608, 186646528, 131072, 8, 78127104, 32768, 218112000, 49, 218106692, 0
    .long 1, 80, 80, 2048, 1024, 1280, 7340032, 65536000, 114688, 7, 120602624, 32768, 218104192, 7, 218106753, 0
    .long 1, 40, 40, 2048, 1024, 1280, 8388608, 186646528, 131072, 8, 78135296, 32768, 218112000, 49, 218106692, 0
    .long 1, 40, 40, 2048, 0, 256, 8388608, 186646528, 131072, 8, 78118912, 32768, 218112000, 49, 218106692, 0
    .long 1, 40, 40, 2048, 1536, 1792, 8388608, 186646528, 131072, 8, 78143488, 32768, 218112000, 49, 218106692, 0
    .long 1, 80, 80, 2048, 1024, 1280, 7340032, 63700992, 114688, 7, 120078336, 32768, 218104128, 7, 218106689, 0
    .long 1, 80, 80, 2048, 1536, 1792, 7340032, 63700992, 114688, 7, 120086528, 32768, 218104128, 7, 218106689, 0
    .long 1, 80, 80, 2048, 0, 256, 7340032, 63700992, 114688, 7, 120061952, 32768, 218104128, 7, 218106689, 0
    .long 1, 80, 80, 2048, 512, 768, 7340032, 63700992, 114688, 7, 120070144, 32768, 218104128, 7, 218106689, 0
    .long 1, 80, 80, 2048, 512, 768, 7340032, 67371008, 114688, 7, 121118720, 32768, 218104256, 7, 218106817, 0
    .long 1, 80, 80, 2048, 1024, 1280, 7340032, 67371008, 114688, 7, 121126912, 32768, 218104256, 7, 218106817, 0
    .long 1, 80, 80, 2048, 1536, 1792, 7340032, 67371008, 114688, 7, 121135104, 32768, 218104256, 7, 218106817, 0
    .long 1, 80, 80, 2048, 0, 256, 7340032, 67371008, 114688, 7, 121110528, 32768, 218104256, 7, 218106817, 0
    .long 6, 1, 3, 2, 0, 16, 0, 3, 0, 0, 0, 0, 0, 0, 0, 0
    .long 6, 0, 51, 0, 0, 0, 0, 51, 0, 0, 0, 0, 0, 0, 0, 0
    .long 6, 1, 1, 2, 0, 16, 0, 1, 0, 0, 0, 0, 0, 0, 0, 0
    .long 6, 1, 0, 2, 0, 16, 0, 0, 0, 0, 0, 0, 0, 0, 0, 0
    .long 6, 1, 5, 2, 0, 16, 0, 5, 0, 0, 0, 0, 0, 0, 0, 0
    .long 6, 1, 4, 2, 0, 16, 0, 4, 0, 0, 0, 0, 0, 0, 0, 0
    .long 6, 1, 22, 2, 0, 16, 0, 22, 0, 0, 0, 0, 0, 0, 0, 0
    .long 6, 1, 6, 2, 0, 16, 0, 6, 0, 0, 0, 0, 0, 0, 0, 0
    .long 6, 1, 18, 2, 0, 16, 0, 18, 0, 0, 0, 0, 0, 0, 0, 0
    .long 6, 1, 19, 2, 0, 16, 0, 19, 0, 0, 0, 0, 0, 0, 0, 0
    .long 6, 1, 20, 2, 0, 16, 0, 20, 0, 0, 0, 0, 0, 0, 0, 0
    .long 6, 1, 7, 2, 0, 16, 0, 7, 0, 0, 0, 0, 0, 0, 0, 0
    .long 6, 1, 2, 2, 0, 16, 0, 2, 0, 0, 0, 0, 0, 0, 0, 0
    .long 6, 1, 17, 2, 0, 16, 0, 17, 0, 0, 0, 0, 0, 0, 0, 0
    .long 6, 1, 21, 2, 0, 16, 0, 21, 0, 0, 0, 0, 0, 0, 0, 0
    .long 6, 1, 16, 2, 0, 16, 0, 16, 0, 0, 0, 0, 0, 0, 0, 0
    .long 6, 0, 50, 0, 0, 0, 0, 50, 0, 0, 0, 0, 0, 0, 0, 0
    .long 6, 0, 52, 0, 0, 0, 0, 52, 0, 0, 0, 0, 0, 0, 0, 0
    .long 6, 0, 54, 0, 0, 0, 0, 54, 0, 0, 0, 0, 0, 0, 0, 0
    .long 6, 0, 49, 0, 0, 0, 0, 49, 0, 0, 0, 0, 0, 0, 0, 0
    .long 6, 0, 48, 0, 0, 0, 0, 48, 0, 0, 0, 0, 0, 0, 0, 0
    .long 6, 0, 53, 0, 0, 0, 0, 53, 0, 0, 0, 0, 0, 0, 0, 0
    .long 6, 0, 55, 0, 0, 0, 0, 55, 0, 0, 0, 0, 0, 0, 0, 0
    .long 6, 0, 56, 0, 0, 0, 0, 56, 0, 0, 0, 0, 0, 0, 0, 0
    .long 6, 1, 23, 2, 0, 16, 0, 23, 0, 0, 0, 0, 0, 0, 0, 0
    .long 6, 1, 24, 2, 0, 16, 0, 24, 0, 0, 0, 0, 0, 0, 0, 0
    .long 6, 1, 25, 2, 0, 16, 0, 25, 0, 0, 0, 0, 0, 0, 0, 0
    .long 6, 1, 26, 2, 0, 16, 0, 26, 0, 0, 0, 0, 0, 0, 0, 0
    .long 6, 1, 27, 2, 0, 16, 0, 27, 0, 0, 0, 0, 0, 0, 0, 0
    .long 6, 1, 28, 2, 0, 16, 0, 28, 0, 0, 0, 0, 0, 0, 0, 0
    .long 6, 1, 29, 2, 0, 16, 0, 29, 0, 0, 0, 0, 0, 0, 0, 0
    .long 6, 1, 30, 2, 0, 16, 0, 30, 0, 0, 0, 0, 0, 0, 0, 0
    .long 6, 1, 31, 2, 0, 16, 0, 31, 0, 0, 0, 0, 0, 0, 0, 0
    .long 6, 0, 40, 1, 0, 16, 0, 40, 0, 0, 0, 0, 0, 0, 0, 0
    .long 6, 0, 41, 1, 0, 16, 0, 41, 0, 0, 0, 0, 0, 0, 0, 0
    .long 6, 0, 43, 1, 0, 16, 0, 43, 0, 0, 0, 0, 0, 0, 0, 0
    .long 6, 0, 45, 1, 0, 16, 0, 45, 0, 0, 0, 0, 0, 0, 0, 0
    .long 6, 0, 46, 1, 0, 16, 0, 46, 0, 0, 0, 0, 0, 0, 0, 0
    .long 6, 0, 47, 1, 0, 16, 0, 47, 0, 0, 0, 0, 0, 0, 0, 0
    .long 6, 1, 32, 1, 0, 16, 0, 32, 0, 0, 0, 0, 0, 0, 0, 0
    .long 6, 1, 33, 1, 0, 16, 0, 33, 0, 0, 0, 0, 0, 0, 0, 0
    .long 6, 1, 35, 1, 0, 16, 0, 35, 0, 0, 0, 0, 0, 0, 0, 0
    .long 6, 1, 36, 1, 0, 16, 0, 36, 0, 0, 0, 0, 0, 0, 0, 0
    .long 6, 1, 38, 1, 0, 16, 0, 38, 0, 0, 0, 0, 0, 0, 0, 0
    .long 6, 1, 39, 1, 0, 16, 0, 39, 0, 0, 0, 0, 0, 0, 0, 0
    .long 6, 0, 57, 0, 0, 0, 0, 57, 0, 0, 0, 0, 0, 0, 0, 0
    .long 6, 0, 44, 1, 0, 16, 0, 44, 0, 0, 0, 0, 0, 0, 0, 0
    .long 6, 1, 34, 1, 0, 16, 0, 34, 0, 0, 0, 0, 0, 0, 0, 0
    .long 6, 0, 58, 0, 0, 0, 0, 58, 0, 0, 0, 0, 0, 0, 0, 0
    .long 6, 1, 37, 1, 0, 16, 0, 37, 0, 0, 0, 0, 0, 0, 0, 0
    .long 6, 0, 42, 1, 0, 16, 0, 42, 0, 0, 0, 0, 0, 0, 0, 0
    .long 6, 0, 59, 0, 0, 0, 0, 59, 0, 0, 0, 0, 0, 0, 0, 0
    .long 6, 1, 8, 2, 0, 16, 0, 8, 0, 0, 0, 0, 0, 0, 0, 0
    .long 6, 1, 9, 2, 0, 16, 0, 9, 0, 0, 0, 0, 0, 0, 0, 0
    .long 6, 1, 10, 2, 0, 16, 0, 10, 0, 0, 0, 0, 0, 0, 0, 0
    .long 6, 1, 11, 2, 0, 16, 0, 11, 0, 0, 0, 0, 0, 0, 0, 0
    .long 6, 1, 12, 2, 0, 16, 0, 12, 0, 0, 0, 0, 0, 0, 0, 0
    .long 6, 1, 13, 2, 0, 16, 0, 13, 0, 0, 0, 0, 0, 0, 0, 0
    .long 6, 1, 14, 2, 0, 16, 0, 14, 0, 0, 0, 0, 0, 0, 0, 0
    .long 6, 1, 15, 2, 0, 16, 0, 15, 0, 0, 0, 0, 0, 0, 0, 0
    .long 7, 0, 60, 0, 0, 0, 0, 60, 0, 0, 0, 0, 0, 0, 0, 0
    .long 7, 0, 60, 0, 1, 0, 0, 60, 0, 0, 0, 0, 0, 0, 0, 0
    .long 7, 0, 60, 0, 2, 0, 0, 60, 0, 0, 0, 0, 0, 0, 0, 0
    .long 7, 0, 60, 0, 3, 0, 0, 60, 0, 0, 0, 0, 0, 0, 0, 0
    .long 7, 0, 61, 0, 0, 0, 0, 61, 0, 0, 0, 0, 0, 0, 0, 0
    .long 7, 0, 61, 0, 1, 0, 0, 61, 0, 0, 0, 0, 0, 0, 0, 0
    .long 7, 0, 61, 0, 2, 0, 0, 61, 0, 0, 0, 0, 0, 0, 0, 0
    .long 7, 0, 61, 0, 3, 0, 0, 61, 0, 0, 0, 0, 0, 0, 0, 0
    .long 7, 0, 62, 0, 0, 0, 0, 62, 0, 0, 0, 0, 0, 0, 0, 0
    .long 7, 0, 62, 0, 1, 0, 0, 62, 0, 0, 0, 0, 0, 0, 0, 0
    .long 7, 0, 62, 0, 2, 0, 0, 62, 0, 0, 0, 0, 0, 0, 0, 0
    .long 7, 0, 62, 0, 3, 0, 0, 62, 0, 0, 0, 0, 0, 0, 0, 0
    .long 7, 0, 63, 0, 0, 0, 0, 63, 0, 0, 0, 0, 0, 0, 0, 0
    .long 7, 0, 63, 0, 1, 0, 0, 63, 0, 0, 0, 0, 0, 0, 0, 0
    .long 7, 0, 63, 0, 2, 0, 0, 63, 0, 0, 0, 0, 0, 0, 0, 0
    .long 7, 0, 63, 0, 3, 0, 0, 63, 0, 0, 0, 0, 0, 0, 0, 0
    .long 0, 0, 0, 0, 0, 0, 0, 0, 0, 0, 0, 0, 0, 0, 0, 0
    .long 4, 24, 24, 8192, 2048, 264192, 8388608, 0, 32768, 4, 21004288, 131072, 0, 0, 218104353, 0
    .long 4, 24, 24, 8192, 2304, 264448, 8388608, 0, 32768, 4, 21008384, 131072, 0, 0, 218104353, 0
    .long 4, 24, 24, 8192, 2560, 264704, 8388608, 0, 32768, 4, 21012480, 131072, 0, 0, 218104353, 0
    .long 4, 24, 24, 8192, 2816, 264960, 8388608, 0, 32768, 4, 21016576, 131072, 0, 0, 218104353, 0
    .long 4, 24, 24, 8192, 3072, 265216, 8388608, 0, 32768, 4, 21020672, 131072, 0, 0, 218104369, 0
    .long 4, 24, 24, 8192, 3328, 265472, 8388608, 0, 32768, 4, 21024768, 131072, 0, 0, 218104369, 0
    .long 4, 24, 24, 8192, 3584, 265728, 8388608, 0, 32768, 4, 21028864, 131072, 0, 0, 218104369, 0
    .long 4, 24, 24, 8192, 3840, 265984, 8388608, 0, 32768, 4, 21032960, 131072, 0, 0, 218104369, 0
    .long 4, 32, 32, 8192, 2048, 264192, 8388608, 0, 32768, 4, 37781504, 131072, 0, 0, 218104353, 0
    .long 4, 32, 32, 8192, 2304, 264448, 8388608, 0, 32768, 4, 37785600, 131072, 0, 0, 218104353, 0
    .long 4, 32, 32, 8192, 2560, 264704, 8388608, 0, 32768, 4, 37789696, 131072, 0, 0, 218104353, 0
    .long 4, 32, 32, 8192, 2816, 264960, 8388608, 0, 32768, 4, 37793792, 131072, 0, 0, 218104353, 0
    .long 4, 32, 32, 8192, 3072, 265216, 8388608, 0, 32768, 4, 37797888, 131072, 0, 0, 218104369, 0
    .long 4, 32, 32, 8192, 3328, 265472, 8388608, 0, 32768, 4, 37801984, 131072, 0, 0, 218104369, 0
    .long 4, 32, 32, 8192, 3584, 265728, 8388608, 0, 32768, 4, 37806080, 131072, 0, 0, 218104369, 0
    .long 4, 32, 32, 8192, 3840, 265984, 8388608, 0, 32768, 4, 37810176, 131072, 0, 0, 218104369, 0
    .long 4, 24, 24, 8192, 2048, 264192, 8388608, 262144, 32768, 4, 22052864, 131072, 0, 0, 218104356, 0
    .long 4, 24, 24, 8192, 2304, 264448, 8388608, 262144, 32768, 4, 22056960, 131072, 0, 0, 218104356, 0
    .long 4, 24, 24, 8192, 2560, 264704, 8388608, 262144, 32768, 4, 22061056, 131072, 0, 0, 218104356, 0
    .long 4, 24, 24, 8192, 2816, 264960, 8388608, 262144, 32768, 4, 22065152, 131072, 0, 0, 218104356, 0
    .long 4, 24, 24, 8192, 3072, 265216, 8388608, 262144, 32768, 4, 22069248, 131072, 0, 0, 218104372, 0
    .long 4, 24, 24, 8192, 3328, 265472, 8388608, 262144, 32768, 4, 22073344, 131072, 0, 0, 218104372, 0
    .long 4, 24, 24, 8192, 3584, 265728, 8388608, 262144, 32768, 4, 22077440, 131072, 0, 0, 218104372, 0
    .long 4, 24, 24, 8192, 3840, 265984, 8388608, 262144, 32768, 4, 22081536, 131072, 0, 0, 218104372, 0
    .long 4, 32, 32, 8192, 2048, 264192, 8388608, 262144, 32768, 4, 38830080, 131072, 0, 0, 218104356, 0
    .long 4, 32, 32, 8192, 2304, 264448, 8388608, 262144, 32768, 4, 38834176, 131072, 0, 0, 218104356, 0
    .long 4, 32, 32, 8192, 2560, 264704, 8388608, 262144, 32768, 4, 38838272, 131072, 0, 0, 218104356, 0
    .long 4, 32, 32, 8192, 2816, 264960, 8388608, 262144, 32768, 4, 38842368, 131072, 0, 0, 218104356, 0
    .long 4, 32, 32, 8192, 3072, 265216, 8388608, 262144, 32768, 4, 38846464, 131072, 0, 0, 218104372, 0
    .long 4, 32, 32, 8192, 3328, 265472, 8388608, 262144, 32768, 4, 38850560, 131072, 0, 0, 218104372, 0
    .long 4, 32, 32, 8192, 3584, 265728, 8388608, 262144, 32768, 4, 38854656, 131072, 0, 0, 218104372, 0
    .long 4, 32, 32, 8192, 3840, 265984, 8388608, 262144, 32768, 4, 38858752, 131072, 0, 0, 218104372, 0
    .long 4, 32, 32, 8192, 2304, 264448, 8388608, 786432, 32768, 4, 40931328, 131072, 0, 0, 218104612, 0
    .long 4, 24, 24, 8192, 2560, 264704, 8388608, 786432, 32768, 4, 24158208, 131072, 0, 0, 218104612, 0
    .long 4, 24, 24, 8192, 3584, 265728, 8388608, 786432, 32768, 4, 24174592, 131072, 0, 0, 218104628, 0
    .long 4, 32, 32, 8192, 2816, 264960, 8388608, 524288, 32768, 4, 39890944, 131072, 0, 0, 218104609, 0
    .long 4, 32, 32, 8192, 3584, 265728, 8388608, 786432, 32768, 4, 40951808, 131072, 0, 0, 218104628, 0
    .long 4, 32, 32, 8192, 3328, 265472, 8388608, 524288, 32768, 4, 39899136, 131072, 0, 0, 218104625, 0
    .long 4, 24, 24, 8192, 3072, 265216, 8388608, 786432, 32768, 4, 24166400, 131072, 0, 0, 218104628, 0
    .long 4, 32, 32, 8192, 3840, 265984, 8388608, 524288, 32768, 4, 39907328, 131072, 0, 0, 218104625, 0
    .long 4, 32, 32, 8192, 2560, 264704, 8388608, 786432, 32768, 4, 40935424, 131072, 0, 0, 218104612, 0
    .long 4, 32, 32, 8192, 2560, 264704, 8388608, 524288, 32768, 4, 39886848, 131072, 0, 0, 218104609, 0
    .long 4, 32, 32, 8192, 3072, 265216, 8388608, 786432, 32768, 4, 40943616, 131072, 0, 0, 218104628, 0
    .long 4, 24, 24, 8192, 2816, 264960, 8388608, 524288, 32768, 4, 23113728, 131072, 0, 0, 218104609, 0
    .long 2, 64, 72, 7168, 1792, 1792, 7340032, 1048576, 32768, 8, 58224640, 114688, 0, 0, 218103937, 0
    .long 4, 24, 24, 8192, 2304, 264448, 8388608, 786432, 32768, 4, 24154112, 131072, 0, 0, 218104612, 0
    .long 4, 24, 24, 8192, 3328, 265472, 8388608, 524288, 32768, 4, 23121920, 131072, 0, 0, 218104625, 0
    .long 4, 32, 32, 8192, 2304, 264448, 8388608, 524288, 32768, 4, 39882752, 131072, 0, 0, 218104609, 0
    .long 4, 32, 32, 8192, 3840, 265984, 8388608, 786432, 32768, 4, 40955904, 131072, 0, 0, 218104628, 0
    .long 4, 24, 24, 8192, 2048, 264192, 8388608, 524288, 32768, 4, 23101440, 131072, 0, 0, 218104609, 0
    .long 4, 24, 24, 8192, 3584, 265728, 8388608, 524288, 32768, 4, 23126016, 131072, 0, 0, 218104625, 0
    .long 4, 32, 32, 8192, 2048, 264192, 8388608, 524288, 32768, 4, 39878656, 131072, 0, 0, 218104609, 0
    .long 4, 24, 24, 8192, 3840, 265984, 8388608, 524288, 32768, 4, 23130112, 131072, 0, 0, 218104625, 0
    .long 4, 32, 32, 8192, 2048, 264192, 8388608, 786432, 32768, 4, 40927232, 131072, 0, 0, 218104612, 0
    .long 4, 24, 24, 8192, 2816, 264960, 8388608, 786432, 32768, 4, 24162304, 131072, 0, 0, 218104612, 0
    .long 4, 32, 32, 8192, 2816, 264960, 8388608, 786432, 32768, 4, 40939520, 131072, 0, 0, 218104612, 0
    .long 4, 32, 32, 8192, 3584, 265728, 8388608, 524288, 32768, 4, 39903232, 131072, 0, 0, 218104625, 0
    .long 4, 24, 24, 8192, 3072, 265216, 8388608, 524288, 32768, 4, 23117824, 131072, 0, 0, 218104625, 0
    .long 4, 32, 32, 8192, 3328, 265472, 8388608, 786432, 32768, 4, 40947712, 131072, 0, 0, 218104628, 0
    .long 4, 24, 24, 8192, 2304, 264448, 8388608, 524288, 32768, 4, 23105536, 131072, 0, 0, 218104609, 0
    .long 4, 32, 32, 8192, 3072, 265216, 8388608, 524288, 32768, 4, 39895040, 131072, 0, 0, 218104625, 0
    .long 4, 24, 24, 8192, 2560, 264704, 8388608, 524288, 32768, 4, 23109632, 131072, 0, 0, 218104609, 0
    .long 4, 24, 24, 8192, 3328, 265472, 8388608, 786432, 32768, 4, 24170496, 131072, 0, 0, 218104628, 0
    .long 4, 24, 24, 8192, 2048, 264192, 8388608, 786432, 32768, 4, 24150016, 131072, 0, 0, 218104612, 0
    .long 1, 32, 32, 8192, 3072, 3328, 8388608, 1048576, 32768, 8, 41992192, 131072, 0, 0, 218104890, 0
    .long 1, 24, 24, 8192, 2560, 2816, 8388608, 1048576, 32768, 8, 25206784, 131072, 0, 0, 218104874, 0
    .long 1, 16, 16, 8192, 2560, 2816, 8388608, 1048576, 32768, 8, 8429568, 131072, 0, 0, 218104874, 0
    .long 1, 24, 24, 8192, 3072, 3328, 8388608, 1048576, 32768, 8, 25214976, 131072, 0, 0, 218104890, 0
    .long 4, 24, 24, 8192, 3840, 265984, 8388608, 786432, 32768, 4, 24178688, 131072, 0, 0, 218104628, 0
    .long 1, 16, 16, 8192, 2048, 2304, 8388608, 1048576, 32768, 8, 8421376, 131072, 0, 0, 218104874, 0
    .long 1, 24, 24, 8192, 2560, 2816, 8388608, 1572864, 32768, 8, 27303936, 131072, 0, 0, 218105130, 0
    .long 1, 32, 32, 8192, 3072, 3328, 8388608, 1572864, 32768, 8, 44089344, 131072, 0, 0, 218105146, 0
    .long 1, 24, 24, 8192, 2048, 2304, 8388608, 1048576, 32768, 8, 25198592, 131072, 0, 0, 218104874, 0
    .long 1, 32, 32, 8192, 2560, 2816, 8388608, 1048576, 32768, 8, 41984000, 131072, 0, 0, 218104874, 0
    .long 1, 16, 16, 8192, 3584, 3840, 8388608, 1572864, 32768, 8, 10543104, 131072, 0, 0, 218105146, 0
    .long 1, 16, 16, 8192, 2048, 2304, 8388608, 0, 32768, 8, 4227072, 131072, 0, 0, 218107946, 0
    .long 1, 24, 24, 8192, 3072, 3328, 8388608, 1572864, 32768, 8, 27312128, 131072, 0, 0, 218105146, 0
    .long 1, 32, 32, 8192, 3584, 3840, 8388608, 1572864, 32768, 8, 44097536, 131072, 0, 0, 218105146, 0
    .long 1, 32, 32, 8192, 2048, 2304, 8388608, 1048576, 32768, 8, 41975808, 131072, 0, 0, 218104874, 0
    .long 1, 16, 16, 8192, 3072, 3328, 8388608, 1572864, 32768, 8, 10534912, 131072, 0, 0, 218105146, 0
    .long 1, 32, 32, 8192, 3584, 3840, 8388608, 1048576, 32768, 8, 42000384, 131072, 0, 0, 218104890, 0
    .long 1, 24, 24, 8192, 3584, 3840, 8388608, 1572864, 32768, 8, 27320320, 131072, 0, 0, 218105146, 0
    .long 1, 16, 16, 8192, 3584, 3840, 8388608, 1048576, 32768, 8, 8445952, 131072, 0, 0, 218104890, 0
    .long 1, 32, 32, 8192, 2048, 2304, 8388608, 1572864, 32768, 8, 44072960, 131072, 0, 0, 218105130, 0
    .long 1, 16, 16, 8192, 3584, 3840, 8388608, 0, 32768, 8, 4251648, 131072, 0, 0, 218107962, 0
    .long 1, 16, 16, 8192, 2560, 2816, 8388608, 2097152, 32768, 8, 12623872, 131072, 0, 0, 218105386, 0
    .long 1, 16, 16, 8192, 3072, 3328, 8388608, 1048576, 32768, 8, 8437760, 131072, 0, 0, 218104890, 0
    .long 1, 16, 16, 8192, 2048, 2304, 8388608, 1572864, 32768, 8, 10518528, 131072, 0, 0, 218105130, 0
    .long 1, 32, 32, 8192, 2048, 2304, 8388608, 2097152, 32768, 8, 46170112, 131072, 0, 0, 218105386, 0
    .long 1, 16, 16, 8192, 2560, 2816, 8388608, 0, 32768, 8, 4235264, 131072, 0, 0, 218107946, 0
    .long 1, 24, 24, 8192, 3584, 3840, 8388608, 1048576, 32768, 8, 25223168, 131072, 0, 0, 218104890, 0
    .long 1, 16, 16, 8192, 2560, 2816, 8388608, 1572864, 32768, 8, 10526720, 131072, 0, 0, 218105130, 0
    .long 1, 16, 16, 8192, 3072, 3328, 8388608, 0, 32768, 8, 4243456, 131072, 0, 0, 218107962, 0
    .long 1, 32, 32, 8192, 2560, 2816, 8388608, 2097152, 32768, 8, 46178304, 131072, 0, 0, 218105386, 0
    .long 1, 32, 32, 8192, 2560, 2816, 8388608, 1572864, 32768, 8, 44081152, 131072, 0, 0, 218105130, 0
    .long 1, 24, 24, 8192, 2048, 2304, 8388608, 1572864, 32768, 8, 27295744, 131072, 0, 0, 218105130, 0
    .long 1, 16, 16, 8192, 2048, 2304, 8388608, 524288, 32768, 8, 6324224, 131072, 0, 0, 218108202, 0
    .long 1, 32, 32, 8192, 3072, 3328, 8388608, 3670016, 32768, 8, 52477952, 131072, 0, 0, 218106170, 0
    .long 1, 16, 16, 8192, 3072, 3328, 8388608, 2621440, 32768, 8, 14729216, 131072, 0, 0, 218105658, 0
    .long 1, 24, 24, 8192, 2560, 2816, 8388608, 3145728, 32768, 8, 33595392, 131072, 0, 0, 218105898, 0
    .long 1, 16, 16, 8192, 2048, 2304, 8388608, 2621440, 32768, 8, 14712832, 131072, 0, 0, 218105642, 0
    .long 1, 32, 32, 8192, 3584, 3840, 8388608, 3670016, 32768, 8, 52486144, 131072, 0, 0, 218106170, 0
    .long 1, 16, 16, 8192, 2048, 2304, 8388608, 3145728, 32768, 8, 16809984, 131072, 0, 0, 218105898, 0
    .long 1, 24, 24, 8192, 3072, 3328, 8388608, 2097152, 32768, 8, 29409280, 131072, 0, 0, 218105402, 0
    .long 1, 16, 16, 8192, 3584, 3840, 8388608, 2097152, 32768, 8, 12640256, 131072, 0, 0, 218105402, 0
    .long 1, 24, 24, 8192, 2560, 2816, 8388608, 3670016, 32768, 8, 35692544, 131072, 0, 0, 218106154, 0
    .long 1, 24, 24, 8192, 3584, 3840, 8388608, 3145728, 32768, 8, 33611776, 131072, 0, 0, 218105914, 0
    .long 1, 32, 32, 8192, 3584, 3840, 8388608, 2621440, 32768, 8, 48291840, 131072, 0, 0, 218105658, 0
    .long 1, 32, 32, 8192, 3584, 3840, 8388608, 2097152, 32768, 8, 46194688, 131072, 0, 0, 218105402, 0
    .long 1, 24, 24, 8192, 3584, 3840, 8388608, 2097152, 32768, 8, 29417472, 131072, 0, 0, 218105402, 0
    .long 1, 24, 24, 8192, 2048, 2304, 8388608, 2097152, 32768, 8, 29392896, 131072, 0, 0, 218105386, 0
    .long 1, 32, 32, 8192, 3584, 3840, 8388608, 3145728, 32768, 8, 50388992, 131072, 0, 0, 218105914, 0
    .long 1, 32, 32, 8192, 2048, 2304, 8388608, 3145728, 32768, 8, 50364416, 131072, 0, 0, 218105898, 0
    .long 1, 16, 16, 8192, 3072, 3328, 8388608, 3145728, 32768, 8, 16826368, 131072, 0, 0, 218105914, 0
    .long 1, 16, 16, 8192, 3072, 3328, 8388608, 2097152, 32768, 8, 12632064, 131072, 0, 0, 218105402, 0
    .long 5, 218107952, 0, 0, 12, 0, 0, 0, 0, 0, 0, 0, 218112128, 4, 218106881, 0
    .long 1, 32, 32, 8192, 3072, 3328, 8388608, 3145728, 32768, 8, 50380800, 131072, 0, 0, 218105914, 0
    .long 1, 24, 24, 8192, 3584, 3840, 8388608, 3670016, 32768, 8, 35708928, 131072, 0, 0, 218106170, 0
    .long 1, 32, 32, 8192, 2048, 2304, 8388608, 2621440, 32768, 8, 48267264, 131072, 0, 0, 218105642, 0
    .long 1, 32, 32, 8192, 3072, 3328, 8388608, 2097152, 32768, 8, 46186496, 131072, 0, 0, 218105402, 0
    .long 1, 24, 24, 8192, 2560, 2816, 8388608, 2621440, 32768, 8, 31498240, 131072, 0, 0, 218105642, 0
    .long 1, 24, 24, 8192, 2560, 2816, 8388608, 2097152, 32768, 8, 29401088, 131072, 0, 0, 218105386, 0
    .long 1, 16, 16, 8192, 3584, 3840, 8388608, 524288, 32768, 8, 6348800, 131072, 0, 0, 218108218, 0
    .long 1, 32, 32, 8192, 3072, 3328, 8388608, 2621440, 32768, 8, 48283648, 131072, 0, 0, 218105658, 0
    .long 1, 16, 16, 8192, 3072, 3328, 8388608, 524288, 32768, 8, 6340608, 131072, 0, 0, 218108218, 0
    .long 1, 24, 24, 8192, 2048, 2304, 8388608, 2621440, 32768, 8, 31490048, 131072, 0, 0, 218105642, 0
    .long 1, 16, 16, 8192, 2048, 2304, 8388608, 2097152, 32768, 8, 12615680, 131072, 0, 0, 218105386, 0
    .long 5, 218107952, 0, 0, 12, 0, 0, 4, 0, 0, 0, 0, 218112128, 8, 218106881, 0
    .long 5, 218107936, 0, 0, 8, 0, 0, 0, 0, 0, 0, 0, 218112128, 4, 218106881, 0
    .long 1, 24, 24, 8192, 3072, 3328, 8388608, 3670016, 32768, 8, 35700736, 131072, 0, 0, 218106170, 0
    .long 2, 64, 72, 7168, 1792, 1792, 7340032, 2097152, 32768, 8, 61894656, 114688, 0, 0, 218104065, 0
    .long 1, 24, 24, 8192, 3584, 3840, 8388608, 2621440, 32768, 8, 31514624, 131072, 0, 0, 218105658, 0
    .long 2, 64, 72, 7168, 2048, 2048, 7340032, 0, 32768, 8, 54558720, 114688, 0, 0, 218103809, 0
    .long 1, 24, 24, 8192, 2048, 2304, 8388608, 3670016, 32768, 8, 35684352, 131072, 0, 0, 218106154, 0
    .long 1, 32, 32, 8192, 2560, 2816, 8388608, 3670016, 32768, 8, 52469760, 131072, 0, 0, 218106154, 0
    .long 2, 64, 72, 7168, 2816, 2816, 7340032, 2621440, 32768, 8, 63746048, 114688, 0, 0, 218104132, 0
    .long 1, 32, 32, 8192, 2560, 2816, 8388608, 2621440, 32768, 8, 48275456, 131072, 0, 0, 218105642, 0
    .long 1, 16, 16, 8192, 2560, 2816, 8388608, 2621440, 32768, 8, 14721024, 131072, 0, 0, 218105642, 0
    .long 2, 64, 72, 7168, 1792, 1792, 7340032, 0, 32768, 8, 54554624, 114688, 0, 0, 218103809, 0
    .long 1, 16, 16, 8192, 3584, 3840, 8388608, 3145728, 32768, 8, 16834560, 131072, 0, 0, 218105914, 0
    .long 1, 24, 24, 8192, 3072, 3328, 8388608, 2621440, 32768, 8, 31506432, 131072, 0, 0, 218105658, 0
    .long 2, 64, 72, 7168, 2048, 2048, 7340032, 524288, 32768, 8, 56393728, 114688, 0, 0, 218103873, 0
    .long 1, 24, 24, 8192, 2048, 2304, 8388608, 3145728, 32768, 8, 33587200, 131072, 0, 0, 218105898, 0
    .long 2, 64, 72, 7168, 2560, 2560, 7340032, 0, 32768, 8, 54566912, 114688, 0, 0, 218103809, 0
    .long 2, 64, 72, 7168, 2560, 2560, 7340032, 524288, 32768, 8, 56401920, 114688, 0, 0, 218103873, 0
    .long 2, 64, 72, 7168, 2304, 2304, 7340032, 2097152, 32768, 8, 61902848, 114688, 0, 0, 218104065, 0
    .long 2, 64, 72, 7168, 2816, 2816, 7340032, 2097152, 32768, 8, 61911040, 114688, 0, 0, 218104065, 0
    .long 1, 16, 16, 8192, 2560, 2816, 8388608, 524288, 32768, 8, 6332416, 131072, 0, 0, 218108202, 0
    .long 1, 16, 16, 8192, 2560, 2816, 8388608, 3145728, 32768, 8, 16818176, 131072, 0, 0, 218105898, 0
    .long 2, 64, 72, 7168, 2816, 2816, 7340032, 0, 32768, 8, 54571008, 114688, 0, 0, 218103809, 0
    .long 2, 64, 72, 7168, 3072, 3072, 7340032, 0, 32768, 8, 54575104, 114688, 0, 0, 218103809, 0
    .long 1, 16, 16, 8192, 3584, 3840, 8388608, 2621440, 32768, 8, 14737408, 131072, 0, 0, 218105658, 0
    .long 1, 24, 24, 8192, 3072, 3328, 8388608, 3145728, 32768, 8, 33603584, 131072, 0, 0, 218105914, 0
    .long 2, 64, 72, 7168, 3072, 3072, 7340032, 3145728, 32768, 8, 65585152, 114688, 0, 0, 218104196, 0
    .long 1, 32, 32, 8192, 2560, 2816, 8388608, 3145728, 32768, 8, 50372608, 131072, 0, 0, 218105898, 0
    .long 1, 16, 16, 8192, 3584, 3840, 8388608, 3670016, 32768, 8, 18931712, 131072, 0, 0, 218106170, 0
    .long 2, 64, 72, 7168, 3328, 3328, 7340032, 0, 32768, 8, 54579200, 114688, 0, 0, 218103809, 0
    .long 2, 64, 72, 7168, 2304, 2304, 7340032, 0, 32768, 8, 54562816, 114688, 0, 0, 218103809, 0
    .long 5, 218107936, 0, 0, 8, 0, 0, 4, 0, 0, 0, 0, 218112128, 8, 218106881, 0
    .long 2, 64, 72, 7168, 3328, 3328, 7340032, 3145728, 32768, 8, 65589248, 114688, 0, 0, 218104196, 0
    .long 2, 64, 72, 7168, 1792, 1792, 7340032, 524288, 32768, 8, 56389632, 114688, 0, 0, 218103873, 0
    .long 2, 64, 72, 7168, 3072, 3072, 7340032, 1572864, 32768, 8, 60080128, 114688, 0, 0, 218104001, 0
    .long 2, 64, 72, 7168, 3328, 3328, 7340032, 524288, 32768, 8, 56414208, 114688, 0, 0, 218103873, 0
    .long 1, 16, 16, 8192, 2048, 2304, 8388608, 3670016, 32768, 8, 18907136, 131072, 0, 0, 218106154, 0
    .long 5, 218108208, 0, 0, 12, 0, 0, 8, 0, 0, 0, 0, 218112128, 12, 218106945, 0
    .long 2, 64, 72, 7168, 1792, 1792, 7340032, 3145728, 32768, 8, 65564672, 114688, 0, 0, 218104196, 0
    .long 2, 64, 72, 7168, 2304, 2304, 7340032, 1572864, 32768, 8, 60067840, 114688, 0, 0, 218104001, 0
    .long 2, 64, 72, 7168, 2560, 2560, 7340032, 2097152, 32768, 8, 61906944, 114688, 0, 0, 218104065, 0
    .long 2, 64, 72, 7168, 1792, 1792, 7340032, 1572864, 32768, 8, 60059648, 114688, 0, 0, 218104001, 0
    .long 2, 64, 72, 7168, 2560, 2560, 7340032, 1572864, 32768, 8, 60071936, 114688, 0, 0, 218104001, 0
    .long 2, 64, 72, 7168, 3328, 3328, 7340032, 1572864, 32768, 8, 60084224, 114688, 0, 0, 218104001, 0
    .long 2, 64, 72, 7168, 2048, 2048, 7340032, 1572864, 32768, 8, 60063744, 114688, 0, 0, 218104001, 0
    .long 2, 64, 72, 7168, 2048, 2048, 7340032, 2097152, 32768, 8, 61898752, 114688, 0, 0, 218104065, 0
    .long 2, 64, 72, 7168, 3072, 3072, 7340032, 2097152, 32768, 8, 61915136, 114688, 0, 0, 218104065, 0
    .long 2, 64, 72, 7168, 2304, 2304, 7340032, 524288, 32768, 8, 56397824, 114688, 0, 0, 218103873, 0
    .long 2, 64, 72, 7168, 3328, 3328, 7340032, 2097152, 32768, 8, 61919232, 114688, 0, 0, 218104065, 0
    .long 2, 64, 72, 7168, 2816, 2816, 7340032, 1572864, 32768, 8, 60076032, 114688, 0, 0, 218104001, 0
    .long 2, 64, 72, 7168, 2048, 2048, 7340032, 1048576, 32768, 8, 58228736, 114688, 0, 0, 218103937, 0
    .long 2, 64, 72, 7168, 2816, 2816, 7340032, 1048576, 32768, 8, 58241024, 114688, 0, 0, 218103937, 0
    .long 2, 64, 72, 7168, 2304, 2304, 7340032, 3145728, 32768, 8, 65572864, 114688, 0, 0, 218104196, 0
    .long 2, 64, 72, 7168, 3072, 3072, 7340032, 1048576, 32768, 8, 58245120, 114688, 0, 0, 218103937, 0
    .long 5, 218108208, 0, 0, 12, 0, 0, 12, 0, 0, 0, 0, 218112128, 16, 218106945, 0
    .long 2, 64, 72, 7168, 3328, 3328, 7340032, 1048576, 32768, 8, 58249216, 114688, 0, 0, 218103937, 0
    .long 2, 64, 72, 7168, 2816, 2816, 7340032, 3145728, 32768, 8, 65581056, 114688, 0, 0, 218104196, 0
    .long 2, 64, 72, 7168, 3072, 3072, 7340032, 524288, 32768, 8, 56410112, 114688, 0, 0, 218103873, 0
    .long 2, 64, 72, 7168, 2560, 2560, 7340032, 1048576, 32768, 8, 58236928, 114688, 0, 0, 218103937, 0
    .long 2, 64, 72, 7168, 2304, 2304, 7340032, 1048576, 32768, 8, 58232832, 114688, 0, 0, 218103937, 0
    .long 2, 64, 72, 7168, 2048, 2048, 7340032, 3145728, 32768, 8, 65568768, 114688, 0, 0, 218104196, 0
    .long 5, 218108192, 0, 0, 8, 0, 0, 12, 0, 0, 0, 0, 218112128, 16, 218106945, 0
    .long 2, 64, 72, 7168, 2560, 2560, 7340032, 3670016, 32768, 8, 67411968, 114688, 0, 0, 218104260, 0
    .long 2, 64, 72, 7168, 2816, 2816, 7340032, 524288, 32768, 8, 56406016, 114688, 0, 0, 218103873, 0
    .long 1, 80, 80, 2048, 1536, 1792, 7340032, 54525952, 114688, 14, 117465088, 32768, 218103808, 14, 218106370, 0
    .long 1, 40, 40, 2048, 1024, 1280, 8388608, 176160768, 131072, 16, 75513856, 32768, 218106880, 8, 218106376, 0
    .long 5, 218108192, 0, 0, 8, 0, 0, 8, 0, 0, 0, 0, 218112128, 12, 218106945, 0
    .long 1, 32, 32, 8192, 2048, 2304, 8388608, 3670016, 32768, 8, 52461568, 131072, 0, 0, 218106154, 0
    .long 1, 16, 16, 8192, 2560, 2816, 8388608, 3670016, 32768, 8, 18915328, 131072, 0, 0, 218106154, 0
    .long 1, 16, 16, 8192, 3072, 3328, 8388608, 3670016, 32768, 8, 18923520, 131072, 0, 0, 218106170, 0
    .long 1, 40, 40, 2048, 1536, 1792, 8388608, 182452224, 131072, 16, 77094912, 32768, 218112128, 33, 218106568, 0
    .long 1, 40, 40, 2048, 1536, 1792, 8388608, 176160768, 131072, 16, 75522048, 32768, 218106880, 8, 218106376, 0
    .long 2, 64, 72, 7168, 2560, 2560, 7340032, 3145728, 32768, 8, 65576960, 114688, 0, 0, 218104196, 0
    .long 1, 40, 40, 2048, 1024, 1280, 8388608, 180355072, 131072, 16, 76562432, 32768, 218112128, 25, 218106504, 0
    .long 1, 40, 40, 2048, 1536, 1792, 8388608, 180355072, 131072, 16, 76570624, 32768, 218112128, 25, 218106504, 0
    .long 2, 64, 72, 7168, 3072, 3072, 7340032, 2621440, 32768, 8, 63750144, 114688, 0, 0, 218104132, 0
    .long 1, 40, 40, 2048, 1024, 1280, 8388608, 182452224, 131072, 16, 77086720, 32768, 218112128, 33, 218106568, 0
    .long 2, 64, 72, 7168, 1792, 1792, 7340032, 2621440, 32768, 8, 63729664, 114688, 0, 0, 218104132, 0
    .long 1, 80, 80, 2048, 1024, 1280, 7340032, 54525952, 114688, 14, 117456896, 32768, 218103808, 14, 218106370, 0
    .long 2, 64, 72, 7168, 3328, 3328, 7340032, 2621440, 32768, 8, 63754240, 114688, 0, 0, 218104132, 0
    .long 2, 64, 72, 7168, 2048, 2048, 7340032, 2621440, 32768, 8, 63733760, 114688, 0, 0, 218104132, 0
    .long 2, 64, 72, 7168, 2304, 2304, 7340032, 3670016, 32768, 8, 67407872, 114688, 0, 0, 218104260, 0
    .long 2, 64, 72, 7168, 3072, 3072, 7340032, 3670016, 32768, 8, 67420160, 114688, 0, 0, 218104260, 0
    .long 1, 40, 40, 2048, 1024, 1280, 8388608, 178257920, 131072, 16, 76038144, 32768, 218106944, 8, 218106440, 0
    .long 1, 40, 40, 2048, 1536, 1792, 8388608, 178257920, 131072, 16, 76046336, 32768, 218106944, 8, 218106440, 0
    .long 2, 64, 72, 7168, 2560, 2560, 7340032, 2621440, 32768, 8, 63741952, 114688, 0, 0, 218104132, 0
    .long 2, 64, 72, 7168, 1792, 1792, 7340032, 3670016, 32768, 8, 67399680, 114688, 0, 0, 218104260, 0
    .long 2, 64, 72, 7168, 2304, 2304, 7340032, 2621440, 32768, 8, 63737856, 114688, 0, 0, 218104132, 0
    .long 1, 80, 80, 2048, 1536, 1792, 7340032, 61865984, 114688, 14, 119562240, 32768, 218104064, 14, 218106626, 0
    .long 1, 80, 80, 2048, 1024, 1280, 7340032, 60030976, 114688, 14, 119029760, 32768, 218104000, 14, 218106562, 0
    .long 1, 80, 80, 2048, 1024, 1280, 7340032, 61865984, 114688, 14, 119554048, 32768, 218104064, 14, 218106626, 0
    .long 1, 80, 80, 2048, 1536, 1792, 7340032, 60030976, 114688, 14, 119037952, 32768, 218104000, 14, 218106562, 0
    .long 2, 64, 72, 7168, 2816, 2816, 7340032, 3670016, 32768, 8, 67416064, 114688, 0, 0, 218104260, 0
    .long 2, 64, 72, 7168, 2048, 2048, 7340032, 3670016, 32768, 8, 67403776, 114688, 0, 0, 218104260, 0
    .long 1, 80, 80, 2048, 1024, 1280, 7340032, 58195968, 114688, 14, 118505472, 32768, 218103936, 14, 218106498, 0
    .long 1, 80, 80, 2048, 1536, 1792, 7340032, 58195968, 114688, 14, 118513664, 32768, 218103936, 14, 218106498, 0
    .long 2, 64, 72, 7168, 3328, 3328, 7340032, 3670016, 32768, 8, 67424256, 114688, 0, 0, 218104260, 0
    .long 1, 80, 80, 2048, 1536, 1792, 7340032, 56360960, 114688, 14, 117989376, 32768, 218103872, 14, 218106434, 0
    .long 1, 80, 80, 2048, 1024, 1280, 7340032, 56360960, 114688, 14, 117981184, 32768, 218103872, 14, 218106434, 0
    .long 1, 40, 40, 2048, 2097664, 2097920, 8388608, 184582144, 131072, 8, 81797120, 32768, 218112128, 41, 218106628, 0
    .long 1, 80, 80, 2048, 1835008, 1835264, 7340032, 65564672, 114688, 7, 124780544, 32768, 218104196, 7, 218106753, 0
    .long 1, 80, 80, 2048, 1835520, 1835776, 7340032, 65564672, 114688, 7, 124788736, 32768, 218104196, 7, 218106753, 0
    .long 1, 40, 40, 2048, 2097152, 2097408, 8388608, 184582144, 131072, 8, 81788928, 32768, 218112128, 41, 218106628, 0
    .long 1, 80, 80, 2048, 1836544, 1836800, 7340032, 65564672, 114688, 7, 124805120, 32768, 218104196, 7, 218106753, 0
    .long 1, 40, 40, 2048, 2098176, 2098432, 8388608, 184582144, 131072, 8, 81805312, 32768, 218112128, 41, 218106628, 0
    .long 1, 40, 40, 2048, 2098688, 2098944, 8388608, 184582144, 131072, 8, 81813504, 32768, 218112128, 41, 218106628, 0
    .long 1, 40, 40, 2048, 2097664, 2097920, 8388608, 186679296, 131072, 8, 82321408, 32768, 218112128, 49, 218106692, 0
    .long 1, 80, 80, 2048, 1836032, 1836288, 7340032, 65564672, 114688, 7, 124796928, 32768, 218104196, 7, 218106753, 0
    .long 1, 40, 40, 2048, 2098176, 2098432, 8388608, 186679296, 131072, 8, 82329600, 32768, 218112128, 49, 218106692, 0
    .long 1, 40, 40, 2048, 2097152, 2097408, 8388608, 186679296, 131072, 8, 82313216, 32768, 218112128, 49, 218106692, 0
    .long 1, 40, 40, 2048, 2098688, 2098944, 8388608, 186679296, 131072, 8, 82337792, 32768, 218112128, 49, 218106692, 0
    .long 1, 80, 80, 2048, 1836032, 1836288, 7340032, 63729664, 114688, 7, 124272640, 32768, 218104132, 7, 218106689, 0
    .long 1, 80, 80, 2048, 1836544, 1836800, 7340032, 63729664, 114688, 7, 124280832, 32768, 218104132, 7, 218106689, 0
    .long 1, 80, 80, 2048, 1835008, 1835264, 7340032, 63729664, 114688, 7, 124256256, 32768, 218104132, 7, 218106689, 0
    .long 1, 80, 80, 2048, 1835520, 1835776, 7340032, 63729664, 114688, 7, 124264448, 32768, 218104132, 7, 218106689, 0
    .long 1, 80, 80, 2048, 1835520, 1835776, 7340032, 67399680, 114688, 7, 125313024, 32768, 218104260, 7, 218106817, 0
    .long 1, 80, 80, 2048, 1836032, 1836288, 7340032, 67399680, 114688, 7, 125321216, 32768, 218104260, 7, 218106817, 0
    .long 1, 80, 80, 2048, 1836544, 1836800, 7340032, 67399680, 114688, 7, 125329408, 32768, 218104260, 7, 218106817, 0
    .long 1, 80, 80, 2048, 1835008, 1835264, 7340032, 67399680, 114688, 7, 125304832, 32768, 218104260, 7, 218106817, 0
    .long 6, 1, 3, 2, 1, 16, 0, 3, 0, 0, 0, 0, 0, 0, 0, 0
    .long 6, 0, 51, 0, 1, 0, 0, 51, 0, 0, 0, 0, 0, 0, 0, 0
    .long 6, 1, 1, 2, 1, 16, 0, 1, 0, 0, 0, 0, 0, 0, 0, 0
    .long 6, 1, 0, 2, 1, 16, 0, 0, 0, 0, 0, 0, 0, 0, 0, 0
    .long 6, 1, 5, 2, 1, 16, 0, 5, 0, 0, 0, 0, 0, 0, 0, 0
    .long 6, 1, 4, 2, 1, 16, 0, 4, 0, 0, 0, 0, 0, 0, 0, 0
    .long 6, 1, 22, 2, 1, 16, 0, 22, 0, 0, 0, 0, 0, 0, 0, 0
    .long 6, 1, 6, 2, 1, 16, 0, 6, 0, 0, 0, 0, 0, 0, 0, 0
    .long 6, 1, 18, 2, 1, 16, 0, 18, 0, 0, 0, 0, 0, 0, 0, 0
    .long 6, 1, 19, 2, 1, 16, 0, 19, 0, 0, 0, 0, 0, 0, 0, 0
    .long 6, 1, 20, 2, 1, 16, 0, 20, 0, 0, 0, 0, 0, 0, 0, 0
    .long 6, 1, 7, 2, 1, 16, 0, 7, 0, 0, 0, 0, 0, 0, 0, 0
    .long 6, 1, 2, 2, 1, 16, 0, 2, 0, 0, 0, 0, 0, 0, 0, 0
    .long 6, 1, 17, 2, 1, 16, 0, 17, 0, 0, 0, 0, 0, 0, 0, 0
    .long 6, 1, 21, 2, 1, 16, 0, 21, 0, 0, 0, 0, 0, 0, 0, 0
    .long 6, 1, 16, 2, 1, 16, 0, 16, 0, 0, 0, 0, 0, 0, 0, 0
    .long 6, 0, 50, 0, 1, 0, 0, 50, 0, 0, 0, 0, 0, 0, 0, 0
    .long 6, 0, 52, 0, 1, 0, 0, 52, 0, 0, 0, 0, 0, 0, 0, 0
    .long 6, 0, 54, 0, 1, 0, 0, 54, 0, 0, 0, 0, 0, 0, 0, 0
    .long 6, 0, 49, 0, 1, 0, 0, 49, 0, 0, 0, 0, 0, 0, 0, 0
    .long 6, 0, 48, 0, 1, 0, 0, 48, 0, 0, 0, 0, 0, 0, 0, 0
    .long 6, 0, 53, 0, 1, 0, 0, 53, 0, 0, 0, 0, 0, 0, 0, 0
    .long 6, 0, 55, 0, 1, 0, 0, 55, 0, 0, 0, 0, 0, 0, 0, 0
    .long 6, 0, 56, 0, 1, 0, 0, 56, 0, 0, 0, 0, 0, 0, 0, 0
    .long 6, 1, 23, 2, 1, 16, 0, 23, 0, 0, 0, 0, 0, 0, 0, 0
    .long 6, 1, 24, 2, 1, 16, 0, 24, 0, 0, 0, 0, 0, 0, 0, 0
    .long 6, 1, 25, 2, 1, 16, 0, 25, 0, 0, 0, 0, 0, 0, 0, 0
    .long 6, 1, 26, 2, 1, 16, 0, 26, 0, 0, 0, 0, 0, 0, 0, 0
    .long 6, 1, 27, 2, 1, 16, 0, 27, 0, 0, 0, 0, 0, 0, 0, 0
    .long 6, 1, 28, 2, 1, 16, 0, 28, 0, 0, 0, 0, 0, 0, 0, 0
    .long 6, 1, 29, 2, 1, 16, 0, 29, 0, 0, 0, 0, 0, 0, 0, 0
    .long 6, 1, 30, 2, 1, 16, 0, 30, 0, 0, 0, 0, 0, 0, 0, 0
    .long 6, 1, 31, 2, 1, 16, 0, 31, 0, 0, 0, 0, 0, 0, 0, 0
    .long 6, 0, 40, 1, 1, 16, 0, 40, 0, 0, 0, 0, 0, 0, 0, 0
    .long 6, 0, 41, 1, 1, 16, 0, 41, 0, 0, 0, 0, 0, 0, 0, 0
    .long 6, 0, 43, 1, 1, 16, 0, 43, 0, 0, 0, 0, 0, 0, 0, 0
    .long 6, 0, 45, 1, 1, 16, 0, 45, 0, 0, 0, 0, 0, 0, 0, 0
    .long 6, 0, 46, 1, 1, 16, 0, 46, 0, 0, 0, 0, 0, 0, 0, 0
    .long 6, 0, 47, 1, 1, 16, 0, 47, 0, 0, 0, 0, 0, 0, 0, 0
    .long 6, 1, 32, 1, 1, 16, 0, 32, 0, 0, 0, 0, 0, 0, 0, 0
    .long 6, 1, 33, 1, 1, 16, 0, 33, 0, 0, 0, 0, 0, 0, 0, 0
    .long 6, 1, 35, 1, 1, 16, 0, 35, 0, 0, 0, 0, 0, 0, 0, 0
    .long 6, 1, 36, 1, 1, 16, 0, 36, 0, 0, 0, 0, 0, 0, 0, 0
    .long 6, 1, 38, 1, 1, 16, 0, 38, 0, 0, 0, 0, 0, 0, 0, 0
    .long 6, 1, 39, 1, 1, 16, 0, 39, 0, 0, 0, 0, 0, 0, 0, 0
    .long 6, 0, 57, 0, 1, 0, 0, 57, 0, 0, 0, 0, 0, 0, 0, 0
    .long 6, 0, 44, 1, 1, 16, 0, 44, 0, 0, 0, 0, 0, 0, 0, 0
    .long 6, 1, 34, 1, 1, 16, 0, 34, 0, 0, 0, 0, 0, 0, 0, 0
    .long 6, 0, 58, 0, 1, 0, 0, 58, 0, 0, 0, 0, 0, 0, 0, 0
    .long 6, 1, 37, 1, 1, 16, 0, 37, 0, 0, 0, 0, 0, 0, 0, 0
    .long 6, 0, 42, 1, 1, 16, 0, 42, 0, 0, 0, 0, 0, 0, 0, 0
    .long 6, 0, 59, 0, 1, 0, 0, 59, 0, 0, 0, 0, 0, 0, 0, 0
    .long 6, 1, 8, 2, 1, 16, 0, 8, 0, 0, 0, 0, 0, 0, 0, 0
    .long 6, 1, 9, 2, 1, 16, 0, 9, 0, 0, 0, 0, 0, 0, 0, 0
    .long 6, 1, 10, 2, 1, 16, 0, 10, 0, 0, 0, 0, 0, 0, 0, 0
    .long 6, 1, 11, 2, 1, 16, 0, 11, 0, 0, 0, 0, 0, 0, 0, 0
    .long 6, 1, 12, 2, 1, 16, 0, 12, 0, 0, 0, 0, 0, 0, 0, 0
    .long 6, 1, 13, 2, 1, 16, 0, 13, 0, 0, 0, 0, 0, 0, 0, 0
    .long 6, 1, 14, 2, 1, 16, 0, 14, 0, 0, 0, 0, 0, 0, 0, 0
    .long 6, 1, 15, 2, 1, 16, 0, 15, 0, 0, 0, 0, 0, 0, 0, 0
    .long 7, 0, 60, 0, 4, 0, 0, 60, 0, 0, 0, 0, 0, 0, 0, 0
    .long 7, 0, 60, 0, 5, 0, 0, 60, 0, 0, 0, 0, 0, 0, 0, 0
    .long 7, 0, 60, 0, 6, 0, 0, 60, 0, 0, 0, 0, 0, 0, 0, 0
    .long 7, 0, 60, 0, 7, 0, 0, 60, 0, 0, 0, 0, 0, 0, 0, 0
    .long 7, 0, 61, 0, 4, 0, 0, 61, 0, 0, 0, 0, 0, 0, 0, 0
    .long 7, 0, 61, 0, 5, 0, 0, 61, 0, 0, 0, 0, 0, 0, 0, 0
    .long 7, 0, 61, 0, 6, 0, 0, 61, 0, 0, 0, 0, 0, 0, 0, 0
    .long 7, 0, 61, 0, 7, 0, 0, 61, 0, 0, 0, 0, 0, 0, 0, 0
    .long 7, 0, 62, 0, 4, 0, 0, 62, 0, 0, 0, 0, 0, 0, 0, 0
    .long 7, 0, 62, 0, 5, 0, 0, 62, 0, 0, 0, 0, 0, 0, 0, 0
    .long 7, 0, 62, 0, 6, 0, 0, 62, 0, 0, 0, 0, 0, 0, 0, 0
    .long 7, 0, 62, 0, 7, 0, 0, 62, 0, 0, 0, 0, 0, 0, 0, 0
    .long 7, 0, 63, 0, 4, 0, 0, 63, 0, 0, 0, 0, 0, 0, 0, 0
    .long 7, 0, 63, 0, 5, 0, 0, 63, 0, 0, 0, 0, 0, 0, 0, 0
    .long 7, 0, 63, 0, 6, 0, 0, 63, 0, 0, 0, 0, 0, 0, 0, 0
    .long 7, 0, 63, 0, 7, 0, 0, 63, 0, 0, 0, 0, 0, 0, 0, 0
    .long 0, 0, 0, 0, 0, 0, 0, 0, 0, 0, 0, 0, 0, 0, 0, 0
    .long 4, 24, 24, 8192, 4096, 266240, 8388608, 0, 32768, 4, 21037056, 131072, 0, 0, 218104385, 0
    .long 4, 24, 24, 8192, 4352, 266496, 8388608, 0, 32768, 4, 21041152, 131072, 0, 0, 218104385, 0
    .long 4, 24, 24, 8192, 4608, 266752, 8388608, 0, 32768, 4, 21045248, 131072, 0, 0, 218104385, 0
    .long 4, 24, 24, 8192, 4864, 267008, 8388608, 0, 32768, 4, 21049344, 131072, 0, 0, 218104385, 0
    .long 4, 24, 24, 8192, 5120, 267264, 8388608, 0, 32768, 4, 21053440, 131072, 0, 0, 218104401, 0
    .long 4, 24, 24, 8192, 5376, 267520, 8388608, 0, 32768, 4, 21057536, 131072, 0, 0, 218104401, 0
    .long 4, 24, 24, 8192, 5632, 267776, 8388608, 0, 32768, 4, 21061632, 131072, 0, 0, 218104401, 0
    .long 4, 24, 24, 8192, 5888, 268032, 8388608, 0, 32768, 4, 21065728, 131072, 0, 0, 218104401, 0
    .long 4, 32, 32, 8192, 4096, 266240, 8388608, 0, 32768, 4, 37814272, 131072, 0, 0, 218104385, 0
    .long 4, 32, 32, 8192, 4352, 266496, 8388608, 0, 32768, 4, 37818368, 131072, 0, 0, 218104385, 0
    .long 4, 32, 32, 8192, 4608, 266752, 8388608, 0, 32768, 4, 37822464, 131072, 0, 0, 218104385, 0
    .long 4, 32, 32, 8192, 4864, 267008, 8388608, 0, 32768, 4, 37826560, 131072, 0, 0, 218104385, 0
    .long 4, 32, 32, 8192, 5120, 267264, 8388608, 0, 32768, 4, 37830656, 131072, 0, 0, 218104401, 0
    .long 4, 32, 32, 8192, 5376, 267520, 8388608, 0, 32768, 4, 37834752, 131072, 0, 0, 218104401, 0
    .long 4, 32, 32, 8192, 5632, 267776, 8388608, 0, 32768, 4, 37838848, 131072, 0, 0, 218104401, 0
    .long 4, 32, 32, 8192, 5888, 268032, 8388608, 0, 32768, 4, 37842944, 131072, 0, 0, 218104401, 0
    .long 4, 24, 24, 8192, 4096, 266240, 8388608, 262144, 32768, 4, 22085632, 131072, 0, 0, 218104388, 0
    .long 4, 24, 24, 8192, 4352, 266496, 8388608, 262144, 32768, 4, 22089728, 131072, 0, 0, 218104388, 0
    .long 4, 24, 24, 8192, 4608, 266752, 8388608, 262144, 32768, 4, 22093824, 131072, 0, 0, 218104388, 0
    .long 4, 24, 24, 8192, 4864, 267008, 8388608, 262144, 32768, 4, 22097920, 131072, 0, 0, 218104388, 0
    .long 4, 24, 24, 8192, 5120, 267264, 8388608, 262144, 32768, 4, 22102016, 131072, 0, 0, 218104404, 0
    .long 4, 24, 24, 8192, 5376, 267520, 8388608, 262144, 32768, 4, 22106112, 131072, 0, 0, 218104404, 0
    .long 4, 24, 24, 8192, 5632, 267776, 8388608, 262144, 32768, 4, 22110208, 131072, 0, 0, 218104404, 0
    .long 4, 24, 24, 8192, 5888, 268032, 8388608, 262144, 32768, 4, 22114304, 131072, 0, 0, 218104404, 0
    .long 4, 32, 32, 8192, 4096, 266240, 8388608, 262144, 32768, 4, 38862848, 131072, 0, 0, 218104388, 0
    .long 4, 32, 32, 8192, 4352, 266496, 8388608, 262144, 32768, 4, 38866944, 131072, 0, 0, 218104388, 0
    .long 4, 32, 32, 8192, 4608, 266752, 8388608, 262144, 32768, 4, 38871040, 131072, 0, 0, 218104388, 0
    .long 4, 32, 32, 8192, 4864, 267008, 8388608, 262144, 32768, 4, 38875136, 131072, 0, 0, 218104388, 0
    .long 4, 32, 32, 8192, 5120, 267264, 8388608, 262144, 32768, 4, 38879232, 131072, 0, 0, 218104404, 0
    .long 4, 32, 32, 8192, 5376, 267520, 8388608, 262144, 32768, 4, 38883328, 131072, 0, 0, 218104404, 0
    .long 4, 32, 32, 8192, 5632, 267776, 8388608, 262144, 32768, 4, 38887424, 131072, 0, 0, 218104404, 0
    .long 4, 32, 32, 8192, 5888, 268032, 8388608, 262144, 32768, 4, 38891520, 131072, 0, 0, 218104404, 0
    .long 4, 32, 32, 8192, 4352, 266496, 8388608, 786432, 32768, 4, 40964096, 131072, 0, 0, 218104644, 0
    .long 4, 24, 24, 8192, 4608, 266752, 8388608, 786432, 32768, 4, 24190976, 131072, 0, 0, 218104644, 0
    .long 4, 24, 24, 8192, 5632, 267776, 8388608, 786432, 32768, 4, 24207360, 131072, 0, 0, 218104660, 0
    .long 4, 32, 32, 8192, 4864, 267008, 8388608, 524288, 32768, 4, 39923712, 131072, 0, 0, 218104641, 0
    .long 4, 32, 32, 8192, 5632, 267776, 8388608, 786432, 32768, 4, 40984576, 131072, 0, 0, 218104660, 0
    .long 4, 32, 32, 8192, 5376, 267520, 8388608, 524288, 32768, 4, 39931904, 131072, 0, 0, 218104657, 0
    .long 4, 24, 24, 8192, 5120, 267264, 8388608, 786432, 32768, 4, 24199168, 131072, 0, 0, 218104660, 0
    .long 4, 32, 32, 8192, 5888, 268032, 8388608, 524288, 32768, 4, 39940096, 131072, 0, 0, 218104657, 0
    .long 4, 32, 32, 8192, 4608, 266752, 8388608, 786432, 32768, 4, 40968192, 131072, 0, 0, 218104644, 0
    .long 4, 32, 32, 8192, 4608, 266752, 8388608, 524288, 32768, 4, 39919616, 131072, 0, 0, 218104641, 0
    .long 4, 32, 32, 8192, 5120, 267264, 8388608, 786432, 32768, 4, 40976384, 131072, 0, 0, 218104660, 0
    .long 4, 24, 24, 8192, 4864, 267008, 8388608, 524288, 32768, 4, 23146496, 131072, 0, 0, 218104641, 0
    .long 2, 64, 72, 7168, 3584, 3584, 7340032, 1048576, 32768, 8, 58253312, 114688, 0, 0, 218103953, 0
    .long 4, 24, 24, 8192, 4352, 266496, 8388608, 786432, 32768, 4, 24186880, 131072, 0, 0, 218104644, 0
    .long 4, 24, 24, 8192, 5376, 267520, 8388608, 524288, 32768, 4, 23154688, 131072, 0, 0, 218104657, 0
    .long 4, 32, 32, 8192, 4352, 266496, 8388608, 524288, 32768, 4, 39915520, 131072, 0, 0, 218104641, 0
    .long 4, 32, 32, 8192, 5888, 268032, 8388608, 786432, 32768, 4, 40988672, 131072, 0, 0, 218104660, 0
    .long 4, 24, 24, 8192, 4096, 266240, 8388608, 524288, 32768, 4, 23134208, 131072, 0, 0, 218104641, 0
    .long 4, 24, 24, 8192, 5632, 267776, 8388608, 524288, 32768, 4, 23158784, 131072, 0, 0, 218104657, 0
    .long 4, 32, 32, 8192, 4096, 266240, 8388608, 524288, 32768, 4, 39911424, 131072, 0, 0, 218104641, 0
    .long 4, 24, 24, 8192, 5888, 268032, 8388608, 524288, 32768, 4, 23162880, 131072, 0, 0, 218104657, 0
    .long 4, 32, 32, 8192, 4096, 266240, 8388608, 786432, 32768, 4, 40960000, 131072, 0, 0, 218104644, 0
    .long 4, 24, 24, 8192, 4864, 267008, 8388608, 786432, 32768, 4, 24195072, 131072, 0, 0, 218104644, 0
    .long 4, 32, 32, 8192, 4864, 267008, 8388608, 786432, 32768, 4, 40972288, 131072, 0, 0, 218104644, 0
    .long 4, 32, 32, 8192, 5632, 267776, 8388608, 524288, 32768, 4, 39936000, 131072, 0, 0, 218104657, 0
    .long 4, 24, 24, 8192, 5120, 267264, 8388608, 524288, 32768, 4, 23150592, 131072, 0, 0, 218104657, 0
    .long 4, 32, 32, 8192, 5376, 267520, 8388608, 786432, 32768, 4, 40980480, 131072, 0, 0, 218104660, 0
    .long 4, 24, 24, 8192, 4352, 266496, 8388608, 524288, 32768, 4, 23138304, 131072, 0, 0, 218104641, 0
    .long 4, 32, 32, 8192, 5120, 267264, 8388608, 524288, 32768, 4, 39927808, 131072, 0, 0, 218104657, 0
    .long 4, 24, 24, 8192, 4608, 266752, 8388608, 524288, 32768, 4, 23142400, 131072, 0, 0, 218104641, 0
    .long 4, 24, 24, 8192, 5376, 267520, 8388608, 786432, 32768, 4, 24203264, 131072, 0, 0, 218104660, 0
    .long 4, 24, 24, 8192, 4096, 266240, 8388608, 786432, 32768, 4, 24182784, 131072, 0, 0, 218104644, 0
    .long 1, 32, 32, 8192, 5120, 5376, 8388608, 1048576, 32768, 8, 42024960, 131072, 0, 0, 218104922, 0
    .long 1, 24, 24, 8192, 4608, 4864, 8388608, 1048576, 32768, 8, 25239552, 131072, 0, 0, 218104906, 0
    .long 1, 16, 16, 8192, 4608, 4864, 8388608, 1048576, 32768, 8, 8462336, 131072, 0, 0, 218104906, 0
    .long 1, 24, 24, 8192, 5120, 5376, 8388608, 1048576, 32768, 8, 25247744, 131072, 0, 0, 218104922, 0
    .long 4, 24, 24, 8192, 5888, 268032, 8388608, 786432, 32768, 4, 24211456, 131072, 0, 0, 218104660, 0
    .long 1, 16, 16, 8192, 4096, 4352, 8388608, 1048576, 32768, 8, 8454144, 131072, 0, 0, 218104906, 0
    .long 1, 24, 24, 8192, 4608, 4864, 8388608, 1572864, 32768, 8, 27336704, 131072, 0, 0, 218105162, 0
    .long 1, 32, 32, 8192, 5120, 5376, 8388608, 1572864, 32768, 8, 44122112, 131072, 0, 0, 218105178, 0
    .long 1, 24, 24, 8192, 4096, 4352, 8388608, 1048576, 32768, 8, 25231360, 131072, 0, 0, 218104906, 0
    .long 1, 32, 32, 8192, 4608, 4864, 8388608, 1048576, 32768, 8, 42016768, 131072, 0, 0, 218104906, 0
    .long 1, 16, 16, 8192, 5632, 5888, 8388608, 1572864, 32768, 8, 10575872, 131072, 0, 0, 218105178, 0
    .long 1, 16, 16, 8192, 4096, 4352, 8388608, 0, 32768, 8, 4259840, 131072, 0, 0, 218107978, 0
    .long 1, 24, 24, 8192, 5120, 5376, 8388608, 1572864, 32768, 8, 27344896, 131072, 0, 0, 218105178, 0
    .long 1, 32, 32, 8192, 5632, 5888, 8388608, 1572864, 32768, 8, 44130304, 131072, 0, 0, 218105178, 0
    .long 1, 32, 32, 8192, 4096, 4352, 8388608, 1048576, 32768, 8, 42008576, 131072, 0, 0, 218104906, 0
    .long 1, 16, 16, 8192, 5120, 5376, 8388608, 1572864, 32768, 8, 10567680, 131072, 0, 0, 218105178, 0
    .long 1, 32, 32, 8192, 5632, 5888, 8388608, 1048576, 32768, 8, 42033152, 131072, 0, 0, 218104922, 0
    .long 1, 24, 24, 8192, 5632, 5888, 8388608, 1572864, 32768, 8, 27353088, 131072, 0, 0, 218105178, 0
    .long 1, 16, 16, 8192, 5632, 5888, 8388608, 1048576, 32768, 8, 8478720, 131072, 0, 0, 218104922, 0
    .long 1, 32, 32, 8192, 4096, 4352, 8388608, 1572864, 32768, 8, 44105728, 131072, 0, 0, 218105162, 0
    .long 1, 16, 16, 8192, 5632, 5888, 8388608, 0, 32768, 8, 4284416, 131072, 0, 0, 218107994, 0
    .long 1, 16, 16, 8192, 4608, 4864, 8388608, 2097152, 32768, 8, 12656640, 131072, 0, 0, 218105418, 0
    .long 1, 16, 16, 8192, 5120, 5376, 8388608, 1048576, 32768, 8, 8470528, 131072, 0, 0, 218104922, 0
    .long 1, 16, 16, 8192, 4096, 4352, 8388608, 1572864, 32768, 8, 10551296, 131072, 0, 0, 218105162, 0
    .long 1, 32, 32, 8192, 4096, 4352, 8388608, 2097152, 32768, 8, 46202880, 131072, 0, 0, 218105418, 0
    .long 1, 16, 16, 8192, 4608, 4864, 8388608, 0, 32768, 8, 4268032, 131072, 0, 0, 218107978, 0
    .long 1, 24, 24, 8192, 5632, 5888, 8388608, 1048576, 32768, 8, 25255936, 131072, 0, 0, 218104922, 0
    .long 1, 16, 16, 8192, 4608, 4864, 8388608, 1572864, 32768, 8, 10559488, 131072, 0, 0, 218105162, 0
    .long 1, 16, 16, 8192, 5120, 5376, 8388608, 0, 32768, 8, 4276224, 131072, 0, 0, 218107994, 0
    .long 1, 32, 32, 8192, 4608, 4864, 8388608, 2097152, 32768, 8, 46211072, 131072, 0, 0, 218105418, 0
    .long 1, 32, 32, 8192, 4608, 4864, 8388608, 1572864, 32768, 8, 44113920, 131072, 0, 0, 218105162, 0
    .long 1, 24, 24, 8192, 4096, 4352, 8388608, 1572864, 32768, 8, 27328512, 131072, 0, 0, 218105162, 0
    .long 1, 16, 16, 8192, 4096, 4352, 8388608, 524288, 32768, 8, 6356992, 131072, 0, 0, 218108234, 0
    .long 1, 32, 32, 8192, 5120, 5376, 8388608, 3670016, 32768, 8, 52510720, 131072, 0, 0, 218106202, 0
    .long 1, 16, 16, 8192, 5120, 5376, 8388608, 2621440, 32768, 8, 14761984, 131072, 0, 0, 218105690, 0
    .long 1, 24, 24, 8192, 4608, 4864, 8388608, 3145728, 32768, 8, 33628160, 131072, 0, 0, 218105930, 0
    .long 1, 16, 16, 8192, 4096, 4352, 8388608, 2621440, 32768, 8, 14745600, 131072, 0, 0, 218105674, 0
    .long 1, 32, 32, 8192, 5632, 5888, 8388608, 3670016, 32768, 8, 52518912, 131072, 0, 0, 218106202, 0
    .long 1, 16, 16, 8192, 4096, 4352, 8388608, 3145728, 32768, 8, 16842752, 131072, 0, 0, 218105930, 0
    .long 1, 24, 24, 8192, 5120, 5376, 8388608, 2097152, 32768, 8, 29442048, 131072, 0, 0, 218105434, 0
    .long 1, 16, 16, 8192, 5632, 5888, 8388608, 2097152, 32768, 8, 12673024, 131072, 0, 0, 218105434, 0
    .long 1, 24, 24, 8192, 4608, 4864, 8388608, 3670016, 32768, 8, 35725312, 131072, 0, 0, 218106186, 0
    .long 1, 24, 24, 8192, 5632, 5888, 8388608, 3145728, 32768, 8, 33644544, 131072, 0, 0, 218105946, 0
    .long 1, 32, 32, 8192, 5632, 5888, 8388608, 2621440, 32768, 8, 48324608, 131072, 0, 0, 218105690, 0
    .long 1, 32, 32, 8192, 5632, 5888, 8388608, 2097152, 32768, 8, 46227456, 131072, 0, 0, 218105434, 0
    .long 1, 24, 24, 8192, 5632, 5888, 8388608, 2097152, 32768, 8, 29450240, 131072, 0, 0, 218105434, 0
    .long 1, 24, 24, 8192, 4096, 4352, 8388608, 2097152, 32768, 8, 29425664, 131072, 0, 0, 218105418, 0
    .long 1, 32, 32, 8192, 5632, 5888, 8388608, 3145728, 32768, 8, 50421760, 131072, 0, 0, 218105946, 0
    .long 1, 32, 32, 8192, 4096, 4352, 8388608, 3145728, 32768, 8, 50397184, 131072, 0, 0, 218105930, 0
    .long 1, 16, 16, 8192, 5120, 5376, 8388608, 3145728, 32768, 8, 16859136, 131072, 0, 0, 218105946, 0
    .long 1, 16, 16, 8192, 5120, 5376, 8388608, 2097152, 32768, 8, 12664832, 131072, 0, 0, 218105434, 0
    .long 5, 218107984, 0, 0, 20, 0, 0, 0, 0, 0, 0, 0, 218112256, 4, 218106897, 0
    .long 1, 32, 32, 8192, 5120, 5376, 8388608, 3145728, 32768, 8, 50413568, 131072, 0, 0, 218105946, 0
    .long 1, 24, 24, 8192, 5632, 5888, 8388608, 3670016, 32768, 8, 35741696, 131072, 0, 0, 218106202, 0
    .long 1, 32, 32, 8192, 4096, 4352, 8388608, 2621440, 32768, 8, 48300032, 131072, 0, 0, 218105674, 0
    .long 1, 32, 32, 8192, 5120, 5376, 8388608, 2097152, 32768, 8, 46219264, 131072, 0, 0, 218105434, 0
    .long 1, 24, 24, 8192, 4608, 4864, 8388608, 2621440, 32768, 8, 31531008, 131072, 0, 0, 218105674, 0
    .long 1, 24, 24, 8192, 4608, 4864, 8388608, 2097152, 32768, 8, 29433856, 131072, 0, 0, 218105418, 0
    .long 1, 16, 16, 8192, 5632, 5888, 8388608, 524288, 32768, 8, 6381568, 131072, 0, 0, 218108250, 0
    .long 1, 32, 32, 8192, 5120, 5376, 8388608, 2621440, 32768, 8, 48316416, 131072, 0, 0, 218105690, 0
    .long 1, 16, 16, 8192, 5120, 5376, 8388608, 524288, 32768, 8, 6373376, 131072, 0, 0, 218108250, 0
    .long 1, 24, 24, 8192, 4096, 4352, 8388608, 2621440, 32768, 8, 31522816, 131072, 0, 0, 218105674, 0
    .long 1, 16, 16, 8192, 4096, 4352, 8388608, 2097152, 32768, 8, 12648448, 131072, 0, 0, 218105418, 0
    .long 5, 218107984, 0, 0, 20, 0, 0, 4, 0, 0, 0, 0, 218112256, 8, 218106897, 0
    .long 5, 218107968, 0, 0, 16, 0, 0, 0, 0, 0, 0, 0, 218112256, 4, 218106897, 0
    .long 1, 24, 24, 8192, 5120, 5376, 8388608, 3670016, 32768, 8, 35733504, 131072, 0, 0, 218106202, 0
    .long 2, 64, 72, 7168, 3584, 3584, 7340032, 2097152, 32768, 8, 61923328, 114688, 0, 0, 218104081, 0
    .long 1, 24, 24, 8192, 5632, 5888, 8388608, 2621440, 32768, 8, 31547392, 131072, 0, 0, 218105690, 0
    .long 2, 64, 72, 7168, 3840, 3840, 7340032, 0, 32768, 8, 54587392, 114688, 0, 0, 218103825, 0
    .long 1, 24, 24, 8192, 4096, 4352, 8388608, 3670016, 32768, 8, 35717120, 131072, 0, 0, 218106186, 0
    .long 1, 32, 32, 8192, 4608, 4864, 8388608, 3670016, 32768, 8, 52502528, 131072, 0, 0, 218106186, 0
    .long 2, 64, 72, 7168, 4608, 4608, 7340032, 2621440, 32768, 8, 63774720, 114688, 0, 0, 218104145, 0
    .long 1, 32, 32, 8192, 4608, 4864, 8388608, 2621440, 32768, 8, 48308224, 131072, 0, 0, 218105674, 0
    .long 1, 16, 16, 8192, 4608, 4864, 8388608, 2621440, 32768, 8, 14753792, 131072, 0, 0, 218105674, 0
    .long 2, 64, 72, 7168, 3584, 3584, 7340032, 0, 32768, 8, 54583296, 114688, 0, 0, 218103825, 0
    .long 1, 16, 16, 8192, 5632, 5888, 8388608, 3145728, 32768, 8, 16867328, 131072, 0, 0, 218105946, 0
    .long 1, 24, 24, 8192, 5120, 5376, 8388608, 2621440, 32768, 8, 31539200, 131072, 0, 0, 218105690, 0
    .long 2, 64, 72, 7168, 3840, 3840, 7340032, 524288, 32768, 8, 56422400, 114688, 0, 0, 218103889, 0
    .long 1, 24, 24, 8192, 4096, 4352, 8388608, 3145728, 32768, 8, 33619968, 131072, 0, 0, 218105930, 0
    .long 2, 64, 72, 7168, 4352, 4352, 7340032, 0, 32768, 8, 54595584, 114688, 0, 0, 218103825, 0
    .long 2, 64, 72, 7168, 4352, 4352, 7340032, 524288, 32768, 8, 56430592, 114688, 0, 0, 218103889, 0
    .long 2, 64, 72, 7168, 4096, 4096, 7340032, 2097152, 32768, 8, 61931520, 114688, 0, 0, 218104081, 0
    .long 2, 64, 72, 7168, 4608, 4608, 7340032, 2097152, 32768, 8, 61939712, 114688, 0, 0, 218104081, 0
    .long 1, 16, 16, 8192, 4608, 4864, 8388608, 524288, 32768, 8, 6365184, 131072, 0, 0, 218108234, 0
    .long 1, 16, 16, 8192, 4608, 4864, 8388608, 3145728, 32768, 8, 16850944, 131072, 0, 0, 218105930, 0
    .long 2, 64, 72, 7168, 4608, 4608, 7340032, 0, 32768, 8, 54599680, 114688, 0, 0, 218103825, 0
    .long 2, 64, 72, 7168, 4864, 4864, 7340032, 0, 32768, 8, 54603776, 114688, 0, 0, 218103825, 0
    .long 1, 16, 16, 8192, 5632, 5888, 8388608, 2621440, 32768, 8, 14770176, 131072, 0, 0, 218105690, 0
    .long 1, 24, 24, 8192, 5120, 5376, 8388608, 3145728, 32768, 8, 33636352, 131072, 0, 0, 218105946, 0
    .long 2, 64, 72, 7168, 4864, 4864, 7340032, 3145728, 32768, 8, 65613824, 114688, 0, 0, 218104209, 0
    .long 1, 32, 32, 8192, 4608, 4864, 8388608, 3145728, 32768, 8, 50405376, 131072, 0, 0, 218105930, 0
    .long 1, 16, 16, 8192, 5632, 5888, 8388608, 3670016, 32768, 8, 18964480, 131072, 0, 0, 218106202, 0
    .long 2, 64, 72, 7168, 5120, 5120, 7340032, 0, 32768, 8, 54607872, 114688, 0, 0, 218103825, 0
    .long 2, 64, 72, 7168, 4096, 4096, 7340032, 0, 32768, 8, 54591488, 114688, 0, 0, 218103825, 0
    .long 5, 218107968, 0, 0, 16, 0, 0, 4, 0, 0, 0, 0, 218112256, 8, 218106897, 0
    .long 2, 64, 72, 7168, 5120, 5120, 7340032, 3145728, 32768, 8, 65617920, 114688, 0, 0, 218104209, 0
    .long 2, 64, 72, 7168, 3584, 3584, 7340032, 524288, 32768, 8, 56418304, 114688, 0, 0, 218103889, 0
    .long 2, 64, 72, 7168, 4864, 4864, 7340032, 1572864, 32768, 8, 60108800, 114688, 0, 0, 218104017, 0
    .long 2, 64, 72, 7168, 5120, 5120, 7340032, 524288, 32768, 8, 56442880, 114688, 0, 0, 218103889, 0
    .long 1, 16, 16, 8192, 4096, 4352, 8388608, 3670016, 32768, 8, 18939904, 131072, 0, 0, 218106186, 0
    .long 5, 218108240, 0, 0, 20, 0, 0, 8, 0, 0, 0, 0, 218112256, 12, 218106961, 0
    .long 2, 64, 72, 7168, 3584, 3584, 7340032, 3145728, 32768, 8, 65593344, 114688, 0, 0, 218104209, 0
    .long 2, 64, 72, 7168, 4096, 4096, 7340032, 1572864, 32768, 8, 60096512, 114688, 0, 0, 218104017, 0
    .long 2, 64, 72, 7168, 4352, 4352, 7340032, 2097152, 32768, 8, 61935616, 114688, 0, 0, 218104081, 0
    .long 2, 64, 72, 7168, 3584, 3584, 7340032, 1572864, 32768, 8, 60088320, 114688, 0, 0, 218104017, 0
    .long 2, 64, 72, 7168, 4352, 4352, 7340032, 1572864, 32768, 8, 60100608, 114688, 0, 0, 218104017, 0
    .long 2, 64, 72, 7168, 5120, 5120, 7340032, 1572864, 32768, 8, 60112896, 114688, 0, 0, 218104017, 0
    .long 2, 64, 72, 7168, 3840, 3840, 7340032, 1572864, 32768, 8, 60092416, 114688, 0, 0, 218104017, 0
    .long 2, 64, 72, 7168, 3840, 3840, 7340032, 2097152, 32768, 8, 61927424, 114688, 0, 0, 218104081, 0
    .long 2, 64, 72, 7168, 4864, 4864, 7340032, 2097152, 32768, 8, 61943808, 114688, 0, 0, 218104081, 0
    .long 2, 64, 72, 7168, 4096, 4096, 7340032, 524288, 32768, 8, 56426496, 114688, 0, 0, 218103889, 0
    .long 2, 64, 72, 7168, 5120, 5120, 7340032, 2097152, 32768, 8, 61947904, 114688, 0, 0, 218104081, 0
    .long 2, 64, 72, 7168, 4608, 4608, 7340032, 1572864, 32768, 8, 60104704, 114688, 0, 0, 218104017, 0
    .long 2, 64, 72, 7168, 3840, 3840, 7340032, 1048576, 32768, 8, 58257408, 114688, 0, 0, 218103953, 0
    .long 2, 64, 72, 7168, 4608, 4608, 7340032, 1048576, 32768, 8, 58269696, 114688, 0, 0, 218103953, 0
    .long 2, 64, 72, 7168, 4096, 4096, 7340032, 3145728, 32768, 8, 65601536, 114688, 0, 0, 218104209, 0
    .long 2, 64, 72, 7168, 4864, 4864, 7340032, 1048576, 32768, 8, 58273792, 114688, 0, 0, 218103953, 0
    .long 5, 218108240, 0, 0, 20, 0, 0, 12, 0, 0, 0, 0, 218112256, 16, 218106961, 0
    .long 2, 64, 72, 7168, 5120, 5120, 7340032, 1048576, 32768, 8, 58277888, 114688, 0, 0, 218103953, 0
    .long 2, 64, 72, 7168, 4608, 4608, 7340032, 3145728, 32768, 8, 65609728, 114688, 0, 0, 218104209, 0
    .long 2, 64, 72, 7168, 4864, 4864, 7340032, 524288, 32768, 8, 56438784, 114688, 0, 0, 218103889, 0
    .long 2, 64, 72, 7168, 4352, 4352, 7340032, 1048576, 32768, 8, 58265600, 114688, 0, 0, 218103953, 0
    .long 2, 64, 72, 7168, 4096, 4096, 7340032, 1048576, 32768, 8, 58261504, 114688, 0, 0, 218103953, 0
    .long 2, 64, 72, 7168, 3840, 3840, 7340032, 3145728, 32768, 8, 65597440, 114688, 0, 0, 218104209, 0
    .long 5, 218108224, 0, 0, 16, 0, 0, 12, 0, 0, 0, 0, 218112256, 16, 218106961, 0
    .long 2, 64, 72, 7168, 4352, 4352, 7340032, 3670016, 32768, 8, 67440640, 114688, 0, 0, 218104273, 0
    .long 2, 64, 72, 7168, 4608, 4608, 7340032, 524288, 32768, 8, 56434688, 114688, 0, 0, 218103889, 0
    .long 1, 80, 80, 2048, 3670528, 3670784, 7340032, 54583296, 114688, 14, 121643008, 32768, 218103824, 14, 218106370, 0
    .long 1, 40, 40, 2048, 4194304, 4194560, 8388608, 176226304, 131072, 16, 79691776, 32768, 218106896, 8, 218106376, 0
    .long 5, 218108224, 0, 0, 16, 0, 0, 8, 0, 0, 0, 0, 218112256, 12, 218106961, 0
    .long 1, 32, 32, 8192, 4096, 4352, 8388608, 3670016, 32768, 8, 52494336, 131072, 0, 0, 218106186, 0
    .long 1, 16, 16, 8192, 4608, 4864, 8388608, 3670016, 32768, 8, 18948096, 131072, 0, 0, 218106186, 0
    .long 1, 16, 16, 8192, 5120, 5376, 8388608, 3670016, 32768, 8, 18956288, 131072, 0, 0, 218106202, 0
    .long 1, 40, 40, 2048, 4194816, 4195072, 8388608, 182517760, 131072, 16, 81272832, 32768, 218112256, 33, 218106568, 0
    .long 1, 40, 40, 2048, 4194816, 4195072, 8388608, 176226304, 131072, 16, 79699968, 32768, 218106896, 8, 218106376, 0
    .long 2, 64, 72, 7168, 4352, 4352, 7340032, 3145728, 32768, 8, 65605632, 114688, 0, 0, 218104209, 0
    .long 1, 40, 40, 2048, 4194304, 4194560, 8388608, 180420608, 131072, 16, 80740352, 32768, 218112256, 25, 218106504, 0
    .long 1, 40, 40, 2048, 4194816, 4195072, 8388608, 180420608, 131072, 16, 80748544, 32768, 218112256, 25, 218106504, 0
    .long 2, 64, 72, 7168, 4864, 4864, 7340032, 2621440, 32768, 8, 63778816, 114688, 0, 0, 218104145, 0
    .long 1, 40, 40, 2048, 4194304, 4194560, 8388608, 182517760, 131072, 16, 81264640, 32768, 218112256, 33, 218106568, 0
    .long 2, 64, 72, 7168, 3584, 3584, 7340032, 2621440, 32768, 8, 63758336, 114688, 0, 0, 218104145, 0
    .long 1, 80, 80, 2048, 3670016, 3670272, 7340032, 54583296, 114688, 14, 121634816, 32768, 218103824, 14, 218106370, 0
    .long 2, 64, 72, 7168, 5120, 5120, 7340032, 2621440, 32768, 8, 63782912, 114688, 0, 0, 218104145, 0
    .long 2, 64, 72, 7168, 3840, 3840, 7340032, 2621440, 32768, 8, 63762432, 114688, 0, 0, 218104145, 0
    .long 2, 64, 72, 7168, 4096, 4096, 7340032, 3670016, 32768, 8, 67436544, 114688, 0, 0, 218104273, 0
    .long 2, 64, 72, 7168, 4864, 4864, 7340032, 3670016, 32768, 8, 67448832, 114688, 0, 0, 218104273, 0
    .long 1, 40, 40, 2048, 4194304, 4194560, 8388608, 178323456, 131072, 16, 80216064, 32768, 218106960, 8, 218106440, 0
    .long 1, 40, 40, 2048, 4194816, 4195072, 8388608, 178323456, 131072, 16, 80224256, 32768, 218106960, 8, 218106440, 0
    .long 2, 64, 72, 7168, 4352, 4352, 7340032, 2621440, 32768, 8, 63770624, 114688, 0, 0, 218104145, 0
    .long 2, 64, 72, 7168, 3584, 3584, 7340032, 3670016, 32768, 8, 67428352, 114688, 0, 0, 218104273, 0
    .long 2, 64, 72, 7168, 4096, 4096, 7340032, 2621440, 32768, 8, 63766528, 114688, 0, 0, 218104145, 0
    .long 1, 80, 80, 2048, 3670528, 3670784, 7340032, 61923328, 114688, 14, 123740160, 32768, 218104080, 14, 218106626, 0
    .long 1, 80, 80, 2048, 3670016, 3670272, 7340032, 60088320, 114688, 14, 123207680, 32768, 218104016, 14, 218106562, 0
    .long 1, 80, 80, 2048, 3670016, 3670272, 7340032, 61923328, 114688, 14, 123731968, 32768, 218104080, 14, 218106626, 0
    .long 1, 80, 80, 2048, 3670528, 3670784, 7340032, 60088320, 114688, 14, 123215872, 32768, 218104016, 14, 218106562, 0
    .long 2, 64, 72, 7168, 4608, 4608, 7340032, 3670016, 32768, 8, 67444736, 114688, 0, 0, 218104273, 0
    .long 2, 64, 72, 7168, 3840, 3840, 7340032, 3670016, 32768, 8, 67432448, 114688, 0, 0, 218104273, 0
    .long 1, 80, 80, 2048, 3670016, 3670272, 7340032, 58253312, 114688, 14, 122683392, 32768, 218103952, 14, 218106498, 0
    .long 1, 80, 80, 2048, 3670528, 3670784, 7340032, 58253312, 114688, 14, 122691584, 32768, 218103952, 14, 218106498, 0
    .long 2, 64, 72, 7168, 5120, 5120, 7340032, 3670016, 32768, 8, 67452928, 114688, 0, 0, 218104273, 0
    .long 1, 80, 80, 2048, 3670528, 3670784, 7340032, 56418304, 114688, 14, 122167296, 32768, 218103888, 14, 218106434, 0
    .long 1, 80, 80, 2048, 3670016, 3670272, 7340032, 56418304, 114688, 14, 122159104, 32768, 218103888, 14, 218106434, 0
    .long 1, 40, 40, 2048, 4194816, 4195072, 8388608, 184614912, 131072, 8, 85991424, 32768, 218112256, 41, 218106628, 0
    .long 1, 80, 80, 2048, 3670016, 3670272, 7340032, 65593344, 114688, 7, 128974848, 32768, 218104208, 7, 218106753, 0
    .long 1, 80, 80, 2048, 3670528, 3670784, 7340032, 65593344, 114688, 7, 128983040, 32768, 218104208, 7, 218106753, 0
    .long 1, 40, 40, 2048, 4194304, 4194560, 8388608, 184614912, 131072, 8, 85983232, 32768, 218112256, 41, 218106628, 0
    .long 1, 80, 80, 2048, 3671552, 3671808, 7340032, 65593344, 114688, 7, 128999424, 32768, 218104208, 7, 218106753, 0
    .long 1, 40, 40, 2048, 4195328, 4195584, 8388608, 184614912, 131072, 8, 85999616, 32768, 218112256, 41, 218106628, 0
    .long 1, 40, 40, 2048, 4195840, 4196096, 8388608, 184614912, 131072, 8, 86007808, 32768, 218112256, 41, 218106628, 0
    .long 1, 40, 40, 2048, 4194816, 4195072, 8388608, 186712064, 131072, 8, 86515712, 32768, 218112256, 49, 218106692, 0
    .long 1, 80, 80, 2048, 3671040, 3671296, 7340032, 65593344, 114688, 7, 128991232, 32768, 218104208, 7, 218106753, 0
    .long 1, 40, 40, 2048, 4195328, 4195584, 8388608, 186712064, 131072, 8, 86523904, 32768, 218112256, 49, 218106692, 0
    .long 1, 40, 40, 2048, 4194304, 4194560, 8388608, 186712064, 131072, 8, 86507520, 32768, 218112256, 49, 218106692, 0
    .long 1, 40, 40, 2048, 4195840, 4196096, 8388608, 186712064, 131072, 8, 86532096, 32768, 218112256, 49, 218106692, 0
    .long 1, 80, 80, 2048, 3671040, 3671296, 7340032, 63758336, 114688, 7, 128466944, 32768, 218104144, 7, 218106689, 0
    .long 1, 80, 80, 2048, 3671552, 3671808, 7340032, 63758336, 114688, 7, 128475136, 32768, 218104144, 7, 218106689, 0
    .long 1, 80, 80, 2048, 3670016, 3670272, 7340032, 63758336, 114688, 7, 128450560, 32768, 218104144, 7, 218106689, 0
    .long 1, 80, 80, 2048, 3670528, 3670784, 7340032, 63758336, 114688, 7, 128458752, 32768, 218104144, 7, 218106689, 0
    .long 1, 80, 80, 2048, 3670528, 3670784, 7340032, 67428352, 114688, 7, 129507328, 32768, 218104272, 7, 218106817, 0
    .long 1, 80, 80, 2048, 3671040, 3671296, 7340032, 67428352, 114688, 7, 129515520, 32768, 218104272, 7, 218106817, 0
    .long 1, 80, 80, 2048, 3671552, 3671808, 7340032, 67428352, 114688, 7, 129523712, 32768, 218104272, 7, 218106817, 0
    .long 1, 80, 80, 2048, 3670016, 3670272, 7340032, 67428352, 114688, 7, 129499136, 32768, 218104272, 7, 218106817, 0
    .long 6, 1, 3, 2, 2, 16, 0, 3, 0, 0, 0, 0, 0, 0, 0, 0
    .long 6, 0, 51, 0, 2, 0, 0, 51, 0, 0, 0, 0, 0, 0, 0, 0
    .long 6, 1, 1, 2, 2, 16, 0, 1, 0, 0, 0, 0, 0, 0, 0, 0
    .long 6, 1, 0, 2, 2, 16, 0, 0, 0, 0, 0, 0, 0, 0, 0, 0
    .long 6, 1, 5, 2, 2, 16, 0, 5, 0, 0, 0, 0, 0, 0, 0, 0
    .long 6, 1, 4, 2, 2, 16, 0, 4, 0, 0, 0, 0, 0, 0, 0, 0
    .long 6, 1, 22, 2, 2, 16, 0, 22, 0, 0, 0, 0, 0, 0, 0, 0
    .long 6, 1, 6, 2, 2, 16, 0, 6, 0, 0, 0, 0, 0, 0, 0, 0
    .long 6, 1, 18, 2, 2, 16, 0, 18, 0, 0, 0, 0, 0, 0, 0, 0
    .long 6, 1, 19, 2, 2, 16, 0, 19, 0, 0, 0, 0, 0, 0, 0, 0
    .long 6, 1, 20, 2, 2, 16, 0, 20, 0, 0, 0, 0, 0, 0, 0, 0
    .long 6, 1, 7, 2, 2, 16, 0, 7, 0, 0, 0, 0, 0, 0, 0, 0
    .long 6, 1, 2, 2, 2, 16, 0, 2, 0, 0, 0, 0, 0, 0, 0, 0
    .long 6, 1, 17, 2, 2, 16, 0, 17, 0, 0, 0, 0, 0, 0, 0, 0
    .long 6, 1, 21, 2, 2, 16, 0, 21, 0, 0, 0, 0, 0, 0, 0, 0
    .long 6, 1, 16, 2, 2, 16, 0, 16, 0, 0, 0, 0, 0, 0, 0, 0
    .long 6, 0, 50, 0, 2, 0, 0, 50, 0, 0, 0, 0, 0, 0, 0, 0
    .long 6, 0, 52, 0, 2, 0, 0, 52, 0, 0, 0, 0, 0, 0, 0, 0
    .long 6, 0, 54, 0, 2, 0, 0, 54, 0, 0, 0, 0, 0, 0, 0, 0
    .long 6, 0, 49, 0, 2, 0, 0, 49, 0, 0, 0, 0, 0, 0, 0, 0
    .long 6, 0, 48, 0, 2, 0, 0, 48, 0, 0, 0, 0, 0, 0, 0, 0
    .long 6, 0, 53, 0, 2, 0, 0, 53, 0, 0, 0, 0, 0, 0, 0, 0
    .long 6, 0, 55, 0, 2, 0, 0, 55, 0, 0, 0, 0, 0, 0, 0, 0
    .long 6, 0, 56, 0, 2, 0, 0, 56, 0, 0, 0, 0, 0, 0, 0, 0
    .long 6, 1, 23, 2, 2, 16, 0, 23, 0, 0, 0, 0, 0, 0, 0, 0
    .long 6, 1, 24, 2, 2, 16, 0, 24, 0, 0, 0, 0, 0, 0, 0, 0
    .long 6, 1, 25, 2, 2, 16, 0, 25, 0, 0, 0, 0, 0, 0, 0, 0
    .long 6, 1, 26, 2, 2, 16, 0, 26, 0, 0, 0, 0, 0, 0, 0, 0
    .long 6, 1, 27, 2, 2, 16, 0, 27, 0, 0, 0, 0, 0, 0, 0, 0
    .long 6, 1, 28, 2, 2, 16, 0, 28, 0, 0, 0, 0, 0, 0, 0, 0
    .long 6, 1, 29, 2, 2, 16, 0, 29, 0, 0, 0, 0, 0, 0, 0, 0
    .long 6, 1, 30, 2, 2, 16, 0, 30, 0, 0, 0, 0, 0, 0, 0, 0
    .long 6, 1, 31, 2, 2, 16, 0, 31, 0, 0, 0, 0, 0, 0, 0, 0
    .long 6, 0, 40, 1, 2, 16, 0, 40, 0, 0, 0, 0, 0, 0, 0, 0
    .long 6, 0, 41, 1, 2, 16, 0, 41, 0, 0, 0, 0, 0, 0, 0, 0
    .long 6, 0, 43, 1, 2, 16, 0, 43, 0, 0, 0, 0, 0, 0, 0, 0
    .long 6, 0, 45, 1, 2, 16, 0, 45, 0, 0, 0, 0, 0, 0, 0, 0
    .long 6, 0, 46, 1, 2, 16, 0, 46, 0, 0, 0, 0, 0, 0, 0, 0
    .long 6, 0, 47, 1, 2, 16, 0, 47, 0, 0, 0, 0, 0, 0, 0, 0
    .long 6, 1, 32, 1, 2, 16, 0, 32, 0, 0, 0, 0, 0, 0, 0, 0
    .long 6, 1, 33, 1, 2, 16, 0, 33, 0, 0, 0, 0, 0, 0, 0, 0
    .long 6, 1, 35, 1, 2, 16, 0, 35, 0, 0, 0, 0, 0, 0, 0, 0
    .long 6, 1, 36, 1, 2, 16, 0, 36, 0, 0, 0, 0, 0, 0, 0, 0
    .long 6, 1, 38, 1, 2, 16, 0, 38, 0, 0, 0, 0, 0, 0, 0, 0
    .long 6, 1, 39, 1, 2, 16, 0, 39, 0, 0, 0, 0, 0, 0, 0, 0
    .long 6, 0, 57, 0, 2, 0, 0, 57, 0, 0, 0, 0, 0, 0, 0, 0
    .long 6, 0, 44, 1, 2, 16, 0, 44, 0, 0, 0, 0, 0, 0, 0, 0
    .long 6, 1, 34, 1, 2, 16, 0, 34, 0, 0, 0, 0, 0, 0, 0, 0
    .long 6, 0, 58, 0, 2, 0, 0, 58, 0, 0, 0, 0, 0, 0, 0, 0
    .long 6, 1, 37, 1, 2, 16, 0, 37, 0, 0, 0, 0, 0, 0, 0, 0
    .long 6, 0, 42, 1, 2, 16, 0, 42, 0, 0, 0, 0, 0, 0, 0, 0
    .long 6, 0, 59, 0, 2, 0, 0, 59, 0, 0, 0, 0, 0, 0, 0, 0
    .long 6, 1, 8, 2, 2, 16, 0, 8, 0, 0, 0, 0, 0, 0, 0, 0
    .long 6, 1, 9, 2, 2, 16, 0, 9, 0, 0, 0, 0, 0, 0, 0, 0
    .long 6, 1, 10, 2, 2, 16, 0, 10, 0, 0, 0, 0, 0, 0, 0, 0
    .long 6, 1, 11, 2, 2, 16, 0, 11, 0, 0, 0, 0, 0, 0, 0, 0
    .long 6, 1, 12, 2, 2, 16, 0, 12, 0, 0, 0, 0, 0, 0, 0, 0
    .long 6, 1, 13, 2, 2, 16, 0, 13, 0, 0, 0, 0, 0, 0, 0, 0
    .long 6, 1, 14, 2, 2, 16, 0, 14, 0, 0, 0, 0, 0, 0, 0, 0
    .long 6, 1, 15, 2, 2, 16, 0, 15, 0, 0, 0, 0, 0, 0, 0, 0
    .long 7, 0, 60, 0, 8, 0, 0, 60, 0, 0, 0, 0, 0, 0, 0, 0
    .long 7, 0, 60, 0, 9, 0, 0, 60, 0, 0, 0, 0, 0, 0, 0, 0
    .long 7, 0, 60, 0, 10, 0, 0, 60, 0, 0, 0, 0, 0, 0, 0, 0
    .long 7, 0, 60, 0, 11, 0, 0, 60, 0, 0, 0, 0, 0, 0, 0, 0
    .long 7, 0, 61, 0, 8, 0, 0, 61, 0, 0, 0, 0, 0, 0, 0, 0
    .long 7, 0, 61, 0, 9, 0, 0, 61, 0, 0, 0, 0, 0, 0, 0, 0
    .long 7, 0, 61, 0, 10, 0, 0, 61, 0, 0, 0, 0, 0, 0, 0, 0
    .long 7, 0, 61, 0, 11, 0, 0, 61, 0, 0, 0, 0, 0, 0, 0, 0
    .long 7, 0, 62, 0, 8, 0, 0, 62, 0, 0, 0, 0, 0, 0, 0, 0
    .long 7, 0, 62, 0, 9, 0, 0, 62, 0, 0, 0, 0, 0, 0, 0, 0
    .long 7, 0, 62, 0, 10, 0, 0, 62, 0, 0, 0, 0, 0, 0, 0, 0
    .long 7, 0, 62, 0, 11, 0, 0, 62, 0, 0, 0, 0, 0, 0, 0, 0
    .long 7, 0, 63, 0, 8, 0, 0, 63, 0, 0, 0, 0, 0, 0, 0, 0
    .long 7, 0, 63, 0, 9, 0, 0, 63, 0, 0, 0, 0, 0, 0, 0, 0
    .long 7, 0, 63, 0, 10, 0, 0, 63, 0, 0, 0, 0, 0, 0, 0, 0
    .long 7, 0, 63, 0, 11, 0, 0, 63, 0, 0, 0, 0, 0, 0, 0, 0
    .long 0, 0, 0, 0, 0, 0, 0, 0, 0, 0, 0, 0, 0, 0, 0, 0
    .long 4, 24, 24, 8192, 6144, 268288, 8388608, 0, 32768, 4, 21069824, 131072, 0, 0, 218104417, 0
    .long 4, 24, 24, 8192, 6400, 268544, 8388608, 0, 32768, 4, 21073920, 131072, 0, 0, 218104417, 0
    .long 4, 24, 24, 8192, 6656, 268800, 8388608, 0, 32768, 4, 21078016, 131072, 0, 0, 218104417, 0
    .long 4, 24, 24, 8192, 6912, 269056, 8388608, 0, 32768, 4, 21082112, 131072, 0, 0, 218104417, 0
    .long 4, 24, 24, 8192, 7168, 269312, 8388608, 0, 32768, 4, 21086208, 131072, 0, 0, 218104433, 0
    .long 4, 24, 24, 8192, 7424, 269568, 8388608, 0, 32768, 4, 21090304, 131072, 0, 0, 218104433, 0
    .long 4, 24, 24, 8192, 7680, 269824, 8388608, 0, 32768, 4, 21094400, 131072, 0, 0, 218104433, 0
    .long 4, 24, 24, 8192, 7936, 270080, 8388608, 0, 32768, 4, 21098496, 131072, 0, 0, 218104433, 0
    .long 4, 32, 32, 8192, 6144, 268288, 8388608, 0, 32768, 4, 37847040, 131072, 0, 0, 218104417, 0
    .long 4, 32, 32, 8192, 6400, 268544, 8388608, 0, 32768, 4, 37851136, 131072, 0, 0, 218104417, 0
    .long 4, 32, 32, 8192, 6656, 268800, 8388608, 0, 32768, 4, 37855232, 131072, 0, 0, 218104417, 0
    .long 4, 32, 32, 8192, 6912, 269056, 8388608, 0, 32768, 4, 37859328, 131072, 0, 0, 218104417, 0
    .long 4, 32, 32, 8192, 7168, 269312, 8388608, 0, 32768, 4, 37863424, 131072, 0, 0, 218104433, 0
    .long 4, 32, 32, 8192, 7424, 269568, 8388608, 0, 32768, 4, 37867520, 131072, 0, 0, 218104433, 0
    .long 4, 32, 32, 8192, 7680, 269824, 8388608, 0, 32768, 4, 37871616, 131072, 0, 0, 218104433, 0
    .long 4, 32, 32, 8192, 7936, 270080, 8388608, 0, 32768, 4, 37875712, 131072, 0, 0, 218104433, 0
    .long 4, 24, 24, 8192, 6144, 268288, 8388608, 262144, 32768, 4, 22118400, 131072, 0, 0, 218104420, 0
    .long 4, 24, 24, 8192, 6400, 268544, 8388608, 262144, 32768, 4, 22122496, 131072, 0, 0, 218104420, 0
    .long 4, 24, 24, 8192, 6656, 268800, 8388608, 262144, 32768, 4, 22126592, 131072, 0, 0, 218104420, 0
    .long 4, 24, 24, 8192, 6912, 269056, 8388608, 262144, 32768, 4, 22130688, 131072, 0, 0, 218104420, 0
    .long 4, 24, 24, 8192, 7168, 269312, 8388608, 262144, 32768, 4, 22134784, 131072, 0, 0, 218104436, 0
    .long 4, 24, 24, 8192, 7424, 269568, 8388608, 262144, 32768, 4, 22138880, 131072, 0, 0, 218104436, 0
    .long 4, 24, 24, 8192, 7680, 269824, 8388608, 262144, 32768, 4, 22142976, 131072, 0, 0, 218104436, 0
    .long 4, 24, 24, 8192, 7936, 270080, 8388608, 262144, 32768, 4, 22147072, 131072, 0, 0, 218104436, 0
    .long 4, 32, 32, 8192, 6144, 268288, 8388608, 262144, 32768, 4, 38895616, 131072, 0, 0, 218104420, 0
    .long 4, 32, 32, 8192, 6400, 268544, 8388608, 262144, 32768, 4, 38899712, 131072, 0, 0, 218104420, 0
    .long 4, 32, 32, 8192, 6656, 268800, 8388608, 262144, 32768, 4, 38903808, 131072, 0, 0, 218104420, 0
    .long 4, 32, 32, 8192, 6912, 269056, 8388608, 262144, 32768, 4, 38907904, 131072, 0, 0, 218104420, 0
    .long 4, 32, 32, 8192, 7168, 269312, 8388608, 262144, 32768, 4, 38912000, 131072, 0, 0, 218104436, 0
    .long 4, 32, 32, 8192, 7424, 269568, 8388608, 262144, 32768, 4, 38916096, 131072, 0, 0, 218104436, 0
    .long 4, 32, 32, 8192, 7680, 269824, 8388608, 262144, 32768, 4, 38920192, 131072, 0, 0, 218104436, 0
    .long 4, 32, 32, 8192, 7936, 270080, 8388608, 262144, 32768, 4, 38924288, 131072, 0, 0, 218104436, 0
    .long 4, 32, 32, 8192, 6400, 268544, 8388608, 786432, 32768, 4, 40996864, 131072, 0, 0, 218104676, 0
    .long 4, 24, 24, 8192, 6656, 268800, 8388608, 786432, 32768, 4, 24223744, 131072, 0, 0, 218104676, 0
    .long 4, 24, 24, 8192, 7680, 269824, 8388608, 786432, 32768, 4, 24240128, 131072, 0, 0, 218104692, 0
    .long 4, 32, 32, 8192, 6912, 269056, 8388608, 524288, 32768, 4, 39956480, 131072, 0, 0, 218104673, 0
    .long 4, 32, 32, 8192, 7680, 269824, 8388608, 786432, 32768, 4, 41017344, 131072, 0, 0, 218104692, 0
    .long 4, 32, 32, 8192, 7424, 269568, 8388608, 524288, 32768, 4, 39964672, 131072, 0, 0, 218104689, 0
    .long 4, 24, 24, 8192, 7168, 269312, 8388608, 786432, 32768, 4, 24231936, 131072, 0, 0, 218104692, 0
    .long 4, 32, 32, 8192, 7936, 270080, 8388608, 524288, 32768, 4, 39972864, 131072, 0, 0, 218104689, 0
    .long 4, 32, 32, 8192, 6656, 268800, 8388608, 786432, 32768, 4, 41000960, 131072, 0, 0, 218104676, 0
    .long 4, 32, 32, 8192, 6656, 268800, 8388608, 524288, 32768, 4, 39952384, 131072, 0, 0, 218104673, 0
    .long 4, 32, 32, 8192, 7168, 269312, 8388608, 786432, 32768, 4, 41009152, 131072, 0, 0, 218104692, 0
    .long 4, 24, 24, 8192, 6912, 269056, 8388608, 524288, 32768, 4, 23179264, 131072, 0, 0, 218104673, 0
    .long 2, 64, 72, 7168, 5376, 5376, 7340032, 1048576, 32768, 8, 58281984, 114688, 0, 0, 218103953, 0
    .long 4, 24, 24, 8192, 6400, 268544, 8388608, 786432, 32768, 4, 24219648, 131072, 0, 0, 218104676, 0
    .long 4, 24, 24, 8192, 7424, 269568, 8388608, 524288, 32768, 4, 23187456, 131072, 0, 0, 218104689, 0
    .long 4, 32, 32, 8192, 6400, 268544, 8388608, 524288, 32768, 4, 39948288, 131072, 0, 0, 218104673, 0
    .long 4, 32, 32, 8192, 7936, 270080, 8388608, 786432, 32768, 4, 41021440, 131072, 0, 0, 218104692, 0
    .long 4, 24, 24, 8192, 6144, 268288, 8388608, 524288, 32768, 4, 23166976, 131072, 0, 0, 218104673, 0
    .long 4, 24, 24, 8192, 7680, 269824, 8388608, 524288, 32768, 4, 23191552, 131072, 0, 0, 218104689, 0
    .long 4, 32, 32, 8192, 6144, 268288, 8388608, 524288, 32768, 4, 39944192, 131072, 0, 0, 218104673, 0
    .long 4, 24, 24, 8192, 7936, 270080, 8388608, 524288, 32768, 4, 23195648, 131072, 0, 0, 218104689, 0
    .long 4, 32, 32, 8192, 6144, 268288, 8388608, 786432, 32768, 4, 40992768, 131072, 0, 0, 218104676, 0
    .long 4, 24, 24, 8192, 6912, 269056, 8388608, 786432, 32768, 4, 24227840, 131072, 0, 0, 218104676, 0
    .long 4, 32, 32, 8192, 6912, 269056, 8388608, 786432, 32768, 4, 41005056, 131072, 0, 0, 218104676, 0
    .long 4, 32, 32, 8192, 7680, 269824, 8388608, 524288, 32768, 4, 39968768, 131072, 0, 0, 218104689, 0
    .long 4, 24, 24, 8192, 7168, 269312, 8388608, 524288, 32768, 4, 23183360, 131072, 0, 0, 218104689, 0
    .long 4, 32, 32, 8192, 7424, 269568, 8388608, 786432, 32768, 4, 41013248, 131072, 0, 0, 218104692, 0
    .long 4, 24, 24, 8192, 6400, 268544, 8388608, 524288, 32768, 4, 23171072, 131072, 0, 0, 218104673, 0
    .long 4, 32, 32, 8192, 7168, 269312, 8388608, 524288, 32768, 4, 39960576, 131072, 0, 0, 218104689, 0
    .long 4, 24, 24, 8192, 6656, 268800, 8388608, 524288, 32768, 4, 23175168, 131072, 0, 0, 218104673, 0
    .long 4, 24, 24, 8192, 7424, 269568, 8388608, 786432, 32768, 4, 24236032, 131072, 0, 0, 218104692, 0
    .long 4, 24, 24, 8192, 6144, 268288, 8388608, 786432, 32768, 4, 24215552, 131072, 0, 0, 218104676, 0
    .long 1, 32, 32, 8192, 7168, 7424, 8388608, 1048576, 32768, 8, 42057728, 131072, 0, 0, 218104954, 0
    .long 1, 24, 24, 8192, 6656, 6912, 8388608, 1048576, 32768, 8, 25272320, 131072, 0, 0, 218104938, 0
    .long 1, 16, 16, 8192, 6656, 6912, 8388608, 1048576, 32768, 8, 8495104, 131072, 0, 0, 218104938, 0
    .long 1, 24, 24, 8192, 7168, 7424, 8388608, 1048576, 32768, 8, 25280512, 131072, 0, 0, 218104954, 0
    .long 4, 24, 24, 8192, 7936, 270080, 8388608, 786432, 32768, 4, 24244224, 131072, 0, 0, 218104692, 0
    .long 1, 16, 16, 8192, 6144, 6400, 8388608, 1048576, 32768, 8, 8486912, 131072, 0, 0, 218104938, 0
    .long 1, 24, 24, 8192, 6656, 6912, 8388608, 1572864, 32768, 8, 27369472, 131072, 0, 0, 218105194, 0
    .long 1, 32, 32, 8192, 7168, 7424, 8388608, 1572864, 32768, 8, 44154880, 131072, 0, 0, 218105210, 0
    .long 1, 24, 24, 8192, 6144, 6400, 8388608, 1048576, 32768, 8, 25264128, 131072, 0, 0, 218104938, 0
    .long 1, 32, 32, 8192, 6656, 6912, 8388608, 1048576, 32768, 8, 42049536, 131072, 0, 0, 218104938, 0
    .long 1, 16, 16, 8192, 7680, 7936, 8388608, 1572864, 32768, 8, 10608640, 131072, 0, 0, 218105210, 0
    .long 1, 16, 16, 8192, 6144, 6400, 8388608, 0, 32768, 8, 4292608, 131072, 0, 0, 218108010, 0
    .long 1, 24, 24, 8192, 7168, 7424, 8388608, 1572864, 32768, 8, 27377664, 131072, 0, 0, 218105210, 0
    .long 1, 32, 32, 8192, 7680, 7936, 8388608, 1572864, 32768, 8, 44163072, 131072, 0, 0, 218105210, 0
    .long 1, 32, 32, 8192, 6144, 6400, 8388608, 1048576, 32768, 8, 42041344, 131072, 0, 0, 218104938, 0
    .long 1, 16, 16, 8192, 7168, 7424, 8388608, 1572864, 32768, 8, 10600448, 131072, 0, 0, 218105210, 0
    .long 1, 32, 32, 8192, 7680, 7936, 8388608, 1048576, 32768, 8, 42065920, 131072, 0, 0, 218104954, 0
    .long 1, 24, 24, 8192, 7680, 7936, 8388608, 1572864, 32768, 8, 27385856, 131072, 0, 0, 218105210, 0
    .long 1, 16, 16, 8192, 7680, 7936, 8388608, 1048576, 32768, 8, 8511488, 131072, 0, 0, 218104954, 0
    .long 1, 32, 32, 8192, 6144, 6400, 8388608, 1572864, 32768, 8, 44138496, 131072, 0, 0, 218105194, 0
    .long 1, 16, 16, 8192, 7680, 7936, 8388608, 0, 32768, 8, 4317184, 131072, 0, 0, 218108026, 0
    .long 1, 16, 16, 8192, 6656, 6912, 8388608, 2097152, 32768, 8, 12689408, 131072, 0, 0, 218105450, 0
    .long 1, 16, 16, 8192, 7168, 7424, 8388608, 1048576, 32768, 8, 8503296, 131072, 0, 0, 218104954, 0
    .long 1, 16, 16, 8192, 6144, 6400, 8388608, 1572864, 32768, 8, 10584064, 131072, 0, 0, 218105194, 0
    .long 1, 32, 32, 8192, 6144, 6400, 8388608, 2097152, 32768, 8, 46235648, 131072, 0, 0, 218105450, 0
    .long 1, 16, 16, 8192, 6656, 6912, 8388608, 0, 32768, 8, 4300800, 131072, 0, 0, 218108010, 0
    .long 1, 24, 24, 8192, 7680, 7936, 8388608, 1048576, 32768, 8, 25288704, 131072, 0, 0, 218104954, 0
    .long 1, 16, 16, 8192, 6656, 6912, 8388608, 1572864, 32768, 8, 10592256, 131072, 0, 0, 218105194, 0
    .long 1, 16, 16, 8192, 7168, 7424, 8388608, 0, 32768, 8, 4308992, 131072, 0, 0, 218108026, 0
    .long 1, 32, 32, 8192, 6656, 6912, 8388608, 2097152, 32768, 8, 46243840, 131072, 0, 0, 218105450, 0
    .long 1, 32, 32, 8192, 6656, 6912, 8388608, 1572864, 32768, 8, 44146688, 131072, 0, 0, 218105194, 0
    .long 1, 24, 24, 8192, 6144, 6400, 8388608, 1572864, 32768, 8, 27361280, 131072, 0, 0, 218105194, 0
    .long 1, 16, 16, 8192, 6144, 6400, 8388608, 524288, 32768, 8, 6389760, 131072, 0, 0, 218108266, 0
    .long 1, 32, 32, 8192, 7168, 7424, 8388608, 3670016, 32768, 8, 52543488, 131072, 0, 0, 218106234, 0
    .long 1, 16, 16, 8192, 7168, 7424, 8388608, 2621440, 32768, 8, 14794752, 131072, 0, 0, 218105722, 0
    .long 1, 24, 24, 8192, 6656, 6912, 8388608, 3145728, 32768, 8, 33660928, 131072, 0, 0, 218105962, 0
    .long 1, 16, 16, 8192, 6144, 6400, 8388608, 2621440, 32768, 8, 14778368, 131072, 0, 0, 218105706, 0
    .long 1, 32, 32, 8192, 7680, 7936, 8388608, 3670016, 32768, 8, 52551680, 131072, 0, 0, 218106234, 0
    .long 1, 16, 16, 8192, 6144, 6400, 8388608, 3145728, 32768, 8, 16875520, 131072, 0, 0, 218105962, 0
    .long 1, 24, 24, 8192, 7168, 7424, 8388608, 2097152, 32768, 8, 29474816, 131072, 0, 0, 218105466, 0
    .long 1, 16, 16, 8192, 7680, 7936, 8388608, 2097152, 32768, 8, 12705792, 131072, 0, 0, 218105466, 0
    .long 1, 24, 24, 8192, 6656, 6912, 8388608, 3670016, 32768, 8, 35758080, 131072, 0, 0, 218106218, 0
    .long 1, 24, 24, 8192, 7680, 7936, 8388608, 3145728, 32768, 8, 33677312, 131072, 0, 0, 218105978, 0
    .long 1, 32, 32, 8192, 7680, 7936, 8388608, 2621440, 32768, 8, 48357376, 131072, 0, 0, 218105722, 0
    .long 1, 32, 32, 8192, 7680, 7936, 8388608, 2097152, 32768, 8, 46260224, 131072, 0, 0, 218105466, 0
    .long 1, 24, 24, 8192, 7680, 7936, 8388608, 2097152, 32768, 8, 29483008, 131072, 0, 0, 218105466, 0
    .long 1, 24, 24, 8192, 6144, 6400, 8388608, 2097152, 32768, 8, 29458432, 131072, 0, 0, 218105450, 0
    .long 1, 32, 32, 8192, 7680, 7936, 8388608, 3145728, 32768, 8, 50454528, 131072, 0, 0, 218105978, 0
    .long 1, 32, 32, 8192, 6144, 6400, 8388608, 3145728, 32768, 8, 50429952, 131072, 0, 0, 218105962, 0
    .long 1, 16, 16, 8192, 7168, 7424, 8388608, 3145728, 32768, 8, 16891904, 131072, 0, 0, 218105978, 0
    .long 1, 16, 16, 8192, 7168, 7424, 8388608, 2097152, 32768, 8, 12697600, 131072, 0, 0, 218105466, 0
    .long 5, 218108016, 0, 0, 28, 0, 0, 0, 0, 0, 0, 0, 218112384, 4, 218106897, 0
    .long 1, 32, 32, 8192, 7168, 7424, 8388608, 3145728, 32768, 8, 50446336, 131072, 0, 0, 218105978, 0
    .long 1, 24, 24, 8192, 7680, 7936, 8388608, 3670016, 32768, 8, 35774464, 131072, 0, 0, 218106234, 0
    .long 1, 32, 32, 8192, 6144, 6400, 8388608, 2621440, 32768, 8, 48332800, 131072, 0, 0, 218105706, 0
    .long 1, 32, 32, 8192, 7168, 7424, 8388608, 2097152, 32768, 8, 46252032, 131072, 0, 0, 218105466, 0
    .long 1, 24, 24, 8192, 6656, 6912, 8388608, 2621440, 32768, 8, 31563776, 131072, 0, 0, 218105706, 0
    .long 1, 24, 24, 8192, 6656, 6912, 8388608, 2097152, 32768, 8, 29466624, 131072, 0, 0, 218105450, 0
    .long 1, 16, 16, 8192, 7680, 7936, 8388608, 524288, 32768, 8, 6414336, 131072, 0, 0, 218108282, 0
    .long 1, 32, 32, 8192, 7168, 7424, 8388608, 2621440, 32768, 8, 48349184, 131072, 0, 0, 218105722, 0
    .long 1, 16, 16, 8192, 7168, 7424, 8388608, 524288, 32768, 8, 6406144, 131072, 0, 0, 218108282, 0
    .long 1, 24, 24, 8192, 6144, 6400, 8388608, 2621440, 32768, 8, 31555584, 131072, 0, 0, 218105706, 0
    .long 1, 16, 16, 8192, 6144, 6400, 8388608, 2097152, 32768, 8, 12681216, 131072, 0, 0, 218105450, 0
    .long 5, 218108016, 0, 0, 28, 0, 0, 4, 0, 0, 0, 0, 218112384, 8, 218106897, 0
    .long 5, 218108000, 0, 0, 24, 0, 0, 0, 0, 0, 0, 0, 218112384, 4, 218106897, 0
    .long 1, 24, 24, 8192, 7168, 7424, 8388608, 3670016, 32768, 8, 35766272, 131072, 0, 0, 218106234, 0
    .long 2, 64, 72, 7168, 5376, 5376, 7340032, 2097152, 32768, 8, 61952000, 114688, 0, 0, 218104081, 0
    .long 1, 24, 24, 8192, 7680, 7936, 8388608, 2621440, 32768, 8, 31580160, 131072, 0, 0, 218105722, 0
    .long 2, 64, 72, 7168, 5632, 5632, 7340032, 0, 32768, 8, 54616064, 114688, 0, 0, 218103825, 0
    .long 1, 24, 24, 8192, 6144, 6400, 8388608, 3670016, 32768, 8, 35749888, 131072, 0, 0, 218106218, 0
    .long 1, 32, 32, 8192, 6656, 6912, 8388608, 3670016, 32768, 8, 52535296, 131072, 0, 0, 218106218, 0
    .long 2, 64, 72, 7168, 6400, 6400, 7340032, 2621440, 32768, 8, 63803392, 114688, 0, 0, 218104148, 0
    .long 1, 32, 32, 8192, 6656, 6912, 8388608, 2621440, 32768, 8, 48340992, 131072, 0, 0, 218105706, 0
    .long 1, 16, 16, 8192, 6656, 6912, 8388608, 2621440, 32768, 8, 14786560, 131072, 0, 0, 218105706, 0
    .long 2, 64, 72, 7168, 5376, 5376, 7340032, 0, 32768, 8, 54611968, 114688, 0, 0, 218103825, 0
    .long 1, 16, 16, 8192, 7680, 7936, 8388608, 3145728, 32768, 8, 16900096, 131072, 0, 0, 218105978, 0
    .long 1, 24, 24, 8192, 7168, 7424, 8388608, 2621440, 32768, 8, 31571968, 131072, 0, 0, 218105722, 0
    .long 2, 64, 72, 7168, 5632, 5632, 7340032, 524288, 32768, 8, 56451072, 114688, 0, 0, 218103889, 0
    .long 1, 24, 24, 8192, 6144, 6400, 8388608, 3145728, 32768, 8, 33652736, 131072, 0, 0, 218105962, 0
    .long 2, 64, 72, 7168, 6144, 6144, 7340032, 0, 32768, 8, 54624256, 114688, 0, 0, 218103825, 0
    .long 2, 64, 72, 7168, 6144, 6144, 7340032, 524288, 32768, 8, 56459264, 114688, 0, 0, 218103889, 0
    .long 2, 64, 72, 7168, 5888, 5888, 7340032, 2097152, 32768, 8, 61960192, 114688, 0, 0, 218104081, 0
    .long 2, 64, 72, 7168, 6400, 6400, 7340032, 2097152, 32768, 8, 61968384, 114688, 0, 0, 218104081, 0
    .long 1, 16, 16, 8192, 6656, 6912, 8388608, 524288, 32768, 8, 6397952, 131072, 0, 0, 218108266, 0
    .long 1, 16, 16, 8192, 6656, 6912, 8388608, 3145728, 32768, 8, 16883712, 131072, 0, 0, 218105962, 0
    .long 2, 64, 72, 7168, 6400, 6400, 7340032, 0, 32768, 8, 54628352, 114688, 0, 0, 218103825, 0
    .long 2, 64, 72, 7168, 6656, 6656, 7340032, 0, 32768, 8, 54632448, 114688, 0, 0, 218103825, 0
    .long 1, 16, 16, 8192, 7680, 7936, 8388608, 2621440, 32768, 8, 14802944, 131072, 0, 0, 218105722, 0
    .long 1, 24, 24, 8192, 7168, 7424, 8388608, 3145728, 32768, 8, 33669120, 131072, 0, 0, 218105978, 0
    .long 2, 64, 72, 7168, 6656, 6656, 7340032, 3145728, 32768, 8, 65642496, 114688, 0, 0, 218104212, 0
    .long 1, 32, 32, 8192, 6656, 6912, 8388608, 3145728, 32768, 8, 50438144, 131072, 0, 0, 218105962, 0
    .long 1, 16, 16, 8192, 7680, 7936, 8388608, 3670016, 32768, 8, 18997248, 131072, 0, 0, 218106234, 0
    .long 2, 64, 72, 7168, 6912, 6912, 7340032, 0, 32768, 8, 54636544, 114688, 0, 0, 218103825, 0
    .long 2, 64, 72, 7168, 5888, 5888, 7340032, 0, 32768, 8, 54620160, 114688, 0, 0, 218103825, 0
    .long 5, 218108000, 0, 0, 24, 0, 0, 4, 0, 0, 0, 0, 218112384, 8, 218106897, 0
    .long 2, 64, 72, 7168, 6912, 6912, 7340032, 3145728, 32768, 8, 65646592, 114688, 0, 0, 218104212, 0
    .long 2, 64, 72, 7168, 5376, 5376, 7340032, 524288, 32768, 8, 56446976, 114688, 0, 0, 218103889, 0
    .long 2, 64, 72, 7168, 6656, 6656, 7340032, 1572864, 32768, 8, 60137472, 114688, 0, 0, 218104017, 0
    .long 2, 64, 72, 7168, 6912, 6912, 7340032, 524288, 32768, 8, 56471552, 114688, 0, 0, 218103889, 0
    .long 1, 16, 16, 8192, 6144, 6400, 8388608, 3670016, 32768, 8, 18972672, 131072, 0, 0, 218106218, 0
    .long 5, 218108272, 0, 0, 28, 0, 0, 8, 0, 0, 0, 0, 218112384, 12, 218106961, 0
    .long 2, 64, 72, 7168, 5376, 5376, 7340032, 3145728, 32768, 8, 65622016, 114688, 0, 0, 218104212, 0
    .long 2, 64, 72, 7168, 5888, 5888, 7340032, 1572864, 32768, 8, 60125184, 114688, 0, 0, 218104017, 0
    .long 2, 64, 72, 7168, 6144, 6144, 7340032, 2097152, 32768, 8, 61964288, 114688, 0, 0, 218104081, 0
    .long 2, 64, 72, 7168, 5376, 5376, 7340032, 1572864, 32768, 8, 60116992, 114688, 0, 0, 218104017, 0
    .long 2, 64, 72, 7168, 6144, 6144, 7340032, 1572864, 32768, 8, 60129280, 114688, 0, 0, 218104017, 0
    .long 2, 64, 72, 7168, 6912, 6912, 7340032, 1572864, 32768, 8, 60141568, 114688, 0, 0, 218104017, 0
    .long 2, 64, 72, 7168, 5632, 5632, 7340032, 1572864, 32768, 8, 60121088, 114688, 0, 0, 218104017, 0
    .long 2, 64, 72, 7168, 5632, 5632, 7340032, 2097152, 32768, 8, 61956096, 114688, 0, 0, 218104081, 0
    .long 2, 64, 72, 7168, 6656, 6656, 7340032, 2097152, 32768, 8, 61972480, 114688, 0, 0, 218104081, 0
    .long 2, 64, 72, 7168, 5888, 5888, 7340032, 524288, 32768, 8, 56455168, 114688, 0, 0, 218103889, 0
    .long 2, 64, 72, 7168, 6912, 6912, 7340032, 2097152, 32768, 8, 61976576, 114688, 0, 0, 218104081, 0
    .long 2, 64, 72, 7168, 6400, 6400, 7340032, 1572864, 32768, 8, 60133376, 114688, 0, 0, 218104017, 0
    .long 2, 64, 72, 7168, 5632, 5632, 7340032, 1048576, 32768, 8, 58286080, 114688, 0, 0, 218103953, 0
    .long 2, 64, 72, 7168, 6400, 6400, 7340032, 1048576, 32768, 8, 58298368, 114688, 0, 0, 218103953, 0
    .long 2, 64, 72, 7168, 5888, 5888, 7340032, 3145728, 32768, 8, 65630208, 114688, 0, 0, 218104212, 0
    .long 2, 64, 72, 7168, 6656, 6656, 7340032, 1048576, 32768, 8, 58302464, 114688, 0, 0, 218103953, 0
    .long 5, 218108272, 0, 0, 28, 0, 0, 12, 0, 0, 0, 0, 218112384, 16, 218106961, 0
    .long 2, 64, 72, 7168, 6912, 6912, 7340032, 1048576, 32768, 8, 58306560, 114688, 0, 0, 218103953, 0
    .long 2, 64, 72, 7168, 6400, 6400, 7340032, 3145728, 32768, 8, 65638400, 114688, 0, 0, 218104212, 0
    .long 2, 64, 72, 7168, 6656, 6656, 7340032, 524288, 32768, 8, 56467456, 114688, 0, 0, 218103889, 0
    .long 2, 64, 72, 7168, 6144, 6144, 7340032, 1048576, 32768, 8, 58294272, 114688, 0, 0, 218103953, 0
    .long 2, 64, 72, 7168, 5888, 5888, 7340032, 1048576, 32768, 8, 58290176, 114688, 0, 0, 218103953, 0
    .long 2, 64, 72, 7168, 5632, 5632, 7340032, 3145728, 32768, 8, 65626112, 114688, 0, 0, 218104212, 0
    .long 5, 218108256, 0, 0, 24, 0, 0, 12, 0, 0, 0, 0, 218112384, 16, 218106961, 0
    .long 2, 64, 72, 7168, 6144, 6144, 7340032, 3670016, 32768, 8, 67469312, 114688, 0, 0, 218104276, 0
    .long 2, 64, 72, 7168, 6400, 6400, 7340032, 524288, 32768, 8, 56463360, 114688, 0, 0, 218103889, 0
    .long 1, 80, 80, 2048, 3671552, 3671808, 7340032, 54583296, 114688, 14, 121659392, 32768, 218103824, 14, 218106370, 0
    .long 1, 40, 40, 2048, 4195328, 4195584, 8388608, 176226304, 131072, 16, 79708160, 32768, 218106896, 8, 218106376, 0
    .long 5, 218108256, 0, 0, 24, 0, 0, 8, 0, 0, 0, 0, 218112384, 12, 218106961, 0
    .long 1, 32, 32, 8192, 6144, 6400, 8388608, 3670016, 32768, 8, 52527104, 131072, 0, 0, 218106218, 0
    .long 1, 16, 16, 8192, 6656, 6912, 8388608, 3670016, 32768, 8, 18980864, 131072, 0, 0, 218106218, 0
    .long 1, 16, 16, 8192, 7168, 7424, 8388608, 3670016, 32768, 8, 18989056, 131072, 0, 0, 218106234, 0
    .long 1, 40, 40, 2048, 4195840, 4196096, 8388608, 182517760, 131072, 16, 81289216, 32768, 218112384, 33, 218106568, 0
    .long 1, 40, 40, 2048, 4195840, 4196096, 8388608, 176226304, 131072, 16, 79716352, 32768, 218106896, 8, 218106376, 0
    .long 2, 64, 72, 7168, 6144, 6144, 7340032, 3145728, 32768, 8, 65634304, 114688, 0, 0, 218104212, 0
    .long 1, 40, 40, 2048, 4195328, 4195584, 8388608, 180420608, 131072, 16, 80756736, 32768, 218112384, 25, 218106504, 0
    .long 1, 40, 40, 2048, 4195840, 4196096, 8388608, 180420608, 131072, 16, 80764928, 32768, 218112384, 25, 218106504, 0
    .long 2, 64, 72, 7168, 6656, 6656, 7340032, 2621440, 32768, 8, 63807488, 114688, 0, 0, 218104148, 0
    .long 1, 40, 40, 2048, 4195328, 4195584, 8388608, 182517760, 131072, 16, 81281024, 32768, 218112384, 33, 218106568, 0
    .long 2, 64, 72, 7168, 5376, 5376, 7340032, 2621440, 32768, 8, 63787008, 114688, 0, 0, 218104148, 0
    .long 1, 80, 80, 2048, 3671040, 3671296, 7340032, 54583296, 114688, 14, 121651200, 32768, 218103824, 14, 218106370, 0
    .long 2, 64, 72, 7168, 6912, 6912, 7340032, 2621440, 32768, 8, 63811584, 114688, 0, 0, 218104148, 0
    .long 2, 64, 72, 7168, 5632, 5632, 7340032, 2621440, 32768, 8, 63791104, 114688, 0, 0, 218104148, 0
    .long 2, 64, 72, 7168, 5888, 5888, 7340032, 3670016, 32768, 8, 67465216, 114688, 0, 0, 218104276, 0
    .long 2, 64, 72, 7168, 6656, 6656, 7340032, 3670016, 32768, 8, 67477504, 114688, 0, 0, 218104276, 0
    .long 1, 40, 40, 2048, 4195328, 4195584, 8388608, 178323456, 131072, 16, 80232448, 32768, 218106960, 8, 218106440, 0
    .long 1, 40, 40, 2048, 4195840, 4196096, 8388608, 178323456, 131072, 16, 80240640, 32768, 218106960, 8, 218106440, 0
    .long 2, 64, 72, 7168, 6144, 6144, 7340032, 2621440, 32768, 8, 63799296, 114688, 0, 0, 218104148, 0
    .long 2, 64, 72, 7168, 5376, 5376, 7340032, 3670016, 32768, 8, 67457024, 114688, 0, 0, 218104276, 0
    .long 2, 64, 72, 7168, 5888, 5888, 7340032, 2621440, 32768, 8, 63795200, 114688, 0, 0, 218104148, 0
    .long 1, 80, 80, 2048, 3671552, 3671808, 7340032, 61923328, 114688, 14, 123756544, 32768, 218104080, 14, 218106626, 0
    .long 1, 80, 80, 2048, 3671040, 3671296, 7340032, 60088320, 114688, 14, 123224064, 32768, 218104016, 14, 218106562, 0
    .long 1, 80, 80, 2048, 3671040, 3671296, 7340032, 61923328, 114688, 14, 123748352, 32768, 218104080, 14, 218106626, 0
    .long 1, 80, 80, 2048, 3671552, 3671808, 7340032, 60088320, 114688, 14, 123232256, 32768, 218104016, 14, 218106562, 0
    .long 2, 64, 72, 7168, 6400, 6400, 7340032, 3670016, 32768, 8, 67473408, 114688, 0, 0, 218104276, 0
    .long 2, 64, 72, 7168, 5632, 5632, 7340032, 3670016, 32768, 8, 67461120, 114688, 0, 0, 218104276, 0
    .long 1, 80, 80, 2048, 3671040, 3671296, 7340032, 58253312, 114688, 14, 122699776, 32768, 218103952, 14, 218106498, 0
    .long 1, 80, 80, 2048, 3671552, 3671808, 7340032, 58253312, 114688, 14, 122707968, 32768, 218103952, 14, 218106498, 0
    .long 2, 64, 72, 7168, 6912, 6912, 7340032, 3670016, 32768, 8, 67481600, 114688, 0, 0, 218104276, 0
    .long 1, 80, 80, 2048, 3671552, 3671808, 7340032, 56418304, 114688, 14, 122183680, 32768, 218103888, 14, 218106434, 0
    .long 1, 80, 80, 2048, 3671040, 3671296, 7340032, 56418304, 114688, 14, 122175488, 32768, 218103888, 14, 218106434, 0
    .long 1, 40, 40, 2048, 6291968, 6292224, 8388608, 184647680, 131072, 8, 90185728, 32768, 218112384, 41, 218106628, 0
    .long 1, 80, 80, 2048, 5505024, 5505280, 7340032, 65622016, 114688, 7, 133169152, 32768, 218104212, 7, 218106753, 0
    .long 1, 80, 80, 2048, 5505536, 5505792, 7340032, 65622016, 114688, 7, 133177344, 32768, 218104212, 7, 218106753, 0
    .long 1, 40, 40, 2048, 6291456, 6291712, 8388608, 184647680, 131072, 8, 90177536, 32768, 218112384, 41, 218106628, 0
    .long 1, 80, 80, 2048, 5506560, 5506816, 7340032, 65622016, 114688, 7, 133193728, 32768, 218104212, 7, 218106753, 0
    .long 1, 40, 40, 2048, 6292480, 6292736, 8388608, 184647680, 131072, 8, 90193920, 32768, 218112384, 41, 218106628, 0
    .long 1, 40, 40, 2048, 6292992, 6293248, 8388608, 184647680, 131072, 8, 90202112, 32768, 218112384, 41, 218106628, 0
    .long 1, 40, 40, 2048, 6291968, 6292224, 8388608, 186744832, 131072, 8, 90710016, 32768, 218112384, 49, 218106692, 0
    .long 1, 80, 80, 2048, 5506048, 5506304, 7340032, 65622016, 114688, 7, 133185536, 32768, 218104212, 7, 218106753, 0
    .long 1, 40, 40, 2048, 6292480, 6292736, 8388608, 186744832, 131072, 8, 90718208, 32768, 218112384, 49, 218106692, 0
    .long 1, 40, 40, 2048, 6291456, 6291712, 8388608, 186744832, 131072, 8, 90701824, 32768, 218112384, 49, 218106692, 0
    .long 1, 40, 40, 2048, 6292992, 6293248, 8388608, 186744832, 131072, 8, 90726400, 32768, 218112384, 49, 218106692, 0
    .long 1, 80, 80, 2048, 5506048, 5506304, 7340032, 63787008, 114688, 7, 132661248, 32768, 218104148, 7, 218106689, 0
    .long 1, 80, 80, 2048, 5506560, 5506816, 7340032, 63787008, 114688, 7, 132669440, 32768, 218104148, 7, 218106689, 0
    .long 1, 80, 80, 2048, 5505024, 5505280, 7340032, 63787008, 114688, 7, 132644864, 32768, 218104148, 7, 218106689, 0
    .long 1, 80, 80, 2048, 5505536, 5505792, 7340032, 63787008, 114688, 7, 132653056, 32768, 218104148, 7, 218106689, 0
    .long 1, 80, 80, 2048, 5505536, 5505792, 7340032, 67457024, 114688, 7, 133701632, 32768, 218104276, 7, 218106817, 0
    .long 1, 80, 80, 2048, 5506048, 5506304, 7340032, 67457024, 114688, 7, 133709824, 32768, 218104276, 7, 218106817, 0
    .long 1, 80, 80, 2048, 5506560, 5506816, 7340032, 67457024, 114688, 7, 133718016, 32768, 218104276, 7, 218106817, 0
    .long 1, 80, 80, 2048, 5505024, 5505280, 7340032, 67457024, 114688, 7, 133693440, 32768, 218104276, 7, 218106817, 0
    .long 6, 1, 3, 2, 3, 16, 0, 3, 0, 0, 0, 0, 0, 0, 0, 0
    .long 6, 0, 51, 0, 3, 0, 0, 51, 0, 0, 0, 0, 0, 0, 0, 0
    .long 6, 1, 1, 2, 3, 16, 0, 1, 0, 0, 0, 0, 0, 0, 0, 0
    .long 6, 1, 0, 2, 3, 16, 0, 0, 0, 0, 0, 0, 0, 0, 0, 0
    .long 6, 1, 5, 2, 3, 16, 0, 5, 0, 0, 0, 0, 0, 0, 0, 0
    .long 6, 1, 4, 2, 3, 16, 0, 4, 0, 0, 0, 0, 0, 0, 0, 0
    .long 6, 1, 22, 2, 3, 16, 0, 22, 0, 0, 0, 0, 0, 0, 0, 0
    .long 6, 1, 6, 2, 3, 16, 0, 6, 0, 0, 0, 0, 0, 0, 0, 0
    .long 6, 1, 18, 2, 3, 16, 0, 18, 0, 0, 0, 0, 0, 0, 0, 0
    .long 6, 1, 19, 2, 3, 16, 0, 19, 0, 0, 0, 0, 0, 0, 0, 0
    .long 6, 1, 20, 2, 3, 16, 0, 20, 0, 0, 0, 0, 0, 0, 0, 0
    .long 6, 1, 7, 2, 3, 16, 0, 7, 0, 0, 0, 0, 0, 0, 0, 0
    .long 6, 1, 2, 2, 3, 16, 0, 2, 0, 0, 0, 0, 0, 0, 0, 0
    .long 6, 1, 17, 2, 3, 16, 0, 17, 0, 0, 0, 0, 0, 0, 0, 0
    .long 6, 1, 21, 2, 3, 16, 0, 21, 0, 0, 0, 0, 0, 0, 0, 0
    .long 6, 1, 16, 2, 3, 16, 0, 16, 0, 0, 0, 0, 0, 0, 0, 0
    .long 6, 0, 50, 0, 3, 0, 0, 50, 0, 0, 0, 0, 0, 0, 0, 0
    .long 6, 0, 52, 0, 3, 0, 0, 52, 0, 0, 0, 0, 0, 0, 0, 0
    .long 6, 0, 54, 0, 3, 0, 0, 54, 0, 0, 0, 0, 0, 0, 0, 0
    .long 6, 0, 49, 0, 3, 0, 0, 49, 0, 0, 0, 0, 0, 0, 0, 0
    .long 6, 0, 48, 0, 3, 0, 0, 48, 0, 0, 0, 0, 0, 0, 0, 0
    .long 6, 0, 53, 0, 3, 0, 0, 53, 0, 0, 0, 0, 0, 0, 0, 0
    .long 6, 0, 55, 0, 3, 0, 0, 55, 0, 0, 0, 0, 0, 0, 0, 0
    .long 6, 0, 56, 0, 3, 0, 0, 56, 0, 0, 0, 0, 0, 0, 0, 0
    .long 6, 1, 23, 2, 3, 16, 0, 23, 0, 0, 0, 0, 0, 0, 0, 0
    .long 6, 1, 24, 2, 3, 16, 0, 24, 0, 0, 0, 0, 0, 0, 0, 0
    .long 6, 1, 25, 2, 3, 16, 0, 25, 0, 0, 0, 0, 0, 0, 0, 0
    .long 6, 1, 26, 2, 3, 16, 0, 26, 0, 0, 0, 0, 0, 0, 0, 0
    .long 6, 1, 27, 2, 3, 16, 0, 27, 0, 0, 0, 0, 0, 0, 0, 0
    .long 6, 1, 28, 2, 3, 16, 0, 28, 0, 0, 0, 0, 0, 0, 0, 0
    .long 6, 1, 29, 2, 3, 16, 0, 29, 0, 0, 0, 0, 0, 0, 0, 0
    .long 6, 1, 30, 2, 3, 16, 0, 30, 0, 0, 0, 0, 0, 0, 0, 0
    .long 6, 1, 31, 2, 3, 16, 0, 31, 0, 0, 0, 0, 0, 0, 0, 0
    .long 6, 0, 40, 1, 3, 16, 0, 40, 0, 0, 0, 0, 0, 0, 0, 0
    .long 6, 0, 41, 1, 3, 16, 0, 41, 0, 0, 0, 0, 0, 0, 0, 0
    .long 6, 0, 43, 1, 3, 16, 0, 43, 0, 0, 0, 0, 0, 0, 0, 0
    .long 6, 0, 45, 1, 3, 16, 0, 45, 0, 0, 0, 0, 0, 0, 0, 0
    .long 6, 0, 46, 1, 3, 16, 0, 46, 0, 0, 0, 0, 0, 0, 0, 0
    .long 6, 0, 47, 1, 3, 16, 0, 47, 0, 0, 0, 0, 0, 0, 0, 0
    .long 6, 1, 32, 1, 3, 16, 0, 32, 0, 0, 0, 0, 0, 0, 0, 0
    .long 6, 1, 33, 1, 3, 16, 0, 33, 0, 0, 0, 0, 0, 0, 0, 0
    .long 6, 1, 35, 1, 3, 16, 0, 35, 0, 0, 0, 0, 0, 0, 0, 0
    .long 6, 1, 36, 1, 3, 16, 0, 36, 0, 0, 0, 0, 0, 0, 0, 0
    .long 6, 1, 38, 1, 3, 16, 0, 38, 0, 0, 0, 0, 0, 0, 0, 0
    .long 6, 1, 39, 1, 3, 16, 0, 39, 0, 0, 0, 0, 0, 0, 0, 0
    .long 6, 0, 57, 0, 3, 0, 0, 57, 0, 0, 0, 0, 0, 0, 0, 0
    .long 6, 0, 44, 1, 3, 16, 0, 44, 0, 0, 0, 0, 0, 0, 0, 0
    .long 6, 1, 34, 1, 3, 16, 0, 34, 0, 0, 0, 0, 0, 0, 0, 0
    .long 6, 0, 58, 0, 3, 0, 0, 58, 0, 0, 0, 0, 0, 0, 0, 0
    .long 6, 1, 37, 1, 3, 16, 0, 37, 0, 0, 0, 0, 0, 0, 0, 0
    .long 6, 0, 42, 1, 3, 16, 0, 42, 0, 0, 0, 0, 0, 0, 0, 0
    .long 6, 0, 59, 0, 3, 0, 0, 59, 0, 0, 0, 0, 0, 0, 0, 0
    .long 6, 1, 8, 2, 3, 16, 0, 8, 0, 0, 0, 0, 0, 0, 0, 0
    .long 6, 1, 9, 2, 3, 16, 0, 9, 0, 0, 0, 0, 0, 0, 0, 0
    .long 6, 1, 10, 2, 3, 16, 0, 10, 0, 0, 0, 0, 0, 0, 0, 0
    .long 6, 1, 11, 2, 3, 16, 0, 11, 0, 0, 0, 0, 0, 0, 0, 0
    .long 6, 1, 12, 2, 3, 16, 0, 12, 0, 0, 0, 0, 0, 0, 0, 0
    .long 6, 1, 13, 2, 3, 16, 0, 13, 0, 0, 0, 0, 0, 0, 0, 0
    .long 6, 1, 14, 2, 3, 16, 0, 14, 0, 0, 0, 0, 0, 0, 0, 0
    .long 6, 1, 15, 2, 3, 16, 0, 15, 0, 0, 0, 0, 0, 0, 0, 0
    .long 7, 0, 60, 0, 12, 0, 0, 60, 0, 0, 0, 0, 0, 0, 0, 0
    .long 7, 0, 60, 0, 13, 0, 0, 60, 0, 0, 0, 0, 0, 0, 0, 0
    .long 7, 0, 60, 0, 14, 0, 0, 60, 0, 0, 0, 0, 0, 0, 0, 0
    .long 7, 0, 60, 0, 15, 0, 0, 60, 0, 0, 0, 0, 0, 0, 0, 0
    .long 7, 0, 61, 0, 12, 0, 0, 61, 0, 0, 0, 0, 0, 0, 0, 0
    .long 7, 0, 61, 0, 13, 0, 0, 61, 0, 0, 0, 0, 0, 0, 0, 0
    .long 7, 0, 61, 0, 14, 0, 0, 61, 0, 0, 0, 0, 0, 0, 0, 0
    .long 7, 0, 61, 0, 15, 0, 0, 61, 0, 0, 0, 0, 0, 0, 0, 0
    .long 7, 0, 62, 0, 12, 0, 0, 62, 0, 0, 0, 0, 0, 0, 0, 0
    .long 7, 0, 62, 0, 13, 0, 0, 62, 0, 0, 0, 0, 0, 0, 0, 0
    .long 7, 0, 62, 0, 14, 0, 0, 62, 0, 0, 0, 0, 0, 0, 0, 0
    .long 7, 0, 62, 0, 15, 0, 0, 62, 0, 0, 0, 0, 0, 0, 0, 0
    .long 7, 0, 63, 0, 12, 0, 0, 63, 0, 0, 0, 0, 0, 0, 0, 0
    .long 7, 0, 63, 0, 13, 0, 0, 63, 0, 0, 0, 0, 0, 0, 0, 0
    .long 7, 0, 63, 0, 14, 0, 0, 63, 0, 0, 0, 0, 0, 0, 0, 0
    .long 7, 0, 63, 0, 15, 0, 0, 63, 0, 0, 0, 0, 0, 0, 0, 0
    .long 0, 0, 0, 0, 0, 0, 0, 0, 0, 0, 0, 0, 0, 0, 0, 0
.p2align 6
.amdhsa_kernel recurrent_scan__memory_aug_recurrent_mem_tr__glu_gated_glu__prompt_kernel
  .amdhsa_next_free_vgpr 256
  .amdhsa_next_free_sgpr 102
  .amdhsa_accum_offset 256
  .amdhsa_group_segment_fixed_size 0
  .amdhsa_kernarg_size 112
  .amdhsa_user_sgpr_count 2
  .amdhsa_user_sgpr_kernarg_segment_ptr 1
  .amdhsa_system_sgpr_workgroup_id_x 1
  .amdhsa_float_denorm_mode_32 3
.end_amdhsa_kernel
```
